```python
import torch

def _softmax(x, axis=-1):
    return torch.softmax(x, dim=axis)

def _gelu(x):
    return torch.nn.functional.gelu(x, approximate='tanh')

def _silu(x):
    return torch.nn.functional.silu(x)

def _sigmoid(x):
    return torch.sigmoid(x)

def _layernorm(x, axis=-1, eps=1e-05):
    m = x.mean(dim=axis, keepdim=True)
    v = x.var(dim=axis, keepdim=True, unbiased=False)
    return (x - m) / torch.sqrt(v + eps)

def _scatter_add(tgt, idx, src, axis=0):
    return tgt.clone().index_add_(axis, idx, src)

def _segment_sum(src, seg, n):
    out = torch.zeros((n,) + src.shape[1:], dtype=src.dtype)
    return out.index_add_(0, seg, src)

def _pad(x, pw):
    flat = tuple((v for pair in reversed(pw) for v in pair))
    return torch.nn.functional.pad(x, flat)
kernel_name = 'adaLN_cond__spectral_fnet__moe_arch_mod__prompt'

def setup_inputs():

    _w = lambda a: (lambda t: t.to(torch.bfloat16) if t.is_floating_point() else t)(torch.as_tensor(a))

    def _A_setup():
        B, S, D = (1, 2048, 1024)
        ns = torch.arange(S)[:, None] * torch.arange(S)[None, :]
        nd = torch.arange(D)[:, None] * torch.arange(D)[None, :]
        Ws_re = torch.cos(-2.0 * torch.pi * ns / S).to(float)
        Ws_im = torch.sin(-2.0 * torch.pi * ns / S).to(float)
        Wd_re = torch.cos(-2.0 * torch.pi * nd / D).to(float)
        Wd_im = torch.sin(-2.0 * torch.pi * nd / D).to(float)
        return {'x': _w((lambda *s: torch.randn(*s, dtype=torch.bfloat16) * 0.1)(B, S, D)), 'dft_seq_re': _w(Ws_re), 'dft_seq_im': _w(Ws_im), 'dft_hid_re': _w(Wd_re), 'dft_hid_im': _w(Wd_im)}
    _A_in = _A_setup()

    def _B_setup():
        B, S, D, F, C = (1, 2048, 1024, 3584, 2)
        return {'x': _w((lambda *s: torch.randn(*s, dtype=torch.bfloat16) * 0.1)(B, S, D)), 'w_r': _w((lambda *s: torch.randn(*s, dtype=torch.bfloat16) * 1.6)(D)), 'w_gate': _w((lambda *s: torch.randn(*s, dtype=torch.bfloat16) * 0.8)(D, F)), 'w_up': _w((lambda *s: torch.randn(*s, dtype=torch.bfloat16) * 0.8)(D, F)), 'w_down': _w((lambda *s: torch.randn(*s, dtype=torch.bfloat16) * 0.8)(F, D))}
    _B_in = _B_setup()
    return {'A_x': _A_in['x'], 'A_dft_seq_re': _A_in['dft_seq_re'], 'A_dft_seq_im': _A_in['dft_seq_im'], 'A_dft_hid_re': _A_in['dft_hid_re'], 'A_dft_hid_im': _A_in['dft_hid_im'], 'B_x': _B_in['x'], 'B_w_r': _B_in['w_r'], 'B_w_gate': _B_in['w_gate'], 'B_w_up': _B_in['w_up'], 'B_w_down': _B_in['w_down'], 'c': _w((lambda *s: torch.randn(*s, dtype=torch.bfloat16) * 0.1)(1, 1024) * 8.0), 'w_mod': _w((lambda *s: torch.randn(*s, dtype=torch.bfloat16) * 0.1)(1024, 6 * 1024) * 1024 ** (-0.5) * 8.0)}

def reference(A_x, A_dft_seq_re, A_dft_seq_im, A_dft_hid_re, A_dft_hid_im, B_x, B_w_r, B_w_gate, B_w_up, B_w_down, c, w_mod):

    def _A_ref(x, dft_seq_re, dft_seq_im, dft_hid_re, dft_hid_im):
        a = torch.einsum('bsd,ed->bse', x, dft_hid_re)
        b = torch.einsum('bsd,ed->bse', x, dft_hid_im)
        y = torch.einsum('ts,bse->bte', dft_seq_re, a) - torch.einsum('ts,bse->bte', dft_seq_im, b)
        return y

    def _B_ref(x, w_r, w_gate, w_up, w_down):
        B, S, D = x.shape
        C = 2
        r = x @ w_r
        idx = torch.argsort(-r, axis=-1)[:, :C]
        idx_e = (lambda x, n, axis: torch.repeat_interleave(x, n, dim=axis))(idx.reshape(B, C, 1), D, axis=2)
        x_sel = (lambda x, i, axis: torch.take_along_dim(x, i, dim=axis))(x, idx_e, axis=1)
        g = _silu(x_sel @ w_gate)
        u = x_sel @ w_up
        y = g * u @ w_down
        r_sel = _sigmoid((lambda x, i, axis: torch.take_along_dim(x, i, dim=axis))(r, idx, axis=1))
        y = y * r_sel.reshape(B, C, 1)
        b_off = (torch.arange(B) * S).reshape(B, 1)
        flat_idx = (idx + b_off).reshape(B * C)
        zero = (x * 0.0).reshape(B * S, D)
        upd = _scatter_add(zero, flat_idx, y.reshape(B * C, D), axis=0)
        return x + upd.reshape(B, S, D)
    x = A_x
    mod = (_silu(c) @ w_mod).reshape(c.shape[0], 6, 1, -1)
    sa, ca, ga, sb, cb, gb = (mod[:, 0].clone(), mod[:, 1].clone(), mod[:, 2].clone(), mod[:, 3].clone(), mod[:, 4].clone(), mod[:, 5].clone())
    h = _layernorm(x, axis=-1) * (1 + ca) + sa
    x = x + ga * _A_ref(h, A_dft_seq_re, A_dft_seq_im, A_dft_hid_re, A_dft_hid_im)
    h = _layernorm(x, axis=-1) * (1 + cb) + sb
    x = x + gb * _B_ref(h, B_w_r, B_w_gate, B_w_up, B_w_down)
    return x
```

```asm
; @launch grid=(256,1,1) block=(512,1,1) lds=139264
.amdgcn_target "amdgcn-amd-amdhsa--gfx950"
.text
.globl adaLN_cond__spectral_fnet__moe_arch_mod__prompt_kernel
.p2align 8
.type adaLN_cond__spectral_fnet__moe_arch_mod__prompt_kernel,@function
adaLN_cond__spectral_fnet__moe_arch_mod__prompt_kernel:
    s_cmp_ge_u32 s2, 256
    s_cbranch_scc1 k_done
    s_load_dwordx2 s[4:5], s[0:1], 0
    s_load_dwordx8 s[20:27], s[0:1], 80
    s_load_dwordx2 s[6:7], s[0:1], 112
    s_load_dwordx8 s[48:55], s[0:1], 48
    s_getpc_b64 s[62:63]
k_pc:
    v_lshrrev_b32 v1, 6, v0
    v_and_b32 v2, 63, v0
    v_readfirstlane_b32 s16, v1
    v_lshlrev_b32 v3, 4, v2
    s_and_b32 s34, s2, 7
    s_lshr_b32 s35, s2, 4
    s_bitcmp1_b32 s2, 3
    s_cbranch_scc0 f_start
    s_lshl_b32 s40, s35, 3
    s_add_u32 s40, s40, s16
    s_lshl_b32 s40, s40, 9
    v_lshl_add_u32 v4, v2, 7, s40
    v_min_u32 v4, tab_end-k_pc-4, v4
    s_mov_b64 exec, 15
    global_load_dword v250, v4, s[62:63]
    s_mov_b64 exec, -1
    v_bfe_u32 v7, v0, 4, 2
    v_lshlrev_b32 v4, 1, v7
    v_xor_b32 v4, v4, v0
    v_and_b32 v4, 15, v4
    v_lshlrev_b32 v4, 4, v4
    s_movk_i32 s42, 12288
    v_mad_u32_u24 v4, v7, s42, v4
    v_xor_b32 v31, 0x80, v4
    s_and_b32 s17, s35, 7
    s_lshr_b32 s41, s35, 3
    s_lshl_b32 s18, s34, 3
    s_add_u32 s18, s18, s16
    s_mul_i32 s18, s18, 196608
    s_lshl_b32 s68, s16, 12
    s_xor_b32 s70, s35, 8
    s_lshl_b32 s70, s70, 8
    s_add_u32 s70, s70, s18
    s_mov_b32 s10, 12582912
    s_mov_b32 s11, 0x00020000
    s_mov_b32 m0, s68
    s_waitcnt lgkmcnt(0)
    s_mov_b32 s8, s22
    s_mov_b32 s9, s23
    buffer_load_dwordx4 v4, s[8:11], s70 offen offset:0  lds
    s_add_u32 s70, s70, 48128
    buffer_load_dwordx4 v4, s[8:11], s70 offen offset:1024  lds
    s_add_u32 s70, s70, 48128
    buffer_load_dwordx4 v31, s[8:11], s70 offen offset:2048  lds
    s_add_u32 s70, s70, 48128
    buffer_load_dwordx4 v31, s[8:11], s70 offen offset:3072  lds
    s_branch g_start
f_start:
    s_add_u32 s62, s62, tables-k_pc
    s_addc_u32 s63, s63, 0
    s_lshl_b32 s43, s16, 11
    v_add_u32 v79, s43, v3
    s_add_u32 s40, s43, 33280
    s_lshl_b32 s42, s16, 10
    s_add_u32 s43, s42, 16384
    s_cmp_eq_u32 s34, 0
    s_cselect_b32 s68, 8192, 0
    s_add_u32 s43, s43, s68
    v_add_u32 v77, s43, v3
    s_or_b32 s69, s34, s16
    s_cselect_b32 s68, 0, 2048
    s_add_u32 s68, s68, 32768
    v_add_u32 v78, s68, v3
    global_load_dwordx4 v[20:23], v77, s[62:63]
    global_load_dwordx4 v[24:27], v78, s[62:63]
    global_load_dwordx4 v[28:31], v78, s[62:63] offset:1024
    s_sub_u32 s17, 16, s34
    s_cmp_eq_u32 s34, 0
    s_cselect_b32 s17, 8, s17
    s_bitcmp1_b32 s35, 0
    s_cselect_b32 s17, s17, s34
    s_lshr_b32 s36, s35, 1
    s_lshl_b32 s36, s36, 4
    s_add_u32 s17, s17, s36
    s_lshl_b32 s36, s16, 8
    s_add_u32 s36, s36, s17
    s_lshl_b32 s36, s36, 11
    s_add_u32 s37, s36, 262144
    s_mov_b32 s10, 4194304
    s_mov_b32 s11, 0x00020000
    v_and_b32 v170, 15, v0
    v_bfe_u32 v171, v0, 4, 2
    v_lshrrev_b32 v72, 1, v170
    v_and_b32 v73, 1, v0
    v_cmp_eq_u32 vcc, 1, v170
    v_mov_b32 v74, s17
    s_nop 0
    v_cndmask_b32_e64 v72, v72, 8, vcc
    v_cndmask_b32_e64 v74, v74, 0, vcc
    v_cndmask_b32_e64 v73, v73, 0, vcc
    v_lshl_add_u32 v74, v171, 9, v74
    s_waitcnt lgkmcnt(0)
    s_mov_b32 s8, s4
    s_mov_b32 s9, s5
    buffer_load_dwordx4 v[32:35], v3, s[8:11], s36 offen offset:0
    buffer_load_dwordx4 v[40:43], v3, s[8:11], s37 offen offset:0
    buffer_load_dwordx4 v[36:39], v3, s[8:11], s36 offen offset:1024
    buffer_load_dwordx4 v[44:47], v3, s[8:11], s37 offen offset:1024
    s_mov_b32 s43, 6619136
    s_load_dword s101, s[6:7], s43
    s_mov_b32 s12, s6
    s_mov_b32 s13, s7
    s_mov_b32 s14, 268435456
    s_mov_b32 s15, 0x00020000
    s_mov_b32 s20, s52
    s_mov_b32 s21, s53
    s_mov_b32 s22, 7340032
    s_mov_b32 s23, 0x00020000
    s_mov_b32 s52, s48
    s_mov_b32 s53, s49
    s_mov_b32 s54, 2048
    s_mov_b32 s55, 0x00020000
    s_mov_b32 s26, 4194304
    s_mov_b32 s27, 0x00020000
    s_getreg_b32 s39, hwreg(HW_REG_XCC_ID)
    s_and_b32 s39, s39, 7
    v_mul_u32_u24 v74, v72, v74
    v_lshl_add_u32 v74, v73, 9, v74
    v_lshlrev_b32 v72, 7, v72
    v_and_b32 v48, 2047, v74
    v_add_u32 v74, v74, v72
    v_and_b32 v49, 2047, v74
    v_add_u32 v74, v74, v72
    v_and_b32 v50, 2047, v74
    v_add_u32 v74, v74, v72
    v_and_b32 v51, 2047, v74
    v_cvt_f32_u32 v48, v48
    v_cvt_f32_u32 v49, v49
    v_cvt_f32_u32 v50, v50
    v_cvt_f32_u32 v51, v51
    v_mul_f32 v48, 0x3a000000, v48
    v_mul_f32 v49, 0x3a000000, v49
    v_mul_f32 v50, 0x3a000000, v50
    v_mul_f32 v51, 0x3a000000, v51
    v_cos_f32 v48, v48
    v_cos_f32 v49, v49
    v_cos_f32 v50, v50
    v_cos_f32 v51, v51
    v_mul_f32 v48, 0x3d800000, v48
    v_mul_f32 v49, 0x3d800000, v49
    v_mul_f32 v50, 0x3d800000, v50
    v_mul_f32 v51, 0x3d800000, v51
    v_lshlrev_b32 v160, 20, v171
    v_lshl_add_u32 v160, v1, 15, v160
    v_lshl_add_u32 v160, v170, 4, v160
    v_mul_u32_u24 v161, 4128, v1
    v_add_u32 v161, v161, v3
    v_lshrrev_b32 v72, 2, v2
    v_mul_u32_u24 v162, 2064, v72
    v_and_b32 v72, 3, v0
    v_lshl_add_u32 v162, v72, 7, v162
    v_lshl_add_u32 v162, v1, 3, v162
    v_lshlrev_b32 v163, 4, v171
    v_add_u32 v163, 103040, v163
    v_lshlrev_b32 v164, 3, v171
    v_add_u32 v164, 103104, v164
    v_lshrrev_b32 v72, 5, v0
    v_lshlrev_b32 v165, 2, v72
    v_add_u32 v11, 102912, v165
    v_add_u32 v165, 103040, v165
    v_lshlrev_b32 v166, 1, v72
    v_add_u32 v166, 103104, v166
    v_mov_b32 v168, 0
    v_and_b32 v172, 255, v0
    v_lshlrev_b32 v172, 3, v172
    v_and_b32 v169, 1, v0
    v_lshlrev_b32 v169, 3, v169
    s_lshl_b32 s3, s34, 4
    s_and_b32 s64, s35, 1
    s_lshl_b32 s64, s64, 3
    s_lshr_b32 s65, s35, 1
    s_add_u32 s64, s64, s65
    s_and_b32 s65, s16, 3
    s_xor_b32 s64, s64, s65
    s_add_u32 s64, s64, s3
    s_add_u32 s3, s3, s35
    s_lshl_b32 s64, s64, 8
    s_add_u32 s64, s64, 0
    s_add_u32 s65, s64, 262144
    s_add_u32 s66, s64, 524288
    s_add_u32 s67, s64, 786432
    s_mov_b32 s44, 0x3f803f80
    s_mov_b32 s46, 0x3a800000
    s_mov_b32 s33, 196611
    s_lshl_b32 s60, s35, 3
    s_add_u32 s60, s60, s16
    s_lshl_b32 s30, s60, 4
    s_add_u32 s30, s30, s34
    s_cmp_lg_u32 s34, 0
    s_cbranch_scc1 f_g1
    s_cmp_ge_u32 s16, 4
    s_cselect_b32 s31, 56, 0
    s_sub_u32 s30, s30, s31
    s_cmp_lg_u32 s16, 0
    s_cbranch_scc1 f_g1
    s_cmp_ge_u32 s35, 8
    s_cselect_b32 s31, 960, 0
    s_sub_u32 s30, s30, s31
f_g1:
    s_sub_u32 s31, 2048, s30
    s_cmp_eq_u32 s30, 0
    s_cselect_b32 s31, 1024, s31
    s_lshl_b32 s18, s30, 11
    s_lshl_b32 s19, s31, 11
    s_lshl_b32 s61, s34, 19
    s_add_u32 s61, s61, 0
    s_lshl_b32 s28, s60, 8
    s_add_u32 s28, s28, s61
    s_add_u32 s29, s28, 131072
    s_add_u32 s50, s28, 262144
    s_add_u32 s51, s28, 393216
    s_lshl_b32 s73, s35, 15
    s_add_u32 s73, s73, s61
    s_lshl_b32 s42, s16, 12
    s_add_u32 s72, s73, s42
    s_add_u32 s45, s42, 49664
    s_lshl_b32 s42, s16, 8
    s_add_u32 s74, s73, s42
    s_add_u32 s75, s74, 4096
    s_lshl_b32 s76, s34, 7
    s_add_u32 s77, s76, 6505472
    s_add_u32 s76, s76, 6504448
    s_lshl_b32 s78, s35, 3
    s_add_u32 s79, s78, s77
    s_add_u32 s78, s78, s76
    s_lshl_b32 s80, s3, 4
    s_add_u32 s80, s80, 4947968
    s_lshl_b32 s81, s34, 12
    s_add_u32 s81, s81, 4947968
    s_lshl_b32 s82, s35, 11
    s_add_u32 s82, s82, 6291456
    v_cvt_f32_u32 v75, v170
    s_lshl_b32 s42, s35, 2
    v_lshl_add_u32 v76, v171, 8, s42
    v_mul_f32 v75, 0x3a800000, v75
    v_cvt_f32_u32 v76, v76
    v_mul_f32 v76, v76, v75
    v_fmamk_f32 v60, v75, 0x00000000, v76
    v_fmamk_f32 v61, v75, 0x42800000, v76
    v_fmamk_f32 v62, v75, 0x43000000, v76
    v_fmamk_f32 v63, v75, 0x43400000, v76
    v_cos_f32 v64, v60
    v_cos_f32 v65, v61
    v_cos_f32 v66, v62
    v_cos_f32 v67, v63
    v_sin_f32 v68, v60
    v_sin_f32 v69, v61
    v_sin_f32 v70, v62
    v_sin_f32 v71, v63
    v_cvt_pk_f16_f32 v144, v64, v68
    v_cvt_pk_f16_f32 v145, v65, v69
    v_cvt_pk_f16_f32 v146, v66, v70
    v_cvt_pk_f16_f32 v147, v67, v71
    v_fmamk_f32 v60, v75, 0x3f800000, v76
    v_fmamk_f32 v61, v75, 0x42820000, v76
    v_fmamk_f32 v62, v75, 0x43010000, v76
    v_fmamk_f32 v63, v75, 0x43410000, v76
    v_cos_f32 v64, v60
    v_cos_f32 v65, v61
    v_cos_f32 v66, v62
    v_cos_f32 v67, v63
    v_sin_f32 v68, v60
    v_sin_f32 v69, v61
    v_sin_f32 v70, v62
    v_sin_f32 v71, v63
    v_cvt_pk_f16_f32 v148, v64, v68
    v_cvt_pk_f16_f32 v149, v65, v69
    v_cvt_pk_f16_f32 v150, v66, v70
    v_cvt_pk_f16_f32 v151, v67, v71
    v_fmamk_f32 v60, v75, 0x40000000, v76
    v_fmamk_f32 v61, v75, 0x42840000, v76
    v_fmamk_f32 v62, v75, 0x43020000, v76
    v_fmamk_f32 v63, v75, 0x43420000, v76
    v_cos_f32 v64, v60
    v_cos_f32 v65, v61
    v_cos_f32 v66, v62
    v_cos_f32 v67, v63
    v_sin_f32 v68, v60
    v_sin_f32 v69, v61
    v_sin_f32 v70, v62
    v_sin_f32 v71, v63
    v_cvt_pk_f16_f32 v152, v64, v68
    v_cvt_pk_f16_f32 v153, v65, v69
    v_cvt_pk_f16_f32 v154, v66, v70
    v_cvt_pk_f16_f32 v155, v67, v71
    v_fmamk_f32 v60, v75, 0x40400000, v76
    v_fmamk_f32 v61, v75, 0x42860000, v76
    v_fmamk_f32 v62, v75, 0x43030000, v76
    v_fmamk_f32 v63, v75, 0x43430000, v76
    v_cos_f32 v64, v60
    v_cos_f32 v65, v61
    v_cos_f32 v66, v62
    v_cos_f32 v67, v63
    v_sin_f32 v68, v60
    v_sin_f32 v69, v61
    v_sin_f32 v70, v62
    v_sin_f32 v71, v63
    v_cvt_pk_f16_f32 v156, v64, v68
    v_cvt_pk_f16_f32 v157, v65, v69
    v_cvt_pk_f16_f32 v158, v66, v70
    v_cvt_pk_f16_f32 v159, v67, v71
    s_mov_b32 m0, s40
    s_nop 0
    global_load_lds_dwordx4 v79, s[62:63]
    global_load_lds_dwordx4 v79, s[62:63] offset:1024
    s_waitcnt vmcnt(5)
    ds_write_b128 v161, v[32:35] offset:0
    v_dot2_f32_bf16 v52, v32, s44, 0
    v_dot2_f32_bf16 v54, v32, v32, 0
    v_dot2_f32_bf16 v52, v33, s44, v52
    v_dot2_f32_bf16 v54, v33, v33, v54
    v_dot2_f32_bf16 v52, v34, s44, v52
    v_dot2_f32_bf16 v54, v34, v34, v54
    v_dot2_f32_bf16 v52, v35, s44, v52
    v_dot2_f32_bf16 v54, v35, v35, v54
    s_waitcnt vmcnt(4)
    ds_write_b128 v161, v[40:43] offset:2064
    v_dot2_f32_bf16 v53, v40, s44, 0
    v_dot2_f32_bf16 v55, v40, v40, 0
    v_dot2_f32_bf16 v53, v41, s44, v53
    v_dot2_f32_bf16 v55, v41, v41, v55
    v_dot2_f32_bf16 v53, v42, s44, v53
    v_dot2_f32_bf16 v55, v42, v42, v55
    v_dot2_f32_bf16 v53, v43, s44, v53
    v_dot2_f32_bf16 v55, v43, v43, v55
    s_waitcnt vmcnt(3)
    ds_write_b128 v161, v[36:39] offset:1024
    v_dot2_f32_bf16 v52, v36, s44, v52
    v_dot2_f32_bf16 v54, v36, v36, v54
    v_dot2_f32_bf16 v52, v37, s44, v52
    v_dot2_f32_bf16 v54, v37, v37, v54
    v_dot2_f32_bf16 v52, v38, s44, v52
    v_dot2_f32_bf16 v54, v38, v38, v54
    v_dot2_f32_bf16 v52, v39, s44, v52
    v_dot2_f32_bf16 v54, v39, v39, v54
    s_waitcnt vmcnt(2)
    ds_write_b128 v161, v[44:47] offset:3088
    v_dot2_f32_bf16 v53, v44, s44, v53
    v_dot2_f32_bf16 v55, v44, v44, v55
    v_dot2_f32_bf16 v53, v45, s44, v53
    v_dot2_f32_bf16 v55, v45, v45, v55
    v_dot2_f32_bf16 v53, v46, s44, v53
    v_dot2_f32_bf16 v55, v46, v46, v55
    v_dot2_f32_bf16 v53, v47, s44, v53
    v_dot2_f32_bf16 v55, v47, v47, v55
    s_nop 2
    v_permlane32_swap_b32 v52, v53
    v_permlane32_swap_b32 v54, v55
    v_add_f32 v52, v52, v53
    v_add_f32 v54, v54, v55
    s_nop 0
    v_add_f32_dpp v52, v52, v52 row_ror:8 row_mask:0xf bank_mask:0xf
    v_add_f32_dpp v54, v54, v54 row_ror:8 row_mask:0xf bank_mask:0xf
    s_nop 0
    v_add_f32_dpp v52, v52, v52 row_ror:4 row_mask:0xf bank_mask:0xf
    v_add_f32_dpp v54, v54, v54 row_ror:4 row_mask:0xf bank_mask:0xf
    s_nop 0
    v_add_f32_dpp v52, v52, v52 row_ror:2 row_mask:0xf bank_mask:0xf
    v_add_f32_dpp v54, v54, v54 row_ror:2 row_mask:0xf bank_mask:0xf
    s_nop 0
    v_add_f32_dpp v52, v52, v52 row_ror:1 row_mask:0xf bank_mask:0xf
    v_add_f32_dpp v54, v54, v54 row_ror:1 row_mask:0xf bank_mask:0xf
    s_nop 0
    v_add_f32_dpp v52, v52, v52 row_bcast:15 row_mask:0xa bank_mask:0xf
    v_add_f32_dpp v54, v54, v54 row_bcast:15 row_mask:0xa bank_mask:0xf
    v_mul_f32 v52, s46, v52
    v_mul_f32 v54, s46, v54
    v_mul_f32 v64, v52, v52
    v_cvt_pk_bf16_f32 v56, -v52, -v52
    v_sub_f32 v54, v54, v64
    v_mul_f32 v66, 0x44000000, v54
    v_cmp_gt_f32 vcc, v64, v66
    s_or_b32 s68, vcc_lo, vcc_hi
    s_bitcmp1_b32 s68, 31
    s_cbranch_scc1 f_slowvar
f_var:
    v_cvt_pk_bf16_f32 v54, v54, v54
    v_lshlrev_b32 v54, 16, v54
    v_add_f32 v54, 0x3727c5ac, v54
    v_cvt_pk_bf16_f32 v54, v54, v54
    v_lshlrev_b32 v54, 16, v54
    v_sqrt_f32 v54, v54
    s_nop 0
    v_cvt_pk_bf16_f32 v54, v54, v54
    v_lshlrev_b32 v54, 16, v54
    v_rcp_f32 v54, v54
    s_mov_b32 exec_lo, 0x80000000
    s_mov_b32 exec_hi, 0x80000000
    ds_write_b16 v166, v56
    ds_write_b32 v165, v54
    s_mov_b64 exec, -1
    s_waitcnt lgkmcnt(0)
    s_cmp_lg_u32 s16, 0
    s_cbranch_scc1 f_nxr
    s_mul_i32 s32, s101, 0x9e3779b1
    s_or_b32 s32, s32, 0x101
    s_and_b32 s32, s32, 0xfffefbfb
    s_and_b32 s56, s32, 0xff
    s_bfe_u32 s57, s32, 0x80008
    s_bfe_u32 s58, s32, 0x80010
    s_lshr_b32 s59, s32, 24
    v_mov_b32 v72, s32
    v_mov_b32 v73, s39
    s_mov_b64 exec, 1
    buffer_store_dwordx2 v[72:73], v168, s[12:15], s78 offen sc1
    s_mov_b64 exec, -1
f_nxr:
    s_barrier
    ds_read_b128 v[60:63], v163
    ds_read_b64 v[64:65], v164
    ds_read_b64_tr_b16 v[80:81], v162 offset:0
    ds_read_b64_tr_b16 v[82:83], v162 offset:512
    ds_read_b64_tr_b16 v[84:85], v162 offset:1024
    ds_read_b64_tr_b16 v[86:87], v162 offset:1536
    ds_read_b64_tr_b16 v[88:89], v162 offset:64
    ds_read_b64_tr_b16 v[90:91], v162 offset:576
    ds_read_b64_tr_b16 v[92:93], v162 offset:1088
    ds_read_b64_tr_b16 v[94:95], v162 offset:1600
    s_mul_i32 s32, s101, 0x9e3779b1
    s_or_b32 s32, s32, 0x101
    s_and_b32 s32, s32, 0xfffefbfb
    s_and_b32 s56, s32, 0xff
    s_bfe_u32 s57, s32, 0x80008
    s_bfe_u32 s58, s32, 0x80010
    s_lshr_b32 s59, s32, 24
    v_lshrrev_b32 v16, v169, s32
    v_lshrrev_b32 v17, 2, v16
    v_lshrrev_b32 v18, 4, v16
    v_lshrrev_b32 v19, 6, v16
    s_waitcnt lgkmcnt(8)
    v_pk_mul_f32 v[48:49], v[48:49], v[60:61]
    v_pk_mul_f32 v[50:51], v[50:51], v[62:63]
    v_cvt_pk_bf16_f32 v58, v48, v49
    v_cvt_pk_bf16_f32 v59, v50, v51
    s_nop 1
    v_mfma_f32_16x16x16_bf16 v[96:99], v[58:59], v[64:65], 0
    s_waitcnt lgkmcnt(0)
    v_mfma_f32_16x16x16_bf16 v[100:103], v[58:59], v[80:81], v[96:99]
    v_mfma_f32_16x16x16_bf16 v[104:107], v[58:59], v[82:83], v[96:99]
    v_mfma_f32_16x16x16_bf16 v[108:111], v[58:59], v[84:85], v[96:99]
    v_mfma_f32_16x16x16_bf16 v[112:115], v[58:59], v[86:87], v[96:99]
    v_mfma_f32_16x16x16_bf16 v[116:119], v[58:59], v[88:89], v[96:99]
    v_mfma_f32_16x16x16_bf16 v[120:123], v[58:59], v[90:91], v[96:99]
    v_mfma_f32_16x16x16_bf16 v[124:127], v[58:59], v[92:93], v[96:99]
    v_mfma_f32_16x16x16_bf16 v[128:131], v[58:59], v[94:95], v[96:99]
    s_nop 0
    v_cvt_pk_f16_f32 v176, v100, v101
    v_cvt_pk_f16_f32 v177, v104, v105
    v_cvt_pk_f16_f32 v178, v108, v109
    v_cvt_pk_f16_f32 v179, v112, v113
    v_bfi_b32 v176, s33, v16, v176
    v_bfi_b32 v177, s33, v17, v177
    v_bfi_b32 v178, s33, v18, v178
    v_bfi_b32 v179, s33, v19, v179
    buffer_store_dwordx4 v[176:179], v160, s[12:15], s64 offen sc1
    v_cvt_pk_f16_f32 v180, v102, v103
    v_cvt_pk_f16_f32 v181, v106, v107
    v_cvt_pk_f16_f32 v182, v110, v111
    v_cvt_pk_f16_f32 v183, v114, v115
    v_bfi_b32 v180, s33, v16, v180
    v_bfi_b32 v181, s33, v17, v181
    v_bfi_b32 v182, s33, v18, v182
    v_bfi_b32 v183, s33, v19, v183
    buffer_store_dwordx4 v[180:183], v160, s[12:15], s66 offen sc1
    v_cvt_pk_f16_f32 v184, v116, v117
    v_cvt_pk_f16_f32 v185, v120, v121
    v_cvt_pk_f16_f32 v186, v124, v125
    v_cvt_pk_f16_f32 v187, v128, v129
    v_bfi_b32 v184, s33, v16, v184
    v_bfi_b32 v185, s33, v17, v185
    v_bfi_b32 v186, s33, v18, v186
    v_bfi_b32 v187, s33, v19, v187
    buffer_store_dwordx4 v[184:187], v160, s[12:15], s65 offen sc1
    v_cvt_pk_f16_f32 v188, v118, v119
    v_cvt_pk_f16_f32 v189, v122, v123
    v_cvt_pk_f16_f32 v190, v126, v127
    v_cvt_pk_f16_f32 v191, v130, v131
    v_bfi_b32 v188, s33, v16, v188
    v_bfi_b32 v189, s33, v17, v189
    v_bfi_b32 v190, s33, v18, v190
    v_bfi_b32 v191, s33, v19, v191
    buffer_store_dwordx4 v[188:191], v160, s[12:15], s67 offen sc1
    s_waitcnt vmcnt(4)
    s_barrier
    v_mov_b32 v48, v170
    v_mov_b32 v49, v171
    v_mov_b32 v50, s32
    v_mov_b32 v51, s39
    s_cmp_lg_u32 s16, 0
    s_cbranch_scc1 f_nzl
    s_lshl_b32 s68, s3, 7
    s_add_u32 s68, s68, 6520832
    v_mov_b32 v52, 0
    s_mov_b64 exec, 1
    buffer_store_dwordx2 v[50:51], v52, s[12:15], s68 offen sc1
    s_mov_b64 exec, -1
f_nzl:
    ds_read_b128 v[192:195], v3 offset:33280
    ds_read_b128 v[196:199], v3 offset:34304
    ds_read_b128 v[200:203], v3 offset:35328
    ds_read_b128 v[204:207], v3 offset:36352
    ds_read_b128 v[208:211], v3 offset:37376
    ds_read_b128 v[212:215], v3 offset:38400
    ds_read_b128 v[216:219], v3 offset:39424
    ds_read_b128 v[220:223], v3 offset:40448
    v_lshlrev_b32 v4, 15, v49
    v_lshl_add_u32 v4, v48, 4, v4
    v_lshlrev_b32 v251, 13, v49
    v_lshl_add_u32 v251, v48, 4, v251
    v_lshl_add_u32 v254, v1, 10, v251
    v_xor_b32 v255, 64, v254
    v_lshrrev_b32 v57, 1, v1
    v_lshlrev_b32 v252, 13, v57
    v_and_b32 v57, 1, v1
    v_lshl_add_u32 v252, v57, 3, v252
    v_lshl_add_u32 v252, v49, 11, v252
    v_and_b32 v57, 3, v0
    v_lshl_add_u32 v252, v57, 8, v252
    v_lshrrev_b32 v58, 2, v48
    v_lshl_add_u32 v252, v58, 4, v252
    v_and_b32 v59, 1, v0
    v_lshl_add_u32 v252, v59, 6, v252
    v_xor_b32 v253, 64, v252
    v_lshl_add_u32 v57, v49, 2, v57
    v_lshlrev_b32 v57, 4, v57
    v_lshl_add_u32 v250, v58, 8, v57
    v_add_u32 v5, 82432, v3
    v_sub_u32 v6, 83440, v3
    v_lshl_add_u32 v57, v48, 2, v49
    v_lshl_add_u32 v8, v57, 3, s45
    s_add_u32 s43, s45, 2552
    v_lshlrev_b32 v58, 3, v57
    v_sub_u32 v9, s43, v58
    v_add_u32 v57, 1, v57
    v_and_b32 v58, 3, v57
    v_and_b32 v57, 60, v57
    v_lshl_add_u32 v7, v58, 6, v57
    v_add_u32 v10, s45, v3
    v_lshlrev_b32 v12, 2, v48
    v_add_u32 v12, 102912, v12
    v_lshlrev_b32 v13, 12, v2
    v_and_b32 v14, 0x70, v3
    v_lshlrev_b32 v15, 4, v0
    v_and_b32 v57, 3, v0
    v_bfe_u32 v58, v0, 2, 4
    v_lshl_add_u32 v57, v57, 4, v58
    v_bfe_u32 v58, v0, 6, 2
    v_lshl_add_u32 v57, v58, 6, v57
    v_lshrrev_b32 v58, 8, v0
    v_lshl_add_u32 v57, v58, 9, v57
    v_lshlrev_b32 v57, 4, v57
    v_add_u32 v1, 82432, v57
    s_and_b32 s42, s35, 3
    s_lshl_b32 s42, s42, 8
    v_xor_b32 v243, s42, v3
    s_mov_b32 s44, 131074
    v_and_b32 v16, s33, v16
    v_and_b32 v17, s33, v17
    v_and_b32 v18, s33, v18
    v_and_b32 v19, s33, v19
    v_xor_b32 v16, s44, v16
    v_xor_b32 v17, s44, v17
    v_xor_b32 v18, s44, v18
    v_xor_b32 v19, s44, v19
    v_mov_b32 v80, 0
    v_mov_b32 v81, 0
    v_mov_b32 v82, 0
    v_mov_b32 v83, 0
    v_mov_b32 v84, 0
    v_mov_b32 v85, 0
    v_mov_b32 v86, 0
    v_mov_b32 v87, 0
    v_mov_b32 v88, 0
    v_mov_b32 v89, 0
    v_mov_b32 v90, 0
    v_mov_b32 v91, 0
    v_mov_b32 v92, 0
    v_mov_b32 v93, 0
    v_mov_b32 v94, 0
    v_mov_b32 v95, 0
    v_mov_b32 v96, 0
    v_mov_b32 v97, 0
    v_mov_b32 v98, 0
    v_mov_b32 v99, 0
    v_mov_b32 v100, 0
    v_mov_b32 v101, 0
    v_mov_b32 v102, 0
    v_mov_b32 v103, 0
    v_mov_b32 v104, 0
    v_mov_b32 v105, 0
    v_mov_b32 v106, 0
    v_mov_b32 v107, 0
    v_mov_b32 v108, 0
    v_mov_b32 v109, 0
    v_mov_b32 v110, 0
    v_mov_b32 v111, 0
    s_barrier
    s_mov_b32 m0, s45
    s_add_u32 s43, s45, 2048
    buffer_load_dwordx4 v3, s[8:11], s18 offen lds
    buffer_load_dwordx4 v3, s[8:11], s18 offen offset:1024 lds
    s_mov_b32 m0, s43
    buffer_load_dwordx2 v[248:249], v172, s[52:55], 0 offen
    buffer_load_dwordx4 v3, s[8:11], s19 offen lds
    buffer_load_dwordx4 v3, s[8:11], s19 offen offset:1024 lds
    s_sleep 6
    s_cmp_lg_u32 s34, 0
    s_cbranch_scc1 f_ci0
    s_add_u32 s68, s82, 32768
    buffer_load_dwordx4 v[120:123], v250, s[12:15], s68 offen offset:0
    buffer_load_dwordx4 v[124:127], v250, s[12:15], s68 offen offset:1024
f_ci0:
    buffer_load_dwordx4 v[112:115], v250, s[12:15], s82 offen offset:0
    buffer_load_dwordx4 v[116:119], v250, s[12:15], s82 offen offset:1024
    buffer_load_dwordx4 v[244:247], v14, s[12:15], s76 offen
    s_sleep 6
    buffer_load_dwordx4 v[32:35], v243, s[12:15], s72 offen offset:0 sc1
    buffer_load_dwordx4 v[36:39], v243, s[12:15], s72 offen offset:1024 sc1
    buffer_load_dwordx4 v[40:43], v243, s[12:15], s72 offen offset:2048 sc1
    buffer_load_dwordx4 v[44:47], v243, s[12:15], s72 offen offset:3072 sc1
    s_waitcnt vmcnt(7)
    ds_read_b64 v[128:129], v8 offset:0
    ds_read_b64 v[130:131], v8 offset:512
    ds_read_b64 v[132:133], v8 offset:1024
    ds_read_b64 v[134:135], v8 offset:1536
    ds_read_b64 v[136:137], v9 offset:1536
    ds_read_b64 v[138:139], v9 offset:1024
    ds_read_b64 v[140:141], v9 offset:512
    ds_read_b64 v[142:143], v9 offset:0
    s_waitcnt lgkmcnt(0)
    v_lshlrev_b32 v160, 16, v128
    v_and_b32 v161, 0xffff0000, v128
    v_lshlrev_b32 v162, 16, v129
    v_and_b32 v163, 0xffff0000, v129
    v_lshlrev_b32 v164, 16, v130
    v_and_b32 v165, 0xffff0000, v130
    v_lshlrev_b32 v166, 16, v131
    v_and_b32 v167, 0xffff0000, v131
    v_lshlrev_b32 v168, 16, v132
    v_and_b32 v169, 0xffff0000, v132
    v_lshlrev_b32 v170, 16, v133
    v_and_b32 v171, 0xffff0000, v133
    v_lshlrev_b32 v172, 16, v134
    v_and_b32 v173, 0xffff0000, v134
    v_lshlrev_b32 v174, 16, v135
    v_and_b32 v175, 0xffff0000, v135
    v_lshlrev_b32 v176, 16, v136
    v_and_b32 v177, 0xffff0000, v136
    v_lshlrev_b32 v178, 16, v137
    v_and_b32 v179, 0xffff0000, v137
    v_lshlrev_b32 v180, 16, v138
    v_and_b32 v181, 0xffff0000, v138
    v_lshlrev_b32 v182, 16, v139
    v_and_b32 v183, 0xffff0000, v139
    v_lshlrev_b32 v184, 16, v140
    v_and_b32 v185, 0xffff0000, v140
    v_lshlrev_b32 v186, 16, v141
    v_and_b32 v187, 0xffff0000, v141
    v_lshlrev_b32 v188, 16, v142
    v_and_b32 v189, 0xffff0000, v142
    v_lshlrev_b32 v190, 16, v143
    v_and_b32 v191, 0xffff0000, v143
    s_mov_b32 s47, 0
    s_mov_b32 s83, 0
    s_waitcnt vmcnt(5)
f_c1:
    v_xor_b32 v112, s56, v112
    v_xor_b32 v113, s57, v113
    v_xor_b32 v114, s58, v114
    v_xor_b32 v115, s59, v115
    v_xor_b32 v116, s56, v116
    v_xor_b32 v117, s57, v117
    v_xor_b32 v118, s58, v118
    v_xor_b32 v119, s59, v119
    v_or3_b32 v48, v112, v113, v114
    v_or3_b32 v48, v48, v115, v116
    v_or3_b32 v48, v48, v117, v118
    v_or_b32 v48, v48, v119
    v_and_b32 v48, 0xff, v48
    v_cmp_ne_u32 vcc, 0, v48
    s_cmp_lg_u32 s34, 0
    s_cbranch_scc1 f_c1n
    s_mov_b64 s[68:69], vcc
    v_xor_b32 v120, s56, v120
    v_xor_b32 v121, s57, v121
    v_xor_b32 v122, s58, v122
    v_xor_b32 v123, s59, v123
    v_xor_b32 v124, s56, v124
    v_xor_b32 v125, s57, v125
    v_xor_b32 v126, s58, v126
    v_xor_b32 v127, s59, v127
    v_or3_b32 v48, v120, v121, v122
    v_or3_b32 v48, v48, v123, v124
    v_or3_b32 v48, v48, v125, v126
    v_or_b32 v48, v48, v127
    v_and_b32 v48, 0xff, v48
    v_cmp_ne_u32 vcc, 0, v48
    s_or_b64 vcc, vcc, s[68:69]
f_c1n:
    s_cbranch_vccnz f_c1bad
f_c1ok:
    v_pk_add_f32 v[112:113], v[112:113], v[116:117]
    v_pk_add_f32 v[114:115], v[114:115], v[118:119]
    s_nop 0
    v_add_f32_dpp v112, v112, v112 row_ror:4 row_mask:0xf bank_mask:0xf
    v_add_f32_dpp v113, v113, v113 row_ror:4 row_mask:0xf bank_mask:0xf
    v_add_f32_dpp v114, v114, v114 row_ror:4 row_mask:0xf bank_mask:0xf
    v_add_f32_dpp v115, v115, v115 row_ror:4 row_mask:0xf bank_mask:0xf
    v_add_f32_dpp v112, v112, v112 row_ror:8 row_mask:0xf bank_mask:0xf
    v_add_f32_dpp v113, v113, v113 row_ror:8 row_mask:0xf bank_mask:0xf
    v_add_f32_dpp v114, v114, v114 row_ror:8 row_mask:0xf bank_mask:0xf
    v_add_f32_dpp v115, v115, v115 row_ror:8 row_mask:0xf bank_mask:0xf
    v_cvt_pk_bf16_f32 v48, v112, v113
    v_lshlrev_b32 v112, 16, v48
    v_and_b32 v113, 0xffff0000, v48
    v_cvt_pk_bf16_f32 v49, v114, v115
    v_lshlrev_b32 v114, 16, v49
    v_and_b32 v115, 0xffff0000, v49
    v_add_f32 v112, 1.0, v112
    v_add_f32 v113, 1.0, v113
    v_add_f32 v114, 1.0, v114
    v_add_f32 v115, 1.0, v115
    v_cvt_pk_bf16_f32 v48, v112, v113
    v_lshlrev_b32 v112, 16, v48
    v_and_b32 v113, 0xffff0000, v48
    v_cvt_pk_bf16_f32 v49, v114, v115
    v_lshlrev_b32 v114, 16, v49
    v_and_b32 v115, 0xffff0000, v49
    v_max_f32_e64 v48, abs(v112), abs(v113)
    v_max3_f32 v48, abs(v114), abs(v115), v48
    s_cmp_lg_u32 s34, 0
    s_cbranch_scc1 f_c1m
    v_mov_b32 v50, v48
    v_pk_add_f32 v[120:121], v[120:121], v[124:125]
    v_pk_add_f32 v[122:123], v[122:123], v[126:127]
    s_nop 0
    v_add_f32_dpp v120, v120, v120 row_ror:4 row_mask:0xf bank_mask:0xf
    v_add_f32_dpp v121, v121, v121 row_ror:4 row_mask:0xf bank_mask:0xf
    v_add_f32_dpp v122, v122, v122 row_ror:4 row_mask:0xf bank_mask:0xf
    v_add_f32_dpp v123, v123, v123 row_ror:4 row_mask:0xf bank_mask:0xf
    v_add_f32_dpp v120, v120, v120 row_ror:8 row_mask:0xf bank_mask:0xf
    v_add_f32_dpp v121, v121, v121 row_ror:8 row_mask:0xf bank_mask:0xf
    v_add_f32_dpp v122, v122, v122 row_ror:8 row_mask:0xf bank_mask:0xf
    v_add_f32_dpp v123, v123, v123 row_ror:8 row_mask:0xf bank_mask:0xf
    v_cvt_pk_bf16_f32 v48, v120, v121
    v_lshlrev_b32 v120, 16, v48
    v_and_b32 v121, 0xffff0000, v48
    v_cvt_pk_bf16_f32 v49, v122, v123
    v_lshlrev_b32 v122, 16, v49
    v_and_b32 v123, 0xffff0000, v49
    v_max3_f32 v48, abs(v120), abs(v121), v50
    v_max3_f32 v48, abs(v122), abs(v123), v48
f_c1m:
    s_nop 1
    v_max_f32_dpp v48, v48, v48 quad_perm:[1,0,3,2] row_mask:0xf bank_mask:0xf
    s_nop 1
    v_max_f32_dpp v48, v48, v48 quad_perm:[2,3,0,1] row_mask:0xf bank_mask:0xf
    s_nop 0
    v_readlane_b32 s68, v48, 0
    v_readlane_b32 s69, v48, 16
    v_readlane_b32 s70, v48, 32
    v_readlane_b32 s71, v48, 48
    s_max_u32 s68, s68, s69
    s_max_u32 s70, s70, s71
    s_max_u32 s68, s68, s70
    s_lshr_b32 s68, s68, 23
    s_sub_u32 s69, s68, 120
    s_sub_i32 s68, s68, 127
    s_max_i32 s68, s68, -100
    s_min_i32 s68, s68, 120
    s_cmp_le_u32 s69, 9
    s_cselect_b32 s68, 2, s68
    s_cselect_b32 s17, 0, 0x20000
    s_sub_i32 s69, 127, s68
    s_lshl_b32 s69, s69, 23
    v_mul_f32 v112, s69, v112
    v_mul_f32 v113, s69, v113
    v_mul_f32 v114, s69, v114
    v_mul_f32 v115, s69, v115
    v_cvt_pk_f16_f32 v48, v112, v113
    v_cvt_pk_f16_f32 v49, v114, v115
    s_lshl_b32 s70, s16, 28
    v_mov_b32 v50, s32
    v_mov_b32 v51, s68
    v_mov_b32 v52, s70
    s_mov_b64 exec, 1
    buffer_store_dwordx2 v[50:51], v52, s[12:15], s79 offen sc1
    s_mov_b64 exec, -1
    s_or_b32 s70, s34, s16
    s_cbranch_scc0 f_sa
f_nkr:
    v_mov_b32_dpp v56, v48 quad_perm:[0,0,0,0] row_mask:0xf bank_mask:0xf
    v_mov_b32_dpp v57, v49 quad_perm:[0,0,0,0] row_mask:0xf bank_mask:0xf
    v_mov_b32_dpp v58, v48 quad_perm:[1,1,1,1] row_mask:0xf bank_mask:0xf
    v_mov_b32_dpp v59, v49 quad_perm:[1,1,1,1] row_mask:0xf bank_mask:0xf
    v_mov_b32_dpp v60, v48 quad_perm:[2,2,2,2] row_mask:0xf bank_mask:0xf
    v_mov_b32_dpp v61, v49 quad_perm:[2,2,2,2] row_mask:0xf bank_mask:0xf
    v_mov_b32_dpp v62, v48 quad_perm:[3,3,3,3] row_mask:0xf bank_mask:0xf
    v_mov_b32_dpp v63, v49 quad_perm:[3,3,3,3] row_mask:0xf bank_mask:0xf
    v_pk_mul_f16 v112, v144, v56 op_sel:[0,0] op_sel_hi:[1,0]
    v_pk_mul_f16 v116, v144, v56 op_sel:[1,0] op_sel_hi:[0,0] neg_lo:[1,0]
    v_pk_mul_f16 v113, v145, v58 op_sel:[0,0] op_sel_hi:[1,0]
    v_pk_mul_f16 v117, v145, v58 op_sel:[1,0] op_sel_hi:[0,0] neg_lo:[1,0]
    v_pk_mul_f16 v114, v146, v60 op_sel:[0,0] op_sel_hi:[1,0]
    v_pk_mul_f16 v118, v146, v60 op_sel:[1,0] op_sel_hi:[0,0] neg_lo:[1,0]
    v_pk_mul_f16 v115, v147, v62 op_sel:[0,0] op_sel_hi:[1,0]
    v_pk_mul_f16 v119, v147, v62 op_sel:[1,0] op_sel_hi:[0,0] neg_lo:[1,0]
    v_pk_mul_f16 v120, v148, v56 op_sel:[0,1] op_sel_hi:[1,1]
    v_pk_mul_f16 v124, v148, v56 op_sel:[1,1] op_sel_hi:[0,1] neg_lo:[1,0]
    v_pk_mul_f16 v121, v149, v58 op_sel:[0,1] op_sel_hi:[1,1]
    v_pk_mul_f16 v125, v149, v58 op_sel:[1,1] op_sel_hi:[0,1] neg_lo:[1,0]
    v_pk_mul_f16 v122, v150, v60 op_sel:[0,1] op_sel_hi:[1,1]
    v_pk_mul_f16 v126, v150, v60 op_sel:[1,1] op_sel_hi:[0,1] neg_lo:[1,0]
    v_pk_mul_f16 v123, v151, v62 op_sel:[0,1] op_sel_hi:[1,1]
    v_pk_mul_f16 v127, v151, v62 op_sel:[1,1] op_sel_hi:[0,1] neg_lo:[1,0]
    v_pk_mul_f16 v128, v152, v57 op_sel:[0,0] op_sel_hi:[1,0]
    v_pk_mul_f16 v132, v152, v57 op_sel:[1,0] op_sel_hi:[0,0] neg_lo:[1,0]
    v_pk_mul_f16 v129, v153, v59 op_sel:[0,0] op_sel_hi:[1,0]
    v_pk_mul_f16 v133, v153, v59 op_sel:[1,0] op_sel_hi:[0,0] neg_lo:[1,0]
    v_pk_mul_f16 v130, v154, v61 op_sel:[0,0] op_sel_hi:[1,0]
    v_pk_mul_f16 v134, v154, v61 op_sel:[1,0] op_sel_hi:[0,0] neg_lo:[1,0]
    v_pk_mul_f16 v131, v155, v63 op_sel:[0,0] op_sel_hi:[1,0]
    v_pk_mul_f16 v135, v155, v63 op_sel:[1,0] op_sel_hi:[0,0] neg_lo:[1,0]
    v_pk_mul_f16 v136, v156, v57 op_sel:[0,1] op_sel_hi:[1,1]
    v_pk_mul_f16 v140, v156, v57 op_sel:[1,1] op_sel_hi:[0,1] neg_lo:[1,0]
    v_pk_mul_f16 v137, v157, v59 op_sel:[0,1] op_sel_hi:[1,1]
    v_pk_mul_f16 v141, v157, v59 op_sel:[1,1] op_sel_hi:[0,1] neg_lo:[1,0]
    v_pk_mul_f16 v138, v158, v61 op_sel:[0,1] op_sel_hi:[1,1]
    v_pk_mul_f16 v142, v158, v61 op_sel:[1,1] op_sel_hi:[0,1] neg_lo:[1,0]
    v_pk_mul_f16 v139, v159, v63 op_sel:[0,1] op_sel_hi:[1,1]
    v_pk_mul_f16 v143, v159, v63 op_sel:[1,1] op_sel_hi:[0,1] neg_lo:[1,0]
    s_bitset1_b32 s47, 1
    s_bitcmp1_b32 s47, 0
    s_cbranch_scc1 f_bar
f_s1:
    s_mov_b32 s83, 0
f_z1:
    s_waitcnt vmcnt(3)
    v_xor_b32 v224, v32, v16
    v_xor_b32 v225, v36, v16
    v_xor_b32 v226, v33, v17
    v_xor_b32 v227, v37, v17
    v_xor_b32 v228, v34, v18
    v_xor_b32 v229, v38, v18
    v_xor_b32 v230, v35, v19
    v_xor_b32 v231, v39, v19
    v_mfma_f32_16x16x16_f16 v[48:51], v[20:21], v[224:225], 0
    v_xor_b32 v2, s44, v224
    v_bitop3_b32 v2, v2, v225, s44 bitop3:0xf6
    v_mfma_f32_16x16x16_f16 v[52:55], v[20:21], v[226:227], 0
    v_bitop3_b32 v2, v2, v226, s44 bitop3:0xf6
    v_bitop3_b32 v2, v2, v227, s44 bitop3:0xf6
    v_mfma_f32_16x16x16_f16 v[56:59], v[20:21], v[228:229], 0
    v_bitop3_b32 v2, v2, v228, s44 bitop3:0xf6
    v_bitop3_b32 v2, v2, v229, s44 bitop3:0xf6
    v_mfma_f32_16x16x16_f16 v[60:63], v[20:21], v[230:231], 0
    v_bitop3_b32 v2, v2, v230, s44 bitop3:0xf6
    v_bitop3_b32 v2, v2, v231, s44 bitop3:0xf6
    s_waitcnt vmcnt(1)
    v_xor_b32 v232, v40, v16
    v_xor_b32 v233, v44, v16
    v_xor_b32 v234, v41, v17
    v_xor_b32 v235, v45, v17
    v_xor_b32 v236, v42, v18
    v_xor_b32 v237, v46, v18
    v_xor_b32 v238, v43, v19
    v_xor_b32 v239, v47, v19
    v_mfma_f32_16x16x16_f16 v[64:67], v[22:23], v[232:233], 0
    v_bitop3_b32 v2, v2, v232, s44 bitop3:0xf6
    v_bitop3_b32 v2, v2, v233, s44 bitop3:0xf6
    v_mfma_f32_16x16x16_f16 v[68:71], v[22:23], v[234:235], 0
    v_bitop3_b32 v2, v2, v234, s44 bitop3:0xf6
    v_bitop3_b32 v2, v2, v235, s44 bitop3:0xf6
    v_mfma_f32_16x16x16_f16 v[72:75], v[22:23], v[236:237], 0
    v_bitop3_b32 v2, v2, v236, s44 bitop3:0xf6
    v_bitop3_b32 v2, v2, v237, s44 bitop3:0xf6
    v_mfma_f32_16x16x16_f16 v[76:79], v[22:23], v[238:239], 0
    v_bitop3_b32 v2, v2, v238, s44 bitop3:0xf6
    v_bitop3_b32 v2, v2, v239, s44 bitop3:0xf6
    v_and_b32 v2, s33, v2
    v_cmp_ne_u32 vcc, 0, v2
    s_cbranch_vccnz f_z1bad
f_z1ok:
    v_cvt_pk_f16_f32 v32, v48, v49
    v_cvt_pk_f16_f32 v33, v64, v65
    ds_write_b64 v252, v[32:33] offset:0
    v_cvt_pk_f16_f32 v34, v50, v51
    v_cvt_pk_f16_f32 v35, v66, v67
    ds_write_b64 v252, v[34:35] offset:1024
    v_cvt_pk_f16_f32 v36, v52, v53
    v_cvt_pk_f16_f32 v37, v68, v69
    ds_write_b64 v253, v[36:37] offset:0
    v_cvt_pk_f16_f32 v38, v54, v55
    v_cvt_pk_f16_f32 v39, v70, v71
    ds_write_b64 v253, v[38:39] offset:1024
    v_cvt_pk_f16_f32 v40, v56, v57
    v_cvt_pk_f16_f32 v41, v72, v73
    ds_write_b64 v252, v[40:41] offset:128
    v_cvt_pk_f16_f32 v42, v58, v59
    v_cvt_pk_f16_f32 v43, v74, v75
    ds_write_b64 v252, v[42:43] offset:1152
    v_cvt_pk_f16_f32 v44, v60, v61
    v_cvt_pk_f16_f32 v45, v76, v77
    ds_write_b64 v253, v[44:45] offset:128
    v_cvt_pk_f16_f32 v46, v62, v63
    v_cvt_pk_f16_f32 v47, v78, v79
    ds_write_b64 v253, v[46:47] offset:1152
    v_xor_b32 v2, s32, v244
    v_bitop3_b32 v2, v2, v246, s32 bitop3:0xf6
    v_bitop3_b32 v2, v2, v245, s39 bitop3:0xf6
    v_bitop3_b32 v2, v2, v247, s39 bitop3:0xf6
    v_cmp_ne_u32 vcc, 0, v2
    v_xor_b32 v16, 65537, v16
    v_xor_b32 v17, 65537, v17
    v_xor_b32 v18, 65537, v18
    v_xor_b32 v19, 65537, v19
    v_mov_b32 v240, -1
    v_mov_b32 v241, -1
    v_mov_b32 v242, -1
    v_mov_b32 v243, -1
    s_lshl_b32 s42, s3, 13
    s_add_u32 s42, s42, 5242880
    buffer_store_dwordx4 v[240:243], v15, s[12:15], s42 offen sc1
    s_mov_b32 s38, vcc_lo
    s_bitset1_b32 s47, 0
    s_mov_b32 s83, 0
    s_bitcmp1_b32 s47, 1
    s_cbranch_scc0 f_c1
f_bar:
    s_mov_b32 s42, 6488064
    s_mov_b32 s41, 6496256
    s_waitcnt lgkmcnt(0)
    s_barrier
    ds_read_b128 v[32:35], v254 offset:0
    ds_read_b128 v[36:39], v255 offset:256
    ds_read_b128 v[40:43], v254 offset:512
    ds_read_b128 v[44:47], v255 offset:768
    ds_read_b128 v[224:227], v3 offset:41472
    ds_read_b128 v[228:231], v3 offset:42496
    ds_read_b128 v[232:235], v3 offset:43520
    ds_read_b128 v[236:239], v3 offset:44544
    v_xor_b32 v19, s17, v19
    s_waitcnt lgkmcnt(7)
    v_mfma_f32_16x16x32_f16 v[48:51], v[32:35], v[24:27], 0
    v_mfma_f32_16x16x32_f16 v[52:55], v[32:35], v[28:31], 0
    s_waitcnt lgkmcnt(6)
    v_mfma_f32_16x16x32_f16 v[56:59], v[36:39], v[24:27], 0
    v_mfma_f32_16x16x32_f16 v[60:63], v[36:39], v[28:31], 0
    s_waitcnt lgkmcnt(5)
    v_mfma_f32_16x16x32_f16 v[64:67], v[40:43], v[24:27], 0
    v_mfma_f32_16x16x32_f16 v[68:71], v[40:43], v[28:31], 0
    s_waitcnt lgkmcnt(4)
    v_mfma_f32_16x16x32_f16 v[72:75], v[44:47], v[24:27], 0
    v_mfma_f32_16x16x32_f16 v[76:79], v[44:47], v[28:31], 0
    v_cvt_pk_f16_f32 v144, v48, v52
    v_cvt_pk_f16_f32 v145, v49, v53
    v_cvt_pk_f16_f32 v146, v50, v54
    v_cvt_pk_f16_f32 v147, v51, v55
    v_cvt_pk_f16_f32 v148, v56, v60
    v_cvt_pk_f16_f32 v149, v57, v61
    v_cvt_pk_f16_f32 v150, v58, v62
    v_cvt_pk_f16_f32 v151, v59, v63
    v_mfma_f32_16x16x32_f16 v[80:83], v[144:147], v[112:115], v[80:83]
    v_mfma_f32_16x16x32_f16 v[84:87], v[144:147], v[116:119], v[84:87]
    v_cvt_pk_f16_f32 v152, v64, v68
    v_cvt_pk_f16_f32 v153, v65, v69
    v_cvt_pk_f16_f32 v154, v66, v70
    v_cvt_pk_f16_f32 v155, v67, v71
    v_mfma_f32_16x16x32_f16 v[88:91], v[148:151], v[120:123], v[88:91]
    v_mfma_f32_16x16x32_f16 v[92:95], v[148:151], v[124:127], v[92:95]
    v_cvt_pk_f16_f32 v156, v72, v76
    v_cvt_pk_f16_f32 v157, v73, v77
    v_cvt_pk_f16_f32 v158, v74, v78
    v_cvt_pk_f16_f32 v159, v75, v79
    v_mfma_f32_16x16x32_f16 v[96:99], v[152:155], v[128:131], v[96:99]
    v_mfma_f32_16x16x32_f16 v[100:103], v[152:155], v[132:135], v[100:103]
    v_mfma_f32_16x16x32_f16 v[104:107], v[156:159], v[136:139], v[104:107]
    v_mfma_f32_16x16x32_f16 v[108:111], v[156:159], v[140:143], v[108:111]
    buffer_load_dwordx4 v[240:243], v15, s[12:15], s42 offen
    v_cvt_pk_f16_f32 v32, v80, v84
    v_cvt_pk_f16_f32 v36, v81, v85
    v_cvt_pk_f16_f32 v40, v82, v86
    v_cvt_pk_f16_f32 v44, v83, v87
    v_bfi_b32 v32, s33, v16, v32
    v_bfi_b32 v36, s33, v16, v36
    v_bfi_b32 v40, s33, v16, v40
    v_bfi_b32 v44, s33, v16, v44
    v_cvt_pk_f16_f32 v33, v88, v92
    v_cvt_pk_f16_f32 v37, v89, v93
    v_cvt_pk_f16_f32 v41, v90, v94
    v_cvt_pk_f16_f32 v45, v91, v95
    v_bfi_b32 v33, s33, v17, v33
    v_bfi_b32 v37, s33, v17, v37
    v_bfi_b32 v41, s33, v17, v41
    v_bfi_b32 v45, s33, v17, v45
    v_cvt_pk_f16_f32 v34, v96, v100
    v_cvt_pk_f16_f32 v38, v97, v101
    v_cvt_pk_f16_f32 v42, v98, v102
    v_cvt_pk_f16_f32 v46, v99, v103
    v_bfi_b32 v34, s33, v18, v34
    v_bfi_b32 v38, s33, v18, v38
    v_bfi_b32 v42, s33, v18, v42
    v_bfi_b32 v46, s33, v18, v46
    v_cvt_pk_f16_f32 v35, v104, v108
    v_cvt_pk_f16_f32 v39, v105, v109
    v_cvt_pk_f16_f32 v43, v106, v110
    v_cvt_pk_f16_f32 v47, v107, v111
    v_bfi_b32 v35, s33, v19, v35
    v_bfi_b32 v39, s33, v19, v39
    v_bfi_b32 v43, s33, v19, v43
    v_bfi_b32 v47, s33, v19, v47
    s_cmp_lg_u32 s38, 0
    s_cbranch_scc1 f_slowst
    buffer_store_dwordx4 v[32:35], v251, s[12:15], s74 offen offset:0
    buffer_store_dwordx4 v[36:39], v251, s[12:15], s74 offen offset:2048
    buffer_store_dwordx4 v[40:43], v251, s[12:15], s75 offen offset:0
    buffer_store_dwordx4 v[44:47], v251, s[12:15], s75 offen offset:2048
f_std:
    v_xor_b32 v19, s17, v19
    v_xor_b32 v16, s44, v16
    v_xor_b32 v17, s44, v17
    v_xor_b32 v18, s44, v18
    v_xor_b32 v19, s44, v19
    s_mov_b32 s83, 0
    s_waitcnt vmcnt(4)
f_pp:
    v_xor_b32 v240, s56, v240
    v_xor_b32 v241, s57, v241
    v_xor_b32 v242, s58, v242
    v_xor_b32 v243, s59, v243
    v_or3_b32 v48, v240, v241, v242
    v_or_b32 v48, v48, v243
    v_and_b32 v48, 0xff, v48
    v_cmp_ne_u32 vcc, 0, v48
    s_cbranch_vccnz f_ppbad
f_ppok:
    s_cmp_ge_u32 s16, 4
    s_cbranch_scc1 f_pv
    v_mul_f32 v240, 0x42800000, v240
    v_mul_f32 v241, 0x42800000, v241
    v_mul_f32 v242, 0x42800000, v242
    v_mul_f32 v243, 0x42800000, v243
    ds_write_b128 v1, v[240:243]
    s_branch f_pw
f_pv:
    ds_write_b128 v1, v[240:243]
    v_lshlrev_b32 v52, 16, v248
    v_and_b32 v53, 0xffff0000, v248
    v_lshlrev_b32 v54, 16, v249
    v_and_b32 v55, 0xffff0000, v249
    v_pk_mul_f32 v[52:53], v[52:53], v[240:241]
    v_pk_mul_f32 v[54:55], v[54:55], v[242:243]
    ds_write_b128 v1, v[52:55] offset:8192
f_pw:
    s_waitcnt lgkmcnt(0)
    s_barrier
    buffer_load_dwordx4 v[32:35], v4, s[12:15], s28 offen sc1
    buffer_load_dwordx4 v[36:39], v4, s[12:15], s29 offen sc1
    buffer_load_dwordx4 v[40:43], v4, s[12:15], s50 offen sc1
    buffer_load_dwordx4 v[44:47], v4, s[12:15], s51 offen sc1
    ds_read_b128 v[48:51], v5 offset:16384
    ds_read_b128 v[52:55], v5 offset:17408
    ds_read_b128 v[56:59], v5 offset:18432
    ds_read_b128 v[60:63], v5 offset:19456
    ds_read_b128 v[240:243], v3 offset:45568
    ds_read_b128 v[244:247], v3 offset:46592
    ds_read_b128 v[248:251], v3 offset:47616
    ds_read_b128 v[252:255], v3 offset:48640
    ds_read_b128 v[112:115], v5 offset:0
    ds_read_b128 v[116:119], v5 offset:1024
    ds_read_b128 v[120:123], v5 offset:2048
    ds_read_b128 v[124:127], v5 offset:3072
    s_waitcnt lgkmcnt(8)
    ds_read_b128 v[128:131], v6 offset:3072
    ds_read_b128 v[132:135], v6 offset:2048
    ds_read_b128 v[136:139], v6 offset:1024
    ds_read_b128 v[140:143], v6 offset:0
    ds_read_b128 v[64:67], v6 offset:19456
    ds_read_b128 v[68:71], v6 offset:18432
    ds_read_b128 v[72:75], v6 offset:17408
    ds_read_b128 v[76:79], v6 offset:16384
    v_pk_add_f32 v[144:145], v[48:49], v[50:51]
    v_pk_add_f32 v[146:147], v[52:53], v[54:55]
    v_pk_add_f32 v[148:149], v[56:57], v[58:59]
    v_pk_add_f32 v[150:151], v[60:61], v[62:63]
    v_pk_add_f32 v[144:145], v[144:145], v[146:147]
    v_pk_add_f32 v[148:149], v[148:149], v[150:151]
    v_pk_add_f32 v[144:145], v[144:145], v[148:149]
    v_add_f32 v144, v144, v145
    s_nop 1
    v_add_f32_dpp v144, v144, v144 row_ror:8 row_mask:0xf bank_mask:0xf
    s_nop 1
    v_add_f32_dpp v144, v144, v144 row_ror:4 row_mask:0xf bank_mask:0xf
    s_nop 1
    v_add_f32_dpp v144, v144, v144 row_ror:2 row_mask:0xf bank_mask:0xf
    s_nop 1
    v_add_f32_dpp v144, v144, v144 row_ror:1 row_mask:0xf bank_mask:0xf
    s_nop 1
    v_add_f32_dpp v144, v144, v144 row_bcast:15 row_mask:0xa bank_mask:0xf
    s_nop 1
    v_add_f32_dpp v144, v144, v144 row_bcast:31 row_mask:0xc bank_mask:0xf
    s_nop 0
    v_readlane_b32 s54, v144, 63
    v_lshrrev_b32 v23, 5, v0
    v_mov_b32 v22, 0xffffff00
    s_mov_b64 s[70:71], 1
    s_mov_b32 s83, 0
f_zf:
    s_waitcnt vmcnt(0) lgkmcnt(0)
    v_xor_b32 v32, v32, v16
    v_xor_b32 v33, v33, v17
    v_xor_b32 v34, v34, v18
    v_xor_b32 v35, v35, v19
    v_xor_b32 v36, v36, v16
    v_xor_b32 v37, v37, v17
    v_xor_b32 v38, v38, v18
    v_xor_b32 v39, v39, v19
    v_mfma_f32_16x16x32_f16 v[80:83], v[32:35], v[192:195], 0
    v_xor_b32 v40, v40, v16
    v_xor_b32 v41, v41, v17
    v_xor_b32 v42, v42, v18
    v_xor_b32 v43, v43, v19
    v_mfma_f32_16x16x32_f16 v[80:83], v[36:39], v[196:199], v[80:83]
    v_xor_b32 v44, v44, v16
    v_xor_b32 v45, v45, v17
    v_xor_b32 v46, v46, v18
    v_xor_b32 v47, v47, v19
    v_mfma_f32_16x16x32_f16 v[80:83], v[40:43], v[200:203], v[80:83]
    v_xor_b32 v2, s44, v32
    v_bitop3_b32 v2, v2, v33, s44 bitop3:0xf6
    v_mfma_f32_16x16x32_f16 v[80:83], v[44:47], v[204:207], v[80:83]
    v_bitop3_b32 v2, v2, v34, s44 bitop3:0xf6
    v_bitop3_b32 v2, v2, v35, s44 bitop3:0xf6
    v_mfma_f32_16x16x32_f16 v[84:87], v[32:35], v[208:211], 0
    v_bitop3_b32 v2, v2, v36, s44 bitop3:0xf6
    v_bitop3_b32 v2, v2, v37, s44 bitop3:0xf6
    v_bitop3_b32 v2, v2, v38, s44 bitop3:0xf6
    v_mfma_f32_16x16x32_f16 v[84:87], v[36:39], v[212:215], v[84:87]
    v_bitop3_b32 v2, v2, v39, s44 bitop3:0xf6
    v_bitop3_b32 v2, v2, v40, s44 bitop3:0xf6
    v_bitop3_b32 v2, v2, v41, s44 bitop3:0xf6
    v_mfma_f32_16x16x32_f16 v[84:87], v[40:43], v[216:219], v[84:87]
    v_bitop3_b32 v2, v2, v42, s44 bitop3:0xf6
    v_bitop3_b32 v2, v2, v43, s44 bitop3:0xf6
    v_bitop3_b32 v2, v2, v44, s44 bitop3:0xf6
    v_mfma_f32_16x16x32_f16 v[84:87], v[44:47], v[220:223], v[84:87]
    v_bitop3_b32 v2, v2, v45, s44 bitop3:0xf6
    v_bitop3_b32 v2, v2, v46, s44 bitop3:0xf6
    v_bitop3_b32 v2, v2, v47, s44 bitop3:0xf6
    v_and_b32 v2, s33, v2
    v_cmp_ne_u32 vcc, 0, v2
    s_cbranch_vccnz f_zfbad
f_zfok:
    buffer_load_dwordx4 v[16:19], v15, s[12:15], s41 offen
    s_cmp_eq_u32 s30, 0
    s_cbranch_scc1 f_sp
    v_mfma_f32_16x16x32_f16 v[88:91], v[32:35], v[224:227], 0
    v_pk_fma_f32 v[160:161], v[112:113], v[80:81], v[160:161]
    v_pk_fma_f32 v[162:163], v[114:115], v[82:83], v[162:163]
    v_mfma_f32_16x16x32_f16 v[88:91], v[36:39], v[228:231], v[88:91]
    v_fmac_f32 v177, v129, v83
    v_fmac_f32 v178, v130, v82
    v_fmac_f32 v179, v131, v81
    v_mfma_f32_16x16x32_f16 v[88:91], v[40:43], v[232:235], v[88:91]
    v_pk_mul_f32 v[146:147], v[160:161], v[160:161]
    v_pk_mul_f32 v[148:149], v[160:161], v[48:49]
    v_mfma_f32_16x16x32_f16 v[88:91], v[44:47], v[236:239], v[88:91]
    v_pk_fma_f32 v[146:147], v[162:163], v[162:163], v[146:147]
    v_pk_fma_f32 v[148:149], v[162:163], v[50:51], v[148:149]
    v_mfma_f32_16x16x32_f16 v[92:95], v[32:35], v[240:243], 0
    v_cndmask_b32 v100, v80, v84, s[70:71]
    ds_bpermute_b32 v96, v7, v100
    v_pk_fma_f32 v[164:165], v[116:117], v[84:85], v[164:165]
    v_pk_fma_f32 v[166:167], v[118:119], v[86:87], v[166:167]
    v_mfma_f32_16x16x32_f16 v[92:95], v[36:39], v[244:247], v[92:95]
    v_fmac_f32 v181, v133, v87
    v_fmac_f32 v182, v134, v86
    v_fmac_f32 v183, v135, v85
    v_mfma_f32_16x16x32_f16 v[92:95], v[40:43], v[248:251], v[92:95]
    v_pk_fma_f32 v[146:147], v[164:165], v[164:165], v[146:147]
    v_pk_fma_f32 v[148:149], v[164:165], v[52:53], v[148:149]
    v_mfma_f32_16x16x32_f16 v[92:95], v[44:47], v[252:255], v[92:95]
    v_pk_fma_f32 v[146:147], v[166:167], v[166:167], v[146:147]
    v_pk_fma_f32 v[148:149], v[166:167], v[54:55], v[148:149]
    v_pk_mul_f32 v[154:155], v[178:179], v[178:179]
    v_pk_mul_f32 v[156:157], v[178:179], v[66:67]
    v_pk_fma_f32 v[154:155], v[182:183], v[182:183], v[154:155]
    v_pk_fma_f32 v[156:157], v[182:183], v[70:71], v[156:157]
    v_pk_add_f32 v[144:145], v[160:161], v[162:163]
    v_pk_add_f32 v[152:153], v[178:179], v[182:183]
    v_cndmask_b32 v101, v84, v88, s[70:71]
    ds_bpermute_b32 v97, v7, v101
    v_pk_fma_f32 v[168:169], v[120:121], v[88:89], v[168:169]
    v_pk_fma_f32 v[170:171], v[122:123], v[90:91], v[170:171]
    v_fmac_f32 v185, v137, v91
    v_fmac_f32 v186, v138, v90
    v_fmac_f32 v187, v139, v89
    v_pk_add_f32 v[144:145], v[144:145], v[164:165]
    v_pk_add_f32 v[144:145], v[144:145], v[166:167]
    v_pk_fma_f32 v[146:147], v[168:169], v[168:169], v[146:147]
    v_pk_fma_f32 v[148:149], v[168:169], v[56:57], v[148:149]
    v_pk_fma_f32 v[146:147], v[170:171], v[170:171], v[146:147]
    v_pk_fma_f32 v[148:149], v[170:171], v[58:59], v[148:149]
    v_pk_fma_f32 v[154:155], v[186:187], v[186:187], v[154:155]
    v_pk_fma_f32 v[156:157], v[186:187], v[74:75], v[156:157]
    v_cndmask_b32 v102, v88, v92, s[70:71]
    ds_bpermute_b32 v98, v7, v102
    v_cndmask_b32 v103, v92, v80, s[70:71]
    ds_bpermute_b32 v99, v7, v103
    v_pk_fma_f32 v[172:173], v[124:125], v[92:93], v[172:173]
    v_pk_fma_f32 v[174:175], v[126:127], v[94:95], v[174:175]
    v_fmac_f32 v189, v141, v95
    v_fmac_f32 v190, v142, v94
    v_fmac_f32 v191, v143, v93
    v_pk_fma_f32 v[146:147], v[172:173], v[172:173], v[146:147]
    v_pk_fma_f32 v[148:149], v[172:173], v[60:61], v[148:149]
    v_pk_fma_f32 v[146:147], v[174:175], v[174:175], v[146:147]
    v_pk_fma_f32 v[148:149], v[174:175], v[62:63], v[148:149]
    v_pk_fma_f32 v[154:155], v[190:191], v[190:191], v[154:155]
    v_pk_fma_f32 v[156:157], v[190:191], v[78:79], v[156:157]
    v_pk_add_f32 v[144:145], v[144:145], v[168:169]
    v_pk_add_f32 v[144:145], v[144:145], v[170:171]
    v_pk_add_f32 v[144:145], v[144:145], v[172:173]
    v_pk_add_f32 v[144:145], v[144:145], v[174:175]
    v_pk_add_f32 v[152:153], v[152:153], v[186:187]
    v_pk_add_f32 v[152:153], v[152:153], v[190:191]
    s_waitcnt lgkmcnt(0)
    v_fmac_f32 v176, v128, v96
    v_fmac_f32 v180, v132, v97
    v_fmac_f32 v184, v136, v98
    v_fmac_f32 v188, v140, v99
    v_pk_fma_f32 v[154:155], v[176:177], v[176:177], v[154:155]
    v_pk_fma_f32 v[156:157], v[176:177], v[64:65], v[156:157]
    v_pk_add_f32 v[152:153], v[152:153], v[176:177]
    v_pk_fma_f32 v[154:155], v[180:181], v[180:181], v[154:155]
    v_pk_fma_f32 v[156:157], v[180:181], v[68:69], v[156:157]
    v_pk_add_f32 v[152:153], v[152:153], v[180:181]
    v_pk_fma_f32 v[154:155], v[184:185], v[184:185], v[154:155]
    v_pk_fma_f32 v[156:157], v[184:185], v[72:73], v[156:157]
    v_pk_add_f32 v[152:153], v[152:153], v[184:185]
    v_pk_fma_f32 v[154:155], v[188:189], v[188:189], v[154:155]
    v_pk_fma_f32 v[156:157], v[188:189], v[76:77], v[156:157]
    v_pk_add_f32 v[152:153], v[152:153], v[188:189]
f_join:
    ds_read_b128 v[192:195], v5 offset:8192
    ds_read_b128 v[196:199], v5 offset:9216
    ds_read_b128 v[200:203], v5 offset:10240
    ds_read_b128 v[204:207], v5 offset:11264
    ds_read_b128 v[208:211], v6 offset:11264
    ds_read_b128 v[212:215], v6 offset:10240
    ds_read_b128 v[216:219], v6 offset:9216
    ds_read_b128 v[220:223], v6 offset:8192
    s_cmp_lg_u32 s16, 0
    s_cbranch_scc1 f_ngo
    s_waitcnt vmcnt(0)
    s_or_b32 s42, s35, s16
    s_cmp_lg_u32 s42, 0
    s_cbranch_scc1 f_ngo
    v_mov_b32 v2, s32
    s_mov_b64 exec, 1
    buffer_store_dword v2, v13, s[12:15], s81 offen offset:2048 sc1
    s_mov_b64 exec, -1
f_ngo:
    v_add_f32 v104, v144, v145
    v_add_f32 v105, v146, v147
    v_add_f32 v106, v148, v149
    v_add_f32 v108, v152, v153
    v_add_f32 v109, v154, v155
    v_add_f32 v110, v156, v157
    v_permlane32_swap_b32 v104, v108
    v_permlane32_swap_b32 v105, v109
    v_permlane32_swap_b32 v106, v110
    v_add_f32 v104, v104, v108
    v_add_f32 v105, v105, v109
    v_add_f32 v106, v106, v110
    v_add_f32_dpp v104, v104, v104 row_ror:8 row_mask:0xf bank_mask:0xf
    v_add_f32_dpp v105, v105, v105 row_ror:8 row_mask:0xf bank_mask:0xf
    v_add_f32_dpp v106, v106, v106 row_ror:8 row_mask:0xf bank_mask:0xf
    v_add_f32_dpp v104, v104, v104 row_ror:4 row_mask:0xf bank_mask:0xf
    v_add_f32_dpp v105, v105, v105 row_ror:4 row_mask:0xf bank_mask:0xf
    v_add_f32_dpp v106, v106, v106 row_ror:4 row_mask:0xf bank_mask:0xf
    v_add_f32_dpp v104, v104, v104 row_ror:2 row_mask:0xf bank_mask:0xf
    v_add_f32_dpp v105, v105, v105 row_ror:2 row_mask:0xf bank_mask:0xf
    v_add_f32_dpp v106, v106, v106 row_ror:2 row_mask:0xf bank_mask:0xf
    v_add_f32_dpp v104, v104, v104 row_ror:1 row_mask:0xf bank_mask:0xf
    v_add_f32_dpp v105, v105, v105 row_ror:1 row_mask:0xf bank_mask:0xf
    v_add_f32_dpp v106, v106, v106 row_ror:1 row_mask:0xf bank_mask:0xf
    v_add_f32_dpp v104, v104, v104 row_bcast:15 row_mask:0xa bank_mask:0xf
    v_add_f32_dpp v105, v105, v105 row_bcast:15 row_mask:0xa bank_mask:0xf
    v_add_f32_dpp v106, v106, v106 row_bcast:15 row_mask:0xa bank_mask:0xf
    v_mul_f32 v104, s46, v104
    v_mul_f32 v105, s46, v105
    v_mul_f32 v108, v104, v104
    v_fma_f32 v106, -v104, s54, v106
    v_sub_f32 v105, v105, v108
    v_mul_f32 v109, 4.0, v105
    v_cmp_gt_f32 vcc, v108, v109
    s_or_b32 s42, vcc_lo, vcc_hi
    s_bitcmp1_b32 s42, 31
    s_cbranch_scc1 f_slow2
f_var2:
    v_cvt_pk_bf16_f32 v105, v105, v105
    v_lshlrev_b32 v105, 16, v105
    v_add_f32 v105, 0x3727c5ac, v105
    v_cvt_pk_bf16_f32 v105, v105, v105
    v_lshlrev_b32 v105, 16, v105
    v_sqrt_f32 v105, v105
    s_nop 0
    v_cvt_pk_bf16_f32 v105, v105, v105
    v_lshlrev_b32 v105, 16, v105
    v_rcp_f32 v105, v105
    s_mov_b32 s42, 0x80000000
    s_mov_b32 exec_lo, s42
    s_mov_b32 exec_hi, s42
    v_mul_f32 v106, v106, v105
    v_ashrrev_i32 v108, 31, v106
    v_or_b32 v108, s42, v108
    v_xor_b32 v106, v106, v108
    v_and_or_b32 v106, v106, v22, v23
    ds_write_b32 v11, v106
    s_mov_b64 exec, -1
    v_readlane_b32 s60, v106, 31
    v_readlane_b32 s64, v104, 31
    v_readlane_b32 s65, v105, 31
    v_readlane_b32 s61, v106, 63
    v_readlane_b32 s66, v104, 63
    v_readlane_b32 s67, v105, 63
    s_waitcnt lgkmcnt(0)
    s_barrier
    ds_read_b32 v24, v12
    s_lshl_b32 s42, s3, 1
    s_movk_i32 s43, 0xff00
    v_mov_b32 v30, s32
    v_mov_b32 v31, s32
    s_cmp_lg_u32 s16, 0
    s_waitcnt lgkmcnt(0)
    s_cbranch_scc1 f_nkey
    s_setprio 3
    v_mov_b32 v28, v24
    s_nop 1
    v_max_u32_dpp v28, v28, v28 row_ror:8 row_mask:0xf bank_mask:0xf
    s_nop 1
    v_max_u32_dpp v28, v28, v28 row_ror:4 row_mask:0xf bank_mask:0xf
    s_nop 1
    v_max_u32_dpp v28, v28, v28 row_ror:2 row_mask:0xf bank_mask:0xf
    s_nop 1
    v_max_u32_dpp v28, v28, v28 row_ror:1 row_mask:0xf bank_mask:0xf
    v_cmp_eq_u32 vcc, v28, v24
    s_nop 1
    v_cndmask_b32_e64 v29, v24, 0, vcc
    v_and_b32 v28, s43, v28
    s_nop 0
    v_max_u32_dpp v29, v29, v29 row_ror:8 row_mask:0xf bank_mask:0xf
    s_nop 1
    v_max_u32_dpp v29, v29, v29 row_ror:4 row_mask:0xf bank_mask:0xf
    s_nop 1
    v_max_u32_dpp v29, v29, v29 row_ror:2 row_mask:0xf bank_mask:0xf
    s_nop 1
    v_max_u32_dpp v29, v29, v29 row_ror:1 row_mask:0xf bank_mask:0xf
    v_or_b32 v28, s42, v28
    v_and_b32 v29, s43, v29
    v_or3_b32 v29, v29, s42, 1
    s_mov_b64 exec, 0xff
    buffer_store_dwordx4 v[28:31], v13, s[12:15], s80 offen sc1
    s_mov_b64 exec, -1
    s_setprio 0
f_nkey:
    s_cmp_eq_u32 s16, 0
    s_cbranch_scc1 f_w0
    s_waitcnt vmcnt(0)
f_w0:
    s_mov_b32 s83, 0
    s_waitcnt vmcnt(63)
f_pb:
    v_xor_b32 v16, s56, v16
    v_xor_b32 v17, s57, v17
    v_xor_b32 v18, s58, v18
    v_xor_b32 v19, s59, v19
    v_or3_b32 v2, v16, v17, v18
    v_or_b32 v2, v2, v19
    v_and_b32 v2, 0xff, v2
    v_cmp_ne_u32 vcc, 0, v2
    s_cbranch_vccnz f_pbbad
f_pbok:
    ds_write_b128 v1, v[16:19] offset:4096
    s_waitcnt lgkmcnt(0)
    s_barrier
    ds_read_b128 v[224:227], v5 offset:4096
    ds_read_b128 v[228:231], v5 offset:5120
    ds_read_b128 v[232:235], v5 offset:6144
    ds_read_b128 v[236:239], v5 offset:7168
    ds_read_b128 v[240:243], v6 offset:7168
    ds_read_b128 v[244:247], v6 offset:6144
    ds_read_b128 v[248:251], v6 offset:5120
    ds_read_b128 v[252:255], v6 offset:4096
    ds_read_b128 v[112:115], v5 offset:12288
    ds_read_b128 v[116:119], v5 offset:13312
    ds_read_b128 v[120:123], v5 offset:14336
    ds_read_b128 v[124:127], v5 offset:15360
    ds_read_b128 v[128:131], v6 offset:15360
    ds_read_b128 v[132:135], v6 offset:14336
    ds_read_b128 v[136:139], v6 offset:13312
    ds_read_b128 v[140:143], v6 offset:12288
    v_mov_b32 v20, 0
    s_movk_i32 s62, 0x100
    v_cmp_lt_u32 vcc, s60, v24
    s_and_b32 s42, vcc_lo, 0xffff
    s_bcnt1_i32_b32 s42, s42
    s_cmp_ge_u32 s42, 2
    s_cbranch_scc1 f_nc0
    s_setprio 2
    s_lshl_b32 s62, s3, 1
    s_add_u32 s62, s62, s42
    s_lshl_b32 s42, s62, 12
    s_add_u32 s42, s42, 5242880
    s_lshl_b32 s43, s62, 3
    s_add_u32 s43, s43, 6506496
    v_pk_add_f32 v[48:49], v[160:161], s[64:65] op_sel:[0,0] op_sel_hi:[1,0] neg_lo:[0,1] neg_hi:[0,1]
    v_pk_add_f32 v[50:51], v[162:163], s[64:65] op_sel:[0,0] op_sel_hi:[1,0] neg_lo:[0,1] neg_hi:[0,1]
    v_pk_add_f32 v[52:53], v[164:165], s[64:65] op_sel:[0,0] op_sel_hi:[1,0] neg_lo:[0,1] neg_hi:[0,1]
    v_pk_add_f32 v[54:55], v[166:167], s[64:65] op_sel:[0,0] op_sel_hi:[1,0] neg_lo:[0,1] neg_hi:[0,1]
    v_pk_add_f32 v[56:57], v[168:169], s[64:65] op_sel:[0,0] op_sel_hi:[1,0] neg_lo:[0,1] neg_hi:[0,1]
    v_pk_add_f32 v[58:59], v[170:171], s[64:65] op_sel:[0,0] op_sel_hi:[1,0] neg_lo:[0,1] neg_hi:[0,1]
    v_pk_add_f32 v[60:61], v[172:173], s[64:65] op_sel:[0,0] op_sel_hi:[1,0] neg_lo:[0,1] neg_hi:[0,1]
    v_pk_add_f32 v[62:63], v[174:175], s[64:65] op_sel:[0,0] op_sel_hi:[1,0] neg_lo:[0,1] neg_hi:[0,1]
    v_pk_mul_f32 v[48:49], v[48:49], v[192:193]
    v_pk_mul_f32 v[50:51], v[50:51], v[194:195]
    v_pk_mul_f32 v[52:53], v[52:53], v[196:197]
    v_pk_mul_f32 v[54:55], v[54:55], v[198:199]
    v_pk_mul_f32 v[56:57], v[56:57], v[200:201]
    v_pk_mul_f32 v[58:59], v[58:59], v[202:203]
    v_pk_mul_f32 v[60:61], v[60:61], v[204:205]
    v_pk_mul_f32 v[62:63], v[62:63], v[206:207]
    s_waitcnt lgkmcnt(0)
    v_pk_fma_f32 v[48:49], v[48:49], s[64:65], v[224:225] op_sel:[0,1,0] op_sel_hi:[1,1,1]
    v_pk_fma_f32 v[50:51], v[50:51], s[64:65], v[226:227] op_sel:[0,1,0] op_sel_hi:[1,1,1]
    v_pk_fma_f32 v[52:53], v[52:53], s[64:65], v[228:229] op_sel:[0,1,0] op_sel_hi:[1,1,1]
    v_pk_fma_f32 v[54:55], v[54:55], s[64:65], v[230:231] op_sel:[0,1,0] op_sel_hi:[1,1,1]
    v_pk_fma_f32 v[56:57], v[56:57], s[64:65], v[232:233] op_sel:[0,1,0] op_sel_hi:[1,1,1]
    v_pk_fma_f32 v[58:59], v[58:59], s[64:65], v[234:235] op_sel:[0,1,0] op_sel_hi:[1,1,1]
    v_pk_fma_f32 v[60:61], v[60:61], s[64:65], v[236:237] op_sel:[0,1,0] op_sel_hi:[1,1,1]
    v_pk_fma_f32 v[62:63], v[62:63], s[64:65], v[238:239] op_sel:[0,1,0] op_sel_hi:[1,1,1]
    v_cvt_pk_bf16_f32 v80, v48, v49
    v_cvt_pk_bf16_f32 v81, v50, v51
    ds_write_b64 v8, v[80:81] offset:0
    v_cvt_pk_bf16_f32 v82, v52, v53
    v_cvt_pk_bf16_f32 v83, v54, v55
    ds_write_b64 v8, v[82:83] offset:512
    v_cvt_pk_bf16_f32 v84, v56, v57
    v_cvt_pk_bf16_f32 v85, v58, v59
    ds_write_b64 v8, v[84:85] offset:1024
    v_cvt_pk_bf16_f32 v86, v60, v61
    v_cvt_pk_bf16_f32 v87, v62, v63
    ds_write_b64 v8, v[86:87] offset:1536
    ds_read_b128 v[88:91], v10 offset:0
    ds_read_b128 v[92:95], v10 offset:1024
    v_pk_fma_f32 v[160:161], v[112:113], v[48:49], v[160:161]
    v_pk_fma_f32 v[162:163], v[114:115], v[50:51], v[162:163]
    v_pk_fma_f32 v[164:165], v[116:117], v[52:53], v[164:165]
    v_pk_fma_f32 v[166:167], v[118:119], v[54:55], v[166:167]
    v_pk_fma_f32 v[168:169], v[120:121], v[56:57], v[168:169]
    v_pk_fma_f32 v[170:171], v[122:123], v[58:59], v[170:171]
    v_pk_fma_f32 v[172:173], v[124:125], v[60:61], v[172:173]
    v_pk_fma_f32 v[174:175], v[126:127], v[62:63], v[174:175]
    s_waitcnt lgkmcnt(0)
    v_min_u32 v88, -2, v88
    v_min_u32 v89, -2, v89
    v_min_u32 v90, -2, v90
    v_min_u32 v91, -2, v91
    v_min_u32 v92, -2, v92
    v_min_u32 v93, -2, v93
    v_min_u32 v94, -2, v94
    v_min_u32 v95, -2, v95
    buffer_store_dwordx4 v[88:91], v3, s[12:15], s42 offen offset:0 sc1
    buffer_store_dwordx4 v[92:95], v3, s[12:15], s42 offen offset:1024 sc1
    v_cvt_pk_bf16_f32 v80, v160, v161
    v_cvt_pk_bf16_f32 v81, v162, v163
    ds_write_b64 v8, v[80:81] offset:0
    v_cvt_pk_bf16_f32 v82, v164, v165
    v_cvt_pk_bf16_f32 v83, v166, v167
    ds_write_b64 v8, v[82:83] offset:512
    v_cvt_pk_bf16_f32 v84, v168, v169
    v_cvt_pk_bf16_f32 v85, v170, v171
    ds_write_b64 v8, v[84:85] offset:1024
    v_cvt_pk_bf16_f32 v86, v172, v173
    v_cvt_pk_bf16_f32 v87, v174, v175
    ds_write_b64 v8, v[86:87] offset:1536
    ds_read_b128 v[32:35], v10 offset:0
    ds_read_b128 v[36:39], v10 offset:1024
    s_waitcnt lgkmcnt(0)
    v_min_u32 v32, -2, v32
    v_min_u32 v33, -2, v33
    v_min_u32 v34, -2, v34
    v_min_u32 v35, -2, v35
    v_min_u32 v36, -2, v36
    v_min_u32 v37, -2, v37
    v_min_u32 v38, -2, v38
    v_min_u32 v39, -2, v39
    buffer_store_dwordx4 v[32:35], v3, s[12:15], s42 offen offset:2048 sc1
    buffer_store_dwordx4 v[36:39], v3, s[12:15], s42 offen offset:3072 sc1
    v_mov_b32 v30, s30
    s_mov_b64 exec, 1
    buffer_store_dwordx2 v[30:31], v20, s[12:15], s43 offen sc1
    s_mov_b64 exec, -1
    s_setprio 0
f_nc0:
    s_movk_i32 s63, 0x100
    v_cmp_lt_u32 vcc, s61, v24
    s_and_b32 s42, vcc_lo, 0xffff
    s_bcnt1_i32_b32 s42, s42
    s_cmp_ge_u32 s42, 2
    s_cbranch_scc1 f_nc1
    s_setprio 2
    s_lshl_b32 s63, s3, 1
    s_add_u32 s63, s63, s42
    s_lshl_b32 s42, s63, 12
    s_add_u32 s42, s42, 5242880
    s_lshl_b32 s43, s63, 3
    s_add_u32 s43, s43, 6506496
    v_pk_add_f32 v[64:65], v[176:177], s[66:67] op_sel:[0,0] op_sel_hi:[1,0] neg_lo:[0,1] neg_hi:[0,1]
    v_pk_add_f32 v[66:67], v[178:179], s[66:67] op_sel:[0,0] op_sel_hi:[1,0] neg_lo:[0,1] neg_hi:[0,1]
    v_pk_add_f32 v[68:69], v[180:181], s[66:67] op_sel:[0,0] op_sel_hi:[1,0] neg_lo:[0,1] neg_hi:[0,1]
    v_pk_add_f32 v[70:71], v[182:183], s[66:67] op_sel:[0,0] op_sel_hi:[1,0] neg_lo:[0,1] neg_hi:[0,1]
    v_pk_add_f32 v[72:73], v[184:185], s[66:67] op_sel:[0,0] op_sel_hi:[1,0] neg_lo:[0,1] neg_hi:[0,1]
    v_pk_add_f32 v[74:75], v[186:187], s[66:67] op_sel:[0,0] op_sel_hi:[1,0] neg_lo:[0,1] neg_hi:[0,1]
    v_pk_add_f32 v[76:77], v[188:189], s[66:67] op_sel:[0,0] op_sel_hi:[1,0] neg_lo:[0,1] neg_hi:[0,1]
    v_pk_add_f32 v[78:79], v[190:191], s[66:67] op_sel:[0,0] op_sel_hi:[1,0] neg_lo:[0,1] neg_hi:[0,1]
    v_pk_mul_f32 v[64:65], v[64:65], v[208:209]
    v_pk_mul_f32 v[66:67], v[66:67], v[210:211]
    v_pk_mul_f32 v[68:69], v[68:69], v[212:213]
    v_pk_mul_f32 v[70:71], v[70:71], v[214:215]
    v_pk_mul_f32 v[72:73], v[72:73], v[216:217]
    v_pk_mul_f32 v[74:75], v[74:75], v[218:219]
    v_pk_mul_f32 v[76:77], v[76:77], v[220:221]
    v_pk_mul_f32 v[78:79], v[78:79], v[222:223]
    s_waitcnt lgkmcnt(0)
    v_pk_fma_f32 v[64:65], v[64:65], s[66:67], v[240:241] op_sel:[0,1,0] op_sel_hi:[1,1,1]
    v_pk_fma_f32 v[66:67], v[66:67], s[66:67], v[242:243] op_sel:[0,1,0] op_sel_hi:[1,1,1]
    v_pk_fma_f32 v[68:69], v[68:69], s[66:67], v[244:245] op_sel:[0,1,0] op_sel_hi:[1,1,1]
    v_pk_fma_f32 v[70:71], v[70:71], s[66:67], v[246:247] op_sel:[0,1,0] op_sel_hi:[1,1,1]
    v_pk_fma_f32 v[72:73], v[72:73], s[66:67], v[248:249] op_sel:[0,1,0] op_sel_hi:[1,1,1]
    v_pk_fma_f32 v[74:75], v[74:75], s[66:67], v[250:251] op_sel:[0,1,0] op_sel_hi:[1,1,1]
    v_pk_fma_f32 v[76:77], v[76:77], s[66:67], v[252:253] op_sel:[0,1,0] op_sel_hi:[1,1,1]
    v_pk_fma_f32 v[78:79], v[78:79], s[66:67], v[254:255] op_sel:[0,1,0] op_sel_hi:[1,1,1]
    v_cvt_pk_bf16_f32 v80, v64, v65
    v_cvt_pk_bf16_f32 v81, v66, v67
    ds_write_b64 v9, v[80:81] offset:1536
    v_cvt_pk_bf16_f32 v82, v68, v69
    v_cvt_pk_bf16_f32 v83, v70, v71
    ds_write_b64 v9, v[82:83] offset:1024
    v_cvt_pk_bf16_f32 v84, v72, v73
    v_cvt_pk_bf16_f32 v85, v74, v75
    ds_write_b64 v9, v[84:85] offset:512
    v_cvt_pk_bf16_f32 v86, v76, v77
    v_cvt_pk_bf16_f32 v87, v78, v79
    ds_write_b64 v9, v[86:87] offset:0
    ds_read_b128 v[88:91], v10 offset:2048
    ds_read_b128 v[92:95], v10 offset:3072
    v_pk_fma_f32 v[176:177], v[128:129], v[64:65], v[176:177]
    v_pk_fma_f32 v[178:179], v[130:131], v[66:67], v[178:179]
    v_pk_fma_f32 v[180:181], v[132:133], v[68:69], v[180:181]
    v_pk_fma_f32 v[182:183], v[134:135], v[70:71], v[182:183]
    v_pk_fma_f32 v[184:185], v[136:137], v[72:73], v[184:185]
    v_pk_fma_f32 v[186:187], v[138:139], v[74:75], v[186:187]
    v_pk_fma_f32 v[188:189], v[140:141], v[76:77], v[188:189]
    v_pk_fma_f32 v[190:191], v[142:143], v[78:79], v[190:191]
    s_waitcnt lgkmcnt(0)
    v_min_u32 v88, -2, v88
    v_min_u32 v89, -2, v89
    v_min_u32 v90, -2, v90
    v_min_u32 v91, -2, v91
    v_min_u32 v92, -2, v92
    v_min_u32 v93, -2, v93
    v_min_u32 v94, -2, v94
    v_min_u32 v95, -2, v95
    buffer_store_dwordx4 v[88:91], v3, s[12:15], s42 offen offset:0 sc1
    buffer_store_dwordx4 v[92:95], v3, s[12:15], s42 offen offset:1024 sc1
    v_cvt_pk_bf16_f32 v80, v176, v177
    v_cvt_pk_bf16_f32 v81, v178, v179
    ds_write_b64 v9, v[80:81] offset:1536
    v_cvt_pk_bf16_f32 v82, v180, v181
    v_cvt_pk_bf16_f32 v83, v182, v183
    ds_write_b64 v9, v[82:83] offset:1024
    v_cvt_pk_bf16_f32 v84, v184, v185
    v_cvt_pk_bf16_f32 v85, v186, v187
    ds_write_b64 v9, v[84:85] offset:512
    v_cvt_pk_bf16_f32 v86, v188, v189
    v_cvt_pk_bf16_f32 v87, v190, v191
    ds_write_b64 v9, v[86:87] offset:0
    ds_read_b128 v[40:43], v10 offset:2048
    ds_read_b128 v[44:47], v10 offset:3072
    s_waitcnt lgkmcnt(0)
    v_min_u32 v40, -2, v40
    v_min_u32 v41, -2, v41
    v_min_u32 v42, -2, v42
    v_min_u32 v43, -2, v43
    v_min_u32 v44, -2, v44
    v_min_u32 v45, -2, v45
    v_min_u32 v46, -2, v46
    v_min_u32 v47, -2, v47
    buffer_store_dwordx4 v[40:43], v3, s[12:15], s42 offen offset:2048 sc1
    buffer_store_dwordx4 v[44:47], v3, s[12:15], s42 offen offset:3072 sc1
    v_mov_b32 v30, s31
    s_mov_b64 exec, 1
    buffer_store_dwordx2 v[30:31], v20, s[12:15], s43 offen sc1
    s_mov_b64 exec, -1
    s_setprio 0
f_nc1:
    s_cmp_lt_u32 s62, 0x100
    s_cbranch_scc1 f_op0
    v_pk_add_f32 v[48:49], v[160:161], s[64:65] op_sel:[0,0] op_sel_hi:[1,0] neg_lo:[0,1] neg_hi:[0,1]
    v_pk_add_f32 v[50:51], v[162:163], s[64:65] op_sel:[0,0] op_sel_hi:[1,0] neg_lo:[0,1] neg_hi:[0,1]
    v_pk_add_f32 v[52:53], v[164:165], s[64:65] op_sel:[0,0] op_sel_hi:[1,0] neg_lo:[0,1] neg_hi:[0,1]
    v_pk_add_f32 v[54:55], v[166:167], s[64:65] op_sel:[0,0] op_sel_hi:[1,0] neg_lo:[0,1] neg_hi:[0,1]
    v_pk_add_f32 v[56:57], v[168:169], s[64:65] op_sel:[0,0] op_sel_hi:[1,0] neg_lo:[0,1] neg_hi:[0,1]
    v_pk_add_f32 v[58:59], v[170:171], s[64:65] op_sel:[0,0] op_sel_hi:[1,0] neg_lo:[0,1] neg_hi:[0,1]
    v_pk_add_f32 v[60:61], v[172:173], s[64:65] op_sel:[0,0] op_sel_hi:[1,0] neg_lo:[0,1] neg_hi:[0,1]
    v_pk_add_f32 v[62:63], v[174:175], s[64:65] op_sel:[0,0] op_sel_hi:[1,0] neg_lo:[0,1] neg_hi:[0,1]
    v_pk_mul_f32 v[48:49], v[48:49], v[192:193]
    v_pk_mul_f32 v[50:51], v[50:51], v[194:195]
    v_pk_mul_f32 v[52:53], v[52:53], v[196:197]
    v_pk_mul_f32 v[54:55], v[54:55], v[198:199]
    v_pk_mul_f32 v[56:57], v[56:57], v[200:201]
    v_pk_mul_f32 v[58:59], v[58:59], v[202:203]
    v_pk_mul_f32 v[60:61], v[60:61], v[204:205]
    v_pk_mul_f32 v[62:63], v[62:63], v[206:207]
    s_waitcnt lgkmcnt(0)
    v_pk_fma_f32 v[48:49], v[48:49], s[64:65], v[224:225] op_sel:[0,1,0] op_sel_hi:[1,1,1]
    v_pk_fma_f32 v[50:51], v[50:51], s[64:65], v[226:227] op_sel:[0,1,0] op_sel_hi:[1,1,1]
    v_pk_fma_f32 v[52:53], v[52:53], s[64:65], v[228:229] op_sel:[0,1,0] op_sel_hi:[1,1,1]
    v_pk_fma_f32 v[54:55], v[54:55], s[64:65], v[230:231] op_sel:[0,1,0] op_sel_hi:[1,1,1]
    v_pk_fma_f32 v[56:57], v[56:57], s[64:65], v[232:233] op_sel:[0,1,0] op_sel_hi:[1,1,1]
    v_pk_fma_f32 v[58:59], v[58:59], s[64:65], v[234:235] op_sel:[0,1,0] op_sel_hi:[1,1,1]
    v_pk_fma_f32 v[60:61], v[60:61], s[64:65], v[236:237] op_sel:[0,1,0] op_sel_hi:[1,1,1]
    v_pk_fma_f32 v[62:63], v[62:63], s[64:65], v[238:239] op_sel:[0,1,0] op_sel_hi:[1,1,1]
    v_pk_fma_f32 v[160:161], v[112:113], v[48:49], v[160:161]
    v_pk_fma_f32 v[162:163], v[114:115], v[50:51], v[162:163]
    v_pk_fma_f32 v[164:165], v[116:117], v[52:53], v[164:165]
    v_pk_fma_f32 v[166:167], v[118:119], v[54:55], v[166:167]
    v_pk_fma_f32 v[168:169], v[120:121], v[56:57], v[168:169]
    v_pk_fma_f32 v[170:171], v[122:123], v[58:59], v[170:171]
    v_pk_fma_f32 v[172:173], v[124:125], v[60:61], v[172:173]
    v_pk_fma_f32 v[174:175], v[126:127], v[62:63], v[174:175]
    v_cvt_pk_bf16_f32 v80, v160, v161
    v_cvt_pk_bf16_f32 v81, v162, v163
    ds_write_b64 v8, v[80:81] offset:0
    v_cvt_pk_bf16_f32 v82, v164, v165
    v_cvt_pk_bf16_f32 v83, v166, v167
    ds_write_b64 v8, v[82:83] offset:512
    v_cvt_pk_bf16_f32 v84, v168, v169
    v_cvt_pk_bf16_f32 v85, v170, v171
    ds_write_b64 v8, v[84:85] offset:1024
    v_cvt_pk_bf16_f32 v86, v172, v173
    v_cvt_pk_bf16_f32 v87, v174, v175
    ds_write_b64 v8, v[86:87] offset:1536
    ds_read_b128 v[32:35], v10 offset:0
    ds_read_b128 v[36:39], v10 offset:1024
f_op0:
    s_cmp_lt_u32 s63, 0x100
    s_cbranch_scc1 f_op1
    v_pk_add_f32 v[64:65], v[176:177], s[66:67] op_sel:[0,0] op_sel_hi:[1,0] neg_lo:[0,1] neg_hi:[0,1]
    v_pk_add_f32 v[66:67], v[178:179], s[66:67] op_sel:[0,0] op_sel_hi:[1,0] neg_lo:[0,1] neg_hi:[0,1]
    v_pk_add_f32 v[68:69], v[180:181], s[66:67] op_sel:[0,0] op_sel_hi:[1,0] neg_lo:[0,1] neg_hi:[0,1]
    v_pk_add_f32 v[70:71], v[182:183], s[66:67] op_sel:[0,0] op_sel_hi:[1,0] neg_lo:[0,1] neg_hi:[0,1]
    v_pk_add_f32 v[72:73], v[184:185], s[66:67] op_sel:[0,0] op_sel_hi:[1,0] neg_lo:[0,1] neg_hi:[0,1]
    v_pk_add_f32 v[74:75], v[186:187], s[66:67] op_sel:[0,0] op_sel_hi:[1,0] neg_lo:[0,1] neg_hi:[0,1]
    v_pk_add_f32 v[76:77], v[188:189], s[66:67] op_sel:[0,0] op_sel_hi:[1,0] neg_lo:[0,1] neg_hi:[0,1]
    v_pk_add_f32 v[78:79], v[190:191], s[66:67] op_sel:[0,0] op_sel_hi:[1,0] neg_lo:[0,1] neg_hi:[0,1]
    v_pk_mul_f32 v[64:65], v[64:65], v[208:209]
    v_pk_mul_f32 v[66:67], v[66:67], v[210:211]
    v_pk_mul_f32 v[68:69], v[68:69], v[212:213]
    v_pk_mul_f32 v[70:71], v[70:71], v[214:215]
    v_pk_mul_f32 v[72:73], v[72:73], v[216:217]
    v_pk_mul_f32 v[74:75], v[74:75], v[218:219]
    v_pk_mul_f32 v[76:77], v[76:77], v[220:221]
    v_pk_mul_f32 v[78:79], v[78:79], v[222:223]
    s_waitcnt lgkmcnt(0)
    v_pk_fma_f32 v[64:65], v[64:65], s[66:67], v[240:241] op_sel:[0,1,0] op_sel_hi:[1,1,1]
    v_pk_fma_f32 v[66:67], v[66:67], s[66:67], v[242:243] op_sel:[0,1,0] op_sel_hi:[1,1,1]
    v_pk_fma_f32 v[68:69], v[68:69], s[66:67], v[244:245] op_sel:[0,1,0] op_sel_hi:[1,1,1]
    v_pk_fma_f32 v[70:71], v[70:71], s[66:67], v[246:247] op_sel:[0,1,0] op_sel_hi:[1,1,1]
    v_pk_fma_f32 v[72:73], v[72:73], s[66:67], v[248:249] op_sel:[0,1,0] op_sel_hi:[1,1,1]
    v_pk_fma_f32 v[74:75], v[74:75], s[66:67], v[250:251] op_sel:[0,1,0] op_sel_hi:[1,1,1]
    v_pk_fma_f32 v[76:77], v[76:77], s[66:67], v[252:253] op_sel:[0,1,0] op_sel_hi:[1,1,1]
    v_pk_fma_f32 v[78:79], v[78:79], s[66:67], v[254:255] op_sel:[0,1,0] op_sel_hi:[1,1,1]
    v_pk_fma_f32 v[176:177], v[128:129], v[64:65], v[176:177]
    v_pk_fma_f32 v[178:179], v[130:131], v[66:67], v[178:179]
    v_pk_fma_f32 v[180:181], v[132:133], v[68:69], v[180:181]
    v_pk_fma_f32 v[182:183], v[134:135], v[70:71], v[182:183]
    v_pk_fma_f32 v[184:185], v[136:137], v[72:73], v[184:185]
    v_pk_fma_f32 v[186:187], v[138:139], v[74:75], v[186:187]
    v_pk_fma_f32 v[188:189], v[140:141], v[76:77], v[188:189]
    v_pk_fma_f32 v[190:191], v[142:143], v[78:79], v[190:191]
    v_cvt_pk_bf16_f32 v80, v176, v177
    v_cvt_pk_bf16_f32 v81, v178, v179
    ds_write_b64 v9, v[80:81] offset:1536
    v_cvt_pk_bf16_f32 v82, v180, v181
    v_cvt_pk_bf16_f32 v83, v182, v183
    ds_write_b64 v9, v[82:83] offset:1024
    v_cvt_pk_bf16_f32 v84, v184, v185
    v_cvt_pk_bf16_f32 v85, v186, v187
    ds_write_b64 v9, v[84:85] offset:512
    v_cvt_pk_bf16_f32 v86, v188, v189
    v_cvt_pk_bf16_f32 v87, v190, v191
    ds_write_b64 v9, v[86:87] offset:0
    ds_read_b128 v[40:43], v10 offset:2048
    ds_read_b128 v[44:47], v10 offset:3072
f_op1:
    v_mov_b32 v21, 103016
    s_cmp_lg_u32 s16, 0
    s_cbranch_scc1 f_nrs
    v_mov_b32 v20, 0
    s_mov_b32 s83, 0
f_rs:
    buffer_load_dwordx2 v[28:29], v20, s[12:15], s81 offen offset:2304 sc1
    s_waitcnt vmcnt(0)
    v_readfirstlane_b32 s40, v28
    v_readfirstlane_b32 s41, v29
    s_cmp_eq_u32 s41, s32
    s_cbranch_scc1 f_rsx
    s_sleep 4
    s_add_u32 s83, s83, 1
    s_cmp_lt_u32 s83, 0x40000
    s_cbranch_scc1 f_rs
f_rsx:
    s_lshr_b32 s41, s40, 8
    s_and_b32 s40, s40, 0xff
    s_and_b32 s41, s41, 0xff
    v_mov_b32 v28, s40
    v_mov_b32 v29, s41
    ds_write_b64 v21, v[28:29]
f_nrs:
    s_waitcnt lgkmcnt(0)
    s_barrier
    ds_read_b64 v[28:29], v21
    s_waitcnt lgkmcnt(0)
    v_readfirstlane_b32 s40, v28
    v_readfirstlane_b32 s41, v29
    s_cmp_eq_u32 s62, s40
    s_cbranch_scc1 f_e0
    s_cmp_eq_u32 s62, s41
    s_cbranch_scc1 f_e0
    buffer_store_dwordx4 v[32:35], v3, s[24:27], s18 offen offset:0 sc1
    buffer_store_dwordx4 v[36:39], v3, s[24:27], s18 offen offset:1024 sc1
f_e0:
    s_cmp_eq_u32 s63, s40
    s_cbranch_scc1 f_e1
    s_cmp_eq_u32 s63, s41
    s_cbranch_scc1 f_e1
    buffer_store_dwordx4 v[40:43], v3, s[24:27], s19 offen offset:0 sc1
    buffer_store_dwordx4 v[44:47], v3, s[24:27], s19 offen offset:1024 sc1
f_e1:
    s_endpgm
f_c1bad:
    s_add_u32 s83, s83, 1
    s_cmp_ge_u32 s83, 0x40000
    s_cbranch_scc1 f_c1ok
    s_bitcmp1_b32 s47, 0
    s_cbranch_scc0 f_c1b2
    s_sleep 3
f_c1b2:
    s_cmp_lg_u32 s34, 0
    s_cbranch_scc1 f_ci1
    s_add_u32 s68, s82, 32768
    buffer_load_dwordx4 v[120:123], v250, s[12:15], s68 offen offset:0 sc1
    buffer_load_dwordx4 v[124:127], v250, s[12:15], s68 offen offset:1024 sc1
f_ci1:
    buffer_load_dwordx4 v[112:115], v250, s[12:15], s82 offen offset:0 sc1
    buffer_load_dwordx4 v[116:119], v250, s[12:15], s82 offen offset:1024 sc1
    s_waitcnt vmcnt(0)
    s_bitcmp1_b32 s47, 0
    s_cbranch_scc1 f_c1
    s_branch f_s1
f_z1bad:
    s_add_u32 s83, s83, 1
    s_cmp_ge_u32 s83, 0x40000
    s_cbranch_scc1 f_z1ok
    s_sleep 4
    buffer_load_dwordx4 v[32:35], v243, s[12:15], s72 offen offset:0 sc1
    buffer_load_dwordx4 v[36:39], v243, s[12:15], s72 offen offset:1024 sc1
    buffer_load_dwordx4 v[40:43], v243, s[12:15], s72 offen offset:2048 sc1
    buffer_load_dwordx4 v[44:47], v243, s[12:15], s72 offen offset:3072 sc1
    s_waitcnt vmcnt(0)
    s_branch f_z1
f_ppbad:
    s_add_u32 s83, s83, 1
    s_cmp_ge_u32 s83, 0x40000
    s_cbranch_scc1 f_ppok
    s_sleep 3
    buffer_load_dwordx4 v[240:243], v15, s[12:15], s42 offen sc1
    s_waitcnt vmcnt(0)
    s_branch f_pp
f_zfbad:
    v_or_b32 v35, 131072, v35
    v_or_b32 v39, 131072, v39
    v_or_b32 v43, 131072, v43
    v_or_b32 v47, 131072, v47
    v_xor_b32 v2, s44, v32
    v_bitop3_b32 v2, v2, v33, s44 bitop3:0xf6
    v_bitop3_b32 v2, v2, v34, s44 bitop3:0xf6
    v_bitop3_b32 v2, v2, v35, s44 bitop3:0xf6
    v_bitop3_b32 v2, v2, v36, s44 bitop3:0xf6
    v_bitop3_b32 v2, v2, v37, s44 bitop3:0xf6
    v_bitop3_b32 v2, v2, v38, s44 bitop3:0xf6
    v_bitop3_b32 v2, v2, v39, s44 bitop3:0xf6
    v_bitop3_b32 v2, v2, v40, s44 bitop3:0xf6
    v_bitop3_b32 v2, v2, v41, s44 bitop3:0xf6
    v_bitop3_b32 v2, v2, v42, s44 bitop3:0xf6
    v_bitop3_b32 v2, v2, v43, s44 bitop3:0xf6
    v_bitop3_b32 v2, v2, v44, s44 bitop3:0xf6
    v_bitop3_b32 v2, v2, v45, s44 bitop3:0xf6
    v_bitop3_b32 v2, v2, v46, s44 bitop3:0xf6
    v_bitop3_b32 v2, v2, v47, s44 bitop3:0xf6
    v_and_b32 v2, s33, v2
    v_cmp_ne_u32 vcc, 0, v2
    s_cbranch_vccz f_rare
    s_add_u32 s83, s83, 1
    s_cmp_ge_u32 s83, 0x40000
    s_cbranch_scc1 f_zfok
    s_sleep 1
    buffer_load_dwordx4 v[32:35], v4, s[12:15], s28 offen sc1
    buffer_load_dwordx4 v[36:39], v4, s[12:15], s29 offen sc1
    buffer_load_dwordx4 v[40:43], v4, s[12:15], s50 offen sc1
    buffer_load_dwordx4 v[44:47], v4, s[12:15], s51 offen sc1
    s_branch f_zf
f_pbbad:
    s_add_u32 s83, s83, 1
    s_cmp_ge_u32 s83, 0x40000
    s_cbranch_scc1 f_pbok
    s_sleep 3
    buffer_load_dwordx4 v[16:19], v15, s[12:15], s41 offen sc1
    s_waitcnt vmcnt(0)
    s_branch f_pb
f_slowst:
    buffer_store_dwordx4 v[32:35], v251, s[12:15], s74 offen offset:0 sc1
    buffer_store_dwordx4 v[36:39], v251, s[12:15], s74 offen offset:2048 sc1
    buffer_store_dwordx4 v[40:43], v251, s[12:15], s75 offen offset:0 sc1
    buffer_store_dwordx4 v[44:47], v251, s[12:15], s75 offen offset:2048 sc1
    s_branch f_std
f_rare:
    v_bfe_u32 v144, v0, 4, 2
    v_lshlrev_b32 v144, 3, v144
    s_mov_b32 s83, 0
f_rz:
    buffer_load_dwordx2 v[152:153], v144, s[12:15], s77 offen offset:0 sc1
    buffer_load_dwordx2 v[154:155], v144, s[12:15], s77 offen offset:32 sc1
    buffer_load_dwordx2 v[156:157], v144, s[12:15], s77 offen offset:64 sc1
    buffer_load_dwordx2 v[158:159], v144, s[12:15], s77 offen offset:96 sc1
    s_waitcnt vmcnt(0)
    v_xor_b32 v2, s32, v152
    v_bitop3_b32 v2, v2, v154, s32 bitop3:0xf6
    v_bitop3_b32 v2, v2, v156, s32 bitop3:0xf6
    v_bitop3_b32 v2, v2, v158, s32 bitop3:0xf6
    v_cmp_ne_u32 vcc, 0, v2
    s_cbranch_vccz f_rzx
    s_sleep 2
    s_add_u32 s83, s83, 1
    s_cmp_lt_u32 s83, 0x40000
    s_cbranch_scc1 f_rz
f_rzx:
    v_mov_b32 v148, v153
    v_mov_b32 v149, v155
    v_mov_b32 v150, v157
    v_mov_b32 v151, v159
    v_max_i32 v145, v148, v149
    v_max3_i32 v145, v145, v150, v151
    s_nop 0
    v_readlane_b32 s64, v145, 0
    v_readlane_b32 s65, v145, 16
    v_readlane_b32 s66, v145, 32
    v_readlane_b32 s67, v145, 48
    s_max_i32 s64, s64, s65
    s_max_i32 s66, s66, s67
    s_max_i32 s64, s64, s66
    s_add_i32 s66, s64, 125
    s_lshl_b32 s66, s66, 23
    s_mov_b32 s33, 0
    v_mov_b32 v16, 0
    v_mov_b32 v17, 0
    v_mov_b32 v18, 0
    v_mov_b32 v19, 0
    v_subrev_u32 v148, s64, v148
    v_ldexp_f32 v148, 1.0, v148
    v_cvt_pk_f16_f32 v148, v148, v148
    v_subrev_u32 v149, s64, v149
    v_ldexp_f32 v149, 1.0, v149
    v_cvt_pk_f16_f32 v149, v149, v149
    v_subrev_u32 v150, s64, v150
    v_ldexp_f32 v150, 1.0, v150
    v_cvt_pk_f16_f32 v150, v150, v150
    v_subrev_u32 v151, s64, v151
    v_ldexp_f32 v151, 1.0, v151
    v_cvt_pk_f16_f32 v151, v151, v151
    v_pk_mul_f16 v32, v32, v148
    v_pk_mul_f16 v33, v33, v148
    v_pk_mul_f16 v34, v34, v148
    v_pk_mul_f16 v35, v35, v148
    v_pk_mul_f16 v36, v36, v149
    v_pk_mul_f16 v37, v37, v149
    v_pk_mul_f16 v38, v38, v149
    v_pk_mul_f16 v39, v39, v149
    v_pk_mul_f16 v40, v40, v150
    v_pk_mul_f16 v41, v41, v150
    v_pk_mul_f16 v42, v42, v150
    v_pk_mul_f16 v43, v43, v150
    v_pk_mul_f16 v44, v44, v151
    v_pk_mul_f16 v45, v45, v151
    v_pk_mul_f16 v46, v46, v151
    v_pk_mul_f16 v47, v47, v151
    v_pk_mul_f32 v[112:113], v[112:113], s[66:67] op_sel:[0,0] op_sel_hi:[1,0]
    v_pk_mul_f32 v[114:115], v[114:115], s[66:67] op_sel:[0,0] op_sel_hi:[1,0]
    v_pk_mul_f32 v[116:117], v[116:117], s[66:67] op_sel:[0,0] op_sel_hi:[1,0]
    v_pk_mul_f32 v[118:119], v[118:119], s[66:67] op_sel:[0,0] op_sel_hi:[1,0]
    v_pk_mul_f32 v[120:121], v[120:121], s[66:67] op_sel:[0,0] op_sel_hi:[1,0]
    v_pk_mul_f32 v[122:123], v[122:123], s[66:67] op_sel:[0,0] op_sel_hi:[1,0]
    v_pk_mul_f32 v[124:125], v[124:125], s[66:67] op_sel:[0,0] op_sel_hi:[1,0]
    v_pk_mul_f32 v[126:127], v[126:127], s[66:67] op_sel:[0,0] op_sel_hi:[1,0]
    v_pk_mul_f32 v[128:129], v[128:129], s[66:67] op_sel:[0,0] op_sel_hi:[1,0]
    v_pk_mul_f32 v[130:131], v[130:131], s[66:67] op_sel:[0,0] op_sel_hi:[1,0]
    v_pk_mul_f32 v[132:133], v[132:133], s[66:67] op_sel:[0,0] op_sel_hi:[1,0]
    v_pk_mul_f32 v[134:135], v[134:135], s[66:67] op_sel:[0,0] op_sel_hi:[1,0]
    v_pk_mul_f32 v[136:137], v[136:137], s[66:67] op_sel:[0,0] op_sel_hi:[1,0]
    v_pk_mul_f32 v[138:139], v[138:139], s[66:67] op_sel:[0,0] op_sel_hi:[1,0]
    v_pk_mul_f32 v[140:141], v[140:141], s[66:67] op_sel:[0,0] op_sel_hi:[1,0]
    v_pk_mul_f32 v[142:143], v[142:143], s[66:67] op_sel:[0,0] op_sel_hi:[1,0]
    s_nop 1
    s_branch f_zf
f_slow2:
    v_cvt_pk_bf16_f32 v144, v160, v161
    v_lshlrev_b32 v160, 16, v144
    v_and_b32 v161, 0xffff0000, v144
    v_cvt_pk_bf16_f32 v144, v162, v163
    v_lshlrev_b32 v162, 16, v144
    v_and_b32 v163, 0xffff0000, v144
    v_cvt_pk_bf16_f32 v144, v164, v165
    v_lshlrev_b32 v164, 16, v144
    v_and_b32 v165, 0xffff0000, v144
    v_cvt_pk_bf16_f32 v144, v166, v167
    v_lshlrev_b32 v166, 16, v144
    v_and_b32 v167, 0xffff0000, v144
    v_cvt_pk_bf16_f32 v144, v168, v169
    v_lshlrev_b32 v168, 16, v144
    v_and_b32 v169, 0xffff0000, v144
    v_cvt_pk_bf16_f32 v144, v170, v171
    v_lshlrev_b32 v170, 16, v144
    v_and_b32 v171, 0xffff0000, v144
    v_cvt_pk_bf16_f32 v144, v172, v173
    v_lshlrev_b32 v172, 16, v144
    v_and_b32 v173, 0xffff0000, v144
    v_cvt_pk_bf16_f32 v144, v174, v175
    v_lshlrev_b32 v174, 16, v144
    v_and_b32 v175, 0xffff0000, v144
    v_pk_add_f32 v[144:145], v[160:161], v[162:163]
    v_pk_add_f32 v[144:145], v[144:145], v[164:165]
    v_pk_add_f32 v[144:145], v[144:145], v[166:167]
    v_pk_add_f32 v[144:145], v[144:145], v[168:169]
    v_pk_add_f32 v[144:145], v[144:145], v[170:171]
    v_pk_add_f32 v[144:145], v[144:145], v[172:173]
    v_pk_add_f32 v[144:145], v[144:145], v[174:175]
    v_cvt_pk_bf16_f32 v152, v176, v177
    v_lshlrev_b32 v176, 16, v152
    v_and_b32 v177, 0xffff0000, v152
    v_cvt_pk_bf16_f32 v152, v178, v179
    v_lshlrev_b32 v178, 16, v152
    v_and_b32 v179, 0xffff0000, v152
    v_cvt_pk_bf16_f32 v152, v180, v181
    v_lshlrev_b32 v180, 16, v152
    v_and_b32 v181, 0xffff0000, v152
    v_cvt_pk_bf16_f32 v152, v182, v183
    v_lshlrev_b32 v182, 16, v152
    v_and_b32 v183, 0xffff0000, v152
    v_cvt_pk_bf16_f32 v152, v184, v185
    v_lshlrev_b32 v184, 16, v152
    v_and_b32 v185, 0xffff0000, v152
    v_cvt_pk_bf16_f32 v152, v186, v187
    v_lshlrev_b32 v186, 16, v152
    v_and_b32 v187, 0xffff0000, v152
    v_cvt_pk_bf16_f32 v152, v188, v189
    v_lshlrev_b32 v188, 16, v152
    v_and_b32 v189, 0xffff0000, v152
    v_cvt_pk_bf16_f32 v152, v190, v191
    v_lshlrev_b32 v190, 16, v152
    v_and_b32 v191, 0xffff0000, v152
    v_pk_add_f32 v[152:153], v[176:177], v[178:179]
    v_pk_add_f32 v[152:153], v[152:153], v[180:181]
    v_pk_add_f32 v[152:153], v[152:153], v[182:183]
    v_pk_add_f32 v[152:153], v[152:153], v[184:185]
    v_pk_add_f32 v[152:153], v[152:153], v[186:187]
    v_pk_add_f32 v[152:153], v[152:153], v[188:189]
    v_pk_add_f32 v[152:153], v[152:153], v[190:191]
    v_add_f32 v104, v144, v145
    v_add_f32 v108, v152, v153
    s_nop 1
    v_permlane32_swap_b32 v104, v108
    v_add_f32 v104, v104, v108
    s_nop 1
    v_add_f32_dpp v104, v104, v104 row_ror:8 row_mask:0xf bank_mask:0xf
    s_nop 1
    v_add_f32_dpp v104, v104, v104 row_ror:4 row_mask:0xf bank_mask:0xf
    s_nop 1
    v_add_f32_dpp v104, v104, v104 row_ror:2 row_mask:0xf bank_mask:0xf
    s_nop 1
    v_add_f32_dpp v104, v104, v104 row_ror:1 row_mask:0xf bank_mask:0xf
    s_nop 1
    v_add_f32_dpp v104, v104, v104 row_bcast:15 row_mask:0xa bank_mask:0xf
    v_mul_f32 v107, s46, v104
    v_cvt_pk_bf16_f32 v104, v107, v107
    v_lshlrev_b32 v104, 16, v104
    v_sub_f32 v107, v107, v104
    v_readlane_b32 s64, v104, 31
    v_readlane_b32 s66, v104, 63
    s_nop 0
    v_pk_add_f32 v[80:81], v[160:161], s[64:65] op_sel:[0,0] op_sel_hi:[1,0] neg_lo:[0,1] neg_hi:[0,1]
    v_pk_add_f32 v[82:83], v[162:163], s[64:65] op_sel:[0,0] op_sel_hi:[1,0] neg_lo:[0,1] neg_hi:[0,1]
    v_pk_add_f32 v[84:85], v[164:165], s[64:65] op_sel:[0,0] op_sel_hi:[1,0] neg_lo:[0,1] neg_hi:[0,1]
    v_pk_add_f32 v[86:87], v[166:167], s[64:65] op_sel:[0,0] op_sel_hi:[1,0] neg_lo:[0,1] neg_hi:[0,1]
    v_pk_add_f32 v[88:89], v[168:169], s[64:65] op_sel:[0,0] op_sel_hi:[1,0] neg_lo:[0,1] neg_hi:[0,1]
    v_pk_add_f32 v[90:91], v[170:171], s[64:65] op_sel:[0,0] op_sel_hi:[1,0] neg_lo:[0,1] neg_hi:[0,1]
    v_pk_add_f32 v[92:93], v[172:173], s[64:65] op_sel:[0,0] op_sel_hi:[1,0] neg_lo:[0,1] neg_hi:[0,1]
    v_pk_add_f32 v[94:95], v[174:175], s[64:65] op_sel:[0,0] op_sel_hi:[1,0] neg_lo:[0,1] neg_hi:[0,1]
    v_pk_mul_f32 v[146:147], v[80:81], v[80:81]
    v_pk_mul_f32 v[148:149], v[80:81], v[48:49]
    v_pk_fma_f32 v[146:147], v[82:83], v[82:83], v[146:147]
    v_pk_fma_f32 v[148:149], v[82:83], v[50:51], v[148:149]
    v_pk_fma_f32 v[146:147], v[84:85], v[84:85], v[146:147]
    v_pk_fma_f32 v[148:149], v[84:85], v[52:53], v[148:149]
    v_pk_fma_f32 v[146:147], v[86:87], v[86:87], v[146:147]
    v_pk_fma_f32 v[148:149], v[86:87], v[54:55], v[148:149]
    v_pk_fma_f32 v[146:147], v[88:89], v[88:89], v[146:147]
    v_pk_fma_f32 v[148:149], v[88:89], v[56:57], v[148:149]
    v_pk_fma_f32 v[146:147], v[90:91], v[90:91], v[146:147]
    v_pk_fma_f32 v[148:149], v[90:91], v[58:59], v[148:149]
    v_pk_fma_f32 v[146:147], v[92:93], v[92:93], v[146:147]
    v_pk_fma_f32 v[148:149], v[92:93], v[60:61], v[148:149]
    v_pk_fma_f32 v[146:147], v[94:95], v[94:95], v[146:147]
    v_pk_fma_f32 v[148:149], v[94:95], v[62:63], v[148:149]
    v_pk_add_f32 v[32:33], v[176:177], s[66:67] op_sel:[0,0] op_sel_hi:[1,0] neg_lo:[0,1] neg_hi:[0,1]
    v_pk_add_f32 v[34:35], v[178:179], s[66:67] op_sel:[0,0] op_sel_hi:[1,0] neg_lo:[0,1] neg_hi:[0,1]
    v_pk_add_f32 v[36:37], v[180:181], s[66:67] op_sel:[0,0] op_sel_hi:[1,0] neg_lo:[0,1] neg_hi:[0,1]
    v_pk_add_f32 v[38:39], v[182:183], s[66:67] op_sel:[0,0] op_sel_hi:[1,0] neg_lo:[0,1] neg_hi:[0,1]
    v_pk_add_f32 v[40:41], v[184:185], s[66:67] op_sel:[0,0] op_sel_hi:[1,0] neg_lo:[0,1] neg_hi:[0,1]
    v_pk_add_f32 v[42:43], v[186:187], s[66:67] op_sel:[0,0] op_sel_hi:[1,0] neg_lo:[0,1] neg_hi:[0,1]
    v_pk_add_f32 v[44:45], v[188:189], s[66:67] op_sel:[0,0] op_sel_hi:[1,0] neg_lo:[0,1] neg_hi:[0,1]
    v_pk_add_f32 v[46:47], v[190:191], s[66:67] op_sel:[0,0] op_sel_hi:[1,0] neg_lo:[0,1] neg_hi:[0,1]
    v_pk_mul_f32 v[154:155], v[32:33], v[32:33]
    v_pk_mul_f32 v[156:157], v[32:33], v[64:65]
    v_pk_fma_f32 v[154:155], v[34:35], v[34:35], v[154:155]
    v_pk_fma_f32 v[156:157], v[34:35], v[66:67], v[156:157]
    v_pk_fma_f32 v[154:155], v[36:37], v[36:37], v[154:155]
    v_pk_fma_f32 v[156:157], v[36:37], v[68:69], v[156:157]
    v_pk_fma_f32 v[154:155], v[38:39], v[38:39], v[154:155]
    v_pk_fma_f32 v[156:157], v[38:39], v[70:71], v[156:157]
    v_pk_fma_f32 v[154:155], v[40:41], v[40:41], v[154:155]
    v_pk_fma_f32 v[156:157], v[40:41], v[72:73], v[156:157]
    v_pk_fma_f32 v[154:155], v[42:43], v[42:43], v[154:155]
    v_pk_fma_f32 v[156:157], v[42:43], v[74:75], v[156:157]
    v_pk_fma_f32 v[154:155], v[44:45], v[44:45], v[154:155]
    v_pk_fma_f32 v[156:157], v[44:45], v[76:77], v[156:157]
    v_pk_fma_f32 v[154:155], v[46:47], v[46:47], v[154:155]
    v_pk_fma_f32 v[156:157], v[46:47], v[78:79], v[156:157]
    v_add_f32 v105, v146, v147
    v_add_f32 v106, v148, v149
    v_add_f32 v109, v154, v155
    v_add_f32 v110, v156, v157
    s_nop 0
    v_permlane32_swap_b32 v105, v109
    v_permlane32_swap_b32 v106, v110
    v_add_f32 v105, v105, v109
    v_add_f32 v106, v106, v110
    s_nop 0
    v_add_f32_dpp v105, v105, v105 row_ror:8 row_mask:0xf bank_mask:0xf
    v_add_f32_dpp v106, v106, v106 row_ror:8 row_mask:0xf bank_mask:0xf
    s_nop 0
    v_add_f32_dpp v105, v105, v105 row_ror:4 row_mask:0xf bank_mask:0xf
    v_add_f32_dpp v106, v106, v106 row_ror:4 row_mask:0xf bank_mask:0xf
    s_nop 0
    v_add_f32_dpp v105, v105, v105 row_ror:2 row_mask:0xf bank_mask:0xf
    v_add_f32_dpp v106, v106, v106 row_ror:2 row_mask:0xf bank_mask:0xf
    s_nop 0
    v_add_f32_dpp v105, v105, v105 row_ror:1 row_mask:0xf bank_mask:0xf
    v_add_f32_dpp v106, v106, v106 row_ror:1 row_mask:0xf bank_mask:0xf
    s_nop 0
    v_add_f32_dpp v105, v105, v105 row_bcast:15 row_mask:0xa bank_mask:0xf
    v_add_f32_dpp v106, v106, v106 row_bcast:15 row_mask:0xa bank_mask:0xf
    v_mul_f32 v105, s46, v105
    v_fma_f32 v105, -v107, v107, v105
    v_max_f32 v105, 0, v105
    s_branch f_var2
f_slowvar:
    v_lshlrev_b32 v66, 16, v56
    s_nop 0
    v_readlane_b32 s68, v66, 31
    v_readlane_b32 s70, v66, 63
    v_lshlrev_b32 v100, 16, v32
    v_and_b32 v101, 0xffff0000, v32
    v_pk_add_f32 v[100:101], v[100:101], s[68:69] op_sel_hi:[1,0]
    v_pk_mul_f32 v[102:103], v[100:101], v[100:101]
    v_lshlrev_b32 v100, 16, v33
    v_and_b32 v101, 0xffff0000, v33
    v_pk_add_f32 v[100:101], v[100:101], s[68:69] op_sel_hi:[1,0]
    v_pk_fma_f32 v[102:103], v[100:101], v[100:101], v[102:103]
    v_lshlrev_b32 v100, 16, v34
    v_and_b32 v101, 0xffff0000, v34
    v_pk_add_f32 v[100:101], v[100:101], s[68:69] op_sel_hi:[1,0]
    v_pk_fma_f32 v[102:103], v[100:101], v[100:101], v[102:103]
    v_lshlrev_b32 v100, 16, v35
    v_and_b32 v101, 0xffff0000, v35
    v_pk_add_f32 v[100:101], v[100:101], s[68:69] op_sel_hi:[1,0]
    v_pk_fma_f32 v[102:103], v[100:101], v[100:101], v[102:103]
    v_lshlrev_b32 v100, 16, v36
    v_and_b32 v101, 0xffff0000, v36
    v_pk_add_f32 v[100:101], v[100:101], s[68:69] op_sel_hi:[1,0]
    v_pk_fma_f32 v[102:103], v[100:101], v[100:101], v[102:103]
    v_lshlrev_b32 v100, 16, v37
    v_and_b32 v101, 0xffff0000, v37
    v_pk_add_f32 v[100:101], v[100:101], s[68:69] op_sel_hi:[1,0]
    v_pk_fma_f32 v[102:103], v[100:101], v[100:101], v[102:103]
    v_lshlrev_b32 v100, 16, v38
    v_and_b32 v101, 0xffff0000, v38
    v_pk_add_f32 v[100:101], v[100:101], s[68:69] op_sel_hi:[1,0]
    v_pk_fma_f32 v[102:103], v[100:101], v[100:101], v[102:103]
    v_lshlrev_b32 v100, 16, v39
    v_and_b32 v101, 0xffff0000, v39
    v_pk_add_f32 v[100:101], v[100:101], s[68:69] op_sel_hi:[1,0]
    v_pk_fma_f32 v[102:103], v[100:101], v[100:101], v[102:103]
    v_add_f32 v54, v102, v103
    v_lshlrev_b32 v100, 16, v40
    v_and_b32 v101, 0xffff0000, v40
    v_pk_add_f32 v[100:101], v[100:101], s[70:71] op_sel_hi:[1,0]
    v_pk_mul_f32 v[102:103], v[100:101], v[100:101]
    v_lshlrev_b32 v100, 16, v41
    v_and_b32 v101, 0xffff0000, v41
    v_pk_add_f32 v[100:101], v[100:101], s[70:71] op_sel_hi:[1,0]
    v_pk_fma_f32 v[102:103], v[100:101], v[100:101], v[102:103]
    v_lshlrev_b32 v100, 16, v42
    v_and_b32 v101, 0xffff0000, v42
    v_pk_add_f32 v[100:101], v[100:101], s[70:71] op_sel_hi:[1,0]
    v_pk_fma_f32 v[102:103], v[100:101], v[100:101], v[102:103]
    v_lshlrev_b32 v100, 16, v43
    v_and_b32 v101, 0xffff0000, v43
    v_pk_add_f32 v[100:101], v[100:101], s[70:71] op_sel_hi:[1,0]
    v_pk_fma_f32 v[102:103], v[100:101], v[100:101], v[102:103]
    v_lshlrev_b32 v100, 16, v44
    v_and_b32 v101, 0xffff0000, v44
    v_pk_add_f32 v[100:101], v[100:101], s[70:71] op_sel_hi:[1,0]
    v_pk_fma_f32 v[102:103], v[100:101], v[100:101], v[102:103]
    v_lshlrev_b32 v100, 16, v45
    v_and_b32 v101, 0xffff0000, v45
    v_pk_add_f32 v[100:101], v[100:101], s[70:71] op_sel_hi:[1,0]
    v_pk_fma_f32 v[102:103], v[100:101], v[100:101], v[102:103]
    v_lshlrev_b32 v100, 16, v46
    v_and_b32 v101, 0xffff0000, v46
    v_pk_add_f32 v[100:101], v[100:101], s[70:71] op_sel_hi:[1,0]
    v_pk_fma_f32 v[102:103], v[100:101], v[100:101], v[102:103]
    v_lshlrev_b32 v100, 16, v47
    v_and_b32 v101, 0xffff0000, v47
    v_pk_add_f32 v[100:101], v[100:101], s[70:71] op_sel_hi:[1,0]
    v_pk_fma_f32 v[102:103], v[100:101], v[100:101], v[102:103]
    v_add_f32 v55, v102, v103
    v_add_f32 v66, v66, v52
    s_nop 0
    v_permlane32_swap_b32 v54, v55
    v_add_f32 v54, v54, v55
    s_nop 1
    v_add_f32_dpp v54, v54, v54 row_ror:8 row_mask:0xf bank_mask:0xf
    s_nop 1
    v_add_f32_dpp v54, v54, v54 row_ror:4 row_mask:0xf bank_mask:0xf
    s_nop 1
    v_add_f32_dpp v54, v54, v54 row_ror:2 row_mask:0xf bank_mask:0xf
    s_nop 1
    v_add_f32_dpp v54, v54, v54 row_ror:1 row_mask:0xf bank_mask:0xf
    s_nop 1
    v_add_f32_dpp v54, v54, v54 row_bcast:15 row_mask:0xa bank_mask:0xf
    v_mul_f32 v54, s46, v54
    v_fma_f32 v54, -v66, v66, v54
    v_max_f32 v54, 0, v54
    s_branch f_var
f_sa:
    s_add_u32 s69, s69, 50331648
    v_mul_f32 v120, s69, v120
    v_mul_f32 v121, s69, v121
    v_mul_f32 v122, s69, v122
    v_mul_f32 v123, s69, v123
    v_cvt_pk_f16_f32 v50, v120, v121
    v_cvt_pk_f16_f32 v51, v122, v123
    s_nop 0
    v_mov_b32_dpp v56, v50 quad_perm:[0,0,0,0] row_mask:0xf bank_mask:0xf
    v_mov_b32_dpp v57, v51 quad_perm:[0,0,0,0] row_mask:0xf bank_mask:0xf
    v_mov_b32_dpp v58, v50 quad_perm:[1,1,1,1] row_mask:0xf bank_mask:0xf
    v_mov_b32_dpp v59, v51 quad_perm:[1,1,1,1] row_mask:0xf bank_mask:0xf
    v_mov_b32_dpp v60, v50 quad_perm:[2,2,2,2] row_mask:0xf bank_mask:0xf
    v_mov_b32_dpp v61, v51 quad_perm:[2,2,2,2] row_mask:0xf bank_mask:0xf
    v_mov_b32_dpp v62, v50 quad_perm:[3,3,3,3] row_mask:0xf bank_mask:0xf
    v_mov_b32_dpp v63, v51 quad_perm:[3,3,3,3] row_mask:0xf bank_mask:0xf
    v_and_b32 v52, 15, v0
    v_cmp_eq_u32 vcc, 0, v52
    v_mov_b32 v53, 0x3c00
    v_mov_b32 v54, 0xbc000000
    v_cndmask_b32 v53, 0, v53, vcc
    v_cndmask_b32 v54, 0, v54, vcc
    v_pk_mul_f16 v128, v53, v56 op_sel:[0,0] op_sel_hi:[1,0]
    v_pk_mul_f16 v129, v53, v58 op_sel:[0,0] op_sel_hi:[1,0]
    v_pk_mul_f16 v130, v53, v60 op_sel:[0,0] op_sel_hi:[1,0]
    v_pk_mul_f16 v131, v53, v62 op_sel:[0,0] op_sel_hi:[1,0]
    v_pk_mul_f16 v132, v54, v56 op_sel:[0,0] op_sel_hi:[1,0]
    v_pk_mul_f16 v133, v54, v58 op_sel:[0,0] op_sel_hi:[1,0]
    v_pk_mul_f16 v134, v54, v60 op_sel:[0,0] op_sel_hi:[1,0]
    v_pk_mul_f16 v135, v54, v62 op_sel:[0,0] op_sel_hi:[1,0]
    v_mfma_f32_16x16x32_f16 v[80:83], v[128:131], v[144:147], 0
    s_nop 0
    v_mfma_f32_16x16x32_f16 v[84:87], v[132:135], v[144:147], 0
    v_pk_mul_f16 v136, v53, v56 op_sel:[0,1] op_sel_hi:[1,1]
    v_pk_mul_f16 v137, v53, v58 op_sel:[0,1] op_sel_hi:[1,1]
    v_pk_mul_f16 v138, v53, v60 op_sel:[0,1] op_sel_hi:[1,1]
    v_pk_mul_f16 v139, v53, v62 op_sel:[0,1] op_sel_hi:[1,1]
    v_pk_mul_f16 v140, v54, v56 op_sel:[0,1] op_sel_hi:[1,1]
    v_pk_mul_f16 v141, v54, v58 op_sel:[0,1] op_sel_hi:[1,1]
    v_pk_mul_f16 v142, v54, v60 op_sel:[0,1] op_sel_hi:[1,1]
    v_pk_mul_f16 v143, v54, v62 op_sel:[0,1] op_sel_hi:[1,1]
    v_mfma_f32_16x16x32_f16 v[88:91], v[136:139], v[148:151], 0
    s_nop 0
    v_mfma_f32_16x16x32_f16 v[92:95], v[140:143], v[148:151], 0
    v_pk_mul_f16 v128, v53, v57 op_sel:[0,0] op_sel_hi:[1,0]
    v_pk_mul_f16 v129, v53, v59 op_sel:[0,0] op_sel_hi:[1,0]
    v_pk_mul_f16 v130, v53, v61 op_sel:[0,0] op_sel_hi:[1,0]
    v_pk_mul_f16 v131, v53, v63 op_sel:[0,0] op_sel_hi:[1,0]
    v_pk_mul_f16 v132, v54, v57 op_sel:[0,0] op_sel_hi:[1,0]
    v_pk_mul_f16 v133, v54, v59 op_sel:[0,0] op_sel_hi:[1,0]
    v_pk_mul_f16 v134, v54, v61 op_sel:[0,0] op_sel_hi:[1,0]
    v_pk_mul_f16 v135, v54, v63 op_sel:[0,0] op_sel_hi:[1,0]
    v_mfma_f32_16x16x32_f16 v[96:99], v[128:131], v[152:155], 0
    s_nop 0
    v_mfma_f32_16x16x32_f16 v[100:103], v[132:135], v[152:155], 0
    v_pk_mul_f16 v136, v53, v57 op_sel:[0,1] op_sel_hi:[1,1]
    v_pk_mul_f16 v137, v53, v59 op_sel:[0,1] op_sel_hi:[1,1]
    v_pk_mul_f16 v138, v53, v61 op_sel:[0,1] op_sel_hi:[1,1]
    v_pk_mul_f16 v139, v53, v63 op_sel:[0,1] op_sel_hi:[1,1]
    v_pk_mul_f16 v140, v54, v57 op_sel:[0,1] op_sel_hi:[1,1]
    v_pk_mul_f16 v141, v54, v59 op_sel:[0,1] op_sel_hi:[1,1]
    v_pk_mul_f16 v142, v54, v61 op_sel:[0,1] op_sel_hi:[1,1]
    v_pk_mul_f16 v143, v54, v63 op_sel:[0,1] op_sel_hi:[1,1]
    v_mfma_f32_16x16x32_f16 v[104:107], v[136:139], v[156:159], 0
    s_nop 0
    v_mfma_f32_16x16x32_f16 v[108:111], v[140:143], v[156:159], 0
    s_branch f_nkr
f_sp:
    v_mfma_f32_16x16x32_f16 v[88:91], v[32:35], v[224:227], 0
    v_mfma_f32_16x16x32_f16 v[88:91], v[36:39], v[228:231], v[88:91]
    v_mfma_f32_16x16x32_f16 v[88:91], v[40:43], v[232:235], v[88:91]
    v_mfma_f32_16x16x32_f16 v[88:91], v[44:47], v[236:239], v[88:91]
    v_mfma_f32_16x16x32_f16 v[92:95], v[32:35], v[240:243], 0
    v_mfma_f32_16x16x32_f16 v[92:95], v[36:39], v[244:247], v[92:95]
    v_mfma_f32_16x16x32_f16 v[92:95], v[40:43], v[248:251], v[92:95]
    v_mfma_f32_16x16x32_f16 v[92:95], v[44:47], v[252:255], v[92:95]
    v_pk_mul_f16 v32, v32, 1.0 op_sel:[1,0] op_sel_hi:[0,0] neg_hi:[1,0]
    v_pk_mul_f16 v33, v33, 1.0 op_sel:[1,0] op_sel_hi:[0,0] neg_hi:[1,0]
    v_pk_mul_f16 v34, v34, 1.0 op_sel:[1,0] op_sel_hi:[0,0] neg_hi:[1,0]
    v_pk_mul_f16 v35, v35, 1.0 op_sel:[1,0] op_sel_hi:[0,0] neg_hi:[1,0]
    v_pk_mul_f16 v36, v36, 1.0 op_sel:[1,0] op_sel_hi:[0,0] neg_hi:[1,0]
    v_pk_mul_f16 v37, v37, 1.0 op_sel:[1,0] op_sel_hi:[0,0] neg_hi:[1,0]
    v_pk_mul_f16 v38, v38, 1.0 op_sel:[1,0] op_sel_hi:[0,0] neg_hi:[1,0]
    v_pk_mul_f16 v39, v39, 1.0 op_sel:[1,0] op_sel_hi:[0,0] neg_hi:[1,0]
    v_pk_mul_f16 v40, v40, 1.0 op_sel:[1,0] op_sel_hi:[0,0] neg_hi:[1,0]
    v_pk_mul_f16 v41, v41, 1.0 op_sel:[1,0] op_sel_hi:[0,0] neg_hi:[1,0]
    v_pk_mul_f16 v42, v42, 1.0 op_sel:[1,0] op_sel_hi:[0,0] neg_hi:[1,0]
    v_pk_mul_f16 v43, v43, 1.0 op_sel:[1,0] op_sel_hi:[0,0] neg_hi:[1,0]
    v_pk_mul_f16 v44, v44, 1.0 op_sel:[1,0] op_sel_hi:[0,0] neg_hi:[1,0]
    v_pk_mul_f16 v45, v45, 1.0 op_sel:[1,0] op_sel_hi:[0,0] neg_hi:[1,0]
    v_pk_mul_f16 v46, v46, 1.0 op_sel:[1,0] op_sel_hi:[0,0] neg_hi:[1,0]
    v_pk_mul_f16 v47, v47, 1.0 op_sel:[1,0] op_sel_hi:[0,0] neg_hi:[1,0]
    v_mfma_f32_16x16x32_f16 v[96:99], v[32:35], v[192:195], 0
    v_mfma_f32_16x16x32_f16 v[96:99], v[36:39], v[196:199], v[96:99]
    v_mfma_f32_16x16x32_f16 v[96:99], v[40:43], v[200:203], v[96:99]
    v_mfma_f32_16x16x32_f16 v[96:99], v[44:47], v[204:207], v[96:99]
    v_mfma_f32_16x16x32_f16 v[100:103], v[32:35], v[208:211], 0
    v_mfma_f32_16x16x32_f16 v[100:103], v[36:39], v[212:215], v[100:103]
    v_mfma_f32_16x16x32_f16 v[100:103], v[40:43], v[216:219], v[100:103]
    v_mfma_f32_16x16x32_f16 v[100:103], v[44:47], v[220:223], v[100:103]
    v_mfma_f32_16x16x32_f16 v[104:107], v[32:35], v[224:227], 0
    v_mfma_f32_16x16x32_f16 v[104:107], v[36:39], v[228:231], v[104:107]
    v_mfma_f32_16x16x32_f16 v[104:107], v[40:43], v[232:235], v[104:107]
    v_mfma_f32_16x16x32_f16 v[104:107], v[44:47], v[236:239], v[104:107]
    v_mfma_f32_16x16x32_f16 v[108:111], v[32:35], v[240:243], 0
    v_mfma_f32_16x16x32_f16 v[108:111], v[36:39], v[244:247], v[108:111]
    v_mfma_f32_16x16x32_f16 v[108:111], v[40:43], v[248:251], v[108:111]
    v_mfma_f32_16x16x32_f16 v[108:111], v[44:47], v[252:255], v[108:111]
    v_subrev_u32 v2, s45, v8
    v_lshlrev_b32 v2, 1, v2
    v_add_u32 v20, s45, v2
    s_add_u32 s42, s45, 1008
    v_sub_u32 v21, s42, v2
    ds_write_b128 v20, v[80:83] offset:0
    ds_write_b128 v20, v[84:87] offset:1024
    ds_write_b128 v20, v[88:91] offset:2048
    ds_write_b128 v20, v[92:95] offset:3072
    v_sub_u32 v148, 4096, v2
    v_and_b32 v148, 4095, v148
    v_add_u32 v148, s45, v148
    v_sub_u32 v149, 3072, v2
    v_and_b32 v149, 4095, v149
    v_add_u32 v149, s45, v149
    v_sub_u32 v150, 2048, v2
    v_and_b32 v150, 4095, v150
    v_add_u32 v150, s45, v150
    v_sub_u32 v151, 1024, v2
    v_and_b32 v151, 4095, v151
    v_add_u32 v151, s45, v151
    ds_read_b128 v[32:35], v21 offset:3072
    ds_read_b128 v[36:39], v21 offset:2048
    ds_read_b128 v[40:43], v21 offset:1024
    ds_read_b128 v[44:47], v21 offset:0
    ds_read_b32 v144, v148
    ds_read_b32 v145, v149
    ds_read_b32 v146, v150
    ds_read_b32 v147, v151
    s_waitcnt lgkmcnt(0)
    v_add_f32 v80, v80, v144
    v_add_f32 v81, v81, v35
    v_add_f32 v82, v82, v34
    v_add_f32 v83, v83, v33
    v_add_f32 v84, v84, v145
    v_add_f32 v85, v85, v39
    v_add_f32 v86, v86, v38
    v_add_f32 v87, v87, v37
    v_add_f32 v88, v88, v146
    v_add_f32 v89, v89, v43
    v_add_f32 v90, v90, v42
    v_add_f32 v91, v91, v41
    v_add_f32 v92, v92, v147
    v_add_f32 v93, v93, v47
    v_add_f32 v94, v94, v46
    v_add_f32 v95, v95, v45
    v_pk_fma_f32 v[160:161], v[112:113], v[80:81], v[160:161]
    v_pk_fma_f32 v[162:163], v[114:115], v[82:83], v[162:163]
    v_pk_fma_f32 v[164:165], v[116:117], v[84:85], v[164:165]
    v_pk_fma_f32 v[166:167], v[118:119], v[86:87], v[166:167]
    v_pk_fma_f32 v[168:169], v[120:121], v[88:89], v[168:169]
    v_pk_fma_f32 v[170:171], v[122:123], v[90:91], v[170:171]
    v_pk_fma_f32 v[172:173], v[124:125], v[92:93], v[172:173]
    v_pk_fma_f32 v[174:175], v[126:127], v[94:95], v[174:175]
    ds_write_b128 v20, v[96:99] offset:0
    ds_write_b128 v20, v[100:103] offset:1024
    ds_write_b128 v20, v[104:107] offset:2048
    ds_write_b128 v20, v[108:111] offset:3072
    v_add_u32 v148, 16, v2
    v_and_b32 v148, 4095, v148
    v_add_u32 v148, s45, v148
    v_add_u32 v149, 1040, v2
    v_and_b32 v149, 4095, v149
    v_add_u32 v149, s45, v149
    v_add_u32 v150, 2064, v2
    v_and_b32 v150, 4095, v150
    v_add_u32 v150, s45, v150
    v_add_u32 v151, 3088, v2
    v_and_b32 v151, 4095, v151
    v_add_u32 v151, s45, v151
    ds_read_b128 v[32:35], v21 offset:3072
    ds_read_b128 v[36:39], v21 offset:2048
    ds_read_b128 v[40:43], v21 offset:1024
    ds_read_b128 v[44:47], v21 offset:0
    ds_read_b32 v144, v148
    ds_read_b32 v145, v149
    ds_read_b32 v146, v150
    ds_read_b32 v147, v151
    s_waitcnt lgkmcnt(0)
    v_add_f32 v32, v32, v144
    v_add_f32 v33, v33, v99
    v_add_f32 v34, v34, v98
    v_add_f32 v35, v35, v97
    v_add_f32 v36, v36, v145
    v_add_f32 v37, v37, v103
    v_add_f32 v38, v38, v102
    v_add_f32 v39, v39, v101
    v_add_f32 v40, v40, v146
    v_add_f32 v41, v41, v107
    v_add_f32 v42, v42, v106
    v_add_f32 v43, v43, v105
    v_add_f32 v44, v44, v147
    v_add_f32 v45, v45, v111
    v_add_f32 v46, v46, v110
    v_add_f32 v47, v47, v109
    v_pk_fma_f32 v[176:177], v[128:129], v[32:33], v[176:177]
    v_pk_fma_f32 v[178:179], v[130:131], v[34:35], v[178:179]
    v_pk_fma_f32 v[180:181], v[132:133], v[36:37], v[180:181]
    v_pk_fma_f32 v[182:183], v[134:135], v[38:39], v[182:183]
    v_pk_fma_f32 v[184:185], v[136:137], v[40:41], v[184:185]
    v_pk_fma_f32 v[186:187], v[138:139], v[42:43], v[186:187]
    v_pk_fma_f32 v[188:189], v[140:141], v[44:45], v[188:189]
    v_pk_fma_f32 v[190:191], v[142:143], v[46:47], v[190:191]
    v_pk_mul_f32 v[146:147], v[160:161], v[160:161]
    v_pk_mul_f32 v[148:149], v[160:161], v[48:49]
    v_pk_fma_f32 v[146:147], v[162:163], v[162:163], v[146:147]
    v_pk_fma_f32 v[148:149], v[162:163], v[50:51], v[148:149]
    v_pk_fma_f32 v[146:147], v[164:165], v[164:165], v[146:147]
    v_pk_fma_f32 v[148:149], v[164:165], v[52:53], v[148:149]
    v_pk_fma_f32 v[146:147], v[166:167], v[166:167], v[146:147]
    v_pk_fma_f32 v[148:149], v[166:167], v[54:55], v[148:149]
    v_pk_fma_f32 v[146:147], v[168:169], v[168:169], v[146:147]
    v_pk_fma_f32 v[148:149], v[168:169], v[56:57], v[148:149]
    v_pk_fma_f32 v[146:147], v[170:171], v[170:171], v[146:147]
    v_pk_fma_f32 v[148:149], v[170:171], v[58:59], v[148:149]
    v_pk_fma_f32 v[146:147], v[172:173], v[172:173], v[146:147]
    v_pk_fma_f32 v[148:149], v[172:173], v[60:61], v[148:149]
    v_pk_fma_f32 v[146:147], v[174:175], v[174:175], v[146:147]
    v_pk_fma_f32 v[148:149], v[174:175], v[62:63], v[148:149]
    v_pk_add_f32 v[144:145], v[160:161], v[162:163]
    v_pk_add_f32 v[144:145], v[144:145], v[164:165]
    v_pk_add_f32 v[144:145], v[144:145], v[166:167]
    v_pk_add_f32 v[144:145], v[144:145], v[168:169]
    v_pk_add_f32 v[144:145], v[144:145], v[170:171]
    v_pk_add_f32 v[144:145], v[144:145], v[172:173]
    v_pk_add_f32 v[144:145], v[144:145], v[174:175]
    v_pk_mul_f32 v[154:155], v[176:177], v[176:177]
    v_pk_mul_f32 v[156:157], v[176:177], v[64:65]
    v_pk_fma_f32 v[154:155], v[178:179], v[178:179], v[154:155]
    v_pk_fma_f32 v[156:157], v[178:179], v[66:67], v[156:157]
    v_pk_fma_f32 v[154:155], v[180:181], v[180:181], v[154:155]
    v_pk_fma_f32 v[156:157], v[180:181], v[68:69], v[156:157]
    v_pk_fma_f32 v[154:155], v[182:183], v[182:183], v[154:155]
    v_pk_fma_f32 v[156:157], v[182:183], v[70:71], v[156:157]
    v_pk_fma_f32 v[154:155], v[184:185], v[184:185], v[154:155]
    v_pk_fma_f32 v[156:157], v[184:185], v[72:73], v[156:157]
    v_pk_fma_f32 v[154:155], v[186:187], v[186:187], v[154:155]
    v_pk_fma_f32 v[156:157], v[186:187], v[74:75], v[156:157]
    v_pk_fma_f32 v[154:155], v[188:189], v[188:189], v[154:155]
    v_pk_fma_f32 v[156:157], v[188:189], v[76:77], v[156:157]
    v_pk_fma_f32 v[154:155], v[190:191], v[190:191], v[154:155]
    v_pk_fma_f32 v[156:157], v[190:191], v[78:79], v[156:157]
    v_pk_add_f32 v[152:153], v[176:177], v[178:179]
    v_pk_add_f32 v[152:153], v[152:153], v[180:181]
    v_pk_add_f32 v[152:153], v[152:153], v[182:183]
    v_pk_add_f32 v[152:153], v[152:153], v[184:185]
    v_pk_add_f32 v[152:153], v[152:153], v[186:187]
    v_pk_add_f32 v[152:153], v[152:153], v[188:189]
    v_pk_add_f32 v[152:153], v[152:153], v[190:191]
    s_branch f_join
g_start:
    s_mov_b32 s43, 6619136
    s_load_dword s101, s[6:7], s43
    s_mov_b32 s44, s20
    s_mov_b32 s45, s21
    s_mov_b32 s46, 2048
    s_mov_b32 s47, 0x00020000
    v_and_b32 v6, 127, v0
    v_lshlrev_b32 v6, 1, v6
    s_lshl_b32 s19, s34, 8
    buffer_load_ushort v110, v6, s[44:47], s19 offen
    s_and_b32 s65, s35, 1
    s_lshr_b32 s40, s35, 1
    s_mul_i32 s64, s34, 7
    s_add_u32 s64, s64, s40
    s_cmp_ge_u32 s35, 14
    s_cselect_b32 s66, 1, 0
    s_mov_b32 s40, s34
    v_bfe_u32 v5, v0, 5, 1
    v_lshlrev_b32 v5, 3, v5
    v_bfe_u32 v9, v0, 3, 2
    v_add_u32 v5, v5, v9
    v_lshlrev_b32 v9, 1, v7
    v_xor_b32 v9, v9, v0
    v_and_b32 v9, 7, v9
    v_lshlrev_b32 v9, 4, v9
    s_movk_i32 s42, 7168
    v_mad_u32_u24 v5, v5, s42, v9
    v_mov_b32 v104, -1
    v_mov_b32 v105, -1
    v_mov_b32 v106, -1
    v_mov_b32 v107, -1
    v_mov_b32 v14, 0
    s_lshl_b32 s38, s64, 12
    s_lshl_b32 s42, s16, 9
    s_add_u32 s38, s38, s42
    s_mul_i32 s42, s65, 262144
    s_add_u32 s38, s38, s42
    s_add_u32 s38, s38, 4718592
    s_mov_b32 s12, s6
    s_mov_b32 s13, s7
    s_mov_b32 s14, 268435456
    s_mov_b32 s15, 0x00020000
    s_lshl_b32 s42, s35, 3
    s_add_u32 s42, s42, s34
    s_lshl_b32 s42, s42, 3
    s_add_u32 s42, s42, s16
    s_lshl_b32 s42, s42, 8
    s_add_u32 s42, s42, 6291456
    v_lshlrev_b32 v9, 7, v2
    s_mov_b64 exec, 3
    buffer_load_dword v251, v9, s[12:15], s42 offen
    s_mov_b64 exec, -1
    s_mov_b32 s44, s50
    s_mov_b32 s45, s51
    s_mov_b32 s46, 7340032
    s_mov_b32 s47, 0x00020000
    s_mov_b32 s60, s52
    s_mov_b32 s61, s53
    s_mov_b32 s62, 7340032
    s_mov_b32 s63, 0x00020000
    s_mov_b32 s72, s54
    s_mov_b32 s73, s55
    s_mov_b32 s74, 7340032
    s_mov_b32 s75, 0x00020000
    s_mov_b32 s26, 4194304
    s_mov_b32 s27, 0x00020000
    s_lshl_b32 s67, s65, 4
    s_add_u32 s67, s67, s16
    s_mul_i32 s67, s67, 229376
    s_lshl_b32 s42, s64, 7
    s_add_u32 s67, s67, s42
    s_lshl_b32 s42, s64, 6
    s_and_b32 s43, s16, 3
    s_lshl_b32 s43, s43, 3
    s_add_u32 s42, s42, s43
    s_and_b32 s43, s16, 4
    s_add_u32 s42, s42, s43
    s_lshl_b32 s69, s42, 11
    s_lshl_b32 s43, s65, 10
    s_add_u32 s69, s69, s43
    s_and_b32 s43, s16, 1
    s_lshl_b32 s43, s43, 7
    v_xor_b32 v21, s43, v3
    v_xor_b32 v22, 32, v21
    v_xor_b32 v23, 64, v21
    v_xor_b32 v24, 96, v21
    v_add_u32 v109, 131072, v6
    v_lshrrev_b32 v6, 2, v2
    v_and_b32 v15, 3, v0
    v_bfe_u32 v16, v0, 3, 2
    v_xor_b32 v12, v16, v1
    v_and_b32 v12, 3, v12
    v_lshlrev_b32 v12, 5, v12
    v_lshl_add_u32 v12, v6, 7, v12
    v_lshl_add_u32 v12, v15, 3, v12
    v_lshrrev_b32 v16, 2, v1
    v_lshl_add_u32 v12, v16, 14, v12
    v_add_u32 v25, 65536, v12
    v_and_b32 v17, 7, v6
    v_lshlrev_b32 v8, 2, v1
    v_xor_b32 v8, v8, v17
    v_lshlrev_b32 v8, 5, v8
    v_lshl_add_u32 v8, v6, 10, v8
    v_lshl_add_u32 v8, v15, 3, v8
    v_xor_b32 v9, 32, v8
    v_xor_b32 v10, 64, v8
    v_xor_b32 v11, 96, v8
    v_and_b32 v6, 1, v0
    v_lshlrev_b32 v17, 10, v6
    v_lshl_add_u32 v17, v16, 8, v17
    v_lshl_add_u32 v17, v7, 4, v17
    v_add_u32 v17, 131584, v17
    v_lshlrev_b32 v19, 7, v6
    v_lshl_add_u32 v19, v7, 4, v19
    v_add_u32 v19, 133632, v19
    v_and_b32 v6, 15, v0
    v_lshlrev_b32 v18, 1, v6
    v_lshl_add_u32 v18, v1, 5, v18
    v_lshl_add_u32 v18, v7, 7, v18
    v_add_u32 v18, 133632, v18
    v_lshlrev_b32 v20, 2, v6
    v_lshl_add_u32 v20, v1, 14, v20
    v_lshl_add_u32 v20, v7, 12, v20
    v_lshlrev_b32 v26, 4, v7
    v_add_u32 v27, 131072, v26
    v_lshlrev_b32 v28, 11, v7
    v_bfe_u32 v29, v0, 2, 3
    v_xor_b32 v29, v29, v1
    v_lshl_add_u32 v29, v29, 5, v28
    v_bfe_u32 v30, v0, 2, 2
    v_lshl_add_u32 v29, v30, 8, v29
    v_lshl_add_u32 v29, v15, 3, v29
    v_add_u32 v30, 65536, v29
    s_lshl_b32 s30, s41, 15
    s_and_b32 s42, s16, 3
    s_lshl_b32 s42, s42, 13
    s_add_u32 s30, s30, s42
    s_lshl_b32 s42, s40, 8
    s_add_u32 s30, s30, s42
    s_lshl_b32 s42, s17, 1
    s_lshr_b32 s43, s16, 2
    s_add_u32 s42, s42, s43
    s_lshl_b32 s42, s42, 4
    s_add_u32 s30, s30, s42
    s_add_u32 s30, s30, 6291456
    s_lshl_b32 s31, s41, 5
    s_lshr_b32 s42, s16, 1
    s_add_u32 s31, s31, s42
    s_lshl_b32 s31, s31, 10
    s_lshl_b32 s42, s40, 7
    s_add_u32 s31, s31, s42
    s_and_b32 s42, s16, 1
    s_lshl_b32 s42, s42, 6
    s_add_u32 s31, s31, s42
    s_add_u32 s31, s31, 6356992
    s_movk_i32 s33, 0xff
    s_cmp_eq_u32 s66, 1
    s_cbranch_scc1 x_start
    s_mul_i32 s70, s41, 4096
    s_add_u32 s70, s70, 4096
    s_add_u32 s70, s70, s18
    s_add_u32 s42, s17, 1
    s_and_b32 s42, s42, 7
    s_lshl_b32 s42, s42, 8
    s_add_u32 s70, s70, s42
    s_add_u32 s43, s68, 32768
    s_mov_b32 m0, s43
    s_add_u32 s42, s70, 0
    s_waitcnt vmcnt(5)
    buffer_load_dwordx4 v4, s[8:11], s42 offen  lds
    s_add_u32 s43, s68, 33792
    s_mov_b32 m0, s43
    s_add_u32 s42, s70, 49152
    s_waitcnt vmcnt(5)
    buffer_load_dwordx4 v4, s[8:11], s42 offen  lds
    s_add_u32 s43, s68, 34816
    s_mov_b32 m0, s43
    s_add_u32 s42, s70, 98304
    s_waitcnt vmcnt(5)
    buffer_load_dwordx4 v31, s[8:11], s42 offen  lds
    s_add_u32 s43, s68, 35840
    s_mov_b32 m0, s43
    s_add_u32 s42, s70, 147456
    s_waitcnt vmcnt(5)
    buffer_load_dwordx4 v31, s[8:11], s42 offen  lds
    s_waitcnt vmcnt(5)
    v_lshlrev_b32 v110, 16, v110
    v_mul_f32 v111, 0xbfb8aa3b, v110
    v_exp_f32 v111, v111
    s_nop 0
    v_add_f32 v111, 1.0, v111
    v_rcp_f32 v111, v111
    s_nop 0
    v_mul_f32 v110, v110, v111
    v_cvt_pk_bf16_f32 v110, v110, v110
    ds_write_b16 v109, v110
    s_waitcnt lgkmcnt(0)
    s_barrier
    ds_read_b128 v[128:131], v27 offset:0
    ds_read_b128 v[132:135], v27 offset:64
    ds_read_b128 v[136:139], v27 offset:128
    ds_read_b128 v[140:143], v27 offset:192
    ds_read_b64_tr_b16 v[144:145], v29 offset:0
    ds_read_b64_tr_b16 v[146:147], v29 offset:1024
    ds_read_b64_tr_b16 v[148:149], v29 offset:8192
    ds_read_b64_tr_b16 v[150:151], v29 offset:9216
    ds_read_b64_tr_b16 v[152:153], v29 offset:16384
    ds_read_b64_tr_b16 v[154:155], v29 offset:17408
    ds_read_b64_tr_b16 v[156:157], v29 offset:24576
    ds_read_b64_tr_b16 v[158:159], v29 offset:25600
    s_mul_i32 s32, s101, 0x9e3779b1
    s_or_b32 s32, s32, 0x101
    s_and_b32 s32, s32, 0xfffefbfb
    s_and_b32 s56, s32, 0xff
    s_bfe_u32 s57, s32, 0x80008
    s_bfe_u32 s58, s32, 0x80010
    s_lshr_b32 s59, s32, 24
    v_mov_b32 v164, s56
    v_mov_b32 v165, s57
    v_mov_b32 v166, s58
    v_mov_b32 v167, s59
    s_waitcnt lgkmcnt(6)
    v_mfma_f32_16x16x32_bf16 v[160:163], v[144:147], v[128:131], 0
    s_waitcnt lgkmcnt(4)
    v_mfma_f32_16x16x32_bf16 v[160:163], v[148:151], v[132:135], v[160:163]
    s_waitcnt lgkmcnt(2)
    v_mfma_f32_16x16x32_bf16 v[160:163], v[152:155], v[136:139], v[160:163]
    s_waitcnt lgkmcnt(0)
    v_mfma_f32_16x16x32_bf16 v[160:163], v[156:159], v[140:143], v[160:163]
    s_nop 7
    v_bfi_b32 v160, s33, v164, v160
    v_bfi_b32 v161, s33, v165, v161
    v_bfi_b32 v162, s33, v166, v162
    v_bfi_b32 v163, s33, v167, v163
    s_mov_b32 exec_lo, 0x00010001
    s_mov_b32 exec_hi, 0x00010001
    buffer_store_dwordx4 v[160:163], v28, s[12:15], s30 offen sc1
    s_mov_b64 exec, -1
    s_mov_b32 exec_hi, 0
    buffer_store_dwordx4 v[104:107], v3, s[12:15], s38 offen sc1
    s_mov_b64 exec, -1
    s_mul_i32 s70, s41, 4096
    s_add_u32 s70, s70, 6144
    s_add_u32 s70, s70, s18
    s_add_u32 s42, s17, 2
    s_and_b32 s42, s42, 7
    s_lshl_b32 s42, s42, 8
    s_add_u32 s70, s70, s42
    s_add_u32 s43, s68, 65536
    s_mov_b32 m0, s43
    s_add_u32 s42, s70, 0
    s_waitcnt vmcnt(5)
    buffer_load_dwordx4 v4, s[8:11], s42 offen  lds
    s_add_u32 s43, s68, 66560
    s_mov_b32 m0, s43
    s_add_u32 s42, s70, 49152
    s_waitcnt vmcnt(5)
    buffer_load_dwordx4 v4, s[8:11], s42 offen  lds
    s_add_u32 s43, s68, 67584
    s_mov_b32 m0, s43
    s_add_u32 s42, s70, 98304
    s_waitcnt vmcnt(5)
    buffer_load_dwordx4 v31, s[8:11], s42 offen  lds
    s_add_u32 s43, s68, 68608
    s_mov_b32 m0, s43
    s_add_u32 s42, s70, 147456
    s_waitcnt vmcnt(5)
    buffer_load_dwordx4 v31, s[8:11], s42 offen  lds
    s_waitcnt lgkmcnt(0)
    s_barrier
    ds_read_b64_tr_b16 v[144:145], v29 offset:32768
    ds_read_b64_tr_b16 v[146:147], v29 offset:33792
    ds_read_b64_tr_b16 v[148:149], v29 offset:40960
    ds_read_b64_tr_b16 v[150:151], v29 offset:41984
    ds_read_b64_tr_b16 v[152:153], v29 offset:49152
    ds_read_b64_tr_b16 v[154:155], v29 offset:50176
    ds_read_b64_tr_b16 v[156:157], v29 offset:57344
    ds_read_b64_tr_b16 v[158:159], v29 offset:58368
    s_waitcnt lgkmcnt(6)
    v_mfma_f32_16x16x32_bf16 v[160:163], v[144:147], v[128:131], 0
    s_waitcnt lgkmcnt(4)
    v_mfma_f32_16x16x32_bf16 v[160:163], v[148:151], v[132:135], v[160:163]
    s_waitcnt lgkmcnt(2)
    v_mfma_f32_16x16x32_bf16 v[160:163], v[152:155], v[136:139], v[160:163]
    s_waitcnt lgkmcnt(0)
    v_mfma_f32_16x16x32_bf16 v[160:163], v[156:159], v[140:143], v[160:163]
    s_add_u32 s42, s17, 1
    s_and_b32 s42, s42, 7
    s_lshl_b32 s42, s42, 12
    s_add_u32 s42, s42, s31
    s_add_u32 s42, s42, 0
    s_nop 2
    v_bfi_b32 v160, s33, v164, v160
    v_bfi_b32 v161, s33, v165, v161
    v_bfi_b32 v162, s33, v166, v162
    v_bfi_b32 v163, s33, v167, v163
    s_mov_b32 exec_lo, 0x00010001
    s_mov_b32 exec_hi, 0x00010001
    buffer_store_dwordx4 v[160:163], v26, s[12:15], s42 offen sc1
    s_mov_b64 exec, -1
    s_add_u32 s43, s68, 98304
    s_mov_b32 m0, s43
    s_add_u32 s42, s69, 0
    s_waitcnt vmcnt(4)
    buffer_load_dwordx4 v21, s[72:75], s42 offen  lds
    s_add_u32 s43, s68, 99328
    s_mov_b32 m0, s43
    s_add_u32 s42, s69, 2048
    s_waitcnt vmcnt(4)
    buffer_load_dwordx4 v22, s[72:75], s42 offen  lds
    s_add_u32 s43, s68, 100352
    s_mov_b32 m0, s43
    s_add_u32 s42, s69, 4096
    s_waitcnt vmcnt(4)
    buffer_load_dwordx4 v23, s[72:75], s42 offen  lds
    s_add_u32 s43, s68, 101376
    s_mov_b32 m0, s43
    s_add_u32 s42, s69, 6144
    s_waitcnt vmcnt(4)
    buffer_load_dwordx4 v24, s[72:75], s42 offen  lds
    s_waitcnt lgkmcnt(0)
    s_barrier
    ds_read_b64_tr_b16 v[144:145], v30 offset:0
    ds_read_b64_tr_b16 v[146:147], v30 offset:1024
    ds_read_b64_tr_b16 v[148:149], v30 offset:8192
    ds_read_b64_tr_b16 v[150:151], v30 offset:9216
    ds_read_b64_tr_b16 v[152:153], v30 offset:16384
    ds_read_b64_tr_b16 v[154:155], v30 offset:17408
    ds_read_b64_tr_b16 v[156:157], v30 offset:24576
    ds_read_b64_tr_b16 v[158:159], v30 offset:25600
    s_waitcnt lgkmcnt(6)
    v_mfma_f32_16x16x32_bf16 v[160:163], v[144:147], v[128:131], 0
    s_waitcnt lgkmcnt(4)
    v_mfma_f32_16x16x32_bf16 v[160:163], v[148:151], v[132:135], v[160:163]
    s_waitcnt lgkmcnt(2)
    v_mfma_f32_16x16x32_bf16 v[160:163], v[152:155], v[136:139], v[160:163]
    s_waitcnt lgkmcnt(0)
    v_mfma_f32_16x16x32_bf16 v[160:163], v[156:159], v[140:143], v[160:163]
    s_add_u32 s42, s17, 2
    s_and_b32 s42, s42, 7
    s_lshl_b32 s42, s42, 12
    s_add_u32 s42, s42, s31
    s_add_u32 s42, s42, 65536
    s_nop 2
    v_bfi_b32 v160, s33, v164, v160
    v_bfi_b32 v161, s33, v165, v161
    v_bfi_b32 v162, s33, v166, v162
    v_bfi_b32 v163, s33, v167, v163
    s_mov_b32 exec_lo, 0x00010001
    s_mov_b32 exec_hi, 0x00010001
    buffer_store_dwordx4 v[160:163], v26, s[12:15], s42 offen sc1
    s_mov_b64 exec, -1
    s_getreg_b32 s39, hwreg(HW_REG_XCC_ID)
    s_and_b32 s39, s39, 7
    s_lshl_b32 s38, s64, 1
    s_add_u32 s38, s38, s65
    s_lshl_b32 s38, s38, 7
    s_add_u32 s38, s38, 6537216
    s_lshl_b32 s42, s16, 28
    v_mov_b32 v28, s32
    v_mov_b32 v29, s39
    v_mov_b32 v30, s42
    s_mov_b64 exec, 1
    buffer_store_dwordx2 v[28:29], v30, s[12:15], s38 offen sc1
    s_mov_b64 exec, -1
    s_xor_b32 s38, s38, 128
    s_cmp_eq_u32 s65, s65
    s_cselect_b32 s8, s50, s52
    s_cselect_b32 s9, s51, s53
    s_mov_b32 s10, 7340032
    s_lshr_b32 s42, s8, 7
    s_sub_u32 s42, 3, s42
    s_add_u32 s42, s42, s34
    s_and_b32 s42, s42, 7
    s_cmp_eq_u32 s42, 7
    s_cselect_b32 s70, 0x1000000, 0
    s_mul_i32 s43, s34, 7
    s_add_u32 s42, s42, s43
    s_lshl_b32 s42, s42, 7
    s_lshr_b32 s43, s35, 1
    s_lshl_b32 s43, s43, 3
    s_add_u32 s43, s43, s16
    s_mul_i32 s43, s43, 35840
    s_add_u32 s42, s42, s43
    s_add_u32 s42, s42, s70
    s_mul_i32 s43, s65, 3670016
    s_add_u32 s42, s42, s43
    s_add_u32 s42, s42, 1662976
    v_mul_u32_u24 v30, 7168, v2
    s_mov_b64 exec, 31
    buffer_load_dword v252, v30, s[8:11], s42 offen
    s_mov_b64 exec, -1
    v_cmp_eq_u32 s[4:5], 1, v7
    v_cmp_eq_u32 s[6:7], 2, v7
    v_cmp_eq_u32 s[28:29], 3, v7
    v_and_b32 v191, 3, v0
    v_lshlrev_b32 v191, 3, v191
    v_lshrrev_b32 v191, v191, s32
    v_add_u32 v13, 131584, v3
    s_lshl_b32 s71, s65, 10
    s_add_u32 s71, s71, 5242880
    s_lshl_b32 s30, s65, 17
    s_lshl_b32 s31, s64, 6
    s_add_u32 s30, s30, s31
    s_add_u32 s30, s30, 4194304
    s_add_u32 s31, s30, 262144
    s_lshl_b32 s79, s64, 2
    s_and_b32 s42, s16, 3
    s_add_u32 s79, s79, s42
    s_lshl_b32 s79, s79, 10
    s_add_u32 s81, s79, 4718592
    s_add_u32 s82, s79, 4980736
    s_lshl_b32 s76, s65, 1
    s_lshr_b32 s42, s16, 2
    s_add_u32 s76, s76, s42
    s_lshl_b32 s76, s76, 8
    s_add_u32 s77, s76, s82
    s_add_u32 s76, s76, s81
    s_lshl_b32 s78, s34, 12
    s_add_u32 s78, s78, 4947968
    s_add_u32 s43, s68, 0
    s_mov_b32 m0, s43
    s_add_u32 s42, s69, 65536
    buffer_load_dwordx4 v21, s[72:75], s42 offen  lds
    s_add_u32 s43, s68, 1024
    s_mov_b32 m0, s43
    s_add_u32 s42, s69, 67584
    buffer_load_dwordx4 v22, s[72:75], s42 offen  lds
    s_add_u32 s43, s68, 2048
    s_mov_b32 m0, s43
    s_add_u32 s42, s69, 69632
    s_waitcnt vmcnt(8)
    buffer_load_dwordx4 v23, s[72:75], s42 offen  lds
    s_add_u32 s43, s68, 3072
    s_mov_b32 m0, s43
    s_add_u32 s42, s69, 71680
    s_waitcnt vmcnt(8)
    buffer_load_dwordx4 v24, s[72:75], s42 offen  lds
    s_add_u32 s43, s68, 32768
    s_mov_b32 m0, s43
    s_add_u32 s42, s67, 0
    s_waitcnt vmcnt(8)
    buffer_load_dwordx4 v5, s[44:47], s42 offen  lds
    s_add_u32 s43, s68, 33792
    s_mov_b32 m0, s43
    s_add_u32 s42, s67, 114688
    s_waitcnt vmcnt(8)
    buffer_load_dwordx4 v5, s[44:47], s42 offen  lds
    s_waitcnt lgkmcnt(0)
    s_barrier
    v_add_u32 v168, 65536, v8
    v_add_u32 v169, 65536, v9
    v_add_u32 v170, 65536, v10
    v_add_u32 v171, 65536, v11
    ds_read_b64_tr_b16 v[32:33], v168 offset:32768
    ds_read_b64_tr_b16 v[34:35], v168 offset:49152
    ds_read_b64_tr_b16 v[36:37], v169 offset:32768
    ds_read_b64_tr_b16 v[38:39], v169 offset:49152
    ds_read_b64_tr_b16 v[40:41], v170 offset:32768
    ds_read_b64_tr_b16 v[42:43], v170 offset:49152
    ds_read_b64_tr_b16 v[44:45], v171 offset:32768
    ds_read_b64_tr_b16 v[46:47], v171 offset:49152
    s_add_u32 s43, s68, 34816
    s_mov_b32 m0, s43
    s_add_u32 s42, s67, 28672
    s_waitcnt vmcnt(5)
    buffer_load_dwordx4 v5, s[44:47], s42 offen  lds
    s_add_u32 s43, s68, 35840
    s_mov_b32 m0, s43
    s_add_u32 s42, s67, 143360
    s_waitcnt vmcnt(5)
    buffer_load_dwordx4 v5, s[44:47], s42 offen  lds
    s_add_u32 s43, s68, 65536
    s_mov_b32 m0, s43
    s_add_u32 s42, s67, 1835008
    s_waitcnt vmcnt(5)
    buffer_load_dwordx4 v5, s[44:47], s42 offen  lds
    s_add_u32 s43, s68, 66560
    s_mov_b32 m0, s43
    s_add_u32 s42, s67, 1949696
    s_waitcnt vmcnt(5)
    buffer_load_dwordx4 v5, s[44:47], s42 offen  lds
    s_waitcnt lgkmcnt(0)
    s_barrier
    ds_read_b64_tr_b16 v[48:49], v8 offset:0
    ds_read_b64_tr_b16 v[50:51], v8 offset:16384
    ds_read_b64_tr_b16 v[52:53], v9 offset:0
    ds_read_b64_tr_b16 v[54:55], v9 offset:16384
    ds_read_b64_tr_b16 v[56:57], v10 offset:0
    ds_read_b64_tr_b16 v[58:59], v10 offset:16384
    ds_read_b64_tr_b16 v[60:61], v11 offset:0
    ds_read_b64_tr_b16 v[62:63], v11 offset:16384
    s_add_u32 s43, s68, 67584
    s_mov_b32 m0, s43
    s_add_u32 s42, s67, 1863680
    s_waitcnt vmcnt(5)
    buffer_load_dwordx4 v5, s[44:47], s42 offen  lds
    s_add_u32 s43, s68, 68608
    s_mov_b32 m0, s43
    s_add_u32 s42, s67, 1978368
    s_waitcnt vmcnt(5)
    buffer_load_dwordx4 v5, s[44:47], s42 offen  lds
    s_add_u32 s43, s68, 98304
    s_mov_b32 m0, s43
    s_add_u32 s42, s67, 0
    s_waitcnt vmcnt(5)
    buffer_load_dwordx4 v5, s[60:63], s42 offen  lds
    s_add_u32 s43, s68, 99328
    s_mov_b32 m0, s43
    s_add_u32 s42, s67, 114688
    s_waitcnt vmcnt(5)
    buffer_load_dwordx4 v5, s[60:63], s42 offen  lds
    s_waitcnt lgkmcnt(0)
    s_barrier
    ds_read_b64_tr_b16 v[64:65], v12 offset:32768
    ds_read_b64_tr_b16 v[66:67], v12 offset:34816
    ds_read_b64_tr_b16 v[68:69], v12 offset:36864
    ds_read_b64_tr_b16 v[70:71], v12 offset:38912
    ds_read_b64_tr_b16 v[72:73], v12 offset:40960
    ds_read_b64_tr_b16 v[74:75], v12 offset:43008
    ds_read_b64_tr_b16 v[76:77], v12 offset:45056
    ds_read_b64_tr_b16 v[78:79], v12 offset:47104
    s_add_u32 s43, s68, 100352
    s_mov_b32 m0, s43
    s_add_u32 s42, s67, 28672
    s_waitcnt vmcnt(5)
    buffer_load_dwordx4 v5, s[60:63], s42 offen  lds
    s_add_u32 s43, s68, 101376
    s_mov_b32 m0, s43
    s_add_u32 s42, s67, 143360
    s_waitcnt vmcnt(5)
    buffer_load_dwordx4 v5, s[60:63], s42 offen  lds
    s_add_u32 s43, s68, 0
    s_mov_b32 m0, s43
    s_add_u32 s42, s67, 1835008
    s_waitcnt vmcnt(5)
    buffer_load_dwordx4 v5, s[60:63], s42 offen  lds
    s_add_u32 s43, s68, 1024
    s_mov_b32 m0, s43
    s_add_u32 s42, s67, 1949696
    s_waitcnt vmcnt(5)
    buffer_load_dwordx4 v5, s[60:63], s42 offen  lds
    s_waitcnt lgkmcnt(0)
    s_barrier
    ds_read_b64_tr_b16 v[80:81], v25 offset:0
    ds_read_b64_tr_b16 v[82:83], v25 offset:2048
    ds_read_b64_tr_b16 v[84:85], v25 offset:4096
    ds_read_b64_tr_b16 v[86:87], v25 offset:6144
    ds_read_b64_tr_b16 v[88:89], v25 offset:8192
    ds_read_b64_tr_b16 v[90:91], v25 offset:10240
    ds_read_b64_tr_b16 v[92:93], v25 offset:12288
    ds_read_b64_tr_b16 v[94:95], v25 offset:14336
    s_add_u32 s43, s68, 2048
    s_mov_b32 m0, s43
    s_add_u32 s42, s67, 1863680
    s_waitcnt vmcnt(5)
    buffer_load_dwordx4 v5, s[60:63], s42 offen  lds
    s_add_u32 s43, s68, 3072
    s_mov_b32 m0, s43
    s_add_u32 s42, s67, 1978368
    s_waitcnt vmcnt(5)
    buffer_load_dwordx4 v5, s[60:63], s42 offen  lds
    s_waitcnt vmcnt(4)
    s_waitcnt lgkmcnt(0)
    s_barrier
    ds_read_b64_tr_b16 v[96:97], v25 offset:32768
    ds_read_b64_tr_b16 v[98:99], v25 offset:34816
    ds_read_b64_tr_b16 v[100:101], v25 offset:36864
    ds_read_b64_tr_b16 v[102:103], v25 offset:38912
    ds_read_b64_tr_b16 v[104:105], v25 offset:40960
    ds_read_b64_tr_b16 v[106:107], v25 offset:43008
    ds_read_b64_tr_b16 v[108:109], v25 offset:45056
    ds_read_b64_tr_b16 v[110:111], v25 offset:47104
    s_cmp_lg_u32 s16, 0
    s_cbranch_scc1 m_n0
    v_lshlrev_b32 v30, 6, v2
    s_waitcnt vmcnt(2)
    buffer_load_dword v31, v30, s[12:15], s81 offen sc1
    buffer_load_dwordx2 v[188:189], v14, s[12:15], s38 offen sc1
    buffer_load_dword v15, v14, s[12:15], s78 offen offset:2048 sc1
m_n0:
    s_waitcnt vmcnt(0)
    s_waitcnt lgkmcnt(0)
    s_barrier
    v_mov_b32 v190, 134656
    s_cmp_lg_u32 s16, 0
    s_cbranch_scc1 m_n1
    v_xor_b32 v188, s32, v188
    v_xor_b32 v189, s39, v189
    v_or_b32 v188, v188, v189
    ds_write_b32 v190, v188
    v_cmp_ne_u32 vcc, s32, v15
    s_cbranch_vccnz m_n1
    buffer_load_dwordx4 v[136:139], v3, s[12:15], s78 offen offset:0 sc1
    buffer_load_dwordx4 v[140:143], v3, s[12:15], s78 offen offset:1024 sc1
m_n1:
    ds_read_b64_tr_b16 v[112:113], v12 offset:0
    ds_read_b64_tr_b16 v[114:115], v12 offset:2048
    ds_read_b64_tr_b16 v[116:117], v12 offset:4096
    ds_read_b64_tr_b16 v[118:119], v12 offset:6144
    ds_read_b64_tr_b16 v[120:121], v12 offset:8192
    ds_read_b64_tr_b16 v[122:123], v12 offset:10240
    ds_read_b64_tr_b16 v[124:125], v12 offset:12288
    ds_read_b64_tr_b16 v[126:127], v12 offset:14336
    s_cmp_lg_u32 s16, 0
    s_cbranch_scc1 m_nk
    s_cbranch_vccnz m_slowk
    s_waitcnt vmcnt(0)
    v_xor_b32 v30, s32, v138
    v_bitop3_b32 v30, v30, v142, s32 bitop3:0xf6
    v_cmp_ne_u32 vcc, 0, v30
    s_cbranch_vccz m_pkx
    s_branch m_gox
m_slowk:
    s_mov_b32 s83, 0
m_go:
    buffer_load_dword v15, v14, s[12:15], s78 offen offset:2048 sc1
    s_waitcnt vmcnt(0)
    v_cmp_ne_u32 vcc, s32, v15
    s_cbranch_vccz m_gox
    s_sleep 3
    s_add_u32 s83, s83, 1
    s_cmp_lt_u32 s83, 0x40000
    s_cbranch_scc1 m_go
m_gox:
    s_sleep 1
    s_mov_b32 s83, 0
m_pk:
    buffer_load_dwordx4 v[136:139], v3, s[12:15], s78 offen offset:0 sc1
    buffer_load_dwordx4 v[140:143], v3, s[12:15], s78 offen offset:1024 sc1
    s_waitcnt vmcnt(0)
    v_xor_b32 v30, s32, v138
    v_bitop3_b32 v30, v30, v142, s32 bitop3:0xf6
    v_cmp_ne_u32 vcc, 0, v30
    s_cbranch_vccz m_pkx
    s_sleep 4
    s_add_u32 s83, s83, 1
    s_cmp_lt_u32 s83, 0x40000
    s_cbranch_scc1 m_pk
m_pkx:
    v_max_u32 v28, v136, v140
    v_min_u32 v29, v136, v140
    v_max3_u32 v29, v29, v137, v141
    v_mov_b32 v30, v28
    s_nop 1
    v_max_u32_dpp v30, v30, v30 row_ror:8 row_mask:0xf bank_mask:0xf
    s_nop 1
    v_max_u32_dpp v30, v30, v30 row_ror:4 row_mask:0xf bank_mask:0xf
    s_nop 1
    v_max_u32_dpp v30, v30, v30 row_ror:2 row_mask:0xf bank_mask:0xf
    s_nop 1
    v_max_u32_dpp v30, v30, v30 row_ror:1 row_mask:0xf bank_mask:0xf
    s_nop 1
    v_max_u32_dpp v30, v30, v30 row_bcast:15 row_mask:0xa bank_mask:0xf
    s_nop 1
    v_max_u32_dpp v30, v30, v30 row_bcast:31 row_mask:0xc bank_mask:0xf
    s_nop 0
    v_readlane_b32 s40, v30, 63
    s_nop 1
    v_cmp_eq_u32 vcc, s40, v28
    s_nop 1
    v_cndmask_b32 v30, v28, v29, vcc
    s_nop 1
    v_max_u32_dpp v30, v30, v30 row_ror:8 row_mask:0xf bank_mask:0xf
    s_nop 1
    v_max_u32_dpp v30, v30, v30 row_ror:4 row_mask:0xf bank_mask:0xf
    s_nop 1
    v_max_u32_dpp v30, v30, v30 row_ror:2 row_mask:0xf bank_mask:0xf
    s_nop 1
    v_max_u32_dpp v30, v30, v30 row_ror:1 row_mask:0xf bank_mask:0xf
    s_nop 1
    v_max_u32_dpp v30, v30, v30 row_bcast:15 row_mask:0xa bank_mask:0xf
    s_nop 1
    v_max_u32_dpp v30, v30, v30 row_bcast:31 row_mask:0xc bank_mask:0xf
    s_nop 0
    v_readlane_b32 s41, v30, 63
    s_and_b32 s40, s40, 0xff
    s_and_b32 s41, s41, 0xff
    s_lshl_b32 s42, s40, 12
    s_lshl_b32 s43, s41, 12
    s_add_u32 s42, s42, s71
    s_add_u32 s43, s43, s71
    s_mov_b32 s83, 0
    buffer_load_dwordx4 v[176:179], v3, s[12:15], s42 offen sc1
    buffer_load_dwordx4 v[180:183], v3, s[12:15], s43 offen sc1
    s_cmp_lg_u32 s35, 0
    s_cbranch_scc1 m_ph2
    s_lshl_b32 s41, s41, 8
    s_or_b32 s40, s40, s41
    v_mov_b32 v28, s40
    v_mov_b32 v29, s32
    s_mov_b64 exec, 1
    buffer_store_dwordx2 v[28:29], v14, s[12:15], s78 offen offset:2304 sc1
    s_mov_b64 exec, -1
    s_waitcnt vmcnt(1)
    s_branch m_ph3
m_ph:
    buffer_load_dwordx4 v[176:179], v3, s[12:15], s42 offen sc1
    buffer_load_dwordx4 v[180:183], v3, s[12:15], s43 offen sc1
m_ph2:
    s_waitcnt vmcnt(0)
m_ph3:
    ds_write_b128 v13, v[176:179]
    ds_write_b128 v13, v[180:183] offset:1024
    v_max3_u32 v30, v176, v177, v178
    v_max3_u32 v30, v30, v179, v180
    v_max3_u32 v30, v30, v181, v182
    v_max_u32 v30, v30, v183
    v_cmp_eq_u32 vcc, -1, v30
    s_cbranch_vccz m_phx
    s_add_u32 s83, s83, 1
    s_cmp_lt_u32 s83, 0x40000
    s_cbranch_scc1 m_ph
m_phx:
m_nk:
    s_waitcnt lgkmcnt(0)
    s_barrier
    ds_read_b32 v188, v190
    ds_read_b128 v[128:131], v17 offset:0
    ds_read_b128 v[132:135], v17 offset:64
    ds_read_b128 v[136:139], v17 offset:128
    ds_read_b128 v[140:143], v17 offset:192
    ds_read_b128 v[144:147], v17 offset:512
    ds_read_b128 v[148:151], v17 offset:576
    ds_read_b128 v[152:155], v17 offset:640
    ds_read_b128 v[156:159], v17 offset:704
    s_waitcnt lgkmcnt(7)
    v_mfma_f32_16x16x32_bf16 v[160:163], v[128:131], v[64:67], 0
    v_mfma_f32_16x16x32_bf16 v[164:167], v[128:131], v[96:99], 0
    s_waitcnt lgkmcnt(6)
    v_mfma_f32_16x16x32_bf16 v[160:163], v[132:135], v[68:71], v[160:163]
    v_mfma_f32_16x16x32_bf16 v[164:167], v[132:135], v[100:103], v[164:167]
    s_waitcnt lgkmcnt(5)
    v_mfma_f32_16x16x32_bf16 v[160:163], v[136:139], v[72:75], v[160:163]
    v_mfma_f32_16x16x32_bf16 v[164:167], v[136:139], v[104:107], v[164:167]
    s_waitcnt lgkmcnt(4)
    v_mfma_f32_16x16x32_bf16 v[160:163], v[140:143], v[76:79], v[160:163]
    v_mfma_f32_16x16x32_bf16 v[164:167], v[140:143], v[108:111], v[164:167]
    s_waitcnt lgkmcnt(3)
    v_mfma_f32_16x16x32_bf16 v[160:163], v[144:147], v[80:83], v[160:163]
    v_mfma_f32_16x16x32_bf16 v[164:167], v[144:147], v[112:115], v[164:167]
    s_waitcnt lgkmcnt(2)
    v_mfma_f32_16x16x32_bf16 v[160:163], v[148:151], v[84:87], v[160:163]
    v_mfma_f32_16x16x32_bf16 v[164:167], v[148:151], v[116:119], v[164:167]
    s_waitcnt lgkmcnt(1)
    v_mfma_f32_16x16x32_bf16 v[160:163], v[152:155], v[88:91], v[160:163]
    v_mfma_f32_16x16x32_bf16 v[164:167], v[152:155], v[120:123], v[164:167]
    s_waitcnt lgkmcnt(0)
    v_mfma_f32_16x16x32_bf16 v[160:163], v[156:159], v[92:95], v[160:163]
    v_mfma_f32_16x16x32_bf16 v[164:167], v[156:159], v[124:127], v[164:167]
    v_readfirstlane_b32 s70, v188
    s_nop 5
    v_min_u32 v184, -2, v160
    v_min_u32 v185, -2, v161
    v_min_u32 v186, -2, v164
    v_min_u32 v187, -2, v165
    s_mov_b64 exec, 0xffff
    buffer_store_dwordx4 v[184:187], v3, s[12:15], s76 offen
    s_cmp_eq_u32 s70, 0
    s_cbranch_scc1 m_same
    buffer_store_dwordx4 v[184:187], v3, s[12:15], s77 offen sc1
m_same:
    s_cselect_b32 s82, s81, s82
    s_mov_b64 exec, -1
    s_cmp_ge_u32 s16, 4
    s_cbranch_scc1 m_na
    s_sleep 2
    s_mov_b32 s83, 0
m_px:
    buffer_load_dwordx4 v[24:27], v3, s[12:15], s81 offen sc1
    s_waitcnt vmcnt(0)
    v_max3_u32 v9, v24, v25, v26
    v_max_u32 v9, v9, v27
    v_cmp_eq_u32 vcc, -1, v9
    s_cbranch_vccz m_pxx
    buffer_load_dwordx4 v[24:27], v3, s[12:15], s82 offen sc1
    s_waitcnt vmcnt(0)
    v_max3_u32 v9, v24, v25, v26
    v_max_u32 v9, v9, v27
    v_cmp_eq_u32 vcc, -1, v9
    s_cbranch_vccz m_pxx
    s_add_u32 s83, s83, 1
    s_cmp_lt_u32 s83, 0x40000
    s_cbranch_scc1 m_px
m_pxx:
    v_permlane32_swap_b32 v24, v26
    v_permlane32_swap_b32 v25, v27
    v_pk_add_f32 v[24:25], v[24:25], v[26:27]
    s_nop 1
    v_permlane16_swap_b32 v24, v25
    v_add_f32 v24, v24, v25
    v_cvt_pk_bf16_f32 v24, v24, v24
    v_lshlrev_b32 v24, 16, v24
    v_mul_f32 v25, 0xbfb8aa3b, v24
    v_exp_f32 v25, v25
    v_mov_b32 v26, v24
    v_add_f32 v25, 1.0, v25
    v_rcp_f32 v25, v25
    v_mov_b32 v27, v24
    v_mul_f32 v25, v24, v25
    s_nop 0
    v_permlane32_swap_b32 v26, v27
    v_cvt_pk_bf16_f32 v25, v25, v25
    v_lshlrev_b32 v25, 16, v25
    v_mul_f32 v25, v25, v27
    v_cvt_pk_bf16_f32 v25, v25, v25
    ds_write_b16 v18, v25
m_na:
    s_waitcnt lgkmcnt(0)
    s_barrier
    ds_read_b128 v[128:131], v19 offset:0
    ds_read_b128 v[132:135], v19 offset:64
    s_waitcnt lgkmcnt(1)
    v_mfma_f32_16x16x32_bf16 v[160:163], v[128:131], v[32:35], 0
    v_mfma_f32_16x16x32_bf16 v[164:167], v[128:131], v[36:39], 0
    v_mfma_f32_16x16x32_bf16 v[168:171], v[128:131], v[40:43], 0
    v_mfma_f32_16x16x32_bf16 v[172:175], v[128:131], v[44:47], 0
    s_waitcnt lgkmcnt(0)
    v_mfma_f32_16x16x32_bf16 v[160:163], v[132:135], v[48:51], v[160:163]
    v_mfma_f32_16x16x32_bf16 v[164:167], v[132:135], v[52:55], v[164:167]
    v_mfma_f32_16x16x32_bf16 v[168:171], v[132:135], v[56:59], v[168:171]
    v_mfma_f32_16x16x32_bf16 v[172:175], v[132:135], v[60:63], v[172:175]
    s_nop 5
    v_cndmask_b32 v24, v160, v164, s[4:5]
    v_cndmask_b32 v25, v161, v165, s[4:5]
    v_cndmask_b32 v24, v24, v168, s[6:7]
    v_cndmask_b32 v25, v25, v169, s[6:7]
    v_cndmask_b32 v24, v24, v172, s[28:29]
    v_cndmask_b32 v25, v25, v173, s[28:29]
    v_bfi_b32 v24, s33, v191, v24
    v_bfi_b32 v25, s33, v191, v25
    buffer_store_dword v24, v20, s[12:15], s30 offen sc1
    buffer_store_dword v25, v20, s[12:15], s31 offen sc1
    s_endpgm
x_start:
    s_lshl_b32 s37, s34, 1
    s_add_u32 s37, s37, s65
    s_lshl_b32 s37, s37, 3
    s_add_u32 s37, s37, s16
    s_lshl_b32 s42, s37, 8
    s_add_u32 s42, s42, 4947968
    s_mov_b64 exec, 0xffff
    buffer_store_dwordx4 v[104:107], v3, s[12:15], s42 offen sc1
    s_mov_b64 exec, -1
    s_lshl_b32 s36, s37, 12
    s_add_u32 s36, s36, 4194304
    s_lshl_b32 s76, s34, 3
    s_add_u32 s76, s76, s16
    s_lshl_b32 s77, s76, 10
    s_add_u32 s77, s77, 6356992
    s_lshl_b32 s79, s76, 7
    s_add_u32 s79, s79, 6488064
    s_lshr_b32 s71, s76, 5
    s_cmp_eq_u32 s71, 1
    s_cselect_b32 s80, 1.0, 0
    s_lshl_b32 s78, s34, 12
    s_add_u32 s78, s78, 4947968
    s_mul_i32 s70, s41, 4096
    s_add_u32 s70, s70, 4096
    s_add_u32 s70, s70, s18
    s_add_u32 s42, s17, 1
    s_and_b32 s42, s42, 7
    s_lshl_b32 s42, s42, 8
    s_add_u32 s70, s70, s42
    s_add_u32 s43, s68, 32768
    s_mov_b32 m0, s43
    s_add_u32 s42, s70, 0
    s_waitcnt vmcnt(6)
    buffer_load_dwordx4 v4, s[8:11], s42 offen  lds
    s_add_u32 s43, s68, 33792
    s_mov_b32 m0, s43
    s_add_u32 s42, s70, 49152
    s_waitcnt vmcnt(6)
    buffer_load_dwordx4 v4, s[8:11], s42 offen  lds
    s_add_u32 s43, s68, 34816
    s_mov_b32 m0, s43
    s_add_u32 s42, s70, 98304
    s_waitcnt vmcnt(6)
    buffer_load_dwordx4 v31, s[8:11], s42 offen  lds
    s_add_u32 s43, s68, 35840
    s_mov_b32 m0, s43
    s_add_u32 s42, s70, 147456
    s_waitcnt vmcnt(6)
    buffer_load_dwordx4 v31, s[8:11], s42 offen  lds
    s_waitcnt vmcnt(6)
    v_lshlrev_b32 v110, 16, v110
    v_mul_f32 v111, 0xbfb8aa3b, v110
    v_exp_f32 v111, v111
    s_nop 0
    v_add_f32 v111, 1.0, v111
    v_rcp_f32 v111, v111
    s_nop 0
    v_mul_f32 v110, v110, v111
    v_cvt_pk_bf16_f32 v110, v110, v110
    ds_write_b16 v109, v110
    s_waitcnt lgkmcnt(0)
    s_barrier
    ds_read_b128 v[128:131], v27 offset:0
    ds_read_b128 v[132:135], v27 offset:64
    ds_read_b128 v[136:139], v27 offset:128
    ds_read_b128 v[140:143], v27 offset:192
    ds_read_b64_tr_b16 v[144:145], v29 offset:0
    ds_read_b64_tr_b16 v[146:147], v29 offset:1024
    ds_read_b64_tr_b16 v[148:149], v29 offset:8192
    ds_read_b64_tr_b16 v[150:151], v29 offset:9216
    ds_read_b64_tr_b16 v[152:153], v29 offset:16384
    ds_read_b64_tr_b16 v[154:155], v29 offset:17408
    ds_read_b64_tr_b16 v[156:157], v29 offset:24576
    ds_read_b64_tr_b16 v[158:159], v29 offset:25600
    s_mul_i32 s32, s101, 0x9e3779b1
    s_or_b32 s32, s32, 0x101
    s_and_b32 s32, s32, 0xfffefbfb
    s_and_b32 s56, s32, 0xff
    s_bfe_u32 s57, s32, 0x80008
    s_bfe_u32 s58, s32, 0x80010
    s_lshr_b32 s59, s32, 24
    v_mov_b32 v164, s56
    v_mov_b32 v165, s57
    v_mov_b32 v166, s58
    v_mov_b32 v167, s59
    s_waitcnt lgkmcnt(6)
    v_mfma_f32_16x16x32_bf16 v[160:163], v[144:147], v[128:131], 0
    s_waitcnt lgkmcnt(4)
    v_mfma_f32_16x16x32_bf16 v[160:163], v[148:151], v[132:135], v[160:163]
    s_waitcnt lgkmcnt(2)
    v_mfma_f32_16x16x32_bf16 v[160:163], v[152:155], v[136:139], v[160:163]
    s_waitcnt lgkmcnt(0)
    v_mfma_f32_16x16x32_bf16 v[160:163], v[156:159], v[140:143], v[160:163]
    s_nop 7
    v_bfi_b32 v160, s33, v164, v160
    v_bfi_b32 v161, s33, v165, v161
    v_bfi_b32 v162, s33, v166, v162
    v_bfi_b32 v163, s33, v167, v163
    s_mov_b32 exec_lo, 0x00010001
    s_mov_b32 exec_hi, 0x00010001
    buffer_store_dwordx4 v[160:163], v28, s[12:15], s30 offen sc1
    s_mov_b64 exec, -1
    s_mul_i32 s70, s41, 4096
    s_add_u32 s70, s70, 6144
    s_add_u32 s70, s70, s18
    s_add_u32 s42, s17, 2
    s_and_b32 s42, s42, 7
    s_lshl_b32 s42, s42, 8
    s_add_u32 s70, s70, s42
    s_add_u32 s43, s68, 65536
    s_mov_b32 m0, s43
    s_add_u32 s42, s70, 0
    s_waitcnt vmcnt(4)
    buffer_load_dwordx4 v4, s[8:11], s42 offen  lds
    s_add_u32 s43, s68, 66560
    s_mov_b32 m0, s43
    s_add_u32 s42, s70, 49152
    s_waitcnt vmcnt(4)
    buffer_load_dwordx4 v4, s[8:11], s42 offen  lds
    s_add_u32 s43, s68, 67584
    s_mov_b32 m0, s43
    s_add_u32 s42, s70, 98304
    s_waitcnt vmcnt(4)
    buffer_load_dwordx4 v31, s[8:11], s42 offen  lds
    s_add_u32 s43, s68, 68608
    s_mov_b32 m0, s43
    s_add_u32 s42, s70, 147456
    s_waitcnt vmcnt(4)
    buffer_load_dwordx4 v31, s[8:11], s42 offen  lds
    s_waitcnt lgkmcnt(0)
    s_barrier
    ds_read_b64_tr_b16 v[144:145], v29 offset:32768
    ds_read_b64_tr_b16 v[146:147], v29 offset:33792
    ds_read_b64_tr_b16 v[148:149], v29 offset:40960
    ds_read_b64_tr_b16 v[150:151], v29 offset:41984
    ds_read_b64_tr_b16 v[152:153], v29 offset:49152
    ds_read_b64_tr_b16 v[154:155], v29 offset:50176
    ds_read_b64_tr_b16 v[156:157], v29 offset:57344
    ds_read_b64_tr_b16 v[158:159], v29 offset:58368
    s_waitcnt lgkmcnt(6)
    v_mfma_f32_16x16x32_bf16 v[160:163], v[144:147], v[128:131], 0
    s_waitcnt lgkmcnt(4)
    v_mfma_f32_16x16x32_bf16 v[160:163], v[148:151], v[132:135], v[160:163]
    s_waitcnt lgkmcnt(2)
    v_mfma_f32_16x16x32_bf16 v[160:163], v[152:155], v[136:139], v[160:163]
    s_waitcnt lgkmcnt(0)
    v_mfma_f32_16x16x32_bf16 v[160:163], v[156:159], v[140:143], v[160:163]
    s_add_u32 s42, s17, 1
    s_and_b32 s42, s42, 7
    s_lshl_b32 s42, s42, 12
    s_add_u32 s42, s42, s31
    s_add_u32 s42, s42, 0
    s_nop 2
    v_bfi_b32 v160, s33, v164, v160
    v_bfi_b32 v161, s33, v165, v161
    v_bfi_b32 v162, s33, v166, v162
    v_bfi_b32 v163, s33, v167, v163
    s_mov_b32 exec_lo, 0x00010001
    s_mov_b32 exec_hi, 0x00010001
    buffer_store_dwordx4 v[160:163], v26, s[12:15], s42 offen sc1
    s_mov_b64 exec, -1
    s_waitcnt vmcnt(1)
    s_waitcnt lgkmcnt(0)
    s_barrier
    ds_read_b64_tr_b16 v[144:145], v30 offset:0
    ds_read_b64_tr_b16 v[146:147], v30 offset:1024
    ds_read_b64_tr_b16 v[148:149], v30 offset:8192
    ds_read_b64_tr_b16 v[150:151], v30 offset:9216
    ds_read_b64_tr_b16 v[152:153], v30 offset:16384
    ds_read_b64_tr_b16 v[154:155], v30 offset:17408
    ds_read_b64_tr_b16 v[156:157], v30 offset:24576
    ds_read_b64_tr_b16 v[158:159], v30 offset:25600
    s_waitcnt lgkmcnt(6)
    v_mfma_f32_16x16x32_bf16 v[160:163], v[144:147], v[128:131], 0
    s_waitcnt lgkmcnt(4)
    v_mfma_f32_16x16x32_bf16 v[160:163], v[148:151], v[132:135], v[160:163]
    s_waitcnt lgkmcnt(2)
    v_mfma_f32_16x16x32_bf16 v[160:163], v[152:155], v[136:139], v[160:163]
    s_waitcnt lgkmcnt(0)
    v_mfma_f32_16x16x32_bf16 v[160:163], v[156:159], v[140:143], v[160:163]
    s_add_u32 s42, s17, 2
    s_and_b32 s42, s42, 7
    s_lshl_b32 s42, s42, 12
    s_add_u32 s42, s42, s31
    s_add_u32 s42, s42, 65536
    s_nop 2
    v_bfi_b32 v160, s33, v164, v160
    v_bfi_b32 v161, s33, v165, v161
    v_bfi_b32 v162, s33, v166, v162
    v_bfi_b32 v163, s33, v167, v163
    s_mov_b32 exec_lo, 0x00010001
    s_mov_b32 exec_hi, 0x00010001
    buffer_store_dwordx4 v[160:163], v26, s[12:15], s42 offen sc1
    s_mov_b64 exec, -1
    s_cmp_eq_u32 s65, 1
    s_cbranch_scc1 x_na
    s_sleep 8
    v_lshlrev_b32 v8, 3, v7
    v_lshrrev_b32 v8, v8, s32
    s_mov_b32 s83, 0
x_pa:
    buffer_load_dwordx4 v[16:19], v3, s[12:15], s77 offen sc1
    s_waitcnt vmcnt(0)
    v_xor_b32 v16, s56, v16
    v_xor_b32 v17, s57, v17
    v_xor_b32 v18, s58, v18
    v_xor_b32 v19, s59, v19
    v_or3_b32 v9, v16, v17, v18
    v_or_b32 v9, v9, v19
    v_and_b32 v9, 0xff, v9
    v_cmp_ne_u32 vcc, 0, v9
    s_cbranch_vccz x_pax
    s_sleep 4
    s_add_u32 s83, s83, 1
    s_cmp_lt_u32 s83, 0x40000
    s_cbranch_scc1 x_pa
x_pax:
    v_permlane32_swap_b32 v16, v18
    v_permlane32_swap_b32 v17, v19
    v_pk_add_f32 v[16:17], v[16:17], v[18:19]
    s_nop 1
    v_permlane16_swap_b32 v16, v17
    v_add_f32 v16, v16, v17
    s_nop 1
    v_add_f32_dpp v16, v16, v16 row_ror:8 row_mask:0xf bank_mask:0xf
    v_cvt_pk_bf16_f32 v16, v16, v16
    v_lshlrev_b32 v16, 16, v16
    v_add_f32 v16, s80, v16
    v_cvt_pk_bf16_f32 v16, v16, v16
    v_lshlrev_b32 v16, 16, v16
    v_bfi_b32 v16, s33, v8, v16
    v_mov_b32 v17, v16
    s_nop 1
    v_permlane16_swap_b32 v16, v17
    v_mov_b32 v18, v16
    v_mov_b32 v19, v17
    s_nop 0
    v_permlane32_swap_b32 v16, v18
    v_permlane32_swap_b32 v17, v19
    s_mov_b64 exec, 0xff
    buffer_store_dwordx4 v[16:19], v3, s[12:15], s79 offen sc1
    s_mov_b64 exec, -1
    s_add_u32 s77, s77, 65536
    s_add_u32 s79, s79, 8192
    s_mov_b32 s80, 0
    s_sleep 24
    v_lshlrev_b32 v8, 3, v7
    v_lshrrev_b32 v8, v8, s32
    s_mov_b32 s83, 0
x_pb:
    buffer_load_dwordx4 v[16:19], v3, s[12:15], s77 offen sc1
    s_waitcnt vmcnt(0)
    v_xor_b32 v16, s56, v16
    v_xor_b32 v17, s57, v17
    v_xor_b32 v18, s58, v18
    v_xor_b32 v19, s59, v19
    v_or3_b32 v9, v16, v17, v18
    v_or_b32 v9, v9, v19
    v_and_b32 v9, 0xff, v9
    v_cmp_ne_u32 vcc, 0, v9
    s_cbranch_vccz x_pbx
    s_sleep 4
    s_add_u32 s83, s83, 1
    s_cmp_lt_u32 s83, 0x40000
    s_cbranch_scc1 x_pb
x_pbx:
    v_permlane32_swap_b32 v16, v18
    v_permlane32_swap_b32 v17, v19
    v_pk_add_f32 v[16:17], v[16:17], v[18:19]
    s_nop 1
    v_permlane16_swap_b32 v16, v17
    v_add_f32 v16, v16, v17
    s_nop 1
    v_add_f32_dpp v16, v16, v16 row_ror:8 row_mask:0xf bank_mask:0xf
    v_cvt_pk_bf16_f32 v16, v16, v16
    v_lshlrev_b32 v16, 16, v16
    v_add_f32 v16, s80, v16
    v_cvt_pk_bf16_f32 v16, v16, v16
    v_lshlrev_b32 v16, 16, v16
    v_bfi_b32 v16, s33, v8, v16
    v_mov_b32 v17, v16
    s_nop 1
    v_permlane16_swap_b32 v16, v17
    v_mov_b32 v18, v16
    v_mov_b32 v19, v17
    s_nop 0
    v_permlane32_swap_b32 v16, v18
    v_permlane32_swap_b32 v17, v19
    s_mov_b64 exec, 0xff
    buffer_store_dwordx4 v[16:19], v3, s[12:15], s79 offen sc1
    s_mov_b64 exec, -1
    s_branch x_nb
x_na:
    v_and_b32 v90, 255, v0
    v_lshrrev_b32 v91, 8, v0
    v_lshl_add_u32 v90, v91, 9, v90
    v_mul_u32_u24 v90, 7168, v90
    s_lshr_b32 s42, s60, 7
    s_sub_u32 s42, 3, s42
    s_add_u32 s42, s42, s34
    s_and_b32 s42, s42, 7
    s_cmp_eq_u32 s42, 7
    s_cselect_b32 s70, 0x1000000, 0
    s_mul_i32 s43, s34, 7
    s_add_u32 s42, s42, s43
    s_lshl_b32 s42, s42, 7
    s_add_u32 s42, s42, 0
    s_add_u32 s42, s42, s70
    buffer_load_dword v92, v90, s[60:63], s42 offen
    s_barrier
    s_lshr_b32 s42, s60, 7
    s_sub_u32 s42, 3, s42
    s_add_u32 s42, s42, s34
    s_and_b32 s42, s42, 7
    s_cmp_eq_u32 s42, 7
    s_cselect_b32 s70, 0x1000000, 0
    s_mul_i32 s43, s34, 7
    s_add_u32 s42, s42, s43
    s_lshl_b32 s42, s42, 7
    s_add_u32 s42, s42, 1835008
    s_add_u32 s42, s42, s70
    buffer_load_dword v93, v90, s[60:63], s42 offen
    s_barrier
x_nb:
    s_mov_b32 s17, s37
    s_barrier
    v_lshlrev_b32 v9, 7, v2
    s_mov_b64 exec, 0xfffffff
    buffer_load_dword v251, v9, s[12:15], s36 offen
    s_mov_b64 exec, -1
    s_mov_b32 s8, s48
    s_mov_b32 s9, s49
    s_mov_b32 s10, 2048
    s_mov_b32 s11, 0x00020000
    s_and_b32 s18, s17, 63
    v_and_b32 v5, 3, v0
    v_lshlrev_b32 v5, 3, v5
    v_lshl_add_u32 v5, v7, 1, v5
    v_lshlrev_b32 v6, 1, v5
    v_and_b32 v86, -4, v5
    v_and_b32 v87, 2, v5
    v_lshlrev_b32 v87, 3, v87
    s_lshl_b32 s31, s18, 6
    s_add_u32 s31, s31, 6500352
    v_cmp_gt_u32 vcc, 32, v2
    v_mov_b32 v7, 0x7ff00000
    s_nop 0
    v_cndmask_b32 v7, v7, v3, vcc
    buffer_load_dwordx4 v[40:43], v3, s[8:11], 0 offen offset:0
    buffer_load_dwordx4 v[44:47], v3, s[8:11], 0 offen offset:1024
    s_waitcnt vmcnt(0)
    v_lshlrev_b32 v48, 16, v40
    v_and_b32 v49, 0xffff0000, v40
    v_lshlrev_b32 v50, 16, v41
    v_and_b32 v51, 0xffff0000, v41
    v_lshlrev_b32 v52, 16, v42
    v_and_b32 v53, 0xffff0000, v42
    v_lshlrev_b32 v54, 16, v43
    v_and_b32 v55, 0xffff0000, v43
    v_lshlrev_b32 v56, 16, v44
    v_and_b32 v57, 0xffff0000, v44
    v_lshlrev_b32 v58, 16, v45
    v_and_b32 v59, 0xffff0000, v45
    v_lshlrev_b32 v60, 16, v46
    v_and_b32 v61, 0xffff0000, v46
    v_lshlrev_b32 v62, 16, v47
    v_and_b32 v63, 0xffff0000, v47
    s_cmp_lg_u32 s16, 0
    s_cbranch_scc1 x_ng
    v_mov_b32 v22, 0
    s_mov_b32 s83, 0
x_r0:
    buffer_load_dwordx2 v[16:17], v22, s[12:15], s78 offen offset:2304 sc1
    s_waitcnt vmcnt(0)
    v_readfirstlane_b32 s40, v16
    v_readfirstlane_b32 s41, v17
    s_cmp_eq_u32 s41, s32
    s_cbranch_scc1 x_r0x
    s_sleep 3
    s_add_u32 s83, s83, 1
    s_cmp_lt_u32 s83, 0x40000
    s_cbranch_scc1 x_r0
x_r0x:
    s_lshr_b32 s41, s40, 8
    s_and_b32 s40, s40, 0xff
    s_and_b32 s41, s41, 0xff
x_ng:
    s_barrier
    v_mov_b32 v22, 0
    s_mov_b32 s83, 0
x_r1:
    buffer_load_dwordx2 v[16:17], v22, s[12:15], s78 offen offset:2304 sc1
    s_waitcnt vmcnt(0)
    v_readfirstlane_b32 s40, v16
    v_readfirstlane_b32 s41, v17
    s_cmp_eq_u32 s41, s32
    s_cbranch_scc1 x_r1x
    s_sleep 1
    s_add_u32 s83, s83, 1
    s_cmp_lt_u32 s83, 0x40000
    s_cbranch_scc1 x_r1
x_r1x:
    s_lshr_b32 s41, s40, 8
    s_and_b32 s40, s40, 0xff
    s_and_b32 s41, s41, 0xff
    s_cmp_lt_u32 s17, 64
    s_cselect_b32 s40, s40, s41
    s_lshl_b32 s42, s40, 12
    s_add_u32 s42, s42, 5242880
    s_lshl_b32 s19, s18, 5
    s_add_u32 s43, s42, s19
    s_lshl_b32 s40, s40, 3
    s_add_u32 s40, s40, 6506496
    buffer_load_dword v80, v6, s[12:15], s31 offen sc1
    s_mov_b32 s83, 0
x_ps:
    buffer_load_dwordx4 v[32:35], v3, s[12:15], s42 offen offset:0 sc1
    buffer_load_dwordx4 v[36:39], v3, s[12:15], s42 offen offset:1024 sc1
    buffer_load_dword v40, v86, s[12:15], s43 offen offset:2048 sc1
    buffer_load_dwordx2 v[42:43], v14, s[12:15], s40 offen sc1
    s_waitcnt vmcnt(0)
    v_cmp_ne_u32 s[68:69], s32, v43
    v_max3_u32 v9, v32, v33, v34
    v_max3_u32 v9, v9, v35, v36
    v_max3_u32 v9, v9, v37, v38
    v_max3_u32 v9, v9, v39, v40
    v_cmp_eq_u32 vcc, -1, v9
    s_or_b64 vcc, vcc, s[68:69]
    s_cbranch_vccz x_psx
    s_add_u32 s83, s83, 1
    s_cmp_lt_u32 s83, 0x40000
    s_cbranch_scc1 x_ps
x_psx:
    v_readfirstlane_b32 s41, v42
    v_and_b32 v80, 0xffff0000, v80
    v_lshlrev_b32 v64, 16, v32
    v_and_b32 v65, 0xffff0000, v32
    v_lshlrev_b32 v66, 16, v33
    v_and_b32 v67, 0xffff0000, v33
    v_lshlrev_b32 v68, 16, v34
    v_and_b32 v69, 0xffff0000, v34
    v_lshlrev_b32 v70, 16, v35
    v_and_b32 v71, 0xffff0000, v35
    v_lshlrev_b32 v72, 16, v36
    v_and_b32 v73, 0xffff0000, v36
    v_lshlrev_b32 v74, 16, v37
    v_and_b32 v75, 0xffff0000, v37
    v_lshlrev_b32 v76, 16, v38
    v_and_b32 v77, 0xffff0000, v38
    v_lshlrev_b32 v78, 16, v39
    v_and_b32 v79, 0xffff0000, v39
    s_and_b32 s41, s41, 0x7ff
    s_lshl_b32 s41, s41, 11
    s_add_u32 s41, s41, s19
    v_pk_mul_f32 v[8:9], v[48:49], v[64:65]
    v_pk_fma_f32 v[8:9], v[50:51], v[66:67], v[8:9]
    v_pk_fma_f32 v[8:9], v[52:53], v[68:69], v[8:9]
    v_pk_fma_f32 v[8:9], v[54:55], v[70:71], v[8:9]
    v_pk_fma_f32 v[8:9], v[56:57], v[72:73], v[8:9]
    v_pk_fma_f32 v[8:9], v[58:59], v[74:75], v[8:9]
    v_pk_fma_f32 v[8:9], v[60:61], v[76:77], v[8:9]
    v_pk_fma_f32 v[8:9], v[62:63], v[78:79], v[8:9]
    v_add_f32 v8, v8, v9
    s_nop 1
    v_add_f32_dpp v8, v8, v8 row_ror:8 row_mask:0xf bank_mask:0xf
    s_nop 1
    v_add_f32_dpp v8, v8, v8 row_ror:4 row_mask:0xf bank_mask:0xf
    s_nop 1
    v_add_f32_dpp v8, v8, v8 row_ror:2 row_mask:0xf bank_mask:0xf
    s_nop 1
    v_add_f32_dpp v8, v8, v8 row_ror:1 row_mask:0xf bank_mask:0xf
    s_nop 1
    v_add_f32_dpp v8, v8, v8 row_bcast:15 row_mask:0xa bank_mask:0xf
    s_nop 1
    v_add_f32_dpp v8, v8, v8 row_bcast:31 row_mask:0xc bank_mask:0xf
    v_cvt_pk_bf16_f32 v8, v8, v8
    v_lshlrev_b32 v8, 16, v8
    v_mul_f32 v8, 0xbfb8aa3b, v8
    v_exp_f32 v8, v8
    s_nop 0
    v_add_f32 v8, 1.0, v8
    v_rcp_f32 v8, v8
    s_nop 0
    v_cvt_pk_bf16_f32 v8, v8, v8
    v_lshlrev_b32 v8, 16, v8
    s_nop 0
    v_readlane_b32 s46, v8, 63
    v_lshrrev_b32 v44, v87, v40
    v_lshlrev_b32 v44, 16, v44
    v_mul_f32 v80, s46, v80
    s_sleep 16
    s_mov_b32 s83, 0
x_p2:
    buffer_load_dwordx4 v[16:19], v3, s[12:15], s36 offen offset:0 sc1
    buffer_load_dwordx4 v[20:23], v3, s[12:15], s36 offen offset:1024 sc1
    buffer_load_dwordx4 v[24:27], v3, s[12:15], s36 offen offset:2048 sc1
    buffer_load_dwordx4 v[28:31], v7, s[12:15], s36 offen offset:3072 sc1
    s_waitcnt vmcnt(0)
    s_mov_b32 exec_hi, 0
    v_xor_b32 v28, s56, v28
    v_xor_b32 v29, s57, v29
    v_xor_b32 v30, s58, v30
    v_xor_b32 v31, s59, v31
    s_mov_b64 exec, -1
    v_xor_b32 v16, s56, v16
    v_xor_b32 v17, s57, v17
    v_xor_b32 v18, s58, v18
    v_xor_b32 v19, s59, v19
    v_xor_b32 v20, s56, v20
    v_xor_b32 v21, s57, v21
    v_xor_b32 v22, s58, v22
    v_xor_b32 v23, s59, v23
    v_xor_b32 v24, s56, v24
    v_xor_b32 v25, s57, v25
    v_xor_b32 v26, s58, v26
    v_xor_b32 v27, s59, v27
    v_or3_b32 v12, v28, v29, v30
    v_or3_b32 v13, v31, v16, v17
    v_or3_b32 v12, v12, v18, v19
    v_or3_b32 v13, v13, v20, v21
    v_or3_b32 v12, v12, v22, v23
    v_or3_b32 v13, v13, v24, v25
    v_or3_b32 v12, v12, v26, v27
    v_bitop3_b32 v12, v12, v13, s33 bitop3:0xa8
    v_cmp_ne_u32 vcc, 0, v12
    s_cbranch_vccz x_p3
    s_add_u32 s83, s83, 1
    s_cmp_lt_u32 s83, 0x40000
    s_cbranch_scc1 x_p2
x_p3:
    v_pk_add_f32 v[16:17], v[16:17], v[20:21]
    v_pk_add_f32 v[24:25], v[24:25], v[28:29]
    v_pk_add_f32 v[18:19], v[18:19], v[22:23]
    v_pk_add_f32 v[26:27], v[26:27], v[30:31]
    v_pk_add_f32 v[16:17], v[16:17], v[24:25]
    v_pk_add_f32 v[18:19], v[18:19], v[26:27]
    s_nop 1
    v_permlane32_swap_b32 v16, v18
    v_permlane32_swap_b32 v17, v19
    v_pk_add_f32 v[16:17], v[16:17], v[18:19]
    s_nop 1
    v_permlane16_swap_b32 v16, v17
    v_add_f32 v16, v16, v17
    s_nop 1
    v_add_f32_dpp v16, v16, v16 row_ror:4 row_mask:0xf bank_mask:0xf
    s_nop 1
    v_add_f32_dpp v16, v16, v16 row_ror:8 row_mask:0xf bank_mask:0xf
    v_fmac_f32 v44, v16, v80
    s_mov_b32 exec_lo, 0x000f000f
    s_mov_b32 exec_hi, 0x000f000f
    v_cvt_pk_bf16_f32 v44, v44, v44
    buffer_store_short v44, v5, s[24:27], s41 offen
    s_cmp_lg_u32 s17, 0
    s_cbranch_scc1 x_end
    s_add_u32 s101, s101, 1
    s_mov_b32 s43, 6619136
    v_mov_b32 v8, s101
    s_mov_b64 exec, 1
    buffer_store_dword v8, v14, s[12:15], s43 offen sc1
x_end:
k_done:
    s_endpgm
code_end:
.p2align 8
.type tables,@object
tables:
.long 0x3c00,0x3c00,0x3c00,0x3c00,0x3c00,0x2e463bf6,0x323e3bd9,0x34a53ba8
.long 0x3c00,0x323e3bd9,0x361f3b64,0x38723aa7,0x3c00,0x34a53ba8,0x38723aa7,0x3a2f3913
.long 0x3c00,0x361f3b64,0x39a839a8,0x3b64361f,0x3c00,0x378b3b0e,0x3aa73872,0x3bf62e46
.long 0x3c00,0x38723aa7,0x3b64361f,0x3bd9b23e,0x3c00,0x39133a2f,0x3bd9323e,0x3b0eb78b
.long 0x3c00,0x39a839a8,0x3c000000,0x39a8b9a8,0x3c00,0x3a2f3913,0x3bd9b23e,0x378bbb0e
.long 0x3c00,0x3aa73872,0x3b64b61f,0x323ebbd9,0x3c00,0x3b0e378b,0x3aa7b872,0xae46bbf6
.long 0x3c00,0x3b64361f,0x39a8b9a8,0xb61fbb64,0x3c00,0x3ba834a5,0x3872baa7,0xb913ba2f
.long 0x3c00,0x3bd9323e,0x361fbb64,0xbaa7b872,0x3c00,0x3bf62e46,0x323ebbd9,0xbba8b4a5
.long 0x3c00,0x3c00,0x3c00,0x3c00,0x361f3b64,0x378b3b0e,0x38723aa7,0x39133a2f
.long 0x39a839a8,0x3aa73872,0x3b64361f,0x3bd9323e,0x3b64361f,0x3bf62e46,0x3bd9b23e,0x3b0eb78b
.long 0x3c000000,0x3b64b61f,0x39a8b9a8,0x361fbb64,0x3b64b61f,0x3913ba2f,0x323ebbd9,0xb4a5bba8
.long 0x39a8b9a8,0x323ebbd9,0xb61fbb64,0xbaa7b872,0x361fbb64,0xb4a5bba8,0xbaa7b872,0xbbf62e46
.long 0xbc00,0xb9a8b9a8,0xbc008000,0xb9a839a8,0xb61fbb64,0xbba8b4a5,0xbaa73872,0xae463bf6
.long 0xb9a8b9a8,0xbbd9323e,0xb61f3b64,0x38723aa7,0xbb64b61f,0xba2f3913,0x323e3bd9,0x3ba834a5
.long 0xbc008000,0xb61f3b64,0x39a839a8,0x3b64b61f,0xbb64361f,0x2e463bf6,0x3bd9323e,0x378bbb0e
.long 0xb9a839a8,0x38723aa7,0x3b64b61f,0xb23ebbd9,0xb61f3b64,0x3b0e378b,0x3872baa7,0xba2fb913
.long 0x3c00,0x3c00,0x3c00,0x3c00,0x39a839a8,0x3a2f3913,0x3aa73872,0x3b0e378b
.long 0x3c000000,0x3bd9b23e,0x3b64b61f,0x3aa7b872,0x39a8b9a8,0x378bbb0e,0x323ebbd9,0xae46bbf6
.long 0xbc00,0xb61fbb64,0xb9a8b9a8,0xbb64b61f,0xb9a8b9a8,0xbba8b4a5,0xbbd9323e,0xba2f3913
.long 0xbc008000,0xbaa73872,0xb61f3b64,0x323e3bd9,0xb9a839a8,0xae463bf6,0x38723aa7,0x3ba834a5
.long 0x3c00,0x39a839a8,0x3c000000,0x39a8b9a8,0x39a839a8,0x3bf6ae46,0x3872baa7,0xb4a5bba8
.long 0x3c000000,0x3872baa7,0xb61fbb64,0xbbd9b23e,0x39a8b9a8,0xb4a5bba8,0xbbd9b23e,0xb9133a2f
.long 0xbc00,0xbb64b61f,0xb9a839a8,0x361f3b64,0xb9a8b9a8,0xbb0e378b,0x323e3bd9,0x3bf62e46
.long 0xbc008000,0xb23e3bd9,0x3b64361f,0x3872baa7,0xb9a839a8,0x39133a2f,0x3aa7b872,0xb78bbb0e
.long 0x3c00,0x3c00,0x3c00,0x3c00,0x3b64361f,0x3ba834a5,0x3bd9323e,0x3bf62e46
.long 0x39a8b9a8,0x3872baa7,0x361fbb64,0x323ebbd9,0xb61fbb64,0xb913ba2f,0xbaa7b872,0xbba8b4a5
.long 0xbc008000,0xbb64361f,0xb9a839a8,0xb61f3b64,0xb61f3b64,0x2e463bf6,0x38723aa7,0x3b0e378b
.long 0x39a839a8,0x3bd9323e,0x3b64b61f,0x3872baa7,0x3b64b61f,0x378bbb0e,0xb23ebbd9,0xba2fb913
.long 0xbc00,0xb9a8b9a8,0xbc008000,0xb9a839a8,0xbb64b61f,0xbb0e378b,0xb23e3bd9,0x39133a2f
.long 0xb9a839a8,0x323e3bd9,0x3b64361f,0x3aa7b872,0x361f3b64,0x3bf62e46,0x3872baa7,0xb78bbb0e
.long 0x3c000000,0x361fbb64,0xb9a8b9a8,0xbb64361f,0x361fbb64,0xba2fb913,0xbaa73872,0x34a53ba8
.long 0xb9a8b9a8,0xbaa73872,0x361f3b64,0x3bd9b23e,0xbb64361f,0x34a53ba8,0x3bd9b23e,0xae46bbf6
.long 0x3c00,0x3c00,0x3c00,0x3c00,0x3c000000,0x3bf6ae46,0x3bd9b23e,0x3ba8b4a5
.long 0xbc00,0xb23ebbd9,0xb61fbb64,0xb872baa7,0xbc008000,0xbba834a5,0xbaa73872,0xb9133a2f
.long 0x3c00,0x361f3b64,0x39a839a8,0x3b64361f,0x3c000000,0x3b0eb78b,0x3872baa7,0x2e46bbf6
.long 0xbc00,0xb872baa7,0xbb64b61f,0xbbd9323e,0xbc008000,0xba2f3913,0xb23e3bd9,0x378b3b0e
.long 0x3c00,0x39a839a8,0x3c000000,0x39a8b9a8,0x3c000000,0x3913ba2f,0xb23ebbd9,0xbb0eb78b
.long 0xbc00,0xbaa7b872,0xbb64361f,0xb23e3bd9,0xbc008000,0xb78b3b0e,0x38723aa7,0x3bf6ae46
.long 0x3c00,0x3b64361f,0x39a8b9a8,0xb61fbb64,0x3c000000,0x34a5bba8,0xbaa7b872,0xba2f3913
.long 0xbc00,0xbbd9b23e,0xb61f3b64,0x3aa73872,0xbc008000,0xae463bf6,0x3bd9323e,0x34a5bba8
.long 0x3c00,0x3c00,0x3c00,0x3c00,0x3b64b61f,0x3b0eb78b,0x3aa7b872,0x3a2fb913
.long 0xb9a8b9a8,0xbaa7b872,0xbb64b61f,0xbbd9b23e,0xb61f3b64,0xae463bf6,0x323e3bd9,0x378b3b0e
.long 0x3c000000,0x3b64b61f,0x39a8b9a8,0x361fbb64,0xb61fbb64,0xba2fb913,0xbbd9b23e,0xbba834a5
.long 0xb9a839a8,0xb23e3bd9,0x361f3b64,0x3aa73872,0x3b64361f,0x3ba8b4a5,0x3872baa7,0xae46bbf6
.long 0xbc00,0xb9a8b9a8,0xbc008000,0xb9a839a8,0xbb64361f,0xb4a53ba8,0x38723aa7,0x3bf62e46
.long 0x39a839a8,0x3bd9b23e,0x361fbb64,0xb872baa7,0x361fbb64,0xb913ba2f,0xbbd9323e,0xb4a53ba8
.long 0xbc008000,0xb61f3b64,0x39a839a8,0x3b64b61f,0x361f3b64,0x3bf6ae46,0x323ebbd9,0xbb0eb78b
.long 0x39a8b9a8,0xb872baa7,0xbb64361f,0x323e3bd9,0xbb64b61f,0xb78b3b0e,0x3aa73872,0x3913ba2f
.long 0x3c00,0x3c00,0x3c00,0x3c00,0x39a8b9a8,0x3913ba2f,0x3872baa7,0x378bbb0e
.long 0xbc008000,0xbbd9323e,0xbb64361f,0xbaa73872,0x39a839a8,0x3b0e378b,0x3bd9323e,0x3bf6ae46
.long 0xbc00,0xb61fbb64,0xb9a8b9a8,0xbb64b61f,0xb9a839a8,0xb4a53ba8,0x323e3bd9,0x39133a2f
.long 0x3c000000,0x3aa7b872,0x361fbb64,0xb23ebbd9,0xb9a8b9a8,0xbbf6ae46,0xbaa73872,0xb4a53ba8
.long 0x3c00,0x39a839a8,0x3c000000,0x39a8b9a8,0x39a8b9a8,0xae46bbf6,0xbaa7b872,0xbba834a5
.long 0xbc008000,0xb8723aa7,0x361f3b64,0x3bd9323e,0x39a839a8,0x3ba8b4a5,0x323ebbd9,0xba2fb913
.long 0xbc00,0xbb64b61f,0xb9a839a8,0x361f3b64,0xb9a839a8,0x378b3b0e,0x3bd9b23e,0x2e46bbf6
.long 0x3c000000,0x323ebbd9,0xbb64b61f,0xb8723aa7,0xb9a8b9a8,0xba2f3913,0x38723aa7,0x3b0eb78b
.long 0x3c00,0x3c00,0x3c00,0x3c00,0x361fbb64,0x34a5bba8,0x323ebbd9,0x2e46bbf6
.long 0xb9a839a8,0xb8723aa7,0xb61f3b64,0xb23e3bd9,0x3b64b61f,0x3a2fb913,0x3872baa7,0x34a5bba8
.long 0xbc008000,0xbb64361f,0xb9a839a8,0xb61f3b64,0x3b64361f,0x3bf6ae46,0x3aa7b872,0x378bbb0e
.long 0xb9a8b9a8,0xbbd9b23e,0xbb64361f,0xb8723aa7,0x361f3b64,0x3b0e378b,0x3bd9b23e,0x3913ba2f
.long 0xbc00,0xb9a8b9a8,0xbc008000,0xb9a839a8,0xb61f3b64,0x378b3b0e,0x3bd9323e,0x3a2fb913
.long 0x39a8b9a8,0xb23ebbd9,0xbb64b61f,0xbaa73872,0xbb64361f,0xae463bf6,0x3aa73872,0x3b0eb78b
.long 0x3c000000,0x361fbb64,0xb9a8b9a8,0xbb64361f,0xbb64b61f,0xb9133a2f,0x38723aa7,0x3ba8b4a5
.long 0x39a839a8,0x3aa7b872,0xb61fbb64,0xbbd9323e,0xb61fbb64,0xbba834a5,0x323e3bd9,0x3bf6ae46
.long 0x3c00,0x3c00,0x3c00,0x3c00,0xbc00,0xae46bbf6,0xb23ebbd9,0xb4a5bba8
.long 0x3c00,0x323e3bd9,0x361f3b64,0x38723aa7,0xbc00,0xb4a5bba8,0xb872baa7,0xba2fb913
.long 0x3c00,0x361f3b64,0x39a839a8,0x3b64361f,0xbc00,0xb78bbb0e,0xbaa7b872,0xbbf6ae46
.long 0x3c00,0x38723aa7,0x3b64361f,0x3bd9b23e,0xbc00,0xb913ba2f,0xbbd9b23e,0xbb0e378b
.long 0x3c00,0x39a839a8,0x3c000000,0x39a8b9a8,0xbc00,0xba2fb913,0xbbd9323e,0xb78b3b0e
.long 0x3c00,0x3aa73872,0x3b64b61f,0x323ebbd9,0xbc00,0xbb0eb78b,0xbaa73872,0x2e463bf6
.long 0x3c00,0x3b64361f,0x39a8b9a8,0xb61fbb64,0xbc00,0xbba8b4a5,0xb8723aa7,0x39133a2f
.long 0x3c00,0x3bd9323e,0x361fbb64,0xbaa7b872,0xbc00,0xbbf6ae46,0xb23e3bd9,0x3ba834a5
.long 0x3c00,0x3c00,0x3c00,0x3c00,0xb61fbb64,0xb78bbb0e,0xb872baa7,0xb913ba2f
.long 0x39a839a8,0x3aa73872,0x3b64361f,0x3bd9323e,0xbb64b61f,0xbbf6ae46,0xbbd9323e,0xbb0e378b
.long 0x3c000000,0x3b64b61f,0x39a8b9a8,0x361fbb64,0xbb64361f,0xb9133a2f,0xb23e3bd9,0x34a53ba8
.long 0x39a8b9a8,0x323ebbd9,0xb61fbb64,0xbaa7b872,0xb61f3b64,0x34a53ba8,0x3aa73872,0x3bf6ae46
.long 0xbc00,0xb9a8b9a8,0xbc008000,0xb9a839a8,0x361f3b64,0x3ba834a5,0x3aa7b872,0x2e46bbf6
.long 0xb9a8b9a8,0xbbd9323e,0xb61f3b64,0x38723aa7,0x3b64361f,0x3a2fb913,0xb23ebbd9,0xbba8b4a5
.long 0xbc008000,0xb61f3b64,0x39a839a8,0x3b64b61f,0x3b64b61f,0xae46bbf6,0xbbd9b23e,0xb78b3b0e
.long 0xb9a839a8,0x38723aa7,0x3b64b61f,0xb23ebbd9,0x361fbb64,0xbb0eb78b,0xb8723aa7,0x3a2f3913
.long 0x3c00,0x3c00,0x3c00,0x3c00,0xb9a8b9a8,0xba2fb913,0xbaa7b872,0xbb0eb78b
.long 0x3c000000,0x3bd9b23e,0x3b64b61f,0x3aa7b872,0xb9a839a8,0xb78b3b0e,0xb23e3bd9,0x2e463bf6
.long 0xbc00,0xb61fbb64,0xb9a8b9a8,0xbb64b61f,0x39a839a8,0x3ba834a5,0x3bd9b23e,0x3a2fb913
.long 0xbc008000,0xbaa73872,0xb61f3b64,0x323e3bd9,0x39a8b9a8,0x2e46bbf6,0xb872baa7,0xbba8b4a5
.long 0x3c00,0x39a839a8,0x3c000000,0x39a8b9a8,0xb9a8b9a8,0xbbf62e46,0xb8723aa7,0x34a53ba8
.long 0x3c000000,0x3872baa7,0xb61fbb64,0xbbd9b23e,0xb9a839a8,0x34a53ba8,0x3bd9323e,0x3913ba2f
.long 0xbc00,0xbb64b61f,0xb9a839a8,0x361f3b64,0x39a839a8,0x3b0eb78b,0xb23ebbd9,0xbbf6ae46
.long 0xbc008000,0xb23e3bd9,0x3b64361f,0x3872baa7,0x39a8b9a8,0xb913ba2f,0xbaa73872,0x378b3b0e
.long 0x3c00,0x3c00,0x3c00,0x3c00,0xbb64b61f,0xbba8b4a5,0xbbd9b23e,0xbbf6ae46
.long 0x39a8b9a8,0x3872baa7,0x361fbb64,0x323ebbd9,0x361f3b64,0x39133a2f,0x3aa73872,0x3ba834a5
.long 0xbc008000,0xbb64361f,0xb9a839a8,0xb61f3b64,0x361fbb64,0xae46bbf6,0xb872baa7,0xbb0eb78b
.long 0x39a839a8,0x3bd9323e,0x3b64b61f,0x3872baa7,0xbb64361f,0xb78b3b0e,0x323e3bd9,0x3a2f3913
.long 0xbc00,0xb9a8b9a8,0xbc008000,0xb9a839a8,0x3b64361f,0x3b0eb78b,0x323ebbd9,0xb913ba2f
.long 0xb9a839a8,0x323e3bd9,0x3b64361f,0x3aa7b872,0xb61fbb64,0xbbf6ae46,0xb8723aa7,0x378b3b0e
.long 0x3c000000,0x361fbb64,0xb9a8b9a8,0xbb64361f,0xb61f3b64,0x3a2f3913,0x3aa7b872,0xb4a5bba8
.long 0xb9a8b9a8,0xbaa73872,0x361f3b64,0x3bd9b23e,0x3b64b61f,0xb4a5bba8,0xbbd9323e,0x2e463bf6
.long 0x3c00,0x3c00,0x3c00,0x3c00,0xbc008000,0xbbf62e46,0xbbd9323e,0xbba834a5
.long 0xbc00,0xb23ebbd9,0xb61fbb64,0xb872baa7,0x3c000000,0x3ba8b4a5,0x3aa7b872,0x3913ba2f
.long 0x3c00,0x361f3b64,0x39a839a8,0x3b64361f,0xbc008000,0xbb0e378b,0xb8723aa7,0xae463bf6
.long 0xbc00,0xb872baa7,0xbb64b61f,0xbbd9323e,0x3c000000,0x3a2fb913,0x323ebbd9,0xb78bbb0e
.long 0x3c00,0x39a839a8,0x3c000000,0x39a8b9a8,0xbc008000,0xb9133a2f,0x323e3bd9,0x3b0e378b
.long 0xbc00,0xbaa7b872,0xbb64361f,0xb23e3bd9,0x3c000000,0x378bbb0e,0xb872baa7,0xbbf62e46
.long 0x3c00,0x3b64361f,0x39a8b9a8,0xb61fbb64,0xbc008000,0xb4a53ba8,0x3aa73872,0x3a2fb913
.long 0xbc00,0xbbd9b23e,0xb61f3b64,0x3aa73872,0x3c000000,0x2e46bbf6,0xbbd9b23e,0xb4a53ba8
.long 0x3c00,0x3c00,0x3c00,0x3c00,0xbb64361f,0xbb0e378b,0xbaa73872,0xba2f3913
.long 0xb9a8b9a8,0xbaa7b872,0xbb64b61f,0xbbd9b23e,0x361fbb64,0x2e46bbf6,0xb23ebbd9,0xb78bbb0e
.long 0x3c000000,0x3b64b61f,0x39a8b9a8,0x361fbb64,0x361f3b64,0x3a2f3913,0x3bd9323e,0x3ba8b4a5
.long 0xb9a839a8,0xb23e3bd9,0x361f3b64,0x3aa73872,0xbb64b61f,0xbba834a5,0xb8723aa7,0x2e463bf6
.long 0xbc00,0xb9a8b9a8,0xbc008000,0xb9a839a8,0x3b64b61f,0x34a5bba8,0xb872baa7,0xbbf6ae46
.long 0x39a839a8,0x3bd9b23e,0x361fbb64,0xb872baa7,0xb61f3b64,0x39133a2f,0x3bd9b23e,0x34a5bba8
.long 0xbc008000,0xb61f3b64,0x39a839a8,0x3b64b61f,0xb61fbb64,0xbbf62e46,0xb23e3bd9,0x3b0e378b
.long 0x39a8b9a8,0xb872baa7,0xbb64361f,0x323e3bd9,0x3b64361f,0x378bbb0e,0xbaa7b872,0xb9133a2f
.long 0x3c00,0x3c00,0x3c00,0x3c00,0xb9a839a8,0xb9133a2f,0xb8723aa7,0xb78b3b0e
.long 0xbc008000,0xbbd9323e,0xbb64361f,0xbaa73872,0xb9a8b9a8,0xbb0eb78b,0xbbd9b23e,0xbbf62e46
.long 0xbc00,0xb61fbb64,0xb9a8b9a8,0xbb64b61f,0x39a8b9a8,0x34a5bba8,0xb23ebbd9,0xb913ba2f
.long 0x3c000000,0x3aa7b872,0x361fbb64,0xb23ebbd9,0x39a839a8,0x3bf62e46,0x3aa7b872,0x34a5bba8
.long 0x3c00,0x39a839a8,0x3c000000,0x39a8b9a8,0xb9a839a8,0x2e463bf6,0x3aa73872,0x3ba8b4a5
.long 0xbc008000,0xb8723aa7,0x361f3b64,0x3bd9323e,0xb9a8b9a8,0xbba834a5,0xb23e3bd9,0x3a2f3913
.long 0xbc00,0xbb64b61f,0xb9a839a8,0x361f3b64,0x39a8b9a8,0xb78bbb0e,0xbbd9323e,0xae463bf6
.long 0x3c000000,0x323ebbd9,0xbb64b61f,0xb8723aa7,0x39a839a8,0x3a2fb913,0xb872baa7,0xbb0e378b
.long 0x3c00,0x3c00,0x3c00,0x3c00,0xb61f3b64,0xb4a53ba8,0xb23e3bd9,0xae463bf6
.long 0xb9a839a8,0xb8723aa7,0xb61f3b64,0xb23e3bd9,0xbb64361f,0xba2f3913,0xb8723aa7,0xb4a53ba8
.long 0xbc008000,0xbb64361f,0xb9a839a8,0xb61f3b64,0xbb64b61f,0xbbf62e46,0xbaa73872,0xb78b3b0e
.long 0xb9a8b9a8,0xbbd9b23e,0xbb64361f,0xb8723aa7,0xb61fbb64,0xbb0eb78b,0xbbd9323e,0xb9133a2f
.long 0xbc00,0xb9a8b9a8,0xbc008000,0xb9a839a8,0x361fbb64,0xb78bbb0e,0xbbd9b23e,0xba2f3913
.long 0x39a8b9a8,0xb23ebbd9,0xbb64b61f,0xbaa73872,0x3b64b61f,0x2e46bbf6,0xbaa7b872,0xbb0e378b
.long 0x3c000000,0x361fbb64,0xb9a8b9a8,0xbb64361f,0x3b64361f,0x3913ba2f,0xb872baa7,0xbba834a5
.long 0x39a839a8,0x3aa7b872,0xb61fbb64,0xbbd9323e,0x361f3b64,0x3ba8b4a5,0xb23ebbd9,0xbbf62e46
.long 0x3c00,0x3c000000,0xbc00,0xbc008000,0x3c00,0x3bf6ae46,0xb23ebbd9,0xbba834a5
.long 0x3c00,0x3bd9b23e,0xb61fbb64,0xbaa73872,0x3c00,0x3ba8b4a5,0xb872baa7,0xb9133a2f
.long 0x3c00,0x3b64b61f,0xb9a8b9a8,0xb61f3b64,0x3c00,0x3b0eb78b,0xbaa7b872,0xae463bf6
.long 0x3c00,0x3aa7b872,0xbb64b61f,0x323e3bd9,0x3c00,0x3a2fb913,0xbbd9b23e,0x378b3b0e
.long 0x3c00,0x39a8b9a8,0xbc008000,0x39a839a8,0x3c00,0x3913ba2f,0xbbd9323e,0x3b0e378b
.long 0x3c00,0x3872baa7,0xbb64361f,0x3bd9323e,0x3c00,0x378bbb0e,0xbaa73872,0x3bf6ae46
.long 0x3c00,0x361fbb64,0xb9a839a8,0x3b64b61f,0x3c00,0x34a5bba8,0xb8723aa7,0x3a2fb913
.long 0x3c00,0x323ebbd9,0xb61f3b64,0x3872baa7,0x3c00,0x2e46bbf6,0xb23e3bd9,0x34a5bba8
.long 0x3c00,0x3c000000,0xbc00,0xbc008000,0x361f3b64,0x3b0eb78b,0xb872baa7,0xba2f3913
.long 0x39a839a8,0x3872baa7,0xbb64b61f,0xb23e3bd9,0x3b64361f,0x2e46bbf6,0xbbd9323e,0x378b3b0e
.long 0x3c000000,0xb61fbb64,0xb9a839a8,0x3b64361f,0x3b64b61f,0xba2fb913,0xb23e3bd9,0x3ba8b4a5
.long 0x39a8b9a8,0xbbd9b23e,0x361f3b64,0x3872baa7,0x361fbb64,0xbba834a5,0x3aa73872,0xae46bbf6
.long 0xbc00,0xb9a839a8,0x3c000000,0xb9a8b9a8,0xb61fbb64,0xb4a53ba8,0x3aa7b872,0xbbf6ae46
.long 0xb9a8b9a8,0x323e3bd9,0x361fbb64,0xbaa73872,0xbb64b61f,0x39133a2f,0xb23ebbd9,0xb4a53ba8
.long 0xbc008000,0x3b64361f,0xb9a8b9a8,0x361f3b64,0xbb64361f,0x3bf6ae46,0xbbd9b23e,0x3b0e378b
.long 0xb9a839a8,0x3aa7b872,0xbb64361f,0x3bd9b23e,0xb61f3b64,0x378bbb0e,0xb8723aa7,0x3913ba2f
.long 0x3c00,0x3c000000,0xbc00,0xbc008000,0x39a839a8,0x3913ba2f,0xbaa7b872,0xb78b3b0e
.long 0x3c000000,0xb23ebbd9,0xbb64361f,0x38723aa7,0x39a8b9a8,0xbb0eb78b,0xb23e3bd9,0x3bf6ae46
.long 0xbc00,0xbb64361f,0x39a839a8,0x361fbb64,0xb9a8b9a8,0xb4a53ba8,0x3bd9b23e,0xb913ba2f
.long 0xbc008000,0x38723aa7,0x361fbb64,0xbbd9323e,0xb9a839a8,0x3bf62e46,0xb872baa7,0xb4a53ba8
.long 0x3c00,0x39a8b9a8,0xbc008000,0x39a839a8,0x39a839a8,0xae46bbf6,0xb8723aa7,0x3ba8b4a5
.long 0x3c000000,0xbaa7b872,0x361f3b64,0x323ebbd9,0x39a8b9a8,0xbba834a5,0x3bd9323e,0xba2fb913
.long 0xbc00,0xb61f3b64,0x39a8b9a8,0xbb64361f,0xb9a8b9a8,0x378b3b0e,0xb23ebbd9,0xae463bf6
.long 0xbc008000,0x3bd9323e,0xbb64b61f,0x3aa73872,0xb9a839a8,0x3a2fb913,0xbaa73872,0x3b0eb78b
.long 0x3c00,0x3c000000,0xbc00,0xbc008000,0x3b64361f,0x34a5bba8,0xbbd9b23e,0xae463bf6
.long 0x39a8b9a8,0xbaa7b872,0xb61f3b64,0x3bd9323e,0xb61fbb64,0xba2f3913,0x3aa73872,0x34a5bba8
.long 0xbc008000,0x361f3b64,0x39a8b9a8,0xbb64b61f,0xb61f3b64,0x3bf6ae46,0xb872baa7,0xb78b3b0e
.long 0x39a839a8,0x323ebbd9,0xbb64361f,0x3aa73872,0x3b64b61f,0xbb0eb78b,0x323e3bd9,0x3913ba2f
.long 0xbc00,0xb9a839a8,0x3c000000,0xb9a8b9a8,0xbb64b61f,0x378b3b0e,0x323ebbd9,0xba2f3913
.long 0xb9a839a8,0x3bd9b23e,0xbb64b61f,0x38723aa7,0x361f3b64,0x2e46bbf6,0xb8723aa7,0x3b0eb78b
.long 0x3c000000,0xbb64b61f,0x39a839a8,0xb61fbb64,0x361fbb64,0xb9133a2f,0x3aa7b872,0xbba834a5
.long 0xb9a8b9a8,0x38723aa7,0xb61fbb64,0x323e3bd9,0xbb64361f,0x3ba8b4a5,0xbbd9323e,0x3bf6ae46
.long 0x3c00,0x3c000000,0xbc00,0xbc008000,0x3c000000,0xae46bbf6,0xbbd9323e,0x34a53ba8
.long 0xbc00,0xbbd9323e,0x361f3b64,0x3aa7b872,0xbc008000,0x34a53ba8,0x3aa7b872,0xba2fb913
.long 0x3c00,0x3b64b61f,0xb9a8b9a8,0xb61f3b64,0x3c000000,0xb78bbb0e,0xb8723aa7,0x3bf62e46
.long 0xbc00,0xbaa73872,0x3b64361f,0xb23ebbd9,0xbc008000,0x39133a2f,0x323ebbd9,0xbb0e378b
.long 0x3c00,0x39a8b9a8,0xbc008000,0x39a839a8,0x3c000000,0xba2fb913,0x323e3bd9,0x378bbb0e
.long 0xbc00,0xb8723aa7,0x3b64b61f,0xbbd9b23e,0xbc008000,0x3b0e378b,0xb872baa7,0x2e463bf6
.long 0x3c00,0x361fbb64,0xb9a839a8,0x3b64b61f,0x3c000000,0xbba8b4a5,0x3aa73872,0xb913ba2f
.long 0xbc00,0xb23e3bd9,0x361fbb64,0xb8723aa7,0xbc008000,0x3bf62e46,0xbbd9b23e,0x3ba834a5
.long 0x3c00,0x3c000000,0xbc00,0xbc008000,0x3b64b61f,0xb78bbb0e,0xbaa73872,0x39133a2f
.long 0xb9a8b9a8,0xb8723aa7,0x3b64361f,0x323ebbd9,0xb61f3b64,0x3bf62e46,0xb23ebbd9,0xbb0e378b
.long 0x3c000000,0xb61fbb64,0xb9a839a8,0x3b64361f,0xb61fbb64,0xb9133a2f,0x3bd9323e,0xb4a5bba8
.long 0xb9a839a8,0x3bd9323e,0xb61fbb64,0xb8723aa7,0x3b64361f,0xb4a5bba8,0xb8723aa7,0x3bf6ae46
.long 0xbc00,0xb9a839a8,0x3c000000,0xb9a8b9a8,0xbb64361f,0x3ba834a5,0xb872baa7,0xae463bf6
.long 0x39a839a8,0xb23ebbd9,0xb61f3b64,0x3aa7b872,0x361fbb64,0xba2f3913,0x3bd9b23e,0xbba8b4a5
.long 0xbc008000,0x3b64361f,0xb9a8b9a8,0x361f3b64,0x361f3b64,0xae46bbf6,0xb23e3bd9,0x378bbb0e
.long 0x39a8b9a8,0xbaa73872,0x3b64b61f,0xbbd9323e,0xbb64b61f,0x3b0e378b,0xbaa7b872,0x3a2f3913
.long 0x3c00,0x3c000000,0xbc00,0xbc008000,0x39a8b9a8,0xba2fb913,0xb8723aa7,0x3b0e378b
.long 0xbc008000,0x323e3bd9,0x3b64b61f,0xb872baa7,0x39a839a8,0x378bbb0e,0xbbd9b23e,0x2e463bf6
.long 0xbc00,0xbb64361f,0x39a839a8,0x361fbb64,0xb9a839a8,0x3ba834a5,0xb23ebbd9,0xba2f3913
.long 0x3c000000,0xb872baa7,0xb61f3b64,0x3bd9b23e,0xb9a8b9a8,0xae463bf6,0x3aa7b872,0xbba8b4a5
.long 0x3c00,0x39a8b9a8,0xbc008000,0x39a839a8,0x39a8b9a8,0xbbf62e46,0x3aa73872,0xb4a5bba8
.long 0xbc008000,0x3aa73872,0xb61fbb64,0xb23e3bd9,0x39a839a8,0xb4a5bba8,0xb23e3bd9,0x3913ba2f
.long 0xbc00,0xb61f3b64,0x39a8b9a8,0xbb64361f,0xb9a839a8,0x3b0eb78b,0xbbd9323e,0x3bf62e46
.long 0x3c000000,0xbbd9b23e,0x3b64361f,0xbaa7b872,0xb9a8b9a8,0x39133a2f,0xb872baa7,0x378b3b0e
.long 0x3c00,0x3c000000,0xbc00,0xbc008000,0x361fbb64,0xbba8b4a5,0xb23e3bd9,0x3bf62e46
.long 0xb9a839a8,0x3aa73872,0x361fbb64,0xbbd9b23e,0x3b64b61f,0xb913ba2f,0xb8723aa7,0x3ba834a5
.long 0xbc008000,0x361f3b64,0x39a8b9a8,0xbb64b61f,0x3b64361f,0xae46bbf6,0xbaa73872,0x3b0e378b
.long 0xb9a8b9a8,0xb23e3bd9,0x3b64b61f,0xbaa7b872,0x361f3b64,0x378bbb0e,0xbbd9323e,0x3a2f3913
.long 0xbc00,0xb9a839a8,0x3c000000,0xb9a8b9a8,0xb61f3b64,0x3b0eb78b,0xbbd9b23e,0x39133a2f
.long 0x39a8b9a8,0xbbd9323e,0x3b64361f,0xb872baa7,0xbb64361f,0x3bf62e46,0xbaa7b872,0x378b3b0e
.long 0x3c000000,0xbb64b61f,0x39a839a8,0xb61fbb64,0xbb64b61f,0x3a2f3913,0xb872baa7,0x34a53ba8
.long 0x39a839a8,0xb872baa7,0x361f3b64,0xb23ebbd9,0xb61fbb64,0x34a53ba8,0xb23ebbd9,0x2e463bf6
.long 0x3c00,0x3c000000,0xbc00,0xbc008000,0xbc00,0xbbf62e46,0x323e3bd9,0x3ba8b4a5
.long 0x3c00,0x3bd9b23e,0xb61fbb64,0xbaa73872,0xbc00,0xbba834a5,0x38723aa7,0x3913ba2f
.long 0x3c00,0x3b64b61f,0xb9a8b9a8,0xb61f3b64,0xbc00,0xbb0e378b,0x3aa73872,0x2e46bbf6
.long 0x3c00,0x3aa7b872,0xbb64b61f,0x323e3bd9,0xbc00,0xba2f3913,0x3bd9323e,0xb78bbb0e
.long 0x3c00,0x39a8b9a8,0xbc008000,0x39a839a8,0xbc00,0xb9133a2f,0x3bd9b23e,0xbb0eb78b
.long 0x3c00,0x3872baa7,0xbb64361f,0x3bd9323e,0xbc00,0xb78b3b0e,0x3aa7b872,0xbbf62e46
.long 0x3c00,0x361fbb64,0xb9a839a8,0x3b64b61f,0xbc00,0xb4a53ba8,0x3872baa7,0xba2f3913
.long 0x3c00,0x323ebbd9,0xb61f3b64,0x3872baa7,0xbc00,0xae463bf6,0x323ebbd9,0xb4a53ba8
.long 0x3c00,0x3c000000,0xbc00,0xbc008000,0xb61fbb64,0xbb0e378b,0x38723aa7,0x3a2fb913
.long 0x39a839a8,0x3872baa7,0xbb64b61f,0xb23e3bd9,0xbb64b61f,0xae463bf6,0x3bd9b23e,0xb78bbb0e
.long 0x3c000000,0xb61fbb64,0xb9a839a8,0x3b64361f,0xbb64361f,0x3a2f3913,0x323ebbd9,0xbba834a5
.long 0x39a8b9a8,0xbbd9b23e,0x361f3b64,0x3872baa7,0xb61f3b64,0x3ba8b4a5,0xbaa7b872,0x2e463bf6
.long 0xbc00,0xb9a839a8,0x3c000000,0xb9a8b9a8,0x361f3b64,0x34a5bba8,0xbaa73872,0x3bf62e46
.long 0xb9a8b9a8,0x323e3bd9,0x361fbb64,0xbaa73872,0x3b64361f,0xb913ba2f,0x323e3bd9,0x34a5bba8
.long 0xbc008000,0x3b64361f,0xb9a8b9a8,0x361f3b64,0x3b64b61f,0xbbf62e46,0x3bd9323e,0xbb0eb78b
.long 0xb9a839a8,0x3aa7b872,0xbb64361f,0x3bd9b23e,0x361fbb64,0xb78b3b0e,0x3872baa7,0xb9133a2f
.long 0x3c00,0x3c000000,0xbc00,0xbc008000,0xb9a8b9a8,0xb9133a2f,0x3aa73872,0x378bbb0e
.long 0x3c000000,0xb23ebbd9,0xbb64361f,0x38723aa7,0xb9a839a8,0x3b0e378b,0x323ebbd9,0xbbf62e46
.long 0xbc00,0xbb64361f,0x39a839a8,0x361fbb64,0x39a839a8,0x34a5bba8,0xbbd9323e,0x39133a2f
.long 0xbc008000,0x38723aa7,0x361fbb64,0xbbd9323e,0x39a8b9a8,0xbbf6ae46,0x38723aa7,0x34a5bba8
.long 0x3c00,0x39a8b9a8,0xbc008000,0x39a839a8,0xb9a8b9a8,0x2e463bf6,0x3872baa7,0xbba834a5
.long 0x3c000000,0xbaa7b872,0x361f3b64,0x323ebbd9,0xb9a839a8,0x3ba8b4a5,0xbbd9b23e,0x3a2f3913
.long 0xbc00,0xb61f3b64,0x39a8b9a8,0xbb64361f,0x39a839a8,0xb78bbb0e,0x323e3bd9,0x2e46bbf6
.long 0xbc008000,0x3bd9323e,0xbb64b61f,0x3aa73872,0x39a8b9a8,0xba2f3913,0x3aa7b872,0xbb0e378b
.long 0x3c00,0x3c000000,0xbc00,0xbc008000,0xbb64b61f,0xb4a53ba8,0x3bd9323e,0x2e46bbf6
.long 0x39a8b9a8,0xbaa7b872,0xb61f3b64,0x3bd9323e,0x361f3b64,0x3a2fb913,0xbaa7b872,0xb4a53ba8
.long 0xbc008000,0x361f3b64,0x39a8b9a8,0xbb64b61f,0x361fbb64,0xbbf62e46,0x38723aa7,0x378bbb0e
.long 0x39a839a8,0x323ebbd9,0xbb64361f,0x3aa73872,0xbb64361f,0x3b0e378b,0xb23ebbd9,0xb9133a2f
.long 0xbc00,0xb9a839a8,0x3c000000,0xb9a8b9a8,0x3b64361f,0xb78bbb0e,0xb23e3bd9,0x3a2fb913
.long 0xb9a839a8,0x3bd9b23e,0xbb64b61f,0x38723aa7,0xb61fbb64,0xae463bf6,0x3872baa7,0xbb0e378b
.long 0x3c000000,0xbb64b61f,0x39a839a8,0xb61fbb64,0xb61f3b64,0x3913ba2f,0xbaa73872,0x3ba8b4a5
.long 0xb9a8b9a8,0x38723aa7,0xb61fbb64,0x323e3bd9,0x3b64b61f,0xbba834a5,0x3bd9b23e,0xbbf62e46
.long 0x3c00,0x3c000000,0xbc00,0xbc008000,0xbc008000,0x2e463bf6,0x3bd9b23e,0xb4a5bba8
.long 0xbc00,0xbbd9323e,0x361f3b64,0x3aa7b872,0x3c000000,0xb4a5bba8,0xbaa73872,0x3a2f3913
.long 0x3c00,0x3b64b61f,0xb9a8b9a8,0xb61f3b64,0xbc008000,0x378b3b0e,0x3872baa7,0xbbf6ae46
.long 0xbc00,0xbaa73872,0x3b64361f,0xb23ebbd9,0x3c000000,0xb913ba2f,0xb23e3bd9,0x3b0eb78b
.long 0x3c00,0x39a8b9a8,0xbc008000,0x39a839a8,0xbc008000,0x3a2f3913,0xb23ebbd9,0xb78b3b0e
.long 0xbc00,0xb8723aa7,0x3b64b61f,0xbbd9b23e,0x3c000000,0xbb0eb78b,0x38723aa7,0xae46bbf6
.long 0x3c00,0x361fbb64,0xb9a839a8,0x3b64b61f,0xbc008000,0x3ba834a5,0xbaa7b872,0x39133a2f
.long 0xbc00,0xb23e3bd9,0x361fbb64,0xb8723aa7,0x3c000000,0xbbf6ae46,0x3bd9323e,0xbba8b4a5
.long 0x3c00,0x3c000000,0xbc00,0xbc008000,0xbb64361f,0x378b3b0e,0x3aa7b872,0xb913ba2f
.long 0xb9a8b9a8,0xb8723aa7,0x3b64361f,0x323ebbd9,0x361fbb64,0xbbf6ae46,0x323e3bd9,0x3b0eb78b
.long 0x3c000000,0xb61fbb64,0xb9a839a8,0x3b64361f,0x361f3b64,0x3913ba2f,0xbbd9b23e,0x34a53ba8
.long 0xb9a839a8,0x3bd9323e,0xb61fbb64,0xb8723aa7,0xbb64b61f,0x34a53ba8,0x3872baa7,0xbbf62e46
.long 0xbc00,0xb9a839a8,0x3c000000,0xb9a8b9a8,0x3b64b61f,0xbba8b4a5,0x38723aa7,0x2e46bbf6
.long 0x39a839a8,0xb23ebbd9,0xb61f3b64,0x3aa7b872,0xb61f3b64,0x3a2fb913,0xbbd9323e,0x3ba834a5
.long 0xbc008000,0x3b64361f,0xb9a8b9a8,0x361f3b64,0xb61fbb64,0x2e463bf6,0x323ebbd9,0xb78b3b0e
.long 0x39a8b9a8,0xbaa73872,0x3b64b61f,0xbbd9323e,0x3b64361f,0xbb0eb78b,0x3aa73872,0xba2fb913
.long 0x3c00,0x3c000000,0xbc00,0xbc008000,0xb9a839a8,0x3a2f3913,0x3872baa7,0xbb0eb78b
.long 0xbc008000,0x323e3bd9,0x3b64b61f,0xb872baa7,0xb9a8b9a8,0xb78b3b0e,0x3bd9323e,0xae46bbf6
.long 0xbc00,0xbb64361f,0x39a839a8,0x361fbb64,0x39a8b9a8,0xbba8b4a5,0x323e3bd9,0x3a2fb913
.long 0x3c000000,0xb872baa7,0xb61f3b64,0x3bd9b23e,0x39a839a8,0x2e46bbf6,0xbaa73872,0x3ba834a5
.long 0x3c00,0x39a8b9a8,0xbc008000,0x39a839a8,0xb9a839a8,0x3bf6ae46,0xbaa7b872,0x34a53ba8
.long 0xbc008000,0x3aa73872,0xb61fbb64,0xb23e3bd9,0xb9a8b9a8,0x34a53ba8,0x323ebbd9,0xb9133a2f
.long 0xbc00,0xb61f3b64,0x39a8b9a8,0xbb64361f,0x39a8b9a8,0xbb0e378b,0x3bd9b23e,0xbbf6ae46
.long 0x3c000000,0xbbd9b23e,0x3b64361f,0xbaa7b872,0x39a839a8,0xb913ba2f,0x38723aa7,0xb78bbb0e
.long 0x3c00,0x3c000000,0xbc00,0xbc008000,0xb61f3b64,0x3ba834a5,0x323ebbd9,0xbbf6ae46
.long 0xb9a839a8,0x3aa73872,0x361fbb64,0xbbd9b23e,0xbb64361f,0x39133a2f,0x3872baa7,0xbba8b4a5
.long 0xbc008000,0x361f3b64,0x39a8b9a8,0xbb64b61f,0xbb64b61f,0x2e463bf6,0x3aa7b872,0xbb0eb78b
.long 0xb9a8b9a8,0xb23e3bd9,0x3b64b61f,0xbaa7b872,0xb61fbb64,0xb78b3b0e,0x3bd9b23e,0xba2fb913
.long 0xbc00,0xb9a839a8,0x3c000000,0xb9a8b9a8,0x361fbb64,0xbb0e378b,0x3bd9323e,0xb913ba2f
.long 0x39a8b9a8,0xbbd9323e,0x3b64361f,0xb872baa7,0x3b64b61f,0xbbf6ae46,0x3aa73872,0xb78bbb0e
.long 0x3c000000,0xbb64b61f,0x39a839a8,0xb61fbb64,0x3b64361f,0xba2fb913,0x38723aa7,0xb4a5bba8
.long 0x39a839a8,0xb872baa7,0x361f3b64,0xb23ebbd9,0x361f3b64,0xb4a5bba8,0x323e3bd9,0xae46bbf6
.long 0x3c00,0xbc00,0x3c00,0xbc00,0x3c00,0xae46bbf6,0x323e3bd9,0xb4a5bba8
.long 0x3c00,0xb23ebbd9,0x361f3b64,0xb872baa7,0x3c00,0xb4a5bba8,0x38723aa7,0xba2fb913
.long 0x3c00,0xb61fbb64,0x39a839a8,0xbb64b61f,0x3c00,0xb78bbb0e,0x3aa73872,0xbbf6ae46
.long 0x3c00,0xb872baa7,0x3b64361f,0xbbd9323e,0x3c00,0xb913ba2f,0x3bd9323e,0xbb0e378b
.long 0x3c00,0xb9a8b9a8,0x3c000000,0xb9a839a8,0x3c00,0xba2fb913,0x3bd9b23e,0xb78b3b0e
.long 0x3c00,0xbaa7b872,0x3b64b61f,0xb23e3bd9,0x3c00,0xbb0eb78b,0x3aa7b872,0x2e463bf6
.long 0x3c00,0xbb64b61f,0x39a8b9a8,0x361f3b64,0x3c00,0xbba8b4a5,0x3872baa7,0x39133a2f
.long 0x3c00,0xbbd9b23e,0x361fbb64,0x3aa73872,0x3c00,0xbbf6ae46,0x323ebbd9,0x3ba834a5
.long 0x3c00,0xbc00,0x3c00,0xbc00,0x361f3b64,0xb78bbb0e,0x38723aa7,0xb913ba2f
.long 0x39a839a8,0xbaa7b872,0x3b64361f,0xbbd9b23e,0x3b64361f,0xbbf6ae46,0x3bd9b23e,0xbb0e378b
.long 0x3c000000,0xbb64361f,0x39a8b9a8,0xb61f3b64,0x3b64b61f,0xb9133a2f,0x323ebbd9,0x34a53ba8
.long 0x39a8b9a8,0xb23e3bd9,0xb61fbb64,0x3aa73872,0x361fbb64,0x34a53ba8,0xbaa7b872,0x3bf6ae46
.long 0xbc00,0x39a839a8,0xbc008000,0x39a8b9a8,0xb61fbb64,0x3ba834a5,0xbaa73872,0x2e46bbf6
.long 0xb9a8b9a8,0x3bd9b23e,0xb61f3b64,0xb872baa7,0xbb64b61f,0x3a2fb913,0x323e3bd9,0xbba8b4a5
.long 0xbc008000,0x361fbb64,0x39a839a8,0xbb64361f,0xbb64361f,0xae46bbf6,0x3bd9323e,0xb78b3b0e
.long 0xb9a839a8,0xb872baa7,0x3b64b61f,0x323e3bd9,0xb61f3b64,0xbb0eb78b,0x3872baa7,0x3a2f3913
.long 0x3c00,0xbc00,0x3c00,0xbc00,0x39a839a8,0xba2fb913,0x3aa73872,0xbb0eb78b
.long 0x3c000000,0xbbd9323e,0x3b64b61f,0xbaa73872,0x39a8b9a8,0xb78b3b0e,0x323ebbd9,0x2e463bf6
.long 0xbc00,0x361f3b64,0xb9a8b9a8,0x3b64361f,0xb9a8b9a8,0x3ba834a5,0xbbd9323e,0x3a2fb913
.long 0xbc008000,0x3aa7b872,0xb61f3b64,0xb23ebbd9,0xb9a839a8,0x2e46bbf6,0x38723aa7,0xbba8b4a5
.long 0x3c00,0xb9a8b9a8,0x3c000000,0xb9a839a8,0x39a839a8,0xbbf62e46,0x3872baa7,0x34a53ba8
.long 0x3c000000,0xb8723aa7,0xb61fbb64,0x3bd9323e,0x39a8b9a8,0x34a53ba8,0xbbd9b23e,0x3913ba2f
.long 0xbc00,0x3b64361f,0xb9a839a8,0xb61fbb64,0xb9a8b9a8,0x3b0eb78b,0x323e3bd9,0xbbf6ae46
.long 0xbc008000,0x323ebbd9,0x3b64361f,0xb8723aa7,0xb9a839a8,0xb913ba2f,0x3aa7b872,0x378b3b0e
.long 0x3c00,0xbc00,0x3c00,0xbc00,0x3b64361f,0xbba8b4a5,0x3bd9323e,0xbbf6ae46
.long 0x39a8b9a8,0xb8723aa7,0x361fbb64,0xb23e3bd9,0xb61fbb64,0x39133a2f,0xbaa7b872,0x3ba834a5
.long 0xbc008000,0x3b64b61f,0xb9a839a8,0x361fbb64,0xb61f3b64,0xae46bbf6,0x38723aa7,0xbb0eb78b
.long 0x39a839a8,0xbbd9b23e,0x3b64b61f,0xb8723aa7,0x3b64b61f,0xb78b3b0e,0xb23ebbd9,0x3a2f3913
.long 0xbc00,0x39a839a8,0xbc008000,0x39a8b9a8,0xbb64b61f,0x3b0eb78b,0xb23e3bd9,0xb913ba2f
.long 0xb9a839a8,0xb23ebbd9,0x3b64361f,0xbaa73872,0x361f3b64,0xbbf6ae46,0x3872baa7,0x378b3b0e
.long 0x3c000000,0xb61f3b64,0xb9a8b9a8,0x3b64b61f,0x361fbb64,0x3a2f3913,0xbaa73872,0xb4a5bba8
.long 0xb9a8b9a8,0x3aa7b872,0x361f3b64,0xbbd9323e,0xbb64361f,0xb4a5bba8,0x3bd9b23e,0x2e463bf6
.long 0x3c00,0xbc00,0x3c00,0xbc00,0x3c000000,0xbbf62e46,0x3bd9b23e,0xbba834a5
.long 0xbc00,0x323e3bd9,0xb61fbb64,0x38723aa7,0xbc008000,0x3ba8b4a5,0xbaa73872,0x3913ba2f
.long 0x3c00,0xb61fbb64,0x39a839a8,0xbb64b61f,0x3c000000,0xbb0e378b,0x3872baa7,0xae463bf6
.long 0xbc00,0x38723aa7,0xbb64b61f,0x3bd9b23e,0xbc008000,0x3a2fb913,0xb23e3bd9,0xb78bbb0e
.long 0x3c00,0xb9a8b9a8,0x3c000000,0xb9a839a8,0x3c000000,0xb9133a2f,0xb23ebbd9,0x3b0e378b
.long 0xbc00,0x3aa73872,0xbb64361f,0x323ebbd9,0xbc008000,0x378bbb0e,0x38723aa7,0xbbf62e46
.long 0x3c00,0xbb64b61f,0x39a8b9a8,0x361f3b64,0x3c000000,0xb4a53ba8,0xbaa7b872,0x3a2fb913
.long 0xbc00,0x3bd9323e,0xb61f3b64,0xbaa7b872,0xbc008000,0x2e46bbf6,0x3bd9323e,0xb4a53ba8
.long 0x3c00,0xbc00,0x3c00,0xbc00,0x3b64b61f,0xbb0e378b,0x3aa7b872,0xba2f3913
.long 0xb9a8b9a8,0x3aa73872,0xbb64b61f,0x3bd9323e,0xb61f3b64,0x2e46bbf6,0x323e3bd9,0xb78bbb0e
.long 0x3c000000,0xbb64361f,0x39a8b9a8,0xb61f3b64,0xb61fbb64,0x3a2f3913,0xbbd9b23e,0x3ba8b4a5
.long 0xb9a839a8,0x323ebbd9,0x361f3b64,0xbaa7b872,0x3b64361f,0xbba834a5,0x3872baa7,0x2e463bf6
.long 0xbc00,0x39a839a8,0xbc008000,0x39a8b9a8,0xbb64361f,0x34a5bba8,0x38723aa7,0xbbf6ae46
.long 0x39a839a8,0xbbd9323e,0x361fbb64,0x38723aa7,0x361fbb64,0x39133a2f,0xbbd9323e,0x34a5bba8
.long 0xbc008000,0x361fbb64,0x39a839a8,0xbb64361f,0x361f3b64,0xbbf62e46,0x323ebbd9,0x3b0e378b
.long 0x39a8b9a8,0x38723aa7,0xbb64361f,0xb23ebbd9,0xbb64b61f,0x378bbb0e,0x3aa73872,0xb9133a2f
.long 0x3c00,0xbc00,0x3c00,0xbc00,0x39a8b9a8,0xb9133a2f,0x3872baa7,0xb78b3b0e
.long 0xbc008000,0x3bd9b23e,0xbb64361f,0x3aa7b872,0x39a839a8,0xbb0eb78b,0x3bd9323e,0xbbf62e46
.long 0xbc00,0x361f3b64,0xb9a8b9a8,0x3b64361f,0xb9a839a8,0x34a5bba8,0x323e3bd9,0xb913ba2f
.long 0x3c000000,0xbaa73872,0x361fbb64,0x323e3bd9,0xb9a8b9a8,0x3bf62e46,0xbaa73872,0x34a5bba8
.long 0x3c00,0xb9a8b9a8,0x3c000000,0xb9a839a8,0x39a8b9a8,0x2e463bf6,0xbaa7b872,0x3ba8b4a5
.long 0xbc008000,0x3872baa7,0x361f3b64,0xbbd9b23e,0x39a839a8,0xbba834a5,0x323ebbd9,0x3a2f3913
.long 0xbc00,0x3b64361f,0xb9a839a8,0xb61fbb64,0xb9a839a8,0xb78bbb0e,0x3bd9b23e,0xae463bf6
.long 0x3c000000,0xb23e3bd9,0xbb64b61f,0x3872baa7,0xb9a8b9a8,0x3a2fb913,0x38723aa7,0xbb0e378b
.long 0x3c00,0xbc00,0x3c00,0xbc00,0x361fbb64,0xb4a53ba8,0x323ebbd9,0xae463bf6
.long 0xb9a839a8,0x3872baa7,0xb61f3b64,0x323ebbd9,0x3b64b61f,0xba2f3913,0x3872baa7,0xb4a53ba8
.long 0xbc008000,0x3b64b61f,0xb9a839a8,0x361fbb64,0x3b64361f,0xbbf62e46,0x3aa7b872,0xb78b3b0e
.long 0xb9a8b9a8,0x3bd9323e,0xbb64361f,0x3872baa7,0x361f3b64,0xbb0eb78b,0x3bd9b23e,0xb9133a2f
.long 0xbc00,0x39a839a8,0xbc008000,0x39a8b9a8,0xb61f3b64,0xb78bbb0e,0x3bd9323e,0xba2f3913
.long 0x39a8b9a8,0x323e3bd9,0xbb64b61f,0x3aa7b872,0xbb64361f,0x2e46bbf6,0x3aa73872,0xbb0e378b
.long 0x3c000000,0xb61f3b64,0xb9a8b9a8,0x3b64b61f,0xbb64b61f,0x3913ba2f,0x38723aa7,0xbba834a5
.long 0x39a839a8,0xbaa73872,0xb61fbb64,0x3bd9b23e,0xb61fbb64,0x3ba8b4a5,0x323e3bd9,0xbbf62e46
.long 0x3c00,0xbc00,0x3c00,0xbc00,0xbc00,0x2e463bf6,0xb23ebbd9,0x34a53ba8
.long 0x3c00,0xb23ebbd9,0x361f3b64,0xb872baa7,0xbc00,0x34a53ba8,0xb872baa7,0x3a2f3913
.long 0x3c00,0xb61fbb64,0x39a839a8,0xbb64b61f,0xbc00,0x378b3b0e,0xbaa7b872,0x3bf62e46
.long 0x3c00,0xb872baa7,0x3b64361f,0xbbd9323e,0xbc00,0x39133a2f,0xbbd9b23e,0x3b0eb78b
.long 0x3c00,0xb9a8b9a8,0x3c000000,0xb9a839a8,0xbc00,0x3a2f3913,0xbbd9323e,0x378bbb0e
.long 0x3c00,0xbaa7b872,0x3b64b61f,0xb23e3bd9,0xbc00,0x3b0e378b,0xbaa73872,0xae46bbf6
.long 0x3c00,0xbb64b61f,0x39a8b9a8,0x361f3b64,0xbc00,0x3ba834a5,0xb8723aa7,0xb913ba2f
.long 0x3c00,0xbbd9b23e,0x361fbb64,0x3aa73872,0xbc00,0x3bf62e46,0xb23e3bd9,0xbba8b4a5
.long 0x3c00,0xbc00,0x3c00,0xbc00,0xb61fbb64,0x378b3b0e,0xb872baa7,0x39133a2f
.long 0x39a839a8,0xbaa7b872,0x3b64361f,0xbbd9b23e,0xbb64b61f,0x3bf62e46,0xbbd9323e,0x3b0eb78b
.long 0x3c000000,0xbb64361f,0x39a8b9a8,0xb61f3b64,0xbb64361f,0x3913ba2f,0xb23e3bd9,0xb4a5bba8
.long 0x39a8b9a8,0xb23e3bd9,0xb61fbb64,0x3aa73872,0xb61f3b64,0xb4a5bba8,0x3aa73872,0xbbf62e46
.long 0xbc00,0x39a839a8,0xbc008000,0x39a8b9a8,0x361f3b64,0xbba8b4a5,0x3aa7b872,0xae463bf6
.long 0xb9a8b9a8,0x3bd9b23e,0xb61f3b64,0xb872baa7,0x3b64361f,0xba2f3913,0xb23ebbd9,0x3ba834a5
.long 0xbc008000,0x361fbb64,0x39a839a8,0xbb64361f,0x3b64b61f,0x2e463bf6,0xbbd9b23e,0x378bbb0e
.long 0xb9a839a8,0xb872baa7,0x3b64b61f,0x323e3bd9,0x361fbb64,0x3b0e378b,0xb8723aa7,0xba2fb913
.long 0x3c00,0xbc00,0x3c00,0xbc00,0xb9a8b9a8,0x3a2f3913,0xbaa7b872,0x3b0e378b
.long 0x3c000000,0xbbd9323e,0x3b64b61f,0xbaa73872,0xb9a839a8,0x378bbb0e,0xb23e3bd9,0xae46bbf6
.long 0xbc00,0x361f3b64,0xb9a8b9a8,0x3b64361f,0x39a839a8,0xbba8b4a5,0x3bd9b23e,0xba2f3913
.long 0xbc008000,0x3aa7b872,0xb61f3b64,0xb23ebbd9,0x39a8b9a8,0xae463bf6,0xb872baa7,0x3ba834a5
.long 0x3c00,0xb9a8b9a8,0x3c000000,0xb9a839a8,0xb9a8b9a8,0x3bf6ae46,0xb8723aa7,0xb4a5bba8
.long 0x3c000000,0xb8723aa7,0xb61fbb64,0x3bd9323e,0xb9a839a8,0xb4a5bba8,0x3bd9323e,0xb9133a2f
.long 0xbc00,0x3b64361f,0xb9a839a8,0xb61fbb64,0x39a839a8,0xbb0e378b,0xb23ebbd9,0x3bf62e46
.long 0xbc008000,0x323ebbd9,0x3b64361f,0xb8723aa7,0x39a8b9a8,0x39133a2f,0xbaa73872,0xb78bbb0e
.long 0x3c00,0xbc00,0x3c00,0xbc00,0xbb64b61f,0x3ba834a5,0xbbd9b23e,0x3bf62e46
.long 0x39a8b9a8,0xb8723aa7,0x361fbb64,0xb23e3bd9,0x361f3b64,0xb913ba2f,0x3aa73872,0xbba8b4a5
.long 0xbc008000,0x3b64b61f,0xb9a839a8,0x361fbb64,0x361fbb64,0x2e463bf6,0xb872baa7,0x3b0e378b
.long 0x39a839a8,0xbbd9b23e,0x3b64b61f,0xb8723aa7,0xbb64361f,0x378bbb0e,0x323e3bd9,0xba2fb913
.long 0xbc00,0x39a839a8,0xbc008000,0x39a8b9a8,0x3b64361f,0xbb0e378b,0x323ebbd9,0x39133a2f
.long 0xb9a839a8,0xb23ebbd9,0x3b64361f,0xbaa73872,0xb61fbb64,0x3bf62e46,0xb8723aa7,0xb78bbb0e
.long 0x3c000000,0xb61f3b64,0xb9a8b9a8,0x3b64b61f,0xb61f3b64,0xba2fb913,0x3aa7b872,0x34a53ba8
.long 0xb9a8b9a8,0x3aa7b872,0x361f3b64,0xbbd9323e,0x3b64b61f,0x34a53ba8,0xbbd9323e,0xae46bbf6
.long 0x3c00,0xbc00,0x3c00,0xbc00,0xbc008000,0x3bf6ae46,0xbbd9323e,0x3ba8b4a5
.long 0xbc00,0x323e3bd9,0xb61fbb64,0x38723aa7,0x3c000000,0xbba834a5,0x3aa7b872,0xb9133a2f
.long 0x3c00,0xb61fbb64,0x39a839a8,0xbb64b61f,0xbc008000,0x3b0eb78b,0xb8723aa7,0x2e46bbf6
.long 0xbc00,0x38723aa7,0xbb64b61f,0x3bd9b23e,0x3c000000,0xba2f3913,0x323ebbd9,0x378b3b0e
.long 0x3c00,0xb9a8b9a8,0x3c000000,0xb9a839a8,0xbc008000,0x3913ba2f,0x323e3bd9,0xbb0eb78b
.long 0xbc00,0x3aa73872,0xbb64361f,0x323ebbd9,0x3c000000,0xb78b3b0e,0xb872baa7,0x3bf6ae46
.long 0x3c00,0xbb64b61f,0x39a8b9a8,0x361f3b64,0xbc008000,0x34a5bba8,0x3aa73872,0xba2f3913
.long 0xbc00,0x3bd9323e,0xb61f3b64,0xbaa7b872,0x3c000000,0xae463bf6,0xbbd9b23e,0x34a5bba8
.long 0x3c00,0xbc00,0x3c00,0xbc00,0xbb64361f,0x3b0eb78b,0xbaa73872,0x3a2fb913
.long 0xb9a8b9a8,0x3aa73872,0xbb64b61f,0x3bd9323e,0x361fbb64,0xae463bf6,0xb23ebbd9,0x378b3b0e
.long 0x3c000000,0xbb64361f,0x39a8b9a8,0xb61f3b64,0x361f3b64,0xba2fb913,0x3bd9323e,0xbba834a5
.long 0xb9a839a8,0x323ebbd9,0x361f3b64,0xbaa7b872,0xbb64b61f,0x3ba8b4a5,0xb8723aa7,0xae46bbf6
.long 0xbc00,0x39a839a8,0xbc008000,0x39a8b9a8,0x3b64b61f,0xb4a53ba8,0xb872baa7,0x3bf62e46
.long 0x39a839a8,0xbbd9323e,0x361fbb64,0x38723aa7,0xb61f3b64,0xb913ba2f,0x3bd9b23e,0xb4a53ba8
.long 0xbc008000,0x361fbb64,0x39a839a8,0xbb64361f,0xb61fbb64,0x3bf6ae46,0xb23e3bd9,0xbb0eb78b
.long 0x39a8b9a8,0x38723aa7,0xbb64361f,0xb23ebbd9,0x3b64361f,0xb78b3b0e,0xbaa7b872,0x3913ba2f
.long 0x3c00,0xbc00,0x3c00,0xbc00,0xb9a839a8,0x3913ba2f,0xb8723aa7,0x378bbb0e
.long 0xbc008000,0x3bd9b23e,0xbb64361f,0x3aa7b872,0xb9a8b9a8,0x3b0e378b,0xbbd9b23e,0x3bf6ae46
.long 0xbc00,0x361f3b64,0xb9a8b9a8,0x3b64361f,0x39a8b9a8,0xb4a53ba8,0xb23ebbd9,0x39133a2f
.long 0x3c000000,0xbaa73872,0x361fbb64,0x323e3bd9,0x39a839a8,0xbbf6ae46,0x3aa7b872,0xb4a53ba8
.long 0x3c00,0xb9a8b9a8,0x3c000000,0xb9a839a8,0xb9a839a8,0xae46bbf6,0x3aa73872,0xbba834a5
.long 0xbc008000,0x3872baa7,0x361f3b64,0xbbd9b23e,0xb9a8b9a8,0x3ba8b4a5,0xb23e3bd9,0xba2fb913
.long 0xbc00,0x3b64361f,0xb9a839a8,0xb61fbb64,0x39a8b9a8,0x378b3b0e,0xbbd9323e,0x2e46bbf6
.long 0x3c000000,0xb23e3bd9,0xbb64b61f,0x3872baa7,0x39a839a8,0xba2f3913,0xb872baa7,0x3b0eb78b
.long 0x3c00,0xbc00,0x3c00,0xbc00,0xb61f3b64,0x34a5bba8,0xb23e3bd9,0x2e46bbf6
.long 0xb9a839a8,0x3872baa7,0xb61f3b64,0x323ebbd9,0xbb64361f,0x3a2fb913,0xb8723aa7,0x34a5bba8
.long 0xbc008000,0x3b64b61f,0xb9a839a8,0x361fbb64,0xbb64b61f,0x3bf6ae46,0xbaa73872,0x378bbb0e
.long 0xb9a8b9a8,0x3bd9323e,0xbb64361f,0x3872baa7,0xb61fbb64,0x3b0e378b,0xbbd9323e,0x3913ba2f
.long 0xbc00,0x39a839a8,0xbc008000,0x39a8b9a8,0x361fbb64,0x378b3b0e,0xbbd9b23e,0x3a2fb913
.long 0x39a8b9a8,0x323e3bd9,0xbb64b61f,0x3aa7b872,0x3b64b61f,0xae463bf6,0xbaa7b872,0x3b0eb78b
.long 0x3c000000,0xb61f3b64,0xb9a8b9a8,0x3b64b61f,0x3b64361f,0xb9133a2f,0xb872baa7,0x3ba8b4a5
.long 0x39a839a8,0xbaa73872,0xb61fbb64,0x3bd9b23e,0x361f3b64,0xbba834a5,0xb23ebbd9,0x3bf6ae46
.long 0x3c00,0xbc008000,0xbc00,0x3c000000,0x3c00,0xbbf62e46,0xb23ebbd9,0x3ba8b4a5
.long 0x3c00,0xbbd9323e,0xb61fbb64,0x3aa7b872,0x3c00,0xbba834a5,0xb872baa7,0x3913ba2f
.long 0x3c00,0xbb64361f,0xb9a8b9a8,0x361fbb64,0x3c00,0xbb0e378b,0xbaa7b872,0x2e46bbf6
.long 0x3c00,0xbaa73872,0xbb64b61f,0xb23ebbd9,0x3c00,0xba2f3913,0xbbd9b23e,0xb78bbb0e
.long 0x3c00,0xb9a839a8,0xbc008000,0xb9a8b9a8,0x3c00,0xb9133a2f,0xbbd9323e,0xbb0eb78b
.long 0x3c00,0xb8723aa7,0xbb64361f,0xbbd9b23e,0x3c00,0xb78b3b0e,0xbaa73872,0xbbf62e46
.long 0x3c00,0xb61f3b64,0xb9a839a8,0xbb64361f,0x3c00,0xb4a53ba8,0xb8723aa7,0xba2f3913
.long 0x3c00,0xb23e3bd9,0xb61f3b64,0xb8723aa7,0x3c00,0xae463bf6,0xb23e3bd9,0xb4a53ba8
.long 0x3c00,0xbc008000,0xbc00,0x3c000000,0x361f3b64,0xbb0e378b,0xb872baa7,0x3a2fb913
.long 0x39a839a8,0xb8723aa7,0xbb64b61f,0x323ebbd9,0x3b64361f,0xae463bf6,0xbbd9323e,0xb78bbb0e
.long 0x3c000000,0x361f3b64,0xb9a839a8,0xbb64b61f,0x3b64b61f,0x3a2f3913,0xb23e3bd9,0xbba834a5
.long 0x39a8b9a8,0x3bd9323e,0x361f3b64,0xb8723aa7,0x361fbb64,0x3ba8b4a5,0x3aa73872,0x2e463bf6
.long 0xbc00,0x39a8b9a8,0x3c000000,0x39a839a8,0xb61fbb64,0x34a5bba8,0x3aa7b872,0x3bf62e46
.long 0xb9a8b9a8,0xb23ebbd9,0x361fbb64,0x3aa7b872,0xbb64b61f,0xb913ba2f,0xb23ebbd9,0x34a5bba8
.long 0xbc008000,0xbb64b61f,0xb9a8b9a8,0xb61fbb64,0xbb64361f,0xbbf62e46,0xbbd9b23e,0xbb0eb78b
.long 0xb9a839a8,0xbaa73872,0xbb64361f,0xbbd9323e,0xb61f3b64,0xb78b3b0e,0xb8723aa7,0xb9133a2f
.long 0x3c00,0xbc008000,0xbc00,0x3c000000,0x39a839a8,0xb9133a2f,0xbaa7b872,0x378bbb0e
.long 0x3c000000,0x323e3bd9,0xbb64361f,0xb872baa7,0x39a8b9a8,0x3b0e378b,0xb23e3bd9,0xbbf62e46
.long 0xbc00,0x3b64b61f,0x39a839a8,0xb61f3b64,0xb9a8b9a8,0x34a5bba8,0x3bd9b23e,0x39133a2f
.long 0xbc008000,0xb872baa7,0x361fbb64,0x3bd9b23e,0xb9a839a8,0xbbf6ae46,0xb872baa7,0x34a5bba8
.long 0x3c00,0xb9a839a8,0xbc008000,0xb9a8b9a8,0x39a839a8,0x2e463bf6,0xb8723aa7,0xbba834a5
.long 0x3c000000,0x3aa73872,0x361f3b64,0xb23e3bd9,0x39a8b9a8,0x3ba8b4a5,0x3bd9323e,0x3a2f3913
.long 0xbc00,0x361fbb64,0x39a8b9a8,0x3b64b61f,0xb9a8b9a8,0xb78bbb0e,0xb23ebbd9,0x2e46bbf6
.long 0xbc008000,0xbbd9b23e,0xbb64b61f,0xbaa7b872,0xb9a839a8,0xba2f3913,0xbaa73872,0xbb0e378b
.long 0x3c00,0xbc008000,0xbc00,0x3c000000,0x3b64361f,0xb4a53ba8,0xbbd9b23e,0x2e46bbf6
.long 0x39a8b9a8,0x3aa73872,0xb61f3b64,0xbbd9b23e,0xb61fbb64,0x3a2fb913,0x3aa73872,0xb4a53ba8
.long 0xbc008000,0xb61fbb64,0x39a8b9a8,0x3b64361f,0xb61f3b64,0xbbf62e46,0xb872baa7,0x378bbb0e
.long 0x39a839a8,0xb23e3bd9,0xbb64361f,0xbaa7b872,0x3b64b61f,0x3b0e378b,0x323e3bd9,0xb9133a2f
.long 0xbc00,0x39a8b9a8,0x3c000000,0x39a839a8,0xbb64b61f,0xb78bbb0e,0x323ebbd9,0x3a2fb913
.long 0xb9a839a8,0xbbd9323e,0xbb64b61f,0xb872baa7,0x361f3b64,0xae463bf6,0xb8723aa7,0xbb0e378b
.long 0x3c000000,0x3b64361f,0x39a839a8,0x361f3b64,0x361fbb64,0x3913ba2f,0x3aa7b872,0x3ba8b4a5
.long 0xb9a8b9a8,0xb872baa7,0xb61fbb64,0xb23ebbd9,0xbb64361f,0xbba834a5,0xbbd9323e,0xbbf62e46
.long 0x3c00,0xbc008000,0xbc00,0x3c000000,0x3c000000,0x2e463bf6,0xbbd9323e,0xb4a5bba8
.long 0xbc00,0x3bd9b23e,0x361f3b64,0xbaa73872,0xbc008000,0xb4a5bba8,0x3aa7b872,0x3a2f3913
.long 0x3c00,0xbb64361f,0xb9a8b9a8,0x361fbb64,0x3c000000,0x378b3b0e,0xb8723aa7,0xbbf6ae46
.long 0xbc00,0x3aa7b872,0x3b64361f,0x323e3bd9,0xbc008000,0xb913ba2f,0x323ebbd9,0x3b0eb78b
.long 0x3c00,0xb9a839a8,0xbc008000,0xb9a8b9a8,0x3c000000,0x3a2f3913,0x323e3bd9,0xb78b3b0e
.long 0xbc00,0x3872baa7,0x3b64b61f,0x3bd9323e,0xbc008000,0xbb0eb78b,0xb872baa7,0xae46bbf6
.long 0x3c00,0xb61f3b64,0xb9a839a8,0xbb64361f,0x3c000000,0x3ba834a5,0x3aa73872,0x39133a2f
.long 0xbc00,0x323ebbd9,0x361fbb64,0x3872baa7,0xbc008000,0xbbf6ae46,0xbbd9b23e,0xbba8b4a5
.long 0x3c00,0xbc008000,0xbc00,0x3c000000,0x3b64b61f,0x378b3b0e,0xbaa73872,0xb913ba2f
.long 0xb9a8b9a8,0x3872baa7,0x3b64361f,0xb23e3bd9,0xb61f3b64,0xbbf6ae46,0xb23ebbd9,0x3b0eb78b
.long 0x3c000000,0x361f3b64,0xb9a839a8,0xbb64b61f,0xb61fbb64,0x3913ba2f,0x3bd9323e,0x34a53ba8
.long 0xb9a839a8,0xbbd9b23e,0xb61fbb64,0x3872baa7,0x3b64361f,0x34a53ba8,0xb8723aa7,0xbbf62e46
.long 0xbc00,0x39a8b9a8,0x3c000000,0x39a839a8,0xbb64361f,0xbba8b4a5,0xb872baa7,0x2e46bbf6
.long 0x39a839a8,0x323e3bd9,0xb61f3b64,0xbaa73872,0x361fbb64,0x3a2fb913,0x3bd9b23e,0x3ba834a5
.long 0xbc008000,0xbb64b61f,0xb9a8b9a8,0xb61fbb64,0x361f3b64,0x2e463bf6,0xb23e3bd9,0xb78b3b0e
.long 0x39a8b9a8,0x3aa7b872,0x3b64b61f,0x3bd9b23e,0xbb64b61f,0xbb0eb78b,0xbaa7b872,0xba2fb913
.long 0x3c00,0xbc008000,0xbc00,0x3c000000,0x39a8b9a8,0x3a2f3913,0xb8723aa7,0xbb0eb78b
.long 0xbc008000,0xb23ebbd9,0x3b64b61f,0x38723aa7,0x39a839a8,0xb78b3b0e,0xbbd9b23e,0xae46bbf6
.long 0xbc00,0x3b64b61f,0x39a839a8,0xb61f3b64,0xb9a839a8,0xbba8b4a5,0xb23ebbd9,0x3a2fb913
.long 0x3c000000,0x38723aa7,0xb61f3b64,0xbbd9323e,0xb9a8b9a8,0x2e46bbf6,0x3aa7b872,0x3ba834a5
.long 0x3c00,0xb9a839a8,0xbc008000,0xb9a8b9a8,0x39a8b9a8,0x3bf6ae46,0x3aa73872,0x34a53ba8
.long 0xbc008000,0xbaa7b872,0xb61fbb64,0x323ebbd9,0x39a839a8,0x34a53ba8,0xb23e3bd9,0xb9133a2f
.long 0xbc00,0x361fbb64,0x39a8b9a8,0x3b64b61f,0xb9a839a8,0xbb0e378b,0xbbd9323e,0xbbf6ae46
.long 0x3c000000,0x3bd9323e,0x3b64361f,0x3aa73872,0xb9a8b9a8,0xb913ba2f,0xb872baa7,0xb78bbb0e
.long 0x3c00,0xbc008000,0xbc00,0x3c000000,0x361fbb64,0x3ba834a5,0xb23e3bd9,0xbbf6ae46
.long 0xb9a839a8,0xbaa7b872,0x361fbb64,0x3bd9323e,0x3b64b61f,0x39133a2f,0xb8723aa7,0xbba8b4a5
.long 0xbc008000,0xb61fbb64,0x39a8b9a8,0x3b64361f,0x3b64361f,0x2e463bf6,0xbaa73872,0xbb0eb78b
.long 0xb9a8b9a8,0x323ebbd9,0x3b64b61f,0x3aa73872,0x361f3b64,0xb78b3b0e,0xbbd9323e,0xba2fb913
.long 0xbc00,0x39a8b9a8,0x3c000000,0x39a839a8,0xb61f3b64,0xbb0e378b,0xbbd9b23e,0xb913ba2f
.long 0x39a8b9a8,0x3bd9b23e,0x3b64361f,0x38723aa7,0xbb64361f,0xbbf6ae46,0xbaa7b872,0xb78bbb0e
.long 0x3c000000,0x3b64361f,0x39a839a8,0x361f3b64,0xbb64b61f,0xba2fb913,0xb872baa7,0xb4a5bba8
.long 0x39a839a8,0x38723aa7,0x361f3b64,0x323e3bd9,0xb61fbb64,0xb4a5bba8,0xb23ebbd9,0xae46bbf6
.long 0x3c00,0xbc008000,0xbc00,0x3c000000,0xbc00,0x3bf6ae46,0x323e3bd9,0xbba834a5
.long 0x3c00,0xbbd9323e,0xb61fbb64,0x3aa7b872,0xbc00,0x3ba8b4a5,0x38723aa7,0xb9133a2f
.long 0x3c00,0xbb64361f,0xb9a8b9a8,0x361fbb64,0xbc00,0x3b0eb78b,0x3aa73872,0xae463bf6
.long 0x3c00,0xbaa73872,0xbb64b61f,0xb23ebbd9,0xbc00,0x3a2fb913,0x3bd9323e,0x378b3b0e
.long 0x3c00,0xb9a839a8,0xbc008000,0xb9a8b9a8,0xbc00,0x3913ba2f,0x3bd9b23e,0x3b0e378b
.long 0x3c00,0xb8723aa7,0xbb64361f,0xbbd9b23e,0xbc00,0x378bbb0e,0x3aa7b872,0x3bf6ae46
.long 0x3c00,0xb61f3b64,0xb9a839a8,0xbb64361f,0xbc00,0x34a5bba8,0x3872baa7,0x3a2fb913
.long 0x3c00,0xb23e3bd9,0xb61f3b64,0xb8723aa7,0xbc00,0x2e46bbf6,0x323ebbd9,0x34a5bba8
.long 0x3c00,0xbc008000,0xbc00,0x3c000000,0xb61fbb64,0x3b0eb78b,0x38723aa7,0xba2f3913
.long 0x39a839a8,0xb8723aa7,0xbb64b61f,0x323ebbd9,0xbb64b61f,0x2e46bbf6,0x3bd9b23e,0x378b3b0e
.long 0x3c000000,0x361f3b64,0xb9a839a8,0xbb64b61f,0xbb64361f,0xba2fb913,0x323ebbd9,0x3ba8b4a5
.long 0x39a8b9a8,0x3bd9323e,0x361f3b64,0xb8723aa7,0xb61f3b64,0xbba834a5,0xbaa7b872,0xae46bbf6
.long 0xbc00,0x39a8b9a8,0x3c000000,0x39a839a8,0x361f3b64,0xb4a53ba8,0xbaa73872,0xbbf6ae46
.long 0xb9a8b9a8,0xb23ebbd9,0x361fbb64,0x3aa7b872,0x3b64361f,0x39133a2f,0x323e3bd9,0xb4a53ba8
.long 0xbc008000,0xbb64b61f,0xb9a8b9a8,0xb61fbb64,0x3b64b61f,0x3bf6ae46,0x3bd9323e,0x3b0e378b
.long 0xb9a839a8,0xbaa73872,0xbb64361f,0xbbd9323e,0x361fbb64,0x378bbb0e,0x3872baa7,0x3913ba2f
.long 0x3c00,0xbc008000,0xbc00,0x3c000000,0xb9a8b9a8,0x3913ba2f,0x3aa73872,0xb78b3b0e
.long 0x3c000000,0x323e3bd9,0xbb64361f,0xb872baa7,0xb9a839a8,0xbb0eb78b,0x323ebbd9,0x3bf6ae46
.long 0xbc00,0x3b64b61f,0x39a839a8,0xb61f3b64,0x39a839a8,0xb4a53ba8,0xbbd9323e,0xb913ba2f
.long 0xbc008000,0xb872baa7,0x361fbb64,0x3bd9b23e,0x39a8b9a8,0x3bf62e46,0x38723aa7,0xb4a53ba8
.long 0x3c00,0xb9a839a8,0xbc008000,0xb9a8b9a8,0xb9a8b9a8,0xae46bbf6,0x3872baa7,0x3ba8b4a5
.long 0x3c000000,0x3aa73872,0x361f3b64,0xb23e3bd9,0xb9a839a8,0xbba834a5,0xbbd9b23e,0xba2fb913
.long 0xbc00,0x361fbb64,0x39a8b9a8,0x3b64b61f,0x39a839a8,0x378b3b0e,0x323e3bd9,0xae463bf6
.long 0xbc008000,0xbbd9b23e,0xbb64b61f,0xbaa7b872,0x39a8b9a8,0x3a2fb913,0x3aa7b872,0x3b0eb78b
.long 0x3c00,0xbc008000,0xbc00,0x3c000000,0xbb64b61f,0x34a5bba8,0x3bd9323e,0xae463bf6
.long 0x39a8b9a8,0x3aa73872,0xb61f3b64,0xbbd9b23e,0x361f3b64,0xba2f3913,0xbaa7b872,0x34a5bba8
.long 0xbc008000,0xb61fbb64,0x39a8b9a8,0x3b64361f,0x361fbb64,0x3bf6ae46,0x38723aa7,0xb78b3b0e
.long 0x39a839a8,0xb23e3bd9,0xbb64361f,0xbaa7b872,0xbb64361f,0xbb0eb78b,0xb23ebbd9,0x3913ba2f
.long 0xbc00,0x39a8b9a8,0x3c000000,0x39a839a8,0x3b64361f,0x378b3b0e,0xb23e3bd9,0xba2f3913
.long 0xb9a839a8,0xbbd9323e,0xbb64b61f,0xb872baa7,0xb61fbb64,0x2e46bbf6,0x3872baa7,0x3b0eb78b
.long 0x3c000000,0x3b64361f,0x39a839a8,0x361f3b64,0xb61f3b64,0xb9133a2f,0xbaa73872,0xbba834a5
.long 0xb9a8b9a8,0xb872baa7,0xb61fbb64,0xb23ebbd9,0x3b64b61f,0x3ba8b4a5,0x3bd9b23e,0x3bf6ae46
.long 0x3c00,0xbc008000,0xbc00,0x3c000000,0xbc008000,0xae46bbf6,0x3bd9b23e,0x34a53ba8
.long 0xbc00,0x3bd9b23e,0x361f3b64,0xbaa73872,0x3c000000,0x34a53ba8,0xbaa73872,0xba2fb913
.long 0x3c00,0xbb64361f,0xb9a8b9a8,0x361fbb64,0xbc008000,0xb78bbb0e,0x3872baa7,0x3bf62e46
.long 0xbc00,0x3aa7b872,0x3b64361f,0x323e3bd9,0x3c000000,0x39133a2f,0xb23e3bd9,0xbb0e378b
.long 0x3c00,0xb9a839a8,0xbc008000,0xb9a8b9a8,0xbc008000,0xba2fb913,0xb23ebbd9,0x378bbb0e
.long 0xbc00,0x3872baa7,0x3b64b61f,0x3bd9323e,0x3c000000,0x3b0e378b,0x38723aa7,0x2e463bf6
.long 0x3c00,0xb61f3b64,0xb9a839a8,0xbb64361f,0xbc008000,0xbba8b4a5,0xbaa7b872,0xb913ba2f
.long 0xbc00,0x323ebbd9,0x361fbb64,0x3872baa7,0x3c000000,0x3bf62e46,0x3bd9323e,0x3ba834a5
.long 0x3c00,0xbc008000,0xbc00,0x3c000000,0xbb64361f,0xb78bbb0e,0x3aa7b872,0x39133a2f
.long 0xb9a8b9a8,0x3872baa7,0x3b64361f,0xb23e3bd9,0x361fbb64,0x3bf62e46,0x323e3bd9,0xbb0e378b
.long 0x3c000000,0x361f3b64,0xb9a839a8,0xbb64b61f,0x361f3b64,0xb9133a2f,0xbbd9b23e,0xb4a5bba8
.long 0xb9a839a8,0xbbd9b23e,0xb61fbb64,0x3872baa7,0xbb64b61f,0xb4a5bba8,0x3872baa7,0x3bf6ae46
.long 0xbc00,0x39a8b9a8,0x3c000000,0x39a839a8,0x3b64b61f,0x3ba834a5,0x38723aa7,0xae463bf6
.long 0x39a839a8,0x323e3bd9,0xb61f3b64,0xbaa73872,0xb61f3b64,0xba2f3913,0xbbd9323e,0xbba8b4a5
.long 0xbc008000,0xbb64b61f,0xb9a8b9a8,0xb61fbb64,0xb61fbb64,0xae46bbf6,0x323ebbd9,0x378bbb0e
.long 0x39a8b9a8,0x3aa7b872,0x3b64b61f,0x3bd9b23e,0x3b64361f,0x3b0e378b,0x3aa73872,0x3a2f3913
.long 0x3c00,0xbc008000,0xbc00,0x3c000000,0xb9a839a8,0xba2fb913,0x3872baa7,0x3b0e378b
.long 0xbc008000,0xb23ebbd9,0x3b64b61f,0x38723aa7,0xb9a8b9a8,0x378bbb0e,0x3bd9323e,0x2e463bf6
.long 0xbc00,0x3b64b61f,0x39a839a8,0xb61f3b64,0x39a8b9a8,0x3ba834a5,0x323e3bd9,0xba2f3913
.long 0x3c000000,0x38723aa7,0xb61f3b64,0xbbd9323e,0x39a839a8,0xae463bf6,0xbaa73872,0xbba8b4a5
.long 0x3c00,0xb9a839a8,0xbc008000,0xb9a8b9a8,0xb9a839a8,0xbbf62e46,0xbaa7b872,0xb4a5bba8
.long 0xbc008000,0xbaa7b872,0xb61fbb64,0x323ebbd9,0xb9a8b9a8,0xb4a5bba8,0x323ebbd9,0x3913ba2f
.long 0xbc00,0x361fbb64,0x39a8b9a8,0x3b64b61f,0x39a8b9a8,0x3b0eb78b,0x3bd9b23e,0x3bf62e46
.long 0x3c000000,0x3bd9323e,0x3b64361f,0x3aa73872,0x39a839a8,0x39133a2f,0x38723aa7,0x378b3b0e
.long 0x3c00,0xbc008000,0xbc00,0x3c000000,0xb61f3b64,0xbba8b4a5,0x323ebbd9,0x3bf62e46
.long 0xb9a839a8,0xbaa7b872,0x361fbb64,0x3bd9323e,0xbb64361f,0xb913ba2f,0x3872baa7,0x3ba834a5
.long 0xbc008000,0xb61fbb64,0x39a8b9a8,0x3b64361f,0xbb64b61f,0xae46bbf6,0x3aa7b872,0x3b0e378b
.long 0xb9a8b9a8,0x323ebbd9,0x3b64b61f,0x3aa73872,0xb61fbb64,0x378bbb0e,0x3bd9b23e,0x3a2f3913
.long 0xbc00,0x39a8b9a8,0x3c000000,0x39a839a8,0x361fbb64,0x3b0eb78b,0x3bd9323e,0x39133a2f
.long 0x39a8b9a8,0x3bd9b23e,0x3b64361f,0x38723aa7,0x3b64b61f,0x3bf62e46,0x3aa73872,0x378b3b0e
.long 0x3c000000,0x3b64361f,0x39a839a8,0x361f3b64,0x3b64361f,0x3a2f3913,0x38723aa7,0x34a53ba8
.long 0x39a839a8,0x38723aa7,0x361f3b64,0x323e3bd9,0x361f3b64,0x34a53ba8,0x323e3bd9,0x2e463bf6
.long 0x3c00,0x3c00,0x3c00,0x3c00,0x3c008000,0x3c008000,0x3c008000,0x3c008000
.long 0x3c00,0xbc00,0x361f3b64,0xb61fbb64,0x3c008000,0xbc008000,0x3b64b61f,0xbb64361f
.long 0x3c00,0x3c00,0x39a839a8,0x39a839a8,0x3c008000,0x3c008000,0x39a8b9a8,0x39a8b9a8
.long 0x3c00,0xbc00,0x3b64361f,0xbb64b61f,0x3c008000,0xbc008000,0x361fbb64,0xb61f3b64
.long 0x3c00,0x3c00,0x3c000000,0x3c000000,0x3c008000,0x3c008000,0xbc00,0xbc00
.long 0x3c00,0xbc00,0x3b64b61f,0xbb64361f,0x3c008000,0xbc008000,0xb61fbb64,0x361f3b64
.long 0x3c00,0x3c00,0x39a8b9a8,0x39a8b9a8,0x3c008000,0x3c008000,0xb9a8b9a8,0xb9a8b9a8
.long 0x3c00,0xbc00,0x361fbb64,0xb61f3b64,0x3c008000,0xbc008000,0xbb64b61f,0x3b64361f
.long 0x3c00,0x3c00,0x3c00,0x3c00,0x3c008000,0x3c008000,0x3c008000,0x3c008000
.long 0x39a839a8,0xb9a8b9a8,0x3b64361f,0xbb64b61f,0x39a8b9a8,0xb9a839a8,0x361fbb64,0xb61f3b64
.long 0x3c000000,0x3c000000,0x39a8b9a8,0x39a8b9a8,0xbc00,0xbc00,0xb9a8b9a8,0xb9a8b9a8
.long 0x39a8b9a8,0xb9a839a8,0xb61fbb64,0x361f3b64,0xb9a8b9a8,0x39a839a8,0xbb64361f,0x3b64b61f
.long 0xbc00,0xbc00,0xbc008000,0xbc008000,0xbc008000,0xbc008000,0x80003c00,0x80003c00
.long 0xb9a8b9a8,0x39a839a8,0xb61f3b64,0x361fbb64,0xb9a839a8,0x39a8b9a8,0x3b64361f,0xbb64b61f
.long 0xbc008000,0xbc008000,0x39a839a8,0x39a839a8,0x80003c00,0x80003c00,0x39a8b9a8,0x39a8b9a8
.long 0xb9a839a8,0x39a8b9a8,0x3b64b61f,0xbb64361f,0x39a839a8,0xb9a8b9a8,0xb61fbb64,0x361f3b64
.long 0x3c00,0x3c00,0x3c00,0x3c00,0x3c008000,0x3c008000,0x3c008000,0x3c008000
.long 0x3c000000,0xbc008000,0x3b64b61f,0xbb64361f,0xbc00,0x80003c00,0xb61fbb64,0x361f3b64
.long 0xbc00,0xbc00,0xb9a8b9a8,0xb9a8b9a8,0xbc008000,0xbc008000,0xb9a839a8,0xb9a839a8
.long 0xbc008000,0x3c000000,0xb61f3b64,0x361fbb64,0x80003c00,0xbc00,0x3b64361f,0xbb64b61f
.long 0x3c00,0x3c00,0x3c000000,0x3c000000,0x3c008000,0x3c008000,0xbc00,0xbc00
.long 0x3c000000,0xbc008000,0xb61fbb64,0x361f3b64,0xbc00,0x80003c00,0xbb64361f,0x3b64b61f
.long 0xbc00,0xbc00,0xb9a839a8,0xb9a839a8,0xbc008000,0xbc008000,0x39a839a8,0x39a839a8
.long 0xbc008000,0x3c000000,0x3b64361f,0xbb64b61f,0x80003c00,0xbc00,0x361fbb64,0xb61f3b64
.long 0x3c00,0x3c00,0x3c00,0x3c00,0x3c008000,0x3c008000,0x3c008000,0x3c008000
.long 0x39a8b9a8,0xb9a839a8,0x361fbb64,0xb61f3b64,0xb9a8b9a8,0x39a839a8,0xbb64b61f,0x3b64361f
.long 0xbc008000,0xbc008000,0xb9a839a8,0xb9a839a8,0x80003c00,0x80003c00,0x39a839a8,0x39a839a8
.long 0x39a839a8,0xb9a8b9a8,0x3b64b61f,0xbb64361f,0x39a8b9a8,0xb9a839a8,0xb61fbb64,0x361f3b64
.long 0xbc00,0xbc00,0xbc008000,0xbc008000,0xbc008000,0xbc008000,0x80003c00,0x80003c00
.long 0xb9a839a8,0x39a8b9a8,0x3b64361f,0xbb64b61f,0x39a839a8,0xb9a8b9a8,0x361fbb64,0xb61f3b64
.long 0x3c000000,0x3c000000,0xb9a8b9a8,0xb9a8b9a8,0xbc00,0xbc00,0xb9a839a8,0xb9a839a8
.long 0xb9a8b9a8,0x39a839a8,0x361f3b64,0xb61fbb64,0xb9a839a8,0x39a8b9a8,0x3b64b61f,0xbb64361f
.long 0x3c00,0x3c00,0x3c00,0x3c00,0x3c008000,0x3c008000,0x3c008000,0x3c008000
.long 0x2a483bfe,0xaa48bbfe,0x395f39ed,0xb95fb9ed,0x3bfeaa48,0xbbfe2a48,0x39edb95f,0xb9ed395f
.long 0x2e463bf6,0x2e463bf6,0x3bf62e46,0x3bf62e46,0x3bf6ae46,0x3bf6ae46,0x2e46bbf6,0x2e46bbf6
.long 0x30b23bea,0xb0b2bbea,0x3a6db8c4,0xba6d38c4,0x3beab0b2,0xbbea30b2,0xb8c4ba6d,0x38c43a6d
.long 0x323e3bd9,0x323e3bd9,0x323ebbd9,0x323ebbd9,0x3bd9b23e,0x3bd9b23e,0xbbd9b23e,0xbbd9b23e
.long 0x33c63bc3,0xb3c6bbc3,0xb81dbadd,0x381d3add,0x3bc3b3c6,0xbbc333c6,0xbadd381d,0x3addb81d
.long 0x34a53ba8,0x34a53ba8,0xbba8b4a5,0xbba8b4a5,0x3ba8b4a5,0x3ba8b4a5,0xb4a53ba8,0xb4a53ba8
.long 0x35643b88,0xb564bb88,0xbb3b36d7,0x3b3bb6d7,0x3b88b564,0xbb883564,0x36d73b3b,0xb6d7bb3b
.long 0x3c00,0x3c00,0x3c00,0x3c00,0x3c008000,0x3c008000,0x3c008000,0x3c008000
.long 0x39ed395f,0xb9edb95f,0x3bfe2a48,0xbbfeaa48,0x395fb9ed,0xb95f39ed,0x2a48bbfe,0xaa483bfe
.long 0x3bf6ae46,0x3bf6ae46,0x2e46bbf6,0x2e46bbf6,0xae46bbf6,0xae46bbf6,0xbbf6ae46,0xbbf6ae46
.long 0x38c4ba6d,0xb8c43a6d,0xbbeab0b2,0x3bea30b2,0xba6db8c4,0x3a6d38c4,0xb0b23bea,0x30b2bbea
.long 0xb23ebbd9,0xb23ebbd9,0xb23e3bd9,0xb23e3bd9,0xbbd9323e,0xbbd9323e,0x3bd9323e,0x3bd9323e
.long 0xbaddb81d,0x3add381d,0x3bc333c6,0xbbc3b3c6,0xb81d3add,0x381dbadd,0x33c6bbc3,0xb3c63bc3
.long 0xbba834a5,0xbba834a5,0x34a5bba8,0x34a5bba8,0x34a53ba8,0x34a53ba8,0xbba8b4a5,0xbba8b4a5
.long 0xb6d73b3b,0x36d7bb3b,0xbb88b564,0x3b883564,0x3b3b36d7,0xbb3bb6d7,0xb5643b88,0x3564bb88
.long 0x3c00,0x3c00,0x3c00,0x3c00,0x3c008000,0x3c008000,0x3c008000,0x3c008000
.long 0x3bfeaa48,0xbbfe2a48,0x39edb95f,0xb9ed395f,0xaa48bbfe,0x2a483bfe,0xb95fb9ed,0x395f39ed
.long 0xae46bbf6,0xae46bbf6,0xbbf6ae46,0xbbf6ae46,0xbbf62e46,0xbbf62e46,0xae463bf6,0xae463bf6
.long 0xbbea30b2,0x3beab0b2,0x38c43a6d,0xb8c4ba6d,0x30b23bea,0xb0b2bbea,0x3a6db8c4,0xba6d38c4
.long 0x323e3bd9,0x323e3bd9,0x323ebbd9,0x323ebbd9,0x3bd9b23e,0x3bd9b23e,0xbbd9b23e,0xbbd9b23e
.long 0x3bc3b3c6,0xbbc333c6,0xbadd381d,0x3addb81d,0xb3c6bbc3,0x33c63bc3,0x381d3add,0xb81dbadd
.long 0xb4a5bba8,0xb4a5bba8,0x3ba834a5,0x3ba834a5,0xbba834a5,0xbba834a5,0x34a5bba8,0x34a5bba8
.long 0xbb883564,0x3b88b564,0xb6d7bb3b,0x36d73b3b,0x35643b88,0xb564bb88,0xbb3b36d7,0x3b3bb6d7
.long 0x3c00,0x3c00,0x3c00,0x3c00,0x3c008000,0x3c008000,0x3c008000,0x3c008000
.long 0x395fb9ed,0xb95f39ed,0x2a48bbfe,0xaa483bfe,0xb9edb95f,0x39ed395f,0xbbfeaa48,0x3bfe2a48
.long 0xbbf62e46,0xbbf62e46,0xae463bf6,0xae463bf6,0x2e463bf6,0x2e463bf6,0x3bf62e46,0x3bf62e46
.long 0x3a6d38c4,0xba6db8c4,0x30b2bbea,0xb0b23bea,0x38c4ba6d,0xb8c43a6d,0xbbeab0b2,0x3bea30b2
.long 0xb23ebbd9,0xb23ebbd9,0xb23e3bd9,0xb23e3bd9,0xbbd9323e,0xbbd9323e,0x3bd9323e,0x3bd9323e
.long 0xb81d3add,0x381dbadd,0x33c6bbc3,0xb3c63bc3,0x3add381d,0xbaddb81d,0xbbc3b3c6,0x3bc333c6
.long 0x3ba8b4a5,0x3ba8b4a5,0xb4a53ba8,0xb4a53ba8,0xb4a5bba8,0xb4a5bba8,0x3ba834a5,0x3ba834a5
.long 0xbb3bb6d7,0x3b3b36d7,0x3564bb88,0xb5643b88,0xb6d73b3b,0x36d7bb3b,0xbb88b564,0x3b883564
.long 0x3c00,0x3c00,0x3c00,0x3c00,0x3c008000,0x3c008000,0x3c008000,0x3c008000
.long 0x2e463bf6,0xae46bbf6,0x39133a2f,0xb913ba2f,0x3bf6ae46,0xbbf62e46,0x3a2fb913,0xba2f3913
.long 0x323e3bd9,0x323e3bd9,0x3bd9323e,0x3bd9323e,0x3bd9b23e,0x3bd9b23e,0x323ebbd9,0x323ebbd9
.long 0x34a53ba8,0xb4a5bba8,0x3b0eb78b,0xbb0e378b,0x3ba8b4a5,0xbba834a5,0xb78bbb0e,0x378b3b0e
.long 0x361f3b64,0x361f3b64,0x361fbb64,0x361fbb64,0x3b64b61f,0x3b64b61f,0xbb64b61f,0xbb64b61f
.long 0x378b3b0e,0xb78bbb0e,0xb4a5bba8,0x34a53ba8,0x3b0eb78b,0xbb0e378b,0xbba834a5,0x3ba8b4a5
.long 0x38723aa7,0x38723aa7,0xbaa7b872,0xbaa7b872,0x3aa7b872,0x3aa7b872,0xb8723aa7,0xb8723aa7
.long 0x39133a2f,0xb913ba2f,0xbbf62e46,0x3bf6ae46,0x3a2fb913,0xba2f3913,0x2e463bf6,0xae46bbf6
.long 0x3c00,0x3c00,0x3c00,0x3c00,0x3c008000,0x3c008000,0x3c008000,0x3c008000
.long 0x3a2f3913,0xba2fb913,0x3bf62e46,0xbbf6ae46,0x3913ba2f,0xb9133a2f,0x2e46bbf6,0xae463bf6
.long 0x3bd9b23e,0x3bd9b23e,0x323ebbd9,0x323ebbd9,0xb23ebbd9,0xb23ebbd9,0xbbd9b23e,0xbbd9b23e
.long 0x378bbb0e,0xb78b3b0e,0xbba8b4a5,0x3ba834a5,0xbb0eb78b,0x3b0e378b,0xb4a53ba8,0x34a5bba8
.long 0xb61fbb64,0xb61fbb64,0xb61f3b64,0xb61f3b64,0xbb64361f,0xbb64361f,0x3b64361f,0x3b64361f
.long 0xbba8b4a5,0x3ba834a5,0x3b0e378b,0xbb0eb78b,0xb4a53ba8,0x34a5bba8,0x378bbb0e,0xb78b3b0e
.long 0xbaa73872,0xbaa73872,0x3872baa7,0x3872baa7,0x38723aa7,0x38723aa7,0xbaa7b872,0xbaa7b872
.long 0xae463bf6,0x2e46bbf6,0xba2fb913,0x3a2f3913,0x3bf62e46,0xbbf6ae46,0xb9133a2f,0x3913ba2f
.long 0x3c00,0x3c00,0x3c00,0x3c00,0x3c008000,0x3c008000,0x3c008000,0x3c008000
.long 0x3bf6ae46,0xbbf62e46,0x3a2fb913,0xba2f3913,0xae46bbf6,0x2e463bf6,0xb913ba2f,0x39133a2f
.long 0xb23ebbd9,0xb23ebbd9,0xbbd9b23e,0xbbd9b23e,0xbbd9323e,0xbbd9323e,0xb23e3bd9,0xb23e3bd9
.long 0xbba834a5,0x3ba8b4a5,0x378b3b0e,0xb78bbb0e,0x34a53ba8,0xb4a5bba8,0x3b0eb78b,0xbb0e378b
.long 0x361f3b64,0x361f3b64,0x361fbb64,0x361fbb64,0x3b64b61f,0x3b64b61f,0xbb64b61f,0xbb64b61f
.long 0x3b0eb78b,0xbb0e378b,0xbba834a5,0x3ba8b4a5,0xb78bbb0e,0x378b3b0e,0x34a53ba8,0xb4a5bba8
.long 0xb872baa7,0xb872baa7,0x3aa73872,0x3aa73872,0xbaa73872,0xbaa73872,0x3872baa7,0x3872baa7
.long 0xba2f3913,0x3a2fb913,0xae46bbf6,0x2e463bf6,0x39133a2f,0xb913ba2f,0xbbf62e46,0x3bf6ae46
.long 0x3c00,0x3c00,0x3c00,0x3c00,0x3c008000,0x3c008000,0x3c008000,0x3c008000
.long 0x3913ba2f,0xb9133a2f,0x2e46bbf6,0xae463bf6,0xba2fb913,0x3a2f3913,0xbbf6ae46,0x3bf62e46
.long 0xbbd9323e,0xbbd9323e,0xb23e3bd9,0xb23e3bd9,0x323e3bd9,0x323e3bd9,0x3bd9323e,0x3bd9323e
.long 0x3b0e378b,0xbb0eb78b,0x34a5bba8,0xb4a53ba8,0x378bbb0e,0xb78b3b0e,0xbba8b4a5,0x3ba834a5
.long 0xb61fbb64,0xb61fbb64,0xb61f3b64,0xb61f3b64,0xbb64361f,0xbb64361f,0x3b64361f,0x3b64361f
.long 0xb4a53ba8,0x34a5bba8,0x378bbb0e,0xb78b3b0e,0x3ba834a5,0xbba8b4a5,0xbb0eb78b,0x3b0e378b
.long 0x3aa7b872,0x3aa7b872,0xb8723aa7,0xb8723aa7,0xb872baa7,0xb872baa7,0x3aa73872,0x3aa73872
.long 0xbbf6ae46,0x3bf62e46,0x3913ba2f,0xb9133a2f,0xae463bf6,0x2e46bbf6,0xba2fb913,0x3a2f3913
.long 0x3c00,0x3c00,0x3c00,0x3c00,0x3c008000,0x3c008000,0x3c008000,0x3c008000
.long 0x30b23bea,0xb0b2bbea,0x38c43a6d,0xb8c4ba6d,0x3beab0b2,0xbbea30b2,0x3a6db8c4,0xba6d38c4
.long 0x34a53ba8,0x34a53ba8,0x3ba834a5,0x3ba834a5,0x3ba8b4a5,0x3ba8b4a5,0x34a5bba8,0x34a5bba8
.long 0x36d73b3b,0xb6d7bb3b,0x3b88b564,0xbb883564,0x3b3bb6d7,0xbb3b36d7,0xb564bb88,0x35643b88
.long 0x38723aa7,0x38723aa7,0x3872baa7,0x3872baa7,0x3aa7b872,0x3aa7b872,0xbaa7b872,0xbaa7b872
.long 0x395f39ed,0xb95fb9ed,0xaa48bbfe,0x2a483bfe,0x39edb95f,0xb9ed395f,0xbbfe2a48,0x3bfeaa48
.long 0x3a2f3913,0x3a2f3913,0xb913ba2f,0xb913ba2f,0x3913ba2f,0x3913ba2f,0xba2f3913,0xba2f3913
.long 0x3add381d,0xbaddb81d,0xbbc3b3c6,0x3bc333c6,0x381dbadd,0xb81d3add,0xb3c63bc3,0x33c6bbc3
.long 0x3c00,0x3c00,0x3c00,0x3c00,0x3c008000,0x3c008000,0x3c008000,0x3c008000
.long 0x3a6d38c4,0xba6db8c4,0x3bea30b2,0xbbeab0b2,0x38c4ba6d,0xb8c43a6d,0x30b2bbea,0xb0b23bea
.long 0x3ba8b4a5,0x3ba8b4a5,0x34a5bba8,0x34a5bba8,0xb4a5bba8,0xb4a5bba8,0xbba8b4a5,0xbba8b4a5
.long 0x3564bb88,0xb5643b88,0xbb3bb6d7,0x3b3b36d7,0xbb88b564,0x3b883564,0xb6d73b3b,0x36d7bb3b
.long 0xb872baa7,0xb872baa7,0xb8723aa7,0xb8723aa7,0xbaa73872,0xbaa73872,0x3aa73872,0x3aa73872
.long 0xbbfeaa48,0x3bfe2a48,0x39ed395f,0xb9edb95f,0xaa483bfe,0x2a48bbfe,0x395fb9ed,0xb95f39ed
.long 0xb9133a2f,0xb9133a2f,0x3a2fb913,0x3a2fb913,0x3a2f3913,0x3a2f3913,0xb913ba2f,0xb913ba2f
.long 0x33c63bc3,0xb3c6bbc3,0xb81dbadd,0x381d3add,0x3bc3b3c6,0xbbc333c6,0xbadd381d,0x3addb81d
.long 0x3c00,0x3c00,0x3c00,0x3c00,0x3c008000,0x3c008000,0x3c008000,0x3c008000
.long 0x3beab0b2,0xbbea30b2,0x3a6db8c4,0xba6d38c4,0xb0b2bbea,0x30b23bea,0xb8c4ba6d,0x38c43a6d
.long 0xb4a5bba8,0xb4a5bba8,0xbba8b4a5,0xbba8b4a5,0xbba834a5,0xbba834a5,0xb4a53ba8,0xb4a53ba8
.long 0xbb3b36d7,0x3b3bb6d7,0x35643b88,0xb564bb88,0x36d73b3b,0xb6d7bb3b,0x3b88b564,0xbb883564
.long 0x38723aa7,0x38723aa7,0x3872baa7,0x3872baa7,0x3aa7b872,0x3aa7b872,0xbaa7b872,0xbaa7b872
.long 0x39edb95f,0xb9ed395f,0xbbfe2a48,0x3bfeaa48,0xb95fb9ed,0x395f39ed,0x2a483bfe,0xaa48bbfe
.long 0xba2fb913,0xba2fb913,0x39133a2f,0x39133a2f,0xb9133a2f,0xb9133a2f,0x3a2fb913,0x3a2fb913
.long 0xb81d3add,0x381dbadd,0x33c6bbc3,0xb3c63bc3,0x3add381d,0xbaddb81d,0xbbc3b3c6,0x3bc333c6
.long 0x3c00,0x3c00,0x3c00,0x3c00,0x3c008000,0x3c008000,0x3c008000,0x3c008000
.long 0x38c4ba6d,0xb8c43a6d,0x30b2bbea,0xb0b23bea,0xba6db8c4,0x3a6d38c4,0xbbeab0b2,0x3bea30b2
.long 0xbba834a5,0xbba834a5,0xb4a53ba8,0xb4a53ba8,0x34a53ba8,0x34a53ba8,0x3ba834a5,0x3ba834a5
.long 0x3b883564,0xbb88b564,0x36d7bb3b,0xb6d73b3b,0x3564bb88,0xb5643b88,0xbb3bb6d7,0x3b3b36d7
.long 0xb872baa7,0xb872baa7,0xb8723aa7,0xb8723aa7,0xbaa73872,0xbaa73872,0x3aa73872,0x3aa73872
.long 0xaa483bfe,0x2a48bbfe,0x395fb9ed,0xb95f39ed,0x3bfe2a48,0xbbfeaa48,0xb9edb95f,0x39ed395f
.long 0x3913ba2f,0x3913ba2f,0xba2f3913,0xba2f3913,0xba2fb913,0xba2fb913,0x39133a2f,0x39133a2f
.long 0xbbc333c6,0x3bc3b3c6,0x3addb81d,0xbadd381d,0x33c63bc3,0xb3c6bbc3,0xb81dbadd,0x381d3add
.long 0x3c00,0x3c00,0x3c00,0x3c00,0x3c008000,0x3c008000,0x3c008000,0x3c008000
.long 0x323e3bd9,0xb23ebbd9,0x38723aa7,0xb872baa7,0x3bd9b23e,0xbbd9323e,0x3aa7b872,0xbaa73872
.long 0x361f3b64,0x361f3b64,0x3b64361f,0x3b64361f,0x3b64b61f,0x3b64b61f,0x361fbb64,0x361fbb64
.long 0x38723aa7,0xb872baa7,0x3bd9b23e,0xbbd9323e,0x3aa7b872,0xbaa73872,0xb23ebbd9,0x323e3bd9
.long 0x39a839a8,0x39a839a8,0x39a8b9a8,0x39a8b9a8,0x39a8b9a8,0x39a8b9a8,0xb9a8b9a8,0xb9a8b9a8
.long 0x3aa73872,0xbaa7b872,0x323ebbd9,0xb23e3bd9,0x3872baa7,0xb8723aa7,0xbbd9b23e,0x3bd9323e
.long 0x3b64361f,0x3b64361f,0xb61fbb64,0xb61fbb64,0x361fbb64,0x361fbb64,0xbb64361f,0xbb64361f
.long 0x3bd9323e,0xbbd9b23e,0xbaa7b872,0x3aa73872,0x323ebbd9,0xb23e3bd9,0xb8723aa7,0x3872baa7
.long 0x3c00,0x3c00,0x3c00,0x3c00,0x3c008000,0x3c008000,0x3c008000,0x3c008000
.long 0x3aa73872,0xbaa7b872,0x3bd9323e,0xbbd9b23e,0x3872baa7,0xb8723aa7,0x323ebbd9,0xb23e3bd9
.long 0x3b64b61f,0x3b64b61f,0x361fbb64,0x361fbb64,0xb61fbb64,0xb61fbb64,0xbb64b61f,0xbb64b61f
.long 0x323ebbd9,0xb23e3bd9,0xbaa7b872,0x3aa73872,0xbbd9b23e,0x3bd9323e,0xb8723aa7,0x3872baa7
.long 0xb9a8b9a8,0xb9a8b9a8,0xb9a839a8,0xb9a839a8,0xb9a839a8,0xb9a839a8,0x39a839a8,0x39a839a8
.long 0xbbd9323e,0x3bd9b23e,0x38723aa7,0xb872baa7,0x323e3bd9,0xb23ebbd9,0x3aa7b872,0xbaa73872
.long 0xb61f3b64,0xb61f3b64,0x3b64b61f,0x3b64b61f,0x3b64361f,0x3b64361f,0xb61fbb64,0xb61fbb64
.long 0x38723aa7,0xb872baa7,0xb23ebbd9,0x323e3bd9,0x3aa7b872,0xbaa73872,0xbbd9323e,0x3bd9b23e
.long 0x3c00,0x3c00,0x3c00,0x3c00,0x3c008000,0x3c008000,0x3c008000,0x3c008000
.long 0x3bd9b23e,0xbbd9323e,0x3aa7b872,0xbaa73872,0xb23ebbd9,0x323e3bd9,0xb872baa7,0x38723aa7
.long 0xb61fbb64,0xb61fbb64,0xbb64b61f,0xbb64b61f,0xbb64361f,0xbb64361f,0xb61f3b64,0xb61f3b64
.long 0xbaa73872,0x3aa7b872,0x323e3bd9,0xb23ebbd9,0x38723aa7,0xb872baa7,0x3bd9b23e,0xbbd9323e
.long 0x39a839a8,0x39a839a8,0x39a8b9a8,0x39a8b9a8,0x39a8b9a8,0x39a8b9a8,0xb9a8b9a8,0xb9a8b9a8
.long 0x3872baa7,0xb8723aa7,0xbbd9b23e,0x3bd9323e,0xbaa7b872,0x3aa73872,0xb23e3bd9,0x323ebbd9
.long 0xbb64b61f,0xbb64b61f,0x361f3b64,0x361f3b64,0xb61f3b64,0xb61f3b64,0x3b64b61f,0x3b64b61f
.long 0xb23e3bd9,0x323ebbd9,0x3872baa7,0xb8723aa7,0x3bd9323e,0xbbd9b23e,0xbaa7b872,0x3aa73872
.long 0x3c00,0x3c00,0x3c00,0x3c00,0x3c008000,0x3c008000,0x3c008000,0x3c008000
.long 0x3872baa7,0xb8723aa7,0x323ebbd9,0xb23e3bd9,0xbaa7b872,0x3aa73872,0xbbd9b23e,0x3bd9323e
.long 0xbb64361f,0xbb64361f,0xb61f3b64,0xb61f3b64,0x361f3b64,0x361f3b64,0x3b64361f,0x3b64361f
.long 0x3bd9323e,0xbbd9b23e,0x3872baa7,0xb8723aa7,0x323ebbd9,0xb23e3bd9,0xbaa7b872,0x3aa73872
.long 0xb9a8b9a8,0xb9a8b9a8,0xb9a839a8,0xb9a839a8,0xb9a839a8,0xb9a839a8,0x39a839a8,0x39a839a8
.long 0x323e3bd9,0xb23ebbd9,0x3aa7b872,0xbaa73872,0x3bd9b23e,0xbbd9323e,0xb872baa7,0x38723aa7
.long 0x361fbb64,0x361fbb64,0xbb64361f,0xbb64361f,0xbb64b61f,0xbb64b61f,0x361f3b64,0x361f3b64
.long 0xbaa73872,0x3aa7b872,0x3bd9b23e,0xbbd9323e,0x38723aa7,0xb872baa7,0xb23ebbd9,0x323e3bd9
.long 0x3c00,0x3c00,0x3c00,0x3c00,0x3c008000,0x3c008000,0x3c008000,0x3c008000
.long 0x33c63bc3,0xb3c6bbc3,0x381d3add,0xb81dbadd,0x3bc3b3c6,0xbbc333c6,0x3addb81d,0xbadd381d
.long 0x378b3b0e,0x378b3b0e,0x3b0e378b,0x3b0e378b,0x3b0eb78b,0x3b0eb78b,0x378bbb0e,0x378bbb0e
.long 0x395f39ed,0xb95fb9ed,0x3bfeaa48,0xbbfe2a48,0x39edb95f,0xb9ed395f,0xaa48bbfe,0x2a483bfe
.long 0x3aa73872,0x3aa73872,0x3aa7b872,0x3aa7b872,0x3872baa7,0x3872baa7,0xb872baa7,0xb872baa7
.long 0x3b883564,0xbb88b564,0x36d7bb3b,0xb6d73b3b,0x3564bb88,0xb5643b88,0xbb3bb6d7,0x3b3b36d7
.long 0x3bf62e46,0x3bf62e46,0xae46bbf6,0xae46bbf6,0x2e46bbf6,0x2e46bbf6,0xbbf62e46,0xbbf62e46
.long 0x3beab0b2,0xbbea30b2,0xb8c4ba6d,0x38c43a6d,0xb0b2bbea,0x30b23bea,0xba6d38c4,0x3a6db8c4
.long 0x3c00,0x3c00,0x3c00,0x3c00,0x3c008000,0x3c008000,0x3c008000,0x3c008000
.long 0x3add381d,0xbaddb81d,0x3bc333c6,0xbbc3b3c6,0x381dbadd,0xb81d3add,0x33c6bbc3,0xb3c63bc3
.long 0x3b0eb78b,0x3b0eb78b,0x378bbb0e,0x378bbb0e,0xb78bbb0e,0xb78bbb0e,0xbb0eb78b,0xbb0eb78b
.long 0x2a48bbfe,0xaa483bfe,0xb9edb95f,0x39ed395f,0xbbfeaa48,0x3bfe2a48,0xb95f39ed,0x395fb9ed
.long 0xbaa7b872,0xbaa7b872,0xbaa73872,0xbaa73872,0xb8723aa7,0xb8723aa7,0x38723aa7,0x38723aa7
.long 0xbb3b36d7,0x3b3bb6d7,0x35643b88,0xb564bb88,0x36d73b3b,0xb6d7bb3b,0x3b88b564,0xbb883564
.long 0xae463bf6,0xae463bf6,0x3bf6ae46,0x3bf6ae46,0x3bf62e46,0x3bf62e46,0xae46bbf6,0xae46bbf6
.long 0x3a6d38c4,0xba6db8c4,0x30b2bbea,0xb0b23bea,0x38c4ba6d,0xb8c43a6d,0xbbeab0b2,0x3bea30b2
.long 0x3c00,0x3c00,0x3c00,0x3c00,0x3c008000,0x3c008000,0x3c008000,0x3c008000
.long 0x3bc3b3c6,0xbbc333c6,0x3addb81d,0xbadd381d,0xb3c6bbc3,0x33c63bc3,0xb81dbadd,0x381d3add
.long 0xb78bbb0e,0xb78bbb0e,0xbb0eb78b,0xbb0eb78b,0xbb0e378b,0xbb0e378b,0xb78b3b0e,0xb78b3b0e
.long 0xb9ed395f,0x39edb95f,0x2a483bfe,0xaa48bbfe,0x395f39ed,0xb95fb9ed,0x3bfeaa48,0xbbfe2a48
.long 0x3aa73872,0x3aa73872,0x3aa7b872,0x3aa7b872,0x3872baa7,0x3872baa7,0xb872baa7,0xb872baa7
.long 0x3564bb88,0xb5643b88,0xbb3bb6d7,0x3b3b36d7,0xbb88b564,0x3b883564,0xb6d73b3b,0x36d7bb3b
.long 0xbbf6ae46,0xbbf6ae46,0x2e463bf6,0x2e463bf6,0xae463bf6,0xae463bf6,0x3bf6ae46,0x3bf6ae46
.long 0x30b23bea,0xb0b2bbea,0x3a6db8c4,0xba6d38c4,0x3beab0b2,0xbbea30b2,0xb8c4ba6d,0x38c43a6d
.long 0x3c00,0x3c00,0x3c00,0x3c00,0x3c008000,0x3c008000,0x3c008000,0x3c008000
.long 0x381dbadd,0xb81d3add,0x33c6bbc3,0xb3c63bc3,0xbaddb81d,0x3add381d,0xbbc3b3c6,0x3bc333c6
.long 0xbb0e378b,0xbb0e378b,0xb78b3b0e,0xb78b3b0e,0x378b3b0e,0x378b3b0e,0x3b0e378b,0x3b0e378b
.long 0x3bfe2a48,0xbbfeaa48,0x395fb9ed,0xb95f39ed,0x2a48bbfe,0xaa483bfe,0xb9edb95f,0x39ed395f
.long 0xbaa7b872,0xbaa7b872,0xbaa73872,0xbaa73872,0xb8723aa7,0xb8723aa7,0x38723aa7,0x38723aa7
.long 0x36d73b3b,0xb6d7bb3b,0x3b88b564,0xbb883564,0x3b3bb6d7,0xbb3b36d7,0xb564bb88,0x35643b88
.long 0x2e46bbf6,0x2e46bbf6,0xbbf62e46,0xbbf62e46,0xbbf6ae46,0xbbf6ae46,0x2e463bf6,0x2e463bf6
.long 0xb8c43a6d,0x38c4ba6d,0x3bea30b2,0xbbeab0b2,0x3a6d38c4,0xba6db8c4,0x30b2bbea,0xb0b23bea
.long 0x3c00,0x3c00,0x3c00,0x3c00,0x3c008000,0x3c008000,0x3c008000,0x3c008000
.long 0x34a53ba8,0xb4a5bba8,0x378b3b0e,0xb78bbb0e,0x3ba8b4a5,0xbba834a5,0x3b0eb78b,0xbb0e378b
.long 0x38723aa7,0x38723aa7,0x3aa73872,0x3aa73872,0x3aa7b872,0x3aa7b872,0x3872baa7,0x3872baa7
.long 0x3a2f3913,0xba2fb913,0x3bf62e46,0xbbf6ae46,0x3913ba2f,0xb9133a2f,0x2e46bbf6,0xae463bf6
.long 0x3b64361f,0x3b64361f,0x3b64b61f,0x3b64b61f,0x361fbb64,0x361fbb64,0xb61fbb64,0xb61fbb64
.long 0x3bf62e46,0xbbf6ae46,0x3913ba2f,0xb9133a2f,0x2e46bbf6,0xae463bf6,0xba2fb913,0x3a2f3913
.long 0x3bd9b23e,0x3bd9b23e,0x323ebbd9,0x323ebbd9,0xb23ebbd9,0xb23ebbd9,0xbbd9b23e,0xbbd9b23e
.long 0x3b0eb78b,0xbb0e378b,0xb4a5bba8,0x34a53ba8,0xb78bbb0e,0x378b3b0e,0xbba834a5,0x3ba8b4a5
.long 0x3c00,0x3c00,0x3c00,0x3c00,0x3c008000,0x3c008000,0x3c008000,0x3c008000
.long 0x3b0e378b,0xbb0eb78b,0x3ba834a5,0xbba8b4a5,0x378bbb0e,0xb78b3b0e,0x34a5bba8,0xb4a53ba8
.long 0x3aa7b872,0x3aa7b872,0x3872baa7,0x3872baa7,0xb872baa7,0xb872baa7,0xbaa7b872,0xbaa7b872
.long 0xae46bbf6,0x2e463bf6,0xb913ba2f,0x39133a2f,0xbbf62e46,0x3bf6ae46,0xba2f3913,0x3a2fb913
.long 0xbb64b61f,0xbb64b61f,0xbb64361f,0xbb64361f,0xb61f3b64,0xb61f3b64,0x361f3b64,0x361f3b64
.long 0xba2f3913,0x3a2fb913,0x2e463bf6,0xae46bbf6,0x39133a2f,0xb913ba2f,0x3bf6ae46,0xbbf62e46
.long 0x323e3bd9,0x323e3bd9,0x3bd9323e,0x3bd9323e,0x3bd9b23e,0x3bd9b23e,0x323ebbd9,0x323ebbd9
.long 0x3ba834a5,0xbba8b4a5,0x378bbb0e,0xb78b3b0e,0x34a5bba8,0xb4a53ba8,0xbb0eb78b,0x3b0e378b
.long 0x3c00,0x3c00,0x3c00,0x3c00,0x3c008000,0x3c008000,0x3c008000,0x3c008000
.long 0x3ba8b4a5,0xbba834a5,0x3b0eb78b,0xbb0e378b,0xb4a5bba8,0x34a53ba8,0xb78bbb0e,0x378b3b0e
.long 0xb872baa7,0xb872baa7,0xbaa7b872,0xbaa7b872,0xbaa73872,0xbaa73872,0xb8723aa7,0xb8723aa7
.long 0xb9133a2f,0x3913ba2f,0xae463bf6,0x2e46bbf6,0x3a2f3913,0xba2fb913,0x3bf62e46,0xbbf6ae46
.long 0x3b64361f,0x3b64361f,0x3b64b61f,0x3b64b61f,0x361fbb64,0x361fbb64,0xb61fbb64,0xb61fbb64
.long 0x2e46bbf6,0xae463bf6,0xba2fb913,0x3a2f3913,0xbbf6ae46,0x3bf62e46,0xb9133a2f,0x3913ba2f
.long 0xbbd9323e,0xbbd9323e,0xb23e3bd9,0xb23e3bd9,0x323e3bd9,0x323e3bd9,0x3bd9323e,0x3bd9323e
.long 0x378b3b0e,0xb78bbb0e,0x3ba8b4a5,0xbba834a5,0x3b0eb78b,0xbb0e378b,0xb4a5bba8,0x34a53ba8
.long 0x3c00,0x3c00,0x3c00,0x3c00,0x3c008000,0x3c008000,0x3c008000,0x3c008000
.long 0x378bbb0e,0xb78b3b0e,0x34a5bba8,0xb4a53ba8,0xbb0eb78b,0x3b0e378b,0xbba8b4a5,0x3ba834a5
.long 0xbaa73872,0xbaa73872,0xb8723aa7,0xb8723aa7,0x38723aa7,0x38723aa7,0x3aa73872,0x3aa73872
.long 0x3bf6ae46,0xbbf62e46,0x3a2fb913,0xba2f3913,0xae46bbf6,0x2e463bf6,0xb913ba2f,0x39133a2f
.long 0xbb64b61f,0xbb64b61f,0xbb64361f,0xbb64361f,0xb61f3b64,0xb61f3b64,0x361f3b64,0x361f3b64
.long 0x39133a2f,0xb913ba2f,0x3bf6ae46,0xbbf62e46,0x3a2fb913,0xba2f3913,0xae46bbf6,0x2e463bf6
.long 0xb23ebbd9,0xb23ebbd9,0xbbd9b23e,0xbbd9b23e,0xbbd9323e,0xbbd9323e,0xb23e3bd9,0xb23e3bd9
.long 0xb4a53ba8,0x34a5bba8,0x3b0e378b,0xbb0eb78b,0x3ba834a5,0xbba8b4a5,0x378bbb0e,0xb78b3b0e
.long 0x3c00,0x3c00,0x3c00,0x3c00,0x3c008000,0x3c008000,0x3c008000,0x3c008000
.long 0x35643b88,0xb564bb88,0x36d73b3b,0xb6d7bb3b,0x3b88b564,0xbb883564,0x3b3bb6d7,0xbb3b36d7
.long 0x39133a2f,0x39133a2f,0x3a2f3913,0x3a2f3913,0x3a2fb913,0x3a2fb913,0x3913ba2f,0x3913ba2f
.long 0x3add381d,0xbaddb81d,0x3bc333c6,0xbbc3b3c6,0x381dbadd,0xb81d3add,0x33c6bbc3,0xb3c63bc3
.long 0x3bd9323e,0x3bd9323e,0x3bd9b23e,0x3bd9b23e,0x323ebbd9,0x323ebbd9,0xb23ebbd9,0xb23ebbd9
.long 0x3beab0b2,0xbbea30b2,0x3a6db8c4,0xba6d38c4,0xb0b2bbea,0x30b23bea,0xb8c4ba6d,0x38c43a6d
.long 0x3b0eb78b,0x3b0eb78b,0x378bbb0e,0x378bbb0e,0xb78bbb0e,0xb78bbb0e,0xbb0eb78b,0xbb0eb78b
.long 0x395fb9ed,0xb95f39ed,0x2a48bbfe,0xaa483bfe,0xb9edb95f,0x39ed395f,0xbbfeaa48,0x3bfe2a48
.long 0x3c00,0x3c00,0x3c00,0x3c00,0x3c008000,0x3c008000,0x3c008000,0x3c008000
.long 0x3b3b36d7,0xbb3bb6d7,0x3b883564,0xbb88b564,0x36d7bb3b,0xb6d73b3b,0x3564bb88,0xb5643b88
.long 0x3a2fb913,0x3a2fb913,0x3913ba2f,0x3913ba2f,0xb913ba2f,0xb913ba2f,0xba2fb913,0xba2fb913
.long 0xb3c6bbc3,0x33c63bc3,0xb81dbadd,0x381d3add,0xbbc333c6,0x3bc3b3c6,0xbadd381d,0x3addb81d
.long 0xbbd9b23e,0xbbd9b23e,0xbbd9323e,0xbbd9323e,0xb23e3bd9,0xb23e3bd9,0x323e3bd9,0x323e3bd9
.long 0xb8c43a6d,0x38c4ba6d,0xb0b23bea,0x30b2bbea,0x3a6d38c4,0xba6db8c4,0x3bea30b2,0xbbeab0b2
.long 0x378b3b0e,0x378b3b0e,0x3b0e378b,0x3b0e378b,0x3b0eb78b,0x3b0eb78b,0x378bbb0e,0x378bbb0e
.long 0x3bfeaa48,0xbbfe2a48,0x39edb95f,0xb9ed395f,0xaa48bbfe,0x2a483bfe,0xb95fb9ed,0x395f39ed
.long 0x3c00,0x3c00,0x3c00,0x3c00,0x3c008000,0x3c008000,0x3c008000,0x3c008000
.long 0x3b88b564,0xbb883564,0x3b3bb6d7,0xbb3b36d7,0xb564bb88,0x35643b88,0xb6d7bb3b,0x36d73b3b
.long 0xb913ba2f,0xb913ba2f,0xba2fb913,0xba2fb913,0xba2f3913,0xba2f3913,0xb9133a2f,0xb9133a2f
.long 0xb81d3add,0x381dbadd,0xb3c63bc3,0x33c6bbc3,0x3add381d,0xbaddb81d,0x3bc333c6,0xbbc3b3c6
.long 0x3bd9323e,0x3bd9323e,0x3bd9b23e,0x3bd9b23e,0x323ebbd9,0x323ebbd9,0xb23ebbd9,0xb23ebbd9
.long 0xb0b2bbea,0x30b23bea,0xb8c4ba6d,0x38c43a6d,0xbbea30b2,0x3beab0b2,0xba6d38c4,0x3a6db8c4
.long 0xbb0e378b,0xbb0e378b,0xb78b3b0e,0xb78b3b0e,0x378b3b0e,0x378b3b0e,0x3b0e378b,0x3b0e378b
.long 0x39ed395f,0xb9edb95f,0x3bfe2a48,0xbbfeaa48,0x395fb9ed,0xb95f39ed,0x2a48bbfe,0xaa483bfe
.long 0x3c00,0x3c00,0x3c00,0x3c00,0x3c008000,0x3c008000,0x3c008000,0x3c008000
.long 0x36d7bb3b,0xb6d73b3b,0x3564bb88,0xb5643b88,0xbb3bb6d7,0x3b3b36d7,0xbb88b564,0x3b883564
.long 0xba2f3913,0xba2f3913,0xb9133a2f,0xb9133a2f,0x39133a2f,0x39133a2f,0x3a2f3913,0x3a2f3913
.long 0x3bc3b3c6,0xbbc333c6,0x3addb81d,0xbadd381d,0xb3c6bbc3,0x33c63bc3,0xb81dbadd,0x381d3add
.long 0xbbd9b23e,0xbbd9b23e,0xbbd9323e,0xbbd9323e,0xb23e3bd9,0xb23e3bd9,0x323e3bd9,0x323e3bd9
.long 0x3a6d38c4,0xba6db8c4,0x3bea30b2,0xbbeab0b2,0x38c4ba6d,0xb8c43a6d,0x30b2bbea,0xb0b23bea
.long 0xb78bbb0e,0xb78bbb0e,0xbb0eb78b,0xbb0eb78b,0xbb0e378b,0xbb0e378b,0xb78b3b0e,0xb78b3b0e
.long 0x2a483bfe,0xaa48bbfe,0x395f39ed,0xb95fb9ed,0x3bfeaa48,0xbbfe2a48,0x39edb95f,0xb9ed395f
.long 0x3c00,0x3c00,0x3c00,0x3c00,0x3c00,0x3c00,0x3c00,0x3c00
.long 0x3c00,0xbc00,0x3b64,0xbb64,0x8000,0x8000,0xb61f,0x361f
.long 0x3c00,0x3c00,0x39a8,0x39a8,0x8000,0x8000,0xb9a8,0xb9a8
.long 0x3c00,0xbc00,0x361f,0xb61f,0x8000,0x8000,0xbb64,0x3b64
.long 0x3c000000,0x0,0x3bd90000,0xb23e0000,0x80000000,0xbc000000,0xb23e0000,0xbbd90000
.long 0x3c000000,0x80000000,0x3aa70000,0x38720000,0x80000000,0x3c000000,0xb8720000,0x3aa70000
.long 0x3c000000,0x0,0x38720000,0xbaa70000,0x80000000,0xbc000000,0xbaa70000,0xb8720000
.long 0x3c000000,0x80000000,0x323e0000,0x3bd90000,0x80000000,0x3c000000,0xbbd90000,0x323e0000
.long 0x3c00,0x3c00,0x3c00,0x3c00,0xbc00,0xbc00,0xbc00,0xbc00
.long 0x39a8,0xb9a8,0x361f,0xb61f,0xb9a8,0x39a8,0xbb64,0x3b64
.long 0x0,0x0,0xb9a8,0xb9a8,0xbc00,0xbc00,0xb9a8,0xb9a8
.long 0xb9a8,0x39a8,0xbb64,0x3b64,0xb9a8,0x39a8,0x361f,0xb61f
.long 0x3b640000,0xb61f0000,0x3aa70000,0xb8720000,0xb61f0000,0xbb640000,0xb8720000,0xbaa70000
.long 0x361f0000,0x3b640000,0xb23e0000,0x3bd90000,0xbb640000,0x361f0000,0xbbd90000,0xb23e0000
.long 0xb61f0000,0xbb640000,0xbbd90000,0xb23e0000,0xbb640000,0x361f0000,0xb23e0000,0x3bd90000
.long 0xbb640000,0x361f0000,0xb8720000,0xbaa70000,0xb61f0000,0xbb640000,0x3aa70000,0xb8720000
.long 0x3c00,0x3c00,0x3c00,0x3c00,0x3c00,0x3c00,0x3c00,0x3c00
.long 0x0,0x8000,0xb61f,0x361f,0xbc00,0x3c00,0xbb64,0x3b64
.long 0xbc00,0xbc00,0xb9a8,0xb9a8,0x8000,0x8000,0x39a8,0x39a8
.long 0x8000,0x0,0x3b64,0xbb64,0x3c00,0xbc00,0x361f,0xb61f
.long 0x39a80000,0xb9a80000,0x38720000,0xbaa70000,0xb9a80000,0xb9a80000,0xbaa70000,0xb8720000
.long 0xb9a80000,0x39a80000,0xbbd90000,0x323e0000,0xb9a80000,0xb9a80000,0xb23e0000,0xbbd90000
.long 0xb9a80000,0x39a80000,0x323e0000,0x3bd90000,0x39a80000,0x39a80000,0x3bd90000,0xb23e0000
.long 0x39a80000,0xb9a80000,0x3aa70000,0x38720000,0x39a80000,0x39a80000,0xb8720000,0x3aa70000
.long 0x3c00,0x3c00,0x3c00,0x3c00,0xbc00,0xbc00,0xbc00,0xbc00
.long 0xb9a8,0x39a8,0xbb64,0x3b64,0xb9a8,0x39a8,0xb61f,0x361f
.long 0x8000,0x8000,0x39a8,0x39a8,0x3c00,0x3c00,0x39a8,0x39a8
.long 0x39a8,0xb9a8,0xb61f,0x361f,0xb9a8,0x39a8,0xbb64,0x3b64
.long 0x361f0000,0xbb640000,0x323e0000,0xbbd90000,0xbb640000,0xb61f0000,0xbbd90000,0xb23e0000
.long 0xbb640000,0xb61f0000,0xb8720000,0xbaa70000,0x361f0000,0xbb640000,0x3aa70000,0xb8720000
.long 0x3b640000,0x361f0000,0x3aa70000,0xb8720000,0x361f0000,0xbb640000,0xb8720000,0xbaa70000
.long 0xb61f0000,0x3b640000,0xbbd90000,0xb23e0000,0xbb640000,0xb61f0000,0x323e0000,0xbbd90000
.long 0x3c00,0x3c00,0x3c00,0x3c00,0x3c00,0x3c00,0x3c00,0x3c00
.long 0x3bfe,0xbbfe,0x39ed,0xb9ed,0xaa48,0x2a48,0xb95f,0x395f
.long 0x3bf6,0x3bf6,0x2e46,0x2e46,0xae46,0xae46,0xbbf6,0xbbf6
.long 0x3bea,0xbbea,0xb8c4,0x38c4,0xb0b2,0x30b2,0xba6d,0x3a6d
.long 0x3bff0000,0xa6480000,0x3b770000,0xb5c20000,0xa6480000,0xbbff0000,0xb5c20000,0xbb770000
.long 0x3bfa0000,0x2cb50000,0x37320000,0x3b250000,0xacb50000,0x3bfa0000,0xbb250000,0x37320000
.long 0x3bf10000,0xafd60000,0xb4440000,0xbbb60000,0xafd60000,0xbbf10000,0xbbb60000,0x34440000
.long 0x3be20000,0x31790000,0xbac20000,0x38480000,0xb1790000,0x3be20000,0xb8480000,0xbac20000
.long 0x3c00,0x3c00,0x3c00,0x3c00,0xbc00,0xbc00,0xbc00,0xbc00
.long 0x395f,0xb95f,0x2a48,0xaa48,0xb9ed,0x39ed,0xbbfe,0x3bfe
.long 0xae46,0xae46,0xbbf6,0xbbf6,0xbbf6,0xbbf6,0xae46,0xae46
.long 0xba6d,0x3a6d,0xb0b2,0x30b2,0xb8c4,0x38c4,0x3bea,0xbbea
.long 0x3b500000,0xb67c0000,0x39cb0000,0xb9840000,0xb67c0000,0xbb500000,0xb9840000,0xb9cb0000
.long 0x35050000,0x3b990000,0xb93a0000,0x3a0f0000,0xbb990000,0x35050000,0xba0f0000,0xb93a0000
.long 0xb7e30000,0xbaf60000,0xba4f0000,0x38ec0000,0xbaf60000,0x37e30000,0x38ec0000,0x3a4f0000
.long 0xbbce0000,0x33030000,0x389b0000,0xba8a0000,0xb3030000,0xbbce0000,0x3a8a0000,0x389b0000
.long 0x3c00,0x3c00,0x3c00,0x3c00,0x3c00,0x3c00,0x3c00,0x3c00
.long 0xaa48,0x2a48,0xb95f,0x395f,0xbbfe,0x3bfe,0xb9ed,0x39ed
.long 0xbbf6,0xbbf6,0xae46,0xae46,0x2e46,0x2e46,0x3bf6,0x3bf6
.long 0x30b2,0xb0b2,0x3a6d,0xba6d,0x3bea,0xbbea,0xb8c4,0x38c4
.long 0x39840000,0xb9cb0000,0x367c0000,0xbb500000,0xb9cb0000,0xb9840000,0xbb500000,0xb67c0000
.long 0xba0f0000,0x393a0000,0xbb990000,0xb5050000,0xb93a0000,0xba0f0000,0x35050000,0xbb990000
.long 0xb8ec0000,0x3a4f0000,0x3af60000,0x37e30000,0x3a4f0000,0x38ec0000,0x37e30000,0xbaf60000
.long 0x3a8a0000,0xb89b0000,0xb3030000,0x3bce0000,0x389b0000,0x3a8a0000,0xbbce0000,0xb3030000
.long 0x3c00,0x3c00,0x3c00,0x3c00,0xbc00,0xbc00,0xbc00,0xbc00
.long 0xb9ed,0x39ed,0xbbfe,0x3bfe,0xb95f,0x395f,0xaa48,0x2a48
.long 0x2e46,0x2e46,0x3bf6,0x3bf6,0x3bf6,0x3bf6,0x2e46,0x2e46
.long 0x38c4,0xb8c4,0xbbea,0x3bea,0xba6d,0x3a6d,0xb0b2,0x30b2
.long 0x35c20000,0xbb770000,0x26480000,0xbbff0000,0xbb770000,0xb5c20000,0xbbff0000,0xa6480000
.long 0xbb250000,0xb7320000,0xacb50000,0xbbfa0000,0x37320000,0xbb250000,0x3bfa0000,0xacb50000
.long 0x3bb60000,0x34440000,0x2fd60000,0xbbf10000,0x34440000,0xbbb60000,0xbbf10000,0xafd60000
.long 0xb8480000,0x3ac20000,0xb1790000,0xbbe20000,0xbac20000,0xb8480000,0x3be20000,0xb1790000
.long 0x3c00,0x3c00,0x3c00,0x3c00,0x3c00,0x3c00,0x3c00,0x3c00
.long 0x3bf6,0xbbf6,0x3a2f,0xba2f,0xae46,0x2e46,0xb913,0x3913
.long 0x3bd9,0x3bd9,0x323e,0x323e,0xb23e,0xb23e,0xbbd9,0xbbd9
.long 0x3ba8,0xbba8,0xb78b,0x378b,0xb4a5,0x34a5,0xbb0e,0x3b0e
.long 0x3bfe0000,0xaa480000,0x3b880000,0xb5640000,0xaa480000,0xbbfe0000,0xb5640000,0xbb880000
.long 0x3bea0000,0x30b20000,0x381d0000,0x3add0000,0xb0b20000,0x3bea0000,0xbadd0000,0x381d0000
.long 0x3bc30000,0xb3c60000,0xb0b20000,0xbbea0000,0xb3c60000,0xbbc30000,0xbbea0000,0x30b20000
.long 0x3b880000,0x35640000,0xb9ed0000,0x395f0000,0xb5640000,0x3b880000,0xb95f0000,0xb9ed0000
.long 0x3c00,0x3c00,0x3c00,0x3c00,0xbc00,0xbc00,0xbc00,0xbc00
.long 0x3913,0xb913,0x2e46,0xae46,0xba2f,0x3a2f,0xbbf6,0x3bf6
.long 0xb23e,0xb23e,0xbbd9,0xbbd9,0xbbd9,0xbbd9,0xb23e,0xb23e
.long 0xbb0e,0x3b0e,0xb4a5,0x34a5,0xb78b,0x378b,0x3ba8,0xbba8
.long 0x3b3b0000,0xb6d70000,0x39ed0000,0xb95f0000,0xb6d70000,0xbb3b0000,0xb95f0000,0xb9ed0000
.long 0x33c60000,0x3bc30000,0xb8c40000,0x3a6d0000,0xbbc30000,0x33c60000,0xba6d0000,0xb8c40000
.long 0xb8c40000,0xba6d0000,0xbadd0000,0x381d0000,0xba6d0000,0x38c40000,0x381d0000,0x3add0000
.long 0xbbfe0000,0x2a480000,0x36d70000,0xbb3b0000,0xaa480000,0xbbfe0000,0x3b3b0000,0x36d70000
.long 0x3c00,0x3c00,0x3c00,0x3c00,0x3c00,0x3c00,0x3c00,0x3c00
.long 0xae46,0x2e46,0xb913,0x3913,0xbbf6,0x3bf6,0xba2f,0x3a2f
.long 0xbbd9,0xbbd9,0xb23e,0xb23e,0x323e,0x323e,0x3bd9,0x3bd9
.long 0x34a5,0xb4a5,0x3b0e,0xbb0e,0x3ba8,0xbba8,0xb78b,0x378b
.long 0x395f0000,0xb9ed0000,0x36d70000,0xbb3b0000,0xb9ed0000,0xb95f0000,0xbb3b0000,0xb6d70000
.long 0xba6d0000,0x38c40000,0xbbc30000,0xb3c60000,0xb8c40000,0xba6d0000,0x33c60000,0xbbc30000
.long 0xb81d0000,0x3add0000,0x3a6d0000,0x38c40000,0x3add0000,0x381d0000,0x38c40000,0xba6d0000
.long 0x3b3b0000,0xb6d70000,0xaa480000,0x3bfe0000,0x36d70000,0x3b3b0000,0xbbfe0000,0xaa480000
.long 0x3c00,0x3c00,0x3c00,0x3c00,0xbc00,0xbc00,0xbc00,0xbc00
.long 0xba2f,0x3a2f,0xbbf6,0x3bf6,0xb913,0x3913,0xae46,0x2e46
.long 0x323e,0x323e,0x3bd9,0x3bd9,0x3bd9,0x3bd9,0x323e,0x323e
.long 0x378b,0xb78b,0xbba8,0x3ba8,0xbb0e,0x3b0e,0xb4a5,0x34a5
.long 0x35640000,0xbb880000,0x2a480000,0xbbfe0000,0xbb880000,0xb5640000,0xbbfe0000,0xaa480000
.long 0xbadd0000,0xb81d0000,0xb0b20000,0xbbea0000,0x381d0000,0xbadd0000,0x3bea0000,0xb0b20000
.long 0x3bea0000,0x30b20000,0x33c60000,0xbbc30000,0x30b20000,0xbbea0000,0xbbc30000,0xb3c60000
.long 0xb95f0000,0x39ed0000,0xb5640000,0xbb880000,0xb9ed0000,0xb95f0000,0x3b880000,0xb5640000
.long 0x3c00,0x3c00,0x3c00,0x3c00,0x3c00,0x3c00,0x3c00,0x3c00
.long 0x3bea,0xbbea,0x3a6d,0xba6d,0xb0b2,0x30b2,0xb8c4,0x38c4
.long 0x3ba8,0x3ba8,0x34a5,0x34a5,0xb4a5,0xb4a5,0xbba8,0xbba8
.long 0x3b3b,0xbb3b,0xb564,0x3564,0xb6d7,0x36d7,0xbb88,0x3b88
.long 0x3bfa0000,0xacb50000,0x3b990000,0xb5050000,0xacb50000,0xbbfa0000,0xb5050000,0xbb990000
.long 0x3bce0000,0x33030000,0x389b0000,0x3a8a0000,0xb3030000,0x3bce0000,0xba8a0000,0x389b0000
.long 0x3b770000,0xb5c20000,0xa6480000,0xbbff0000,0xb5c20000,0xbb770000,0xbbff0000,0x26480000
.long 0x3af60000,0x37e30000,0xb8ec0000,0x3a4f0000,0xb7e30000,0x3af60000,0xba4f0000,0xb8ec0000
.long 0x3c00,0x3c00,0x3c00,0x3c00,0xbc00,0xbc00,0xbc00,0xbc00
.long 0x38c4,0xb8c4,0x30b2,0xb0b2,0xba6d,0x3a6d,0xbbea,0x3bea
.long 0xb4a5,0xb4a5,0xbba8,0xbba8,0xbba8,0xbba8,0xb4a5,0xb4a5
.long 0xbb88,0x3b88,0xb6d7,0x36d7,0xb564,0x3564,0x3b3b,0xbb3b
.long 0x3b250000,0xb7320000,0x3a0f0000,0xb93a0000,0xb7320000,0xbb250000,0xb93a0000,0xba0f0000
.long 0x31790000,0x3be20000,0xb8480000,0x3ac20000,0xbbe20000,0x31790000,0xbac20000,0xb8480000
.long 0xb9840000,0xb9cb0000,0xbb500000,0x367c0000,0xb9cb0000,0x39840000,0x367c0000,0x3b500000
.long 0xbbf10000,0xafd60000,0x34440000,0xbbb60000,0x2fd60000,0xbbf10000,0x3bb60000,0x34440000
.long 0x3c00,0x3c00,0x3c00,0x3c00,0x3c00,0x3c00,0x3c00,0x3c00
.long 0xb0b2,0x30b2,0xb8c4,0x38c4,0xbbea,0x3bea,0xba6d,0x3a6d
.long 0xbba8,0xbba8,0xb4a5,0xb4a5,0x34a5,0x34a5,0x3ba8,0x3ba8
.long 0x36d7,0xb6d7,0x3b88,0xbb88,0x3b3b,0xbb3b,0xb564,0x3564
.long 0x393a0000,0xba0f0000,0x37320000,0xbb250000,0xba0f0000,0xb93a0000,0xbb250000,0xb7320000
.long 0xbac20000,0x38480000,0xbbe20000,0xb1790000,0xb8480000,0xbac20000,0x31790000,0xbbe20000
.long 0xb67c0000,0x3b500000,0x39cb0000,0x39840000,0x3b500000,0x367c0000,0x39840000,0xb9cb0000
.long 0x3bb60000,0xb4440000,0x2fd60000,0x3bf10000,0x34440000,0x3bb60000,0xbbf10000,0x2fd60000
.long 0x3c00,0x3c00,0x3c00,0x3c00,0xbc00,0xbc00,0xbc00,0xbc00
.long 0xba6d,0x3a6d,0xbbea,0x3bea,0xb8c4,0x38c4,0xb0b2,0x30b2
.long 0x34a5,0x34a5,0x3ba8,0x3ba8,0x3ba8,0x3ba8,0x34a5,0x34a5
.long 0x3564,0xb564,0xbb3b,0x3b3b,0xbb88,0x3b88,0xb6d7,0x36d7
.long 0x35050000,0xbb990000,0x2cb50000,0xbbfa0000,0xbb990000,0xb5050000,0xbbfa0000,0xacb50000
.long 0xba8a0000,0xb89b0000,0xb3030000,0xbbce0000,0x389b0000,0xba8a0000,0x3bce0000,0xb3030000
.long 0x3bff0000,0x26480000,0x35c20000,0xbb770000,0x26480000,0xbbff0000,0xbb770000,0xb5c20000
.long 0xba4f0000,0x38ec0000,0xb7e30000,0xbaf60000,0xb8ec0000,0xba4f0000,0x3af60000,0xb7e30000
.long 0x3c00,0x3c00,0x3c00,0x3c00,0x3c00,0x3c00,0x3c00,0x3c00
.long 0x3bd9,0xbbd9,0x3aa7,0xbaa7,0xb23e,0x323e,0xb872,0x3872
.long 0x3b64,0x3b64,0x361f,0x361f,0xb61f,0xb61f,0xbb64,0xbb64
.long 0x3aa7,0xbaa7,0xb23e,0x323e,0xb872,0x3872,0xbbd9,0x3bd9
.long 0x3bf60000,0xae460000,0x3ba80000,0xb4a50000,0xae460000,0xbbf60000,0xb4a50000,0xbba80000
.long 0x3ba80000,0x34a50000,0x39130000,0x3a2f0000,0xb4a50000,0x3ba80000,0xba2f0000,0x39130000
.long 0x3b0e0000,0xb78b0000,0x2e460000,0xbbf60000,0xb78b0000,0xbb0e0000,0xbbf60000,0xae460000
.long 0x3a2f0000,0x39130000,0xb78b0000,0x3b0e0000,0xb9130000,0x3a2f0000,0xbb0e0000,0xb78b0000
.long 0x3c00,0x3c00,0x3c00,0x3c00,0xbc00,0xbc00,0xbc00,0xbc00
.long 0x3872,0xb872,0x323e,0xb23e,0xbaa7,0x3aa7,0xbbd9,0x3bd9
.long 0xb61f,0xb61f,0xbb64,0xbb64,0xbb64,0xbb64,0xb61f,0xb61f
.long 0xbbd9,0x3bd9,0xb872,0x3872,0xb23e,0x323e,0x3aa7,0xbaa7
.long 0x3b0e0000,0xb78b0000,0x3a2f0000,0xb9130000,0xb78b0000,0xbb0e0000,0xb9130000,0xba2f0000
.long 0x2e460000,0x3bf60000,0xb78b0000,0x3b0e0000,0xbbf60000,0x2e460000,0xbb0e0000,0xb78b0000
.long 0xba2f0000,0xb9130000,0xbba80000,0x34a50000,0xb9130000,0x3a2f0000,0x34a50000,0x3ba80000
.long 0xbba80000,0xb4a50000,0x2e460000,0xbbf60000,0x34a50000,0xbba80000,0x3bf60000,0x2e460000
.long 0x3c00,0x3c00,0x3c00,0x3c00,0x3c00,0x3c00,0x3c00,0x3c00
.long 0xb23e,0x323e,0xb872,0x3872,0xbbd9,0x3bd9,0xbaa7,0x3aa7
.long 0xbb64,0xbb64,0xb61f,0xb61f,0x361f,0x361f,0x3b64,0x3b64
.long 0x3872,0xb872,0x3bd9,0xbbd9,0x3aa7,0xbaa7,0xb23e,0x323e
.long 0x39130000,0xba2f0000,0x378b0000,0xbb0e0000,0xba2f0000,0xb9130000,0xbb0e0000,0xb78b0000
.long 0xbb0e0000,0x378b0000,0xbbf60000,0xae460000,0xb78b0000,0xbb0e0000,0x2e460000,0xbbf60000
.long 0xb4a50000,0x3ba80000,0x39130000,0x3a2f0000,0x3ba80000,0x34a50000,0x3a2f0000,0xb9130000
.long 0x3bf60000,0xae460000,0x34a50000,0x3ba80000,0x2e460000,0x3bf60000,0xbba80000,0x34a50000
.long 0x3c00,0x3c00,0x3c00,0x3c00,0xbc00,0xbc00,0xbc00,0xbc00
.long 0xbaa7,0x3aa7,0xbbd9,0x3bd9,0xb872,0x3872,0xb23e,0x323e
.long 0x361f,0x361f,0x3b64,0x3b64,0x3b64,0x3b64,0x361f,0x361f
.long 0x323e,0xb23e,0xbaa7,0x3aa7,0xbbd9,0x3bd9,0xb872,0x3872
.long 0x34a50000,0xbba80000,0x2e460000,0xbbf60000,0xbba80000,0xb4a50000,0xbbf60000,0xae460000
.long 0xba2f0000,0xb9130000,0xb4a50000,0xbba80000,0x39130000,0xba2f0000,0x3ba80000,0xb4a50000
.long 0x3bf60000,0xae460000,0x378b0000,0xbb0e0000,0xae460000,0xbbf60000,0xbb0e0000,0xb78b0000
.long 0xbb0e0000,0x378b0000,0xb9130000,0xba2f0000,0xb78b0000,0xbb0e0000,0x3a2f0000,0xb9130000
.long 0x3c00,0x3c00,0x3c00,0x3c00,0x3c00,0x3c00,0x3c00,0x3c00
.long 0x3bc3,0xbbc3,0x3add,0xbadd,0xb3c6,0x33c6,0xb81d,0x381d
.long 0x3b0e,0x3b0e,0x378b,0x378b,0xb78b,0xb78b,0xbb0e,0xbb0e
.long 0x39ed,0xb9ed,0xaa48,0x2a48,0xb95f,0x395f,0xbbfe,0x3bfe
.long 0x3bf10000,0xafd60000,0x3bb60000,0xb4440000,0xafd60000,0xbbf10000,0xb4440000,0xbbb60000
.long 0x3b770000,0x35c20000,0x39840000,0x39cb0000,0xb5c20000,0x3b770000,0xb9cb0000,0x39840000
.long 0x3a8a0000,0xb89b0000,0x33030000,0xbbce0000,0xb89b0000,0xba8a0000,0xbbce0000,0xb3030000
.long 0x393a0000,0x3a0f0000,0xb5050000,0x3b990000,0xba0f0000,0x393a0000,0xbb990000,0xb5050000
.long 0x3c00,0x3c00,0x3c00,0x3c00,0xbc00,0xbc00,0xbc00,0xbc00
.long 0x381d,0xb81d,0x33c6,0xb3c6,0xbadd,0x3add,0xbbc3,0x3bc3
.long 0xb78b,0xb78b,0xbb0e,0xbb0e,0xbb0e,0xbb0e,0xb78b,0xb78b
.long 0xbbfe,0x3bfe,0xb95f,0x395f,0xaa48,0x2a48,0x39ed,0xb9ed
.long 0x3af60000,0xb7e30000,0x3a4f0000,0xb8ec0000,0xb7e30000,0xbaf60000,0xb8ec0000,0xba4f0000
.long 0x26480000,0x3bff0000,0xb67c0000,0x3b500000,0xbbff0000,0x26480000,0xbb500000,0xb67c0000
.long 0xbac20000,0xb8480000,0xbbe20000,0x31790000,0xb8480000,0x3ac20000,0x31790000,0x3be20000
.long 0xbb250000,0xb7320000,0xacb50000,0xbbfa0000,0x37320000,0xbb250000,0x3bfa0000,0xacb50000
.long 0x3c00,0x3c00,0x3c00,0x3c00,0x3c00,0x3c00,0x3c00,0x3c00
.long 0xb3c6,0x33c6,0xb81d,0x381d,0xbbc3,0x3bc3,0xbadd,0x3add
.long 0xbb0e,0xbb0e,0xb78b,0xb78b,0x378b,0x378b,0x3b0e,0x3b0e
.long 0x395f,0xb95f,0x3bfe,0xbbfe,0x39ed,0xb9ed,0xaa48,0x2a48
.long 0x38ec0000,0xba4f0000,0x37e30000,0xbaf60000,0xba4f0000,0xb8ec0000,0xbaf60000,0xb7e30000
.long 0xbb500000,0x367c0000,0xbbff0000,0xa6480000,0xb67c0000,0xbb500000,0x26480000,0xbbff0000
.long 0xb1790000,0x3be20000,0x38480000,0x3ac20000,0x3be20000,0x31790000,0x3ac20000,0xb8480000
.long 0x3bfa0000,0x2cb50000,0x37320000,0x3b250000,0xacb50000,0x3bfa0000,0xbb250000,0x37320000
.long 0x3c00,0x3c00,0x3c00,0x3c00,0xbc00,0xbc00,0xbc00,0xbc00
.long 0xbadd,0x3add,0xbbc3,0x3bc3,0xb81d,0x381d,0xb3c6,0x33c6
.long 0x378b,0x378b,0x3b0e,0x3b0e,0x3b0e,0x3b0e,0x378b,0x378b
.long 0x2a48,0xaa48,0xb9ed,0x39ed,0xbbfe,0x3bfe,0xb95f,0x395f
.long 0x34440000,0xbbb60000,0x2fd60000,0xbbf10000,0xbbb60000,0xb4440000,0xbbf10000,0xafd60000
.long 0xb9cb0000,0xb9840000,0xb5c20000,0xbb770000,0x39840000,0xb9cb0000,0x3b770000,0xb5c20000
.long 0x3bce0000,0xb3030000,0x389b0000,0xba8a0000,0xb3030000,0xbbce0000,0xba8a0000,0xb89b0000
.long 0xbb990000,0x35050000,0xba0f0000,0xb93a0000,0xb5050000,0xbb990000,0x393a0000,0xba0f0000
.long 0x3c00,0x3c00,0x3c00,0x3c00,0x3c00,0x3c00,0x3c00,0x3c00
.long 0x3ba8,0xbba8,0x3b0e,0xbb0e,0xb4a5,0x34a5,0xb78b,0x378b
.long 0x3aa7,0x3aa7,0x3872,0x3872,0xb872,0xb872,0xbaa7,0xbaa7
.long 0x3913,0xb913,0x2e46,0xae46,0xba2f,0x3a2f,0xbbf6,0x3bf6
.long 0x3bea0000,0xb0b20000,0x3bc30000,0xb3c60000,0xb0b20000,0xbbea0000,0xb3c60000,0xbbc30000
.long 0x3b3b0000,0x36d70000,0x39ed0000,0x395f0000,0xb6d70000,0x3b3b0000,0xb95f0000,0x39ed0000
.long 0x39ed0000,0xb95f0000,0x35640000,0xbb880000,0xb95f0000,0xb9ed0000,0xbb880000,0xb5640000
.long 0x381d0000,0x3add0000,0xb0b20000,0x3bea0000,0xbadd0000,0x381d0000,0xbbea0000,0xb0b20000
.long 0x3c00,0x3c00,0x3c00,0x3c00,0xbc00,0xbc00,0xbc00,0xbc00
.long 0x378b,0xb78b,0x34a5,0xb4a5,0xbb0e,0x3b0e,0xbba8,0x3ba8
.long 0xb872,0xb872,0xbaa7,0xbaa7,0xbaa7,0xbaa7,0xb872,0xb872
.long 0xbbf6,0x3bf6,0xba2f,0x3a2f,0x2e46,0xae46,0x3913,0xb913
.long 0x3add0000,0xb81d0000,0x3a6d0000,0xb8c40000,0xb81d0000,0xbadd0000,0xb8c40000,0xba6d0000
.long 0xaa480000,0x3bfe0000,0xb5640000,0x3b880000,0xbbfe0000,0xaa480000,0xbb880000,0xb5640000
.long 0xbb3b0000,0xb6d70000,0xbbfe0000,0x2a480000,0xb6d70000,0x3b3b0000,0x2a480000,0x3bfe0000
.long 0xba6d0000,0xb8c40000,0xb3c60000,0xbbc30000,0x38c40000,0xba6d0000,0x3bc30000,0xb3c60000
.long 0x3c00,0x3c00,0x3c00,0x3c00,0x3c00,0x3c00,0x3c00,0x3c00
.long 0xb4a5,0x34a5,0xb78b,0x378b,0xbba8,0x3ba8,0xbb0e,0x3b0e
.long 0xbaa7,0xbaa7,0xb872,0xb872,0x3872,0x3872,0x3aa7,0x3aa7
.long 0x3a2f,0xba2f,0x3bf6,0xbbf6,0x3913,0xb913,0x2e46,0xae46
.long 0x38c40000,0xba6d0000,0x381d0000,0xbadd0000,0xba6d0000,0xb8c40000,0xbadd0000,0xb81d0000
.long 0xbb880000,0x35640000,0xbbfe0000,0x2a480000,0xb5640000,0xbb880000,0xaa480000,0xbbfe0000
.long 0xaa480000,0x3bfe0000,0x36d70000,0x3b3b0000,0x3bfe0000,0x2a480000,0x3b3b0000,0xb6d70000
.long 0x3bc30000,0x33c60000,0x38c40000,0x3a6d0000,0xb3c60000,0x3bc30000,0xba6d0000,0x38c40000
.long 0x3c00,0x3c00,0x3c00,0x3c00,0xbc00,0xbc00,0xbc00,0xbc00
.long 0xbb0e,0x3b0e,0xbba8,0x3ba8,0xb78b,0x378b,0xb4a5,0x34a5
.long 0x3872,0x3872,0x3aa7,0x3aa7,0x3aa7,0x3aa7,0x3872,0x3872
.long 0xae46,0x2e46,0xb913,0x3913,0xbbf6,0x3bf6,0xba2f,0x3a2f
.long 0x33c60000,0xbbc30000,0x30b20000,0xbbea0000,0xbbc30000,0xb3c60000,0xbbea0000,0xb0b20000
.long 0xb95f0000,0xb9ed0000,0xb6d70000,0xbb3b0000,0x39ed0000,0xb95f0000,0x3b3b0000,0xb6d70000
.long 0x3b880000,0xb5640000,0x395f0000,0xb9ed0000,0xb5640000,0xbb880000,0xb9ed0000,0xb95f0000
.long 0xbbea0000,0x30b20000,0xbadd0000,0xb81d0000,0xb0b20000,0xbbea0000,0x381d0000,0xbadd0000
.long 0x3c00,0x3c00,0x3c00,0x3c00,0x3c00,0x3c00,0x3c00,0x3c00
.long 0x3b88,0xbb88,0x3b3b,0xbb3b,0xb564,0x3564,0xb6d7,0x36d7
.long 0x3a2f,0x3a2f,0x3913,0x3913,0xb913,0xb913,0xba2f,0xba2f
.long 0x381d,0xb81d,0x33c6,0xb3c6,0xbadd,0x3add,0xbbc3,0x3bc3
.long 0x3be20000,0xb1790000,0x3bce0000,0xb3030000,0xb1790000,0xbbe20000,0xb3030000,0xbbce0000
.long 0x3af60000,0x37e30000,0x3a4f0000,0x38ec0000,0xb7e30000,0x3af60000,0xb8ec0000,0x3a4f0000
.long 0x393a0000,0xba0f0000,0x37320000,0xbb250000,0xba0f0000,0xb93a0000,0xbb250000,0xb7320000
.long 0x35c20000,0x3b770000,0x26480000,0x3bff0000,0xbb770000,0x35c20000,0xbbff0000,0x26480000
.long 0x3c00,0x3c00,0x3c00,0x3c00,0xbc00,0xbc00,0xbc00,0xbc00
.long 0x36d7,0xb6d7,0x3564,0xb564,0xbb3b,0x3b3b,0xbb88,0x3b88
.long 0xb913,0xb913,0xba2f,0xba2f,0xba2f,0xba2f,0xb913,0xb913
.long 0xbbc3,0x3bc3,0xbadd,0x3add,0x33c6,0xb3c6,0x381d,0xb81d
.long 0x3ac20000,0xb8480000,0x3a8a0000,0xb89b0000,0xb8480000,0xbac20000,0xb89b0000,0xba8a0000
.long 0xafd60000,0x3bf10000,0xb4440000,0x3bb60000,0xbbf10000,0xafd60000,0xbbb60000,0xb4440000
.long 0xbb990000,0xb5050000,0xbbfa0000,0xacb50000,0xb5050000,0x3b990000,0xacb50000,0x3bfa0000
.long 0xb9840000,0xb9cb0000,0xb67c0000,0xbb500000,0x39cb0000,0xb9840000,0x3b500000,0xb67c0000
.long 0x3c00,0x3c00,0x3c00,0x3c00,0x3c00,0x3c00,0x3c00,0x3c00
.long 0xb564,0x3564,0xb6d7,0x36d7,0xbb88,0x3b88,0xbb3b,0x3b3b
.long 0xba2f,0xba2f,0xb913,0xb913,0x3913,0x3913,0x3a2f,0x3a2f
.long 0x3add,0xbadd,0x3bc3,0xbbc3,0x381d,0xb81d,0x33c6,0xb3c6
.long 0x389b0000,0xba8a0000,0x38480000,0xbac20000,0xba8a0000,0xb89b0000,0xbac20000,0xb8480000
.long 0xbbb60000,0x34440000,0xbbf10000,0x2fd60000,0xb4440000,0xbbb60000,0xafd60000,0xbbf10000
.long 0x2cb50000,0x3bfa0000,0x35050000,0x3b990000,0x3bfa0000,0xacb50000,0x3b990000,0xb5050000
.long 0x3b500000,0x367c0000,0x39cb0000,0x39840000,0xb67c0000,0x3b500000,0xb9840000,0x39cb0000
.long 0x3c00,0x3c00,0x3c00,0x3c00,0xbc00,0xbc00,0xbc00,0xbc00
.long 0xbb3b,0x3b3b,0xbb88,0x3b88,0xb6d7,0x36d7,0xb564,0x3564
.long 0x3913,0x3913,0x3a2f,0x3a2f,0x3a2f,0x3a2f,0x3913,0x3913
.long 0xb3c6,0x33c6,0xb81d,0x381d,0xbbc3,0x3bc3,0xbadd,0x3add
.long 0x33030000,0xbbce0000,0x31790000,0xbbe20000,0xbbce0000,0xb3030000,0xbbe20000,0xb1790000
.long 0xb8ec0000,0xba4f0000,0xb7e30000,0xbaf60000,0x3a4f0000,0xb8ec0000,0x3af60000,0xb7e30000
.long 0x3b250000,0xb7320000,0x3a0f0000,0xb93a0000,0xb7320000,0xbb250000,0xb93a0000,0xba0f0000
.long 0xbbff0000,0xa6480000,0xbb770000,0xb5c20000,0x26480000,0xbbff0000,0x35c20000,0xbb770000
.long 0x3c00,0x3c00,0x3c00,0x3c00,0x3c00,0xbc00,0x361f3b64,0xb61f3b64
.long 0x3c00,0x3c00,0x39a839a8,0xb9a839a8,0x3c00,0xbc00,0x3b64361f,0xbb64361f
.long 0x3c00,0x3c00,0x3c000000,0xbc008000,0x3c00,0xbc00,0x3b64b61f,0xbb64b61f
.long 0x3c00,0x3c00,0x39a8b9a8,0xb9a8b9a8,0x3c00,0xbc00,0x361fbb64,0xb61fbb64
.long 0x3c00,0x3c00,0xbc00,0xbc00,0x3c00,0xbc00,0xb61fbb64,0x361fbb64
.long 0x3c00,0x3c00,0xb9a8b9a8,0x39a8b9a8,0x3c00,0xbc00,0xbb64b61f,0x3b64b61f
.long 0x3c00,0x3c00,0xbc008000,0x3c000000,0x3c00,0xbc00,0xbb64361f,0x3b64361f
.long 0x3c00,0x3c00,0xb9a839a8,0x39a839a8,0x3c00,0xbc00,0xb61f3b64,0x361f3b64
.long 0x3c00,0x3c00,0x3c00,0x3c00,0x39a839a8,0xb9a839a8,0x3b64361f,0xbb64361f
.long 0x3c000000,0xbc008000,0x39a8b9a8,0xb9a8b9a8,0x39a8b9a8,0xb9a8b9a8,0xb61fbb64,0x361fbb64
.long 0xbc00,0xbc00,0xbc008000,0x3c000000,0xb9a8b9a8,0x39a8b9a8,0xb61f3b64,0x361f3b64
.long 0xbc008000,0x3c000000,0x39a839a8,0xb9a839a8,0xb9a839a8,0x39a839a8,0x3b64b61f,0xbb64b61f
.long 0x3c00,0x3c00,0xbc00,0xbc00,0x39a839a8,0xb9a839a8,0xbb64b61f,0x3b64b61f
.long 0x3c000000,0xbc008000,0xb9a839a8,0x39a839a8,0x39a8b9a8,0xb9a8b9a8,0x361f3b64,0xb61f3b64
.long 0xbc00,0xbc00,0x3c000000,0xbc008000,0xb9a8b9a8,0x39a8b9a8,0x361fbb64,0xb61fbb64
.long 0xbc008000,0x3c000000,0xb9a8b9a8,0x39a8b9a8,0xb9a839a8,0x39a839a8,0xbb64361f,0x3b64361f
.long 0x3c00,0x3c00,0x3c00,0x3c00,0x3c000000,0xbc008000,0x3b64b61f,0xbb64b61f
.long 0xbc00,0xbc00,0xb9a8b9a8,0x39a8b9a8,0xbc008000,0x3c000000,0xb61f3b64,0x361f3b64
.long 0x3c00,0x3c00,0x3c000000,0xbc008000,0x3c000000,0xbc008000,0xb61fbb64,0x361fbb64
.long 0xbc00,0xbc00,0xb9a839a8,0x39a839a8,0xbc008000,0x3c000000,0x3b64361f,0xbb64361f
.long 0x3c00,0x3c00,0xbc00,0xbc00,0x3c000000,0xbc008000,0xbb64361f,0x3b64361f
.long 0xbc00,0xbc00,0x39a839a8,0xb9a839a8,0xbc008000,0x3c000000,0x361fbb64,0xb61fbb64
.long 0x3c00,0x3c00,0xbc008000,0x3c000000,0x3c000000,0xbc008000,0x361f3b64,0xb61f3b64
.long 0xbc00,0xbc00,0x39a8b9a8,0xb9a8b9a8,0xbc008000,0x3c000000,0xbb64b61f,0x3b64b61f
.long 0x3c00,0x3c00,0x3c00,0x3c00,0x39a8b9a8,0xb9a8b9a8,0x361fbb64,0xb61fbb64
.long 0xbc008000,0x3c000000,0xb9a839a8,0x39a839a8,0x39a839a8,0xb9a839a8,0x3b64b61f,0xbb64b61f
.long 0xbc00,0xbc00,0xbc008000,0x3c000000,0xb9a839a8,0x39a839a8,0x3b64361f,0xbb64361f
.long 0x3c000000,0xbc008000,0xb9a8b9a8,0x39a8b9a8,0xb9a8b9a8,0x39a8b9a8,0x361f3b64,0xb61f3b64
.long 0x3c00,0x3c00,0xbc00,0xbc00,0x39a8b9a8,0xb9a8b9a8,0xb61f3b64,0x361f3b64
.long 0xbc008000,0x3c000000,0x39a8b9a8,0xb9a8b9a8,0x39a839a8,0xb9a839a8,0xbb64361f,0x3b64361f
.long 0xbc00,0xbc00,0x3c000000,0xbc008000,0xb9a839a8,0x39a839a8,0xbb64b61f,0x3b64b61f
.long 0x3c000000,0xbc008000,0x39a839a8,0xb9a839a8,0xb9a8b9a8,0x39a8b9a8,0xb61fbb64,0x361fbb64
.long 0x3c008000,0x3c008000,0x3c008000,0x3c008000,0x3c008000,0xbc008000,0x3b64b61f,0x3b64361f
.long 0x3c008000,0x3c008000,0x39a8b9a8,0x39a839a8,0x3c008000,0xbc008000,0x361fbb64,0x361f3b64
.long 0x3c008000,0x3c008000,0xbc00,0x80003c00,0x3c008000,0xbc008000,0xb61fbb64,0xb61f3b64
.long 0x3c008000,0x3c008000,0xb9a8b9a8,0xb9a839a8,0x3c008000,0xbc008000,0xbb64b61f,0xbb64361f
.long 0x3c008000,0x3c008000,0xbc008000,0xbc008000,0x3c008000,0xbc008000,0xbb64361f,0xbb64b61f
.long 0x3c008000,0x3c008000,0xb9a839a8,0xb9a8b9a8,0x3c008000,0xbc008000,0xb61f3b64,0xb61fbb64
.long 0x3c008000,0x3c008000,0x80003c00,0xbc00,0x3c008000,0xbc008000,0x361f3b64,0x361fbb64
.long 0x3c008000,0x3c008000,0x39a839a8,0x39a8b9a8,0x3c008000,0xbc008000,0x3b64361f,0x3b64b61f
.long 0x3c008000,0x3c008000,0x3c008000,0x3c008000,0x39a8b9a8,0x39a839a8,0x361fbb64,0x361f3b64
.long 0xbc00,0x80003c00,0xb9a8b9a8,0xb9a839a8,0xb9a8b9a8,0xb9a839a8,0xbb64361f,0xbb64b61f
.long 0xbc008000,0xbc008000,0x80003c00,0xbc00,0xb9a839a8,0xb9a8b9a8,0x3b64361f,0x3b64b61f
.long 0x80003c00,0xbc00,0x39a8b9a8,0x39a839a8,0x39a839a8,0x39a8b9a8,0xb61fbb64,0xb61f3b64
.long 0x3c008000,0x3c008000,0xbc008000,0xbc008000,0x39a8b9a8,0x39a839a8,0xb61f3b64,0xb61fbb64
.long 0xbc00,0x80003c00,0x39a839a8,0x39a8b9a8,0xb9a8b9a8,0xb9a839a8,0x3b64b61f,0x3b64361f
.long 0xbc008000,0xbc008000,0xbc00,0x80003c00,0xb9a839a8,0xb9a8b9a8,0xbb64b61f,0xbb64361f
.long 0x80003c00,0xbc00,0xb9a839a8,0xb9a8b9a8,0x39a839a8,0x39a8b9a8,0x361f3b64,0x361fbb64
.long 0x3c008000,0x3c008000,0x3c008000,0x3c008000,0xbc00,0x80003c00,0xb61fbb64,0xb61f3b64
.long 0xbc008000,0xbc008000,0xb9a839a8,0xb9a8b9a8,0x80003c00,0xbc00,0x3b64361f,0x3b64b61f
.long 0x3c008000,0x3c008000,0xbc00,0x80003c00,0xbc00,0x80003c00,0xbb64361f,0xbb64b61f
.long 0xbc008000,0xbc008000,0x39a839a8,0x39a8b9a8,0x80003c00,0xbc00,0x361fbb64,0x361f3b64
.long 0x3c008000,0x3c008000,0xbc008000,0xbc008000,0xbc00,0x80003c00,0x361f3b64,0x361fbb64
.long 0xbc008000,0xbc008000,0x39a8b9a8,0x39a839a8,0x80003c00,0xbc00,0xbb64b61f,0xbb64361f
.long 0x3c008000,0x3c008000,0x80003c00,0xbc00,0xbc00,0x80003c00,0x3b64b61f,0x3b64361f
.long 0xbc008000,0xbc008000,0xb9a8b9a8,0xb9a839a8,0x80003c00,0xbc00,0xb61f3b64,0xb61fbb64
.long 0x3c008000,0x3c008000,0x3c008000,0x3c008000,0xb9a8b9a8,0xb9a839a8,0xbb64b61f,0xbb64361f
.long 0x80003c00,0xbc00,0x39a839a8,0x39a8b9a8,0x39a8b9a8,0x39a839a8,0xb61fbb64,0xb61f3b64
.long 0xbc008000,0xbc008000,0x80003c00,0xbc00,0x39a839a8,0x39a8b9a8,0x361fbb64,0x361f3b64
.long 0xbc00,0x80003c00,0xb9a839a8,0xb9a8b9a8,0xb9a839a8,0xb9a8b9a8,0x3b64b61f,0x3b64361f
.long 0x3c008000,0x3c008000,0xbc008000,0xbc008000,0xb9a8b9a8,0xb9a839a8,0x3b64361f,0x3b64b61f
.long 0x80003c00,0xbc00,0xb9a8b9a8,0xb9a839a8,0x39a8b9a8,0x39a839a8,0x361f3b64,0x361fbb64
.long 0xbc008000,0xbc008000,0xbc00,0x80003c00,0x39a839a8,0x39a8b9a8,0xb61f3b64,0xb61fbb64
.long 0xbc00,0x80003c00,0x39a8b9a8,0x39a839a8,0xb9a839a8,0xb9a8b9a8,0xbb64361f,0xbb64b61f
.long 0x3800,0x3800,0x3800,0x3800,0x3c00,0xbc00,0x3b64,0x3b64
.long 0x3c00,0x3c00,0x39a8,0x39a8,0x3c00,0xbc00,0x361f,0x361f
.long 0x3c00,0x3c00,0x0,0x8000,0x3c00,0xbc00,0xb61f,0xb61f
.long 0x3c00,0x3c00,0xb9a8,0xb9a8,0x3c00,0xbc00,0xbb64,0xbb64
.long 0x3c000000,0x0,0x3bd90000,0xbbd90000,0x3c000000,0x80000000,0x3aa70000,0xbaa70000
.long 0x3c000000,0x0,0x38720000,0xb8720000,0x3c000000,0x80000000,0x323e0000,0xb23e0000
.long 0x3c000000,0x0,0xb23e0000,0x323e0000,0x3c000000,0x80000000,0xb8720000,0x38720000
.long 0x3c000000,0x0,0xbaa70000,0x3aa70000,0x3c000000,0x80000000,0xbbd90000,0x3bd90000
.long 0x3800,0x3800,0x3800,0x3800,0x39a8,0x39a8,0x361f,0x361f
.long 0x0,0x8000,0xb9a8,0xb9a8,0xb9a8,0xb9a8,0xbb64,0xbb64
.long 0xbc00,0xbc00,0x8000,0x0,0xb9a8,0xb9a8,0x3b64,0x3b64
.long 0x8000,0x0,0x39a8,0x39a8,0x39a8,0x39a8,0xb61f,0xb61f
.long 0x3b640000,0xbb640000,0x3aa70000,0xbaa70000,0x361f0000,0xb61f0000,0xb23e0000,0x323e0000
.long 0xb61f0000,0x361f0000,0xbbd90000,0x3bd90000,0xbb640000,0x3b640000,0xb8720000,0x38720000
.long 0xbb640000,0x3b640000,0x38720000,0xb8720000,0xb61f0000,0x361f0000,0x3bd90000,0xbbd90000
.long 0x361f0000,0xb61f0000,0x323e0000,0xb23e0000,0x3b640000,0xbb640000,0xbaa70000,0x3aa70000
.long 0x3800,0x3800,0x3800,0x3800,0x0,0x8000,0xb61f,0xb61f
.long 0xbc00,0xbc00,0xb9a8,0xb9a8,0x8000,0x0,0x3b64,0x3b64
.long 0x3c00,0x3c00,0x0,0x8000,0x0,0x8000,0xbb64,0xbb64
.long 0xbc00,0xbc00,0x39a8,0x39a8,0x8000,0x0,0x361f,0x361f
.long 0x39a80000,0xb9a80000,0x38720000,0xb8720000,0xb9a80000,0x39a80000,0xbbd90000,0x3bd90000
.long 0xb9a80000,0x39a80000,0x323e0000,0xb23e0000,0x39a80000,0xb9a80000,0x3aa70000,0xbaa70000
.long 0x39a80000,0xb9a80000,0xbaa70000,0x3aa70000,0xb9a80000,0x39a80000,0xb23e0000,0x323e0000
.long 0xb9a80000,0x39a80000,0x3bd90000,0xbbd90000,0x39a80000,0xb9a80000,0xb8720000,0x38720000
.long 0x3800,0x3800,0x3800,0x3800,0xb9a8,0xb9a8,0xbb64,0xbb64
.long 0x8000,0x0,0x39a8,0x39a8,0x39a8,0x39a8,0xb61f,0xb61f
.long 0xbc00,0xbc00,0x8000,0x0,0x39a8,0x39a8,0x361f,0x361f
.long 0x0,0x8000,0xb9a8,0xb9a8,0xb9a8,0xb9a8,0x3b64,0x3b64
.long 0x361f0000,0xb61f0000,0x323e0000,0xb23e0000,0xbb640000,0x3b640000,0xb8720000,0x38720000
.long 0x3b640000,0xbb640000,0x3aa70000,0xbaa70000,0xb61f0000,0x361f0000,0xbbd90000,0x3bd90000
.long 0xb61f0000,0x361f0000,0x3bd90000,0xbbd90000,0x3b640000,0xbb640000,0xbaa70000,0x3aa70000
.long 0xbb640000,0x3b640000,0x38720000,0xb8720000,0x361f0000,0xb61f0000,0xb23e0000,0x323e0000
.long 0x3800,0x3800,0xb800,0xb800,0x8000,0x8000,0xb61f,0x361f
.long 0x8000,0x8000,0xb9a8,0x39a8,0x8000,0x8000,0xbb64,0x3b64
.long 0x8000,0x8000,0xbc00,0x3c00,0x8000,0x8000,0xbb64,0x3b64
.long 0x8000,0x8000,0xb9a8,0x39a8,0x8000,0x8000,0xb61f,0x361f
.long 0x80000000,0xbc000000,0xb23e0000,0xb23e0000,0x80000000,0x3c000000,0xb8720000,0xb8720000
.long 0x80000000,0xbc000000,0xbaa70000,0xbaa70000,0x80000000,0x3c000000,0xbbd90000,0xbbd90000
.long 0x80000000,0xbc000000,0xbbd90000,0xbbd90000,0x80000000,0x3c000000,0xbaa70000,0xbaa70000
.long 0x80000000,0xbc000000,0xb8720000,0xb8720000,0x80000000,0x3c000000,0xb23e0000,0xb23e0000
.long 0x3800,0x3800,0xb800,0xb800,0xb9a8,0x39a8,0xbb64,0x3b64
.long 0xbc00,0x3c00,0xb9a8,0x39a8,0xb9a8,0x39a8,0x361f,0xb61f
.long 0x8000,0x8000,0x3c00,0xbc00,0x39a8,0xb9a8,0x361f,0xb61f
.long 0x3c00,0xbc00,0xb9a8,0x39a8,0x39a8,0xb9a8,0xbb64,0x3b64
.long 0xb61f0000,0xb61f0000,0xb8720000,0xb8720000,0xbb640000,0xbb640000,0xbbd90000,0xbbd90000
.long 0xbb640000,0xbb640000,0xb23e0000,0xb23e0000,0xb61f0000,0xb61f0000,0x3aa70000,0x3aa70000
.long 0x361f0000,0x361f0000,0x3aa70000,0x3aa70000,0x3b640000,0x3b640000,0xb23e0000,0xb23e0000
.long 0x3b640000,0x3b640000,0xbbd90000,0xbbd90000,0x361f0000,0x361f0000,0xb8720000,0xb8720000
.long 0x3800,0x3800,0xb800,0xb800,0xbc00,0x3c00,0xbb64,0x3b64
.long 0x8000,0x8000,0x39a8,0xb9a8,0x3c00,0xbc00,0x361f,0xb61f
.long 0x8000,0x8000,0xbc00,0x3c00,0xbc00,0x3c00,0x361f,0xb61f
.long 0x8000,0x8000,0x39a8,0xb9a8,0x3c00,0xbc00,0xbb64,0x3b64
.long 0xb9a80000,0xb9a80000,0xbaa70000,0xbaa70000,0xb9a80000,0xb9a80000,0xb23e0000,0xb23e0000
.long 0x39a80000,0x39a80000,0x3bd90000,0x3bd90000,0x39a80000,0x39a80000,0xb8720000,0xb8720000
.long 0xb9a80000,0xb9a80000,0xb8720000,0xb8720000,0xb9a80000,0xb9a80000,0x3bd90000,0x3bd90000
.long 0x39a80000,0x39a80000,0xb23e0000,0xb23e0000,0x39a80000,0x39a80000,0xbaa70000,0xbaa70000
.long 0x3800,0x3800,0xb800,0xb800,0xb9a8,0x39a8,0xb61f,0x361f
.long 0x3c00,0xbc00,0x39a8,0xb9a8,0xb9a8,0x39a8,0xbb64,0x3b64
.long 0x8000,0x8000,0x3c00,0xbc00,0x39a8,0xb9a8,0xbb64,0x3b64
.long 0xbc00,0x3c00,0x39a8,0xb9a8,0x39a8,0xb9a8,0xb61f,0x361f
.long 0xbb640000,0xbb640000,0xbbd90000,0xbbd90000,0x361f0000,0x361f0000,0x3aa70000,0x3aa70000
.long 0x361f0000,0x361f0000,0xb8720000,0xb8720000,0xbb640000,0xbb640000,0x323e0000,0x323e0000
.long 0x3b640000,0x3b640000,0x323e0000,0x323e0000,0xb61f0000,0xb61f0000,0xb8720000,0xb8720000
.long 0xb61f0000,0xb61f0000,0x3aa70000,0x3aa70000,0x3b640000,0x3b640000,0xbbd90000,0xbbd90000
tab_end:
.size tables, 36864
.section .rodata,"a"
.p2align 6
.amdhsa_kernel adaLN_cond__spectral_fnet__moe_arch_mod__prompt_kernel
  .amdhsa_next_free_vgpr 256
  .amdhsa_next_free_sgpr 102
  .amdhsa_accum_offset 256
  .amdhsa_group_segment_fixed_size 0
  .amdhsa_kernarg_size 120
  .amdhsa_user_sgpr_count 2
  .amdhsa_user_sgpr_kernarg_segment_ptr 1
  .amdhsa_system_sgpr_workgroup_id_x 1
  .amdhsa_float_denorm_mode_32 3
  .amdhsa_float_denorm_mode_16_64 3
.end_amdhsa_kernel
```

```asm
; @launch grid=(256,1,1) block=(512,1,1) lds=139264
.amdgcn_target "amdgcn-amd-amdhsa--gfx950"
.text
.globl adaLN_cond__spectral_fnet__moe_arch_mod__prompt_kernel
.p2align 8
.type adaLN_cond__spectral_fnet__moe_arch_mod__prompt_kernel,@function
adaLN_cond__spectral_fnet__moe_arch_mod__prompt_kernel:
    s_cmp_ge_u32 s2, 256
    s_cbranch_scc1 k_done
    s_load_dwordx2 s[4:5], s[0:1], 0
    s_load_dwordx8 s[20:27], s[0:1], 80
    s_load_dwordx2 s[6:7], s[0:1], 112
    s_load_dwordx8 s[48:55], s[0:1], 48
    s_getpc_b64 s[62:63]
k_pc:
    v_lshrrev_b32 v1, 6, v0
    v_and_b32 v2, 63, v0
    v_readfirstlane_b32 s16, v1
    v_lshlrev_b32 v3, 4, v2
    s_and_b32 s34, s2, 7
    s_lshr_b32 s35, s2, 4
    s_bitcmp1_b32 s2, 3
    s_cbranch_scc0 f_start
    s_lshl_b32 s40, s35, 3
    s_add_u32 s40, s40, s16
    s_lshl_b32 s40, s40, 9
    v_lshl_add_u32 v4, v2, 7, s40
    v_min_u32 v4, tab_end-k_pc-4, v4
    s_mov_b64 exec, 15
    global_load_dword v250, v4, s[62:63]
    s_mov_b64 exec, -1
    v_bfe_u32 v7, v0, 4, 2
    v_lshlrev_b32 v4, 1, v7
    v_xor_b32 v4, v4, v0
    v_and_b32 v4, 15, v4
    v_lshlrev_b32 v4, 4, v4
    s_movk_i32 s42, 12288
    v_mad_u32_u24 v4, v7, s42, v4
    v_xor_b32 v31, 0x80, v4
    s_and_b32 s17, s35, 7
    s_lshr_b32 s41, s35, 3
    s_lshl_b32 s18, s34, 3
    s_add_u32 s18, s18, s16
    s_mul_i32 s18, s18, 196608
    s_lshl_b32 s68, s16, 12
    s_xor_b32 s70, s35, 8
    s_lshl_b32 s70, s70, 8
    s_add_u32 s70, s70, s18
    s_mov_b32 s10, 12582912
    s_mov_b32 s11, 0x00020000
    s_mov_b32 m0, s68
    s_waitcnt lgkmcnt(0)
    s_mov_b32 s8, s22
    s_mov_b32 s9, s23
    buffer_load_dwordx4 v4, s[8:11], s70 offen offset:0  lds
    s_add_u32 s70, s70, 48128
    buffer_load_dwordx4 v4, s[8:11], s70 offen offset:1024  lds
    s_add_u32 s70, s70, 48128
    buffer_load_dwordx4 v31, s[8:11], s70 offen offset:2048  lds
    s_add_u32 s70, s70, 48128
    buffer_load_dwordx4 v31, s[8:11], s70 offen offset:3072  lds
    s_branch g_start
f_start:
    s_add_u32 s62, s62, tables-k_pc
    s_addc_u32 s63, s63, 0
    s_lshl_b32 s43, s16, 11
    v_add_u32 v79, s43, v3
    s_add_u32 s40, s43, 33280
    s_lshl_b32 s42, s16, 10
    s_add_u32 s43, s42, 16384
    s_cmp_eq_u32 s34, 0
    s_cselect_b32 s68, 8192, 0
    s_add_u32 s43, s43, s68
    v_add_u32 v77, s43, v3
    s_or_b32 s69, s34, s16
    s_cselect_b32 s68, 0, 2048
    s_add_u32 s68, s68, 32768
    v_add_u32 v78, s68, v3
    s_sub_u32 s17, 16, s34
    s_cmp_eq_u32 s34, 0
    s_cselect_b32 s17, 8, s17
    s_bitcmp1_b32 s35, 0
    s_cselect_b32 s17, s17, s34
    s_lshr_b32 s36, s35, 1
    s_lshl_b32 s36, s36, 4
    s_add_u32 s17, s17, s36
    s_lshl_b32 s36, s16, 8
    s_add_u32 s36, s36, s17
    s_lshl_b32 s36, s36, 11
    s_add_u32 s37, s36, 262144
    s_mov_b32 s10, 4194304
    s_mov_b32 s11, 0x00020000
    v_and_b32 v170, 15, v0
    v_bfe_u32 v171, v0, 4, 2
    v_lshrrev_b32 v72, 1, v170
    v_and_b32 v73, 1, v0
    v_cmp_eq_u32 vcc, 1, v170
    v_mov_b32 v74, s17
    s_nop 0
    v_cndmask_b32_e64 v72, v72, 8, vcc
    v_cndmask_b32_e64 v74, v74, 0, vcc
    v_cndmask_b32_e64 v73, v73, 0, vcc
    v_lshl_add_u32 v74, v171, 9, v74
    s_waitcnt lgkmcnt(0)
    s_mov_b32 s8, s4
    s_mov_b32 s9, s5
    buffer_load_dwordx4 v[32:35], v3, s[8:11], s36 offen offset:0
    buffer_load_dwordx4 v[40:43], v3, s[8:11], s37 offen offset:0
    buffer_load_dwordx4 v[36:39], v3, s[8:11], s36 offen offset:1024
    buffer_load_dwordx4 v[44:47], v3, s[8:11], s37 offen offset:1024
    s_mov_b32 s43, 6619136
    s_load_dword s101, s[6:7], s43
    s_mov_b32 s12, s6
    s_mov_b32 s13, s7
    s_mov_b32 s14, 268435456
    s_mov_b32 s15, 0x00020000
    s_mov_b32 s20, s52
    s_mov_b32 s21, s53
    s_mov_b32 s22, 7340032
    s_mov_b32 s23, 0x00020000
    s_mov_b32 s26, 4194304
    s_mov_b32 s27, 0x00020000
    s_getreg_b32 s39, hwreg(HW_REG_XCC_ID)
    s_and_b32 s39, s39, 7
    v_mul_u32_u24 v74, v72, v74
    v_lshl_add_u32 v74, v73, 9, v74
    v_lshlrev_b32 v72, 7, v72
    v_and_b32 v48, 2047, v74
    v_add_u32 v74, v74, v72
    v_and_b32 v49, 2047, v74
    v_add_u32 v74, v74, v72
    v_and_b32 v50, 2047, v74
    v_add_u32 v74, v74, v72
    v_and_b32 v51, 2047, v74
    v_cvt_f32_u32 v48, v48
    v_cvt_f32_u32 v49, v49
    v_cvt_f32_u32 v50, v50
    v_cvt_f32_u32 v51, v51
    v_mul_f32 v48, 0x3a000000, v48
    v_mul_f32 v49, 0x3a000000, v49
    v_mul_f32 v50, 0x3a000000, v50
    v_mul_f32 v51, 0x3a000000, v51
    v_cos_f32 v48, v48
    v_cos_f32 v49, v49
    v_cos_f32 v50, v50
    v_cos_f32 v51, v51
    v_mul_f32 v48, 0x3d800000, v48
    v_mul_f32 v49, 0x3d800000, v49
    v_mul_f32 v50, 0x3d800000, v50
    v_mul_f32 v51, 0x3d800000, v51
    v_lshlrev_b32 v160, 20, v171
    v_lshl_add_u32 v160, v1, 15, v160
    v_lshl_add_u32 v160, v170, 4, v160
    v_mul_u32_u24 v161, 4128, v1
    v_add_u32 v161, v161, v3
    v_lshrrev_b32 v72, 2, v2
    v_mul_u32_u24 v162, 2064, v72
    v_and_b32 v72, 3, v0
    v_lshl_add_u32 v162, v72, 7, v162
    v_lshl_add_u32 v162, v1, 3, v162
    v_lshlrev_b32 v163, 4, v171
    v_add_u32 v163, 103040, v163
    v_lshlrev_b32 v164, 3, v171
    v_add_u32 v164, 103104, v164
    v_lshrrev_b32 v72, 5, v0
    v_lshlrev_b32 v165, 2, v72
    v_add_u32 v11, 102912, v165
    v_add_u32 v165, 103040, v165
    v_lshlrev_b32 v166, 1, v72
    v_add_u32 v166, 103104, v166
    v_mov_b32 v168, 0
    v_and_b32 v169, 1, v0
    v_lshlrev_b32 v169, 3, v169
    s_lshl_b32 s3, s34, 4
    s_and_b32 s64, s35, 1
    s_lshl_b32 s64, s64, 3
    s_lshr_b32 s65, s35, 1
    s_add_u32 s64, s64, s65
    s_and_b32 s65, s16, 3
    s_xor_b32 s64, s64, s65
    s_add_u32 s64, s64, s3
    s_add_u32 s3, s3, s35
    s_lshl_b32 s64, s64, 8
    s_add_u32 s64, s64, 0
    s_add_u32 s65, s64, 262144
    s_add_u32 s66, s64, 524288
    s_add_u32 s67, s64, 786432
    s_mov_b32 s44, 0x3f803f80
    s_mov_b32 s46, 0x3a800000
    s_mov_b32 s33, 196611
    s_lshl_b32 s60, s35, 3
    s_add_u32 s60, s60, s16
    s_lshl_b32 s30, s60, 4
    s_add_u32 s30, s30, s34
    s_cmp_lg_u32 s34, 0
    s_cbranch_scc1 f_g1
    s_cmp_ge_u32 s16, 4
    s_cselect_b32 s31, 56, 0
    s_sub_u32 s30, s30, s31
    s_cmp_lg_u32 s16, 0
    s_cbranch_scc1 f_g1
    s_cmp_ge_u32 s35, 8
    s_cselect_b32 s31, 960, 0
    s_sub_u32 s30, s30, s31
f_g1:
    s_sub_u32 s31, 2048, s30
    s_cmp_eq_u32 s30, 0
    s_cselect_b32 s31, 1024, s31
    s_lshl_b32 s18, s30, 11
    s_lshl_b32 s19, s31, 11
    s_lshl_b32 s61, s34, 19
    s_add_u32 s61, s61, 0
    s_lshl_b32 s28, s60, 8
    s_add_u32 s28, s28, s61
    s_add_u32 s29, s28, 131072
    s_add_u32 s50, s28, 262144
    s_add_u32 s51, s28, 393216
    s_lshl_b32 s73, s35, 15
    s_add_u32 s73, s73, s61
    s_lshl_b32 s42, s16, 12
    s_add_u32 s72, s73, s42
    s_add_u32 s45, s42, 49664
    s_lshl_b32 s42, s16, 8
    s_add_u32 s74, s73, s42
    s_add_u32 s75, s74, 4096
    s_lshl_b32 s76, s34, 7
    s_add_u32 s77, s76, 6509568
    s_add_u32 s76, s76, 6508544
    s_lshl_b32 s78, s35, 3
    s_add_u32 s79, s78, s77
    s_add_u32 s78, s78, s76
    s_lshl_b32 s80, s3, 4
    s_add_u32 s80, s80, 4947968
    s_lshl_b32 s81, s34, 12
    s_add_u32 s81, s81, 4947968
    s_lshl_b32 s82, s35, 11
    s_add_u32 s82, s82, 6291456
    v_cvt_f32_u32 v75, v170
    s_lshl_b32 s42, s35, 2
    s_and_b32 s43, s16, 3
    s_add_u32 s42, s42, s43
    v_lshl_add_u32 v76, v171, 8, s42
    v_mul_f32 v75, 0x3a800000, v75
    v_cvt_f32_u32 v76, v76
    v_mul_f32 v60, v76, v75
    v_fmamk_f32 v61, v75, 0x42800000, v60
    v_fmamk_f32 v62, v75, 0x43000000, v60
    v_fmamk_f32 v63, v75, 0x43400000, v60
    v_cos_f32 v64, v60
    v_cos_f32 v65, v61
    v_cos_f32 v66, v62
    v_cos_f32 v67, v63
    v_sin_f32 v68, v60
    v_sin_f32 v69, v61
    v_sin_f32 v70, v62
    v_sin_f32 v71, v63
    v_cvt_pk_f16_f32 v144, v64, v68
    v_cvt_pk_f16_f32 v145, v65, v69
    v_cvt_pk_f16_f32 v146, v66, v70
    v_cvt_pk_f16_f32 v147, v67, v71
    s_mov_b32 m0, s40
    s_nop 0
    global_load_lds_dwordx4 v79, s[62:63]
    global_load_lds_dwordx4 v79, s[62:63] offset:1024
    global_load_dwordx4 v[20:23], v77, s[62:63]
    global_load_dwordx4 v[24:27], v78, s[62:63]
    global_load_dwordx4 v[28:31], v78, s[62:63] offset:1024
    s_waitcnt vmcnt(8)
    ds_write_b128 v161, v[32:35] offset:0
    v_dot2_f32_bf16 v52, v32, s44, 0
    v_dot2_f32_bf16 v54, v32, v32, 0
    v_dot2_f32_bf16 v52, v33, s44, v52
    v_dot2_f32_bf16 v54, v33, v33, v54
    v_dot2_f32_bf16 v52, v34, s44, v52
    v_dot2_f32_bf16 v54, v34, v34, v54
    v_dot2_f32_bf16 v52, v35, s44, v52
    v_dot2_f32_bf16 v54, v35, v35, v54
    s_waitcnt vmcnt(7)
    ds_write_b128 v161, v[40:43] offset:2064
    v_dot2_f32_bf16 v53, v40, s44, 0
    v_dot2_f32_bf16 v55, v40, v40, 0
    v_dot2_f32_bf16 v53, v41, s44, v53
    v_dot2_f32_bf16 v55, v41, v41, v55
    v_dot2_f32_bf16 v53, v42, s44, v53
    v_dot2_f32_bf16 v55, v42, v42, v55
    v_dot2_f32_bf16 v53, v43, s44, v53
    v_dot2_f32_bf16 v55, v43, v43, v55
    s_waitcnt vmcnt(6)
    ds_write_b128 v161, v[36:39] offset:1024
    v_dot2_f32_bf16 v52, v36, s44, v52
    v_dot2_f32_bf16 v54, v36, v36, v54
    v_dot2_f32_bf16 v52, v37, s44, v52
    v_dot2_f32_bf16 v54, v37, v37, v54
    v_dot2_f32_bf16 v52, v38, s44, v52
    v_dot2_f32_bf16 v54, v38, v38, v54
    v_dot2_f32_bf16 v52, v39, s44, v52
    v_dot2_f32_bf16 v54, v39, v39, v54
    s_waitcnt vmcnt(5)
    ds_write_b128 v161, v[44:47] offset:3088
    v_dot2_f32_bf16 v53, v44, s44, v53
    v_dot2_f32_bf16 v55, v44, v44, v55
    v_dot2_f32_bf16 v53, v45, s44, v53
    v_dot2_f32_bf16 v55, v45, v45, v55
    v_dot2_f32_bf16 v53, v46, s44, v53
    v_dot2_f32_bf16 v55, v46, v46, v55
    v_dot2_f32_bf16 v53, v47, s44, v53
    v_dot2_f32_bf16 v55, v47, v47, v55
    s_nop 2
    v_permlane32_swap_b32 v52, v53
    v_permlane32_swap_b32 v54, v55
    v_add_f32 v52, v52, v53
    v_add_f32 v54, v54, v55
    s_nop 0
    v_add_f32_dpp v52, v52, v52 row_ror:8 row_mask:0xf bank_mask:0xf
    v_add_f32_dpp v54, v54, v54 row_ror:8 row_mask:0xf bank_mask:0xf
    s_nop 0
    v_add_f32_dpp v52, v52, v52 row_ror:4 row_mask:0xf bank_mask:0xf
    v_add_f32_dpp v54, v54, v54 row_ror:4 row_mask:0xf bank_mask:0xf
    s_nop 0
    v_add_f32_dpp v52, v52, v52 row_ror:2 row_mask:0xf bank_mask:0xf
    v_add_f32_dpp v54, v54, v54 row_ror:2 row_mask:0xf bank_mask:0xf
    s_nop 0
    v_add_f32_dpp v52, v52, v52 row_ror:1 row_mask:0xf bank_mask:0xf
    v_add_f32_dpp v54, v54, v54 row_ror:1 row_mask:0xf bank_mask:0xf
    s_nop 0
    v_add_f32_dpp v52, v52, v52 row_bcast:15 row_mask:0xa bank_mask:0xf
    v_add_f32_dpp v54, v54, v54 row_bcast:15 row_mask:0xa bank_mask:0xf
    v_mul_f32 v52, s46, v52
    v_mul_f32 v54, s46, v54
    v_mul_f32 v64, v52, v52
    v_cvt_pk_bf16_f32 v56, -v52, -v52
    v_sub_f32 v54, v54, v64
    v_mul_f32 v66, 0x44000000, v54
    v_cmp_gt_f32 vcc, v64, v66
    s_or_b32 s68, vcc_lo, vcc_hi
    s_bitcmp1_b32 s68, 31
    s_cbranch_scc1 f_slowvar
f_var:
    v_cvt_pk_bf16_f32 v54, v54, v54
    v_lshlrev_b32 v54, 16, v54
    v_add_f32 v54, 0x3727c5ac, v54
    v_cvt_pk_bf16_f32 v54, v54, v54
    v_lshlrev_b32 v54, 16, v54
    v_sqrt_f32 v54, v54
    s_nop 0
    v_cvt_pk_bf16_f32 v54, v54, v54
    v_lshlrev_b32 v54, 16, v54
    v_rcp_f32 v54, v54
    s_mov_b32 exec_lo, 0x80000000
    s_mov_b32 exec_hi, 0x80000000
    ds_write_b16 v166, v56
    ds_write_b32 v165, v54
    s_mov_b64 exec, -1
    s_waitcnt lgkmcnt(0)
    s_cmp_lg_u32 s16, 0
    s_cbranch_scc1 f_nxr
    s_mul_i32 s32, s101, 0x9e3779b1
    s_or_b32 s32, s32, 0x101
    s_and_b32 s32, s32, 0xfffefbfb
    s_and_b32 s56, s32, 0xff
    s_bfe_u32 s57, s32, 0x80008
    s_bfe_u32 s58, s32, 0x80010
    s_lshr_b32 s59, s32, 24
    v_mov_b32 v72, s32
    v_mov_b32 v73, s39
    v_mov_b32 v74, 111488
    s_mov_b64 exec, 1
    ds_write_b32 v74, v168 offset:4
    buffer_store_dwordx2 v[72:73], v168, s[12:15], s78 offen sc1
    s_mov_b64 exec, -1
    s_waitcnt lgkmcnt(0)
f_nxr:
    s_barrier
    ds_read_b128 v[60:63], v163
    ds_read_b64 v[64:65], v164
    ds_read_b64_tr_b16 v[80:81], v162 offset:0
    ds_read_b64_tr_b16 v[82:83], v162 offset:512
    ds_read_b64_tr_b16 v[84:85], v162 offset:1024
    ds_read_b64_tr_b16 v[86:87], v162 offset:1536
    ds_read_b64_tr_b16 v[88:89], v162 offset:64
    ds_read_b64_tr_b16 v[90:91], v162 offset:576
    ds_read_b64_tr_b16 v[92:93], v162 offset:1088
    ds_read_b64_tr_b16 v[94:95], v162 offset:1600
    s_mul_i32 s32, s101, 0x9e3779b1
    s_or_b32 s32, s32, 0x101
    s_and_b32 s32, s32, 0xfffefbfb
    s_and_b32 s56, s32, 0xff
    s_bfe_u32 s57, s32, 0x80008
    s_bfe_u32 s58, s32, 0x80010
    s_lshr_b32 s59, s32, 24
    v_lshrrev_b32 v16, v169, s32
    v_lshrrev_b32 v17, 2, v16
    v_lshrrev_b32 v18, 4, v16
    v_lshrrev_b32 v19, 6, v16
    s_waitcnt lgkmcnt(8)
    v_pk_mul_f32 v[48:49], v[48:49], v[60:61]
    v_pk_mul_f32 v[50:51], v[50:51], v[62:63]
    v_cvt_pk_bf16_f32 v58, v48, v49
    v_cvt_pk_bf16_f32 v59, v50, v51
    s_nop 1
    v_mfma_f32_16x16x16_bf16 v[96:99], v[58:59], v[64:65], 0
    s_waitcnt lgkmcnt(0)
    v_mfma_f32_16x16x16_bf16 v[100:103], v[58:59], v[80:81], v[96:99]
    v_mfma_f32_16x16x16_bf16 v[104:107], v[58:59], v[82:83], v[96:99]
    v_mfma_f32_16x16x16_bf16 v[108:111], v[58:59], v[84:85], v[96:99]
    v_mfma_f32_16x16x16_bf16 v[112:115], v[58:59], v[86:87], v[96:99]
    v_mfma_f32_16x16x16_bf16 v[116:119], v[58:59], v[88:89], v[96:99]
    v_mfma_f32_16x16x16_bf16 v[120:123], v[58:59], v[90:91], v[96:99]
    v_mfma_f32_16x16x16_bf16 v[124:127], v[58:59], v[92:93], v[96:99]
    v_mfma_f32_16x16x16_bf16 v[128:131], v[58:59], v[94:95], v[96:99]
    s_nop 0
    v_cvt_pk_f16_f32 v176, v100, v101
    v_cvt_pk_f16_f32 v177, v104, v105
    v_cvt_pk_f16_f32 v178, v108, v109
    v_cvt_pk_f16_f32 v179, v112, v113
    v_bfi_b32 v176, s33, v16, v176
    v_bfi_b32 v177, s33, v17, v177
    v_bfi_b32 v178, s33, v18, v178
    v_bfi_b32 v179, s33, v19, v179
    buffer_store_dwordx4 v[176:179], v160, s[12:15], s64 offen sc1
    v_cvt_pk_f16_f32 v180, v102, v103
    v_cvt_pk_f16_f32 v181, v106, v107
    v_cvt_pk_f16_f32 v182, v110, v111
    v_cvt_pk_f16_f32 v183, v114, v115
    v_bfi_b32 v180, s33, v16, v180
    v_bfi_b32 v181, s33, v17, v181
    v_bfi_b32 v182, s33, v18, v182
    v_bfi_b32 v183, s33, v19, v183
    buffer_store_dwordx4 v[180:183], v160, s[12:15], s66 offen sc1
    v_cvt_pk_f16_f32 v184, v116, v117
    v_cvt_pk_f16_f32 v185, v120, v121
    v_cvt_pk_f16_f32 v186, v124, v125
    v_cvt_pk_f16_f32 v187, v128, v129
    v_bfi_b32 v184, s33, v16, v184
    v_bfi_b32 v185, s33, v17, v185
    v_bfi_b32 v186, s33, v18, v186
    v_bfi_b32 v187, s33, v19, v187
    buffer_store_dwordx4 v[184:187], v160, s[12:15], s65 offen sc1
    v_cvt_pk_f16_f32 v188, v118, v119
    v_cvt_pk_f16_f32 v189, v122, v123
    v_cvt_pk_f16_f32 v190, v126, v127
    v_cvt_pk_f16_f32 v191, v130, v131
    v_bfi_b32 v188, s33, v16, v188
    v_bfi_b32 v189, s33, v17, v189
    v_bfi_b32 v190, s33, v18, v190
    v_bfi_b32 v191, s33, v19, v191
    buffer_store_dwordx4 v[188:191], v160, s[12:15], s67 offen sc1
    s_waitcnt vmcnt(4)
    s_barrier
    v_mov_b32 v48, v170
    v_mov_b32 v49, v171
    v_mov_b32 v50, s32
    v_mov_b32 v51, s39
    s_cmp_lg_u32 s16, 0
    s_cbranch_scc1 f_nzl
    s_lshl_b32 s68, s3, 7
    s_add_u32 s68, s68, 6520832
    v_mov_b32 v52, 0
    s_mov_b64 exec, 1
    buffer_store_dwordx2 v[50:51], v52, s[12:15], s68 offen sc1
    s_mov_b64 exec, -1
f_nzl:
    ds_read_b128 v[192:195], v3 offset:33280
    ds_read_b128 v[196:199], v3 offset:34304
    ds_read_b128 v[200:203], v3 offset:35328
    ds_read_b128 v[204:207], v3 offset:36352
    ds_read_b128 v[208:211], v3 offset:37376
    ds_read_b128 v[212:215], v3 offset:38400
    ds_read_b128 v[216:219], v3 offset:39424
    ds_read_b128 v[220:223], v3 offset:40448
    ds_read_b128 v[224:227], v3 offset:41472
    ds_read_b128 v[228:231], v3 offset:42496
    ds_read_b128 v[232:235], v3 offset:43520
    ds_read_b128 v[236:239], v3 offset:44544
    v_lshlrev_b32 v4, 15, v49
    v_lshl_add_u32 v4, v48, 4, v4
    v_lshlrev_b32 v14, 13, v49
    v_lshl_add_u32 v14, v48, 4, v14
    v_lshl_add_u32 v254, v1, 10, v14
    v_xor_b32 v255, 64, v254
    v_lshrrev_b32 v57, 1, v1
    v_lshlrev_b32 v252, 13, v57
    v_and_b32 v57, 1, v1
    v_lshl_add_u32 v252, v57, 3, v252
    v_lshl_add_u32 v252, v49, 11, v252
    v_and_b32 v57, 3, v0
    v_lshl_add_u32 v252, v57, 8, v252
    v_lshrrev_b32 v58, 2, v48
    v_lshl_add_u32 v252, v58, 4, v252
    v_and_b32 v59, 1, v0
    v_lshl_add_u32 v252, v59, 6, v252
    v_xor_b32 v253, 64, v252
    v_lshl_add_u32 v57, v49, 2, v57
    v_lshlrev_b32 v57, 4, v57
    v_lshl_add_u32 v250, v58, 8, v57
    v_add_u32 v5, 82432, v3
    v_sub_u32 v6, 83440, v3
    v_lshl_add_u32 v57, v48, 2, v49
    v_lshl_add_u32 v8, v57, 3, s45
    s_add_u32 s43, s45, 2552
    v_lshlrev_b32 v58, 3, v57
    v_sub_u32 v9, s43, v58
    v_add_u32 v57, 1, v57
    v_and_b32 v58, 3, v57
    v_and_b32 v57, 60, v57
    v_lshl_add_u32 v7, v58, 6, v57
    v_add_u32 v10, s45, v3
    v_lshlrev_b32 v12, 2, v48
    v_add_u32 v12, 102912, v12
    v_lshlrev_b32 v13, 12, v2
    v_and_b32 v251, 0x70, v3
    v_lshlrev_b32 v15, 4, v0
    v_and_b32 v57, 3, v0
    v_bfe_u32 v58, v0, 2, 4
    v_lshl_add_u32 v57, v57, 4, v58
    v_bfe_u32 v58, v0, 6, 2
    v_lshl_add_u32 v57, v58, 6, v57
    v_lshrrev_b32 v58, 8, v0
    v_lshl_add_u32 v57, v58, 9, v57
    v_lshlrev_b32 v57, 4, v57
    v_add_u32 v1, 82432, v57
    s_and_b32 s42, s35, 3
    s_lshl_b32 s42, s42, 8
    v_xor_b32 v249, s42, v3
    s_mov_b32 s44, 131074
    v_and_b32 v16, s33, v16
    v_and_b32 v17, s33, v17
    v_and_b32 v18, s33, v18
    v_and_b32 v19, s33, v19
    v_xor_b32 v16, s44, v16
    v_xor_b32 v17, s44, v17
    v_xor_b32 v18, s44, v18
    v_xor_b32 v19, s44, v19
    s_mov_b32 s41, 6496256
    s_and_b32 s40, s16, 4
    s_lshl_b32 s40, s40, 10
    s_sub_u32 s40, 6504448, s40
    s_lshl_b32 s54, s3, 13
    s_add_u32 s54, s54, 5242880
    s_lshr_b32 s43, s60, 6
    s_and_b32 s55, s60, 63
    s_mul_i32 s55, s55, 5
    s_lshl_b32 s43, s43, 9
    s_add_u32 s55, s55, s43
    s_add_u32 s55, s55, 192
    s_mul_i32 s55, s55, 7168
    s_mul_i32 s43, s34, 896
    s_add_u32 s55, s55, s43
    s_mov_b32 s48, 4294967295
    s_mov_b32 s49, 255
    s_cmp_lt_u32 s16, 0
    s_cselect_b64 s[48:49], 0, s[48:49]
    s_mov_b32 s52, 6488064
    s_mov_b32 s53, 6492160
    s_barrier
    s_mov_b32 m0, s45
    s_add_u32 s43, s45, 2048
    buffer_load_dwordx4 v3, s[8:11], s18 offen lds
    buffer_load_dwordx4 v3, s[8:11], s18 offen offset:1024 lds
    s_mov_b32 m0, s43
    s_nop 0
    buffer_load_dwordx4 v3, s[8:11], s19 offen lds
    buffer_load_dwordx4 v3, s[8:11], s19 offen offset:1024 lds
    buffer_load_dwordx4 v[244:247], v251, s[12:15], s76 offen
    v_add_u32 v248, 103296, v3
    s_mov_b32 s47, 2
    s_mov_b32 s83, 0
    s_cmp_ge_u32 s16, 4
    s_cbranch_scc1 f_s0
    s_sleep 4
    s_cmp_lg_u32 s34, 0
    s_cbranch_scc1 f_ci0
    s_add_u32 s68, s82, 32768
    buffer_load_dwordx4 v[120:123], v250, s[12:15], s68 offen offset:0
    buffer_load_dwordx4 v[124:127], v250, s[12:15], s68 offen offset:1024
f_ci0:
    buffer_load_dwordx4 v[112:115], v250, s[12:15], s82 offen offset:0
    buffer_load_dwordx4 v[116:119], v250, s[12:15], s82 offen offset:1024
    s_mov_b32 s47, 0
    s_waitcnt vmcnt(0)
f_c1:
    v_xor_b32 v112, s56, v112
    v_xor_b32 v113, s57, v113
    v_xor_b32 v114, s58, v114
    v_xor_b32 v115, s59, v115
    v_xor_b32 v116, s56, v116
    v_xor_b32 v117, s57, v117
    v_xor_b32 v118, s58, v118
    v_xor_b32 v119, s59, v119
    v_or3_b32 v48, v112, v113, v114
    v_or3_b32 v48, v48, v115, v116
    v_or3_b32 v48, v48, v117, v118
    v_or_b32 v48, v48, v119
    v_and_b32 v48, 0xff, v48
    v_cmp_ne_u32 vcc, 0, v48
    s_cmp_lg_u32 s34, 0
    s_cbranch_scc1 f_c1n
    s_mov_b64 s[68:69], vcc
    v_xor_b32 v120, s56, v120
    v_xor_b32 v121, s57, v121
    v_xor_b32 v122, s58, v122
    v_xor_b32 v123, s59, v123
    v_xor_b32 v124, s56, v124
    v_xor_b32 v125, s57, v125
    v_xor_b32 v126, s58, v126
    v_xor_b32 v127, s59, v127
    v_or3_b32 v48, v120, v121, v122
    v_or3_b32 v48, v48, v123, v124
    v_or3_b32 v48, v48, v125, v126
    v_or_b32 v48, v48, v127
    v_and_b32 v48, 0xff, v48
    v_cmp_ne_u32 vcc, 0, v48
    s_or_b64 vcc, vcc, s[68:69]
f_c1n:
    s_cbranch_vccnz f_c1bad
f_c1ok:
    v_pk_add_f32 v[112:113], v[112:113], v[116:117]
    v_pk_add_f32 v[114:115], v[114:115], v[118:119]
    s_nop 0
    v_add_f32_dpp v112, v112, v112 row_ror:4 row_mask:0xf bank_mask:0xf
    v_add_f32_dpp v113, v113, v113 row_ror:4 row_mask:0xf bank_mask:0xf
    v_add_f32_dpp v114, v114, v114 row_ror:4 row_mask:0xf bank_mask:0xf
    v_add_f32_dpp v115, v115, v115 row_ror:4 row_mask:0xf bank_mask:0xf
    v_add_f32_dpp v112, v112, v112 row_ror:8 row_mask:0xf bank_mask:0xf
    v_add_f32_dpp v113, v113, v113 row_ror:8 row_mask:0xf bank_mask:0xf
    v_add_f32_dpp v114, v114, v114 row_ror:8 row_mask:0xf bank_mask:0xf
    v_add_f32_dpp v115, v115, v115 row_ror:8 row_mask:0xf bank_mask:0xf
    v_cvt_pk_bf16_f32 v48, v112, v113
    v_lshlrev_b32 v112, 16, v48
    v_and_b32 v113, 0xffff0000, v48
    v_cvt_pk_bf16_f32 v49, v114, v115
    v_lshlrev_b32 v114, 16, v49
    v_and_b32 v115, 0xffff0000, v49
    v_add_f32 v112, 1.0, v112
    v_add_f32 v113, 1.0, v113
    v_add_f32 v114, 1.0, v114
    v_add_f32 v115, 1.0, v115
    v_cvt_pk_bf16_f32 v48, v112, v113
    v_lshlrev_b32 v112, 16, v48
    v_and_b32 v113, 0xffff0000, v48
    v_cvt_pk_bf16_f32 v49, v114, v115
    v_lshlrev_b32 v114, 16, v49
    v_and_b32 v115, 0xffff0000, v49
    v_max_f32_e64 v48, abs(v112), abs(v113)
    v_max3_f32 v48, abs(v114), abs(v115), v48
    s_cmp_lg_u32 s34, 0
    s_cbranch_scc1 f_c1m
    v_mov_b32 v50, v48
    v_pk_add_f32 v[120:121], v[120:121], v[124:125]
    v_pk_add_f32 v[122:123], v[122:123], v[126:127]
    s_nop 0
    v_add_f32_dpp v120, v120, v120 row_ror:4 row_mask:0xf bank_mask:0xf
    v_add_f32_dpp v121, v121, v121 row_ror:4 row_mask:0xf bank_mask:0xf
    v_add_f32_dpp v122, v122, v122 row_ror:4 row_mask:0xf bank_mask:0xf
    v_add_f32_dpp v123, v123, v123 row_ror:4 row_mask:0xf bank_mask:0xf
    v_add_f32_dpp v120, v120, v120 row_ror:8 row_mask:0xf bank_mask:0xf
    v_add_f32_dpp v121, v121, v121 row_ror:8 row_mask:0xf bank_mask:0xf
    v_add_f32_dpp v122, v122, v122 row_ror:8 row_mask:0xf bank_mask:0xf
    v_add_f32_dpp v123, v123, v123 row_ror:8 row_mask:0xf bank_mask:0xf
    v_cvt_pk_bf16_f32 v48, v120, v121
    v_lshlrev_b32 v120, 16, v48
    v_and_b32 v121, 0xffff0000, v48
    v_cvt_pk_bf16_f32 v49, v122, v123
    v_lshlrev_b32 v122, 16, v49
    v_and_b32 v123, 0xffff0000, v49
    v_max3_f32 v48, abs(v120), abs(v121), v50
    v_max3_f32 v48, abs(v122), abs(v123), v48
f_c1m:
    s_nop 1
    v_max_f32_dpp v48, v48, v48 quad_perm:[1,0,3,2] row_mask:0xf bank_mask:0xf
    s_nop 1
    v_max_f32_dpp v48, v48, v48 quad_perm:[2,3,0,1] row_mask:0xf bank_mask:0xf
    s_nop 0
    v_readlane_b32 s68, v48, 0
    v_readlane_b32 s69, v48, 16
    v_readlane_b32 s70, v48, 32
    v_readlane_b32 s71, v48, 48
    s_max_u32 s68, s68, s69
    s_max_u32 s70, s70, s71
    s_max_u32 s68, s68, s70
    s_lshr_b32 s68, s68, 23
    s_sub_u32 s69, s68, 120
    s_sub_i32 s68, s68, 127
    s_max_i32 s68, s68, -100
    s_min_i32 s68, s68, 120
    s_cmp_le_u32 s69, 9
    s_cselect_b32 s68, 2, s68
    s_cselect_b32 s17, 0, 0x20000
    s_sub_i32 s69, 127, s68
    s_lshl_b32 s69, s69, 23
    s_bitcmp1_b32 s16, 0
    s_cselect_b64 s[64:65], -1, 0
    s_bitcmp1_b32 s16, 1
    s_cselect_b64 s[66:67], -1, 0
    s_lshl_b32 s70, s16, 11
    v_cndmask_b32 v112, v112, v113, s[64:65]
    v_cndmask_b32 v114, v114, v115, s[64:65]
    v_cndmask_b32 v112, v112, v114, s[66:67]
    v_mul_f32 v112, s69, v112
    v_add_u32 v53, s70, v248
    v_cvt_pk_f16_f32 v48, v112, v112
    s_nop 0
    s_nop 0
    v_mov_b32_dpp v56, v48 quad_perm:[0,0,0,0] row_mask:0xf bank_mask:0xf
    v_mov_b32_dpp v57, v48 quad_perm:[1,1,1,1] row_mask:0xf bank_mask:0xf
    v_mov_b32_dpp v58, v48 quad_perm:[2,2,2,2] row_mask:0xf bank_mask:0xf
    v_mov_b32_dpp v59, v48 quad_perm:[3,3,3,3] row_mask:0xf bank_mask:0xf
    v_pk_mul_f16 v64, v144, v56
    v_pk_mul_f16 v68, v144, v56 op_sel:[1,0] op_sel_hi:[0,1] neg_lo:[1,0]
    v_pk_mul_f16 v65, v145, v57
    v_pk_mul_f16 v69, v145, v57 op_sel:[1,0] op_sel_hi:[0,1] neg_lo:[1,0]
    v_pk_mul_f16 v66, v146, v58
    v_pk_mul_f16 v70, v146, v58 op_sel:[1,0] op_sel_hi:[0,1] neg_lo:[1,0]
    v_pk_mul_f16 v67, v147, v59
    v_pk_mul_f16 v71, v147, v59 op_sel:[1,0] op_sel_hi:[0,1] neg_lo:[1,0]
    ds_write_b128 v53, v[64:67]
    ds_write_b128 v53, v[68:71] offset:1024
    s_cmp_lg_u32 s16, 0
    s_cbranch_scc1 f_nkr
    v_mov_b32 v54, s17
    s_mov_b32 s61, s68
    s_mov_b64 exec, 1
    ds_write_b32 v248, v54 offset:8192
    s_mov_b64 exec, -1
f_nkr:
    s_cmp_eq_u32 s34, 0
    s_cbranch_scc1 f_sa
f_nsa:
    v_mov_b32 v54, 1
    s_mov_b64 exec, 1
    ds_add_u32 v248, v54 offset:8196
    s_mov_b64 exec, -1
    s_bitset1_b32 s47, 1
    s_bitcmp1_b32 s47, 0
    s_cbranch_scc1 f_bar
    s_branch f_s1
f_s0:
    s_sleep 8
f_s1:
    buffer_load_dwordx4 v[32:35], v249, s[12:15], s72 offen offset:0 sc1
    buffer_load_dwordx4 v[36:39], v249, s[12:15], s72 offen offset:1024 sc1
    buffer_load_dwordx4 v[40:43], v249, s[12:15], s72 offen offset:2048 sc1
    buffer_load_dwordx4 v[44:47], v249, s[12:15], s72 offen offset:3072 sc1
    s_waitcnt vmcnt(4)
    s_mov_b32 s83, 0
    ds_read_b64 v[96:97], v8 offset:0
    ds_read_b64 v[98:99], v8 offset:512
    ds_read_b64 v[100:101], v8 offset:1024
    ds_read_b64 v[102:103], v8 offset:1536
    ds_read_b64 v[104:105], v9 offset:1536
    ds_read_b64 v[106:107], v9 offset:1024
    ds_read_b64 v[108:109], v9 offset:512
    ds_read_b64 v[110:111], v9 offset:0
    v_xor_b32 v2, s32, v244
    v_bitop3_b32 v2, v2, v246, s32 bitop3:0xf6
    v_bitop3_b32 v2, v2, v245, s39 bitop3:0xf6
    v_bitop3_b32 v2, v2, v247, s39 bitop3:0xf6
    v_cmp_ne_u32 vcc, 0, v2
    s_mov_b32 s38, vcc_lo
    v_mov_b32 v244, 111488
    s_waitcnt lgkmcnt(0)
    v_lshlrev_b32 v160, 16, v96
    v_and_b32 v161, 0xffff0000, v96
    v_lshlrev_b32 v162, 16, v97
    v_and_b32 v163, 0xffff0000, v97
    v_lshlrev_b32 v164, 16, v98
    v_and_b32 v165, 0xffff0000, v98
    v_lshlrev_b32 v166, 16, v99
    v_and_b32 v167, 0xffff0000, v99
    v_lshlrev_b32 v168, 16, v100
    v_and_b32 v169, 0xffff0000, v100
    v_lshlrev_b32 v170, 16, v101
    v_and_b32 v171, 0xffff0000, v101
    v_lshlrev_b32 v172, 16, v102
    v_and_b32 v173, 0xffff0000, v102
    v_lshlrev_b32 v174, 16, v103
    v_and_b32 v175, 0xffff0000, v103
    v_lshlrev_b32 v176, 16, v104
    v_and_b32 v177, 0xffff0000, v104
    v_lshlrev_b32 v178, 16, v105
    v_and_b32 v179, 0xffff0000, v105
    v_lshlrev_b32 v180, 16, v106
    v_and_b32 v181, 0xffff0000, v106
    v_lshlrev_b32 v182, 16, v107
    v_and_b32 v183, 0xffff0000, v107
    v_lshlrev_b32 v184, 16, v108
    v_and_b32 v185, 0xffff0000, v108
    v_lshlrev_b32 v186, 16, v109
    v_and_b32 v187, 0xffff0000, v109
    v_lshlrev_b32 v188, 16, v110
    v_and_b32 v189, 0xffff0000, v110
    v_lshlrev_b32 v190, 16, v111
    v_and_b32 v191, 0xffff0000, v111
    ds_read_b32 v246, v244 offset:4
    s_waitcnt lgkmcnt(0)
    v_readfirstlane_b32 s43, v246
    s_cmp_lg_u32 s43, 4
    s_cbranch_scc1 f_t1
    ds_read_b128 v[112:115], v248 offset:0
    ds_read_b128 v[116:119], v248 offset:1024
    ds_read_b128 v[120:123], v248 offset:2048
    ds_read_b128 v[124:127], v248 offset:3072
    ds_read_b128 v[128:131], v248 offset:4096
    ds_read_b128 v[132:135], v248 offset:5120
    ds_read_b128 v[136:139], v248 offset:6144
    ds_read_b128 v[140:143], v248 offset:7168
    ds_read_b32 v245, v244
    s_bitset1_b32 s47, 2
f_t1:
f_z1:
    s_waitcnt vmcnt(2)
    v_xor_b32 v80, v32, v16
    v_xor_b32 v81, v36, v16
    v_xor_b32 v82, v33, v17
    v_xor_b32 v83, v37, v17
    v_xor_b32 v84, v34, v18
    v_xor_b32 v85, v38, v18
    v_xor_b32 v86, v35, v19
    v_xor_b32 v87, v39, v19
    v_mfma_f32_16x16x16_f16 v[48:51], v[20:21], v[80:81], 0
    v_xor_b32 v2, s44, v80
    v_bitop3_b32 v2, v2, v81, s44 bitop3:0xf6
    v_mfma_f32_16x16x16_f16 v[52:55], v[20:21], v[82:83], 0
    v_bitop3_b32 v2, v2, v82, s44 bitop3:0xf6
    v_bitop3_b32 v2, v2, v83, s44 bitop3:0xf6
    v_mfma_f32_16x16x16_f16 v[56:59], v[20:21], v[84:85], 0
    v_bitop3_b32 v2, v2, v84, s44 bitop3:0xf6
    v_bitop3_b32 v2, v2, v85, s44 bitop3:0xf6
    v_mfma_f32_16x16x16_f16 v[60:63], v[20:21], v[86:87], 0
    v_bitop3_b32 v2, v2, v86, s44 bitop3:0xf6
    v_bitop3_b32 v2, v2, v87, s44 bitop3:0xf6
    s_waitcnt vmcnt(0)
    v_xor_b32 v88, v40, v16
    v_xor_b32 v89, v44, v16
    v_xor_b32 v90, v41, v17
    v_xor_b32 v91, v45, v17
    v_xor_b32 v92, v42, v18
    v_xor_b32 v93, v46, v18
    v_xor_b32 v94, v43, v19
    v_xor_b32 v95, v47, v19
    v_mfma_f32_16x16x16_f16 v[64:67], v[22:23], v[88:89], 0
    v_bitop3_b32 v2, v2, v88, s44 bitop3:0xf6
    v_bitop3_b32 v2, v2, v89, s44 bitop3:0xf6
    v_mfma_f32_16x16x16_f16 v[68:71], v[22:23], v[90:91], 0
    v_bitop3_b32 v2, v2, v90, s44 bitop3:0xf6
    v_bitop3_b32 v2, v2, v91, s44 bitop3:0xf6
    v_mfma_f32_16x16x16_f16 v[72:75], v[22:23], v[92:93], 0
    v_bitop3_b32 v2, v2, v92, s44 bitop3:0xf6
    v_bitop3_b32 v2, v2, v93, s44 bitop3:0xf6
    v_mfma_f32_16x16x16_f16 v[76:79], v[22:23], v[94:95], 0
    v_bitop3_b32 v2, v2, v94, s44 bitop3:0xf6
    v_bitop3_b32 v2, v2, v95, s44 bitop3:0xf6
    v_and_b32 v2, s33, v2
    v_cmp_ne_u32 vcc, 0, v2
    s_cbranch_vccnz f_z1bad
f_z1ok:
    v_cvt_pk_f16_f32 v32, v48, v49
    v_cvt_pk_f16_f32 v33, v64, v65
    ds_write_b64 v252, v[32:33] offset:0
    v_cvt_pk_f16_f32 v34, v50, v51
    v_cvt_pk_f16_f32 v35, v66, v67
    ds_write_b64 v252, v[34:35] offset:1024
    v_cvt_pk_f16_f32 v36, v52, v53
    v_cvt_pk_f16_f32 v37, v68, v69
    ds_write_b64 v253, v[36:37] offset:0
    v_cvt_pk_f16_f32 v38, v54, v55
    v_cvt_pk_f16_f32 v39, v70, v71
    ds_write_b64 v253, v[38:39] offset:1024
    v_cvt_pk_f16_f32 v40, v56, v57
    v_cvt_pk_f16_f32 v41, v72, v73
    ds_write_b64 v252, v[40:41] offset:128
    v_cvt_pk_f16_f32 v42, v58, v59
    v_cvt_pk_f16_f32 v43, v74, v75
    ds_write_b64 v252, v[42:43] offset:1152
    v_cvt_pk_f16_f32 v44, v60, v61
    v_cvt_pk_f16_f32 v45, v76, v77
    ds_write_b64 v253, v[44:45] offset:128
    v_cvt_pk_f16_f32 v46, v62, v63
    v_cvt_pk_f16_f32 v47, v78, v79
    ds_write_b64 v253, v[46:47] offset:1152
    s_bitset1_b32 s47, 0
    s_mov_b32 s83, 0
    s_bitcmp1_b32 s47, 1
    s_cbranch_scc0 f_c1
    s_bitcmp1_b32 s47, 2
    s_cbranch_scc1 f_bar
    ds_read_b32 v246, v244 offset:4
    s_waitcnt lgkmcnt(0)
    v_readfirstlane_b32 s43, v246
    s_cmp_lg_u32 s43, 4
    s_cbranch_scc1 f_bar
    ds_read_b128 v[112:115], v248 offset:0
    ds_read_b128 v[116:119], v248 offset:1024
    ds_read_b128 v[120:123], v248 offset:2048
    ds_read_b128 v[124:127], v248 offset:3072
    ds_read_b128 v[128:131], v248 offset:4096
    ds_read_b128 v[132:135], v248 offset:5120
    ds_read_b128 v[136:139], v248 offset:6144
    ds_read_b128 v[140:143], v248 offset:7168
    ds_read_b32 v245, v244
    s_bitset1_b32 s47, 2
f_bar:
    s_waitcnt lgkmcnt(0)
    s_bitcmp1_b32 s47, 2
    s_barrier
    s_cbranch_scc0 f_t3l
f_t3d:
    ds_read_b128 v[32:35], v254 offset:0
    ds_read_b128 v[36:39], v255 offset:256
    ds_read_b128 v[40:43], v254 offset:512
    ds_read_b128 v[44:47], v255 offset:768
    v_xor_b32 v16, 65537, v16
    v_xor_b32 v17, 65537, v17
    v_xor_b32 v18, 65537, v18
    v_xor_b32 v19, 65537, v19
    s_waitcnt lgkmcnt(3)
    v_mfma_f32_16x16x32_f16 v[48:51], v[32:35], v[24:27], 0
    v_mfma_f32_16x16x32_f16 v[52:55], v[32:35], v[28:31], 0
    s_waitcnt lgkmcnt(2)
    v_mfma_f32_16x16x32_f16 v[56:59], v[36:39], v[24:27], 0
    v_mfma_f32_16x16x32_f16 v[60:63], v[36:39], v[28:31], 0
    s_waitcnt lgkmcnt(1)
    v_mfma_f32_16x16x32_f16 v[64:67], v[40:43], v[24:27], 0
    v_mfma_f32_16x16x32_f16 v[68:71], v[40:43], v[28:31], 0
    s_waitcnt lgkmcnt(0)
    v_mfma_f32_16x16x32_f16 v[72:75], v[44:47], v[24:27], 0
    v_mfma_f32_16x16x32_f16 v[76:79], v[44:47], v[28:31], 0
    v_mov_b32 v2, v245
    v_xor_b32 v19, v245, v19
    ds_read_b128 v[240:243], v3 offset:45568
    ds_read_b128 v[244:247], v3 offset:46592
    ds_read_b128 v[248:251], v3 offset:47616
    ds_read_b128 v[252:255], v3 offset:48640
    v_cvt_pk_f16_f32 v144, v48, v52
    v_cvt_pk_f16_f32 v145, v49, v53
    v_cvt_pk_f16_f32 v146, v50, v54
    v_cvt_pk_f16_f32 v147, v51, v55
    v_cvt_pk_f16_f32 v148, v56, v60
    v_cvt_pk_f16_f32 v149, v57, v61
    v_cvt_pk_f16_f32 v150, v58, v62
    v_cvt_pk_f16_f32 v151, v59, v63
    v_mfma_f32_16x16x32_f16 v[80:83], v[144:147], v[112:115], 0
    v_mfma_f32_16x16x32_f16 v[84:87], v[144:147], v[116:119], 0
    v_cvt_pk_f16_f32 v152, v64, v68
    v_cvt_pk_f16_f32 v153, v65, v69
    v_cvt_pk_f16_f32 v154, v66, v70
    v_cvt_pk_f16_f32 v155, v67, v71
    v_mfma_f32_16x16x32_f16 v[88:91], v[148:151], v[120:123], 0
    v_mfma_f32_16x16x32_f16 v[92:95], v[148:151], v[124:127], 0
    v_cvt_pk_f16_f32 v156, v72, v76
    v_cvt_pk_f16_f32 v157, v73, v77
    v_cvt_pk_f16_f32 v158, v74, v78
    v_cvt_pk_f16_f32 v159, v75, v79
    v_mfma_f32_16x16x32_f16 v[96:99], v[152:155], v[128:131], 0
    v_mfma_f32_16x16x32_f16 v[100:103], v[152:155], v[132:135], 0
    v_mfma_f32_16x16x32_f16 v[104:107], v[156:159], v[136:139], 0
    v_mfma_f32_16x16x32_f16 v[108:111], v[156:159], v[140:143], 0
    s_cmp_eq_u32 s16, 0
    s_cbranch_scc1 f_sb
f_nsb:
    buffer_load_dwordx4 v[20:23], v15, s[12:15], s52 offen
    v_cvt_pk_f16_f32 v32, v80, v84
    v_cvt_pk_f16_f32 v36, v81, v85
    v_cvt_pk_f16_f32 v40, v82, v86
    v_cvt_pk_f16_f32 v44, v83, v87
    v_bfi_b32 v32, s33, v16, v32
    v_bfi_b32 v36, s33, v16, v36
    v_bfi_b32 v40, s33, v16, v40
    v_bfi_b32 v44, s33, v16, v44
    v_cvt_pk_f16_f32 v33, v88, v92
    v_cvt_pk_f16_f32 v37, v89, v93
    v_cvt_pk_f16_f32 v41, v90, v94
    v_cvt_pk_f16_f32 v45, v91, v95
    v_bfi_b32 v33, s33, v17, v33
    v_bfi_b32 v37, s33, v17, v37
    v_bfi_b32 v41, s33, v17, v41
    v_bfi_b32 v45, s33, v17, v45
    v_cvt_pk_f16_f32 v34, v96, v100
    v_cvt_pk_f16_f32 v38, v97, v101
    v_cvt_pk_f16_f32 v42, v98, v102
    v_cvt_pk_f16_f32 v46, v99, v103
    v_bfi_b32 v34, s33, v18, v34
    v_bfi_b32 v38, s33, v18, v38
    v_bfi_b32 v42, s33, v18, v42
    v_bfi_b32 v46, s33, v18, v46
    v_cvt_pk_f16_f32 v35, v104, v108
    v_cvt_pk_f16_f32 v39, v105, v109
    v_cvt_pk_f16_f32 v43, v106, v110
    v_cvt_pk_f16_f32 v47, v107, v111
    v_bfi_b32 v35, s33, v19, v35
    v_bfi_b32 v39, s33, v19, v39
    v_bfi_b32 v43, s33, v19, v43
    v_bfi_b32 v47, s33, v19, v47
    s_cmp_lg_u32 s38, 0
    s_cbranch_scc1 f_slowst
    buffer_store_dwordx4 v[32:35], v14, s[12:15], s74 offen offset:0 nt
    buffer_store_dwordx4 v[36:39], v14, s[12:15], s74 offen offset:2048 nt
    buffer_store_dwordx4 v[40:43], v14, s[12:15], s75 offen offset:0 nt
    buffer_store_dwordx4 v[44:47], v14, s[12:15], s75 offen offset:2048 nt
f_std:
    s_mov_b32 s83, 0
    s_waitcnt vmcnt(4)
f_pp:
    v_xor_b32 v20, s56, v20
    v_xor_b32 v21, s57, v21
    v_xor_b32 v22, s58, v22
    v_xor_b32 v23, s59, v23
    v_or3_b32 v48, v20, v21, v22
    v_or_b32 v48, v48, v23
    v_and_b32 v48, 0xff, v48
    v_cmp_ne_u32 vcc, 0, v48
    s_cbranch_vccnz f_ppbad
f_ppok:
    ds_write_b128 v1, v[20:23]
    s_cmp_ge_u32 s16, 4
    s_cbranch_scc1 f_pw
    v_pk_add_f32 v[48:49], v[20:21], v[22:23]
    v_add_f32 v48, v48, v49
    s_nop 1
    v_add_f32_dpp v48, v48, v48 row_ror:8 row_mask:0xf bank_mask:0xf
    s_nop 1
    v_add_f32_dpp v48, v48, v48 row_ror:4 row_mask:0xf bank_mask:0xf
    s_nop 1
    v_add_f32_dpp v48, v48, v48 row_ror:2 row_mask:0xf bank_mask:0xf
    s_nop 1
    v_add_f32_dpp v48, v48, v48 row_ror:1 row_mask:0xf bank_mask:0xf
    s_nop 1
    v_add_f32_dpp v48, v48, v48 row_bcast:15 row_mask:0xa bank_mask:0xf
    s_nop 1
    v_add_f32_dpp v48, v48, v48 row_bcast:31 row_mask:0xc bank_mask:0xf
    s_mov_b32 exec_lo, 0
    s_mov_b32 exec_hi, 0x80000000
    ds_write_b32 v11, v48 offset:64
    s_mov_b64 exec, -1
f_pw:
    s_waitcnt lgkmcnt(0)
    s_barrier
    buffer_load_dwordx4 v[32:35], v4, s[12:15], s28 offen sc1 nt
    buffer_load_dwordx4 v[36:39], v4, s[12:15], s29 offen sc1 nt
    buffer_load_dwordx4 v[40:43], v4, s[12:15], s50 offen sc1 nt
    buffer_load_dwordx4 v[44:47], v4, s[12:15], s51 offen sc1 nt
    ds_read_b128 v[112:115], v5 offset:8192
    ds_read_b128 v[128:131], v6 offset:11264
    ds_read_b128 v[48:51], v5 offset:0
    ds_read_b128 v[64:67], v6 offset:3072
    ds_read_b128 v[116:119], v5 offset:9216
    ds_read_b128 v[132:135], v6 offset:10240
    ds_read_b128 v[52:55], v5 offset:1024
    ds_read_b128 v[68:71], v6 offset:2048
    v_xor_b32 v19, v2, v19
    v_xor_b32 v16, s44, v16
    v_xor_b32 v17, s44, v17
    v_xor_b32 v18, s44, v18
    v_xor_b32 v19, s44, v19
    v_bfe_u32 v20, v0, 3, 3
    v_mul_u32_u24 v20, 7168, v20
    v_and_b32 v151, 7, v0
    v_min_u32 v151, 6, v151
    v_lshl_add_u32 v151, v151, 7, v20
    v_mov_b32 v20, 102976
    v_lshrrev_b32 v23, 5, v0
    v_mov_b32 v22, 0xffffff00
    v_mov_b32 v21, 0x20000
    s_mov_b64 s[70:71], 1
    s_mov_b32 s83, 1
    s_mov_b32 s83, 0
    s_mov_b64 s[72:73], -1
    s_mov_b64 s[74:75], -1
    s_mov_b64 s[78:79], -1
    s_mov_b64 s[36:37], -1
    s_branch f_zp
f_zr:
    s_mov_b64 exec, s[72:73]
    buffer_load_dwordx4 v[32:35], v4, s[12:15], s28 offen sc1 nt
    s_mov_b64 exec, s[74:75]
    buffer_load_dwordx4 v[36:39], v4, s[12:15], s29 offen sc1 nt
    s_mov_b64 exec, s[78:79]
    buffer_load_dwordx4 v[40:43], v4, s[12:15], s50 offen sc1 nt
    s_mov_b64 exec, s[36:37]
    buffer_load_dwordx4 v[44:47], v4, s[12:15], s51 offen sc1 nt
f_zp:
    s_add_u32 s83, s83, 1
    s_cmp_lt_u32 s83, 0x40000
    s_cselect_b64 s[68:69], -1, 0
    s_mov_b64 exec, s[72:73]
    s_waitcnt vmcnt(3)
    v_xor_b32 v32, v32, v16
    v_xor_b32 v33, v33, v17
    v_xor_b32 v34, v34, v18
    v_xor_b32 v35, v35, v19
    v_bitop3_b32 v144, v35, v21, s44 bitop3:0x56
    v_bitop3_b32 v144, v144, v32, s44 bitop3:0xf6
    v_bitop3_b32 v144, v144, v33, s44 bitop3:0xf6
    v_bitop3_b32 v144, v144, v34, s44 bitop3:0xf6
    v_and_b32 v144, s33, v144
    v_cmp_ne_u32 s[72:73], 0, v144
    s_mov_b64 exec, s[74:75]
    s_waitcnt vmcnt(2)
    v_xor_b32 v36, v36, v16
    v_xor_b32 v37, v37, v17
    v_xor_b32 v38, v38, v18
    v_xor_b32 v39, v39, v19
    v_bitop3_b32 v145, v39, v21, s44 bitop3:0x56
    v_bitop3_b32 v145, v145, v36, s44 bitop3:0xf6
    v_bitop3_b32 v145, v145, v37, s44 bitop3:0xf6
    v_bitop3_b32 v145, v145, v38, s44 bitop3:0xf6
    v_and_b32 v145, s33, v145
    v_cmp_ne_u32 s[74:75], 0, v145
    s_mov_b64 exec, s[78:79]
    s_waitcnt vmcnt(1)
    v_xor_b32 v40, v40, v16
    v_xor_b32 v41, v41, v17
    v_xor_b32 v42, v42, v18
    v_xor_b32 v43, v43, v19
    v_bitop3_b32 v146, v43, v21, s44 bitop3:0x56
    v_bitop3_b32 v146, v146, v40, s44 bitop3:0xf6
    v_bitop3_b32 v146, v146, v41, s44 bitop3:0xf6
    v_bitop3_b32 v146, v146, v42, s44 bitop3:0xf6
    v_and_b32 v146, s33, v146
    v_cmp_ne_u32 s[78:79], 0, v146
    s_or_b64 s[64:65], s[72:73], s[74:75]
    s_mov_b64 exec, s[36:37]
    s_waitcnt vmcnt(0)
    v_xor_b32 v44, v44, v16
    v_xor_b32 v45, v45, v17
    v_xor_b32 v46, v46, v18
    v_xor_b32 v47, v47, v19
    v_bitop3_b32 v147, v47, v21, s44 bitop3:0x56
    v_bitop3_b32 v147, v147, v44, s44 bitop3:0xf6
    v_bitop3_b32 v147, v147, v45, s44 bitop3:0xf6
    v_bitop3_b32 v147, v147, v46, s44 bitop3:0xf6
    v_and_b32 v147, s33, v147
    v_cmp_ne_u32 s[36:37], 0, v147
    s_mov_b64 exec, -1
    v_bitop3_b32 v2, v35, v39, v21 bitop3:0x80
    v_bitop3_b32 v2, v2, v43, v47 bitop3:0x80
    v_cmp_eq_u32 vcc, 0, v2
    s_or_b64 s[66:67], s[78:79], s[36:37]
    s_or_b64 s[64:65], s[64:65], s[66:67]
    s_and_b64 s[64:65], s[64:65], s[68:69]
    s_cbranch_scc1 f_zr
    s_cbranch_vccnz f_rare
f_zf:
    v_mfma_f32_16x16x32_f16 v[80:83], v[32:35], v[192:195], 0
    ds_read_b128 v[120:123], v5 offset:10240
    ds_read_b128 v[136:139], v6 offset:9216
    v_mfma_f32_16x16x32_f16 v[80:83], v[36:39], v[196:199], v[80:83]
    ds_read_b128 v[56:59], v5 offset:2048
    ds_read_b128 v[72:75], v6 offset:1024
    v_mfma_f32_16x16x32_f16 v[80:83], v[40:43], v[200:203], v[80:83]
    ds_read_b128 v[124:127], v5 offset:11264
    ds_read_b128 v[140:143], v6 offset:8192
    v_mfma_f32_16x16x32_f16 v[80:83], v[44:47], v[204:207], v[80:83]
    ds_read_b128 v[60:63], v5 offset:3072
    ds_read_b128 v[76:79], v6 offset:0
    v_mfma_f32_16x16x32_f16 v[84:87], v[32:35], v[208:211], 0
    ds_read2_b32 v[28:29], v20 offset0:1 offset1:3
    ds_read2_b32 v[30:31], v20 offset0:5 offset1:7
    v_mfma_f32_16x16x32_f16 v[84:87], v[36:39], v[212:215], v[84:87]
    v_mfma_f32_16x16x32_f16 v[84:87], v[40:43], v[216:219], v[84:87]
    v_mfma_f32_16x16x32_f16 v[84:87], v[44:47], v[220:223], v[84:87]
f_zfok:
    s_waitcnt lgkmcnt(10)
    s_cmp_eq_u32 s30, 0
    s_cbranch_scc1 f_sp
    v_mfma_f32_16x16x32_f16 v[88:91], v[32:35], v[224:227], 0
    v_pk_fma_f32 v[160:161], v[112:113], v[80:81], v[160:161]
    v_pk_fma_f32 v[162:163], v[114:115], v[82:83], v[162:163]
    v_mfma_f32_16x16x32_f16 v[88:91], v[36:39], v[228:231], v[88:91]
    v_fmac_f32 v177, v129, v83
    v_fmac_f32 v178, v130, v82
    v_fmac_f32 v179, v131, v81
    v_mfma_f32_16x16x32_f16 v[88:91], v[40:43], v[232:235], v[88:91]
    v_pk_mul_f32 v[146:147], v[160:161], v[160:161]
    v_pk_mul_f32 v[148:149], v[160:161], v[48:49]
    v_mfma_f32_16x16x32_f16 v[88:91], v[44:47], v[236:239], v[88:91]
    v_pk_fma_f32 v[146:147], v[162:163], v[162:163], v[146:147]
    v_pk_fma_f32 v[148:149], v[162:163], v[50:51], v[148:149]
    v_mfma_f32_16x16x32_f16 v[92:95], v[32:35], v[240:243], 0
    v_cndmask_b32 v100, v80, v84, s[70:71]
    ds_bpermute_b32 v96, v7, v100
    v_pk_fma_f32 v[164:165], v[116:117], v[84:85], v[164:165]
    v_pk_fma_f32 v[166:167], v[118:119], v[86:87], v[166:167]
    v_mfma_f32_16x16x32_f16 v[92:95], v[36:39], v[244:247], v[92:95]
    v_fmac_f32 v181, v133, v87
    v_fmac_f32 v182, v134, v86
    v_fmac_f32 v183, v135, v85
    v_mfma_f32_16x16x32_f16 v[92:95], v[40:43], v[248:251], v[92:95]
    v_pk_fma_f32 v[146:147], v[164:165], v[164:165], v[146:147]
    v_pk_fma_f32 v[148:149], v[164:165], v[52:53], v[148:149]
    v_mfma_f32_16x16x32_f16 v[92:95], v[44:47], v[252:255], v[92:95]
    v_pk_fma_f32 v[146:147], v[166:167], v[166:167], v[146:147]
    v_pk_fma_f32 v[148:149], v[166:167], v[54:55], v[148:149]
    v_pk_mul_f32 v[154:155], v[178:179], v[178:179]
    v_pk_mul_f32 v[156:157], v[178:179], v[66:67]
    v_pk_fma_f32 v[154:155], v[182:183], v[182:183], v[154:155]
    v_pk_fma_f32 v[156:157], v[182:183], v[70:71], v[156:157]
    v_pk_add_f32 v[144:145], v[160:161], v[162:163]
    v_pk_add_f32 v[152:153], v[178:179], v[182:183]
    s_waitcnt lgkmcnt(1)
    v_cndmask_b32 v101, v84, v88, s[70:71]
    ds_bpermute_b32 v97, v7, v101
    v_pk_fma_f32 v[168:169], v[120:121], v[88:89], v[168:169]
    v_pk_fma_f32 v[170:171], v[122:123], v[90:91], v[170:171]
    v_fmac_f32 v185, v137, v91
    v_fmac_f32 v186, v138, v90
    v_fmac_f32 v187, v139, v89
    v_pk_add_f32 v[144:145], v[144:145], v[164:165]
    v_pk_add_f32 v[144:145], v[144:145], v[166:167]
    v_pk_fma_f32 v[146:147], v[168:169], v[168:169], v[146:147]
    v_pk_fma_f32 v[148:149], v[168:169], v[56:57], v[148:149]
    v_pk_fma_f32 v[146:147], v[170:171], v[170:171], v[146:147]
    v_pk_fma_f32 v[148:149], v[170:171], v[58:59], v[148:149]
    v_pk_fma_f32 v[154:155], v[186:187], v[186:187], v[154:155]
    v_pk_fma_f32 v[156:157], v[186:187], v[74:75], v[156:157]
    v_cndmask_b32 v102, v88, v92, s[70:71]
    ds_bpermute_b32 v98, v7, v102
    v_cndmask_b32 v103, v92, v80, s[70:71]
    ds_bpermute_b32 v99, v7, v103
    v_pk_fma_f32 v[172:173], v[124:125], v[92:93], v[172:173]
    v_pk_fma_f32 v[174:175], v[126:127], v[94:95], v[174:175]
    v_fmac_f32 v189, v141, v95
    v_fmac_f32 v190, v142, v94
    v_fmac_f32 v191, v143, v93
    v_pk_fma_f32 v[146:147], v[172:173], v[172:173], v[146:147]
    v_pk_fma_f32 v[148:149], v[172:173], v[60:61], v[148:149]
    v_pk_fma_f32 v[146:147], v[174:175], v[174:175], v[146:147]
    v_pk_fma_f32 v[148:149], v[174:175], v[62:63], v[148:149]
    v_pk_fma_f32 v[154:155], v[190:191], v[190:191], v[154:155]
    v_pk_fma_f32 v[156:157], v[190:191], v[78:79], v[156:157]
    v_pk_add_f32 v[144:145], v[144:145], v[168:169]
    v_pk_add_f32 v[144:145], v[144:145], v[170:171]
    v_pk_add_f32 v[144:145], v[144:145], v[172:173]
    v_pk_add_f32 v[144:145], v[144:145], v[174:175]
    v_pk_add_f32 v[152:153], v[152:153], v[186:187]
    v_pk_add_f32 v[152:153], v[152:153], v[190:191]
    s_waitcnt lgkmcnt(0)
    v_fmac_f32 v176, v128, v96
    v_fmac_f32 v180, v132, v97
    v_fmac_f32 v184, v136, v98
    v_fmac_f32 v188, v140, v99
    v_pk_fma_f32 v[154:155], v[176:177], v[176:177], v[154:155]
    v_pk_fma_f32 v[156:157], v[176:177], v[64:65], v[156:157]
    v_pk_add_f32 v[152:153], v[152:153], v[176:177]
    v_pk_fma_f32 v[154:155], v[180:181], v[180:181], v[154:155]
    v_pk_fma_f32 v[156:157], v[180:181], v[68:69], v[156:157]
    v_pk_add_f32 v[152:153], v[152:153], v[180:181]
    v_pk_fma_f32 v[154:155], v[184:185], v[184:185], v[154:155]
    v_pk_fma_f32 v[156:157], v[184:185], v[72:73], v[156:157]
    v_pk_add_f32 v[152:153], v[152:153], v[184:185]
    v_pk_fma_f32 v[154:155], v[188:189], v[188:189], v[154:155]
    v_pk_fma_f32 v[156:157], v[188:189], v[76:77], v[156:157]
    v_pk_add_f32 v[152:153], v[152:153], v[188:189]
f_join:
    v_pk_add_f32 v[28:29], v[28:29], v[30:31]
    s_mov_b64 exec, s[48:49]
    buffer_load_dword v150, v151, s[20:23], s55 offen
    s_mov_b64 exec, -1
f_ngo:
    v_add_f32 v104, v144, v145
    v_add_f32 v105, v146, v147
    v_add_f32 v106, v148, v149
    v_add_f32 v108, v152, v153
    v_add_f32 v109, v154, v155
    v_add_f32 v110, v156, v157
    v_add_f32 v28, v28, v29
    v_permlane32_swap_b32 v104, v108
    v_permlane32_swap_b32 v105, v109
    v_permlane32_swap_b32 v106, v110
    v_add_f32 v104, v104, v108
    v_add_f32 v105, v105, v109
    v_add_f32 v106, v106, v110
    v_add_f32_dpp v104, v104, v104 row_ror:8 row_mask:0xf bank_mask:0xf
    v_add_f32_dpp v105, v105, v105 row_ror:8 row_mask:0xf bank_mask:0xf
    v_add_f32_dpp v106, v106, v106 row_ror:8 row_mask:0xf bank_mask:0xf
    v_add_f32_dpp v104, v104, v104 row_ror:4 row_mask:0xf bank_mask:0xf
    v_add_f32_dpp v105, v105, v105 row_ror:4 row_mask:0xf bank_mask:0xf
    v_add_f32_dpp v106, v106, v106 row_ror:4 row_mask:0xf bank_mask:0xf
    v_add_f32_dpp v104, v104, v104 row_ror:2 row_mask:0xf bank_mask:0xf
    v_add_f32_dpp v105, v105, v105 row_ror:2 row_mask:0xf bank_mask:0xf
    v_add_f32_dpp v106, v106, v106 row_ror:2 row_mask:0xf bank_mask:0xf
    v_add_f32_dpp v104, v104, v104 row_ror:1 row_mask:0xf bank_mask:0xf
    v_add_f32_dpp v105, v105, v105 row_ror:1 row_mask:0xf bank_mask:0xf
    v_add_f32_dpp v106, v106, v106 row_ror:1 row_mask:0xf bank_mask:0xf
    v_add_f32_dpp v104, v104, v104 row_bcast:15 row_mask:0xa bank_mask:0xf
    v_add_f32_dpp v105, v105, v105 row_bcast:15 row_mask:0xa bank_mask:0xf
    v_add_f32_dpp v106, v106, v106 row_bcast:15 row_mask:0xa bank_mask:0xf
    v_mul_f32 v104, s46, v104
    v_mul_f32 v105, s46, v105
    v_mul_f32 v108, v104, v104
    v_fma_f32 v106, -v104, v28, v106
    v_sub_f32 v105, v105, v108
    v_mul_f32 v109, 4.0, v105
    v_cmp_gt_f32 vcc, v108, v109
    s_or_b32 s42, vcc_lo, vcc_hi
    s_bitcmp1_b32 s42, 31
    s_cbranch_scc1 f_slow2
f_var2:
    v_cvt_pk_bf16_f32 v105, v105, v105
    v_lshlrev_b32 v105, 16, v105
    v_add_f32 v105, 0x3727c5ac, v105
    v_cvt_pk_bf16_f32 v105, v105, v105
    v_lshlrev_b32 v105, 16, v105
    v_sqrt_f32 v105, v105
    s_nop 0
    v_cvt_pk_bf16_f32 v105, v105, v105
    v_lshlrev_b32 v105, 16, v105
    v_rcp_f32 v105, v105
    s_mov_b32 s42, 0x80000000
    s_mov_b32 exec_lo, s42
    s_mov_b32 exec_hi, s42
    v_mul_f32 v106, v106, v105
    v_ashrrev_i32 v108, 31, v106
    v_or_b32 v108, s42, v108
    v_xor_b32 v106, v106, v108
    v_and_or_b32 v106, v106, v22, v23
    ds_write_b32 v11, v106
    s_mov_b64 exec, -1
    v_readlane_b32 s60, v106, 31
    v_readlane_b32 s64, v104, 31
    v_readlane_b32 s65, v105, 31
    v_readlane_b32 s61, v106, 63
    v_readlane_b32 s66, v104, 63
    v_readlane_b32 s67, v105, 63
    s_waitcnt lgkmcnt(0)
    s_barrier
    ds_read_b32 v21, v12
    s_lshl_b32 s42, s3, 1
    s_movk_i32 s43, 0xff00
    v_mov_b32 v30, s32
    v_mov_b32 v31, s32
    s_cmp_lg_u32 s16, 0
    s_waitcnt lgkmcnt(0)
    s_cbranch_scc1 f_nkey
    s_setprio 3
    v_mov_b32 v28, v21
    s_nop 1
    v_max_u32_dpp v28, v28, v28 row_ror:8 row_mask:0xf bank_mask:0xf
    s_nop 1
    v_max_u32_dpp v28, v28, v28 row_ror:4 row_mask:0xf bank_mask:0xf
    s_nop 1
    v_max_u32_dpp v28, v28, v28 row_ror:2 row_mask:0xf bank_mask:0xf
    s_nop 1
    v_max_u32_dpp v28, v28, v28 row_ror:1 row_mask:0xf bank_mask:0xf
    v_cmp_eq_u32 vcc, v28, v21
    s_nop 1
    v_cndmask_b32_e64 v29, v21, 0, vcc
    v_and_b32 v28, s43, v28
    s_nop 0
    v_max_u32_dpp v29, v29, v29 row_ror:8 row_mask:0xf bank_mask:0xf
    s_nop 1
    v_max_u32_dpp v29, v29, v29 row_ror:4 row_mask:0xf bank_mask:0xf
    s_nop 1
    v_max_u32_dpp v29, v29, v29 row_ror:2 row_mask:0xf bank_mask:0xf
    s_nop 1
    v_max_u32_dpp v29, v29, v29 row_ror:1 row_mask:0xf bank_mask:0xf
    v_or_b32 v28, s42, v28
    v_and_b32 v29, s43, v29
    v_or3_b32 v29, v29, s42, 1
    s_mov_b64 exec, 0xff
    buffer_store_dwordx4 v[28:31], v13, s[12:15], s80 offen sc1
    s_mov_b64 exec, -1
    s_setprio 0
f_nkey:
    s_or_b32 s42, s35, s16
    s_cmp_lg_u32 s42, 0
    s_cbranch_scc1 f_ng1
    v_mov_b32 v2, s32
    s_mov_b64 exec, 1
    buffer_store_dword v2, v13, s[12:15], s81 offen offset:2048 sc1
    s_mov_b64 exec, -1
f_ng1:
    s_movk_i32 s62, 0x100
    v_cmp_lt_u32 vcc, s60, v21
    s_and_b32 s42, vcc_lo, 0xffff
    s_bcnt1_i32_b32 s42, s42
    s_cmp_ge_u32 s42, 2
    s_cbranch_scc1 f_nc0
    s_setprio 2
    v_pk_add_f32 v[48:49], v[160:161], s[64:65] op_sel:[0,0] op_sel_hi:[1,0] neg_lo:[0,1] neg_hi:[0,1]
    v_pk_add_f32 v[50:51], v[162:163], s[64:65] op_sel:[0,0] op_sel_hi:[1,0] neg_lo:[0,1] neg_hi:[0,1]
    v_pk_add_f32 v[52:53], v[164:165], s[64:65] op_sel:[0,0] op_sel_hi:[1,0] neg_lo:[0,1] neg_hi:[0,1]
    v_pk_add_f32 v[54:55], v[166:167], s[64:65] op_sel:[0,0] op_sel_hi:[1,0] neg_lo:[0,1] neg_hi:[0,1]
    v_pk_add_f32 v[56:57], v[168:169], s[64:65] op_sel:[0,0] op_sel_hi:[1,0] neg_lo:[0,1] neg_hi:[0,1]
    v_pk_add_f32 v[58:59], v[170:171], s[64:65] op_sel:[0,0] op_sel_hi:[1,0] neg_lo:[0,1] neg_hi:[0,1]
    v_pk_add_f32 v[60:61], v[172:173], s[64:65] op_sel:[0,0] op_sel_hi:[1,0] neg_lo:[0,1] neg_hi:[0,1]
    v_pk_add_f32 v[62:63], v[174:175], s[64:65] op_sel:[0,0] op_sel_hi:[1,0] neg_lo:[0,1] neg_hi:[0,1]
    v_pk_mul_f32 v[48:49], v[48:49], s[64:65] op_sel:[0,1] op_sel_hi:[1,1]
    v_pk_mul_f32 v[50:51], v[50:51], s[64:65] op_sel:[0,1] op_sel_hi:[1,1]
    v_pk_mul_f32 v[52:53], v[52:53], s[64:65] op_sel:[0,1] op_sel_hi:[1,1]
    v_pk_mul_f32 v[54:55], v[54:55], s[64:65] op_sel:[0,1] op_sel_hi:[1,1]
    v_pk_mul_f32 v[56:57], v[56:57], s[64:65] op_sel:[0,1] op_sel_hi:[1,1]
    v_pk_mul_f32 v[58:59], v[58:59], s[64:65] op_sel:[0,1] op_sel_hi:[1,1]
    v_pk_mul_f32 v[60:61], v[60:61], s[64:65] op_sel:[0,1] op_sel_hi:[1,1]
    v_pk_mul_f32 v[62:63], v[62:63], s[64:65] op_sel:[0,1] op_sel_hi:[1,1]
    v_cvt_pk_f16_f32 v80, v48, v49
    v_cvt_pk_f16_f32 v81, v50, v51
    ds_write_b64 v8, v[80:81] offset:0
    v_cvt_pk_f16_f32 v82, v52, v53
    v_cvt_pk_f16_f32 v83, v54, v55
    ds_write_b64 v8, v[82:83] offset:512
    v_cvt_pk_f16_f32 v84, v56, v57
    v_cvt_pk_f16_f32 v85, v58, v59
    ds_write_b64 v8, v[84:85] offset:1024
    v_cvt_pk_f16_f32 v86, v60, v61
    v_cvt_pk_f16_f32 v87, v62, v63
    ds_write_b64 v8, v[86:87] offset:1536
    ds_read_b128 v[88:91], v10 offset:0
    ds_read_b128 v[92:95], v10 offset:1024
    s_lshl_b32 s62, s3, 1
    s_add_u32 s62, s62, s42
    s_lshl_b32 s42, s62, 11
    s_add_u32 s42, s42, 5242880
    s_lshl_b32 s43, s62, 4
    s_add_u32 s43, s43, 6512640
    s_lshl_b32 s68, s30, 8
    s_or_b32 s68, s68, s56
    s_andn2_b32 s69, s64, 0xff
    s_or_b32 s69, s69, s57
    s_andn2_b32 s70, s65, 0xff
    s_or_b32 s70, s70, s58
    s_andn2_b32 s71, s60, 0xff
    s_or_b32 s71, s71, s59
    s_waitcnt lgkmcnt(0)
    v_bfi_b32 v88, s33, v16, v88
    v_bfi_b32 v89, s33, v17, v89
    v_bfi_b32 v90, s33, v18, v90
    v_bfi_b32 v91, s33, v19, v91
    v_bfi_b32 v92, s33, v16, v92
    v_bfi_b32 v93, s33, v17, v93
    v_bfi_b32 v94, s33, v18, v94
    v_bfi_b32 v95, s33, v19, v95
    buffer_store_dwordx4 v[88:91], v3, s[12:15], s42 offen offset:0 sc1
    buffer_store_dwordx4 v[92:95], v3, s[12:15], s42 offen offset:1024 sc1
    v_mov_b32 v24, s68
    v_mov_b32 v25, s69
    v_mov_b32 v26, s70
    v_mov_b32 v27, s71
    s_mov_b64 exec, 1
    buffer_store_dwordx4 v[24:27], v3, s[12:15], s43 offen sc1
    s_mov_b64 exec, -1
    s_setprio 0
f_nc0:
    s_movk_i32 s63, 0x100
    v_cmp_lt_u32 vcc, s61, v21
    s_and_b32 s42, vcc_lo, 0xffff
    s_bcnt1_i32_b32 s42, s42
    s_cmp_ge_u32 s42, 2
    s_cbranch_scc1 f_nc1
    s_setprio 2
    v_pk_add_f32 v[64:65], v[176:177], s[66:67] op_sel:[0,0] op_sel_hi:[1,0] neg_lo:[0,1] neg_hi:[0,1]
    v_pk_add_f32 v[66:67], v[178:179], s[66:67] op_sel:[0,0] op_sel_hi:[1,0] neg_lo:[0,1] neg_hi:[0,1]
    v_pk_add_f32 v[68:69], v[180:181], s[66:67] op_sel:[0,0] op_sel_hi:[1,0] neg_lo:[0,1] neg_hi:[0,1]
    v_pk_add_f32 v[70:71], v[182:183], s[66:67] op_sel:[0,0] op_sel_hi:[1,0] neg_lo:[0,1] neg_hi:[0,1]
    v_pk_add_f32 v[72:73], v[184:185], s[66:67] op_sel:[0,0] op_sel_hi:[1,0] neg_lo:[0,1] neg_hi:[0,1]
    v_pk_add_f32 v[74:75], v[186:187], s[66:67] op_sel:[0,0] op_sel_hi:[1,0] neg_lo:[0,1] neg_hi:[0,1]
    v_pk_add_f32 v[76:77], v[188:189], s[66:67] op_sel:[0,0] op_sel_hi:[1,0] neg_lo:[0,1] neg_hi:[0,1]
    v_pk_add_f32 v[78:79], v[190:191], s[66:67] op_sel:[0,0] op_sel_hi:[1,0] neg_lo:[0,1] neg_hi:[0,1]
    v_pk_mul_f32 v[64:65], v[64:65], s[66:67] op_sel:[0,1] op_sel_hi:[1,1]
    v_pk_mul_f32 v[66:67], v[66:67], s[66:67] op_sel:[0,1] op_sel_hi:[1,1]
    v_pk_mul_f32 v[68:69], v[68:69], s[66:67] op_sel:[0,1] op_sel_hi:[1,1]
    v_pk_mul_f32 v[70:71], v[70:71], s[66:67] op_sel:[0,1] op_sel_hi:[1,1]
    v_pk_mul_f32 v[72:73], v[72:73], s[66:67] op_sel:[0,1] op_sel_hi:[1,1]
    v_pk_mul_f32 v[74:75], v[74:75], s[66:67] op_sel:[0,1] op_sel_hi:[1,1]
    v_pk_mul_f32 v[76:77], v[76:77], s[66:67] op_sel:[0,1] op_sel_hi:[1,1]
    v_pk_mul_f32 v[78:79], v[78:79], s[66:67] op_sel:[0,1] op_sel_hi:[1,1]
    v_cvt_pk_f16_f32 v80, v64, v65
    v_cvt_pk_f16_f32 v81, v66, v67
    ds_write_b64 v9, v[80:81] offset:1536
    v_cvt_pk_f16_f32 v82, v68, v69
    v_cvt_pk_f16_f32 v83, v70, v71
    ds_write_b64 v9, v[82:83] offset:1024
    v_cvt_pk_f16_f32 v84, v72, v73
    v_cvt_pk_f16_f32 v85, v74, v75
    ds_write_b64 v9, v[84:85] offset:512
    v_cvt_pk_f16_f32 v86, v76, v77
    v_cvt_pk_f16_f32 v87, v78, v79
    ds_write_b64 v9, v[86:87] offset:0
    ds_read_b128 v[88:91], v10 offset:2048
    ds_read_b128 v[92:95], v10 offset:3072
    s_lshl_b32 s63, s3, 1
    s_add_u32 s63, s63, s42
    s_lshl_b32 s42, s63, 11
    s_add_u32 s42, s42, 5242880
    s_lshl_b32 s43, s63, 4
    s_add_u32 s43, s43, 6512640
    s_lshl_b32 s68, s31, 8
    s_or_b32 s68, s68, s56
    s_andn2_b32 s69, s66, 0xff
    s_or_b32 s69, s69, s57
    s_andn2_b32 s70, s67, 0xff
    s_or_b32 s70, s70, s58
    s_andn2_b32 s71, s61, 0xff
    s_or_b32 s71, s71, s59
    s_waitcnt lgkmcnt(0)
    v_bfi_b32 v88, s33, v16, v88
    v_bfi_b32 v89, s33, v17, v89
    v_bfi_b32 v90, s33, v18, v90
    v_bfi_b32 v91, s33, v19, v91
    v_bfi_b32 v92, s33, v16, v92
    v_bfi_b32 v93, s33, v17, v93
    v_bfi_b32 v94, s33, v18, v94
    v_bfi_b32 v95, s33, v19, v95
    buffer_store_dwordx4 v[88:91], v3, s[12:15], s42 offen offset:0 sc1
    buffer_store_dwordx4 v[92:95], v3, s[12:15], s42 offen offset:1024 sc1
    v_mov_b32 v24, s68
    v_mov_b32 v25, s69
    v_mov_b32 v26, s70
    v_mov_b32 v27, s71
    s_mov_b64 exec, 1
    buffer_store_dwordx4 v[24:27], v3, s[12:15], s43 offen sc1
    s_mov_b64 exec, -1
    s_setprio 0
f_nc1:
    buffer_load_dwordx4 v[96:99], v15, s[12:15], s41 offen
    buffer_load_dwordx4 v[100:103], v15, s[12:15], s40 offen
    s_cmp_lt_u32 s62, 0x100
    s_cbranch_scc1 f_op0
    v_pk_add_f32 v[48:49], v[160:161], s[64:65] op_sel:[0,0] op_sel_hi:[1,0] neg_lo:[0,1] neg_hi:[0,1]
    v_pk_add_f32 v[50:51], v[162:163], s[64:65] op_sel:[0,0] op_sel_hi:[1,0] neg_lo:[0,1] neg_hi:[0,1]
    v_pk_add_f32 v[52:53], v[164:165], s[64:65] op_sel:[0,0] op_sel_hi:[1,0] neg_lo:[0,1] neg_hi:[0,1]
    v_pk_add_f32 v[54:55], v[166:167], s[64:65] op_sel:[0,0] op_sel_hi:[1,0] neg_lo:[0,1] neg_hi:[0,1]
    v_pk_add_f32 v[56:57], v[168:169], s[64:65] op_sel:[0,0] op_sel_hi:[1,0] neg_lo:[0,1] neg_hi:[0,1]
    v_pk_add_f32 v[58:59], v[170:171], s[64:65] op_sel:[0,0] op_sel_hi:[1,0] neg_lo:[0,1] neg_hi:[0,1]
    v_pk_add_f32 v[60:61], v[172:173], s[64:65] op_sel:[0,0] op_sel_hi:[1,0] neg_lo:[0,1] neg_hi:[0,1]
    v_pk_add_f32 v[62:63], v[174:175], s[64:65] op_sel:[0,0] op_sel_hi:[1,0] neg_lo:[0,1] neg_hi:[0,1]
    v_pk_mul_f32 v[48:49], v[48:49], s[64:65] op_sel:[0,1] op_sel_hi:[1,1]
    v_pk_mul_f32 v[50:51], v[50:51], s[64:65] op_sel:[0,1] op_sel_hi:[1,1]
    v_pk_mul_f32 v[52:53], v[52:53], s[64:65] op_sel:[0,1] op_sel_hi:[1,1]
    v_pk_mul_f32 v[54:55], v[54:55], s[64:65] op_sel:[0,1] op_sel_hi:[1,1]
    v_pk_mul_f32 v[56:57], v[56:57], s[64:65] op_sel:[0,1] op_sel_hi:[1,1]
    v_pk_mul_f32 v[58:59], v[58:59], s[64:65] op_sel:[0,1] op_sel_hi:[1,1]
    v_pk_mul_f32 v[60:61], v[60:61], s[64:65] op_sel:[0,1] op_sel_hi:[1,1]
    v_pk_mul_f32 v[62:63], v[62:63], s[64:65] op_sel:[0,1] op_sel_hi:[1,1]
f_op0:
    s_cmp_lt_u32 s63, 0x100
    s_cbranch_scc1 f_op1
    v_pk_add_f32 v[64:65], v[176:177], s[66:67] op_sel:[0,0] op_sel_hi:[1,0] neg_lo:[0,1] neg_hi:[0,1]
    v_pk_add_f32 v[66:67], v[178:179], s[66:67] op_sel:[0,0] op_sel_hi:[1,0] neg_lo:[0,1] neg_hi:[0,1]
    v_pk_add_f32 v[68:69], v[180:181], s[66:67] op_sel:[0,0] op_sel_hi:[1,0] neg_lo:[0,1] neg_hi:[0,1]
    v_pk_add_f32 v[70:71], v[182:183], s[66:67] op_sel:[0,0] op_sel_hi:[1,0] neg_lo:[0,1] neg_hi:[0,1]
    v_pk_add_f32 v[72:73], v[184:185], s[66:67] op_sel:[0,0] op_sel_hi:[1,0] neg_lo:[0,1] neg_hi:[0,1]
    v_pk_add_f32 v[74:75], v[186:187], s[66:67] op_sel:[0,0] op_sel_hi:[1,0] neg_lo:[0,1] neg_hi:[0,1]
    v_pk_add_f32 v[76:77], v[188:189], s[66:67] op_sel:[0,0] op_sel_hi:[1,0] neg_lo:[0,1] neg_hi:[0,1]
    v_pk_add_f32 v[78:79], v[190:191], s[66:67] op_sel:[0,0] op_sel_hi:[1,0] neg_lo:[0,1] neg_hi:[0,1]
    v_pk_mul_f32 v[64:65], v[64:65], s[66:67] op_sel:[0,1] op_sel_hi:[1,1]
    v_pk_mul_f32 v[66:67], v[66:67], s[66:67] op_sel:[0,1] op_sel_hi:[1,1]
    v_pk_mul_f32 v[68:69], v[68:69], s[66:67] op_sel:[0,1] op_sel_hi:[1,1]
    v_pk_mul_f32 v[70:71], v[70:71], s[66:67] op_sel:[0,1] op_sel_hi:[1,1]
    v_pk_mul_f32 v[72:73], v[72:73], s[66:67] op_sel:[0,1] op_sel_hi:[1,1]
    v_pk_mul_f32 v[74:75], v[74:75], s[66:67] op_sel:[0,1] op_sel_hi:[1,1]
    v_pk_mul_f32 v[76:77], v[76:77], s[66:67] op_sel:[0,1] op_sel_hi:[1,1]
    v_pk_mul_f32 v[78:79], v[78:79], s[66:67] op_sel:[0,1] op_sel_hi:[1,1]
f_op1:
    s_mov_b32 s83, 0
    s_waitcnt vmcnt(0)
f_pb:
    v_xor_b32 v96, s56, v96
    v_xor_b32 v97, s57, v97
    v_xor_b32 v98, s58, v98
    v_xor_b32 v99, s59, v99
    v_xor_b32 v100, s56, v100
    v_xor_b32 v101, s57, v101
    v_xor_b32 v102, s58, v102
    v_xor_b32 v103, s59, v103
    v_or3_b32 v2, v96, v97, v98
    v_or3_b32 v2, v2, v99, v100
    v_or3_b32 v2, v2, v101, v102
    v_or_b32 v2, v2, v103
    v_and_b32 v2, 0xff, v2
    v_cmp_ne_u32 vcc, 0, v2
    s_cbranch_vccnz f_pbbad
f_pbok:
    ds_write_b128 v1, v[96:99] offset:4096
    s_cmp_ge_u32 s16, 4
    s_cbranch_scc1 f_pbx
    ds_write_b128 v1, v[100:103] offset:16384
f_pbx:
    s_waitcnt lgkmcnt(0)
    s_barrier
    ds_read_b128 v[192:195], v5 offset:16384
    ds_read_b128 v[196:199], v5 offset:17408
    ds_read_b128 v[200:203], v5 offset:18432
    ds_read_b128 v[204:207], v5 offset:19456
    ds_read_b128 v[224:227], v5 offset:4096
    ds_read_b128 v[228:231], v5 offset:5120
    ds_read_b128 v[232:235], v5 offset:6144
    ds_read_b128 v[236:239], v5 offset:7168
    ds_read_b128 v[112:115], v5 offset:12288
    ds_read_b128 v[116:119], v5 offset:13312
    ds_read_b128 v[120:123], v5 offset:14336
    ds_read_b128 v[124:127], v5 offset:15360
    s_waitcnt lgkmcnt(4)
    v_pk_fma_f32 v[48:49], v[48:49], v[192:193], v[224:225]
    v_pk_fma_f32 v[50:51], v[50:51], v[194:195], v[226:227]
    v_pk_fma_f32 v[52:53], v[52:53], v[196:197], v[228:229]
    v_pk_fma_f32 v[54:55], v[54:55], v[198:199], v[230:231]
    v_pk_fma_f32 v[56:57], v[56:57], v[200:201], v[232:233]
    v_pk_fma_f32 v[58:59], v[58:59], v[202:203], v[234:235]
    v_pk_fma_f32 v[60:61], v[60:61], v[204:205], v[236:237]
    v_pk_fma_f32 v[62:63], v[62:63], v[206:207], v[238:239]
    s_waitcnt lgkmcnt(0)
    v_pk_fma_f32 v[160:161], v[112:113], v[48:49], v[160:161]
    v_pk_fma_f32 v[162:163], v[114:115], v[50:51], v[162:163]
    v_pk_fma_f32 v[164:165], v[116:117], v[52:53], v[164:165]
    v_pk_fma_f32 v[166:167], v[118:119], v[54:55], v[166:167]
    v_pk_fma_f32 v[168:169], v[120:121], v[56:57], v[168:169]
    v_pk_fma_f32 v[170:171], v[122:123], v[58:59], v[170:171]
    v_pk_fma_f32 v[172:173], v[124:125], v[60:61], v[172:173]
    v_pk_fma_f32 v[174:175], v[126:127], v[62:63], v[174:175]
    v_cvt_pk_bf16_f32 v80, v160, v161
    v_cvt_pk_bf16_f32 v81, v162, v163
    ds_write_b64 v8, v[80:81] offset:0
    v_cvt_pk_bf16_f32 v82, v164, v165
    v_cvt_pk_bf16_f32 v83, v166, v167
    ds_write_b64 v8, v[82:83] offset:512
    v_cvt_pk_bf16_f32 v84, v168, v169
    v_cvt_pk_bf16_f32 v85, v170, v171
    ds_write_b64 v8, v[84:85] offset:1024
    v_cvt_pk_bf16_f32 v86, v172, v173
    v_cvt_pk_bf16_f32 v87, v174, v175
    ds_write_b64 v8, v[86:87] offset:1536
    ds_read_b128 v[32:35], v10 offset:0
    ds_read_b128 v[36:39], v10 offset:1024
    ds_read_b128 v[208:211], v6 offset:19456
    ds_read_b128 v[212:215], v6 offset:18432
    ds_read_b128 v[216:219], v6 offset:17408
    ds_read_b128 v[220:223], v6 offset:16384
    ds_read_b128 v[240:243], v6 offset:7168
    ds_read_b128 v[244:247], v6 offset:6144
    ds_read_b128 v[248:251], v6 offset:5120
    ds_read_b128 v[252:255], v6 offset:4096
    ds_read_b128 v[128:131], v6 offset:15360
    ds_read_b128 v[132:135], v6 offset:14336
    ds_read_b128 v[136:139], v6 offset:13312
    ds_read_b128 v[140:143], v6 offset:12288
    s_waitcnt lgkmcnt(4)
    v_pk_fma_f32 v[64:65], v[64:65], v[208:209], v[240:241]
    v_pk_fma_f32 v[66:67], v[66:67], v[210:211], v[242:243]
    v_pk_fma_f32 v[68:69], v[68:69], v[212:213], v[244:245]
    v_pk_fma_f32 v[70:71], v[70:71], v[214:215], v[246:247]
    v_pk_fma_f32 v[72:73], v[72:73], v[216:217], v[248:249]
    v_pk_fma_f32 v[74:75], v[74:75], v[218:219], v[250:251]
    v_pk_fma_f32 v[76:77], v[76:77], v[220:221], v[252:253]
    v_pk_fma_f32 v[78:79], v[78:79], v[222:223], v[254:255]
    s_waitcnt lgkmcnt(0)
    v_pk_fma_f32 v[176:177], v[128:129], v[64:65], v[176:177]
    v_pk_fma_f32 v[178:179], v[130:131], v[66:67], v[178:179]
    v_pk_fma_f32 v[180:181], v[132:133], v[68:69], v[180:181]
    v_pk_fma_f32 v[182:183], v[134:135], v[70:71], v[182:183]
    v_pk_fma_f32 v[184:185], v[136:137], v[72:73], v[184:185]
    v_pk_fma_f32 v[186:187], v[138:139], v[74:75], v[186:187]
    v_pk_fma_f32 v[188:189], v[140:141], v[76:77], v[188:189]
    v_pk_fma_f32 v[190:191], v[142:143], v[78:79], v[190:191]
    v_cvt_pk_bf16_f32 v80, v176, v177
    v_cvt_pk_bf16_f32 v81, v178, v179
    ds_write_b64 v9, v[80:81] offset:1536
    v_cvt_pk_bf16_f32 v82, v180, v181
    v_cvt_pk_bf16_f32 v83, v182, v183
    ds_write_b64 v9, v[82:83] offset:1024
    v_cvt_pk_bf16_f32 v84, v184, v185
    v_cvt_pk_bf16_f32 v85, v186, v187
    ds_write_b64 v9, v[84:85] offset:512
    v_cvt_pk_bf16_f32 v86, v188, v189
    v_cvt_pk_bf16_f32 v87, v190, v191
    ds_write_b64 v9, v[86:87] offset:0
    ds_read_b128 v[40:43], v10 offset:2048
    ds_read_b128 v[44:47], v10 offset:3072
    v_mov_b32 v21, 103016
    s_cmp_lg_u32 s16, 0
    s_cbranch_scc1 f_nrs
    s_sleep 8
    s_mov_b32 s83, 0
f_kq:
    buffer_load_dwordx4 v[96:99], v3, s[12:15], s81 offen offset:0 sc1
    buffer_load_dwordx4 v[100:103], v3, s[12:15], s81 offen offset:1024 sc1
    s_waitcnt vmcnt(0)
    v_xor_b32 v2, s32, v98
    v_bitop3_b32 v2, v2, v102, s32 bitop3:0xf6
    v_cmp_ne_u32 vcc, 0, v2
    s_cbranch_vccz f_kqx
    s_sleep 4
    s_add_u32 s83, s83, 1
    s_cmp_lt_u32 s83, 0x40000
    s_cbranch_scc1 f_kq
f_kqx:
    v_max_u32 v24, v96, v100
    v_min_u32 v25, v96, v100
    v_max3_u32 v25, v25, v97, v101
    v_mov_b32 v26, v24
    s_nop 1
    v_max_u32_dpp v26, v26, v26 row_ror:8 row_mask:0xf bank_mask:0xf
    s_nop 1
    v_max_u32_dpp v26, v26, v26 row_ror:4 row_mask:0xf bank_mask:0xf
    s_nop 1
    v_max_u32_dpp v26, v26, v26 row_ror:2 row_mask:0xf bank_mask:0xf
    s_nop 1
    v_max_u32_dpp v26, v26, v26 row_ror:1 row_mask:0xf bank_mask:0xf
    s_nop 1
    v_max_u32_dpp v26, v26, v26 row_bcast:15 row_mask:0xa bank_mask:0xf
    s_nop 1
    v_max_u32_dpp v26, v26, v26 row_bcast:31 row_mask:0xc bank_mask:0xf
    s_nop 0
    v_readlane_b32 s40, v26, 63
    s_nop 1
    v_cmp_eq_u32 vcc, s40, v24
    s_nop 1
    v_cndmask_b32 v26, v24, v25, vcc
    s_nop 1
    v_max_u32_dpp v26, v26, v26 row_ror:8 row_mask:0xf bank_mask:0xf
    s_nop 1
    v_max_u32_dpp v26, v26, v26 row_ror:4 row_mask:0xf bank_mask:0xf
    s_nop 1
    v_max_u32_dpp v26, v26, v26 row_ror:2 row_mask:0xf bank_mask:0xf
    s_nop 1
    v_max_u32_dpp v26, v26, v26 row_ror:1 row_mask:0xf bank_mask:0xf
    s_nop 1
    v_max_u32_dpp v26, v26, v26 row_bcast:15 row_mask:0xa bank_mask:0xf
    s_nop 1
    v_max_u32_dpp v26, v26, v26 row_bcast:31 row_mask:0xc bank_mask:0xf
    s_nop 0
    v_readlane_b32 s41, v26, 63
    s_and_b32 s40, s40, 0xff
    s_and_b32 s41, s41, 0xff
    v_mov_b32 v28, s40
    v_mov_b32 v29, s41
    ds_write_b64 v21, v[28:29]
f_nrs:
    s_waitcnt lgkmcnt(0)
    s_barrier
    ds_read_b64 v[28:29], v21
    s_waitcnt lgkmcnt(0)
    v_readfirstlane_b32 s40, v28
    v_readfirstlane_b32 s41, v29
    s_cmp_eq_u32 s62, s40
    s_cbranch_scc1 f_e0
    s_cmp_eq_u32 s62, s41
    s_cbranch_scc1 f_e0
    s_waitcnt vmcnt(1)
    buffer_store_dwordx4 v[32:35], v3, s[24:27], s18 offen offset:0 sc1
    s_waitcnt vmcnt(1)
    buffer_store_dwordx4 v[36:39], v3, s[24:27], s18 offen offset:1024 sc1
f_e0:
    s_cmp_eq_u32 s63, s40
    s_cbranch_scc1 f_e1
    s_cmp_eq_u32 s63, s41
    s_cbranch_scc1 f_e1
    s_waitcnt vmcnt(1)
    buffer_store_dwordx4 v[40:43], v3, s[24:27], s19 offen offset:0 sc1
    s_waitcnt vmcnt(1)
    buffer_store_dwordx4 v[44:47], v3, s[24:27], s19 offen offset:1024 sc1
f_e1:
    s_endpgm
f_t3l:
    ds_read_b128 v[112:115], v248 offset:0
    ds_read_b128 v[116:119], v248 offset:1024
    ds_read_b128 v[120:123], v248 offset:2048
    ds_read_b128 v[124:127], v248 offset:3072
    ds_read_b128 v[128:131], v248 offset:4096
    ds_read_b128 v[132:135], v248 offset:5120
    ds_read_b128 v[136:139], v248 offset:6144
    ds_read_b128 v[140:143], v248 offset:7168
    ds_read_b32 v245, v244
    s_branch f_t3d
f_c1bad:
    s_add_u32 s83, s83, 1
    s_cmp_ge_u32 s83, 0x40000
    s_cbranch_scc1 f_c1ok
    s_bitcmp1_b32 s47, 0
    s_cbranch_scc0 f_c1b2
    s_sleep 3
f_c1b2:
    s_cmp_lg_u32 s34, 0
    s_cbranch_scc1 f_ci1
    s_add_u32 s68, s82, 32768
    buffer_load_dwordx4 v[120:123], v250, s[12:15], s68 offen offset:0 sc1
    buffer_load_dwordx4 v[124:127], v250, s[12:15], s68 offen offset:1024 sc1
f_ci1:
    buffer_load_dwordx4 v[112:115], v250, s[12:15], s82 offen offset:0 sc1
    buffer_load_dwordx4 v[116:119], v250, s[12:15], s82 offen offset:1024 sc1
    s_bitcmp1_b32 s47, 0
    s_cbranch_scc0 f_s1
    s_waitcnt vmcnt(0)
    s_branch f_c1
f_z1bad:
    s_add_u32 s83, s83, 1
    s_cmp_ge_u32 s83, 0x40000
    s_cbranch_scc1 f_z1ok
    s_sleep 4
    buffer_load_dwordx4 v[32:35], v249, s[12:15], s72 offen offset:0 sc1
    buffer_load_dwordx4 v[36:39], v249, s[12:15], s72 offen offset:1024 sc1
    buffer_load_dwordx4 v[40:43], v249, s[12:15], s72 offen offset:2048 sc1
    buffer_load_dwordx4 v[44:47], v249, s[12:15], s72 offen offset:3072 sc1
    s_waitcnt vmcnt(0)
    s_branch f_z1
f_ppbad:
    s_add_u32 s83, s83, 1
    s_cmp_ge_u32 s83, 0x40000
    s_cbranch_scc1 f_ppok
    s_sleep 3
    buffer_load_dwordx4 v[20:23], v15, s[12:15], s52 offen sc1
    s_waitcnt vmcnt(0)
    s_branch f_pp
f_pbbad:
    s_add_u32 s83, s83, 1
    s_cmp_ge_u32 s83, 0x40000
    s_cbranch_scc1 f_pbok
    s_sleep 3
    buffer_load_dwordx4 v[96:99], v15, s[12:15], s41 offen sc1
    buffer_load_dwordx4 v[100:103], v15, s[12:15], s40 offen sc1
    s_waitcnt vmcnt(0)
    s_branch f_pb
f_slowst:
    buffer_store_dwordx4 v[32:35], v14, s[12:15], s74 offen offset:0 sc1
    buffer_store_dwordx4 v[36:39], v14, s[12:15], s74 offen offset:2048 sc1
    buffer_store_dwordx4 v[40:43], v14, s[12:15], s75 offen offset:0 sc1
    buffer_store_dwordx4 v[44:47], v14, s[12:15], s75 offen offset:2048 sc1
    s_branch f_std
f_rare:
    v_or_b32 v35, v21, v35
    v_or_b32 v39, v21, v39
    v_or_b32 v43, v21, v43
    v_or_b32 v47, v21, v47
    v_bfe_u32 v144, v0, 4, 2
    v_lshlrev_b32 v144, 3, v144
    ds_read_b128 v[120:123], v5 offset:10240
    ds_read_b128 v[136:139], v6 offset:9216
    ds_read_b128 v[56:59], v5 offset:2048
    ds_read_b128 v[72:75], v6 offset:1024
    ds_read_b128 v[124:127], v5 offset:11264
    ds_read_b128 v[140:143], v6 offset:8192
    ds_read_b128 v[60:63], v5 offset:3072
    ds_read_b128 v[76:79], v6 offset:0
    ds_read2_b32 v[28:29], v20 offset0:1 offset1:3
    ds_read2_b32 v[30:31], v20 offset0:5 offset1:7
    s_mov_b32 s83, 0
    s_waitcnt lgkmcnt(0)
f_rz:
    buffer_load_dwordx2 v[152:153], v144, s[12:15], s77 offen offset:0 sc1
    buffer_load_dwordx2 v[154:155], v144, s[12:15], s77 offen offset:32 sc1
    buffer_load_dwordx2 v[156:157], v144, s[12:15], s77 offen offset:64 sc1
    buffer_load_dwordx2 v[158:159], v144, s[12:15], s77 offen offset:96 sc1
    s_waitcnt vmcnt(0)
    v_xor_b32 v2, s32, v152
    v_bitop3_b32 v2, v2, v154, s32 bitop3:0xf6
    v_bitop3_b32 v2, v2, v156, s32 bitop3:0xf6
    v_bitop3_b32 v2, v2, v158, s32 bitop3:0xf6
    v_cmp_ne_u32 vcc, 0, v2
    s_cbranch_vccz f_rzx
    s_sleep 2
    s_add_u32 s83, s83, 1
    s_cmp_lt_u32 s83, 0x40000
    s_cbranch_scc1 f_rz
f_rzx:
    v_mov_b32 v148, v153
    v_mov_b32 v149, v155
    v_mov_b32 v150, v157
    v_mov_b32 v151, v159
    v_max_i32 v145, v148, v149
    v_max3_i32 v145, v145, v150, v151
    s_nop 0
    v_readlane_b32 s64, v145, 0
    v_readlane_b32 s65, v145, 16
    v_readlane_b32 s66, v145, 32
    v_readlane_b32 s67, v145, 48
    s_max_i32 s64, s64, s65
    s_max_i32 s66, s66, s67
    s_max_i32 s64, s64, s66
    s_add_i32 s66, s64, 125
    s_lshl_b32 s66, s66, 23
    s_nop 0
    v_subrev_u32 v148, s64, v148
    v_ldexp_f32 v148, 1.0, v148
    v_cvt_pk_f16_f32 v148, v148, v148
    v_subrev_u32 v149, s64, v149
    v_ldexp_f32 v149, 1.0, v149
    v_cvt_pk_f16_f32 v149, v149, v149
    v_subrev_u32 v150, s64, v150
    v_ldexp_f32 v150, 1.0, v150
    v_cvt_pk_f16_f32 v150, v150, v150
    v_subrev_u32 v151, s64, v151
    v_ldexp_f32 v151, 1.0, v151
    v_cvt_pk_f16_f32 v151, v151, v151
    v_pk_mul_f16 v32, v32, v148
    v_pk_mul_f16 v33, v33, v148
    v_pk_mul_f16 v34, v34, v148
    v_pk_mul_f16 v35, v35, v148
    v_pk_mul_f16 v36, v36, v149
    v_pk_mul_f16 v37, v37, v149
    v_pk_mul_f16 v38, v38, v149
    v_pk_mul_f16 v39, v39, v149
    v_pk_mul_f16 v40, v40, v150
    v_pk_mul_f16 v41, v41, v150
    v_pk_mul_f16 v42, v42, v150
    v_pk_mul_f16 v43, v43, v150
    v_pk_mul_f16 v44, v44, v151
    v_pk_mul_f16 v45, v45, v151
    v_pk_mul_f16 v46, v46, v151
    v_pk_mul_f16 v47, v47, v151
    v_pk_mul_f32 v[112:113], v[112:113], s[66:67] op_sel:[0,0] op_sel_hi:[1,0]
    v_pk_mul_f32 v[114:115], v[114:115], s[66:67] op_sel:[0,0] op_sel_hi:[1,0]
    v_pk_mul_f32 v[116:117], v[116:117], s[66:67] op_sel:[0,0] op_sel_hi:[1,0]
    v_pk_mul_f32 v[118:119], v[118:119], s[66:67] op_sel:[0,0] op_sel_hi:[1,0]
    v_pk_mul_f32 v[120:121], v[120:121], s[66:67] op_sel:[0,0] op_sel_hi:[1,0]
    v_pk_mul_f32 v[122:123], v[122:123], s[66:67] op_sel:[0,0] op_sel_hi:[1,0]
    v_pk_mul_f32 v[124:125], v[124:125], s[66:67] op_sel:[0,0] op_sel_hi:[1,0]
    v_pk_mul_f32 v[126:127], v[126:127], s[66:67] op_sel:[0,0] op_sel_hi:[1,0]
    v_pk_mul_f32 v[128:129], v[128:129], s[66:67] op_sel:[0,0] op_sel_hi:[1,0]
    v_pk_mul_f32 v[130:131], v[130:131], s[66:67] op_sel:[0,0] op_sel_hi:[1,0]
    v_pk_mul_f32 v[132:133], v[132:133], s[66:67] op_sel:[0,0] op_sel_hi:[1,0]
    v_pk_mul_f32 v[134:135], v[134:135], s[66:67] op_sel:[0,0] op_sel_hi:[1,0]
    v_pk_mul_f32 v[136:137], v[136:137], s[66:67] op_sel:[0,0] op_sel_hi:[1,0]
    v_pk_mul_f32 v[138:139], v[138:139], s[66:67] op_sel:[0,0] op_sel_hi:[1,0]
    v_pk_mul_f32 v[140:141], v[140:141], s[66:67] op_sel:[0,0] op_sel_hi:[1,0]
    v_pk_mul_f32 v[142:143], v[142:143], s[66:67] op_sel:[0,0] op_sel_hi:[1,0]
    v_mfma_f32_16x16x32_f16 v[80:83], v[32:35], v[192:195], 0
    v_mfma_f32_16x16x32_f16 v[80:83], v[36:39], v[196:199], v[80:83]
    v_mfma_f32_16x16x32_f16 v[80:83], v[40:43], v[200:203], v[80:83]
    v_mfma_f32_16x16x32_f16 v[80:83], v[44:47], v[204:207], v[80:83]
    v_mfma_f32_16x16x32_f16 v[84:87], v[32:35], v[208:211], 0
    v_mfma_f32_16x16x32_f16 v[84:87], v[36:39], v[212:215], v[84:87]
    v_mfma_f32_16x16x32_f16 v[84:87], v[40:43], v[216:219], v[84:87]
    v_mfma_f32_16x16x32_f16 v[84:87], v[44:47], v[220:223], v[84:87]
    s_nop 7
    s_branch f_zfok
f_slow2:
    v_cvt_pk_bf16_f32 v144, v160, v161
    v_lshlrev_b32 v160, 16, v144
    v_and_b32 v161, 0xffff0000, v144
    v_cvt_pk_bf16_f32 v144, v162, v163
    v_lshlrev_b32 v162, 16, v144
    v_and_b32 v163, 0xffff0000, v144
    v_cvt_pk_bf16_f32 v144, v164, v165
    v_lshlrev_b32 v164, 16, v144
    v_and_b32 v165, 0xffff0000, v144
    v_cvt_pk_bf16_f32 v144, v166, v167
    v_lshlrev_b32 v166, 16, v144
    v_and_b32 v167, 0xffff0000, v144
    v_cvt_pk_bf16_f32 v144, v168, v169
    v_lshlrev_b32 v168, 16, v144
    v_and_b32 v169, 0xffff0000, v144
    v_cvt_pk_bf16_f32 v144, v170, v171
    v_lshlrev_b32 v170, 16, v144
    v_and_b32 v171, 0xffff0000, v144
    v_cvt_pk_bf16_f32 v144, v172, v173
    v_lshlrev_b32 v172, 16, v144
    v_and_b32 v173, 0xffff0000, v144
    v_cvt_pk_bf16_f32 v144, v174, v175
    v_lshlrev_b32 v174, 16, v144
    v_and_b32 v175, 0xffff0000, v144
    v_pk_add_f32 v[144:145], v[160:161], v[162:163]
    v_pk_add_f32 v[144:145], v[144:145], v[164:165]
    v_pk_add_f32 v[144:145], v[144:145], v[166:167]
    v_pk_add_f32 v[144:145], v[144:145], v[168:169]
    v_pk_add_f32 v[144:145], v[144:145], v[170:171]
    v_pk_add_f32 v[144:145], v[144:145], v[172:173]
    v_pk_add_f32 v[144:145], v[144:145], v[174:175]
    v_cvt_pk_bf16_f32 v152, v176, v177
    v_lshlrev_b32 v176, 16, v152
    v_and_b32 v177, 0xffff0000, v152
    v_cvt_pk_bf16_f32 v152, v178, v179
    v_lshlrev_b32 v178, 16, v152
    v_and_b32 v179, 0xffff0000, v152
    v_cvt_pk_bf16_f32 v152, v180, v181
    v_lshlrev_b32 v180, 16, v152
    v_and_b32 v181, 0xffff0000, v152
    v_cvt_pk_bf16_f32 v152, v182, v183
    v_lshlrev_b32 v182, 16, v152
    v_and_b32 v183, 0xffff0000, v152
    v_cvt_pk_bf16_f32 v152, v184, v185
    v_lshlrev_b32 v184, 16, v152
    v_and_b32 v185, 0xffff0000, v152
    v_cvt_pk_bf16_f32 v152, v186, v187
    v_lshlrev_b32 v186, 16, v152
    v_and_b32 v187, 0xffff0000, v152
    v_cvt_pk_bf16_f32 v152, v188, v189
    v_lshlrev_b32 v188, 16, v152
    v_and_b32 v189, 0xffff0000, v152
    v_cvt_pk_bf16_f32 v152, v190, v191
    v_lshlrev_b32 v190, 16, v152
    v_and_b32 v191, 0xffff0000, v152
    v_pk_add_f32 v[152:153], v[176:177], v[178:179]
    v_pk_add_f32 v[152:153], v[152:153], v[180:181]
    v_pk_add_f32 v[152:153], v[152:153], v[182:183]
    v_pk_add_f32 v[152:153], v[152:153], v[184:185]
    v_pk_add_f32 v[152:153], v[152:153], v[186:187]
    v_pk_add_f32 v[152:153], v[152:153], v[188:189]
    v_pk_add_f32 v[152:153], v[152:153], v[190:191]
    v_add_f32 v104, v144, v145
    v_add_f32 v108, v152, v153
    s_nop 1
    v_permlane32_swap_b32 v104, v108
    v_add_f32 v104, v104, v108
    s_nop 1
    v_add_f32_dpp v104, v104, v104 row_ror:8 row_mask:0xf bank_mask:0xf
    s_nop 1
    v_add_f32_dpp v104, v104, v104 row_ror:4 row_mask:0xf bank_mask:0xf
    s_nop 1
    v_add_f32_dpp v104, v104, v104 row_ror:2 row_mask:0xf bank_mask:0xf
    s_nop 1
    v_add_f32_dpp v104, v104, v104 row_ror:1 row_mask:0xf bank_mask:0xf
    s_nop 1
    v_add_f32_dpp v104, v104, v104 row_bcast:15 row_mask:0xa bank_mask:0xf
    v_mul_f32 v107, s46, v104
    v_cvt_pk_bf16_f32 v104, v107, v107
    v_lshlrev_b32 v104, 16, v104
    v_sub_f32 v107, v107, v104
    v_readlane_b32 s64, v104, 31
    v_readlane_b32 s66, v104, 63
    s_nop 0
    v_pk_add_f32 v[80:81], v[160:161], s[64:65] op_sel:[0,0] op_sel_hi:[1,0] neg_lo:[0,1] neg_hi:[0,1]
    v_pk_add_f32 v[82:83], v[162:163], s[64:65] op_sel:[0,0] op_sel_hi:[1,0] neg_lo:[0,1] neg_hi:[0,1]
    v_pk_add_f32 v[84:85], v[164:165], s[64:65] op_sel:[0,0] op_sel_hi:[1,0] neg_lo:[0,1] neg_hi:[0,1]
    v_pk_add_f32 v[86:87], v[166:167], s[64:65] op_sel:[0,0] op_sel_hi:[1,0] neg_lo:[0,1] neg_hi:[0,1]
    v_pk_add_f32 v[88:89], v[168:169], s[64:65] op_sel:[0,0] op_sel_hi:[1,0] neg_lo:[0,1] neg_hi:[0,1]
    v_pk_add_f32 v[90:91], v[170:171], s[64:65] op_sel:[0,0] op_sel_hi:[1,0] neg_lo:[0,1] neg_hi:[0,1]
    v_pk_add_f32 v[92:93], v[172:173], s[64:65] op_sel:[0,0] op_sel_hi:[1,0] neg_lo:[0,1] neg_hi:[0,1]
    v_pk_add_f32 v[94:95], v[174:175], s[64:65] op_sel:[0,0] op_sel_hi:[1,0] neg_lo:[0,1] neg_hi:[0,1]
    v_pk_mul_f32 v[146:147], v[80:81], v[80:81]
    v_pk_mul_f32 v[148:149], v[80:81], v[48:49]
    v_pk_fma_f32 v[146:147], v[82:83], v[82:83], v[146:147]
    v_pk_fma_f32 v[148:149], v[82:83], v[50:51], v[148:149]
    v_pk_fma_f32 v[146:147], v[84:85], v[84:85], v[146:147]
    v_pk_fma_f32 v[148:149], v[84:85], v[52:53], v[148:149]
    v_pk_fma_f32 v[146:147], v[86:87], v[86:87], v[146:147]
    v_pk_fma_f32 v[148:149], v[86:87], v[54:55], v[148:149]
    v_pk_fma_f32 v[146:147], v[88:89], v[88:89], v[146:147]
    v_pk_fma_f32 v[148:149], v[88:89], v[56:57], v[148:149]
    v_pk_fma_f32 v[146:147], v[90:91], v[90:91], v[146:147]
    v_pk_fma_f32 v[148:149], v[90:91], v[58:59], v[148:149]
    v_pk_fma_f32 v[146:147], v[92:93], v[92:93], v[146:147]
    v_pk_fma_f32 v[148:149], v[92:93], v[60:61], v[148:149]
    v_pk_fma_f32 v[146:147], v[94:95], v[94:95], v[146:147]
    v_pk_fma_f32 v[148:149], v[94:95], v[62:63], v[148:149]
    v_pk_add_f32 v[32:33], v[176:177], s[66:67] op_sel:[0,0] op_sel_hi:[1,0] neg_lo:[0,1] neg_hi:[0,1]
    v_pk_add_f32 v[34:35], v[178:179], s[66:67] op_sel:[0,0] op_sel_hi:[1,0] neg_lo:[0,1] neg_hi:[0,1]
    v_pk_add_f32 v[36:37], v[180:181], s[66:67] op_sel:[0,0] op_sel_hi:[1,0] neg_lo:[0,1] neg_hi:[0,1]
    v_pk_add_f32 v[38:39], v[182:183], s[66:67] op_sel:[0,0] op_sel_hi:[1,0] neg_lo:[0,1] neg_hi:[0,1]
    v_pk_add_f32 v[40:41], v[184:185], s[66:67] op_sel:[0,0] op_sel_hi:[1,0] neg_lo:[0,1] neg_hi:[0,1]
    v_pk_add_f32 v[42:43], v[186:187], s[66:67] op_sel:[0,0] op_sel_hi:[1,0] neg_lo:[0,1] neg_hi:[0,1]
    v_pk_add_f32 v[44:45], v[188:189], s[66:67] op_sel:[0,0] op_sel_hi:[1,0] neg_lo:[0,1] neg_hi:[0,1]
    v_pk_add_f32 v[46:47], v[190:191], s[66:67] op_sel:[0,0] op_sel_hi:[1,0] neg_lo:[0,1] neg_hi:[0,1]
    v_pk_mul_f32 v[154:155], v[32:33], v[32:33]
    v_pk_mul_f32 v[156:157], v[32:33], v[64:65]
    v_pk_fma_f32 v[154:155], v[34:35], v[34:35], v[154:155]
    v_pk_fma_f32 v[156:157], v[34:35], v[66:67], v[156:157]
    v_pk_fma_f32 v[154:155], v[36:37], v[36:37], v[154:155]
    v_pk_fma_f32 v[156:157], v[36:37], v[68:69], v[156:157]
    v_pk_fma_f32 v[154:155], v[38:39], v[38:39], v[154:155]
    v_pk_fma_f32 v[156:157], v[38:39], v[70:71], v[156:157]
    v_pk_fma_f32 v[154:155], v[40:41], v[40:41], v[154:155]
    v_pk_fma_f32 v[156:157], v[40:41], v[72:73], v[156:157]
    v_pk_fma_f32 v[154:155], v[42:43], v[42:43], v[154:155]
    v_pk_fma_f32 v[156:157], v[42:43], v[74:75], v[156:157]
    v_pk_fma_f32 v[154:155], v[44:45], v[44:45], v[154:155]
    v_pk_fma_f32 v[156:157], v[44:45], v[76:77], v[156:157]
    v_pk_fma_f32 v[154:155], v[46:47], v[46:47], v[154:155]
    v_pk_fma_f32 v[156:157], v[46:47], v[78:79], v[156:157]
    v_add_f32 v105, v146, v147
    v_add_f32 v106, v148, v149
    v_add_f32 v109, v154, v155
    v_add_f32 v110, v156, v157
    s_nop 0
    v_permlane32_swap_b32 v105, v109
    v_permlane32_swap_b32 v106, v110
    v_add_f32 v105, v105, v109
    v_add_f32 v106, v106, v110
    s_nop 0
    v_add_f32_dpp v105, v105, v105 row_ror:8 row_mask:0xf bank_mask:0xf
    v_add_f32_dpp v106, v106, v106 row_ror:8 row_mask:0xf bank_mask:0xf
    s_nop 0
    v_add_f32_dpp v105, v105, v105 row_ror:4 row_mask:0xf bank_mask:0xf
    v_add_f32_dpp v106, v106, v106 row_ror:4 row_mask:0xf bank_mask:0xf
    s_nop 0
    v_add_f32_dpp v105, v105, v105 row_ror:2 row_mask:0xf bank_mask:0xf
    v_add_f32_dpp v106, v106, v106 row_ror:2 row_mask:0xf bank_mask:0xf
    s_nop 0
    v_add_f32_dpp v105, v105, v105 row_ror:1 row_mask:0xf bank_mask:0xf
    v_add_f32_dpp v106, v106, v106 row_ror:1 row_mask:0xf bank_mask:0xf
    s_nop 0
    v_add_f32_dpp v105, v105, v105 row_bcast:15 row_mask:0xa bank_mask:0xf
    v_add_f32_dpp v106, v106, v106 row_bcast:15 row_mask:0xa bank_mask:0xf
    v_mul_f32 v105, s46, v105
    v_fma_f32 v105, -v107, v107, v105
    v_max_f32 v105, 0, v105
    s_branch f_var2
f_slowvar:
    v_lshlrev_b32 v66, 16, v56
    s_nop 0
    v_readlane_b32 s68, v66, 31
    v_readlane_b32 s70, v66, 63
    v_lshlrev_b32 v100, 16, v32
    v_and_b32 v101, 0xffff0000, v32
    v_pk_add_f32 v[100:101], v[100:101], s[68:69] op_sel_hi:[1,0]
    v_pk_mul_f32 v[102:103], v[100:101], v[100:101]
    v_lshlrev_b32 v100, 16, v33
    v_and_b32 v101, 0xffff0000, v33
    v_pk_add_f32 v[100:101], v[100:101], s[68:69] op_sel_hi:[1,0]
    v_pk_fma_f32 v[102:103], v[100:101], v[100:101], v[102:103]
    v_lshlrev_b32 v100, 16, v34
    v_and_b32 v101, 0xffff0000, v34
    v_pk_add_f32 v[100:101], v[100:101], s[68:69] op_sel_hi:[1,0]
    v_pk_fma_f32 v[102:103], v[100:101], v[100:101], v[102:103]
    v_lshlrev_b32 v100, 16, v35
    v_and_b32 v101, 0xffff0000, v35
    v_pk_add_f32 v[100:101], v[100:101], s[68:69] op_sel_hi:[1,0]
    v_pk_fma_f32 v[102:103], v[100:101], v[100:101], v[102:103]
    v_lshlrev_b32 v100, 16, v36
    v_and_b32 v101, 0xffff0000, v36
    v_pk_add_f32 v[100:101], v[100:101], s[68:69] op_sel_hi:[1,0]
    v_pk_fma_f32 v[102:103], v[100:101], v[100:101], v[102:103]
    v_lshlrev_b32 v100, 16, v37
    v_and_b32 v101, 0xffff0000, v37
    v_pk_add_f32 v[100:101], v[100:101], s[68:69] op_sel_hi:[1,0]
    v_pk_fma_f32 v[102:103], v[100:101], v[100:101], v[102:103]
    v_lshlrev_b32 v100, 16, v38
    v_and_b32 v101, 0xffff0000, v38
    v_pk_add_f32 v[100:101], v[100:101], s[68:69] op_sel_hi:[1,0]
    v_pk_fma_f32 v[102:103], v[100:101], v[100:101], v[102:103]
    v_lshlrev_b32 v100, 16, v39
    v_and_b32 v101, 0xffff0000, v39
    v_pk_add_f32 v[100:101], v[100:101], s[68:69] op_sel_hi:[1,0]
    v_pk_fma_f32 v[102:103], v[100:101], v[100:101], v[102:103]
    v_add_f32 v54, v102, v103
    v_lshlrev_b32 v100, 16, v40
    v_and_b32 v101, 0xffff0000, v40
    v_pk_add_f32 v[100:101], v[100:101], s[70:71] op_sel_hi:[1,0]
    v_pk_mul_f32 v[102:103], v[100:101], v[100:101]
    v_lshlrev_b32 v100, 16, v41
    v_and_b32 v101, 0xffff0000, v41
    v_pk_add_f32 v[100:101], v[100:101], s[70:71] op_sel_hi:[1,0]
    v_pk_fma_f32 v[102:103], v[100:101], v[100:101], v[102:103]
    v_lshlrev_b32 v100, 16, v42
    v_and_b32 v101, 0xffff0000, v42
    v_pk_add_f32 v[100:101], v[100:101], s[70:71] op_sel_hi:[1,0]
    v_pk_fma_f32 v[102:103], v[100:101], v[100:101], v[102:103]
    v_lshlrev_b32 v100, 16, v43
    v_and_b32 v101, 0xffff0000, v43
    v_pk_add_f32 v[100:101], v[100:101], s[70:71] op_sel_hi:[1,0]
    v_pk_fma_f32 v[102:103], v[100:101], v[100:101], v[102:103]
    v_lshlrev_b32 v100, 16, v44
    v_and_b32 v101, 0xffff0000, v44
    v_pk_add_f32 v[100:101], v[100:101], s[70:71] op_sel_hi:[1,0]
    v_pk_fma_f32 v[102:103], v[100:101], v[100:101], v[102:103]
    v_lshlrev_b32 v100, 16, v45
    v_and_b32 v101, 0xffff0000, v45
    v_pk_add_f32 v[100:101], v[100:101], s[70:71] op_sel_hi:[1,0]
    v_pk_fma_f32 v[102:103], v[100:101], v[100:101], v[102:103]
    v_lshlrev_b32 v100, 16, v46
    v_and_b32 v101, 0xffff0000, v46
    v_pk_add_f32 v[100:101], v[100:101], s[70:71] op_sel_hi:[1,0]
    v_pk_fma_f32 v[102:103], v[100:101], v[100:101], v[102:103]
    v_lshlrev_b32 v100, 16, v47
    v_and_b32 v101, 0xffff0000, v47
    v_pk_add_f32 v[100:101], v[100:101], s[70:71] op_sel_hi:[1,0]
    v_pk_fma_f32 v[102:103], v[100:101], v[100:101], v[102:103]
    v_add_f32 v55, v102, v103
    v_add_f32 v66, v66, v52
    s_nop 0
    v_permlane32_swap_b32 v54, v55
    v_add_f32 v54, v54, v55
    s_nop 1
    v_add_f32_dpp v54, v54, v54 row_ror:8 row_mask:0xf bank_mask:0xf
    s_nop 1
    v_add_f32_dpp v54, v54, v54 row_ror:4 row_mask:0xf bank_mask:0xf
    s_nop 1
    v_add_f32_dpp v54, v54, v54 row_ror:2 row_mask:0xf bank_mask:0xf
    s_nop 1
    v_add_f32_dpp v54, v54, v54 row_ror:1 row_mask:0xf bank_mask:0xf
    s_nop 1
    v_add_f32_dpp v54, v54, v54 row_bcast:15 row_mask:0xa bank_mask:0xf
    v_mul_f32 v54, s46, v54
    v_fma_f32 v54, -v66, v66, v54
    v_max_f32 v54, 0, v54
    s_branch f_var
f_sa:
    s_add_u32 s69, s69, 50331648
    v_cndmask_b32 v120, v120, v121, s[64:65]
    v_cndmask_b32 v122, v122, v123, s[64:65]
    v_cndmask_b32 v120, v120, v122, s[66:67]
    v_mul_f32 v120, s69, v120
    v_and_b32 v52, 15, v0
    v_cvt_pk_f16_f32 v48, v120, v120
    v_cmp_eq_u32 vcc, 0, v52
    v_mov_b32 v54, 0x3c00
    v_mov_b32 v55, 0xbc000000
    v_cndmask_b32 v54, 0, v54, vcc
    v_cndmask_b32 v55, 0, v55, vcc
    v_mov_b32_dpp v56, v48 quad_perm:[0,0,0,0] row_mask:0xf bank_mask:0xf
    v_mov_b32_dpp v57, v48 quad_perm:[1,1,1,1] row_mask:0xf bank_mask:0xf
    v_mov_b32_dpp v58, v48 quad_perm:[2,2,2,2] row_mask:0xf bank_mask:0xf
    v_mov_b32_dpp v59, v48 quad_perm:[3,3,3,3] row_mask:0xf bank_mask:0xf
    v_pk_mul_f16 v72, v54, v56
    v_pk_mul_f16 v73, v54, v57
    v_pk_mul_f16 v74, v54, v58
    v_pk_mul_f16 v75, v54, v59
    v_pk_mul_f16 v76, v55, v56
    v_pk_mul_f16 v77, v55, v57
    v_pk_mul_f16 v78, v55, v58
    v_pk_mul_f16 v79, v55, v59
    v_mfma_f32_16x16x32_f16 v[112:115], v[72:75], v[144:147], 0
    s_nop 0
    v_mfma_f32_16x16x32_f16 v[116:119], v[76:79], v[144:147], 0
    s_lshl_b32 s70, s16, 7
    v_mov_b32 v53, 8592
    v_add3_u32 v52, s70, v12, v53
    s_mov_b64 exec, 0xffff
    s_nop 3
    ds_write2_b32 v52, v112, v116 offset0:0 offset1:16
    s_mov_b64 exec, -1
    s_branch f_nsa
f_sb:
    v_mov_b32 v48, s32
    v_mov_b32 v49, s61
    v_mov_b32 v50, 0
    s_mov_b64 exec, 1
    buffer_store_dwordx2 v[48:49], v50, s[12:15], s79 offen sc1
    s_mov_b64 exec, -1
    s_cmp_lg_u32 s34, 0
    s_cbranch_scc1 f_sb2
    s_mov_b64 exec, 0xffff
    ds_read_b32 v56, v12 offset:8592
    ds_read_b32 v57, v12 offset:8656
    ds_read_b32 v58, v12 offset:8720
    ds_read_b32 v59, v12 offset:8784
    ds_read_b32 v60, v12 offset:8848
    ds_read_b32 v61, v12 offset:8912
    ds_read_b32 v62, v12 offset:8976
    ds_read_b32 v63, v12 offset:9040
    s_waitcnt lgkmcnt(0)
    v_add_f32 v80, v80, v56
    v_add_f32 v84, v84, v57
    v_add_f32 v88, v88, v58
    v_add_f32 v92, v92, v59
    v_add_f32 v96, v96, v60
    v_add_f32 v100, v100, v61
    v_add_f32 v104, v104, v62
    v_add_f32 v108, v108, v63
    s_mov_b64 exec, -1
f_sb2:
    s_branch f_nsb
f_sp:
    s_waitcnt lgkmcnt(0)
    v_mfma_f32_16x16x32_f16 v[88:91], v[32:35], v[224:227], 0
    v_mfma_f32_16x16x32_f16 v[88:91], v[36:39], v[228:231], v[88:91]
    v_mfma_f32_16x16x32_f16 v[88:91], v[40:43], v[232:235], v[88:91]
    v_mfma_f32_16x16x32_f16 v[88:91], v[44:47], v[236:239], v[88:91]
    v_mfma_f32_16x16x32_f16 v[92:95], v[32:35], v[240:243], 0
    v_mfma_f32_16x16x32_f16 v[92:95], v[36:39], v[244:247], v[92:95]
    v_mfma_f32_16x16x32_f16 v[92:95], v[40:43], v[248:251], v[92:95]
    v_mfma_f32_16x16x32_f16 v[92:95], v[44:47], v[252:255], v[92:95]
    v_pk_mul_f16 v32, v32, 1.0 op_sel:[1,0] op_sel_hi:[0,0] neg_hi:[1,0]
    v_pk_mul_f16 v33, v33, 1.0 op_sel:[1,0] op_sel_hi:[0,0] neg_hi:[1,0]
    v_pk_mul_f16 v34, v34, 1.0 op_sel:[1,0] op_sel_hi:[0,0] neg_hi:[1,0]
    v_pk_mul_f16 v35, v35, 1.0 op_sel:[1,0] op_sel_hi:[0,0] neg_hi:[1,0]
    v_pk_mul_f16 v36, v36, 1.0 op_sel:[1,0] op_sel_hi:[0,0] neg_hi:[1,0]
    v_pk_mul_f16 v37, v37, 1.0 op_sel:[1,0] op_sel_hi:[0,0] neg_hi:[1,0]
    v_pk_mul_f16 v38, v38, 1.0 op_sel:[1,0] op_sel_hi:[0,0] neg_hi:[1,0]
    v_pk_mul_f16 v39, v39, 1.0 op_sel:[1,0] op_sel_hi:[0,0] neg_hi:[1,0]
    v_pk_mul_f16 v40, v40, 1.0 op_sel:[1,0] op_sel_hi:[0,0] neg_hi:[1,0]
    v_pk_mul_f16 v41, v41, 1.0 op_sel:[1,0] op_sel_hi:[0,0] neg_hi:[1,0]
    v_pk_mul_f16 v42, v42, 1.0 op_sel:[1,0] op_sel_hi:[0,0] neg_hi:[1,0]
    v_pk_mul_f16 v43, v43, 1.0 op_sel:[1,0] op_sel_hi:[0,0] neg_hi:[1,0]
    v_pk_mul_f16 v44, v44, 1.0 op_sel:[1,0] op_sel_hi:[0,0] neg_hi:[1,0]
    v_pk_mul_f16 v45, v45, 1.0 op_sel:[1,0] op_sel_hi:[0,0] neg_hi:[1,0]
    v_pk_mul_f16 v46, v46, 1.0 op_sel:[1,0] op_sel_hi:[0,0] neg_hi:[1,0]
    v_pk_mul_f16 v47, v47, 1.0 op_sel:[1,0] op_sel_hi:[0,0] neg_hi:[1,0]
    v_mfma_f32_16x16x32_f16 v[96:99], v[32:35], v[192:195], 0
    v_mfma_f32_16x16x32_f16 v[96:99], v[36:39], v[196:199], v[96:99]
    v_mfma_f32_16x16x32_f16 v[96:99], v[40:43], v[200:203], v[96:99]
    v_mfma_f32_16x16x32_f16 v[96:99], v[44:47], v[204:207], v[96:99]
    v_mfma_f32_16x16x32_f16 v[100:103], v[32:35], v[208:211], 0
    v_mfma_f32_16x16x32_f16 v[100:103], v[36:39], v[212:215], v[100:103]
    v_mfma_f32_16x16x32_f16 v[100:103], v[40:43], v[216:219], v[100:103]
    v_mfma_f32_16x16x32_f16 v[100:103], v[44:47], v[220:223], v[100:103]
    v_mfma_f32_16x16x32_f16 v[104:107], v[32:35], v[224:227], 0
    v_mfma_f32_16x16x32_f16 v[104:107], v[36:39], v[228:231], v[104:107]
    v_mfma_f32_16x16x32_f16 v[104:107], v[40:43], v[232:235], v[104:107]
    v_mfma_f32_16x16x32_f16 v[104:107], v[44:47], v[236:239], v[104:107]
    v_mfma_f32_16x16x32_f16 v[108:111], v[32:35], v[240:243], 0
    v_mfma_f32_16x16x32_f16 v[108:111], v[36:39], v[244:247], v[108:111]
    v_mfma_f32_16x16x32_f16 v[108:111], v[40:43], v[248:251], v[108:111]
    v_mfma_f32_16x16x32_f16 v[108:111], v[44:47], v[252:255], v[108:111]
    v_subrev_u32 v2, s45, v8
    v_lshlrev_b32 v2, 1, v2
    v_add_u32 v20, s45, v2
    s_add_u32 s42, s45, 1008
    v_sub_u32 v21, s42, v2
    ds_write_b128 v20, v[80:83] offset:0
    ds_write_b128 v20, v[84:87] offset:1024
    ds_write_b128 v20, v[88:91] offset:2048
    ds_write_b128 v20, v[92:95] offset:3072
    v_sub_u32 v156, 4096, v2
    v_and_b32 v156, 4095, v156
    v_add_u32 v156, s45, v156
    v_sub_u32 v157, 3072, v2
    v_and_b32 v157, 4095, v157
    v_add_u32 v157, s45, v157
    v_sub_u32 v158, 2048, v2
    v_and_b32 v158, 4095, v158
    v_add_u32 v158, s45, v158
    v_sub_u32 v159, 1024, v2
    v_and_b32 v159, 4095, v159
    v_add_u32 v159, s45, v159
    ds_read_b128 v[32:35], v21 offset:3072
    ds_read_b128 v[36:39], v21 offset:2048
    ds_read_b128 v[40:43], v21 offset:1024
    ds_read_b128 v[44:47], v21 offset:0
    ds_read_b32 v152, v156
    ds_read_b32 v153, v157
    ds_read_b32 v154, v158
    ds_read_b32 v155, v159
    s_waitcnt lgkmcnt(0)
    v_add_f32 v80, v80, v152
    v_add_f32 v81, v81, v35
    v_add_f32 v82, v82, v34
    v_add_f32 v83, v83, v33
    v_add_f32 v84, v84, v153
    v_add_f32 v85, v85, v39
    v_add_f32 v86, v86, v38
    v_add_f32 v87, v87, v37
    v_add_f32 v88, v88, v154
    v_add_f32 v89, v89, v43
    v_add_f32 v90, v90, v42
    v_add_f32 v91, v91, v41
    v_add_f32 v92, v92, v155
    v_add_f32 v93, v93, v47
    v_add_f32 v94, v94, v46
    v_add_f32 v95, v95, v45
    v_pk_fma_f32 v[160:161], v[112:113], v[80:81], v[160:161]
    v_pk_fma_f32 v[162:163], v[114:115], v[82:83], v[162:163]
    v_pk_fma_f32 v[164:165], v[116:117], v[84:85], v[164:165]
    v_pk_fma_f32 v[166:167], v[118:119], v[86:87], v[166:167]
    v_pk_fma_f32 v[168:169], v[120:121], v[88:89], v[168:169]
    v_pk_fma_f32 v[170:171], v[122:123], v[90:91], v[170:171]
    v_pk_fma_f32 v[172:173], v[124:125], v[92:93], v[172:173]
    v_pk_fma_f32 v[174:175], v[126:127], v[94:95], v[174:175]
    ds_write_b128 v20, v[96:99] offset:0
    ds_write_b128 v20, v[100:103] offset:1024
    ds_write_b128 v20, v[104:107] offset:2048
    ds_write_b128 v20, v[108:111] offset:3072
    v_add_u32 v156, 16, v2
    v_and_b32 v156, 4095, v156
    v_add_u32 v156, s45, v156
    v_add_u32 v157, 1040, v2
    v_and_b32 v157, 4095, v157
    v_add_u32 v157, s45, v157
    v_add_u32 v158, 2064, v2
    v_and_b32 v158, 4095, v158
    v_add_u32 v158, s45, v158
    v_add_u32 v159, 3088, v2
    v_and_b32 v159, 4095, v159
    v_add_u32 v159, s45, v159
    ds_read_b128 v[32:35], v21 offset:3072
    ds_read_b128 v[36:39], v21 offset:2048
    ds_read_b128 v[40:43], v21 offset:1024
    ds_read_b128 v[44:47], v21 offset:0
    ds_read_b32 v152, v156
    ds_read_b32 v153, v157
    ds_read_b32 v154, v158
    ds_read_b32 v155, v159
    s_waitcnt lgkmcnt(0)
    v_add_f32 v32, v32, v152
    v_add_f32 v33, v33, v99
    v_add_f32 v34, v34, v98
    v_add_f32 v35, v35, v97
    v_add_f32 v36, v36, v153
    v_add_f32 v37, v37, v103
    v_add_f32 v38, v38, v102
    v_add_f32 v39, v39, v101
    v_add_f32 v40, v40, v154
    v_add_f32 v41, v41, v107
    v_add_f32 v42, v42, v106
    v_add_f32 v43, v43, v105
    v_add_f32 v44, v44, v155
    v_add_f32 v45, v45, v111
    v_add_f32 v46, v46, v110
    v_add_f32 v47, v47, v109
    v_pk_fma_f32 v[176:177], v[128:129], v[32:33], v[176:177]
    v_pk_fma_f32 v[178:179], v[130:131], v[34:35], v[178:179]
    v_pk_fma_f32 v[180:181], v[132:133], v[36:37], v[180:181]
    v_pk_fma_f32 v[182:183], v[134:135], v[38:39], v[182:183]
    v_pk_fma_f32 v[184:185], v[136:137], v[40:41], v[184:185]
    v_pk_fma_f32 v[186:187], v[138:139], v[42:43], v[186:187]
    v_pk_fma_f32 v[188:189], v[140:141], v[44:45], v[188:189]
    v_pk_fma_f32 v[190:191], v[142:143], v[46:47], v[190:191]
    v_pk_mul_f32 v[146:147], v[160:161], v[160:161]
    v_pk_mul_f32 v[148:149], v[160:161], v[48:49]
    v_pk_fma_f32 v[146:147], v[162:163], v[162:163], v[146:147]
    v_pk_fma_f32 v[148:149], v[162:163], v[50:51], v[148:149]
    v_pk_fma_f32 v[146:147], v[164:165], v[164:165], v[146:147]
    v_pk_fma_f32 v[148:149], v[164:165], v[52:53], v[148:149]
    v_pk_fma_f32 v[146:147], v[166:167], v[166:167], v[146:147]
    v_pk_fma_f32 v[148:149], v[166:167], v[54:55], v[148:149]
    v_pk_fma_f32 v[146:147], v[168:169], v[168:169], v[146:147]
    v_pk_fma_f32 v[148:149], v[168:169], v[56:57], v[148:149]
    v_pk_fma_f32 v[146:147], v[170:171], v[170:171], v[146:147]
    v_pk_fma_f32 v[148:149], v[170:171], v[58:59], v[148:149]
    v_pk_fma_f32 v[146:147], v[172:173], v[172:173], v[146:147]
    v_pk_fma_f32 v[148:149], v[172:173], v[60:61], v[148:149]
    v_pk_fma_f32 v[146:147], v[174:175], v[174:175], v[146:147]
    v_pk_fma_f32 v[148:149], v[174:175], v[62:63], v[148:149]
    v_pk_add_f32 v[144:145], v[160:161], v[162:163]
    v_pk_add_f32 v[144:145], v[144:145], v[164:165]
    v_pk_add_f32 v[144:145], v[144:145], v[166:167]
    v_pk_add_f32 v[144:145], v[144:145], v[168:169]
    v_pk_add_f32 v[144:145], v[144:145], v[170:171]
    v_pk_add_f32 v[144:145], v[144:145], v[172:173]
    v_pk_add_f32 v[144:145], v[144:145], v[174:175]
    v_pk_mul_f32 v[154:155], v[176:177], v[176:177]
    v_pk_mul_f32 v[156:157], v[176:177], v[64:65]
    v_pk_fma_f32 v[154:155], v[178:179], v[178:179], v[154:155]
    v_pk_fma_f32 v[156:157], v[178:179], v[66:67], v[156:157]
    v_pk_fma_f32 v[154:155], v[180:181], v[180:181], v[154:155]
    v_pk_fma_f32 v[156:157], v[180:181], v[68:69], v[156:157]
    v_pk_fma_f32 v[154:155], v[182:183], v[182:183], v[154:155]
    v_pk_fma_f32 v[156:157], v[182:183], v[70:71], v[156:157]
    v_pk_fma_f32 v[154:155], v[184:185], v[184:185], v[154:155]
    v_pk_fma_f32 v[156:157], v[184:185], v[72:73], v[156:157]
    v_pk_fma_f32 v[154:155], v[186:187], v[186:187], v[154:155]
    v_pk_fma_f32 v[156:157], v[186:187], v[74:75], v[156:157]
    v_pk_fma_f32 v[154:155], v[188:189], v[188:189], v[154:155]
    v_pk_fma_f32 v[156:157], v[188:189], v[76:77], v[156:157]
    v_pk_fma_f32 v[154:155], v[190:191], v[190:191], v[154:155]
    v_pk_fma_f32 v[156:157], v[190:191], v[78:79], v[156:157]
    v_pk_add_f32 v[152:153], v[176:177], v[178:179]
    v_pk_add_f32 v[152:153], v[152:153], v[180:181]
    v_pk_add_f32 v[152:153], v[152:153], v[182:183]
    v_pk_add_f32 v[152:153], v[152:153], v[184:185]
    v_pk_add_f32 v[152:153], v[152:153], v[186:187]
    v_pk_add_f32 v[152:153], v[152:153], v[188:189]
    v_pk_add_f32 v[152:153], v[152:153], v[190:191]
    s_branch f_join
g_start:
    s_mov_b32 s43, 6619136
    s_load_dword s101, s[6:7], s43
    s_mov_b32 s44, s20
    s_mov_b32 s45, s21
    s_mov_b32 s46, 2048
    s_mov_b32 s47, 0x00020000
    v_and_b32 v6, 127, v0
    v_lshlrev_b32 v6, 1, v6
    s_lshl_b32 s19, s34, 8
    buffer_load_ushort v110, v6, s[44:47], s19 offen
    s_and_b32 s65, s35, 1
    s_lshr_b32 s40, s35, 1
    s_mul_i32 s64, s34, 7
    s_add_u32 s64, s64, s40
    s_cmp_ge_u32 s35, 14
    s_cselect_b32 s66, 1, 0
    s_mov_b32 s40, s34
    v_bfe_u32 v5, v0, 5, 1
    v_lshlrev_b32 v5, 3, v5
    v_bfe_u32 v9, v0, 3, 2
    v_add_u32 v5, v5, v9
    v_lshlrev_b32 v9, 1, v7
    v_xor_b32 v9, v9, v0
    v_and_b32 v9, 7, v9
    v_lshlrev_b32 v9, 4, v9
    s_movk_i32 s42, 7168
    v_mad_u32_u24 v5, v5, s42, v9
    v_mov_b32 v104, -1
    v_mov_b32 v105, -1
    v_mov_b32 v106, -1
    v_mov_b32 v107, -1
    v_mov_b32 v14, 0
    s_lshl_b32 s38, s64, 12
    s_lshl_b32 s42, s16, 9
    s_add_u32 s38, s38, s42
    s_mul_i32 s42, s65, 262144
    s_add_u32 s38, s38, s42
    s_add_u32 s38, s38, 4718592
    s_mov_b32 s12, s6
    s_mov_b32 s13, s7
    s_mov_b32 s14, 268435456
    s_mov_b32 s15, 0x00020000
    s_lshl_b32 s42, s35, 3
    s_add_u32 s42, s42, s34
    s_lshl_b32 s42, s42, 3
    s_add_u32 s42, s42, s16
    s_lshl_b32 s42, s42, 8
    s_add_u32 s42, s42, 6291456
    v_lshlrev_b32 v9, 7, v2
    s_mov_b64 exec, 3
    buffer_load_dword v251, v9, s[12:15], s42 offen
    s_mov_b64 exec, -1
    s_mov_b32 s44, s50
    s_mov_b32 s45, s51
    s_mov_b32 s46, 7340032
    s_mov_b32 s47, 0x00020000
    s_mov_b32 s60, s52
    s_mov_b32 s61, s53
    s_mov_b32 s62, 7340032
    s_mov_b32 s63, 0x00020000
    s_mov_b32 s72, s54
    s_mov_b32 s73, s55
    s_mov_b32 s74, 7340032
    s_mov_b32 s75, 0x00020000
    s_mov_b32 s26, 4194304
    s_mov_b32 s27, 0x00020000
    s_lshl_b32 s67, s65, 4
    s_add_u32 s67, s67, s16
    s_mul_i32 s67, s67, 229376
    s_lshl_b32 s42, s64, 7
    s_add_u32 s67, s67, s42
    s_lshl_b32 s42, s64, 6
    s_and_b32 s43, s16, 3
    s_lshl_b32 s43, s43, 3
    s_add_u32 s42, s42, s43
    s_and_b32 s43, s16, 4
    s_add_u32 s42, s42, s43
    s_lshl_b32 s69, s42, 11
    s_lshl_b32 s43, s65, 10
    s_add_u32 s69, s69, s43
    s_and_b32 s43, s16, 1
    s_lshl_b32 s43, s43, 7
    v_xor_b32 v21, s43, v3
    v_xor_b32 v22, 32, v21
    v_xor_b32 v23, 64, v21
    v_xor_b32 v24, 96, v21
    v_add_u32 v109, 131072, v6
    v_lshrrev_b32 v6, 2, v2
    v_and_b32 v15, 3, v0
    v_bfe_u32 v16, v0, 3, 2
    v_xor_b32 v12, v16, v1
    v_and_b32 v12, 3, v12
    v_lshlrev_b32 v12, 5, v12
    v_lshl_add_u32 v12, v6, 7, v12
    v_lshl_add_u32 v12, v15, 3, v12
    v_lshrrev_b32 v16, 2, v1
    v_lshl_add_u32 v12, v16, 14, v12
    v_add_u32 v25, 65536, v12
    v_and_b32 v17, 7, v6
    v_lshlrev_b32 v8, 2, v1
    v_xor_b32 v8, v8, v17
    v_lshlrev_b32 v8, 5, v8
    v_lshl_add_u32 v8, v6, 10, v8
    v_lshl_add_u32 v8, v15, 3, v8
    v_xor_b32 v9, 32, v8
    v_xor_b32 v10, 64, v8
    v_xor_b32 v11, 96, v8
    v_and_b32 v6, 1, v0
    v_lshlrev_b32 v17, 10, v6
    v_lshl_add_u32 v17, v16, 8, v17
    v_lshl_add_u32 v17, v7, 4, v17
    v_add_u32 v17, 131584, v17
    v_lshlrev_b32 v19, 7, v6
    v_lshl_add_u32 v19, v7, 4, v19
    v_add_u32 v19, 133632, v19
    v_and_b32 v6, 15, v0
    v_lshlrev_b32 v18, 1, v6
    v_lshl_add_u32 v18, v1, 5, v18
    v_lshl_add_u32 v18, v7, 7, v18
    v_add_u32 v18, 133632, v18
    v_lshlrev_b32 v20, 2, v6
    v_lshl_add_u32 v20, v1, 14, v20
    v_lshl_add_u32 v20, v7, 12, v20
    v_lshlrev_b32 v26, 4, v7
    v_add_u32 v27, 131072, v26
    v_lshlrev_b32 v28, 11, v7
    v_bfe_u32 v29, v0, 2, 3
    v_xor_b32 v29, v29, v1
    v_lshl_add_u32 v29, v29, 5, v28
    v_bfe_u32 v30, v0, 2, 2
    v_lshl_add_u32 v29, v30, 8, v29
    v_lshl_add_u32 v29, v15, 3, v29
    v_add_u32 v30, 65536, v29
    s_lshl_b32 s30, s41, 15
    s_and_b32 s42, s16, 3
    s_lshl_b32 s42, s42, 13
    s_add_u32 s30, s30, s42
    s_lshl_b32 s42, s40, 8
    s_add_u32 s30, s30, s42
    s_lshl_b32 s42, s17, 1
    s_lshr_b32 s43, s16, 2
    s_add_u32 s42, s42, s43
    s_lshl_b32 s42, s42, 4
    s_add_u32 s30, s30, s42
    s_add_u32 s30, s30, 6291456
    s_lshl_b32 s31, s41, 5
    s_lshr_b32 s42, s16, 1
    s_add_u32 s31, s31, s42
    s_lshl_b32 s31, s31, 10
    s_lshl_b32 s42, s40, 7
    s_add_u32 s31, s31, s42
    s_and_b32 s42, s16, 1
    s_lshl_b32 s42, s42, 6
    s_add_u32 s31, s31, s42
    s_add_u32 s31, s31, 6356992
    s_movk_i32 s33, 0xff
    s_cmp_eq_u32 s66, 1
    s_cbranch_scc1 x_start
    s_mul_i32 s70, s41, -4096
    s_add_u32 s70, s70, 8192
    s_add_u32 s70, s70, s18
    s_add_u32 s42, s17, 1
    s_and_b32 s42, s42, 7
    s_lshl_b32 s42, s42, 8
    s_add_u32 s70, s70, s42
    s_add_u32 s43, s68, 32768
    s_mov_b32 m0, s43
    s_add_u32 s42, s70, 0
    s_waitcnt vmcnt(5)
    buffer_load_dwordx4 v4, s[8:11], s42 offen  lds
    s_add_u32 s43, s68, 33792
    s_mov_b32 m0, s43
    s_add_u32 s42, s70, 49152
    s_waitcnt vmcnt(5)
    buffer_load_dwordx4 v4, s[8:11], s42 offen  lds
    s_add_u32 s43, s68, 34816
    s_mov_b32 m0, s43
    s_add_u32 s42, s70, 98304
    s_waitcnt vmcnt(5)
    buffer_load_dwordx4 v31, s[8:11], s42 offen  lds
    s_add_u32 s43, s68, 35840
    s_mov_b32 m0, s43
    s_add_u32 s42, s70, 147456
    s_waitcnt vmcnt(5)
    buffer_load_dwordx4 v31, s[8:11], s42 offen  lds
    s_waitcnt vmcnt(5)
    v_lshlrev_b32 v110, 16, v110
    v_mul_f32 v111, 0xbfb8aa3b, v110
    v_exp_f32 v111, v111
    s_nop 0
    v_add_f32 v111, 1.0, v111
    v_rcp_f32 v111, v111
    s_nop 0
    v_mul_f32 v110, v110, v111
    v_cvt_pk_bf16_f32 v110, v110, v110
    ds_write_b16 v109, v110
    s_waitcnt lgkmcnt(0)
    s_barrier
    ds_read_b128 v[128:131], v27 offset:0
    ds_read_b128 v[132:135], v27 offset:64
    ds_read_b128 v[136:139], v27 offset:128
    ds_read_b128 v[140:143], v27 offset:192
    ds_read_b64_tr_b16 v[144:145], v29 offset:0
    ds_read_b64_tr_b16 v[146:147], v29 offset:1024
    ds_read_b64_tr_b16 v[148:149], v29 offset:8192
    ds_read_b64_tr_b16 v[150:151], v29 offset:9216
    ds_read_b64_tr_b16 v[152:153], v29 offset:16384
    ds_read_b64_tr_b16 v[154:155], v29 offset:17408
    ds_read_b64_tr_b16 v[156:157], v29 offset:24576
    ds_read_b64_tr_b16 v[158:159], v29 offset:25600
    s_mul_i32 s32, s101, 0x9e3779b1
    s_or_b32 s32, s32, 0x101
    s_and_b32 s32, s32, 0xfffefbfb
    s_and_b32 s56, s32, 0xff
    s_bfe_u32 s57, s32, 0x80008
    s_bfe_u32 s58, s32, 0x80010
    s_lshr_b32 s59, s32, 24
    v_mov_b32 v164, s56
    v_mov_b32 v165, s57
    v_mov_b32 v166, s58
    v_mov_b32 v167, s59
    s_waitcnt lgkmcnt(6)
    v_mfma_f32_16x16x32_bf16 v[160:163], v[144:147], v[128:131], 0
    s_waitcnt lgkmcnt(4)
    v_mfma_f32_16x16x32_bf16 v[160:163], v[148:151], v[132:135], v[160:163]
    s_waitcnt lgkmcnt(2)
    v_mfma_f32_16x16x32_bf16 v[160:163], v[152:155], v[136:139], v[160:163]
    s_waitcnt lgkmcnt(0)
    v_mfma_f32_16x16x32_bf16 v[160:163], v[156:159], v[140:143], v[160:163]
    s_nop 7
    v_bfi_b32 v160, s33, v164, v160
    v_bfi_b32 v161, s33, v165, v161
    v_bfi_b32 v162, s33, v166, v162
    v_bfi_b32 v163, s33, v167, v163
    s_mov_b32 exec_lo, 0x00010001
    s_mov_b32 exec_hi, 0x00010001
    buffer_store_dwordx4 v[160:163], v28, s[12:15], s30 offen sc1
    s_mov_b64 exec, -1
    s_mul_i32 s70, s41, 4096
    s_add_u32 s70, s70, 6144
    s_add_u32 s70, s70, s18
    s_add_u32 s42, s17, 2
    s_and_b32 s42, s42, 7
    s_lshl_b32 s42, s42, 8
    s_add_u32 s70, s70, s42
    s_add_u32 s43, s68, 65536
    s_mov_b32 m0, s43
    s_add_u32 s42, s70, 0
    s_waitcnt vmcnt(4)
    buffer_load_dwordx4 v4, s[8:11], s42 offen  lds
    s_add_u32 s43, s68, 66560
    s_mov_b32 m0, s43
    s_add_u32 s42, s70, 49152
    s_waitcnt vmcnt(4)
    buffer_load_dwordx4 v4, s[8:11], s42 offen  lds
    s_add_u32 s43, s68, 67584
    s_mov_b32 m0, s43
    s_add_u32 s42, s70, 98304
    s_waitcnt vmcnt(4)
    buffer_load_dwordx4 v31, s[8:11], s42 offen  lds
    s_add_u32 s43, s68, 68608
    s_mov_b32 m0, s43
    s_add_u32 s42, s70, 147456
    s_waitcnt vmcnt(4)
    buffer_load_dwordx4 v31, s[8:11], s42 offen  lds
    s_waitcnt lgkmcnt(0)
    s_barrier
    ds_read_b64_tr_b16 v[144:145], v29 offset:32768
    ds_read_b64_tr_b16 v[146:147], v29 offset:33792
    ds_read_b64_tr_b16 v[148:149], v29 offset:40960
    ds_read_b64_tr_b16 v[150:151], v29 offset:41984
    ds_read_b64_tr_b16 v[152:153], v29 offset:49152
    ds_read_b64_tr_b16 v[154:155], v29 offset:50176
    ds_read_b64_tr_b16 v[156:157], v29 offset:57344
    ds_read_b64_tr_b16 v[158:159], v29 offset:58368
    s_waitcnt lgkmcnt(6)
    v_mfma_f32_16x16x32_bf16 v[160:163], v[144:147], v[128:131], 0
    s_waitcnt lgkmcnt(4)
    v_mfma_f32_16x16x32_bf16 v[160:163], v[148:151], v[132:135], v[160:163]
    s_waitcnt lgkmcnt(2)
    v_mfma_f32_16x16x32_bf16 v[160:163], v[152:155], v[136:139], v[160:163]
    s_waitcnt lgkmcnt(0)
    v_mfma_f32_16x16x32_bf16 v[160:163], v[156:159], v[140:143], v[160:163]
    s_add_u32 s42, s17, 1
    s_and_b32 s42, s42, 7
    s_lshl_b32 s42, s42, 12
    s_add_u32 s42, s42, s31
    s_add_u32 s42, s42, 0
    s_nop 2
    v_bfi_b32 v160, s33, v164, v160
    v_bfi_b32 v161, s33, v165, v161
    v_bfi_b32 v162, s33, v166, v162
    v_bfi_b32 v163, s33, v167, v163
    s_mov_b32 exec_lo, 0x00010001
    s_mov_b32 exec_hi, 0x00010001
    buffer_store_dwordx4 v[160:163], v26, s[12:15], s42 offen sc1
    s_mov_b64 exec, -1
    s_add_u32 s43, s68, 98304
    s_mov_b32 m0, s43
    s_add_u32 s42, s69, 0
    s_waitcnt vmcnt(4)
    buffer_load_dwordx4 v21, s[72:75], s42 offen  lds
    s_add_u32 s43, s68, 99328
    s_mov_b32 m0, s43
    s_add_u32 s42, s69, 2048
    s_waitcnt vmcnt(4)
    buffer_load_dwordx4 v22, s[72:75], s42 offen  lds
    s_add_u32 s43, s68, 100352
    s_mov_b32 m0, s43
    s_add_u32 s42, s69, 4096
    s_waitcnt vmcnt(4)
    buffer_load_dwordx4 v23, s[72:75], s42 offen  lds
    s_add_u32 s43, s68, 101376
    s_mov_b32 m0, s43
    s_add_u32 s42, s69, 6144
    s_waitcnt vmcnt(4)
    buffer_load_dwordx4 v24, s[72:75], s42 offen  lds
    s_waitcnt lgkmcnt(0)
    s_barrier
    ds_read_b64_tr_b16 v[144:145], v30 offset:0
    ds_read_b64_tr_b16 v[146:147], v30 offset:1024
    ds_read_b64_tr_b16 v[148:149], v30 offset:8192
    ds_read_b64_tr_b16 v[150:151], v30 offset:9216
    ds_read_b64_tr_b16 v[152:153], v30 offset:16384
    ds_read_b64_tr_b16 v[154:155], v30 offset:17408
    ds_read_b64_tr_b16 v[156:157], v30 offset:24576
    ds_read_b64_tr_b16 v[158:159], v30 offset:25600
    s_waitcnt lgkmcnt(6)
    v_mfma_f32_16x16x32_bf16 v[160:163], v[144:147], v[128:131], 0
    s_waitcnt lgkmcnt(4)
    v_mfma_f32_16x16x32_bf16 v[160:163], v[148:151], v[132:135], v[160:163]
    s_waitcnt lgkmcnt(2)
    v_mfma_f32_16x16x32_bf16 v[160:163], v[152:155], v[136:139], v[160:163]
    s_waitcnt lgkmcnt(0)
    v_mfma_f32_16x16x32_bf16 v[160:163], v[156:159], v[140:143], v[160:163]
    s_add_u32 s42, s17, 2
    s_and_b32 s42, s42, 7
    s_lshl_b32 s42, s42, 12
    s_add_u32 s42, s42, s31
    s_add_u32 s42, s42, 65536
    s_nop 2
    v_bfi_b32 v160, s33, v164, v160
    v_bfi_b32 v161, s33, v165, v161
    v_bfi_b32 v162, s33, v166, v162
    v_bfi_b32 v163, s33, v167, v163
    s_mov_b32 exec_lo, 0x00010001
    s_mov_b32 exec_hi, 0x00010001
    buffer_store_dwordx4 v[160:163], v26, s[12:15], s42 offen sc1
    s_mov_b64 exec, -1
    s_getreg_b32 s39, hwreg(HW_REG_XCC_ID)
    s_and_b32 s39, s39, 7
    s_lshl_b32 s38, s64, 1
    s_add_u32 s38, s38, s65
    s_lshl_b32 s38, s38, 7
    s_add_u32 s38, s38, 6537216
    s_lshl_b32 s42, s16, 28
    v_mov_b32 v28, s32
    v_mov_b32 v29, s39
    v_mov_b32 v30, s42
    s_mov_b64 exec, 1
    buffer_store_dwordx2 v[28:29], v30, s[12:15], s38 offen sc1
    s_mov_b64 exec, -1
    s_xor_b32 s38, s38, 128
    s_cmp_eq_u32 s65, s65
    s_cselect_b32 s8, s50, s52
    s_cselect_b32 s9, s51, s53
    s_mov_b32 s10, 7340032
    s_lshr_b32 s42, s8, 7
    s_sub_u32 s42, 3, s42
    s_add_u32 s42, s42, s34
    s_and_b32 s42, s42, 7
    s_cmp_eq_u32 s42, 7
    s_cselect_b32 s70, 0x1000000, 0
    s_mul_i32 s43, s34, 7
    s_add_u32 s42, s42, s43
    s_lshl_b32 s42, s42, 7
    s_lshr_b32 s43, s35, 1
    s_lshl_b32 s43, s43, 3
    s_add_u32 s43, s43, s16
    s_mul_i32 s43, s43, 35840
    s_add_u32 s42, s42, s43
    s_add_u32 s42, s42, s70
    s_mul_i32 s43, s65, 3670016
    s_add_u32 s42, s42, s43
    s_add_u32 s42, s42, 1662976
    v_mul_u32_u24 v30, 7168, v2
    s_mov_b64 exec, 31
    buffer_load_dword v252, v30, s[8:11], s42 offen
    s_mov_b64 exec, -1
    v_cmp_eq_u32 s[4:5], 1, v7
    v_cmp_eq_u32 s[6:7], 2, v7
    v_cmp_eq_u32 s[28:29], 3, v7
    v_and_b32 v191, 3, v0
    v_lshlrev_b32 v191, 3, v191
    v_lshrrev_b32 v191, v191, s32
    v_lshlrev_b32 v212, 5, v2
    s_lshl_b32 s36, s65, 11
    s_add_u32 s37, s36, 6496256
    s_add_u32 s36, s36, 6504448
    s_mov_b32 s18, 196611
    s_mov_b32 s19, 0x00020002
    v_and_b32 v208, 1, v0
    v_lshlrev_b32 v208, 3, v208
    s_not_b32 s42, s32
    v_lshrrev_b32 v208, v208, s42
    v_lshrrev_b32 v209, 2, v208
    v_lshrrev_b32 v210, 4, v208
    v_lshrrev_b32 v211, 6, v208
    v_and_b32 v208, s18, v208
    v_and_b32 v209, s18, v209
    v_and_b32 v210, s18, v210
    v_and_b32 v211, s18, v211
    v_mov_b32 v216, s56
    v_mov_b32 v217, s57
    v_mov_b32 v218, s58
    v_mov_b32 v219, s59
    v_add_u32 v13, 131584, v3
    s_lshl_b32 s71, s65, 10
    s_add_u32 s71, s71, 5242880
    s_lshl_b32 s30, s65, 17
    s_lshl_b32 s31, s64, 6
    s_add_u32 s30, s30, s31
    s_add_u32 s30, s30, 4194304
    s_add_u32 s31, s30, 262144
    s_lshl_b32 s79, s64, 2
    s_and_b32 s42, s16, 3
    s_add_u32 s79, s79, s42
    s_lshl_b32 s79, s79, 10
    s_add_u32 s81, s79, 4718592
    s_add_u32 s82, s79, 4980736
    s_lshl_b32 s76, s65, 1
    s_lshr_b32 s42, s16, 2
    s_add_u32 s76, s76, s42
    s_lshl_b32 s76, s76, 8
    s_add_u32 s77, s76, s82
    s_add_u32 s76, s76, s81
    s_lshl_b32 s78, s34, 12
    s_add_u32 s78, s78, 4947968
    s_add_u32 s43, s68, 0
    s_mov_b32 m0, s43
    s_add_u32 s42, s69, 65536
    buffer_load_dwordx4 v21, s[72:75], s42 offen  lds
    s_add_u32 s43, s68, 1024
    s_mov_b32 m0, s43
    s_add_u32 s42, s69, 67584
    buffer_load_dwordx4 v22, s[72:75], s42 offen  lds
    s_add_u32 s43, s68, 2048
    s_mov_b32 m0, s43
    s_add_u32 s42, s69, 69632
    s_waitcnt vmcnt(8)
    buffer_load_dwordx4 v23, s[72:75], s42 offen  lds
    s_add_u32 s43, s68, 3072
    s_mov_b32 m0, s43
    s_add_u32 s42, s69, 71680
    s_waitcnt vmcnt(8)
    buffer_load_dwordx4 v24, s[72:75], s42 offen  lds
    s_add_u32 s43, s68, 32768
    s_mov_b32 m0, s43
    s_add_u32 s42, s67, 0
    s_waitcnt vmcnt(8)
    buffer_load_dwordx4 v5, s[44:47], s42 offen  lds
    s_add_u32 s43, s68, 33792
    s_mov_b32 m0, s43
    s_add_u32 s42, s67, 114688
    s_waitcnt vmcnt(8)
    buffer_load_dwordx4 v5, s[44:47], s42 offen  lds
    s_waitcnt lgkmcnt(0)
    s_barrier
    v_add_u32 v168, 65536, v8
    v_add_u32 v169, 65536, v9
    v_add_u32 v170, 65536, v10
    v_add_u32 v171, 65536, v11
    ds_read_b64_tr_b16 v[32:33], v168 offset:32768
    ds_read_b64_tr_b16 v[34:35], v168 offset:49152
    ds_read_b64_tr_b16 v[36:37], v169 offset:32768
    ds_read_b64_tr_b16 v[38:39], v169 offset:49152
    ds_read_b64_tr_b16 v[40:41], v170 offset:32768
    ds_read_b64_tr_b16 v[42:43], v170 offset:49152
    ds_read_b64_tr_b16 v[44:45], v171 offset:32768
    ds_read_b64_tr_b16 v[46:47], v171 offset:49152
    s_add_u32 s43, s68, 34816
    s_mov_b32 m0, s43
    s_add_u32 s42, s67, 28672
    s_waitcnt vmcnt(5)
    buffer_load_dwordx4 v5, s[44:47], s42 offen  lds
    s_add_u32 s43, s68, 35840
    s_mov_b32 m0, s43
    s_add_u32 s42, s67, 143360
    s_waitcnt vmcnt(5)
    buffer_load_dwordx4 v5, s[44:47], s42 offen  lds
    s_add_u32 s43, s68, 65536
    s_mov_b32 m0, s43
    s_add_u32 s42, s67, 1835008
    s_waitcnt vmcnt(5)
    buffer_load_dwordx4 v5, s[44:47], s42 offen  lds
    s_add_u32 s43, s68, 66560
    s_mov_b32 m0, s43
    s_add_u32 s42, s67, 1949696
    s_waitcnt vmcnt(5)
    buffer_load_dwordx4 v5, s[44:47], s42 offen  lds
    s_waitcnt lgkmcnt(0)
    s_barrier
    ds_read_b64_tr_b16 v[48:49], v8 offset:0
    ds_read_b64_tr_b16 v[50:51], v8 offset:16384
    ds_read_b64_tr_b16 v[52:53], v9 offset:0
    ds_read_b64_tr_b16 v[54:55], v9 offset:16384
    ds_read_b64_tr_b16 v[56:57], v10 offset:0
    ds_read_b64_tr_b16 v[58:59], v10 offset:16384
    ds_read_b64_tr_b16 v[60:61], v11 offset:0
    ds_read_b64_tr_b16 v[62:63], v11 offset:16384
    s_add_u32 s43, s68, 67584
    s_mov_b32 m0, s43
    s_add_u32 s42, s67, 1863680
    s_waitcnt vmcnt(5)
    buffer_load_dwordx4 v5, s[44:47], s42 offen  lds
    s_add_u32 s43, s68, 68608
    s_mov_b32 m0, s43
    s_add_u32 s42, s67, 1978368
    s_waitcnt vmcnt(5)
    buffer_load_dwordx4 v5, s[44:47], s42 offen  lds
    s_add_u32 s43, s68, 98304
    s_mov_b32 m0, s43
    s_add_u32 s42, s67, 0
    s_waitcnt vmcnt(5)
    buffer_load_dwordx4 v5, s[60:63], s42 offen  lds
    s_add_u32 s43, s68, 99328
    s_mov_b32 m0, s43
    s_add_u32 s42, s67, 114688
    s_waitcnt vmcnt(5)
    buffer_load_dwordx4 v5, s[60:63], s42 offen  lds
    s_waitcnt lgkmcnt(0)
    s_barrier
    ds_read_b64_tr_b16 v[64:65], v12 offset:32768
    ds_read_b64_tr_b16 v[66:67], v12 offset:34816
    ds_read_b64_tr_b16 v[68:69], v12 offset:36864
    ds_read_b64_tr_b16 v[70:71], v12 offset:38912
    ds_read_b64_tr_b16 v[72:73], v12 offset:40960
    ds_read_b64_tr_b16 v[74:75], v12 offset:43008
    ds_read_b64_tr_b16 v[76:77], v12 offset:45056
    ds_read_b64_tr_b16 v[78:79], v12 offset:47104
    s_add_u32 s43, s68, 100352
    s_mov_b32 m0, s43
    s_add_u32 s42, s67, 28672
    s_waitcnt vmcnt(5)
    buffer_load_dwordx4 v5, s[60:63], s42 offen  lds
    s_add_u32 s43, s68, 101376
    s_mov_b32 m0, s43
    s_add_u32 s42, s67, 143360
    s_waitcnt vmcnt(5)
    buffer_load_dwordx4 v5, s[60:63], s42 offen  lds
    v_lshlrev_b32 v30, 6, v2
    s_cmp_eq_u32 s16, 0
    s_cselect_b64 exec, -1, 0
    buffer_load_dword v31, v30, s[12:15], s81 offen sc1
    buffer_load_dwordx2 v[188:189], v14, s[12:15], s38 offen sc1
    buffer_load_dwordx4 v[192:195], v212, s[12:15], s36 offen offset:0
    buffer_load_dwordx4 v[196:199], v212, s[12:15], s36 offen offset:16
    buffer_load_dwordx4 v[200:203], v212, s[12:15], s37 offen offset:0
    buffer_load_dwordx4 v[204:207], v212, s[12:15], s37 offen offset:16
    s_mov_b64 exec, -1
    s_add_u32 s43, s68, 0
    s_mov_b32 m0, s43
    s_add_u32 s42, s67, 1835008
    s_waitcnt vmcnt(11)
    buffer_load_dwordx4 v5, s[60:63], s42 offen  lds
    s_add_u32 s43, s68, 1024
    s_mov_b32 m0, s43
    s_add_u32 s42, s67, 1949696
    s_waitcnt vmcnt(11)
    buffer_load_dwordx4 v5, s[60:63], s42 offen  lds
    s_waitcnt lgkmcnt(0)
    s_barrier
    ds_read_b64_tr_b16 v[80:81], v25 offset:0
    ds_read_b64_tr_b16 v[82:83], v25 offset:2048
    ds_read_b64_tr_b16 v[84:85], v25 offset:4096
    ds_read_b64_tr_b16 v[86:87], v25 offset:6144
    ds_read_b64_tr_b16 v[88:89], v25 offset:8192
    ds_read_b64_tr_b16 v[90:91], v25 offset:10240
    ds_read_b64_tr_b16 v[92:93], v25 offset:12288
    ds_read_b64_tr_b16 v[94:95], v25 offset:14336
    s_cmp_eq_u32 s16, 0
    s_cselect_b64 exec, -1, 0
    buffer_load_dword v15, v14, s[12:15], s78 offen offset:2048 sc1
    s_mov_b64 exec, -1
    s_add_u32 s43, s68, 2048
    s_mov_b32 m0, s43
    s_add_u32 s42, s67, 1863680
    s_waitcnt vmcnt(12)
    buffer_load_dwordx4 v5, s[60:63], s42 offen  lds
    s_add_u32 s43, s68, 3072
    s_mov_b32 m0, s43
    s_add_u32 s42, s67, 1978368
    s_waitcnt vmcnt(12)
    buffer_load_dwordx4 v5, s[60:63], s42 offen  lds
    s_waitcnt vmcnt(11)
    s_waitcnt lgkmcnt(0)
    s_barrier
    ds_read_b64_tr_b16 v[96:97], v25 offset:32768
    ds_read_b64_tr_b16 v[98:99], v25 offset:34816
    ds_read_b64_tr_b16 v[100:101], v25 offset:36864
    ds_read_b64_tr_b16 v[102:103], v25 offset:38912
    ds_read_b64_tr_b16 v[104:105], v25 offset:40960
    ds_read_b64_tr_b16 v[106:107], v25 offset:43008
    ds_read_b64_tr_b16 v[108:109], v25 offset:45056
    ds_read_b64_tr_b16 v[110:111], v25 offset:47104
    v_mov_b32 v190, 134656
    s_cmp_lg_u32 s16, 0
    s_cbranch_scc1 m_nk
    s_mov_b32 s83, 0
    s_waitcnt vmcnt(5)
    v_xor_b32 v188, s32, v188
    v_xor_b32 v189, s39, v189
    v_or_b32 v188, v188, v189
    ds_write_b32 v190, v188
m_pm:
    v_xor_b32 v192, s56, v192
    v_xor_b32 v193, s57, v193
    v_xor_b32 v194, s58, v194
    v_xor_b32 v195, s59, v195
    v_xor_b32 v196, s56, v196
    v_xor_b32 v197, s57, v197
    v_xor_b32 v198, s58, v198
    v_xor_b32 v199, s59, v199
    v_xor_b32 v200, s56, v200
    v_xor_b32 v201, s57, v201
    v_xor_b32 v202, s58, v202
    v_xor_b32 v203, s59, v203
    v_xor_b32 v204, s56, v204
    v_xor_b32 v205, s57, v205
    v_xor_b32 v206, s58, v206
    v_xor_b32 v207, s59, v207
    v_or3_b32 v30, v192, v193, v194
    v_or3_b32 v30, v30, v195, v196
    v_or3_b32 v30, v30, v197, v198
    v_or3_b32 v30, v30, v199, v200
    v_or3_b32 v30, v30, v201, v202
    v_or3_b32 v30, v30, v203, v204
    v_or3_b32 v30, v30, v205, v206
    v_or_b32 v30, v30, v207
    v_and_b32 v30, 0xff, v30
    v_cmp_ne_u32 vcc, 0, v30
    s_cbranch_vccz m_pmx
    s_sleep 4
    buffer_load_dwordx4 v[192:195], v212, s[12:15], s36 offen offset:0 sc1
    buffer_load_dwordx4 v[196:199], v212, s[12:15], s36 offen offset:16 sc1
    buffer_load_dwordx4 v[200:203], v212, s[12:15], s37 offen offset:0 sc1
    buffer_load_dwordx4 v[204:207], v212, s[12:15], s37 offen offset:16 sc1
    s_waitcnt vmcnt(0)
    s_add_u32 s83, s83, 1
    s_cmp_lt_u32 s83, 0x40000
    s_cbranch_scc1 m_pm
m_pmx:
    s_mov_b32 s83, 0
    s_waitcnt vmcnt(2)
m_go:
    v_cmp_ne_u32 vcc, s32, v15
    s_cbranch_vccz m_gox
    s_sleep 3
    buffer_load_dword v15, v14, s[12:15], s78 offen offset:2048 sc1
    s_waitcnt vmcnt(0)
    s_add_u32 s83, s83, 1
    s_cmp_lt_u32 s83, 0x40000
    s_cbranch_scc1 m_go
m_gox:
    s_mov_b32 s83, 0
m_pk:
    buffer_load_dwordx4 v[136:139], v3, s[12:15], s78 offen offset:0 sc1
    buffer_load_dwordx4 v[140:143], v3, s[12:15], s78 offen offset:1024 sc1
    s_waitcnt vmcnt(0)
    v_xor_b32 v30, s32, v138
    v_bitop3_b32 v30, v30, v142, s32 bitop3:0xf6
    v_cmp_ne_u32 vcc, 0, v30
    s_cbranch_vccz m_pkx
    s_sleep 4
    s_add_u32 s83, s83, 1
    s_cmp_lt_u32 s83, 0x40000
    s_cbranch_scc1 m_pk
m_pkx:
    v_max_u32 v28, v136, v140
    v_min_u32 v29, v136, v140
    v_max3_u32 v29, v29, v137, v141
    v_mov_b32 v30, v28
    s_nop 1
    v_max_u32_dpp v30, v30, v30 row_ror:8 row_mask:0xf bank_mask:0xf
    s_nop 1
    v_max_u32_dpp v30, v30, v30 row_ror:4 row_mask:0xf bank_mask:0xf
    s_nop 1
    v_max_u32_dpp v30, v30, v30 row_ror:2 row_mask:0xf bank_mask:0xf
    s_nop 1
    v_max_u32_dpp v30, v30, v30 row_ror:1 row_mask:0xf bank_mask:0xf
    s_nop 1
    v_max_u32_dpp v30, v30, v30 row_bcast:15 row_mask:0xa bank_mask:0xf
    s_nop 1
    v_max_u32_dpp v30, v30, v30 row_bcast:31 row_mask:0xc bank_mask:0xf
    s_nop 0
    v_readlane_b32 s40, v30, 63
    s_nop 1
    v_cmp_eq_u32 vcc, s40, v28
    s_nop 1
    v_cndmask_b32 v30, v28, v29, vcc
    s_nop 1
    v_max_u32_dpp v30, v30, v30 row_ror:8 row_mask:0xf bank_mask:0xf
    s_nop 1
    v_max_u32_dpp v30, v30, v30 row_ror:4 row_mask:0xf bank_mask:0xf
    s_nop 1
    v_max_u32_dpp v30, v30, v30 row_ror:2 row_mask:0xf bank_mask:0xf
    s_nop 1
    v_max_u32_dpp v30, v30, v30 row_ror:1 row_mask:0xf bank_mask:0xf
    s_nop 1
    v_max_u32_dpp v30, v30, v30 row_bcast:15 row_mask:0xa bank_mask:0xf
    s_nop 1
    v_max_u32_dpp v30, v30, v30 row_bcast:31 row_mask:0xc bank_mask:0xf
    s_nop 0
    v_readlane_b32 s41, v30, 63
    s_and_b32 s40, s40, 0xff
    s_and_b32 s41, s41, 0xff
    s_lshl_b32 s42, s40, 11
    s_lshl_b32 s43, s41, 11
    s_add_u32 s42, s42, s71
    s_add_u32 s43, s43, s71
    s_mov_b32 s83, 0
    buffer_load_dwordx4 v[176:179], v3, s[12:15], s42 offen sc1
    buffer_load_dwordx4 v[180:183], v3, s[12:15], s43 offen sc1
    s_lshl_b32 s41, s41, 8
    s_or_b32 s40, s40, s41
    v_mov_b32 v28, s40
    v_mov_b32 v29, s32
    s_cmp_eq_u32 s35, 0
    s_cselect_b64 exec, 1, 0
    buffer_store_dwordx2 v[28:29], v14, s[12:15], s78 offen offset:2304 sc1
    s_mov_b64 exec, -1
    s_barrier
    ds_read_b64_tr_b16 v[112:113], v12 offset:0
    ds_read_b64_tr_b16 v[114:115], v12 offset:2048
    ds_read_b64_tr_b16 v[116:117], v12 offset:4096
    ds_read_b64_tr_b16 v[118:119], v12 offset:6144
    ds_read_b64_tr_b16 v[120:121], v12 offset:8192
    ds_read_b64_tr_b16 v[122:123], v12 offset:10240
    ds_read_b64_tr_b16 v[124:125], v12 offset:12288
    ds_read_b64_tr_b16 v[126:127], v12 offset:14336
    s_waitcnt vmcnt(1)
m_ph:
    v_xor_b32 v176, v176, v208
    v_xor_b32 v177, v177, v209
    v_xor_b32 v178, v178, v210
    v_xor_b32 v179, v179, v211
    v_fma_mix_f32 v220, v176, v192, v200 op_sel:[0,0,0] op_sel_hi:[1,0,0]
    v_fma_mix_f32 v221, v176, v193, v201 op_sel:[1,0,0] op_sel_hi:[1,0,0]
    v_fma_mix_f32 v222, v177, v194, v202 op_sel:[0,0,0] op_sel_hi:[1,0,0]
    v_fma_mix_f32 v223, v177, v195, v203 op_sel:[1,0,0] op_sel_hi:[1,0,0]
    v_fma_mix_f32 v224, v178, v196, v204 op_sel:[0,0,0] op_sel_hi:[1,0,0]
    v_fma_mix_f32 v225, v178, v197, v205 op_sel:[1,0,0] op_sel_hi:[1,0,0]
    v_fma_mix_f32 v226, v179, v198, v206 op_sel:[0,0,0] op_sel_hi:[1,0,0]
    v_fma_mix_f32 v227, v179, v199, v207 op_sel:[1,0,0] op_sel_hi:[1,0,0]
    v_cvt_pk_bf16_f32 v236, v220, v221
    v_cvt_pk_bf16_f32 v237, v222, v223
    v_cvt_pk_bf16_f32 v238, v224, v225
    v_cvt_pk_bf16_f32 v239, v226, v227
    ds_write_b128 v13, v[236:239] offset:0
    v_xor_b32 v180, v180, v208
    v_xor_b32 v181, v181, v209
    v_xor_b32 v182, v182, v210
    v_xor_b32 v183, v183, v211
    v_fma_mix_f32 v228, v180, v192, v200 op_sel:[0,0,0] op_sel_hi:[1,0,0]
    v_fma_mix_f32 v229, v180, v193, v201 op_sel:[1,0,0] op_sel_hi:[1,0,0]
    v_fma_mix_f32 v230, v181, v194, v202 op_sel:[0,0,0] op_sel_hi:[1,0,0]
    v_fma_mix_f32 v231, v181, v195, v203 op_sel:[1,0,0] op_sel_hi:[1,0,0]
    v_fma_mix_f32 v232, v182, v196, v204 op_sel:[0,0,0] op_sel_hi:[1,0,0]
    v_fma_mix_f32 v233, v182, v197, v205 op_sel:[1,0,0] op_sel_hi:[1,0,0]
    v_fma_mix_f32 v234, v183, v198, v206 op_sel:[0,0,0] op_sel_hi:[1,0,0]
    v_fma_mix_f32 v235, v183, v199, v207 op_sel:[1,0,0] op_sel_hi:[1,0,0]
    v_cvt_pk_bf16_f32 v240, v228, v229
    v_cvt_pk_bf16_f32 v241, v230, v231
    v_cvt_pk_bf16_f32 v242, v232, v233
    v_cvt_pk_bf16_f32 v243, v234, v235
    ds_write_b128 v13, v[240:243] offset:1024
    v_xor_b32 v30, s19, v176
    v_bitop3_b32 v30, v30, v177, s19 bitop3:0xf6
    v_bitop3_b32 v30, v30, v178, s19 bitop3:0xf6
    v_bitop3_b32 v30, v30, v179, s19 bitop3:0xf6
    v_bitop3_b32 v30, v30, v180, s19 bitop3:0xf6
    v_bitop3_b32 v30, v30, v181, s19 bitop3:0xf6
    v_bitop3_b32 v30, v30, v182, s19 bitop3:0xf6
    v_bitop3_b32 v30, v30, v183, s19 bitop3:0xf6
    v_and_b32 v30, s18, v30
    v_cmp_ne_u32 vcc, 0, v30
    s_cbranch_vccnz m_phb
m_phx:
m_nk2:
    s_waitcnt lgkmcnt(0)
    s_barrier
    ds_read_b32 v188, v190
    ds_read_b128 v[128:131], v17 offset:0
    ds_read_b128 v[132:135], v17 offset:64
    ds_read_b128 v[136:139], v17 offset:128
    ds_read_b128 v[140:143], v17 offset:192
    ds_read_b128 v[144:147], v17 offset:512
    ds_read_b128 v[148:151], v17 offset:576
    ds_read_b128 v[152:155], v17 offset:640
    ds_read_b128 v[156:159], v17 offset:704
    s_waitcnt lgkmcnt(7)
    v_mfma_f32_16x16x32_bf16 v[160:163], v[128:131], v[64:67], 0
    v_mfma_f32_16x16x32_bf16 v[164:167], v[128:131], v[96:99], 0
    s_waitcnt lgkmcnt(6)
    v_mfma_f32_16x16x32_bf16 v[160:163], v[132:135], v[68:71], v[160:163]
    v_mfma_f32_16x16x32_bf16 v[164:167], v[132:135], v[100:103], v[164:167]
    s_waitcnt lgkmcnt(5)
    v_mfma_f32_16x16x32_bf16 v[160:163], v[136:139], v[72:75], v[160:163]
    v_mfma_f32_16x16x32_bf16 v[164:167], v[136:139], v[104:107], v[164:167]
    s_waitcnt lgkmcnt(4)
    v_mfma_f32_16x16x32_bf16 v[160:163], v[140:143], v[76:79], v[160:163]
    v_mfma_f32_16x16x32_bf16 v[164:167], v[140:143], v[108:111], v[164:167]
    s_waitcnt lgkmcnt(3)
    v_mfma_f32_16x16x32_bf16 v[160:163], v[144:147], v[80:83], v[160:163]
    v_mfma_f32_16x16x32_bf16 v[164:167], v[144:147], v[112:115], v[164:167]
    s_waitcnt lgkmcnt(2)
    v_mfma_f32_16x16x32_bf16 v[160:163], v[148:151], v[84:87], v[160:163]
    v_mfma_f32_16x16x32_bf16 v[164:167], v[148:151], v[116:119], v[164:167]
    s_waitcnt lgkmcnt(1)
    v_mfma_f32_16x16x32_bf16 v[160:163], v[152:155], v[88:91], v[160:163]
    v_mfma_f32_16x16x32_bf16 v[164:167], v[152:155], v[120:123], v[164:167]
    s_waitcnt lgkmcnt(0)
    v_mfma_f32_16x16x32_bf16 v[160:163], v[156:159], v[92:95], v[160:163]
    v_mfma_f32_16x16x32_bf16 v[164:167], v[156:159], v[124:127], v[164:167]
    v_readfirstlane_b32 s70, v188
    s_nop 5
    v_bfi_b32 v184, s33, v216, v160
    v_bfi_b32 v185, s33, v217, v161
    v_bfi_b32 v186, s33, v218, v164
    v_bfi_b32 v187, s33, v219, v165
    s_mov_b64 exec, 0xffff
    buffer_store_dwordx4 v[184:187], v3, s[12:15], s76 offen
    s_cmp_eq_u32 s70, 0
    s_cbranch_scc1 m_same
    buffer_store_dwordx4 v[184:187], v3, s[12:15], s77 offen sc1
m_same:
    s_cselect_b32 s82, s81, s82
    s_mov_b64 exec, -1
    s_cmp_ge_u32 s16, 4
    s_cbranch_scc1 m_na
    s_sleep 2
    s_mov_b32 s83, 0
m_px:
    buffer_load_dwordx4 v[24:27], v3, s[12:15], s81 offen sc1
    s_waitcnt vmcnt(0)
    v_xor_b32 v24, s56, v24
    v_xor_b32 v25, s57, v25
    v_xor_b32 v26, s58, v26
    v_xor_b32 v27, s59, v27
    v_or3_b32 v9, v24, v25, v26
    v_or_b32 v9, v9, v27
    v_and_b32 v9, 0xff, v9
    v_cmp_ne_u32 vcc, 0, v9
    s_cbranch_vccz m_pxx
    buffer_load_dwordx4 v[24:27], v3, s[12:15], s82 offen sc1
    s_waitcnt vmcnt(0)
    v_xor_b32 v24, s56, v24
    v_xor_b32 v25, s57, v25
    v_xor_b32 v26, s58, v26
    v_xor_b32 v27, s59, v27
    v_or3_b32 v9, v24, v25, v26
    v_or_b32 v9, v9, v27
    v_and_b32 v9, 0xff, v9
    v_cmp_ne_u32 vcc, 0, v9
    s_cbranch_vccz m_pxx
    s_add_u32 s83, s83, 1
    s_cmp_lt_u32 s83, 0x40000
    s_cbranch_scc1 m_px
m_pxx:
    v_permlane32_swap_b32 v24, v26
    v_permlane32_swap_b32 v25, v27
    v_pk_add_f32 v[24:25], v[24:25], v[26:27]
    s_nop 1
    v_permlane16_swap_b32 v24, v25
    v_add_f32 v24, v24, v25
    v_cvt_pk_bf16_f32 v24, v24, v24
    v_lshlrev_b32 v24, 16, v24
    v_mul_f32 v25, 0xbfb8aa3b, v24
    v_exp_f32 v25, v25
    v_mov_b32 v26, v24
    v_add_f32 v25, 1.0, v25
    v_rcp_f32 v25, v25
    v_mov_b32 v27, v24
    v_mul_f32 v25, v24, v25
    s_nop 0
    v_permlane32_swap_b32 v26, v27
    v_cvt_pk_bf16_f32 v25, v25, v25
    v_lshlrev_b32 v25, 16, v25
    v_mul_f32 v25, v25, v27
    v_cvt_pk_bf16_f32 v25, v25, v25
    ds_write_b16 v18, v25
m_na:
    s_waitcnt lgkmcnt(0)
    s_barrier
    ds_read_b128 v[128:131], v19 offset:0
    ds_read_b128 v[132:135], v19 offset:64
    s_waitcnt lgkmcnt(1)
    v_mfma_f32_16x16x32_bf16 v[160:163], v[128:131], v[32:35], 0
    v_mfma_f32_16x16x32_bf16 v[164:167], v[128:131], v[36:39], 0
    v_mfma_f32_16x16x32_bf16 v[168:171], v[128:131], v[40:43], 0
    v_mfma_f32_16x16x32_bf16 v[172:175], v[128:131], v[44:47], 0
    s_waitcnt lgkmcnt(0)
    v_mfma_f32_16x16x32_bf16 v[160:163], v[132:135], v[48:51], v[160:163]
    v_mfma_f32_16x16x32_bf16 v[164:167], v[132:135], v[52:55], v[164:167]
    v_mfma_f32_16x16x32_bf16 v[168:171], v[132:135], v[56:59], v[168:171]
    v_mfma_f32_16x16x32_bf16 v[172:175], v[132:135], v[60:63], v[172:175]
    s_nop 5
    v_cndmask_b32 v24, v160, v164, s[4:5]
    v_cndmask_b32 v25, v161, v165, s[4:5]
    v_cndmask_b32 v24, v24, v168, s[6:7]
    v_cndmask_b32 v25, v25, v169, s[6:7]
    v_cndmask_b32 v24, v24, v172, s[28:29]
    v_cndmask_b32 v25, v25, v173, s[28:29]
    v_bfi_b32 v24, s33, v191, v24
    v_bfi_b32 v25, s33, v191, v25
    buffer_store_dword v24, v20, s[12:15], s30 offen sc1
    buffer_store_dword v25, v20, s[12:15], s31 offen sc1
    s_endpgm
m_nk:
    s_waitcnt vmcnt(0)
    s_barrier
    ds_read_b64_tr_b16 v[112:113], v12 offset:0
    ds_read_b64_tr_b16 v[114:115], v12 offset:2048
    ds_read_b64_tr_b16 v[116:117], v12 offset:4096
    ds_read_b64_tr_b16 v[118:119], v12 offset:6144
    ds_read_b64_tr_b16 v[120:121], v12 offset:8192
    ds_read_b64_tr_b16 v[122:123], v12 offset:10240
    ds_read_b64_tr_b16 v[124:125], v12 offset:12288
    ds_read_b64_tr_b16 v[126:127], v12 offset:14336
    s_branch m_nk2
m_phb:
    s_add_u32 s83, s83, 1
    s_cmp_ge_u32 s83, 0x40000
    s_cbranch_scc1 m_phx
    buffer_load_dwordx4 v[176:179], v3, s[12:15], s42 offen sc1
    buffer_load_dwordx4 v[180:183], v3, s[12:15], s43 offen sc1
    s_waitcnt vmcnt(0)
    s_branch m_ph
x_start:
    s_lshl_b32 s37, s34, 1
    s_add_u32 s37, s37, s65
    s_lshl_b32 s37, s37, 3
    s_add_u32 s37, s37, s16
    s_lshl_b32 s42, s37, 8
    s_add_u32 s42, s42, 4947968
    s_mov_b64 exec, 0xffff
    buffer_store_dwordx4 v[104:107], v3, s[12:15], s42 offen sc1
    s_mov_b64 exec, -1
    s_lshl_b32 s36, s37, 12
    s_add_u32 s36, s36, 4194304
    s_lshl_b32 s76, s34, 3
    s_add_u32 s76, s76, s16
    s_lshl_b32 s77, s76, 10
    s_add_u32 s77, s77, 6356992
    s_lshl_b32 s79, s76, 7
    s_add_u32 s79, s79, 6488064
    s_lshr_b32 s71, s76, 5
    s_cmp_eq_u32 s71, 0
    s_cselect_b32 s80, 1.0, 0
    s_lshl_b32 s78, s34, 12
    s_add_u32 s78, s78, 4947968
    s_mov_b32 s72, s48
    s_mov_b32 s73, s49
    s_mov_b32 s74, 2048
    s_mov_b32 s75, 0x00020000
    v_and_b32 v10, 7, v0
    v_lshl_add_u32 v10, v10, 2, v7
    v_lshlrev_b32 v10, 1, v10
    s_lshl_b32 s42, s76, 6
    buffer_load_ushort v10, v10, s[72:75], s42 offen
    s_mul_i32 s70, s41, -4096
    s_add_u32 s70, s70, 8192
    s_add_u32 s70, s70, s18
    s_add_u32 s42, s17, 1
    s_and_b32 s42, s42, 7
    s_lshl_b32 s42, s42, 8
    s_add_u32 s70, s70, s42
    s_add_u32 s43, s68, 32768
    s_mov_b32 m0, s43
    s_add_u32 s42, s70, 0
    s_waitcnt vmcnt(7)
    buffer_load_dwordx4 v4, s[8:11], s42 offen  lds
    s_add_u32 s43, s68, 33792
    s_mov_b32 m0, s43
    s_add_u32 s42, s70, 49152
    s_waitcnt vmcnt(7)
    buffer_load_dwordx4 v4, s[8:11], s42 offen  lds
    s_add_u32 s43, s68, 34816
    s_mov_b32 m0, s43
    s_add_u32 s42, s70, 98304
    s_waitcnt vmcnt(7)
    buffer_load_dwordx4 v31, s[8:11], s42 offen  lds
    s_add_u32 s43, s68, 35840
    s_mov_b32 m0, s43
    s_add_u32 s42, s70, 147456
    s_waitcnt vmcnt(7)
    buffer_load_dwordx4 v31, s[8:11], s42 offen  lds
    s_waitcnt vmcnt(7)
    v_lshlrev_b32 v110, 16, v110
    v_mul_f32 v111, 0xbfb8aa3b, v110
    v_exp_f32 v111, v111
    s_nop 0
    v_add_f32 v111, 1.0, v111
    v_rcp_f32 v111, v111
    s_nop 0
    v_mul_f32 v110, v110, v111
    v_cvt_pk_bf16_f32 v110, v110, v110
    ds_write_b16 v109, v110
    s_waitcnt lgkmcnt(0)
    s_barrier
    ds_read_b128 v[128:131], v27 offset:0
    ds_read_b128 v[132:135], v27 offset:64
    ds_read_b128 v[136:139], v27 offset:128
    ds_read_b128 v[140:143], v27 offset:192
    ds_read_b64_tr_b16 v[144:145], v29 offset:0
    ds_read_b64_tr_b16 v[146:147], v29 offset:1024
    ds_read_b64_tr_b16 v[148:149], v29 offset:8192
    ds_read_b64_tr_b16 v[150:151], v29 offset:9216
    ds_read_b64_tr_b16 v[152:153], v29 offset:16384
    ds_read_b64_tr_b16 v[154:155], v29 offset:17408
    ds_read_b64_tr_b16 v[156:157], v29 offset:24576
    ds_read_b64_tr_b16 v[158:159], v29 offset:25600
    s_mul_i32 s32, s101, 0x9e3779b1
    s_or_b32 s32, s32, 0x101
    s_and_b32 s32, s32, 0xfffefbfb
    s_and_b32 s56, s32, 0xff
    s_bfe_u32 s57, s32, 0x80008
    s_bfe_u32 s58, s32, 0x80010
    s_lshr_b32 s59, s32, 24
    v_mov_b32 v164, s56
    v_mov_b32 v165, s57
    v_mov_b32 v166, s58
    v_mov_b32 v167, s59
    s_waitcnt lgkmcnt(6)
    v_mfma_f32_16x16x32_bf16 v[160:163], v[144:147], v[128:131], 0
    s_waitcnt lgkmcnt(4)
    v_mfma_f32_16x16x32_bf16 v[160:163], v[148:151], v[132:135], v[160:163]
    s_waitcnt lgkmcnt(2)
    v_mfma_f32_16x16x32_bf16 v[160:163], v[152:155], v[136:139], v[160:163]
    s_waitcnt lgkmcnt(0)
    v_mfma_f32_16x16x32_bf16 v[160:163], v[156:159], v[140:143], v[160:163]
    s_nop 7
    v_bfi_b32 v160, s33, v164, v160
    v_bfi_b32 v161, s33, v165, v161
    v_bfi_b32 v162, s33, v166, v162
    v_bfi_b32 v163, s33, v167, v163
    s_mov_b32 exec_lo, 0x00010001
    s_mov_b32 exec_hi, 0x00010001
    buffer_store_dwordx4 v[160:163], v28, s[12:15], s30 offen sc1
    s_mov_b64 exec, -1
    s_mul_i32 s70, s41, 4096
    s_add_u32 s70, s70, 6144
    s_add_u32 s70, s70, s18
    s_add_u32 s42, s17, 2
    s_and_b32 s42, s42, 7
    s_lshl_b32 s42, s42, 8
    s_add_u32 s70, s70, s42
    s_add_u32 s43, s68, 65536
    s_mov_b32 m0, s43
    s_add_u32 s42, s70, 0
    s_waitcnt vmcnt(4)
    buffer_load_dwordx4 v4, s[8:11], s42 offen  lds
    s_add_u32 s43, s68, 66560
    s_mov_b32 m0, s43
    s_add_u32 s42, s70, 49152
    s_waitcnt vmcnt(4)
    buffer_load_dwordx4 v4, s[8:11], s42 offen  lds
    s_add_u32 s43, s68, 67584
    s_mov_b32 m0, s43
    s_add_u32 s42, s70, 98304
    s_waitcnt vmcnt(4)
    buffer_load_dwordx4 v31, s[8:11], s42 offen  lds
    s_add_u32 s43, s68, 68608
    s_mov_b32 m0, s43
    s_add_u32 s42, s70, 147456
    s_waitcnt vmcnt(4)
    buffer_load_dwordx4 v31, s[8:11], s42 offen  lds
    s_waitcnt lgkmcnt(0)
    s_barrier
    ds_read_b64_tr_b16 v[144:145], v29 offset:32768
    ds_read_b64_tr_b16 v[146:147], v29 offset:33792
    ds_read_b64_tr_b16 v[148:149], v29 offset:40960
    ds_read_b64_tr_b16 v[150:151], v29 offset:41984
    ds_read_b64_tr_b16 v[152:153], v29 offset:49152
    ds_read_b64_tr_b16 v[154:155], v29 offset:50176
    ds_read_b64_tr_b16 v[156:157], v29 offset:57344
    ds_read_b64_tr_b16 v[158:159], v29 offset:58368
    s_waitcnt lgkmcnt(6)
    v_mfma_f32_16x16x32_bf16 v[160:163], v[144:147], v[128:131], 0
    s_waitcnt lgkmcnt(4)
    v_mfma_f32_16x16x32_bf16 v[160:163], v[148:151], v[132:135], v[160:163]
    s_waitcnt lgkmcnt(2)
    v_mfma_f32_16x16x32_bf16 v[160:163], v[152:155], v[136:139], v[160:163]
    s_waitcnt lgkmcnt(0)
    v_mfma_f32_16x16x32_bf16 v[160:163], v[156:159], v[140:143], v[160:163]
    s_add_u32 s42, s17, 1
    s_and_b32 s42, s42, 7
    s_lshl_b32 s42, s42, 12
    s_add_u32 s42, s42, s31
    s_add_u32 s42, s42, 0
    s_nop 2
    v_bfi_b32 v160, s33, v164, v160
    v_bfi_b32 v161, s33, v165, v161
    v_bfi_b32 v162, s33, v166, v162
    v_bfi_b32 v163, s33, v167, v163
    s_mov_b32 exec_lo, 0x00010001
    s_mov_b32 exec_hi, 0x00010001
    buffer_store_dwordx4 v[160:163], v26, s[12:15], s42 offen sc1
    s_mov_b64 exec, -1
    s_waitcnt vmcnt(1)
    s_waitcnt lgkmcnt(0)
    s_barrier
    ds_read_b64_tr_b16 v[144:145], v30 offset:0
    ds_read_b64_tr_b16 v[146:147], v30 offset:1024
    ds_read_b64_tr_b16 v[148:149], v30 offset:8192
    ds_read_b64_tr_b16 v[150:151], v30 offset:9216
    ds_read_b64_tr_b16 v[152:153], v30 offset:16384
    ds_read_b64_tr_b16 v[154:155], v30 offset:17408
    ds_read_b64_tr_b16 v[156:157], v30 offset:24576
    ds_read_b64_tr_b16 v[158:159], v30 offset:25600
    s_waitcnt lgkmcnt(6)
    v_mfma_f32_16x16x32_bf16 v[160:163], v[144:147], v[128:131], 0
    s_waitcnt lgkmcnt(4)
    v_mfma_f32_16x16x32_bf16 v[160:163], v[148:151], v[132:135], v[160:163]
    s_waitcnt lgkmcnt(2)
    v_mfma_f32_16x16x32_bf16 v[160:163], v[152:155], v[136:139], v[160:163]
    s_waitcnt lgkmcnt(0)
    v_mfma_f32_16x16x32_bf16 v[160:163], v[156:159], v[140:143], v[160:163]
    s_add_u32 s42, s17, 2
    s_and_b32 s42, s42, 7
    s_lshl_b32 s42, s42, 12
    s_add_u32 s42, s42, s31
    s_add_u32 s42, s42, 65536
    s_nop 2
    v_bfi_b32 v160, s33, v164, v160
    v_bfi_b32 v161, s33, v165, v161
    v_bfi_b32 v162, s33, v166, v162
    v_bfi_b32 v163, s33, v167, v163
    s_mov_b32 exec_lo, 0x00010001
    s_mov_b32 exec_hi, 0x00010001
    buffer_store_dwordx4 v[160:163], v26, s[12:15], s42 offen sc1
    s_mov_b64 exec, -1
    s_cmp_eq_u32 s65, 1
    s_cbranch_scc1 x_na
    s_cmp_eq_u32 s80, 0
    s_cselect_b32 s42, 0x42800000, 0
    v_lshl_or_b32 v10, v10, 16, s42
    v_lshlrev_b32 v8, 3, v7
    v_lshrrev_b32 v8, v8, s32
    s_mov_b32 s83, 0
x_pa:
    buffer_load_dwordx4 v[16:19], v3, s[12:15], s77 offen sc1
    s_waitcnt vmcnt(0)
    v_xor_b32 v16, s56, v16
    v_xor_b32 v17, s57, v17
    v_xor_b32 v18, s58, v18
    v_xor_b32 v19, s59, v19
    v_or3_b32 v9, v16, v17, v18
    v_or_b32 v9, v9, v19
    v_and_b32 v9, 0xff, v9
    v_cmp_ne_u32 vcc, 0, v9
    s_cbranch_vccz x_pax
    s_sleep 4
    s_add_u32 s83, s83, 1
    s_cmp_lt_u32 s83, 0x40000
    s_cbranch_scc1 x_pa
x_pax:
    v_permlane32_swap_b32 v16, v18
    v_permlane32_swap_b32 v17, v19
    v_pk_add_f32 v[16:17], v[16:17], v[18:19]
    s_nop 1
    v_permlane16_swap_b32 v16, v17
    v_add_f32 v16, v16, v17
    s_nop 1
    v_add_f32_dpp v16, v16, v16 row_ror:8 row_mask:0xf bank_mask:0xf
    v_cvt_pk_bf16_f32 v16, v16, v16
    v_lshlrev_b32 v16, 16, v16
    v_add_f32 v16, s80, v16
    v_cvt_pk_bf16_f32 v16, v16, v16
    v_lshlrev_b32 v16, 16, v16
    v_mul_f32 v20, v16, v10
    v_bfi_b32 v20, s33, v8, v20
    v_mov_b32 v21, v20
    s_nop 1
    v_permlane16_swap_b32 v20, v21
    v_mov_b32 v22, v20
    v_mov_b32 v23, v21
    s_nop 0
    v_permlane32_swap_b32 v20, v22
    v_permlane32_swap_b32 v21, v23
    s_mov_b64 exec, 0xff
    buffer_store_dwordx4 v[20:23], v3, s[12:15], s79 offen sc1
    s_mov_b64 exec, -1
    s_cmp_eq_u32 s80, 0
    s_cbranch_scc1 x_nc
    s_add_u32 s42, s79, 16384
    v_bfi_b32 v16, s33, v8, v16
    v_mov_b32 v17, v16
    s_nop 1
    v_permlane16_swap_b32 v16, v17
    v_mov_b32 v18, v16
    v_mov_b32 v19, v17
    s_nop 0
    v_permlane32_swap_b32 v16, v18
    v_permlane32_swap_b32 v17, v19
    s_mov_b64 exec, 0xff
    buffer_store_dwordx4 v[16:19], v3, s[12:15], s42 offen sc1
    s_mov_b64 exec, -1
x_nc:
    s_add_u32 s77, s77, 65536
    s_add_u32 s79, s79, 8192
    s_mov_b32 s80, 0
    s_sleep 12
    v_lshlrev_b32 v8, 3, v7
    v_lshrrev_b32 v8, v8, s32
    s_mov_b32 s83, 0
x_pb:
    buffer_load_dwordx4 v[16:19], v3, s[12:15], s77 offen sc1
    s_waitcnt vmcnt(0)
    v_xor_b32 v16, s56, v16
    v_xor_b32 v17, s57, v17
    v_xor_b32 v18, s58, v18
    v_xor_b32 v19, s59, v19
    v_or3_b32 v9, v16, v17, v18
    v_or_b32 v9, v9, v19
    v_and_b32 v9, 0xff, v9
    v_cmp_ne_u32 vcc, 0, v9
    s_cbranch_vccz x_pbx
    s_sleep 4
    s_add_u32 s83, s83, 1
    s_cmp_lt_u32 s83, 0x40000
    s_cbranch_scc1 x_pb
x_pbx:
    v_permlane32_swap_b32 v16, v18
    v_permlane32_swap_b32 v17, v19
    v_pk_add_f32 v[16:17], v[16:17], v[18:19]
    s_nop 1
    v_permlane16_swap_b32 v16, v17
    v_add_f32 v16, v16, v17
    s_nop 1
    v_add_f32_dpp v16, v16, v16 row_ror:8 row_mask:0xf bank_mask:0xf
    v_cvt_pk_bf16_f32 v16, v16, v16
    v_lshlrev_b32 v16, 16, v16
    v_add_f32 v16, s80, v16
    v_cvt_pk_bf16_f32 v16, v16, v16
    v_lshlrev_b32 v16, 16, v16
    v_bfi_b32 v16, s33, v8, v16
    v_mov_b32 v17, v16
    s_nop 1
    v_permlane16_swap_b32 v16, v17
    v_mov_b32 v18, v16
    v_mov_b32 v19, v17
    s_nop 0
    v_permlane32_swap_b32 v16, v18
    v_permlane32_swap_b32 v17, v19
    s_mov_b64 exec, 0xff
    buffer_store_dwordx4 v[16:19], v3, s[12:15], s79 offen sc1
    s_mov_b64 exec, -1
    s_branch x_nb
x_na:
    v_and_b32 v90, 255, v0
    v_lshrrev_b32 v91, 8, v0
    v_lshl_add_u32 v90, v91, 9, v90
    v_mul_u32_u24 v90, 7168, v90
    s_lshr_b32 s42, s60, 7
    s_sub_u32 s42, 3, s42
    s_add_u32 s42, s42, s34
    s_and_b32 s42, s42, 7
    s_cmp_eq_u32 s42, 7
    s_cselect_b32 s70, 0x1000000, 0
    s_mul_i32 s43, s34, 7
    s_add_u32 s42, s42, s43
    s_lshl_b32 s42, s42, 7
    s_add_u32 s42, s42, 0
    s_add_u32 s42, s42, s70
    buffer_load_dword v92, v90, s[60:63], s42 offen
    s_barrier
x_nb:
    s_mov_b32 s17, s37
    s_barrier
    v_lshlrev_b32 v9, 7, v2
    s_mov_b64 exec, 0xfffffff
    buffer_load_dword v251, v9, s[12:15], s36 offen
    s_mov_b64 exec, -1
    s_mov_b32 s8, s48
    s_mov_b32 s9, s49
    s_mov_b32 s10, 2048
    s_mov_b32 s11, 0x00020000
    s_and_b32 s18, s17, 63
    v_and_b32 v5, 3, v0
    v_lshlrev_b32 v5, 3, v5
    v_lshl_add_u32 v5, v7, 1, v5
    v_lshlrev_b32 v6, 1, v5
    v_and_b32 v86, -4, v5
    v_and_b32 v87, 2, v5
    v_lshlrev_b32 v87, 3, v87
    s_lshl_b32 s31, s18, 6
    s_add_u32 s30, s31, 6496256
    s_add_u32 s31, s30, 4096
    s_add_u32 s29, s30, 8192
    s_mov_b32 s28, 6496256
    v_lshlrev_b32 v88, 3, v7
    v_lshrrev_b32 v88, v88, s32
    v_lshrrev_b32 v89, 1, v86
    s_not_b32 s42, s32
    v_lshrrev_b32 v89, v89, s42
    v_and_b32 v89, 196611, v89
    v_lshlrev_b32 v9, 3, v2
    buffer_load_dwordx2 v[40:41], v9, s[8:11], 0 offen offset:0
    buffer_load_dwordx2 v[42:43], v9, s[8:11], 0 offen offset:512
    buffer_load_dwordx2 v[44:45], v9, s[8:11], 0 offen offset:1024
    buffer_load_dwordx2 v[46:47], v9, s[8:11], 0 offen offset:1536
    s_waitcnt vmcnt(0)
    v_lshlrev_b32 v48, 16, v40
    v_and_b32 v49, 0xffff0000, v40
    v_lshlrev_b32 v50, 16, v41
    v_and_b32 v51, 0xffff0000, v41
    v_lshlrev_b32 v52, 16, v42
    v_and_b32 v53, 0xffff0000, v42
    v_lshlrev_b32 v54, 16, v43
    v_and_b32 v55, 0xffff0000, v43
    v_lshlrev_b32 v56, 16, v44
    v_and_b32 v57, 0xffff0000, v44
    v_lshlrev_b32 v58, 16, v45
    v_and_b32 v59, 0xffff0000, v45
    v_lshlrev_b32 v60, 16, v46
    v_and_b32 v61, 0xffff0000, v46
    v_lshlrev_b32 v62, 16, v47
    v_and_b32 v63, 0xffff0000, v47
    s_cmp_lg_u32 s16, 0
    s_cbranch_scc1 x_g1x
    s_mov_b32 s83, 0
x_g1:
    buffer_load_dword v15, v14, s[12:15], s78 offen offset:2048 sc1
    s_waitcnt vmcnt(0)
    v_cmp_ne_u32 vcc, s32, v15
    s_cbranch_vccz x_g1x
    s_sleep 6
    s_add_u32 s83, s83, 1
    s_cmp_lt_u32 s83, 0x40000
    s_cbranch_scc1 x_g1
x_g1x:
    s_barrier
    s_mov_b32 s83, 0
x_pq:
    buffer_load_dwordx4 v[64:67], v3, s[12:15], s28 offen offset:0 sc1
    buffer_load_dwordx4 v[68:71], v3, s[12:15], s28 offen offset:1024 sc1
    buffer_load_dwordx4 v[72:75], v3, s[12:15], s28 offen offset:2048 sc1
    buffer_load_dwordx4 v[76:79], v3, s[12:15], s28 offen offset:3072 sc1
    buffer_load_dword v32, v6, s[12:15], s30 offen sc1
    buffer_load_dword v33, v6, s[12:15], s31 offen sc1
    buffer_load_dword v34, v6, s[12:15], s29 offen sc1
    s_waitcnt vmcnt(0)
    v_xor_b32 v36, v32, v88
    v_bitop3_b32 v36, v36, v33, v88 bitop3:0xf6
    v_bitop3_b32 v36, v36, v34, v88 bitop3:0xf6
    v_and_b32 v36, s33, v36
    v_cmp_ne_u32 s[68:69], 0, v36
    v_xor_b32 v64, s56, v64
    v_xor_b32 v65, s57, v65
    v_xor_b32 v66, s58, v66
    v_xor_b32 v67, s59, v67
    v_xor_b32 v68, s56, v68
    v_xor_b32 v69, s57, v69
    v_xor_b32 v70, s58, v70
    v_xor_b32 v71, s59, v71
    v_xor_b32 v72, s56, v72
    v_xor_b32 v73, s57, v73
    v_xor_b32 v74, s58, v74
    v_xor_b32 v75, s59, v75
    v_xor_b32 v76, s56, v76
    v_xor_b32 v77, s57, v77
    v_xor_b32 v78, s58, v78
    v_xor_b32 v79, s59, v79
    v_or3_b32 v9, v64, v65, v66
    v_or3_b32 v9, v9, v67, v68
    v_or3_b32 v9, v9, v69, v70
    v_or3_b32 v9, v9, v71, v72
    v_or3_b32 v9, v9, v73, v74
    v_or3_b32 v9, v9, v75, v76
    v_or3_b32 v9, v9, v77, v78
    v_or_b32 v9, v9, v79
    v_and_b32 v9, 0xff, v9
    v_cmp_ne_u32 vcc, 0, v9
    s_or_b64 vcc, vcc, s[68:69]
    s_cbranch_vccz x_pqx
    s_sleep 4
    s_add_u32 s83, s83, 1
    s_cmp_lt_u32 s83, 0x40000
    s_cbranch_scc1 x_pq
x_pqx:
    v_and_b32 v32, 0xffff0000, v32
    v_and_b32 v33, 0xffff0000, v33
    v_and_b32 v34, 0xffff0000, v34
    v_pk_mul_f32 v[8:9], v[48:49], v[64:65]
    v_pk_fma_f32 v[8:9], v[50:51], v[66:67], v[8:9]
    v_pk_fma_f32 v[8:9], v[52:53], v[68:69], v[8:9]
    v_pk_fma_f32 v[8:9], v[54:55], v[70:71], v[8:9]
    v_pk_fma_f32 v[8:9], v[56:57], v[72:73], v[8:9]
    v_pk_fma_f32 v[8:9], v[58:59], v[74:75], v[8:9]
    v_pk_fma_f32 v[8:9], v[60:61], v[76:77], v[8:9]
    v_pk_fma_f32 v[8:9], v[62:63], v[78:79], v[8:9]
    v_add_f32 v8, v8, v9
    s_nop 1
    v_add_f32_dpp v8, v8, v8 row_ror:8 row_mask:0xf bank_mask:0xf
    s_nop 1
    v_add_f32_dpp v8, v8, v8 row_ror:4 row_mask:0xf bank_mask:0xf
    s_nop 1
    v_add_f32_dpp v8, v8, v8 row_ror:2 row_mask:0xf bank_mask:0xf
    s_nop 1
    v_add_f32_dpp v8, v8, v8 row_ror:1 row_mask:0xf bank_mask:0xf
    s_nop 1
    v_add_f32_dpp v8, v8, v8 row_bcast:15 row_mask:0xa bank_mask:0xf
    s_nop 1
    v_add_f32_dpp v8, v8, v8 row_bcast:31 row_mask:0xc bank_mask:0xf
    s_cmp_lg_u32 s16, 0
    s_cbranch_scc1 x_ng
    v_mov_b32 v22, 0
    s_mov_b32 s83, 0
x_r0:
    buffer_load_dwordx2 v[16:17], v22, s[12:15], s78 offen offset:2304 sc1
    s_waitcnt vmcnt(0)
    v_readfirstlane_b32 s40, v16
    v_readfirstlane_b32 s41, v17
    s_cmp_eq_u32 s41, s32
    s_cbranch_scc1 x_r0x
    s_sleep 3
    s_add_u32 s83, s83, 1
    s_cmp_lt_u32 s83, 0x40000
    s_cbranch_scc1 x_r0
x_r0x:
    s_lshr_b32 s41, s40, 8
    s_and_b32 s40, s40, 0xff
    s_and_b32 s41, s41, 0xff
x_ng:
    s_barrier
    v_mov_b32 v22, 0
    s_mov_b32 s83, 0
x_r1:
    buffer_load_dwordx2 v[16:17], v22, s[12:15], s78 offen offset:2304 sc1
    s_waitcnt vmcnt(0)
    v_readfirstlane_b32 s40, v16
    v_readfirstlane_b32 s41, v17
    s_cmp_eq_u32 s41, s32
    s_cbranch_scc1 x_r1x
    s_sleep 1
    s_add_u32 s83, s83, 1
    s_cmp_lt_u32 s83, 0x40000
    s_cbranch_scc1 x_r1
x_r1x:
    s_lshr_b32 s41, s40, 8
    s_and_b32 s40, s40, 0xff
    s_and_b32 s41, s41, 0xff
    s_cmp_lt_u32 s17, 64
    s_cselect_b32 s40, s40, s41
    s_lshl_b32 s42, s40, 11
    s_add_u32 s42, s42, 5242880
    s_lshl_b32 s19, s18, 5
    s_add_u32 s43, s42, s19
    s_lshl_b32 s40, s40, 4
    s_add_u32 s40, s40, 6512640
    s_mov_b32 s83, 0
x_ps:
    buffer_load_dwordx4 v[80:83], v14, s[12:15], s40 offen sc1
    buffer_load_dword v40, v86, s[12:15], s43 offen sc1
    s_waitcnt vmcnt(0)
    v_xor_b32 v40, v40, v89
    v_xor_b32 v35, 0x00020002, v40
    v_and_b32 v35, 196611, v35
    v_cmp_ne_u32 s[68:69], 0, v35
    v_xor_b32 v80, s56, v80
    v_xor_b32 v81, s57, v81
    v_xor_b32 v82, s58, v82
    v_xor_b32 v83, s59, v83
    v_or3_b32 v9, v80, v81, v82
    v_or_b32 v9, v9, v83
    v_and_b32 v9, 0xff, v9
    v_cmp_ne_u32 vcc, 0, v9
    s_or_b64 vcc, vcc, s[68:69]
    s_cbranch_vccz x_psx
    s_sleep 2
    s_add_u32 s83, s83, 1
    s_cmp_lt_u32 s83, 0x40000
    s_cbranch_scc1 x_ps
x_psx:
    v_readfirstlane_b32 s41, v80
    s_bfe_u32 s41, s41, 0xb0008
    s_lshl_b32 s41, s41, 11
    s_add_u32 s41, s41, s19
    v_not_b32 v36, v83
    v_ashrrev_i32 v36, 31, v36
    v_or_b32 v36, 0x80000000, v36
    v_xor_b32 v36, v36, v83
    v_add_f32 v8, v8, v36
    v_cvt_pk_bf16_f32 v8, v8, v8
    v_lshlrev_b32 v8, 16, v8
    v_mul_f32 v8, 0xbfb8aa3b, v8
    v_exp_f32 v8, v8
    s_nop 0
    v_add_f32 v8, 1.0, v8
    v_rcp_f32 v8, v8
    s_nop 0
    v_cvt_pk_bf16_f32 v8, v8, v8
    v_lshlrev_b32 v8, 16, v8
    s_nop 0
    v_readlane_b32 s46, v8, 63
    v_lshrrev_b32 v40, v87, v40
    v_cvt_f32_f16 v40, v40
    v_rcp_f32 v82, v82
    v_fma_f32 v36, v40, v34, v32
    v_fma_f32 v44, v40, v82, v81
    v_fmac_f32 v44, v33, v36
    v_mul_f32 v80, s46, v33
    s_sleep 18
    s_mov_b32 s83, 0
    s_mov_b64 s[60:61], -1
    s_mov_b64 s[62:63], -1
    s_mov_b64 s[64:65], -1
    s_mov_b32 s66, -1
    s_mov_b32 s67, 0
    v_mov_b32 v28, 0
    v_mov_b32 v29, 0
    v_mov_b32 v30, 0
    v_mov_b32 v31, 0
x_p2:
    s_mov_b64 exec, s[60:61]
    buffer_load_dwordx4 v[16:19], v3, s[12:15], s36 offen offset:0 sc1
    s_mov_b64 exec, s[62:63]
    buffer_load_dwordx4 v[20:23], v3, s[12:15], s36 offen offset:1024 sc1
    s_mov_b64 exec, s[64:65]
    buffer_load_dwordx4 v[24:27], v3, s[12:15], s36 offen offset:2048 sc1
    s_mov_b64 exec, s[66:67]
    buffer_load_dwordx4 v[28:31], v3, s[12:15], s36 offen offset:3072 sc1
    s_mov_b64 exec, s[60:61]
    s_waitcnt vmcnt(3)
    v_xor_b32 v16, s56, v16
    v_xor_b32 v17, s57, v17
    v_xor_b32 v18, s58, v18
    v_xor_b32 v19, s59, v19
    v_or3_b32 v12, v16, v17, v18
    v_bitop3_b32 v12, v12, v19, s33 bitop3:0xa8
    v_cmp_ne_u32 s[60:61], 0, v12
    s_mov_b64 exec, s[62:63]
    s_waitcnt vmcnt(2)
    v_xor_b32 v20, s56, v20
    v_xor_b32 v21, s57, v21
    v_xor_b32 v22, s58, v22
    v_xor_b32 v23, s59, v23
    v_or3_b32 v12, v20, v21, v22
    v_bitop3_b32 v12, v12, v23, s33 bitop3:0xa8
    v_cmp_ne_u32 s[62:63], 0, v12
    s_mov_b64 exec, s[64:65]
    s_waitcnt vmcnt(1)
    v_xor_b32 v24, s56, v24
    v_xor_b32 v25, s57, v25
    v_xor_b32 v26, s58, v26
    v_xor_b32 v27, s59, v27
    v_or3_b32 v12, v24, v25, v26
    v_bitop3_b32 v12, v12, v27, s33 bitop3:0xa8
    v_cmp_ne_u32 s[64:65], 0, v12
    s_mov_b64 exec, s[66:67]
    s_waitcnt vmcnt(0)
    v_xor_b32 v28, s56, v28
    v_xor_b32 v29, s57, v29
    v_xor_b32 v30, s58, v30
    v_xor_b32 v31, s59, v31
    v_or3_b32 v12, v28, v29, v30
    v_bitop3_b32 v12, v12, v31, s33 bitop3:0xa8
    v_cmp_ne_u32 s[66:67], 0, v12
    s_mov_b64 exec, -1
    s_add_u32 s83, s83, 1
    s_cmp_lt_u32 s83, 0x40000
    s_cselect_b64 s[68:69], -1, 0
    s_or_b64 s[70:71], s[60:61], s[62:63]
    s_or_b64 s[72:73], s[64:65], s[66:67]
    s_or_b64 s[70:71], s[70:71], s[72:73]
    s_and_b64 s[70:71], s[70:71], s[68:69]
    s_cbranch_scc1 x_p2
    v_pk_add_f32 v[16:17], v[16:17], v[20:21]
    v_pk_add_f32 v[24:25], v[24:25], v[28:29]
    v_pk_add_f32 v[18:19], v[18:19], v[22:23]
    v_pk_add_f32 v[26:27], v[26:27], v[30:31]
    v_pk_add_f32 v[16:17], v[16:17], v[24:25]
    v_pk_add_f32 v[18:19], v[18:19], v[26:27]
    s_nop 1
    v_permlane32_swap_b32 v16, v18
    v_permlane32_swap_b32 v17, v19
    v_pk_add_f32 v[16:17], v[16:17], v[18:19]
    s_nop 1
    v_permlane16_swap_b32 v16, v17
    v_add_f32 v16, v16, v17
    s_nop 1
    v_add_f32_dpp v16, v16, v16 row_ror:4 row_mask:0xf bank_mask:0xf
    s_nop 1
    v_add_f32_dpp v16, v16, v16 row_ror:8 row_mask:0xf bank_mask:0xf
    v_fmac_f32 v44, v16, v80
    s_mov_b32 exec_lo, 0x000f000f
    s_mov_b32 exec_hi, 0x000f000f
    v_cvt_pk_bf16_f32 v44, v44, v44
    buffer_store_short v44, v5, s[24:27], s41 offen
    s_cmp_lg_u32 s17, 0
    s_cbranch_scc1 x_end
    s_add_u32 s101, s101, 1
    s_mov_b32 s43, 6619136
    v_mov_b32 v8, s101
    s_mov_b64 exec, 1
    buffer_store_dword v8, v14, s[12:15], s43 offen sc1
x_end:
k_done:
    s_endpgm
code_end:
.p2align 8
.type tables,@object
tables:
.long 0x3c00,0x3c00,0x3c00,0x3c00,0x3c00,0x2e463bf6,0x323e3bd9,0x34a53ba8
.long 0x3c00,0x323e3bd9,0x361f3b64,0x38723aa7,0x3c00,0x34a53ba8,0x38723aa7,0x3a2f3913
.long 0x3c00,0x361f3b64,0x39a839a8,0x3b64361f,0x3c00,0x378b3b0e,0x3aa73872,0x3bf62e46
.long 0x3c00,0x38723aa7,0x3b64361f,0x3bd9b23e,0x3c00,0x39133a2f,0x3bd9323e,0x3b0eb78b
.long 0x3c00,0x39a839a8,0x3c000000,0x39a8b9a8,0x3c00,0x3a2f3913,0x3bd9b23e,0x378bbb0e
.long 0x3c00,0x3aa73872,0x3b64b61f,0x323ebbd9,0x3c00,0x3b0e378b,0x3aa7b872,0xae46bbf6
.long 0x3c00,0x3b64361f,0x39a8b9a8,0xb61fbb64,0x3c00,0x3ba834a5,0x3872baa7,0xb913ba2f
.long 0x3c00,0x3bd9323e,0x361fbb64,0xbaa7b872,0x3c00,0x3bf62e46,0x323ebbd9,0xbba8b4a5
.long 0x3c00,0x3c00,0x3c00,0x3c00,0x361f3b64,0x378b3b0e,0x38723aa7,0x39133a2f
.long 0x39a839a8,0x3aa73872,0x3b64361f,0x3bd9323e,0x3b64361f,0x3bf62e46,0x3bd9b23e,0x3b0eb78b
.long 0x3c000000,0x3b64b61f,0x39a8b9a8,0x361fbb64,0x3b64b61f,0x3913ba2f,0x323ebbd9,0xb4a5bba8
.long 0x39a8b9a8,0x323ebbd9,0xb61fbb64,0xbaa7b872,0x361fbb64,0xb4a5bba8,0xbaa7b872,0xbbf62e46
.long 0xbc00,0xb9a8b9a8,0xbc008000,0xb9a839a8,0xb61fbb64,0xbba8b4a5,0xbaa73872,0xae463bf6
.long 0xb9a8b9a8,0xbbd9323e,0xb61f3b64,0x38723aa7,0xbb64b61f,0xba2f3913,0x323e3bd9,0x3ba834a5
.long 0xbc008000,0xb61f3b64,0x39a839a8,0x3b64b61f,0xbb64361f,0x2e463bf6,0x3bd9323e,0x378bbb0e
.long 0xb9a839a8,0x38723aa7,0x3b64b61f,0xb23ebbd9,0xb61f3b64,0x3b0e378b,0x3872baa7,0xba2fb913
.long 0x3c00,0x3c00,0x3c00,0x3c00,0x39a839a8,0x3a2f3913,0x3aa73872,0x3b0e378b
.long 0x3c000000,0x3bd9b23e,0x3b64b61f,0x3aa7b872,0x39a8b9a8,0x378bbb0e,0x323ebbd9,0xae46bbf6
.long 0xbc00,0xb61fbb64,0xb9a8b9a8,0xbb64b61f,0xb9a8b9a8,0xbba8b4a5,0xbbd9323e,0xba2f3913
.long 0xbc008000,0xbaa73872,0xb61f3b64,0x323e3bd9,0xb9a839a8,0xae463bf6,0x38723aa7,0x3ba834a5
.long 0x3c00,0x39a839a8,0x3c000000,0x39a8b9a8,0x39a839a8,0x3bf6ae46,0x3872baa7,0xb4a5bba8
.long 0x3c000000,0x3872baa7,0xb61fbb64,0xbbd9b23e,0x39a8b9a8,0xb4a5bba8,0xbbd9b23e,0xb9133a2f
.long 0xbc00,0xbb64b61f,0xb9a839a8,0x361f3b64,0xb9a8b9a8,0xbb0e378b,0x323e3bd9,0x3bf62e46
.long 0xbc008000,0xb23e3bd9,0x3b64361f,0x3872baa7,0xb9a839a8,0x39133a2f,0x3aa7b872,0xb78bbb0e
.long 0x3c00,0x3c00,0x3c00,0x3c00,0x3b64361f,0x3ba834a5,0x3bd9323e,0x3bf62e46
.long 0x39a8b9a8,0x3872baa7,0x361fbb64,0x323ebbd9,0xb61fbb64,0xb913ba2f,0xbaa7b872,0xbba8b4a5
.long 0xbc008000,0xbb64361f,0xb9a839a8,0xb61f3b64,0xb61f3b64,0x2e463bf6,0x38723aa7,0x3b0e378b
.long 0x39a839a8,0x3bd9323e,0x3b64b61f,0x3872baa7,0x3b64b61f,0x378bbb0e,0xb23ebbd9,0xba2fb913
.long 0xbc00,0xb9a8b9a8,0xbc008000,0xb9a839a8,0xbb64b61f,0xbb0e378b,0xb23e3bd9,0x39133a2f
.long 0xb9a839a8,0x323e3bd9,0x3b64361f,0x3aa7b872,0x361f3b64,0x3bf62e46,0x3872baa7,0xb78bbb0e
.long 0x3c000000,0x361fbb64,0xb9a8b9a8,0xbb64361f,0x361fbb64,0xba2fb913,0xbaa73872,0x34a53ba8
.long 0xb9a8b9a8,0xbaa73872,0x361f3b64,0x3bd9b23e,0xbb64361f,0x34a53ba8,0x3bd9b23e,0xae46bbf6
.long 0x3c00,0x3c00,0x3c00,0x3c00,0x3c000000,0x3bf6ae46,0x3bd9b23e,0x3ba8b4a5
.long 0xbc00,0xb23ebbd9,0xb61fbb64,0xb872baa7,0xbc008000,0xbba834a5,0xbaa73872,0xb9133a2f
.long 0x3c00,0x361f3b64,0x39a839a8,0x3b64361f,0x3c000000,0x3b0eb78b,0x3872baa7,0x2e46bbf6
.long 0xbc00,0xb872baa7,0xbb64b61f,0xbbd9323e,0xbc008000,0xba2f3913,0xb23e3bd9,0x378b3b0e
.long 0x3c00,0x39a839a8,0x3c000000,0x39a8b9a8,0x3c000000,0x3913ba2f,0xb23ebbd9,0xbb0eb78b
.long 0xbc00,0xbaa7b872,0xbb64361f,0xb23e3bd9,0xbc008000,0xb78b3b0e,0x38723aa7,0x3bf6ae46
.long 0x3c00,0x3b64361f,0x39a8b9a8,0xb61fbb64,0x3c000000,0x34a5bba8,0xbaa7b872,0xba2f3913
.long 0xbc00,0xbbd9b23e,0xb61f3b64,0x3aa73872,0xbc008000,0xae463bf6,0x3bd9323e,0x34a5bba8
.long 0x3c00,0x3c00,0x3c00,0x3c00,0x3b64b61f,0x3b0eb78b,0x3aa7b872,0x3a2fb913
.long 0xb9a8b9a8,0xbaa7b872,0xbb64b61f,0xbbd9b23e,0xb61f3b64,0xae463bf6,0x323e3bd9,0x378b3b0e
.long 0x3c000000,0x3b64b61f,0x39a8b9a8,0x361fbb64,0xb61fbb64,0xba2fb913,0xbbd9b23e,0xbba834a5
.long 0xb9a839a8,0xb23e3bd9,0x361f3b64,0x3aa73872,0x3b64361f,0x3ba8b4a5,0x3872baa7,0xae46bbf6
.long 0xbc00,0xb9a8b9a8,0xbc008000,0xb9a839a8,0xbb64361f,0xb4a53ba8,0x38723aa7,0x3bf62e46
.long 0x39a839a8,0x3bd9b23e,0x361fbb64,0xb872baa7,0x361fbb64,0xb913ba2f,0xbbd9323e,0xb4a53ba8
.long 0xbc008000,0xb61f3b64,0x39a839a8,0x3b64b61f,0x361f3b64,0x3bf6ae46,0x323ebbd9,0xbb0eb78b
.long 0x39a8b9a8,0xb872baa7,0xbb64361f,0x323e3bd9,0xbb64b61f,0xb78b3b0e,0x3aa73872,0x3913ba2f
.long 0x3c00,0x3c00,0x3c00,0x3c00,0x39a8b9a8,0x3913ba2f,0x3872baa7,0x378bbb0e
.long 0xbc008000,0xbbd9323e,0xbb64361f,0xbaa73872,0x39a839a8,0x3b0e378b,0x3bd9323e,0x3bf6ae46
.long 0xbc00,0xb61fbb64,0xb9a8b9a8,0xbb64b61f,0xb9a839a8,0xb4a53ba8,0x323e3bd9,0x39133a2f
.long 0x3c000000,0x3aa7b872,0x361fbb64,0xb23ebbd9,0xb9a8b9a8,0xbbf6ae46,0xbaa73872,0xb4a53ba8
.long 0x3c00,0x39a839a8,0x3c000000,0x39a8b9a8,0x39a8b9a8,0xae46bbf6,0xbaa7b872,0xbba834a5
.long 0xbc008000,0xb8723aa7,0x361f3b64,0x3bd9323e,0x39a839a8,0x3ba8b4a5,0x323ebbd9,0xba2fb913
.long 0xbc00,0xbb64b61f,0xb9a839a8,0x361f3b64,0xb9a839a8,0x378b3b0e,0x3bd9b23e,0x2e46bbf6
.long 0x3c000000,0x323ebbd9,0xbb64b61f,0xb8723aa7,0xb9a8b9a8,0xba2f3913,0x38723aa7,0x3b0eb78b
.long 0x3c00,0x3c00,0x3c00,0x3c00,0x361fbb64,0x34a5bba8,0x323ebbd9,0x2e46bbf6
.long 0xb9a839a8,0xb8723aa7,0xb61f3b64,0xb23e3bd9,0x3b64b61f,0x3a2fb913,0x3872baa7,0x34a5bba8
.long 0xbc008000,0xbb64361f,0xb9a839a8,0xb61f3b64,0x3b64361f,0x3bf6ae46,0x3aa7b872,0x378bbb0e
.long 0xb9a8b9a8,0xbbd9b23e,0xbb64361f,0xb8723aa7,0x361f3b64,0x3b0e378b,0x3bd9b23e,0x3913ba2f
.long 0xbc00,0xb9a8b9a8,0xbc008000,0xb9a839a8,0xb61f3b64,0x378b3b0e,0x3bd9323e,0x3a2fb913
.long 0x39a8b9a8,0xb23ebbd9,0xbb64b61f,0xbaa73872,0xbb64361f,0xae463bf6,0x3aa73872,0x3b0eb78b
.long 0x3c000000,0x361fbb64,0xb9a8b9a8,0xbb64361f,0xbb64b61f,0xb9133a2f,0x38723aa7,0x3ba8b4a5
.long 0x39a839a8,0x3aa7b872,0xb61fbb64,0xbbd9323e,0xb61fbb64,0xbba834a5,0x323e3bd9,0x3bf6ae46
.long 0x3c00,0x3c00,0x3c00,0x3c00,0xbc00,0xae46bbf6,0xb23ebbd9,0xb4a5bba8
.long 0x3c00,0x323e3bd9,0x361f3b64,0x38723aa7,0xbc00,0xb4a5bba8,0xb872baa7,0xba2fb913
.long 0x3c00,0x361f3b64,0x39a839a8,0x3b64361f,0xbc00,0xb78bbb0e,0xbaa7b872,0xbbf6ae46
.long 0x3c00,0x38723aa7,0x3b64361f,0x3bd9b23e,0xbc00,0xb913ba2f,0xbbd9b23e,0xbb0e378b
.long 0x3c00,0x39a839a8,0x3c000000,0x39a8b9a8,0xbc00,0xba2fb913,0xbbd9323e,0xb78b3b0e
.long 0x3c00,0x3aa73872,0x3b64b61f,0x323ebbd9,0xbc00,0xbb0eb78b,0xbaa73872,0x2e463bf6
.long 0x3c00,0x3b64361f,0x39a8b9a8,0xb61fbb64,0xbc00,0xbba8b4a5,0xb8723aa7,0x39133a2f
.long 0x3c00,0x3bd9323e,0x361fbb64,0xbaa7b872,0xbc00,0xbbf6ae46,0xb23e3bd9,0x3ba834a5
.long 0x3c00,0x3c00,0x3c00,0x3c00,0xb61fbb64,0xb78bbb0e,0xb872baa7,0xb913ba2f
.long 0x39a839a8,0x3aa73872,0x3b64361f,0x3bd9323e,0xbb64b61f,0xbbf6ae46,0xbbd9323e,0xbb0e378b
.long 0x3c000000,0x3b64b61f,0x39a8b9a8,0x361fbb64,0xbb64361f,0xb9133a2f,0xb23e3bd9,0x34a53ba8
.long 0x39a8b9a8,0x323ebbd9,0xb61fbb64,0xbaa7b872,0xb61f3b64,0x34a53ba8,0x3aa73872,0x3bf6ae46
.long 0xbc00,0xb9a8b9a8,0xbc008000,0xb9a839a8,0x361f3b64,0x3ba834a5,0x3aa7b872,0x2e46bbf6
.long 0xb9a8b9a8,0xbbd9323e,0xb61f3b64,0x38723aa7,0x3b64361f,0x3a2fb913,0xb23ebbd9,0xbba8b4a5
.long 0xbc008000,0xb61f3b64,0x39a839a8,0x3b64b61f,0x3b64b61f,0xae46bbf6,0xbbd9b23e,0xb78b3b0e
.long 0xb9a839a8,0x38723aa7,0x3b64b61f,0xb23ebbd9,0x361fbb64,0xbb0eb78b,0xb8723aa7,0x3a2f3913
.long 0x3c00,0x3c00,0x3c00,0x3c00,0xb9a8b9a8,0xba2fb913,0xbaa7b872,0xbb0eb78b
.long 0x3c000000,0x3bd9b23e,0x3b64b61f,0x3aa7b872,0xb9a839a8,0xb78b3b0e,0xb23e3bd9,0x2e463bf6
.long 0xbc00,0xb61fbb64,0xb9a8b9a8,0xbb64b61f,0x39a839a8,0x3ba834a5,0x3bd9b23e,0x3a2fb913
.long 0xbc008000,0xbaa73872,0xb61f3b64,0x323e3bd9,0x39a8b9a8,0x2e46bbf6,0xb872baa7,0xbba8b4a5
.long 0x3c00,0x39a839a8,0x3c000000,0x39a8b9a8,0xb9a8b9a8,0xbbf62e46,0xb8723aa7,0x34a53ba8
.long 0x3c000000,0x3872baa7,0xb61fbb64,0xbbd9b23e,0xb9a839a8,0x34a53ba8,0x3bd9323e,0x3913ba2f
.long 0xbc00,0xbb64b61f,0xb9a839a8,0x361f3b64,0x39a839a8,0x3b0eb78b,0xb23ebbd9,0xbbf6ae46
.long 0xbc008000,0xb23e3bd9,0x3b64361f,0x3872baa7,0x39a8b9a8,0xb913ba2f,0xbaa73872,0x378b3b0e
.long 0x3c00,0x3c00,0x3c00,0x3c00,0xbb64b61f,0xbba8b4a5,0xbbd9b23e,0xbbf6ae46
.long 0x39a8b9a8,0x3872baa7,0x361fbb64,0x323ebbd9,0x361f3b64,0x39133a2f,0x3aa73872,0x3ba834a5
.long 0xbc008000,0xbb64361f,0xb9a839a8,0xb61f3b64,0x361fbb64,0xae46bbf6,0xb872baa7,0xbb0eb78b
.long 0x39a839a8,0x3bd9323e,0x3b64b61f,0x3872baa7,0xbb64361f,0xb78b3b0e,0x323e3bd9,0x3a2f3913
.long 0xbc00,0xb9a8b9a8,0xbc008000,0xb9a839a8,0x3b64361f,0x3b0eb78b,0x323ebbd9,0xb913ba2f
.long 0xb9a839a8,0x323e3bd9,0x3b64361f,0x3aa7b872,0xb61fbb64,0xbbf6ae46,0xb8723aa7,0x378b3b0e
.long 0x3c000000,0x361fbb64,0xb9a8b9a8,0xbb64361f,0xb61f3b64,0x3a2f3913,0x3aa7b872,0xb4a5bba8
.long 0xb9a8b9a8,0xbaa73872,0x361f3b64,0x3bd9b23e,0x3b64b61f,0xb4a5bba8,0xbbd9323e,0x2e463bf6
.long 0x3c00,0x3c00,0x3c00,0x3c00,0xbc008000,0xbbf62e46,0xbbd9323e,0xbba834a5
.long 0xbc00,0xb23ebbd9,0xb61fbb64,0xb872baa7,0x3c000000,0x3ba8b4a5,0x3aa7b872,0x3913ba2f
.long 0x3c00,0x361f3b64,0x39a839a8,0x3b64361f,0xbc008000,0xbb0e378b,0xb8723aa7,0xae463bf6
.long 0xbc00,0xb872baa7,0xbb64b61f,0xbbd9323e,0x3c000000,0x3a2fb913,0x323ebbd9,0xb78bbb0e
.long 0x3c00,0x39a839a8,0x3c000000,0x39a8b9a8,0xbc008000,0xb9133a2f,0x323e3bd9,0x3b0e378b
.long 0xbc00,0xbaa7b872,0xbb64361f,0xb23e3bd9,0x3c000000,0x378bbb0e,0xb872baa7,0xbbf62e46
.long 0x3c00,0x3b64361f,0x39a8b9a8,0xb61fbb64,0xbc008000,0xb4a53ba8,0x3aa73872,0x3a2fb913
.long 0xbc00,0xbbd9b23e,0xb61f3b64,0x3aa73872,0x3c000000,0x2e46bbf6,0xbbd9b23e,0xb4a53ba8
.long 0x3c00,0x3c00,0x3c00,0x3c00,0xbb64361f,0xbb0e378b,0xbaa73872,0xba2f3913
.long 0xb9a8b9a8,0xbaa7b872,0xbb64b61f,0xbbd9b23e,0x361fbb64,0x2e46bbf6,0xb23ebbd9,0xb78bbb0e
.long 0x3c000000,0x3b64b61f,0x39a8b9a8,0x361fbb64,0x361f3b64,0x3a2f3913,0x3bd9323e,0x3ba8b4a5
.long 0xb9a839a8,0xb23e3bd9,0x361f3b64,0x3aa73872,0xbb64b61f,0xbba834a5,0xb8723aa7,0x2e463bf6
.long 0xbc00,0xb9a8b9a8,0xbc008000,0xb9a839a8,0x3b64b61f,0x34a5bba8,0xb872baa7,0xbbf6ae46
.long 0x39a839a8,0x3bd9b23e,0x361fbb64,0xb872baa7,0xb61f3b64,0x39133a2f,0x3bd9b23e,0x34a5bba8
.long 0xbc008000,0xb61f3b64,0x39a839a8,0x3b64b61f,0xb61fbb64,0xbbf62e46,0xb23e3bd9,0x3b0e378b
.long 0x39a8b9a8,0xb872baa7,0xbb64361f,0x323e3bd9,0x3b64361f,0x378bbb0e,0xbaa7b872,0xb9133a2f
.long 0x3c00,0x3c00,0x3c00,0x3c00,0xb9a839a8,0xb9133a2f,0xb8723aa7,0xb78b3b0e
.long 0xbc008000,0xbbd9323e,0xbb64361f,0xbaa73872,0xb9a8b9a8,0xbb0eb78b,0xbbd9b23e,0xbbf62e46
.long 0xbc00,0xb61fbb64,0xb9a8b9a8,0xbb64b61f,0x39a8b9a8,0x34a5bba8,0xb23ebbd9,0xb913ba2f
.long 0x3c000000,0x3aa7b872,0x361fbb64,0xb23ebbd9,0x39a839a8,0x3bf62e46,0x3aa7b872,0x34a5bba8
.long 0x3c00,0x39a839a8,0x3c000000,0x39a8b9a8,0xb9a839a8,0x2e463bf6,0x3aa73872,0x3ba8b4a5
.long 0xbc008000,0xb8723aa7,0x361f3b64,0x3bd9323e,0xb9a8b9a8,0xbba834a5,0xb23e3bd9,0x3a2f3913
.long 0xbc00,0xbb64b61f,0xb9a839a8,0x361f3b64,0x39a8b9a8,0xb78bbb0e,0xbbd9323e,0xae463bf6
.long 0x3c000000,0x323ebbd9,0xbb64b61f,0xb8723aa7,0x39a839a8,0x3a2fb913,0xb872baa7,0xbb0e378b
.long 0x3c00,0x3c00,0x3c00,0x3c00,0xb61f3b64,0xb4a53ba8,0xb23e3bd9,0xae463bf6
.long 0xb9a839a8,0xb8723aa7,0xb61f3b64,0xb23e3bd9,0xbb64361f,0xba2f3913,0xb8723aa7,0xb4a53ba8
.long 0xbc008000,0xbb64361f,0xb9a839a8,0xb61f3b64,0xbb64b61f,0xbbf62e46,0xbaa73872,0xb78b3b0e
.long 0xb9a8b9a8,0xbbd9b23e,0xbb64361f,0xb8723aa7,0xb61fbb64,0xbb0eb78b,0xbbd9323e,0xb9133a2f
.long 0xbc00,0xb9a8b9a8,0xbc008000,0xb9a839a8,0x361fbb64,0xb78bbb0e,0xbbd9b23e,0xba2f3913
.long 0x39a8b9a8,0xb23ebbd9,0xbb64b61f,0xbaa73872,0x3b64b61f,0x2e46bbf6,0xbaa7b872,0xbb0e378b
.long 0x3c000000,0x361fbb64,0xb9a8b9a8,0xbb64361f,0x3b64361f,0x3913ba2f,0xb872baa7,0xbba834a5
.long 0x39a839a8,0x3aa7b872,0xb61fbb64,0xbbd9323e,0x361f3b64,0x3ba8b4a5,0xb23ebbd9,0xbbf62e46
.long 0x3c00,0x3c000000,0xbc00,0xbc008000,0x3c00,0x3bf6ae46,0xb23ebbd9,0xbba834a5
.long 0x3c00,0x3bd9b23e,0xb61fbb64,0xbaa73872,0x3c00,0x3ba8b4a5,0xb872baa7,0xb9133a2f
.long 0x3c00,0x3b64b61f,0xb9a8b9a8,0xb61f3b64,0x3c00,0x3b0eb78b,0xbaa7b872,0xae463bf6
.long 0x3c00,0x3aa7b872,0xbb64b61f,0x323e3bd9,0x3c00,0x3a2fb913,0xbbd9b23e,0x378b3b0e
.long 0x3c00,0x39a8b9a8,0xbc008000,0x39a839a8,0x3c00,0x3913ba2f,0xbbd9323e,0x3b0e378b
.long 0x3c00,0x3872baa7,0xbb64361f,0x3bd9323e,0x3c00,0x378bbb0e,0xbaa73872,0x3bf6ae46
.long 0x3c00,0x361fbb64,0xb9a839a8,0x3b64b61f,0x3c00,0x34a5bba8,0xb8723aa7,0x3a2fb913
.long 0x3c00,0x323ebbd9,0xb61f3b64,0x3872baa7,0x3c00,0x2e46bbf6,0xb23e3bd9,0x34a5bba8
.long 0x3c00,0x3c000000,0xbc00,0xbc008000,0x361f3b64,0x3b0eb78b,0xb872baa7,0xba2f3913
.long 0x39a839a8,0x3872baa7,0xbb64b61f,0xb23e3bd9,0x3b64361f,0x2e46bbf6,0xbbd9323e,0x378b3b0e
.long 0x3c000000,0xb61fbb64,0xb9a839a8,0x3b64361f,0x3b64b61f,0xba2fb913,0xb23e3bd9,0x3ba8b4a5
.long 0x39a8b9a8,0xbbd9b23e,0x361f3b64,0x3872baa7,0x361fbb64,0xbba834a5,0x3aa73872,0xae46bbf6
.long 0xbc00,0xb9a839a8,0x3c000000,0xb9a8b9a8,0xb61fbb64,0xb4a53ba8,0x3aa7b872,0xbbf6ae46
.long 0xb9a8b9a8,0x323e3bd9,0x361fbb64,0xbaa73872,0xbb64b61f,0x39133a2f,0xb23ebbd9,0xb4a53ba8
.long 0xbc008000,0x3b64361f,0xb9a8b9a8,0x361f3b64,0xbb64361f,0x3bf6ae46,0xbbd9b23e,0x3b0e378b
.long 0xb9a839a8,0x3aa7b872,0xbb64361f,0x3bd9b23e,0xb61f3b64,0x378bbb0e,0xb8723aa7,0x3913ba2f
.long 0x3c00,0x3c000000,0xbc00,0xbc008000,0x39a839a8,0x3913ba2f,0xbaa7b872,0xb78b3b0e
.long 0x3c000000,0xb23ebbd9,0xbb64361f,0x38723aa7,0x39a8b9a8,0xbb0eb78b,0xb23e3bd9,0x3bf6ae46
.long 0xbc00,0xbb64361f,0x39a839a8,0x361fbb64,0xb9a8b9a8,0xb4a53ba8,0x3bd9b23e,0xb913ba2f
.long 0xbc008000,0x38723aa7,0x361fbb64,0xbbd9323e,0xb9a839a8,0x3bf62e46,0xb872baa7,0xb4a53ba8
.long 0x3c00,0x39a8b9a8,0xbc008000,0x39a839a8,0x39a839a8,0xae46bbf6,0xb8723aa7,0x3ba8b4a5
.long 0x3c000000,0xbaa7b872,0x361f3b64,0x323ebbd9,0x39a8b9a8,0xbba834a5,0x3bd9323e,0xba2fb913
.long 0xbc00,0xb61f3b64,0x39a8b9a8,0xbb64361f,0xb9a8b9a8,0x378b3b0e,0xb23ebbd9,0xae463bf6
.long 0xbc008000,0x3bd9323e,0xbb64b61f,0x3aa73872,0xb9a839a8,0x3a2fb913,0xbaa73872,0x3b0eb78b
.long 0x3c00,0x3c000000,0xbc00,0xbc008000,0x3b64361f,0x34a5bba8,0xbbd9b23e,0xae463bf6
.long 0x39a8b9a8,0xbaa7b872,0xb61f3b64,0x3bd9323e,0xb61fbb64,0xba2f3913,0x3aa73872,0x34a5bba8
.long 0xbc008000,0x361f3b64,0x39a8b9a8,0xbb64b61f,0xb61f3b64,0x3bf6ae46,0xb872baa7,0xb78b3b0e
.long 0x39a839a8,0x323ebbd9,0xbb64361f,0x3aa73872,0x3b64b61f,0xbb0eb78b,0x323e3bd9,0x3913ba2f
.long 0xbc00,0xb9a839a8,0x3c000000,0xb9a8b9a8,0xbb64b61f,0x378b3b0e,0x323ebbd9,0xba2f3913
.long 0xb9a839a8,0x3bd9b23e,0xbb64b61f,0x38723aa7,0x361f3b64,0x2e46bbf6,0xb8723aa7,0x3b0eb78b
.long 0x3c000000,0xbb64b61f,0x39a839a8,0xb61fbb64,0x361fbb64,0xb9133a2f,0x3aa7b872,0xbba834a5
.long 0xb9a8b9a8,0x38723aa7,0xb61fbb64,0x323e3bd9,0xbb64361f,0x3ba8b4a5,0xbbd9323e,0x3bf6ae46
.long 0x3c00,0x3c000000,0xbc00,0xbc008000,0x3c000000,0xae46bbf6,0xbbd9323e,0x34a53ba8
.long 0xbc00,0xbbd9323e,0x361f3b64,0x3aa7b872,0xbc008000,0x34a53ba8,0x3aa7b872,0xba2fb913
.long 0x3c00,0x3b64b61f,0xb9a8b9a8,0xb61f3b64,0x3c000000,0xb78bbb0e,0xb8723aa7,0x3bf62e46
.long 0xbc00,0xbaa73872,0x3b64361f,0xb23ebbd9,0xbc008000,0x39133a2f,0x323ebbd9,0xbb0e378b
.long 0x3c00,0x39a8b9a8,0xbc008000,0x39a839a8,0x3c000000,0xba2fb913,0x323e3bd9,0x378bbb0e
.long 0xbc00,0xb8723aa7,0x3b64b61f,0xbbd9b23e,0xbc008000,0x3b0e378b,0xb872baa7,0x2e463bf6
.long 0x3c00,0x361fbb64,0xb9a839a8,0x3b64b61f,0x3c000000,0xbba8b4a5,0x3aa73872,0xb913ba2f
.long 0xbc00,0xb23e3bd9,0x361fbb64,0xb8723aa7,0xbc008000,0x3bf62e46,0xbbd9b23e,0x3ba834a5
.long 0x3c00,0x3c000000,0xbc00,0xbc008000,0x3b64b61f,0xb78bbb0e,0xbaa73872,0x39133a2f
.long 0xb9a8b9a8,0xb8723aa7,0x3b64361f,0x323ebbd9,0xb61f3b64,0x3bf62e46,0xb23ebbd9,0xbb0e378b
.long 0x3c000000,0xb61fbb64,0xb9a839a8,0x3b64361f,0xb61fbb64,0xb9133a2f,0x3bd9323e,0xb4a5bba8
.long 0xb9a839a8,0x3bd9323e,0xb61fbb64,0xb8723aa7,0x3b64361f,0xb4a5bba8,0xb8723aa7,0x3bf6ae46
.long 0xbc00,0xb9a839a8,0x3c000000,0xb9a8b9a8,0xbb64361f,0x3ba834a5,0xb872baa7,0xae463bf6
.long 0x39a839a8,0xb23ebbd9,0xb61f3b64,0x3aa7b872,0x361fbb64,0xba2f3913,0x3bd9b23e,0xbba8b4a5
.long 0xbc008000,0x3b64361f,0xb9a8b9a8,0x361f3b64,0x361f3b64,0xae46bbf6,0xb23e3bd9,0x378bbb0e
.long 0x39a8b9a8,0xbaa73872,0x3b64b61f,0xbbd9323e,0xbb64b61f,0x3b0e378b,0xbaa7b872,0x3a2f3913
.long 0x3c00,0x3c000000,0xbc00,0xbc008000,0x39a8b9a8,0xba2fb913,0xb8723aa7,0x3b0e378b
.long 0xbc008000,0x323e3bd9,0x3b64b61f,0xb872baa7,0x39a839a8,0x378bbb0e,0xbbd9b23e,0x2e463bf6
.long 0xbc00,0xbb64361f,0x39a839a8,0x361fbb64,0xb9a839a8,0x3ba834a5,0xb23ebbd9,0xba2f3913
.long 0x3c000000,0xb872baa7,0xb61f3b64,0x3bd9b23e,0xb9a8b9a8,0xae463bf6,0x3aa7b872,0xbba8b4a5
.long 0x3c00,0x39a8b9a8,0xbc008000,0x39a839a8,0x39a8b9a8,0xbbf62e46,0x3aa73872,0xb4a5bba8
.long 0xbc008000,0x3aa73872,0xb61fbb64,0xb23e3bd9,0x39a839a8,0xb4a5bba8,0xb23e3bd9,0x3913ba2f
.long 0xbc00,0xb61f3b64,0x39a8b9a8,0xbb64361f,0xb9a839a8,0x3b0eb78b,0xbbd9323e,0x3bf62e46
.long 0x3c000000,0xbbd9b23e,0x3b64361f,0xbaa7b872,0xb9a8b9a8,0x39133a2f,0xb872baa7,0x378b3b0e
.long 0x3c00,0x3c000000,0xbc00,0xbc008000,0x361fbb64,0xbba8b4a5,0xb23e3bd9,0x3bf62e46
.long 0xb9a839a8,0x3aa73872,0x361fbb64,0xbbd9b23e,0x3b64b61f,0xb913ba2f,0xb8723aa7,0x3ba834a5
.long 0xbc008000,0x361f3b64,0x39a8b9a8,0xbb64b61f,0x3b64361f,0xae46bbf6,0xbaa73872,0x3b0e378b
.long 0xb9a8b9a8,0xb23e3bd9,0x3b64b61f,0xbaa7b872,0x361f3b64,0x378bbb0e,0xbbd9323e,0x3a2f3913
.long 0xbc00,0xb9a839a8,0x3c000000,0xb9a8b9a8,0xb61f3b64,0x3b0eb78b,0xbbd9b23e,0x39133a2f
.long 0x39a8b9a8,0xbbd9323e,0x3b64361f,0xb872baa7,0xbb64361f,0x3bf62e46,0xbaa7b872,0x378b3b0e
.long 0x3c000000,0xbb64b61f,0x39a839a8,0xb61fbb64,0xbb64b61f,0x3a2f3913,0xb872baa7,0x34a53ba8
.long 0x39a839a8,0xb872baa7,0x361f3b64,0xb23ebbd9,0xb61fbb64,0x34a53ba8,0xb23ebbd9,0x2e463bf6
.long 0x3c00,0x3c000000,0xbc00,0xbc008000,0xbc00,0xbbf62e46,0x323e3bd9,0x3ba8b4a5
.long 0x3c00,0x3bd9b23e,0xb61fbb64,0xbaa73872,0xbc00,0xbba834a5,0x38723aa7,0x3913ba2f
.long 0x3c00,0x3b64b61f,0xb9a8b9a8,0xb61f3b64,0xbc00,0xbb0e378b,0x3aa73872,0x2e46bbf6
.long 0x3c00,0x3aa7b872,0xbb64b61f,0x323e3bd9,0xbc00,0xba2f3913,0x3bd9323e,0xb78bbb0e
.long 0x3c00,0x39a8b9a8,0xbc008000,0x39a839a8,0xbc00,0xb9133a2f,0x3bd9b23e,0xbb0eb78b
.long 0x3c00,0x3872baa7,0xbb64361f,0x3bd9323e,0xbc00,0xb78b3b0e,0x3aa7b872,0xbbf62e46
.long 0x3c00,0x361fbb64,0xb9a839a8,0x3b64b61f,0xbc00,0xb4a53ba8,0x3872baa7,0xba2f3913
.long 0x3c00,0x323ebbd9,0xb61f3b64,0x3872baa7,0xbc00,0xae463bf6,0x323ebbd9,0xb4a53ba8
.long 0x3c00,0x3c000000,0xbc00,0xbc008000,0xb61fbb64,0xbb0e378b,0x38723aa7,0x3a2fb913
.long 0x39a839a8,0x3872baa7,0xbb64b61f,0xb23e3bd9,0xbb64b61f,0xae463bf6,0x3bd9b23e,0xb78bbb0e
.long 0x3c000000,0xb61fbb64,0xb9a839a8,0x3b64361f,0xbb64361f,0x3a2f3913,0x323ebbd9,0xbba834a5
.long 0x39a8b9a8,0xbbd9b23e,0x361f3b64,0x3872baa7,0xb61f3b64,0x3ba8b4a5,0xbaa7b872,0x2e463bf6
.long 0xbc00,0xb9a839a8,0x3c000000,0xb9a8b9a8,0x361f3b64,0x34a5bba8,0xbaa73872,0x3bf62e46
.long 0xb9a8b9a8,0x323e3bd9,0x361fbb64,0xbaa73872,0x3b64361f,0xb913ba2f,0x323e3bd9,0x34a5bba8
.long 0xbc008000,0x3b64361f,0xb9a8b9a8,0x361f3b64,0x3b64b61f,0xbbf62e46,0x3bd9323e,0xbb0eb78b
.long 0xb9a839a8,0x3aa7b872,0xbb64361f,0x3bd9b23e,0x361fbb64,0xb78b3b0e,0x3872baa7,0xb9133a2f
.long 0x3c00,0x3c000000,0xbc00,0xbc008000,0xb9a8b9a8,0xb9133a2f,0x3aa73872,0x378bbb0e
.long 0x3c000000,0xb23ebbd9,0xbb64361f,0x38723aa7,0xb9a839a8,0x3b0e378b,0x323ebbd9,0xbbf62e46
.long 0xbc00,0xbb64361f,0x39a839a8,0x361fbb64,0x39a839a8,0x34a5bba8,0xbbd9323e,0x39133a2f
.long 0xbc008000,0x38723aa7,0x361fbb64,0xbbd9323e,0x39a8b9a8,0xbbf6ae46,0x38723aa7,0x34a5bba8
.long 0x3c00,0x39a8b9a8,0xbc008000,0x39a839a8,0xb9a8b9a8,0x2e463bf6,0x3872baa7,0xbba834a5
.long 0x3c000000,0xbaa7b872,0x361f3b64,0x323ebbd9,0xb9a839a8,0x3ba8b4a5,0xbbd9b23e,0x3a2f3913
.long 0xbc00,0xb61f3b64,0x39a8b9a8,0xbb64361f,0x39a839a8,0xb78bbb0e,0x323e3bd9,0x2e46bbf6
.long 0xbc008000,0x3bd9323e,0xbb64b61f,0x3aa73872,0x39a8b9a8,0xba2f3913,0x3aa7b872,0xbb0e378b
.long 0x3c00,0x3c000000,0xbc00,0xbc008000,0xbb64b61f,0xb4a53ba8,0x3bd9323e,0x2e46bbf6
.long 0x39a8b9a8,0xbaa7b872,0xb61f3b64,0x3bd9323e,0x361f3b64,0x3a2fb913,0xbaa7b872,0xb4a53ba8
.long 0xbc008000,0x361f3b64,0x39a8b9a8,0xbb64b61f,0x361fbb64,0xbbf62e46,0x38723aa7,0x378bbb0e
.long 0x39a839a8,0x323ebbd9,0xbb64361f,0x3aa73872,0xbb64361f,0x3b0e378b,0xb23ebbd9,0xb9133a2f
.long 0xbc00,0xb9a839a8,0x3c000000,0xb9a8b9a8,0x3b64361f,0xb78bbb0e,0xb23e3bd9,0x3a2fb913
.long 0xb9a839a8,0x3bd9b23e,0xbb64b61f,0x38723aa7,0xb61fbb64,0xae463bf6,0x3872baa7,0xbb0e378b
.long 0x3c000000,0xbb64b61f,0x39a839a8,0xb61fbb64,0xb61f3b64,0x3913ba2f,0xbaa73872,0x3ba8b4a5
.long 0xb9a8b9a8,0x38723aa7,0xb61fbb64,0x323e3bd9,0x3b64b61f,0xbba834a5,0x3bd9b23e,0xbbf62e46
.long 0x3c00,0x3c000000,0xbc00,0xbc008000,0xbc008000,0x2e463bf6,0x3bd9b23e,0xb4a5bba8
.long 0xbc00,0xbbd9323e,0x361f3b64,0x3aa7b872,0x3c000000,0xb4a5bba8,0xbaa73872,0x3a2f3913
.long 0x3c00,0x3b64b61f,0xb9a8b9a8,0xb61f3b64,0xbc008000,0x378b3b0e,0x3872baa7,0xbbf6ae46
.long 0xbc00,0xbaa73872,0x3b64361f,0xb23ebbd9,0x3c000000,0xb913ba2f,0xb23e3bd9,0x3b0eb78b
.long 0x3c00,0x39a8b9a8,0xbc008000,0x39a839a8,0xbc008000,0x3a2f3913,0xb23ebbd9,0xb78b3b0e
.long 0xbc00,0xb8723aa7,0x3b64b61f,0xbbd9b23e,0x3c000000,0xbb0eb78b,0x38723aa7,0xae46bbf6
.long 0x3c00,0x361fbb64,0xb9a839a8,0x3b64b61f,0xbc008000,0x3ba834a5,0xbaa7b872,0x39133a2f
.long 0xbc00,0xb23e3bd9,0x361fbb64,0xb8723aa7,0x3c000000,0xbbf6ae46,0x3bd9323e,0xbba8b4a5
.long 0x3c00,0x3c000000,0xbc00,0xbc008000,0xbb64361f,0x378b3b0e,0x3aa7b872,0xb913ba2f
.long 0xb9a8b9a8,0xb8723aa7,0x3b64361f,0x323ebbd9,0x361fbb64,0xbbf6ae46,0x323e3bd9,0x3b0eb78b
.long 0x3c000000,0xb61fbb64,0xb9a839a8,0x3b64361f,0x361f3b64,0x3913ba2f,0xbbd9b23e,0x34a53ba8
.long 0xb9a839a8,0x3bd9323e,0xb61fbb64,0xb8723aa7,0xbb64b61f,0x34a53ba8,0x3872baa7,0xbbf62e46
.long 0xbc00,0xb9a839a8,0x3c000000,0xb9a8b9a8,0x3b64b61f,0xbba8b4a5,0x38723aa7,0x2e46bbf6
.long 0x39a839a8,0xb23ebbd9,0xb61f3b64,0x3aa7b872,0xb61f3b64,0x3a2fb913,0xbbd9323e,0x3ba834a5
.long 0xbc008000,0x3b64361f,0xb9a8b9a8,0x361f3b64,0xb61fbb64,0x2e463bf6,0x323ebbd9,0xb78b3b0e
.long 0x39a8b9a8,0xbaa73872,0x3b64b61f,0xbbd9323e,0x3b64361f,0xbb0eb78b,0x3aa73872,0xba2fb913
.long 0x3c00,0x3c000000,0xbc00,0xbc008000,0xb9a839a8,0x3a2f3913,0x3872baa7,0xbb0eb78b
.long 0xbc008000,0x323e3bd9,0x3b64b61f,0xb872baa7,0xb9a8b9a8,0xb78b3b0e,0x3bd9323e,0xae46bbf6
.long 0xbc00,0xbb64361f,0x39a839a8,0x361fbb64,0x39a8b9a8,0xbba8b4a5,0x323e3bd9,0x3a2fb913
.long 0x3c000000,0xb872baa7,0xb61f3b64,0x3bd9b23e,0x39a839a8,0x2e46bbf6,0xbaa73872,0x3ba834a5
.long 0x3c00,0x39a8b9a8,0xbc008000,0x39a839a8,0xb9a839a8,0x3bf6ae46,0xbaa7b872,0x34a53ba8
.long 0xbc008000,0x3aa73872,0xb61fbb64,0xb23e3bd9,0xb9a8b9a8,0x34a53ba8,0x323ebbd9,0xb9133a2f
.long 0xbc00,0xb61f3b64,0x39a8b9a8,0xbb64361f,0x39a8b9a8,0xbb0e378b,0x3bd9b23e,0xbbf6ae46
.long 0x3c000000,0xbbd9b23e,0x3b64361f,0xbaa7b872,0x39a839a8,0xb913ba2f,0x38723aa7,0xb78bbb0e
.long 0x3c00,0x3c000000,0xbc00,0xbc008000,0xb61f3b64,0x3ba834a5,0x323ebbd9,0xbbf6ae46
.long 0xb9a839a8,0x3aa73872,0x361fbb64,0xbbd9b23e,0xbb64361f,0x39133a2f,0x3872baa7,0xbba8b4a5
.long 0xbc008000,0x361f3b64,0x39a8b9a8,0xbb64b61f,0xbb64b61f,0x2e463bf6,0x3aa7b872,0xbb0eb78b
.long 0xb9a8b9a8,0xb23e3bd9,0x3b64b61f,0xbaa7b872,0xb61fbb64,0xb78b3b0e,0x3bd9b23e,0xba2fb913
.long 0xbc00,0xb9a839a8,0x3c000000,0xb9a8b9a8,0x361fbb64,0xbb0e378b,0x3bd9323e,0xb913ba2f
.long 0x39a8b9a8,0xbbd9323e,0x3b64361f,0xb872baa7,0x3b64b61f,0xbbf6ae46,0x3aa73872,0xb78bbb0e
.long 0x3c000000,0xbb64b61f,0x39a839a8,0xb61fbb64,0x3b64361f,0xba2fb913,0x38723aa7,0xb4a5bba8
.long 0x39a839a8,0xb872baa7,0x361f3b64,0xb23ebbd9,0x361f3b64,0xb4a5bba8,0x323e3bd9,0xae46bbf6
.long 0x3c00,0xbc00,0x3c00,0xbc00,0x3c00,0xae46bbf6,0x323e3bd9,0xb4a5bba8
.long 0x3c00,0xb23ebbd9,0x361f3b64,0xb872baa7,0x3c00,0xb4a5bba8,0x38723aa7,0xba2fb913
.long 0x3c00,0xb61fbb64,0x39a839a8,0xbb64b61f,0x3c00,0xb78bbb0e,0x3aa73872,0xbbf6ae46
.long 0x3c00,0xb872baa7,0x3b64361f,0xbbd9323e,0x3c00,0xb913ba2f,0x3bd9323e,0xbb0e378b
.long 0x3c00,0xb9a8b9a8,0x3c000000,0xb9a839a8,0x3c00,0xba2fb913,0x3bd9b23e,0xb78b3b0e
.long 0x3c00,0xbaa7b872,0x3b64b61f,0xb23e3bd9,0x3c00,0xbb0eb78b,0x3aa7b872,0x2e463bf6
.long 0x3c00,0xbb64b61f,0x39a8b9a8,0x361f3b64,0x3c00,0xbba8b4a5,0x3872baa7,0x39133a2f
.long 0x3c00,0xbbd9b23e,0x361fbb64,0x3aa73872,0x3c00,0xbbf6ae46,0x323ebbd9,0x3ba834a5
.long 0x3c00,0xbc00,0x3c00,0xbc00,0x361f3b64,0xb78bbb0e,0x38723aa7,0xb913ba2f
.long 0x39a839a8,0xbaa7b872,0x3b64361f,0xbbd9b23e,0x3b64361f,0xbbf6ae46,0x3bd9b23e,0xbb0e378b
.long 0x3c000000,0xbb64361f,0x39a8b9a8,0xb61f3b64,0x3b64b61f,0xb9133a2f,0x323ebbd9,0x34a53ba8
.long 0x39a8b9a8,0xb23e3bd9,0xb61fbb64,0x3aa73872,0x361fbb64,0x34a53ba8,0xbaa7b872,0x3bf6ae46
.long 0xbc00,0x39a839a8,0xbc008000,0x39a8b9a8,0xb61fbb64,0x3ba834a5,0xbaa73872,0x2e46bbf6
.long 0xb9a8b9a8,0x3bd9b23e,0xb61f3b64,0xb872baa7,0xbb64b61f,0x3a2fb913,0x323e3bd9,0xbba8b4a5
.long 0xbc008000,0x361fbb64,0x39a839a8,0xbb64361f,0xbb64361f,0xae46bbf6,0x3bd9323e,0xb78b3b0e
.long 0xb9a839a8,0xb872baa7,0x3b64b61f,0x323e3bd9,0xb61f3b64,0xbb0eb78b,0x3872baa7,0x3a2f3913
.long 0x3c00,0xbc00,0x3c00,0xbc00,0x39a839a8,0xba2fb913,0x3aa73872,0xbb0eb78b
.long 0x3c000000,0xbbd9323e,0x3b64b61f,0xbaa73872,0x39a8b9a8,0xb78b3b0e,0x323ebbd9,0x2e463bf6
.long 0xbc00,0x361f3b64,0xb9a8b9a8,0x3b64361f,0xb9a8b9a8,0x3ba834a5,0xbbd9323e,0x3a2fb913
.long 0xbc008000,0x3aa7b872,0xb61f3b64,0xb23ebbd9,0xb9a839a8,0x2e46bbf6,0x38723aa7,0xbba8b4a5
.long 0x3c00,0xb9a8b9a8,0x3c000000,0xb9a839a8,0x39a839a8,0xbbf62e46,0x3872baa7,0x34a53ba8
.long 0x3c000000,0xb8723aa7,0xb61fbb64,0x3bd9323e,0x39a8b9a8,0x34a53ba8,0xbbd9b23e,0x3913ba2f
.long 0xbc00,0x3b64361f,0xb9a839a8,0xb61fbb64,0xb9a8b9a8,0x3b0eb78b,0x323e3bd9,0xbbf6ae46
.long 0xbc008000,0x323ebbd9,0x3b64361f,0xb8723aa7,0xb9a839a8,0xb913ba2f,0x3aa7b872,0x378b3b0e
.long 0x3c00,0xbc00,0x3c00,0xbc00,0x3b64361f,0xbba8b4a5,0x3bd9323e,0xbbf6ae46
.long 0x39a8b9a8,0xb8723aa7,0x361fbb64,0xb23e3bd9,0xb61fbb64,0x39133a2f,0xbaa7b872,0x3ba834a5
.long 0xbc008000,0x3b64b61f,0xb9a839a8,0x361fbb64,0xb61f3b64,0xae46bbf6,0x38723aa7,0xbb0eb78b
.long 0x39a839a8,0xbbd9b23e,0x3b64b61f,0xb8723aa7,0x3b64b61f,0xb78b3b0e,0xb23ebbd9,0x3a2f3913
.long 0xbc00,0x39a839a8,0xbc008000,0x39a8b9a8,0xbb64b61f,0x3b0eb78b,0xb23e3bd9,0xb913ba2f
.long 0xb9a839a8,0xb23ebbd9,0x3b64361f,0xbaa73872,0x361f3b64,0xbbf6ae46,0x3872baa7,0x378b3b0e
.long 0x3c000000,0xb61f3b64,0xb9a8b9a8,0x3b64b61f,0x361fbb64,0x3a2f3913,0xbaa73872,0xb4a5bba8
.long 0xb9a8b9a8,0x3aa7b872,0x361f3b64,0xbbd9323e,0xbb64361f,0xb4a5bba8,0x3bd9b23e,0x2e463bf6
.long 0x3c00,0xbc00,0x3c00,0xbc00,0x3c000000,0xbbf62e46,0x3bd9b23e,0xbba834a5
.long 0xbc00,0x323e3bd9,0xb61fbb64,0x38723aa7,0xbc008000,0x3ba8b4a5,0xbaa73872,0x3913ba2f
.long 0x3c00,0xb61fbb64,0x39a839a8,0xbb64b61f,0x3c000000,0xbb0e378b,0x3872baa7,0xae463bf6
.long 0xbc00,0x38723aa7,0xbb64b61f,0x3bd9b23e,0xbc008000,0x3a2fb913,0xb23e3bd9,0xb78bbb0e
.long 0x3c00,0xb9a8b9a8,0x3c000000,0xb9a839a8,0x3c000000,0xb9133a2f,0xb23ebbd9,0x3b0e378b
.long 0xbc00,0x3aa73872,0xbb64361f,0x323ebbd9,0xbc008000,0x378bbb0e,0x38723aa7,0xbbf62e46
.long 0x3c00,0xbb64b61f,0x39a8b9a8,0x361f3b64,0x3c000000,0xb4a53ba8,0xbaa7b872,0x3a2fb913
.long 0xbc00,0x3bd9323e,0xb61f3b64,0xbaa7b872,0xbc008000,0x2e46bbf6,0x3bd9323e,0xb4a53ba8
.long 0x3c00,0xbc00,0x3c00,0xbc00,0x3b64b61f,0xbb0e378b,0x3aa7b872,0xba2f3913
.long 0xb9a8b9a8,0x3aa73872,0xbb64b61f,0x3bd9323e,0xb61f3b64,0x2e46bbf6,0x323e3bd9,0xb78bbb0e
.long 0x3c000000,0xbb64361f,0x39a8b9a8,0xb61f3b64,0xb61fbb64,0x3a2f3913,0xbbd9b23e,0x3ba8b4a5
.long 0xb9a839a8,0x323ebbd9,0x361f3b64,0xbaa7b872,0x3b64361f,0xbba834a5,0x3872baa7,0x2e463bf6
.long 0xbc00,0x39a839a8,0xbc008000,0x39a8b9a8,0xbb64361f,0x34a5bba8,0x38723aa7,0xbbf6ae46
.long 0x39a839a8,0xbbd9323e,0x361fbb64,0x38723aa7,0x361fbb64,0x39133a2f,0xbbd9323e,0x34a5bba8
.long 0xbc008000,0x361fbb64,0x39a839a8,0xbb64361f,0x361f3b64,0xbbf62e46,0x323ebbd9,0x3b0e378b
.long 0x39a8b9a8,0x38723aa7,0xbb64361f,0xb23ebbd9,0xbb64b61f,0x378bbb0e,0x3aa73872,0xb9133a2f
.long 0x3c00,0xbc00,0x3c00,0xbc00,0x39a8b9a8,0xb9133a2f,0x3872baa7,0xb78b3b0e
.long 0xbc008000,0x3bd9b23e,0xbb64361f,0x3aa7b872,0x39a839a8,0xbb0eb78b,0x3bd9323e,0xbbf62e46
.long 0xbc00,0x361f3b64,0xb9a8b9a8,0x3b64361f,0xb9a839a8,0x34a5bba8,0x323e3bd9,0xb913ba2f
.long 0x3c000000,0xbaa73872,0x361fbb64,0x323e3bd9,0xb9a8b9a8,0x3bf62e46,0xbaa73872,0x34a5bba8
.long 0x3c00,0xb9a8b9a8,0x3c000000,0xb9a839a8,0x39a8b9a8,0x2e463bf6,0xbaa7b872,0x3ba8b4a5
.long 0xbc008000,0x3872baa7,0x361f3b64,0xbbd9b23e,0x39a839a8,0xbba834a5,0x323ebbd9,0x3a2f3913
.long 0xbc00,0x3b64361f,0xb9a839a8,0xb61fbb64,0xb9a839a8,0xb78bbb0e,0x3bd9b23e,0xae463bf6
.long 0x3c000000,0xb23e3bd9,0xbb64b61f,0x3872baa7,0xb9a8b9a8,0x3a2fb913,0x38723aa7,0xbb0e378b
.long 0x3c00,0xbc00,0x3c00,0xbc00,0x361fbb64,0xb4a53ba8,0x323ebbd9,0xae463bf6
.long 0xb9a839a8,0x3872baa7,0xb61f3b64,0x323ebbd9,0x3b64b61f,0xba2f3913,0x3872baa7,0xb4a53ba8
.long 0xbc008000,0x3b64b61f,0xb9a839a8,0x361fbb64,0x3b64361f,0xbbf62e46,0x3aa7b872,0xb78b3b0e
.long 0xb9a8b9a8,0x3bd9323e,0xbb64361f,0x3872baa7,0x361f3b64,0xbb0eb78b,0x3bd9b23e,0xb9133a2f
.long 0xbc00,0x39a839a8,0xbc008000,0x39a8b9a8,0xb61f3b64,0xb78bbb0e,0x3bd9323e,0xba2f3913
.long 0x39a8b9a8,0x323e3bd9,0xbb64b61f,0x3aa7b872,0xbb64361f,0x2e46bbf6,0x3aa73872,0xbb0e378b
.long 0x3c000000,0xb61f3b64,0xb9a8b9a8,0x3b64b61f,0xbb64b61f,0x3913ba2f,0x38723aa7,0xbba834a5
.long 0x39a839a8,0xbaa73872,0xb61fbb64,0x3bd9b23e,0xb61fbb64,0x3ba8b4a5,0x323e3bd9,0xbbf62e46
.long 0x3c00,0xbc00,0x3c00,0xbc00,0xbc00,0x2e463bf6,0xb23ebbd9,0x34a53ba8
.long 0x3c00,0xb23ebbd9,0x361f3b64,0xb872baa7,0xbc00,0x34a53ba8,0xb872baa7,0x3a2f3913
.long 0x3c00,0xb61fbb64,0x39a839a8,0xbb64b61f,0xbc00,0x378b3b0e,0xbaa7b872,0x3bf62e46
.long 0x3c00,0xb872baa7,0x3b64361f,0xbbd9323e,0xbc00,0x39133a2f,0xbbd9b23e,0x3b0eb78b
.long 0x3c00,0xb9a8b9a8,0x3c000000,0xb9a839a8,0xbc00,0x3a2f3913,0xbbd9323e,0x378bbb0e
.long 0x3c00,0xbaa7b872,0x3b64b61f,0xb23e3bd9,0xbc00,0x3b0e378b,0xbaa73872,0xae46bbf6
.long 0x3c00,0xbb64b61f,0x39a8b9a8,0x361f3b64,0xbc00,0x3ba834a5,0xb8723aa7,0xb913ba2f
.long 0x3c00,0xbbd9b23e,0x361fbb64,0x3aa73872,0xbc00,0x3bf62e46,0xb23e3bd9,0xbba8b4a5
.long 0x3c00,0xbc00,0x3c00,0xbc00,0xb61fbb64,0x378b3b0e,0xb872baa7,0x39133a2f
.long 0x39a839a8,0xbaa7b872,0x3b64361f,0xbbd9b23e,0xbb64b61f,0x3bf62e46,0xbbd9323e,0x3b0eb78b
.long 0x3c000000,0xbb64361f,0x39a8b9a8,0xb61f3b64,0xbb64361f,0x3913ba2f,0xb23e3bd9,0xb4a5bba8
.long 0x39a8b9a8,0xb23e3bd9,0xb61fbb64,0x3aa73872,0xb61f3b64,0xb4a5bba8,0x3aa73872,0xbbf62e46
.long 0xbc00,0x39a839a8,0xbc008000,0x39a8b9a8,0x361f3b64,0xbba8b4a5,0x3aa7b872,0xae463bf6
.long 0xb9a8b9a8,0x3bd9b23e,0xb61f3b64,0xb872baa7,0x3b64361f,0xba2f3913,0xb23ebbd9,0x3ba834a5
.long 0xbc008000,0x361fbb64,0x39a839a8,0xbb64361f,0x3b64b61f,0x2e463bf6,0xbbd9b23e,0x378bbb0e
.long 0xb9a839a8,0xb872baa7,0x3b64b61f,0x323e3bd9,0x361fbb64,0x3b0e378b,0xb8723aa7,0xba2fb913
.long 0x3c00,0xbc00,0x3c00,0xbc00,0xb9a8b9a8,0x3a2f3913,0xbaa7b872,0x3b0e378b
.long 0x3c000000,0xbbd9323e,0x3b64b61f,0xbaa73872,0xb9a839a8,0x378bbb0e,0xb23e3bd9,0xae46bbf6
.long 0xbc00,0x361f3b64,0xb9a8b9a8,0x3b64361f,0x39a839a8,0xbba8b4a5,0x3bd9b23e,0xba2f3913
.long 0xbc008000,0x3aa7b872,0xb61f3b64,0xb23ebbd9,0x39a8b9a8,0xae463bf6,0xb872baa7,0x3ba834a5
.long 0x3c00,0xb9a8b9a8,0x3c000000,0xb9a839a8,0xb9a8b9a8,0x3bf6ae46,0xb8723aa7,0xb4a5bba8
.long 0x3c000000,0xb8723aa7,0xb61fbb64,0x3bd9323e,0xb9a839a8,0xb4a5bba8,0x3bd9323e,0xb9133a2f
.long 0xbc00,0x3b64361f,0xb9a839a8,0xb61fbb64,0x39a839a8,0xbb0e378b,0xb23ebbd9,0x3bf62e46
.long 0xbc008000,0x323ebbd9,0x3b64361f,0xb8723aa7,0x39a8b9a8,0x39133a2f,0xbaa73872,0xb78bbb0e
.long 0x3c00,0xbc00,0x3c00,0xbc00,0xbb64b61f,0x3ba834a5,0xbbd9b23e,0x3bf62e46
.long 0x39a8b9a8,0xb8723aa7,0x361fbb64,0xb23e3bd9,0x361f3b64,0xb913ba2f,0x3aa73872,0xbba8b4a5
.long 0xbc008000,0x3b64b61f,0xb9a839a8,0x361fbb64,0x361fbb64,0x2e463bf6,0xb872baa7,0x3b0e378b
.long 0x39a839a8,0xbbd9b23e,0x3b64b61f,0xb8723aa7,0xbb64361f,0x378bbb0e,0x323e3bd9,0xba2fb913
.long 0xbc00,0x39a839a8,0xbc008000,0x39a8b9a8,0x3b64361f,0xbb0e378b,0x323ebbd9,0x39133a2f
.long 0xb9a839a8,0xb23ebbd9,0x3b64361f,0xbaa73872,0xb61fbb64,0x3bf62e46,0xb8723aa7,0xb78bbb0e
.long 0x3c000000,0xb61f3b64,0xb9a8b9a8,0x3b64b61f,0xb61f3b64,0xba2fb913,0x3aa7b872,0x34a53ba8
.long 0xb9a8b9a8,0x3aa7b872,0x361f3b64,0xbbd9323e,0x3b64b61f,0x34a53ba8,0xbbd9323e,0xae46bbf6
.long 0x3c00,0xbc00,0x3c00,0xbc00,0xbc008000,0x3bf6ae46,0xbbd9323e,0x3ba8b4a5
.long 0xbc00,0x323e3bd9,0xb61fbb64,0x38723aa7,0x3c000000,0xbba834a5,0x3aa7b872,0xb9133a2f
.long 0x3c00,0xb61fbb64,0x39a839a8,0xbb64b61f,0xbc008000,0x3b0eb78b,0xb8723aa7,0x2e46bbf6
.long 0xbc00,0x38723aa7,0xbb64b61f,0x3bd9b23e,0x3c000000,0xba2f3913,0x323ebbd9,0x378b3b0e
.long 0x3c00,0xb9a8b9a8,0x3c000000,0xb9a839a8,0xbc008000,0x3913ba2f,0x323e3bd9,0xbb0eb78b
.long 0xbc00,0x3aa73872,0xbb64361f,0x323ebbd9,0x3c000000,0xb78b3b0e,0xb872baa7,0x3bf6ae46
.long 0x3c00,0xbb64b61f,0x39a8b9a8,0x361f3b64,0xbc008000,0x34a5bba8,0x3aa73872,0xba2f3913
.long 0xbc00,0x3bd9323e,0xb61f3b64,0xbaa7b872,0x3c000000,0xae463bf6,0xbbd9b23e,0x34a5bba8
.long 0x3c00,0xbc00,0x3c00,0xbc00,0xbb64361f,0x3b0eb78b,0xbaa73872,0x3a2fb913
.long 0xb9a8b9a8,0x3aa73872,0xbb64b61f,0x3bd9323e,0x361fbb64,0xae463bf6,0xb23ebbd9,0x378b3b0e
.long 0x3c000000,0xbb64361f,0x39a8b9a8,0xb61f3b64,0x361f3b64,0xba2fb913,0x3bd9323e,0xbba834a5
.long 0xb9a839a8,0x323ebbd9,0x361f3b64,0xbaa7b872,0xbb64b61f,0x3ba8b4a5,0xb8723aa7,0xae46bbf6
.long 0xbc00,0x39a839a8,0xbc008000,0x39a8b9a8,0x3b64b61f,0xb4a53ba8,0xb872baa7,0x3bf62e46
.long 0x39a839a8,0xbbd9323e,0x361fbb64,0x38723aa7,0xb61f3b64,0xb913ba2f,0x3bd9b23e,0xb4a53ba8
.long 0xbc008000,0x361fbb64,0x39a839a8,0xbb64361f,0xb61fbb64,0x3bf6ae46,0xb23e3bd9,0xbb0eb78b
.long 0x39a8b9a8,0x38723aa7,0xbb64361f,0xb23ebbd9,0x3b64361f,0xb78b3b0e,0xbaa7b872,0x3913ba2f
.long 0x3c00,0xbc00,0x3c00,0xbc00,0xb9a839a8,0x3913ba2f,0xb8723aa7,0x378bbb0e
.long 0xbc008000,0x3bd9b23e,0xbb64361f,0x3aa7b872,0xb9a8b9a8,0x3b0e378b,0xbbd9b23e,0x3bf6ae46
.long 0xbc00,0x361f3b64,0xb9a8b9a8,0x3b64361f,0x39a8b9a8,0xb4a53ba8,0xb23ebbd9,0x39133a2f
.long 0x3c000000,0xbaa73872,0x361fbb64,0x323e3bd9,0x39a839a8,0xbbf6ae46,0x3aa7b872,0xb4a53ba8
.long 0x3c00,0xb9a8b9a8,0x3c000000,0xb9a839a8,0xb9a839a8,0xae46bbf6,0x3aa73872,0xbba834a5
.long 0xbc008000,0x3872baa7,0x361f3b64,0xbbd9b23e,0xb9a8b9a8,0x3ba8b4a5,0xb23e3bd9,0xba2fb913
.long 0xbc00,0x3b64361f,0xb9a839a8,0xb61fbb64,0x39a8b9a8,0x378b3b0e,0xbbd9323e,0x2e46bbf6
.long 0x3c000000,0xb23e3bd9,0xbb64b61f,0x3872baa7,0x39a839a8,0xba2f3913,0xb872baa7,0x3b0eb78b
.long 0x3c00,0xbc00,0x3c00,0xbc00,0xb61f3b64,0x34a5bba8,0xb23e3bd9,0x2e46bbf6
.long 0xb9a839a8,0x3872baa7,0xb61f3b64,0x323ebbd9,0xbb64361f,0x3a2fb913,0xb8723aa7,0x34a5bba8
.long 0xbc008000,0x3b64b61f,0xb9a839a8,0x361fbb64,0xbb64b61f,0x3bf6ae46,0xbaa73872,0x378bbb0e
.long 0xb9a8b9a8,0x3bd9323e,0xbb64361f,0x3872baa7,0xb61fbb64,0x3b0e378b,0xbbd9323e,0x3913ba2f
.long 0xbc00,0x39a839a8,0xbc008000,0x39a8b9a8,0x361fbb64,0x378b3b0e,0xbbd9b23e,0x3a2fb913
.long 0x39a8b9a8,0x323e3bd9,0xbb64b61f,0x3aa7b872,0x3b64b61f,0xae463bf6,0xbaa7b872,0x3b0eb78b
.long 0x3c000000,0xb61f3b64,0xb9a8b9a8,0x3b64b61f,0x3b64361f,0xb9133a2f,0xb872baa7,0x3ba8b4a5
.long 0x39a839a8,0xbaa73872,0xb61fbb64,0x3bd9b23e,0x361f3b64,0xbba834a5,0xb23ebbd9,0x3bf6ae46
.long 0x3c00,0xbc008000,0xbc00,0x3c000000,0x3c00,0xbbf62e46,0xb23ebbd9,0x3ba8b4a5
.long 0x3c00,0xbbd9323e,0xb61fbb64,0x3aa7b872,0x3c00,0xbba834a5,0xb872baa7,0x3913ba2f
.long 0x3c00,0xbb64361f,0xb9a8b9a8,0x361fbb64,0x3c00,0xbb0e378b,0xbaa7b872,0x2e46bbf6
.long 0x3c00,0xbaa73872,0xbb64b61f,0xb23ebbd9,0x3c00,0xba2f3913,0xbbd9b23e,0xb78bbb0e
.long 0x3c00,0xb9a839a8,0xbc008000,0xb9a8b9a8,0x3c00,0xb9133a2f,0xbbd9323e,0xbb0eb78b
.long 0x3c00,0xb8723aa7,0xbb64361f,0xbbd9b23e,0x3c00,0xb78b3b0e,0xbaa73872,0xbbf62e46
.long 0x3c00,0xb61f3b64,0xb9a839a8,0xbb64361f,0x3c00,0xb4a53ba8,0xb8723aa7,0xba2f3913
.long 0x3c00,0xb23e3bd9,0xb61f3b64,0xb8723aa7,0x3c00,0xae463bf6,0xb23e3bd9,0xb4a53ba8
.long 0x3c00,0xbc008000,0xbc00,0x3c000000,0x361f3b64,0xbb0e378b,0xb872baa7,0x3a2fb913
.long 0x39a839a8,0xb8723aa7,0xbb64b61f,0x323ebbd9,0x3b64361f,0xae463bf6,0xbbd9323e,0xb78bbb0e
.long 0x3c000000,0x361f3b64,0xb9a839a8,0xbb64b61f,0x3b64b61f,0x3a2f3913,0xb23e3bd9,0xbba834a5
.long 0x39a8b9a8,0x3bd9323e,0x361f3b64,0xb8723aa7,0x361fbb64,0x3ba8b4a5,0x3aa73872,0x2e463bf6
.long 0xbc00,0x39a8b9a8,0x3c000000,0x39a839a8,0xb61fbb64,0x34a5bba8,0x3aa7b872,0x3bf62e46
.long 0xb9a8b9a8,0xb23ebbd9,0x361fbb64,0x3aa7b872,0xbb64b61f,0xb913ba2f,0xb23ebbd9,0x34a5bba8
.long 0xbc008000,0xbb64b61f,0xb9a8b9a8,0xb61fbb64,0xbb64361f,0xbbf62e46,0xbbd9b23e,0xbb0eb78b
.long 0xb9a839a8,0xbaa73872,0xbb64361f,0xbbd9323e,0xb61f3b64,0xb78b3b0e,0xb8723aa7,0xb9133a2f
.long 0x3c00,0xbc008000,0xbc00,0x3c000000,0x39a839a8,0xb9133a2f,0xbaa7b872,0x378bbb0e
.long 0x3c000000,0x323e3bd9,0xbb64361f,0xb872baa7,0x39a8b9a8,0x3b0e378b,0xb23e3bd9,0xbbf62e46
.long 0xbc00,0x3b64b61f,0x39a839a8,0xb61f3b64,0xb9a8b9a8,0x34a5bba8,0x3bd9b23e,0x39133a2f
.long 0xbc008000,0xb872baa7,0x361fbb64,0x3bd9b23e,0xb9a839a8,0xbbf6ae46,0xb872baa7,0x34a5bba8
.long 0x3c00,0xb9a839a8,0xbc008000,0xb9a8b9a8,0x39a839a8,0x2e463bf6,0xb8723aa7,0xbba834a5
.long 0x3c000000,0x3aa73872,0x361f3b64,0xb23e3bd9,0x39a8b9a8,0x3ba8b4a5,0x3bd9323e,0x3a2f3913
.long 0xbc00,0x361fbb64,0x39a8b9a8,0x3b64b61f,0xb9a8b9a8,0xb78bbb0e,0xb23ebbd9,0x2e46bbf6
.long 0xbc008000,0xbbd9b23e,0xbb64b61f,0xbaa7b872,0xb9a839a8,0xba2f3913,0xbaa73872,0xbb0e378b
.long 0x3c00,0xbc008000,0xbc00,0x3c000000,0x3b64361f,0xb4a53ba8,0xbbd9b23e,0x2e46bbf6
.long 0x39a8b9a8,0x3aa73872,0xb61f3b64,0xbbd9b23e,0xb61fbb64,0x3a2fb913,0x3aa73872,0xb4a53ba8
.long 0xbc008000,0xb61fbb64,0x39a8b9a8,0x3b64361f,0xb61f3b64,0xbbf62e46,0xb872baa7,0x378bbb0e
.long 0x39a839a8,0xb23e3bd9,0xbb64361f,0xbaa7b872,0x3b64b61f,0x3b0e378b,0x323e3bd9,0xb9133a2f
.long 0xbc00,0x39a8b9a8,0x3c000000,0x39a839a8,0xbb64b61f,0xb78bbb0e,0x323ebbd9,0x3a2fb913
.long 0xb9a839a8,0xbbd9323e,0xbb64b61f,0xb872baa7,0x361f3b64,0xae463bf6,0xb8723aa7,0xbb0e378b
.long 0x3c000000,0x3b64361f,0x39a839a8,0x361f3b64,0x361fbb64,0x3913ba2f,0x3aa7b872,0x3ba8b4a5
.long 0xb9a8b9a8,0xb872baa7,0xb61fbb64,0xb23ebbd9,0xbb64361f,0xbba834a5,0xbbd9323e,0xbbf62e46
.long 0x3c00,0xbc008000,0xbc00,0x3c000000,0x3c000000,0x2e463bf6,0xbbd9323e,0xb4a5bba8
.long 0xbc00,0x3bd9b23e,0x361f3b64,0xbaa73872,0xbc008000,0xb4a5bba8,0x3aa7b872,0x3a2f3913
.long 0x3c00,0xbb64361f,0xb9a8b9a8,0x361fbb64,0x3c000000,0x378b3b0e,0xb8723aa7,0xbbf6ae46
.long 0xbc00,0x3aa7b872,0x3b64361f,0x323e3bd9,0xbc008000,0xb913ba2f,0x323ebbd9,0x3b0eb78b
.long 0x3c00,0xb9a839a8,0xbc008000,0xb9a8b9a8,0x3c000000,0x3a2f3913,0x323e3bd9,0xb78b3b0e
.long 0xbc00,0x3872baa7,0x3b64b61f,0x3bd9323e,0xbc008000,0xbb0eb78b,0xb872baa7,0xae46bbf6
.long 0x3c00,0xb61f3b64,0xb9a839a8,0xbb64361f,0x3c000000,0x3ba834a5,0x3aa73872,0x39133a2f
.long 0xbc00,0x323ebbd9,0x361fbb64,0x3872baa7,0xbc008000,0xbbf6ae46,0xbbd9b23e,0xbba8b4a5
.long 0x3c00,0xbc008000,0xbc00,0x3c000000,0x3b64b61f,0x378b3b0e,0xbaa73872,0xb913ba2f
.long 0xb9a8b9a8,0x3872baa7,0x3b64361f,0xb23e3bd9,0xb61f3b64,0xbbf6ae46,0xb23ebbd9,0x3b0eb78b
.long 0x3c000000,0x361f3b64,0xb9a839a8,0xbb64b61f,0xb61fbb64,0x3913ba2f,0x3bd9323e,0x34a53ba8
.long 0xb9a839a8,0xbbd9b23e,0xb61fbb64,0x3872baa7,0x3b64361f,0x34a53ba8,0xb8723aa7,0xbbf62e46
.long 0xbc00,0x39a8b9a8,0x3c000000,0x39a839a8,0xbb64361f,0xbba8b4a5,0xb872baa7,0x2e46bbf6
.long 0x39a839a8,0x323e3bd9,0xb61f3b64,0xbaa73872,0x361fbb64,0x3a2fb913,0x3bd9b23e,0x3ba834a5
.long 0xbc008000,0xbb64b61f,0xb9a8b9a8,0xb61fbb64,0x361f3b64,0x2e463bf6,0xb23e3bd9,0xb78b3b0e
.long 0x39a8b9a8,0x3aa7b872,0x3b64b61f,0x3bd9b23e,0xbb64b61f,0xbb0eb78b,0xbaa7b872,0xba2fb913
.long 0x3c00,0xbc008000,0xbc00,0x3c000000,0x39a8b9a8,0x3a2f3913,0xb8723aa7,0xbb0eb78b
.long 0xbc008000,0xb23ebbd9,0x3b64b61f,0x38723aa7,0x39a839a8,0xb78b3b0e,0xbbd9b23e,0xae46bbf6
.long 0xbc00,0x3b64b61f,0x39a839a8,0xb61f3b64,0xb9a839a8,0xbba8b4a5,0xb23ebbd9,0x3a2fb913
.long 0x3c000000,0x38723aa7,0xb61f3b64,0xbbd9323e,0xb9a8b9a8,0x2e46bbf6,0x3aa7b872,0x3ba834a5
.long 0x3c00,0xb9a839a8,0xbc008000,0xb9a8b9a8,0x39a8b9a8,0x3bf6ae46,0x3aa73872,0x34a53ba8
.long 0xbc008000,0xbaa7b872,0xb61fbb64,0x323ebbd9,0x39a839a8,0x34a53ba8,0xb23e3bd9,0xb9133a2f
.long 0xbc00,0x361fbb64,0x39a8b9a8,0x3b64b61f,0xb9a839a8,0xbb0e378b,0xbbd9323e,0xbbf6ae46
.long 0x3c000000,0x3bd9323e,0x3b64361f,0x3aa73872,0xb9a8b9a8,0xb913ba2f,0xb872baa7,0xb78bbb0e
.long 0x3c00,0xbc008000,0xbc00,0x3c000000,0x361fbb64,0x3ba834a5,0xb23e3bd9,0xbbf6ae46
.long 0xb9a839a8,0xbaa7b872,0x361fbb64,0x3bd9323e,0x3b64b61f,0x39133a2f,0xb8723aa7,0xbba8b4a5
.long 0xbc008000,0xb61fbb64,0x39a8b9a8,0x3b64361f,0x3b64361f,0x2e463bf6,0xbaa73872,0xbb0eb78b
.long 0xb9a8b9a8,0x323ebbd9,0x3b64b61f,0x3aa73872,0x361f3b64,0xb78b3b0e,0xbbd9323e,0xba2fb913
.long 0xbc00,0x39a8b9a8,0x3c000000,0x39a839a8,0xb61f3b64,0xbb0e378b,0xbbd9b23e,0xb913ba2f
.long 0x39a8b9a8,0x3bd9b23e,0x3b64361f,0x38723aa7,0xbb64361f,0xbbf6ae46,0xbaa7b872,0xb78bbb0e
.long 0x3c000000,0x3b64361f,0x39a839a8,0x361f3b64,0xbb64b61f,0xba2fb913,0xb872baa7,0xb4a5bba8
.long 0x39a839a8,0x38723aa7,0x361f3b64,0x323e3bd9,0xb61fbb64,0xb4a5bba8,0xb23ebbd9,0xae46bbf6
.long 0x3c00,0xbc008000,0xbc00,0x3c000000,0xbc00,0x3bf6ae46,0x323e3bd9,0xbba834a5
.long 0x3c00,0xbbd9323e,0xb61fbb64,0x3aa7b872,0xbc00,0x3ba8b4a5,0x38723aa7,0xb9133a2f
.long 0x3c00,0xbb64361f,0xb9a8b9a8,0x361fbb64,0xbc00,0x3b0eb78b,0x3aa73872,0xae463bf6
.long 0x3c00,0xbaa73872,0xbb64b61f,0xb23ebbd9,0xbc00,0x3a2fb913,0x3bd9323e,0x378b3b0e
.long 0x3c00,0xb9a839a8,0xbc008000,0xb9a8b9a8,0xbc00,0x3913ba2f,0x3bd9b23e,0x3b0e378b
.long 0x3c00,0xb8723aa7,0xbb64361f,0xbbd9b23e,0xbc00,0x378bbb0e,0x3aa7b872,0x3bf6ae46
.long 0x3c00,0xb61f3b64,0xb9a839a8,0xbb64361f,0xbc00,0x34a5bba8,0x3872baa7,0x3a2fb913
.long 0x3c00,0xb23e3bd9,0xb61f3b64,0xb8723aa7,0xbc00,0x2e46bbf6,0x323ebbd9,0x34a5bba8
.long 0x3c00,0xbc008000,0xbc00,0x3c000000,0xb61fbb64,0x3b0eb78b,0x38723aa7,0xba2f3913
.long 0x39a839a8,0xb8723aa7,0xbb64b61f,0x323ebbd9,0xbb64b61f,0x2e46bbf6,0x3bd9b23e,0x378b3b0e
.long 0x3c000000,0x361f3b64,0xb9a839a8,0xbb64b61f,0xbb64361f,0xba2fb913,0x323ebbd9,0x3ba8b4a5
.long 0x39a8b9a8,0x3bd9323e,0x361f3b64,0xb8723aa7,0xb61f3b64,0xbba834a5,0xbaa7b872,0xae46bbf6
.long 0xbc00,0x39a8b9a8,0x3c000000,0x39a839a8,0x361f3b64,0xb4a53ba8,0xbaa73872,0xbbf6ae46
.long 0xb9a8b9a8,0xb23ebbd9,0x361fbb64,0x3aa7b872,0x3b64361f,0x39133a2f,0x323e3bd9,0xb4a53ba8
.long 0xbc008000,0xbb64b61f,0xb9a8b9a8,0xb61fbb64,0x3b64b61f,0x3bf6ae46,0x3bd9323e,0x3b0e378b
.long 0xb9a839a8,0xbaa73872,0xbb64361f,0xbbd9323e,0x361fbb64,0x378bbb0e,0x3872baa7,0x3913ba2f
.long 0x3c00,0xbc008000,0xbc00,0x3c000000,0xb9a8b9a8,0x3913ba2f,0x3aa73872,0xb78b3b0e
.long 0x3c000000,0x323e3bd9,0xbb64361f,0xb872baa7,0xb9a839a8,0xbb0eb78b,0x323ebbd9,0x3bf6ae46
.long 0xbc00,0x3b64b61f,0x39a839a8,0xb61f3b64,0x39a839a8,0xb4a53ba8,0xbbd9323e,0xb913ba2f
.long 0xbc008000,0xb872baa7,0x361fbb64,0x3bd9b23e,0x39a8b9a8,0x3bf62e46,0x38723aa7,0xb4a53ba8
.long 0x3c00,0xb9a839a8,0xbc008000,0xb9a8b9a8,0xb9a8b9a8,0xae46bbf6,0x3872baa7,0x3ba8b4a5
.long 0x3c000000,0x3aa73872,0x361f3b64,0xb23e3bd9,0xb9a839a8,0xbba834a5,0xbbd9b23e,0xba2fb913
.long 0xbc00,0x361fbb64,0x39a8b9a8,0x3b64b61f,0x39a839a8,0x378b3b0e,0x323e3bd9,0xae463bf6
.long 0xbc008000,0xbbd9b23e,0xbb64b61f,0xbaa7b872,0x39a8b9a8,0x3a2fb913,0x3aa7b872,0x3b0eb78b
.long 0x3c00,0xbc008000,0xbc00,0x3c000000,0xbb64b61f,0x34a5bba8,0x3bd9323e,0xae463bf6
.long 0x39a8b9a8,0x3aa73872,0xb61f3b64,0xbbd9b23e,0x361f3b64,0xba2f3913,0xbaa7b872,0x34a5bba8
.long 0xbc008000,0xb61fbb64,0x39a8b9a8,0x3b64361f,0x361fbb64,0x3bf6ae46,0x38723aa7,0xb78b3b0e
.long 0x39a839a8,0xb23e3bd9,0xbb64361f,0xbaa7b872,0xbb64361f,0xbb0eb78b,0xb23ebbd9,0x3913ba2f
.long 0xbc00,0x39a8b9a8,0x3c000000,0x39a839a8,0x3b64361f,0x378b3b0e,0xb23e3bd9,0xba2f3913
.long 0xb9a839a8,0xbbd9323e,0xbb64b61f,0xb872baa7,0xb61fbb64,0x2e46bbf6,0x3872baa7,0x3b0eb78b
.long 0x3c000000,0x3b64361f,0x39a839a8,0x361f3b64,0xb61f3b64,0xb9133a2f,0xbaa73872,0xbba834a5
.long 0xb9a8b9a8,0xb872baa7,0xb61fbb64,0xb23ebbd9,0x3b64b61f,0x3ba8b4a5,0x3bd9b23e,0x3bf6ae46
.long 0x3c00,0xbc008000,0xbc00,0x3c000000,0xbc008000,0xae46bbf6,0x3bd9b23e,0x34a53ba8
.long 0xbc00,0x3bd9b23e,0x361f3b64,0xbaa73872,0x3c000000,0x34a53ba8,0xbaa73872,0xba2fb913
.long 0x3c00,0xbb64361f,0xb9a8b9a8,0x361fbb64,0xbc008000,0xb78bbb0e,0x3872baa7,0x3bf62e46
.long 0xbc00,0x3aa7b872,0x3b64361f,0x323e3bd9,0x3c000000,0x39133a2f,0xb23e3bd9,0xbb0e378b
.long 0x3c00,0xb9a839a8,0xbc008000,0xb9a8b9a8,0xbc008000,0xba2fb913,0xb23ebbd9,0x378bbb0e
.long 0xbc00,0x3872baa7,0x3b64b61f,0x3bd9323e,0x3c000000,0x3b0e378b,0x38723aa7,0x2e463bf6
.long 0x3c00,0xb61f3b64,0xb9a839a8,0xbb64361f,0xbc008000,0xbba8b4a5,0xbaa7b872,0xb913ba2f
.long 0xbc00,0x323ebbd9,0x361fbb64,0x3872baa7,0x3c000000,0x3bf62e46,0x3bd9323e,0x3ba834a5
.long 0x3c00,0xbc008000,0xbc00,0x3c000000,0xbb64361f,0xb78bbb0e,0x3aa7b872,0x39133a2f
.long 0xb9a8b9a8,0x3872baa7,0x3b64361f,0xb23e3bd9,0x361fbb64,0x3bf62e46,0x323e3bd9,0xbb0e378b
.long 0x3c000000,0x361f3b64,0xb9a839a8,0xbb64b61f,0x361f3b64,0xb9133a2f,0xbbd9b23e,0xb4a5bba8
.long 0xb9a839a8,0xbbd9b23e,0xb61fbb64,0x3872baa7,0xbb64b61f,0xb4a5bba8,0x3872baa7,0x3bf6ae46
.long 0xbc00,0x39a8b9a8,0x3c000000,0x39a839a8,0x3b64b61f,0x3ba834a5,0x38723aa7,0xae463bf6
.long 0x39a839a8,0x323e3bd9,0xb61f3b64,0xbaa73872,0xb61f3b64,0xba2f3913,0xbbd9323e,0xbba8b4a5
.long 0xbc008000,0xbb64b61f,0xb9a8b9a8,0xb61fbb64,0xb61fbb64,0xae46bbf6,0x323ebbd9,0x378bbb0e
.long 0x39a8b9a8,0x3aa7b872,0x3b64b61f,0x3bd9b23e,0x3b64361f,0x3b0e378b,0x3aa73872,0x3a2f3913
.long 0x3c00,0xbc008000,0xbc00,0x3c000000,0xb9a839a8,0xba2fb913,0x3872baa7,0x3b0e378b
.long 0xbc008000,0xb23ebbd9,0x3b64b61f,0x38723aa7,0xb9a8b9a8,0x378bbb0e,0x3bd9323e,0x2e463bf6
.long 0xbc00,0x3b64b61f,0x39a839a8,0xb61f3b64,0x39a8b9a8,0x3ba834a5,0x323e3bd9,0xba2f3913
.long 0x3c000000,0x38723aa7,0xb61f3b64,0xbbd9323e,0x39a839a8,0xae463bf6,0xbaa73872,0xbba8b4a5
.long 0x3c00,0xb9a839a8,0xbc008000,0xb9a8b9a8,0xb9a839a8,0xbbf62e46,0xbaa7b872,0xb4a5bba8
.long 0xbc008000,0xbaa7b872,0xb61fbb64,0x323ebbd9,0xb9a8b9a8,0xb4a5bba8,0x323ebbd9,0x3913ba2f
.long 0xbc00,0x361fbb64,0x39a8b9a8,0x3b64b61f,0x39a8b9a8,0x3b0eb78b,0x3bd9b23e,0x3bf62e46
.long 0x3c000000,0x3bd9323e,0x3b64361f,0x3aa73872,0x39a839a8,0x39133a2f,0x38723aa7,0x378b3b0e
.long 0x3c00,0xbc008000,0xbc00,0x3c000000,0xb61f3b64,0xbba8b4a5,0x323ebbd9,0x3bf62e46
.long 0xb9a839a8,0xbaa7b872,0x361fbb64,0x3bd9323e,0xbb64361f,0xb913ba2f,0x3872baa7,0x3ba834a5
.long 0xbc008000,0xb61fbb64,0x39a8b9a8,0x3b64361f,0xbb64b61f,0xae46bbf6,0x3aa7b872,0x3b0e378b
.long 0xb9a8b9a8,0x323ebbd9,0x3b64b61f,0x3aa73872,0xb61fbb64,0x378bbb0e,0x3bd9b23e,0x3a2f3913
.long 0xbc00,0x39a8b9a8,0x3c000000,0x39a839a8,0x361fbb64,0x3b0eb78b,0x3bd9323e,0x39133a2f
.long 0x39a8b9a8,0x3bd9b23e,0x3b64361f,0x38723aa7,0x3b64b61f,0x3bf62e46,0x3aa73872,0x378b3b0e
.long 0x3c000000,0x3b64361f,0x39a839a8,0x361f3b64,0x3b64361f,0x3a2f3913,0x38723aa7,0x34a53ba8
.long 0x39a839a8,0x38723aa7,0x361f3b64,0x323e3bd9,0x361f3b64,0x34a53ba8,0x323e3bd9,0x2e463bf6
.long 0x3c00,0x3c00,0x3c00,0x3c00,0x3c008000,0x3c008000,0x3c008000,0x3c008000
.long 0x3c00,0xbc00,0x361f3b64,0xb61fbb64,0x3c008000,0xbc008000,0x3b64b61f,0xbb64361f
.long 0x3c00,0x3c00,0x39a839a8,0x39a839a8,0x3c008000,0x3c008000,0x39a8b9a8,0x39a8b9a8
.long 0x3c00,0xbc00,0x3b64361f,0xbb64b61f,0x3c008000,0xbc008000,0x361fbb64,0xb61f3b64
.long 0x3c00,0x3c00,0x3c000000,0x3c000000,0x3c008000,0x3c008000,0xbc00,0xbc00
.long 0x3c00,0xbc00,0x3b64b61f,0xbb64361f,0x3c008000,0xbc008000,0xb61fbb64,0x361f3b64
.long 0x3c00,0x3c00,0x39a8b9a8,0x39a8b9a8,0x3c008000,0x3c008000,0xb9a8b9a8,0xb9a8b9a8
.long 0x3c00,0xbc00,0x361fbb64,0xb61f3b64,0x3c008000,0xbc008000,0xbb64b61f,0x3b64361f
.long 0x3c00,0x3c00,0x3c00,0x3c00,0x3c008000,0x3c008000,0x3c008000,0x3c008000
.long 0x39a839a8,0xb9a8b9a8,0x3b64361f,0xbb64b61f,0x39a8b9a8,0xb9a839a8,0x361fbb64,0xb61f3b64
.long 0x3c000000,0x3c000000,0x39a8b9a8,0x39a8b9a8,0xbc00,0xbc00,0xb9a8b9a8,0xb9a8b9a8
.long 0x39a8b9a8,0xb9a839a8,0xb61fbb64,0x361f3b64,0xb9a8b9a8,0x39a839a8,0xbb64361f,0x3b64b61f
.long 0xbc00,0xbc00,0xbc008000,0xbc008000,0xbc008000,0xbc008000,0x80003c00,0x80003c00
.long 0xb9a8b9a8,0x39a839a8,0xb61f3b64,0x361fbb64,0xb9a839a8,0x39a8b9a8,0x3b64361f,0xbb64b61f
.long 0xbc008000,0xbc008000,0x39a839a8,0x39a839a8,0x80003c00,0x80003c00,0x39a8b9a8,0x39a8b9a8
.long 0xb9a839a8,0x39a8b9a8,0x3b64b61f,0xbb64361f,0x39a839a8,0xb9a8b9a8,0xb61fbb64,0x361f3b64
.long 0x3c00,0x3c00,0x3c00,0x3c00,0x3c008000,0x3c008000,0x3c008000,0x3c008000
.long 0x3c000000,0xbc008000,0x3b64b61f,0xbb64361f,0xbc00,0x80003c00,0xb61fbb64,0x361f3b64
.long 0xbc00,0xbc00,0xb9a8b9a8,0xb9a8b9a8,0xbc008000,0xbc008000,0xb9a839a8,0xb9a839a8
.long 0xbc008000,0x3c000000,0xb61f3b64,0x361fbb64,0x80003c00,0xbc00,0x3b64361f,0xbb64b61f
.long 0x3c00,0x3c00,0x3c000000,0x3c000000,0x3c008000,0x3c008000,0xbc00,0xbc00
.long 0x3c000000,0xbc008000,0xb61fbb64,0x361f3b64,0xbc00,0x80003c00,0xbb64361f,0x3b64b61f
.long 0xbc00,0xbc00,0xb9a839a8,0xb9a839a8,0xbc008000,0xbc008000,0x39a839a8,0x39a839a8
.long 0xbc008000,0x3c000000,0x3b64361f,0xbb64b61f,0x80003c00,0xbc00,0x361fbb64,0xb61f3b64
.long 0x3c00,0x3c00,0x3c00,0x3c00,0x3c008000,0x3c008000,0x3c008000,0x3c008000
.long 0x39a8b9a8,0xb9a839a8,0x361fbb64,0xb61f3b64,0xb9a8b9a8,0x39a839a8,0xbb64b61f,0x3b64361f
.long 0xbc008000,0xbc008000,0xb9a839a8,0xb9a839a8,0x80003c00,0x80003c00,0x39a839a8,0x39a839a8
.long 0x39a839a8,0xb9a8b9a8,0x3b64b61f,0xbb64361f,0x39a8b9a8,0xb9a839a8,0xb61fbb64,0x361f3b64
.long 0xbc00,0xbc00,0xbc008000,0xbc008000,0xbc008000,0xbc008000,0x80003c00,0x80003c00
.long 0xb9a839a8,0x39a8b9a8,0x3b64361f,0xbb64b61f,0x39a839a8,0xb9a8b9a8,0x361fbb64,0xb61f3b64
.long 0x3c000000,0x3c000000,0xb9a8b9a8,0xb9a8b9a8,0xbc00,0xbc00,0xb9a839a8,0xb9a839a8
.long 0xb9a8b9a8,0x39a839a8,0x361f3b64,0xb61fbb64,0xb9a839a8,0x39a8b9a8,0x3b64b61f,0xbb64361f
.long 0x3c00,0x3c00,0x3c00,0x3c00,0x3c008000,0x3c008000,0x3c008000,0x3c008000
.long 0x2a483bfe,0xaa48bbfe,0x395f39ed,0xb95fb9ed,0x3bfeaa48,0xbbfe2a48,0x39edb95f,0xb9ed395f
.long 0x2e463bf6,0x2e463bf6,0x3bf62e46,0x3bf62e46,0x3bf6ae46,0x3bf6ae46,0x2e46bbf6,0x2e46bbf6
.long 0x30b23bea,0xb0b2bbea,0x3a6db8c4,0xba6d38c4,0x3beab0b2,0xbbea30b2,0xb8c4ba6d,0x38c43a6d
.long 0x323e3bd9,0x323e3bd9,0x323ebbd9,0x323ebbd9,0x3bd9b23e,0x3bd9b23e,0xbbd9b23e,0xbbd9b23e
.long 0x33c63bc3,0xb3c6bbc3,0xb81dbadd,0x381d3add,0x3bc3b3c6,0xbbc333c6,0xbadd381d,0x3addb81d
.long 0x34a53ba8,0x34a53ba8,0xbba8b4a5,0xbba8b4a5,0x3ba8b4a5,0x3ba8b4a5,0xb4a53ba8,0xb4a53ba8
.long 0x35643b88,0xb564bb88,0xbb3b36d7,0x3b3bb6d7,0x3b88b564,0xbb883564,0x36d73b3b,0xb6d7bb3b
.long 0x3c00,0x3c00,0x3c00,0x3c00,0x3c008000,0x3c008000,0x3c008000,0x3c008000
.long 0x39ed395f,0xb9edb95f,0x3bfe2a48,0xbbfeaa48,0x395fb9ed,0xb95f39ed,0x2a48bbfe,0xaa483bfe
.long 0x3bf6ae46,0x3bf6ae46,0x2e46bbf6,0x2e46bbf6,0xae46bbf6,0xae46bbf6,0xbbf6ae46,0xbbf6ae46
.long 0x38c4ba6d,0xb8c43a6d,0xbbeab0b2,0x3bea30b2,0xba6db8c4,0x3a6d38c4,0xb0b23bea,0x30b2bbea
.long 0xb23ebbd9,0xb23ebbd9,0xb23e3bd9,0xb23e3bd9,0xbbd9323e,0xbbd9323e,0x3bd9323e,0x3bd9323e
.long 0xbaddb81d,0x3add381d,0x3bc333c6,0xbbc3b3c6,0xb81d3add,0x381dbadd,0x33c6bbc3,0xb3c63bc3
.long 0xbba834a5,0xbba834a5,0x34a5bba8,0x34a5bba8,0x34a53ba8,0x34a53ba8,0xbba8b4a5,0xbba8b4a5
.long 0xb6d73b3b,0x36d7bb3b,0xbb88b564,0x3b883564,0x3b3b36d7,0xbb3bb6d7,0xb5643b88,0x3564bb88
.long 0x3c00,0x3c00,0x3c00,0x3c00,0x3c008000,0x3c008000,0x3c008000,0x3c008000
.long 0x3bfeaa48,0xbbfe2a48,0x39edb95f,0xb9ed395f,0xaa48bbfe,0x2a483bfe,0xb95fb9ed,0x395f39ed
.long 0xae46bbf6,0xae46bbf6,0xbbf6ae46,0xbbf6ae46,0xbbf62e46,0xbbf62e46,0xae463bf6,0xae463bf6
.long 0xbbea30b2,0x3beab0b2,0x38c43a6d,0xb8c4ba6d,0x30b23bea,0xb0b2bbea,0x3a6db8c4,0xba6d38c4
.long 0x323e3bd9,0x323e3bd9,0x323ebbd9,0x323ebbd9,0x3bd9b23e,0x3bd9b23e,0xbbd9b23e,0xbbd9b23e
.long 0x3bc3b3c6,0xbbc333c6,0xbadd381d,0x3addb81d,0xb3c6bbc3,0x33c63bc3,0x381d3add,0xb81dbadd
.long 0xb4a5bba8,0xb4a5bba8,0x3ba834a5,0x3ba834a5,0xbba834a5,0xbba834a5,0x34a5bba8,0x34a5bba8
.long 0xbb883564,0x3b88b564,0xb6d7bb3b,0x36d73b3b,0x35643b88,0xb564bb88,0xbb3b36d7,0x3b3bb6d7
.long 0x3c00,0x3c00,0x3c00,0x3c00,0x3c008000,0x3c008000,0x3c008000,0x3c008000
.long 0x395fb9ed,0xb95f39ed,0x2a48bbfe,0xaa483bfe,0xb9edb95f,0x39ed395f,0xbbfeaa48,0x3bfe2a48
.long 0xbbf62e46,0xbbf62e46,0xae463bf6,0xae463bf6,0x2e463bf6,0x2e463bf6,0x3bf62e46,0x3bf62e46
.long 0x3a6d38c4,0xba6db8c4,0x30b2bbea,0xb0b23bea,0x38c4ba6d,0xb8c43a6d,0xbbeab0b2,0x3bea30b2
.long 0xb23ebbd9,0xb23ebbd9,0xb23e3bd9,0xb23e3bd9,0xbbd9323e,0xbbd9323e,0x3bd9323e,0x3bd9323e
.long 0xb81d3add,0x381dbadd,0x33c6bbc3,0xb3c63bc3,0x3add381d,0xbaddb81d,0xbbc3b3c6,0x3bc333c6
.long 0x3ba8b4a5,0x3ba8b4a5,0xb4a53ba8,0xb4a53ba8,0xb4a5bba8,0xb4a5bba8,0x3ba834a5,0x3ba834a5
.long 0xbb3bb6d7,0x3b3b36d7,0x3564bb88,0xb5643b88,0xb6d73b3b,0x36d7bb3b,0xbb88b564,0x3b883564
.long 0x3c00,0x3c00,0x3c00,0x3c00,0x3c008000,0x3c008000,0x3c008000,0x3c008000
.long 0x2e463bf6,0xae46bbf6,0x39133a2f,0xb913ba2f,0x3bf6ae46,0xbbf62e46,0x3a2fb913,0xba2f3913
.long 0x323e3bd9,0x323e3bd9,0x3bd9323e,0x3bd9323e,0x3bd9b23e,0x3bd9b23e,0x323ebbd9,0x323ebbd9
.long 0x34a53ba8,0xb4a5bba8,0x3b0eb78b,0xbb0e378b,0x3ba8b4a5,0xbba834a5,0xb78bbb0e,0x378b3b0e
.long 0x361f3b64,0x361f3b64,0x361fbb64,0x361fbb64,0x3b64b61f,0x3b64b61f,0xbb64b61f,0xbb64b61f
.long 0x378b3b0e,0xb78bbb0e,0xb4a5bba8,0x34a53ba8,0x3b0eb78b,0xbb0e378b,0xbba834a5,0x3ba8b4a5
.long 0x38723aa7,0x38723aa7,0xbaa7b872,0xbaa7b872,0x3aa7b872,0x3aa7b872,0xb8723aa7,0xb8723aa7
.long 0x39133a2f,0xb913ba2f,0xbbf62e46,0x3bf6ae46,0x3a2fb913,0xba2f3913,0x2e463bf6,0xae46bbf6
.long 0x3c00,0x3c00,0x3c00,0x3c00,0x3c008000,0x3c008000,0x3c008000,0x3c008000
.long 0x3a2f3913,0xba2fb913,0x3bf62e46,0xbbf6ae46,0x3913ba2f,0xb9133a2f,0x2e46bbf6,0xae463bf6
.long 0x3bd9b23e,0x3bd9b23e,0x323ebbd9,0x323ebbd9,0xb23ebbd9,0xb23ebbd9,0xbbd9b23e,0xbbd9b23e
.long 0x378bbb0e,0xb78b3b0e,0xbba8b4a5,0x3ba834a5,0xbb0eb78b,0x3b0e378b,0xb4a53ba8,0x34a5bba8
.long 0xb61fbb64,0xb61fbb64,0xb61f3b64,0xb61f3b64,0xbb64361f,0xbb64361f,0x3b64361f,0x3b64361f
.long 0xbba8b4a5,0x3ba834a5,0x3b0e378b,0xbb0eb78b,0xb4a53ba8,0x34a5bba8,0x378bbb0e,0xb78b3b0e
.long 0xbaa73872,0xbaa73872,0x3872baa7,0x3872baa7,0x38723aa7,0x38723aa7,0xbaa7b872,0xbaa7b872
.long 0xae463bf6,0x2e46bbf6,0xba2fb913,0x3a2f3913,0x3bf62e46,0xbbf6ae46,0xb9133a2f,0x3913ba2f
.long 0x3c00,0x3c00,0x3c00,0x3c00,0x3c008000,0x3c008000,0x3c008000,0x3c008000
.long 0x3bf6ae46,0xbbf62e46,0x3a2fb913,0xba2f3913,0xae46bbf6,0x2e463bf6,0xb913ba2f,0x39133a2f
.long 0xb23ebbd9,0xb23ebbd9,0xbbd9b23e,0xbbd9b23e,0xbbd9323e,0xbbd9323e,0xb23e3bd9,0xb23e3bd9
.long 0xbba834a5,0x3ba8b4a5,0x378b3b0e,0xb78bbb0e,0x34a53ba8,0xb4a5bba8,0x3b0eb78b,0xbb0e378b
.long 0x361f3b64,0x361f3b64,0x361fbb64,0x361fbb64,0x3b64b61f,0x3b64b61f,0xbb64b61f,0xbb64b61f
.long 0x3b0eb78b,0xbb0e378b,0xbba834a5,0x3ba8b4a5,0xb78bbb0e,0x378b3b0e,0x34a53ba8,0xb4a5bba8
.long 0xb872baa7,0xb872baa7,0x3aa73872,0x3aa73872,0xbaa73872,0xbaa73872,0x3872baa7,0x3872baa7
.long 0xba2f3913,0x3a2fb913,0xae46bbf6,0x2e463bf6,0x39133a2f,0xb913ba2f,0xbbf62e46,0x3bf6ae46
.long 0x3c00,0x3c00,0x3c00,0x3c00,0x3c008000,0x3c008000,0x3c008000,0x3c008000
.long 0x3913ba2f,0xb9133a2f,0x2e46bbf6,0xae463bf6,0xba2fb913,0x3a2f3913,0xbbf6ae46,0x3bf62e46
.long 0xbbd9323e,0xbbd9323e,0xb23e3bd9,0xb23e3bd9,0x323e3bd9,0x323e3bd9,0x3bd9323e,0x3bd9323e
.long 0x3b0e378b,0xbb0eb78b,0x34a5bba8,0xb4a53ba8,0x378bbb0e,0xb78b3b0e,0xbba8b4a5,0x3ba834a5
.long 0xb61fbb64,0xb61fbb64,0xb61f3b64,0xb61f3b64,0xbb64361f,0xbb64361f,0x3b64361f,0x3b64361f
.long 0xb4a53ba8,0x34a5bba8,0x378bbb0e,0xb78b3b0e,0x3ba834a5,0xbba8b4a5,0xbb0eb78b,0x3b0e378b
.long 0x3aa7b872,0x3aa7b872,0xb8723aa7,0xb8723aa7,0xb872baa7,0xb872baa7,0x3aa73872,0x3aa73872
.long 0xbbf6ae46,0x3bf62e46,0x3913ba2f,0xb9133a2f,0xae463bf6,0x2e46bbf6,0xba2fb913,0x3a2f3913
.long 0x3c00,0x3c00,0x3c00,0x3c00,0x3c008000,0x3c008000,0x3c008000,0x3c008000
.long 0x30b23bea,0xb0b2bbea,0x38c43a6d,0xb8c4ba6d,0x3beab0b2,0xbbea30b2,0x3a6db8c4,0xba6d38c4
.long 0x34a53ba8,0x34a53ba8,0x3ba834a5,0x3ba834a5,0x3ba8b4a5,0x3ba8b4a5,0x34a5bba8,0x34a5bba8
.long 0x36d73b3b,0xb6d7bb3b,0x3b88b564,0xbb883564,0x3b3bb6d7,0xbb3b36d7,0xb564bb88,0x35643b88
.long 0x38723aa7,0x38723aa7,0x3872baa7,0x3872baa7,0x3aa7b872,0x3aa7b872,0xbaa7b872,0xbaa7b872
.long 0x395f39ed,0xb95fb9ed,0xaa48bbfe,0x2a483bfe,0x39edb95f,0xb9ed395f,0xbbfe2a48,0x3bfeaa48
.long 0x3a2f3913,0x3a2f3913,0xb913ba2f,0xb913ba2f,0x3913ba2f,0x3913ba2f,0xba2f3913,0xba2f3913
.long 0x3add381d,0xbaddb81d,0xbbc3b3c6,0x3bc333c6,0x381dbadd,0xb81d3add,0xb3c63bc3,0x33c6bbc3
.long 0x3c00,0x3c00,0x3c00,0x3c00,0x3c008000,0x3c008000,0x3c008000,0x3c008000
.long 0x3a6d38c4,0xba6db8c4,0x3bea30b2,0xbbeab0b2,0x38c4ba6d,0xb8c43a6d,0x30b2bbea,0xb0b23bea
.long 0x3ba8b4a5,0x3ba8b4a5,0x34a5bba8,0x34a5bba8,0xb4a5bba8,0xb4a5bba8,0xbba8b4a5,0xbba8b4a5
.long 0x3564bb88,0xb5643b88,0xbb3bb6d7,0x3b3b36d7,0xbb88b564,0x3b883564,0xb6d73b3b,0x36d7bb3b
.long 0xb872baa7,0xb872baa7,0xb8723aa7,0xb8723aa7,0xbaa73872,0xbaa73872,0x3aa73872,0x3aa73872
.long 0xbbfeaa48,0x3bfe2a48,0x39ed395f,0xb9edb95f,0xaa483bfe,0x2a48bbfe,0x395fb9ed,0xb95f39ed
.long 0xb9133a2f,0xb9133a2f,0x3a2fb913,0x3a2fb913,0x3a2f3913,0x3a2f3913,0xb913ba2f,0xb913ba2f
.long 0x33c63bc3,0xb3c6bbc3,0xb81dbadd,0x381d3add,0x3bc3b3c6,0xbbc333c6,0xbadd381d,0x3addb81d
.long 0x3c00,0x3c00,0x3c00,0x3c00,0x3c008000,0x3c008000,0x3c008000,0x3c008000
.long 0x3beab0b2,0xbbea30b2,0x3a6db8c4,0xba6d38c4,0xb0b2bbea,0x30b23bea,0xb8c4ba6d,0x38c43a6d
.long 0xb4a5bba8,0xb4a5bba8,0xbba8b4a5,0xbba8b4a5,0xbba834a5,0xbba834a5,0xb4a53ba8,0xb4a53ba8
.long 0xbb3b36d7,0x3b3bb6d7,0x35643b88,0xb564bb88,0x36d73b3b,0xb6d7bb3b,0x3b88b564,0xbb883564
.long 0x38723aa7,0x38723aa7,0x3872baa7,0x3872baa7,0x3aa7b872,0x3aa7b872,0xbaa7b872,0xbaa7b872
.long 0x39edb95f,0xb9ed395f,0xbbfe2a48,0x3bfeaa48,0xb95fb9ed,0x395f39ed,0x2a483bfe,0xaa48bbfe
.long 0xba2fb913,0xba2fb913,0x39133a2f,0x39133a2f,0xb9133a2f,0xb9133a2f,0x3a2fb913,0x3a2fb913
.long 0xb81d3add,0x381dbadd,0x33c6bbc3,0xb3c63bc3,0x3add381d,0xbaddb81d,0xbbc3b3c6,0x3bc333c6
.long 0x3c00,0x3c00,0x3c00,0x3c00,0x3c008000,0x3c008000,0x3c008000,0x3c008000
.long 0x38c4ba6d,0xb8c43a6d,0x30b2bbea,0xb0b23bea,0xba6db8c4,0x3a6d38c4,0xbbeab0b2,0x3bea30b2
.long 0xbba834a5,0xbba834a5,0xb4a53ba8,0xb4a53ba8,0x34a53ba8,0x34a53ba8,0x3ba834a5,0x3ba834a5
.long 0x3b883564,0xbb88b564,0x36d7bb3b,0xb6d73b3b,0x3564bb88,0xb5643b88,0xbb3bb6d7,0x3b3b36d7
.long 0xb872baa7,0xb872baa7,0xb8723aa7,0xb8723aa7,0xbaa73872,0xbaa73872,0x3aa73872,0x3aa73872
.long 0xaa483bfe,0x2a48bbfe,0x395fb9ed,0xb95f39ed,0x3bfe2a48,0xbbfeaa48,0xb9edb95f,0x39ed395f
.long 0x3913ba2f,0x3913ba2f,0xba2f3913,0xba2f3913,0xba2fb913,0xba2fb913,0x39133a2f,0x39133a2f
.long 0xbbc333c6,0x3bc3b3c6,0x3addb81d,0xbadd381d,0x33c63bc3,0xb3c6bbc3,0xb81dbadd,0x381d3add
.long 0x3c00,0x3c00,0x3c00,0x3c00,0x3c008000,0x3c008000,0x3c008000,0x3c008000
.long 0x323e3bd9,0xb23ebbd9,0x38723aa7,0xb872baa7,0x3bd9b23e,0xbbd9323e,0x3aa7b872,0xbaa73872
.long 0x361f3b64,0x361f3b64,0x3b64361f,0x3b64361f,0x3b64b61f,0x3b64b61f,0x361fbb64,0x361fbb64
.long 0x38723aa7,0xb872baa7,0x3bd9b23e,0xbbd9323e,0x3aa7b872,0xbaa73872,0xb23ebbd9,0x323e3bd9
.long 0x39a839a8,0x39a839a8,0x39a8b9a8,0x39a8b9a8,0x39a8b9a8,0x39a8b9a8,0xb9a8b9a8,0xb9a8b9a8
.long 0x3aa73872,0xbaa7b872,0x323ebbd9,0xb23e3bd9,0x3872baa7,0xb8723aa7,0xbbd9b23e,0x3bd9323e
.long 0x3b64361f,0x3b64361f,0xb61fbb64,0xb61fbb64,0x361fbb64,0x361fbb64,0xbb64361f,0xbb64361f
.long 0x3bd9323e,0xbbd9b23e,0xbaa7b872,0x3aa73872,0x323ebbd9,0xb23e3bd9,0xb8723aa7,0x3872baa7
.long 0x3c00,0x3c00,0x3c00,0x3c00,0x3c008000,0x3c008000,0x3c008000,0x3c008000
.long 0x3aa73872,0xbaa7b872,0x3bd9323e,0xbbd9b23e,0x3872baa7,0xb8723aa7,0x323ebbd9,0xb23e3bd9
.long 0x3b64b61f,0x3b64b61f,0x361fbb64,0x361fbb64,0xb61fbb64,0xb61fbb64,0xbb64b61f,0xbb64b61f
.long 0x323ebbd9,0xb23e3bd9,0xbaa7b872,0x3aa73872,0xbbd9b23e,0x3bd9323e,0xb8723aa7,0x3872baa7
.long 0xb9a8b9a8,0xb9a8b9a8,0xb9a839a8,0xb9a839a8,0xb9a839a8,0xb9a839a8,0x39a839a8,0x39a839a8
.long 0xbbd9323e,0x3bd9b23e,0x38723aa7,0xb872baa7,0x323e3bd9,0xb23ebbd9,0x3aa7b872,0xbaa73872
.long 0xb61f3b64,0xb61f3b64,0x3b64b61f,0x3b64b61f,0x3b64361f,0x3b64361f,0xb61fbb64,0xb61fbb64
.long 0x38723aa7,0xb872baa7,0xb23ebbd9,0x323e3bd9,0x3aa7b872,0xbaa73872,0xbbd9323e,0x3bd9b23e
.long 0x3c00,0x3c00,0x3c00,0x3c00,0x3c008000,0x3c008000,0x3c008000,0x3c008000
.long 0x3bd9b23e,0xbbd9323e,0x3aa7b872,0xbaa73872,0xb23ebbd9,0x323e3bd9,0xb872baa7,0x38723aa7
.long 0xb61fbb64,0xb61fbb64,0xbb64b61f,0xbb64b61f,0xbb64361f,0xbb64361f,0xb61f3b64,0xb61f3b64
.long 0xbaa73872,0x3aa7b872,0x323e3bd9,0xb23ebbd9,0x38723aa7,0xb872baa7,0x3bd9b23e,0xbbd9323e
.long 0x39a839a8,0x39a839a8,0x39a8b9a8,0x39a8b9a8,0x39a8b9a8,0x39a8b9a8,0xb9a8b9a8,0xb9a8b9a8
.long 0x3872baa7,0xb8723aa7,0xbbd9b23e,0x3bd9323e,0xbaa7b872,0x3aa73872,0xb23e3bd9,0x323ebbd9
.long 0xbb64b61f,0xbb64b61f,0x361f3b64,0x361f3b64,0xb61f3b64,0xb61f3b64,0x3b64b61f,0x3b64b61f
.long 0xb23e3bd9,0x323ebbd9,0x3872baa7,0xb8723aa7,0x3bd9323e,0xbbd9b23e,0xbaa7b872,0x3aa73872
.long 0x3c00,0x3c00,0x3c00,0x3c00,0x3c008000,0x3c008000,0x3c008000,0x3c008000
.long 0x3872baa7,0xb8723aa7,0x323ebbd9,0xb23e3bd9,0xbaa7b872,0x3aa73872,0xbbd9b23e,0x3bd9323e
.long 0xbb64361f,0xbb64361f,0xb61f3b64,0xb61f3b64,0x361f3b64,0x361f3b64,0x3b64361f,0x3b64361f
.long 0x3bd9323e,0xbbd9b23e,0x3872baa7,0xb8723aa7,0x323ebbd9,0xb23e3bd9,0xbaa7b872,0x3aa73872
.long 0xb9a8b9a8,0xb9a8b9a8,0xb9a839a8,0xb9a839a8,0xb9a839a8,0xb9a839a8,0x39a839a8,0x39a839a8
.long 0x323e3bd9,0xb23ebbd9,0x3aa7b872,0xbaa73872,0x3bd9b23e,0xbbd9323e,0xb872baa7,0x38723aa7
.long 0x361fbb64,0x361fbb64,0xbb64361f,0xbb64361f,0xbb64b61f,0xbb64b61f,0x361f3b64,0x361f3b64
.long 0xbaa73872,0x3aa7b872,0x3bd9b23e,0xbbd9323e,0x38723aa7,0xb872baa7,0xb23ebbd9,0x323e3bd9
.long 0x3c00,0x3c00,0x3c00,0x3c00,0x3c008000,0x3c008000,0x3c008000,0x3c008000
.long 0x33c63bc3,0xb3c6bbc3,0x381d3add,0xb81dbadd,0x3bc3b3c6,0xbbc333c6,0x3addb81d,0xbadd381d
.long 0x378b3b0e,0x378b3b0e,0x3b0e378b,0x3b0e378b,0x3b0eb78b,0x3b0eb78b,0x378bbb0e,0x378bbb0e
.long 0x395f39ed,0xb95fb9ed,0x3bfeaa48,0xbbfe2a48,0x39edb95f,0xb9ed395f,0xaa48bbfe,0x2a483bfe
.long 0x3aa73872,0x3aa73872,0x3aa7b872,0x3aa7b872,0x3872baa7,0x3872baa7,0xb872baa7,0xb872baa7
.long 0x3b883564,0xbb88b564,0x36d7bb3b,0xb6d73b3b,0x3564bb88,0xb5643b88,0xbb3bb6d7,0x3b3b36d7
.long 0x3bf62e46,0x3bf62e46,0xae46bbf6,0xae46bbf6,0x2e46bbf6,0x2e46bbf6,0xbbf62e46,0xbbf62e46
.long 0x3beab0b2,0xbbea30b2,0xb8c4ba6d,0x38c43a6d,0xb0b2bbea,0x30b23bea,0xba6d38c4,0x3a6db8c4
.long 0x3c00,0x3c00,0x3c00,0x3c00,0x3c008000,0x3c008000,0x3c008000,0x3c008000
.long 0x3add381d,0xbaddb81d,0x3bc333c6,0xbbc3b3c6,0x381dbadd,0xb81d3add,0x33c6bbc3,0xb3c63bc3
.long 0x3b0eb78b,0x3b0eb78b,0x378bbb0e,0x378bbb0e,0xb78bbb0e,0xb78bbb0e,0xbb0eb78b,0xbb0eb78b
.long 0x2a48bbfe,0xaa483bfe,0xb9edb95f,0x39ed395f,0xbbfeaa48,0x3bfe2a48,0xb95f39ed,0x395fb9ed
.long 0xbaa7b872,0xbaa7b872,0xbaa73872,0xbaa73872,0xb8723aa7,0xb8723aa7,0x38723aa7,0x38723aa7
.long 0xbb3b36d7,0x3b3bb6d7,0x35643b88,0xb564bb88,0x36d73b3b,0xb6d7bb3b,0x3b88b564,0xbb883564
.long 0xae463bf6,0xae463bf6,0x3bf6ae46,0x3bf6ae46,0x3bf62e46,0x3bf62e46,0xae46bbf6,0xae46bbf6
.long 0x3a6d38c4,0xba6db8c4,0x30b2bbea,0xb0b23bea,0x38c4ba6d,0xb8c43a6d,0xbbeab0b2,0x3bea30b2
.long 0x3c00,0x3c00,0x3c00,0x3c00,0x3c008000,0x3c008000,0x3c008000,0x3c008000
.long 0x3bc3b3c6,0xbbc333c6,0x3addb81d,0xbadd381d,0xb3c6bbc3,0x33c63bc3,0xb81dbadd,0x381d3add
.long 0xb78bbb0e,0xb78bbb0e,0xbb0eb78b,0xbb0eb78b,0xbb0e378b,0xbb0e378b,0xb78b3b0e,0xb78b3b0e
.long 0xb9ed395f,0x39edb95f,0x2a483bfe,0xaa48bbfe,0x395f39ed,0xb95fb9ed,0x3bfeaa48,0xbbfe2a48
.long 0x3aa73872,0x3aa73872,0x3aa7b872,0x3aa7b872,0x3872baa7,0x3872baa7,0xb872baa7,0xb872baa7
.long 0x3564bb88,0xb5643b88,0xbb3bb6d7,0x3b3b36d7,0xbb88b564,0x3b883564,0xb6d73b3b,0x36d7bb3b
.long 0xbbf6ae46,0xbbf6ae46,0x2e463bf6,0x2e463bf6,0xae463bf6,0xae463bf6,0x3bf6ae46,0x3bf6ae46
.long 0x30b23bea,0xb0b2bbea,0x3a6db8c4,0xba6d38c4,0x3beab0b2,0xbbea30b2,0xb8c4ba6d,0x38c43a6d
.long 0x3c00,0x3c00,0x3c00,0x3c00,0x3c008000,0x3c008000,0x3c008000,0x3c008000
.long 0x381dbadd,0xb81d3add,0x33c6bbc3,0xb3c63bc3,0xbaddb81d,0x3add381d,0xbbc3b3c6,0x3bc333c6
.long 0xbb0e378b,0xbb0e378b,0xb78b3b0e,0xb78b3b0e,0x378b3b0e,0x378b3b0e,0x3b0e378b,0x3b0e378b
.long 0x3bfe2a48,0xbbfeaa48,0x395fb9ed,0xb95f39ed,0x2a48bbfe,0xaa483bfe,0xb9edb95f,0x39ed395f
.long 0xbaa7b872,0xbaa7b872,0xbaa73872,0xbaa73872,0xb8723aa7,0xb8723aa7,0x38723aa7,0x38723aa7
.long 0x36d73b3b,0xb6d7bb3b,0x3b88b564,0xbb883564,0x3b3bb6d7,0xbb3b36d7,0xb564bb88,0x35643b88
.long 0x2e46bbf6,0x2e46bbf6,0xbbf62e46,0xbbf62e46,0xbbf6ae46,0xbbf6ae46,0x2e463bf6,0x2e463bf6
.long 0xb8c43a6d,0x38c4ba6d,0x3bea30b2,0xbbeab0b2,0x3a6d38c4,0xba6db8c4,0x30b2bbea,0xb0b23bea
.long 0x3c00,0x3c00,0x3c00,0x3c00,0x3c008000,0x3c008000,0x3c008000,0x3c008000
.long 0x34a53ba8,0xb4a5bba8,0x378b3b0e,0xb78bbb0e,0x3ba8b4a5,0xbba834a5,0x3b0eb78b,0xbb0e378b
.long 0x38723aa7,0x38723aa7,0x3aa73872,0x3aa73872,0x3aa7b872,0x3aa7b872,0x3872baa7,0x3872baa7
.long 0x3a2f3913,0xba2fb913,0x3bf62e46,0xbbf6ae46,0x3913ba2f,0xb9133a2f,0x2e46bbf6,0xae463bf6
.long 0x3b64361f,0x3b64361f,0x3b64b61f,0x3b64b61f,0x361fbb64,0x361fbb64,0xb61fbb64,0xb61fbb64
.long 0x3bf62e46,0xbbf6ae46,0x3913ba2f,0xb9133a2f,0x2e46bbf6,0xae463bf6,0xba2fb913,0x3a2f3913
.long 0x3bd9b23e,0x3bd9b23e,0x323ebbd9,0x323ebbd9,0xb23ebbd9,0xb23ebbd9,0xbbd9b23e,0xbbd9b23e
.long 0x3b0eb78b,0xbb0e378b,0xb4a5bba8,0x34a53ba8,0xb78bbb0e,0x378b3b0e,0xbba834a5,0x3ba8b4a5
.long 0x3c00,0x3c00,0x3c00,0x3c00,0x3c008000,0x3c008000,0x3c008000,0x3c008000
.long 0x3b0e378b,0xbb0eb78b,0x3ba834a5,0xbba8b4a5,0x378bbb0e,0xb78b3b0e,0x34a5bba8,0xb4a53ba8
.long 0x3aa7b872,0x3aa7b872,0x3872baa7,0x3872baa7,0xb872baa7,0xb872baa7,0xbaa7b872,0xbaa7b872
.long 0xae46bbf6,0x2e463bf6,0xb913ba2f,0x39133a2f,0xbbf62e46,0x3bf6ae46,0xba2f3913,0x3a2fb913
.long 0xbb64b61f,0xbb64b61f,0xbb64361f,0xbb64361f,0xb61f3b64,0xb61f3b64,0x361f3b64,0x361f3b64
.long 0xba2f3913,0x3a2fb913,0x2e463bf6,0xae46bbf6,0x39133a2f,0xb913ba2f,0x3bf6ae46,0xbbf62e46
.long 0x323e3bd9,0x323e3bd9,0x3bd9323e,0x3bd9323e,0x3bd9b23e,0x3bd9b23e,0x323ebbd9,0x323ebbd9
.long 0x3ba834a5,0xbba8b4a5,0x378bbb0e,0xb78b3b0e,0x34a5bba8,0xb4a53ba8,0xbb0eb78b,0x3b0e378b
.long 0x3c00,0x3c00,0x3c00,0x3c00,0x3c008000,0x3c008000,0x3c008000,0x3c008000
.long 0x3ba8b4a5,0xbba834a5,0x3b0eb78b,0xbb0e378b,0xb4a5bba8,0x34a53ba8,0xb78bbb0e,0x378b3b0e
.long 0xb872baa7,0xb872baa7,0xbaa7b872,0xbaa7b872,0xbaa73872,0xbaa73872,0xb8723aa7,0xb8723aa7
.long 0xb9133a2f,0x3913ba2f,0xae463bf6,0x2e46bbf6,0x3a2f3913,0xba2fb913,0x3bf62e46,0xbbf6ae46
.long 0x3b64361f,0x3b64361f,0x3b64b61f,0x3b64b61f,0x361fbb64,0x361fbb64,0xb61fbb64,0xb61fbb64
.long 0x2e46bbf6,0xae463bf6,0xba2fb913,0x3a2f3913,0xbbf6ae46,0x3bf62e46,0xb9133a2f,0x3913ba2f
.long 0xbbd9323e,0xbbd9323e,0xb23e3bd9,0xb23e3bd9,0x323e3bd9,0x323e3bd9,0x3bd9323e,0x3bd9323e
.long 0x378b3b0e,0xb78bbb0e,0x3ba8b4a5,0xbba834a5,0x3b0eb78b,0xbb0e378b,0xb4a5bba8,0x34a53ba8
.long 0x3c00,0x3c00,0x3c00,0x3c00,0x3c008000,0x3c008000,0x3c008000,0x3c008000
.long 0x378bbb0e,0xb78b3b0e,0x34a5bba8,0xb4a53ba8,0xbb0eb78b,0x3b0e378b,0xbba8b4a5,0x3ba834a5
.long 0xbaa73872,0xbaa73872,0xb8723aa7,0xb8723aa7,0x38723aa7,0x38723aa7,0x3aa73872,0x3aa73872
.long 0x3bf6ae46,0xbbf62e46,0x3a2fb913,0xba2f3913,0xae46bbf6,0x2e463bf6,0xb913ba2f,0x39133a2f
.long 0xbb64b61f,0xbb64b61f,0xbb64361f,0xbb64361f,0xb61f3b64,0xb61f3b64,0x361f3b64,0x361f3b64
.long 0x39133a2f,0xb913ba2f,0x3bf6ae46,0xbbf62e46,0x3a2fb913,0xba2f3913,0xae46bbf6,0x2e463bf6
.long 0xb23ebbd9,0xb23ebbd9,0xbbd9b23e,0xbbd9b23e,0xbbd9323e,0xbbd9323e,0xb23e3bd9,0xb23e3bd9
.long 0xb4a53ba8,0x34a5bba8,0x3b0e378b,0xbb0eb78b,0x3ba834a5,0xbba8b4a5,0x378bbb0e,0xb78b3b0e
.long 0x3c00,0x3c00,0x3c00,0x3c00,0x3c008000,0x3c008000,0x3c008000,0x3c008000
.long 0x35643b88,0xb564bb88,0x36d73b3b,0xb6d7bb3b,0x3b88b564,0xbb883564,0x3b3bb6d7,0xbb3b36d7
.long 0x39133a2f,0x39133a2f,0x3a2f3913,0x3a2f3913,0x3a2fb913,0x3a2fb913,0x3913ba2f,0x3913ba2f
.long 0x3add381d,0xbaddb81d,0x3bc333c6,0xbbc3b3c6,0x381dbadd,0xb81d3add,0x33c6bbc3,0xb3c63bc3
.long 0x3bd9323e,0x3bd9323e,0x3bd9b23e,0x3bd9b23e,0x323ebbd9,0x323ebbd9,0xb23ebbd9,0xb23ebbd9
.long 0x3beab0b2,0xbbea30b2,0x3a6db8c4,0xba6d38c4,0xb0b2bbea,0x30b23bea,0xb8c4ba6d,0x38c43a6d
.long 0x3b0eb78b,0x3b0eb78b,0x378bbb0e,0x378bbb0e,0xb78bbb0e,0xb78bbb0e,0xbb0eb78b,0xbb0eb78b
.long 0x395fb9ed,0xb95f39ed,0x2a48bbfe,0xaa483bfe,0xb9edb95f,0x39ed395f,0xbbfeaa48,0x3bfe2a48
.long 0x3c00,0x3c00,0x3c00,0x3c00,0x3c008000,0x3c008000,0x3c008000,0x3c008000
.long 0x3b3b36d7,0xbb3bb6d7,0x3b883564,0xbb88b564,0x36d7bb3b,0xb6d73b3b,0x3564bb88,0xb5643b88
.long 0x3a2fb913,0x3a2fb913,0x3913ba2f,0x3913ba2f,0xb913ba2f,0xb913ba2f,0xba2fb913,0xba2fb913
.long 0xb3c6bbc3,0x33c63bc3,0xb81dbadd,0x381d3add,0xbbc333c6,0x3bc3b3c6,0xbadd381d,0x3addb81d
.long 0xbbd9b23e,0xbbd9b23e,0xbbd9323e,0xbbd9323e,0xb23e3bd9,0xb23e3bd9,0x323e3bd9,0x323e3bd9
.long 0xb8c43a6d,0x38c4ba6d,0xb0b23bea,0x30b2bbea,0x3a6d38c4,0xba6db8c4,0x3bea30b2,0xbbeab0b2
.long 0x378b3b0e,0x378b3b0e,0x3b0e378b,0x3b0e378b,0x3b0eb78b,0x3b0eb78b,0x378bbb0e,0x378bbb0e
.long 0x3bfeaa48,0xbbfe2a48,0x39edb95f,0xb9ed395f,0xaa48bbfe,0x2a483bfe,0xb95fb9ed,0x395f39ed
.long 0x3c00,0x3c00,0x3c00,0x3c00,0x3c008000,0x3c008000,0x3c008000,0x3c008000
.long 0x3b88b564,0xbb883564,0x3b3bb6d7,0xbb3b36d7,0xb564bb88,0x35643b88,0xb6d7bb3b,0x36d73b3b
.long 0xb913ba2f,0xb913ba2f,0xba2fb913,0xba2fb913,0xba2f3913,0xba2f3913,0xb9133a2f,0xb9133a2f
.long 0xb81d3add,0x381dbadd,0xb3c63bc3,0x33c6bbc3,0x3add381d,0xbaddb81d,0x3bc333c6,0xbbc3b3c6
.long 0x3bd9323e,0x3bd9323e,0x3bd9b23e,0x3bd9b23e,0x323ebbd9,0x323ebbd9,0xb23ebbd9,0xb23ebbd9
.long 0xb0b2bbea,0x30b23bea,0xb8c4ba6d,0x38c43a6d,0xbbea30b2,0x3beab0b2,0xba6d38c4,0x3a6db8c4
.long 0xbb0e378b,0xbb0e378b,0xb78b3b0e,0xb78b3b0e,0x378b3b0e,0x378b3b0e,0x3b0e378b,0x3b0e378b
.long 0x39ed395f,0xb9edb95f,0x3bfe2a48,0xbbfeaa48,0x395fb9ed,0xb95f39ed,0x2a48bbfe,0xaa483bfe
.long 0x3c00,0x3c00,0x3c00,0x3c00,0x3c008000,0x3c008000,0x3c008000,0x3c008000
.long 0x36d7bb3b,0xb6d73b3b,0x3564bb88,0xb5643b88,0xbb3bb6d7,0x3b3b36d7,0xbb88b564,0x3b883564
.long 0xba2f3913,0xba2f3913,0xb9133a2f,0xb9133a2f,0x39133a2f,0x39133a2f,0x3a2f3913,0x3a2f3913
.long 0x3bc3b3c6,0xbbc333c6,0x3addb81d,0xbadd381d,0xb3c6bbc3,0x33c63bc3,0xb81dbadd,0x381d3add
.long 0xbbd9b23e,0xbbd9b23e,0xbbd9323e,0xbbd9323e,0xb23e3bd9,0xb23e3bd9,0x323e3bd9,0x323e3bd9
.long 0x3a6d38c4,0xba6db8c4,0x3bea30b2,0xbbeab0b2,0x38c4ba6d,0xb8c43a6d,0x30b2bbea,0xb0b23bea
.long 0xb78bbb0e,0xb78bbb0e,0xbb0eb78b,0xbb0eb78b,0xbb0e378b,0xbb0e378b,0xb78b3b0e,0xb78b3b0e
.long 0x2a483bfe,0xaa48bbfe,0x395f39ed,0xb95fb9ed,0x3bfeaa48,0xbbfe2a48,0x39edb95f,0xb9ed395f
.long 0x3c00,0x3c00,0x3c00,0x3c00,0x3c00,0x3c00,0x3c00,0x3c00
.long 0x3c00,0xbc00,0x3b64,0xbb64,0x8000,0x8000,0xb61f,0x361f
.long 0x3c00,0x3c00,0x39a8,0x39a8,0x8000,0x8000,0xb9a8,0xb9a8
.long 0x3c00,0xbc00,0x361f,0xb61f,0x8000,0x8000,0xbb64,0x3b64
.long 0x3c000000,0x0,0x3bd90000,0xb23e0000,0x80000000,0xbc000000,0xb23e0000,0xbbd90000
.long 0x3c000000,0x80000000,0x3aa70000,0x38720000,0x80000000,0x3c000000,0xb8720000,0x3aa70000
.long 0x3c000000,0x0,0x38720000,0xbaa70000,0x80000000,0xbc000000,0xbaa70000,0xb8720000
.long 0x3c000000,0x80000000,0x323e0000,0x3bd90000,0x80000000,0x3c000000,0xbbd90000,0x323e0000
.long 0x3c00,0x3c00,0x3c00,0x3c00,0xbc00,0xbc00,0xbc00,0xbc00
.long 0x39a8,0xb9a8,0x361f,0xb61f,0xb9a8,0x39a8,0xbb64,0x3b64
.long 0x0,0x0,0xb9a8,0xb9a8,0xbc00,0xbc00,0xb9a8,0xb9a8
.long 0xb9a8,0x39a8,0xbb64,0x3b64,0xb9a8,0x39a8,0x361f,0xb61f
.long 0x3b640000,0xb61f0000,0x3aa70000,0xb8720000,0xb61f0000,0xbb640000,0xb8720000,0xbaa70000
.long 0x361f0000,0x3b640000,0xb23e0000,0x3bd90000,0xbb640000,0x361f0000,0xbbd90000,0xb23e0000
.long 0xb61f0000,0xbb640000,0xbbd90000,0xb23e0000,0xbb640000,0x361f0000,0xb23e0000,0x3bd90000
.long 0xbb640000,0x361f0000,0xb8720000,0xbaa70000,0xb61f0000,0xbb640000,0x3aa70000,0xb8720000
.long 0x3c00,0x3c00,0x3c00,0x3c00,0x3c00,0x3c00,0x3c00,0x3c00
.long 0x0,0x8000,0xb61f,0x361f,0xbc00,0x3c00,0xbb64,0x3b64
.long 0xbc00,0xbc00,0xb9a8,0xb9a8,0x8000,0x8000,0x39a8,0x39a8
.long 0x8000,0x0,0x3b64,0xbb64,0x3c00,0xbc00,0x361f,0xb61f
.long 0x39a80000,0xb9a80000,0x38720000,0xbaa70000,0xb9a80000,0xb9a80000,0xbaa70000,0xb8720000
.long 0xb9a80000,0x39a80000,0xbbd90000,0x323e0000,0xb9a80000,0xb9a80000,0xb23e0000,0xbbd90000
.long 0xb9a80000,0x39a80000,0x323e0000,0x3bd90000,0x39a80000,0x39a80000,0x3bd90000,0xb23e0000
.long 0x39a80000,0xb9a80000,0x3aa70000,0x38720000,0x39a80000,0x39a80000,0xb8720000,0x3aa70000
.long 0x3c00,0x3c00,0x3c00,0x3c00,0xbc00,0xbc00,0xbc00,0xbc00
.long 0xb9a8,0x39a8,0xbb64,0x3b64,0xb9a8,0x39a8,0xb61f,0x361f
.long 0x8000,0x8000,0x39a8,0x39a8,0x3c00,0x3c00,0x39a8,0x39a8
.long 0x39a8,0xb9a8,0xb61f,0x361f,0xb9a8,0x39a8,0xbb64,0x3b64
.long 0x361f0000,0xbb640000,0x323e0000,0xbbd90000,0xbb640000,0xb61f0000,0xbbd90000,0xb23e0000
.long 0xbb640000,0xb61f0000,0xb8720000,0xbaa70000,0x361f0000,0xbb640000,0x3aa70000,0xb8720000
.long 0x3b640000,0x361f0000,0x3aa70000,0xb8720000,0x361f0000,0xbb640000,0xb8720000,0xbaa70000
.long 0xb61f0000,0x3b640000,0xbbd90000,0xb23e0000,0xbb640000,0xb61f0000,0x323e0000,0xbbd90000
.long 0x3c00,0x3c00,0x3c00,0x3c00,0x3c00,0x3c00,0x3c00,0x3c00
.long 0x3bfe,0xbbfe,0x39ed,0xb9ed,0xaa48,0x2a48,0xb95f,0x395f
.long 0x3bf6,0x3bf6,0x2e46,0x2e46,0xae46,0xae46,0xbbf6,0xbbf6
.long 0x3bea,0xbbea,0xb8c4,0x38c4,0xb0b2,0x30b2,0xba6d,0x3a6d
.long 0x3bff0000,0xa6480000,0x3b770000,0xb5c20000,0xa6480000,0xbbff0000,0xb5c20000,0xbb770000
.long 0x3bfa0000,0x2cb50000,0x37320000,0x3b250000,0xacb50000,0x3bfa0000,0xbb250000,0x37320000
.long 0x3bf10000,0xafd60000,0xb4440000,0xbbb60000,0xafd60000,0xbbf10000,0xbbb60000,0x34440000
.long 0x3be20000,0x31790000,0xbac20000,0x38480000,0xb1790000,0x3be20000,0xb8480000,0xbac20000
.long 0x3c00,0x3c00,0x3c00,0x3c00,0xbc00,0xbc00,0xbc00,0xbc00
.long 0x395f,0xb95f,0x2a48,0xaa48,0xb9ed,0x39ed,0xbbfe,0x3bfe
.long 0xae46,0xae46,0xbbf6,0xbbf6,0xbbf6,0xbbf6,0xae46,0xae46
.long 0xba6d,0x3a6d,0xb0b2,0x30b2,0xb8c4,0x38c4,0x3bea,0xbbea
.long 0x3b500000,0xb67c0000,0x39cb0000,0xb9840000,0xb67c0000,0xbb500000,0xb9840000,0xb9cb0000
.long 0x35050000,0x3b990000,0xb93a0000,0x3a0f0000,0xbb990000,0x35050000,0xba0f0000,0xb93a0000
.long 0xb7e30000,0xbaf60000,0xba4f0000,0x38ec0000,0xbaf60000,0x37e30000,0x38ec0000,0x3a4f0000
.long 0xbbce0000,0x33030000,0x389b0000,0xba8a0000,0xb3030000,0xbbce0000,0x3a8a0000,0x389b0000
.long 0x3c00,0x3c00,0x3c00,0x3c00,0x3c00,0x3c00,0x3c00,0x3c00
.long 0xaa48,0x2a48,0xb95f,0x395f,0xbbfe,0x3bfe,0xb9ed,0x39ed
.long 0xbbf6,0xbbf6,0xae46,0xae46,0x2e46,0x2e46,0x3bf6,0x3bf6
.long 0x30b2,0xb0b2,0x3a6d,0xba6d,0x3bea,0xbbea,0xb8c4,0x38c4
.long 0x39840000,0xb9cb0000,0x367c0000,0xbb500000,0xb9cb0000,0xb9840000,0xbb500000,0xb67c0000
.long 0xba0f0000,0x393a0000,0xbb990000,0xb5050000,0xb93a0000,0xba0f0000,0x35050000,0xbb990000
.long 0xb8ec0000,0x3a4f0000,0x3af60000,0x37e30000,0x3a4f0000,0x38ec0000,0x37e30000,0xbaf60000
.long 0x3a8a0000,0xb89b0000,0xb3030000,0x3bce0000,0x389b0000,0x3a8a0000,0xbbce0000,0xb3030000
.long 0x3c00,0x3c00,0x3c00,0x3c00,0xbc00,0xbc00,0xbc00,0xbc00
.long 0xb9ed,0x39ed,0xbbfe,0x3bfe,0xb95f,0x395f,0xaa48,0x2a48
.long 0x2e46,0x2e46,0x3bf6,0x3bf6,0x3bf6,0x3bf6,0x2e46,0x2e46
.long 0x38c4,0xb8c4,0xbbea,0x3bea,0xba6d,0x3a6d,0xb0b2,0x30b2
.long 0x35c20000,0xbb770000,0x26480000,0xbbff0000,0xbb770000,0xb5c20000,0xbbff0000,0xa6480000
.long 0xbb250000,0xb7320000,0xacb50000,0xbbfa0000,0x37320000,0xbb250000,0x3bfa0000,0xacb50000
.long 0x3bb60000,0x34440000,0x2fd60000,0xbbf10000,0x34440000,0xbbb60000,0xbbf10000,0xafd60000
.long 0xb8480000,0x3ac20000,0xb1790000,0xbbe20000,0xbac20000,0xb8480000,0x3be20000,0xb1790000
.long 0x3c00,0x3c00,0x3c00,0x3c00,0x3c00,0x3c00,0x3c00,0x3c00
.long 0x3bf6,0xbbf6,0x3a2f,0xba2f,0xae46,0x2e46,0xb913,0x3913
.long 0x3bd9,0x3bd9,0x323e,0x323e,0xb23e,0xb23e,0xbbd9,0xbbd9
.long 0x3ba8,0xbba8,0xb78b,0x378b,0xb4a5,0x34a5,0xbb0e,0x3b0e
.long 0x3bfe0000,0xaa480000,0x3b880000,0xb5640000,0xaa480000,0xbbfe0000,0xb5640000,0xbb880000
.long 0x3bea0000,0x30b20000,0x381d0000,0x3add0000,0xb0b20000,0x3bea0000,0xbadd0000,0x381d0000
.long 0x3bc30000,0xb3c60000,0xb0b20000,0xbbea0000,0xb3c60000,0xbbc30000,0xbbea0000,0x30b20000
.long 0x3b880000,0x35640000,0xb9ed0000,0x395f0000,0xb5640000,0x3b880000,0xb95f0000,0xb9ed0000
.long 0x3c00,0x3c00,0x3c00,0x3c00,0xbc00,0xbc00,0xbc00,0xbc00
.long 0x3913,0xb913,0x2e46,0xae46,0xba2f,0x3a2f,0xbbf6,0x3bf6
.long 0xb23e,0xb23e,0xbbd9,0xbbd9,0xbbd9,0xbbd9,0xb23e,0xb23e
.long 0xbb0e,0x3b0e,0xb4a5,0x34a5,0xb78b,0x378b,0x3ba8,0xbba8
.long 0x3b3b0000,0xb6d70000,0x39ed0000,0xb95f0000,0xb6d70000,0xbb3b0000,0xb95f0000,0xb9ed0000
.long 0x33c60000,0x3bc30000,0xb8c40000,0x3a6d0000,0xbbc30000,0x33c60000,0xba6d0000,0xb8c40000
.long 0xb8c40000,0xba6d0000,0xbadd0000,0x381d0000,0xba6d0000,0x38c40000,0x381d0000,0x3add0000
.long 0xbbfe0000,0x2a480000,0x36d70000,0xbb3b0000,0xaa480000,0xbbfe0000,0x3b3b0000,0x36d70000
.long 0x3c00,0x3c00,0x3c00,0x3c00,0x3c00,0x3c00,0x3c00,0x3c00
.long 0xae46,0x2e46,0xb913,0x3913,0xbbf6,0x3bf6,0xba2f,0x3a2f
.long 0xbbd9,0xbbd9,0xb23e,0xb23e,0x323e,0x323e,0x3bd9,0x3bd9
.long 0x34a5,0xb4a5,0x3b0e,0xbb0e,0x3ba8,0xbba8,0xb78b,0x378b
.long 0x395f0000,0xb9ed0000,0x36d70000,0xbb3b0000,0xb9ed0000,0xb95f0000,0xbb3b0000,0xb6d70000
.long 0xba6d0000,0x38c40000,0xbbc30000,0xb3c60000,0xb8c40000,0xba6d0000,0x33c60000,0xbbc30000
.long 0xb81d0000,0x3add0000,0x3a6d0000,0x38c40000,0x3add0000,0x381d0000,0x38c40000,0xba6d0000
.long 0x3b3b0000,0xb6d70000,0xaa480000,0x3bfe0000,0x36d70000,0x3b3b0000,0xbbfe0000,0xaa480000
.long 0x3c00,0x3c00,0x3c00,0x3c00,0xbc00,0xbc00,0xbc00,0xbc00
.long 0xba2f,0x3a2f,0xbbf6,0x3bf6,0xb913,0x3913,0xae46,0x2e46
.long 0x323e,0x323e,0x3bd9,0x3bd9,0x3bd9,0x3bd9,0x323e,0x323e
.long 0x378b,0xb78b,0xbba8,0x3ba8,0xbb0e,0x3b0e,0xb4a5,0x34a5
.long 0x35640000,0xbb880000,0x2a480000,0xbbfe0000,0xbb880000,0xb5640000,0xbbfe0000,0xaa480000
.long 0xbadd0000,0xb81d0000,0xb0b20000,0xbbea0000,0x381d0000,0xbadd0000,0x3bea0000,0xb0b20000
.long 0x3bea0000,0x30b20000,0x33c60000,0xbbc30000,0x30b20000,0xbbea0000,0xbbc30000,0xb3c60000
.long 0xb95f0000,0x39ed0000,0xb5640000,0xbb880000,0xb9ed0000,0xb95f0000,0x3b880000,0xb5640000
.long 0x3c00,0x3c00,0x3c00,0x3c00,0x3c00,0x3c00,0x3c00,0x3c00
.long 0x3bea,0xbbea,0x3a6d,0xba6d,0xb0b2,0x30b2,0xb8c4,0x38c4
.long 0x3ba8,0x3ba8,0x34a5,0x34a5,0xb4a5,0xb4a5,0xbba8,0xbba8
.long 0x3b3b,0xbb3b,0xb564,0x3564,0xb6d7,0x36d7,0xbb88,0x3b88
.long 0x3bfa0000,0xacb50000,0x3b990000,0xb5050000,0xacb50000,0xbbfa0000,0xb5050000,0xbb990000
.long 0x3bce0000,0x33030000,0x389b0000,0x3a8a0000,0xb3030000,0x3bce0000,0xba8a0000,0x389b0000
.long 0x3b770000,0xb5c20000,0xa6480000,0xbbff0000,0xb5c20000,0xbb770000,0xbbff0000,0x26480000
.long 0x3af60000,0x37e30000,0xb8ec0000,0x3a4f0000,0xb7e30000,0x3af60000,0xba4f0000,0xb8ec0000
.long 0x3c00,0x3c00,0x3c00,0x3c00,0xbc00,0xbc00,0xbc00,0xbc00
.long 0x38c4,0xb8c4,0x30b2,0xb0b2,0xba6d,0x3a6d,0xbbea,0x3bea
.long 0xb4a5,0xb4a5,0xbba8,0xbba8,0xbba8,0xbba8,0xb4a5,0xb4a5
.long 0xbb88,0x3b88,0xb6d7,0x36d7,0xb564,0x3564,0x3b3b,0xbb3b
.long 0x3b250000,0xb7320000,0x3a0f0000,0xb93a0000,0xb7320000,0xbb250000,0xb93a0000,0xba0f0000
.long 0x31790000,0x3be20000,0xb8480000,0x3ac20000,0xbbe20000,0x31790000,0xbac20000,0xb8480000
.long 0xb9840000,0xb9cb0000,0xbb500000,0x367c0000,0xb9cb0000,0x39840000,0x367c0000,0x3b500000
.long 0xbbf10000,0xafd60000,0x34440000,0xbbb60000,0x2fd60000,0xbbf10000,0x3bb60000,0x34440000
.long 0x3c00,0x3c00,0x3c00,0x3c00,0x3c00,0x3c00,0x3c00,0x3c00
.long 0xb0b2,0x30b2,0xb8c4,0x38c4,0xbbea,0x3bea,0xba6d,0x3a6d
.long 0xbba8,0xbba8,0xb4a5,0xb4a5,0x34a5,0x34a5,0x3ba8,0x3ba8
.long 0x36d7,0xb6d7,0x3b88,0xbb88,0x3b3b,0xbb3b,0xb564,0x3564
.long 0x393a0000,0xba0f0000,0x37320000,0xbb250000,0xba0f0000,0xb93a0000,0xbb250000,0xb7320000
.long 0xbac20000,0x38480000,0xbbe20000,0xb1790000,0xb8480000,0xbac20000,0x31790000,0xbbe20000
.long 0xb67c0000,0x3b500000,0x39cb0000,0x39840000,0x3b500000,0x367c0000,0x39840000,0xb9cb0000
.long 0x3bb60000,0xb4440000,0x2fd60000,0x3bf10000,0x34440000,0x3bb60000,0xbbf10000,0x2fd60000
.long 0x3c00,0x3c00,0x3c00,0x3c00,0xbc00,0xbc00,0xbc00,0xbc00
.long 0xba6d,0x3a6d,0xbbea,0x3bea,0xb8c4,0x38c4,0xb0b2,0x30b2
.long 0x34a5,0x34a5,0x3ba8,0x3ba8,0x3ba8,0x3ba8,0x34a5,0x34a5
.long 0x3564,0xb564,0xbb3b,0x3b3b,0xbb88,0x3b88,0xb6d7,0x36d7
.long 0x35050000,0xbb990000,0x2cb50000,0xbbfa0000,0xbb990000,0xb5050000,0xbbfa0000,0xacb50000
.long 0xba8a0000,0xb89b0000,0xb3030000,0xbbce0000,0x389b0000,0xba8a0000,0x3bce0000,0xb3030000
.long 0x3bff0000,0x26480000,0x35c20000,0xbb770000,0x26480000,0xbbff0000,0xbb770000,0xb5c20000
.long 0xba4f0000,0x38ec0000,0xb7e30000,0xbaf60000,0xb8ec0000,0xba4f0000,0x3af60000,0xb7e30000
.long 0x3c00,0x3c00,0x3c00,0x3c00,0x3c00,0x3c00,0x3c00,0x3c00
.long 0x3bd9,0xbbd9,0x3aa7,0xbaa7,0xb23e,0x323e,0xb872,0x3872
.long 0x3b64,0x3b64,0x361f,0x361f,0xb61f,0xb61f,0xbb64,0xbb64
.long 0x3aa7,0xbaa7,0xb23e,0x323e,0xb872,0x3872,0xbbd9,0x3bd9
.long 0x3bf60000,0xae460000,0x3ba80000,0xb4a50000,0xae460000,0xbbf60000,0xb4a50000,0xbba80000
.long 0x3ba80000,0x34a50000,0x39130000,0x3a2f0000,0xb4a50000,0x3ba80000,0xba2f0000,0x39130000
.long 0x3b0e0000,0xb78b0000,0x2e460000,0xbbf60000,0xb78b0000,0xbb0e0000,0xbbf60000,0xae460000
.long 0x3a2f0000,0x39130000,0xb78b0000,0x3b0e0000,0xb9130000,0x3a2f0000,0xbb0e0000,0xb78b0000
.long 0x3c00,0x3c00,0x3c00,0x3c00,0xbc00,0xbc00,0xbc00,0xbc00
.long 0x3872,0xb872,0x323e,0xb23e,0xbaa7,0x3aa7,0xbbd9,0x3bd9
.long 0xb61f,0xb61f,0xbb64,0xbb64,0xbb64,0xbb64,0xb61f,0xb61f
.long 0xbbd9,0x3bd9,0xb872,0x3872,0xb23e,0x323e,0x3aa7,0xbaa7
.long 0x3b0e0000,0xb78b0000,0x3a2f0000,0xb9130000,0xb78b0000,0xbb0e0000,0xb9130000,0xba2f0000
.long 0x2e460000,0x3bf60000,0xb78b0000,0x3b0e0000,0xbbf60000,0x2e460000,0xbb0e0000,0xb78b0000
.long 0xba2f0000,0xb9130000,0xbba80000,0x34a50000,0xb9130000,0x3a2f0000,0x34a50000,0x3ba80000
.long 0xbba80000,0xb4a50000,0x2e460000,0xbbf60000,0x34a50000,0xbba80000,0x3bf60000,0x2e460000
.long 0x3c00,0x3c00,0x3c00,0x3c00,0x3c00,0x3c00,0x3c00,0x3c00
.long 0xb23e,0x323e,0xb872,0x3872,0xbbd9,0x3bd9,0xbaa7,0x3aa7
.long 0xbb64,0xbb64,0xb61f,0xb61f,0x361f,0x361f,0x3b64,0x3b64
.long 0x3872,0xb872,0x3bd9,0xbbd9,0x3aa7,0xbaa7,0xb23e,0x323e
.long 0x39130000,0xba2f0000,0x378b0000,0xbb0e0000,0xba2f0000,0xb9130000,0xbb0e0000,0xb78b0000
.long 0xbb0e0000,0x378b0000,0xbbf60000,0xae460000,0xb78b0000,0xbb0e0000,0x2e460000,0xbbf60000
.long 0xb4a50000,0x3ba80000,0x39130000,0x3a2f0000,0x3ba80000,0x34a50000,0x3a2f0000,0xb9130000
.long 0x3bf60000,0xae460000,0x34a50000,0x3ba80000,0x2e460000,0x3bf60000,0xbba80000,0x34a50000
.long 0x3c00,0x3c00,0x3c00,0x3c00,0xbc00,0xbc00,0xbc00,0xbc00
.long 0xbaa7,0x3aa7,0xbbd9,0x3bd9,0xb872,0x3872,0xb23e,0x323e
.long 0x361f,0x361f,0x3b64,0x3b64,0x3b64,0x3b64,0x361f,0x361f
.long 0x323e,0xb23e,0xbaa7,0x3aa7,0xbbd9,0x3bd9,0xb872,0x3872
.long 0x34a50000,0xbba80000,0x2e460000,0xbbf60000,0xbba80000,0xb4a50000,0xbbf60000,0xae460000
.long 0xba2f0000,0xb9130000,0xb4a50000,0xbba80000,0x39130000,0xba2f0000,0x3ba80000,0xb4a50000
.long 0x3bf60000,0xae460000,0x378b0000,0xbb0e0000,0xae460000,0xbbf60000,0xbb0e0000,0xb78b0000
.long 0xbb0e0000,0x378b0000,0xb9130000,0xba2f0000,0xb78b0000,0xbb0e0000,0x3a2f0000,0xb9130000
.long 0x3c00,0x3c00,0x3c00,0x3c00,0x3c00,0x3c00,0x3c00,0x3c00
.long 0x3bc3,0xbbc3,0x3add,0xbadd,0xb3c6,0x33c6,0xb81d,0x381d
.long 0x3b0e,0x3b0e,0x378b,0x378b,0xb78b,0xb78b,0xbb0e,0xbb0e
.long 0x39ed,0xb9ed,0xaa48,0x2a48,0xb95f,0x395f,0xbbfe,0x3bfe
.long 0x3bf10000,0xafd60000,0x3bb60000,0xb4440000,0xafd60000,0xbbf10000,0xb4440000,0xbbb60000
.long 0x3b770000,0x35c20000,0x39840000,0x39cb0000,0xb5c20000,0x3b770000,0xb9cb0000,0x39840000
.long 0x3a8a0000,0xb89b0000,0x33030000,0xbbce0000,0xb89b0000,0xba8a0000,0xbbce0000,0xb3030000
.long 0x393a0000,0x3a0f0000,0xb5050000,0x3b990000,0xba0f0000,0x393a0000,0xbb990000,0xb5050000
.long 0x3c00,0x3c00,0x3c00,0x3c00,0xbc00,0xbc00,0xbc00,0xbc00
.long 0x381d,0xb81d,0x33c6,0xb3c6,0xbadd,0x3add,0xbbc3,0x3bc3
.long 0xb78b,0xb78b,0xbb0e,0xbb0e,0xbb0e,0xbb0e,0xb78b,0xb78b
.long 0xbbfe,0x3bfe,0xb95f,0x395f,0xaa48,0x2a48,0x39ed,0xb9ed
.long 0x3af60000,0xb7e30000,0x3a4f0000,0xb8ec0000,0xb7e30000,0xbaf60000,0xb8ec0000,0xba4f0000
.long 0x26480000,0x3bff0000,0xb67c0000,0x3b500000,0xbbff0000,0x26480000,0xbb500000,0xb67c0000
.long 0xbac20000,0xb8480000,0xbbe20000,0x31790000,0xb8480000,0x3ac20000,0x31790000,0x3be20000
.long 0xbb250000,0xb7320000,0xacb50000,0xbbfa0000,0x37320000,0xbb250000,0x3bfa0000,0xacb50000
.long 0x3c00,0x3c00,0x3c00,0x3c00,0x3c00,0x3c00,0x3c00,0x3c00
.long 0xb3c6,0x33c6,0xb81d,0x381d,0xbbc3,0x3bc3,0xbadd,0x3add
.long 0xbb0e,0xbb0e,0xb78b,0xb78b,0x378b,0x378b,0x3b0e,0x3b0e
.long 0x395f,0xb95f,0x3bfe,0xbbfe,0x39ed,0xb9ed,0xaa48,0x2a48
.long 0x38ec0000,0xba4f0000,0x37e30000,0xbaf60000,0xba4f0000,0xb8ec0000,0xbaf60000,0xb7e30000
.long 0xbb500000,0x367c0000,0xbbff0000,0xa6480000,0xb67c0000,0xbb500000,0x26480000,0xbbff0000
.long 0xb1790000,0x3be20000,0x38480000,0x3ac20000,0x3be20000,0x31790000,0x3ac20000,0xb8480000
.long 0x3bfa0000,0x2cb50000,0x37320000,0x3b250000,0xacb50000,0x3bfa0000,0xbb250000,0x37320000
.long 0x3c00,0x3c00,0x3c00,0x3c00,0xbc00,0xbc00,0xbc00,0xbc00
.long 0xbadd,0x3add,0xbbc3,0x3bc3,0xb81d,0x381d,0xb3c6,0x33c6
.long 0x378b,0x378b,0x3b0e,0x3b0e,0x3b0e,0x3b0e,0x378b,0x378b
.long 0x2a48,0xaa48,0xb9ed,0x39ed,0xbbfe,0x3bfe,0xb95f,0x395f
.long 0x34440000,0xbbb60000,0x2fd60000,0xbbf10000,0xbbb60000,0xb4440000,0xbbf10000,0xafd60000
.long 0xb9cb0000,0xb9840000,0xb5c20000,0xbb770000,0x39840000,0xb9cb0000,0x3b770000,0xb5c20000
.long 0x3bce0000,0xb3030000,0x389b0000,0xba8a0000,0xb3030000,0xbbce0000,0xba8a0000,0xb89b0000
.long 0xbb990000,0x35050000,0xba0f0000,0xb93a0000,0xb5050000,0xbb990000,0x393a0000,0xba0f0000
.long 0x3c00,0x3c00,0x3c00,0x3c00,0x3c00,0x3c00,0x3c00,0x3c00
.long 0x3ba8,0xbba8,0x3b0e,0xbb0e,0xb4a5,0x34a5,0xb78b,0x378b
.long 0x3aa7,0x3aa7,0x3872,0x3872,0xb872,0xb872,0xbaa7,0xbaa7
.long 0x3913,0xb913,0x2e46,0xae46,0xba2f,0x3a2f,0xbbf6,0x3bf6
.long 0x3bea0000,0xb0b20000,0x3bc30000,0xb3c60000,0xb0b20000,0xbbea0000,0xb3c60000,0xbbc30000
.long 0x3b3b0000,0x36d70000,0x39ed0000,0x395f0000,0xb6d70000,0x3b3b0000,0xb95f0000,0x39ed0000
.long 0x39ed0000,0xb95f0000,0x35640000,0xbb880000,0xb95f0000,0xb9ed0000,0xbb880000,0xb5640000
.long 0x381d0000,0x3add0000,0xb0b20000,0x3bea0000,0xbadd0000,0x381d0000,0xbbea0000,0xb0b20000
.long 0x3c00,0x3c00,0x3c00,0x3c00,0xbc00,0xbc00,0xbc00,0xbc00
.long 0x378b,0xb78b,0x34a5,0xb4a5,0xbb0e,0x3b0e,0xbba8,0x3ba8
.long 0xb872,0xb872,0xbaa7,0xbaa7,0xbaa7,0xbaa7,0xb872,0xb872
.long 0xbbf6,0x3bf6,0xba2f,0x3a2f,0x2e46,0xae46,0x3913,0xb913
.long 0x3add0000,0xb81d0000,0x3a6d0000,0xb8c40000,0xb81d0000,0xbadd0000,0xb8c40000,0xba6d0000
.long 0xaa480000,0x3bfe0000,0xb5640000,0x3b880000,0xbbfe0000,0xaa480000,0xbb880000,0xb5640000
.long 0xbb3b0000,0xb6d70000,0xbbfe0000,0x2a480000,0xb6d70000,0x3b3b0000,0x2a480000,0x3bfe0000
.long 0xba6d0000,0xb8c40000,0xb3c60000,0xbbc30000,0x38c40000,0xba6d0000,0x3bc30000,0xb3c60000
.long 0x3c00,0x3c00,0x3c00,0x3c00,0x3c00,0x3c00,0x3c00,0x3c00
.long 0xb4a5,0x34a5,0xb78b,0x378b,0xbba8,0x3ba8,0xbb0e,0x3b0e
.long 0xbaa7,0xbaa7,0xb872,0xb872,0x3872,0x3872,0x3aa7,0x3aa7
.long 0x3a2f,0xba2f,0x3bf6,0xbbf6,0x3913,0xb913,0x2e46,0xae46
.long 0x38c40000,0xba6d0000,0x381d0000,0xbadd0000,0xba6d0000,0xb8c40000,0xbadd0000,0xb81d0000
.long 0xbb880000,0x35640000,0xbbfe0000,0x2a480000,0xb5640000,0xbb880000,0xaa480000,0xbbfe0000
.long 0xaa480000,0x3bfe0000,0x36d70000,0x3b3b0000,0x3bfe0000,0x2a480000,0x3b3b0000,0xb6d70000
.long 0x3bc30000,0x33c60000,0x38c40000,0x3a6d0000,0xb3c60000,0x3bc30000,0xba6d0000,0x38c40000
.long 0x3c00,0x3c00,0x3c00,0x3c00,0xbc00,0xbc00,0xbc00,0xbc00
.long 0xbb0e,0x3b0e,0xbba8,0x3ba8,0xb78b,0x378b,0xb4a5,0x34a5
.long 0x3872,0x3872,0x3aa7,0x3aa7,0x3aa7,0x3aa7,0x3872,0x3872
.long 0xae46,0x2e46,0xb913,0x3913,0xbbf6,0x3bf6,0xba2f,0x3a2f
.long 0x33c60000,0xbbc30000,0x30b20000,0xbbea0000,0xbbc30000,0xb3c60000,0xbbea0000,0xb0b20000
.long 0xb95f0000,0xb9ed0000,0xb6d70000,0xbb3b0000,0x39ed0000,0xb95f0000,0x3b3b0000,0xb6d70000
.long 0x3b880000,0xb5640000,0x395f0000,0xb9ed0000,0xb5640000,0xbb880000,0xb9ed0000,0xb95f0000
.long 0xbbea0000,0x30b20000,0xbadd0000,0xb81d0000,0xb0b20000,0xbbea0000,0x381d0000,0xbadd0000
.long 0x3c00,0x3c00,0x3c00,0x3c00,0x3c00,0x3c00,0x3c00,0x3c00
.long 0x3b88,0xbb88,0x3b3b,0xbb3b,0xb564,0x3564,0xb6d7,0x36d7
.long 0x3a2f,0x3a2f,0x3913,0x3913,0xb913,0xb913,0xba2f,0xba2f
.long 0x381d,0xb81d,0x33c6,0xb3c6,0xbadd,0x3add,0xbbc3,0x3bc3
.long 0x3be20000,0xb1790000,0x3bce0000,0xb3030000,0xb1790000,0xbbe20000,0xb3030000,0xbbce0000
.long 0x3af60000,0x37e30000,0x3a4f0000,0x38ec0000,0xb7e30000,0x3af60000,0xb8ec0000,0x3a4f0000
.long 0x393a0000,0xba0f0000,0x37320000,0xbb250000,0xba0f0000,0xb93a0000,0xbb250000,0xb7320000
.long 0x35c20000,0x3b770000,0x26480000,0x3bff0000,0xbb770000,0x35c20000,0xbbff0000,0x26480000
.long 0x3c00,0x3c00,0x3c00,0x3c00,0xbc00,0xbc00,0xbc00,0xbc00
.long 0x36d7,0xb6d7,0x3564,0xb564,0xbb3b,0x3b3b,0xbb88,0x3b88
.long 0xb913,0xb913,0xba2f,0xba2f,0xba2f,0xba2f,0xb913,0xb913
.long 0xbbc3,0x3bc3,0xbadd,0x3add,0x33c6,0xb3c6,0x381d,0xb81d
.long 0x3ac20000,0xb8480000,0x3a8a0000,0xb89b0000,0xb8480000,0xbac20000,0xb89b0000,0xba8a0000
.long 0xafd60000,0x3bf10000,0xb4440000,0x3bb60000,0xbbf10000,0xafd60000,0xbbb60000,0xb4440000
.long 0xbb990000,0xb5050000,0xbbfa0000,0xacb50000,0xb5050000,0x3b990000,0xacb50000,0x3bfa0000
.long 0xb9840000,0xb9cb0000,0xb67c0000,0xbb500000,0x39cb0000,0xb9840000,0x3b500000,0xb67c0000
.long 0x3c00,0x3c00,0x3c00,0x3c00,0x3c00,0x3c00,0x3c00,0x3c00
.long 0xb564,0x3564,0xb6d7,0x36d7,0xbb88,0x3b88,0xbb3b,0x3b3b
.long 0xba2f,0xba2f,0xb913,0xb913,0x3913,0x3913,0x3a2f,0x3a2f
.long 0x3add,0xbadd,0x3bc3,0xbbc3,0x381d,0xb81d,0x33c6,0xb3c6
.long 0x389b0000,0xba8a0000,0x38480000,0xbac20000,0xba8a0000,0xb89b0000,0xbac20000,0xb8480000
.long 0xbbb60000,0x34440000,0xbbf10000,0x2fd60000,0xb4440000,0xbbb60000,0xafd60000,0xbbf10000
.long 0x2cb50000,0x3bfa0000,0x35050000,0x3b990000,0x3bfa0000,0xacb50000,0x3b990000,0xb5050000
.long 0x3b500000,0x367c0000,0x39cb0000,0x39840000,0xb67c0000,0x3b500000,0xb9840000,0x39cb0000
.long 0x3c00,0x3c00,0x3c00,0x3c00,0xbc00,0xbc00,0xbc00,0xbc00
.long 0xbb3b,0x3b3b,0xbb88,0x3b88,0xb6d7,0x36d7,0xb564,0x3564
.long 0x3913,0x3913,0x3a2f,0x3a2f,0x3a2f,0x3a2f,0x3913,0x3913
.long 0xb3c6,0x33c6,0xb81d,0x381d,0xbbc3,0x3bc3,0xbadd,0x3add
.long 0x33030000,0xbbce0000,0x31790000,0xbbe20000,0xbbce0000,0xb3030000,0xbbe20000,0xb1790000
.long 0xb8ec0000,0xba4f0000,0xb7e30000,0xbaf60000,0x3a4f0000,0xb8ec0000,0x3af60000,0xb7e30000
.long 0x3b250000,0xb7320000,0x3a0f0000,0xb93a0000,0xb7320000,0xbb250000,0xb93a0000,0xba0f0000
.long 0xbbff0000,0xa6480000,0xbb770000,0xb5c20000,0x26480000,0xbbff0000,0x35c20000,0xbb770000
.long 0x3c00,0x3c00,0x3c00,0x3c00,0x3c00,0xbc00,0x361f3b64,0xb61f3b64
.long 0x3c00,0x3c00,0x39a839a8,0xb9a839a8,0x3c00,0xbc00,0x3b64361f,0xbb64361f
.long 0x3c00,0x3c00,0x3c000000,0xbc008000,0x3c00,0xbc00,0x3b64b61f,0xbb64b61f
.long 0x3c00,0x3c00,0x39a8b9a8,0xb9a8b9a8,0x3c00,0xbc00,0x361fbb64,0xb61fbb64
.long 0x3c00,0x3c00,0xbc00,0xbc00,0x3c00,0xbc00,0xb61fbb64,0x361fbb64
.long 0x3c00,0x3c00,0xb9a8b9a8,0x39a8b9a8,0x3c00,0xbc00,0xbb64b61f,0x3b64b61f
.long 0x3c00,0x3c00,0xbc008000,0x3c000000,0x3c00,0xbc00,0xbb64361f,0x3b64361f
.long 0x3c00,0x3c00,0xb9a839a8,0x39a839a8,0x3c00,0xbc00,0xb61f3b64,0x361f3b64
.long 0x3c00,0x3c00,0x3c00,0x3c00,0x39a839a8,0xb9a839a8,0x3b64361f,0xbb64361f
.long 0x3c000000,0xbc008000,0x39a8b9a8,0xb9a8b9a8,0x39a8b9a8,0xb9a8b9a8,0xb61fbb64,0x361fbb64
.long 0xbc00,0xbc00,0xbc008000,0x3c000000,0xb9a8b9a8,0x39a8b9a8,0xb61f3b64,0x361f3b64
.long 0xbc008000,0x3c000000,0x39a839a8,0xb9a839a8,0xb9a839a8,0x39a839a8,0x3b64b61f,0xbb64b61f
.long 0x3c00,0x3c00,0xbc00,0xbc00,0x39a839a8,0xb9a839a8,0xbb64b61f,0x3b64b61f
.long 0x3c000000,0xbc008000,0xb9a839a8,0x39a839a8,0x39a8b9a8,0xb9a8b9a8,0x361f3b64,0xb61f3b64
.long 0xbc00,0xbc00,0x3c000000,0xbc008000,0xb9a8b9a8,0x39a8b9a8,0x361fbb64,0xb61fbb64
.long 0xbc008000,0x3c000000,0xb9a8b9a8,0x39a8b9a8,0xb9a839a8,0x39a839a8,0xbb64361f,0x3b64361f
.long 0x3c00,0x3c00,0x3c00,0x3c00,0x3c000000,0xbc008000,0x3b64b61f,0xbb64b61f
.long 0xbc00,0xbc00,0xb9a8b9a8,0x39a8b9a8,0xbc008000,0x3c000000,0xb61f3b64,0x361f3b64
.long 0x3c00,0x3c00,0x3c000000,0xbc008000,0x3c000000,0xbc008000,0xb61fbb64,0x361fbb64
.long 0xbc00,0xbc00,0xb9a839a8,0x39a839a8,0xbc008000,0x3c000000,0x3b64361f,0xbb64361f
.long 0x3c00,0x3c00,0xbc00,0xbc00,0x3c000000,0xbc008000,0xbb64361f,0x3b64361f
.long 0xbc00,0xbc00,0x39a839a8,0xb9a839a8,0xbc008000,0x3c000000,0x361fbb64,0xb61fbb64
.long 0x3c00,0x3c00,0xbc008000,0x3c000000,0x3c000000,0xbc008000,0x361f3b64,0xb61f3b64
.long 0xbc00,0xbc00,0x39a8b9a8,0xb9a8b9a8,0xbc008000,0x3c000000,0xbb64b61f,0x3b64b61f
.long 0x3c00,0x3c00,0x3c00,0x3c00,0x39a8b9a8,0xb9a8b9a8,0x361fbb64,0xb61fbb64
.long 0xbc008000,0x3c000000,0xb9a839a8,0x39a839a8,0x39a839a8,0xb9a839a8,0x3b64b61f,0xbb64b61f
.long 0xbc00,0xbc00,0xbc008000,0x3c000000,0xb9a839a8,0x39a839a8,0x3b64361f,0xbb64361f
.long 0x3c000000,0xbc008000,0xb9a8b9a8,0x39a8b9a8,0xb9a8b9a8,0x39a8b9a8,0x361f3b64,0xb61f3b64
.long 0x3c00,0x3c00,0xbc00,0xbc00,0x39a8b9a8,0xb9a8b9a8,0xb61f3b64,0x361f3b64
.long 0xbc008000,0x3c000000,0x39a8b9a8,0xb9a8b9a8,0x39a839a8,0xb9a839a8,0xbb64361f,0x3b64361f
.long 0xbc00,0xbc00,0x3c000000,0xbc008000,0xb9a839a8,0x39a839a8,0xbb64b61f,0x3b64b61f
.long 0x3c000000,0xbc008000,0x39a839a8,0xb9a839a8,0xb9a8b9a8,0x39a8b9a8,0xb61fbb64,0x361fbb64
.long 0x3c008000,0x3c008000,0x3c008000,0x3c008000,0x3c008000,0xbc008000,0x3b64b61f,0x3b64361f
.long 0x3c008000,0x3c008000,0x39a8b9a8,0x39a839a8,0x3c008000,0xbc008000,0x361fbb64,0x361f3b64
.long 0x3c008000,0x3c008000,0xbc00,0x80003c00,0x3c008000,0xbc008000,0xb61fbb64,0xb61f3b64
.long 0x3c008000,0x3c008000,0xb9a8b9a8,0xb9a839a8,0x3c008000,0xbc008000,0xbb64b61f,0xbb64361f
.long 0x3c008000,0x3c008000,0xbc008000,0xbc008000,0x3c008000,0xbc008000,0xbb64361f,0xbb64b61f
.long 0x3c008000,0x3c008000,0xb9a839a8,0xb9a8b9a8,0x3c008000,0xbc008000,0xb61f3b64,0xb61fbb64
.long 0x3c008000,0x3c008000,0x80003c00,0xbc00,0x3c008000,0xbc008000,0x361f3b64,0x361fbb64
.long 0x3c008000,0x3c008000,0x39a839a8,0x39a8b9a8,0x3c008000,0xbc008000,0x3b64361f,0x3b64b61f
.long 0x3c008000,0x3c008000,0x3c008000,0x3c008000,0x39a8b9a8,0x39a839a8,0x361fbb64,0x361f3b64
.long 0xbc00,0x80003c00,0xb9a8b9a8,0xb9a839a8,0xb9a8b9a8,0xb9a839a8,0xbb64361f,0xbb64b61f
.long 0xbc008000,0xbc008000,0x80003c00,0xbc00,0xb9a839a8,0xb9a8b9a8,0x3b64361f,0x3b64b61f
.long 0x80003c00,0xbc00,0x39a8b9a8,0x39a839a8,0x39a839a8,0x39a8b9a8,0xb61fbb64,0xb61f3b64
.long 0x3c008000,0x3c008000,0xbc008000,0xbc008000,0x39a8b9a8,0x39a839a8,0xb61f3b64,0xb61fbb64
.long 0xbc00,0x80003c00,0x39a839a8,0x39a8b9a8,0xb9a8b9a8,0xb9a839a8,0x3b64b61f,0x3b64361f
.long 0xbc008000,0xbc008000,0xbc00,0x80003c00,0xb9a839a8,0xb9a8b9a8,0xbb64b61f,0xbb64361f
.long 0x80003c00,0xbc00,0xb9a839a8,0xb9a8b9a8,0x39a839a8,0x39a8b9a8,0x361f3b64,0x361fbb64
.long 0x3c008000,0x3c008000,0x3c008000,0x3c008000,0xbc00,0x80003c00,0xb61fbb64,0xb61f3b64
.long 0xbc008000,0xbc008000,0xb9a839a8,0xb9a8b9a8,0x80003c00,0xbc00,0x3b64361f,0x3b64b61f
.long 0x3c008000,0x3c008000,0xbc00,0x80003c00,0xbc00,0x80003c00,0xbb64361f,0xbb64b61f
.long 0xbc008000,0xbc008000,0x39a839a8,0x39a8b9a8,0x80003c00,0xbc00,0x361fbb64,0x361f3b64
.long 0x3c008000,0x3c008000,0xbc008000,0xbc008000,0xbc00,0x80003c00,0x361f3b64,0x361fbb64
.long 0xbc008000,0xbc008000,0x39a8b9a8,0x39a839a8,0x80003c00,0xbc00,0xbb64b61f,0xbb64361f
.long 0x3c008000,0x3c008000,0x80003c00,0xbc00,0xbc00,0x80003c00,0x3b64b61f,0x3b64361f
.long 0xbc008000,0xbc008000,0xb9a8b9a8,0xb9a839a8,0x80003c00,0xbc00,0xb61f3b64,0xb61fbb64
.long 0x3c008000,0x3c008000,0x3c008000,0x3c008000,0xb9a8b9a8,0xb9a839a8,0xbb64b61f,0xbb64361f
.long 0x80003c00,0xbc00,0x39a839a8,0x39a8b9a8,0x39a8b9a8,0x39a839a8,0xb61fbb64,0xb61f3b64
.long 0xbc008000,0xbc008000,0x80003c00,0xbc00,0x39a839a8,0x39a8b9a8,0x361fbb64,0x361f3b64
.long 0xbc00,0x80003c00,0xb9a839a8,0xb9a8b9a8,0xb9a839a8,0xb9a8b9a8,0x3b64b61f,0x3b64361f
.long 0x3c008000,0x3c008000,0xbc008000,0xbc008000,0xb9a8b9a8,0xb9a839a8,0x3b64361f,0x3b64b61f
.long 0x80003c00,0xbc00,0xb9a8b9a8,0xb9a839a8,0x39a8b9a8,0x39a839a8,0x361f3b64,0x361fbb64
.long 0xbc008000,0xbc008000,0xbc00,0x80003c00,0x39a839a8,0x39a8b9a8,0xb61f3b64,0xb61fbb64
.long 0xbc00,0x80003c00,0x39a8b9a8,0x39a839a8,0xb9a839a8,0xb9a8b9a8,0xbb64361f,0xbb64b61f
.long 0x3800,0x3800,0x3800,0x3800,0x3c00,0xbc00,0x3b64,0x3b64
.long 0x3c00,0x3c00,0x39a8,0x39a8,0x3c00,0xbc00,0x361f,0x361f
.long 0x3c00,0x3c00,0x0,0x8000,0x3c00,0xbc00,0xb61f,0xb61f
.long 0x3c00,0x3c00,0xb9a8,0xb9a8,0x3c00,0xbc00,0xbb64,0xbb64
.long 0x3c000000,0x0,0x3bd90000,0xbbd90000,0x3c000000,0x80000000,0x3aa70000,0xbaa70000
.long 0x3c000000,0x0,0x38720000,0xb8720000,0x3c000000,0x80000000,0x323e0000,0xb23e0000
.long 0x3c000000,0x0,0xb23e0000,0x323e0000,0x3c000000,0x80000000,0xb8720000,0x38720000
.long 0x3c000000,0x0,0xbaa70000,0x3aa70000,0x3c000000,0x80000000,0xbbd90000,0x3bd90000
.long 0x3800,0x3800,0x3800,0x3800,0x39a8,0x39a8,0x361f,0x361f
.long 0x0,0x8000,0xb9a8,0xb9a8,0xb9a8,0xb9a8,0xbb64,0xbb64
.long 0xbc00,0xbc00,0x8000,0x0,0xb9a8,0xb9a8,0x3b64,0x3b64
.long 0x8000,0x0,0x39a8,0x39a8,0x39a8,0x39a8,0xb61f,0xb61f
.long 0x3b640000,0xbb640000,0x3aa70000,0xbaa70000,0x361f0000,0xb61f0000,0xb23e0000,0x323e0000
.long 0xb61f0000,0x361f0000,0xbbd90000,0x3bd90000,0xbb640000,0x3b640000,0xb8720000,0x38720000
.long 0xbb640000,0x3b640000,0x38720000,0xb8720000,0xb61f0000,0x361f0000,0x3bd90000,0xbbd90000
.long 0x361f0000,0xb61f0000,0x323e0000,0xb23e0000,0x3b640000,0xbb640000,0xbaa70000,0x3aa70000
.long 0x3800,0x3800,0x3800,0x3800,0x0,0x8000,0xb61f,0xb61f
.long 0xbc00,0xbc00,0xb9a8,0xb9a8,0x8000,0x0,0x3b64,0x3b64
.long 0x3c00,0x3c00,0x0,0x8000,0x0,0x8000,0xbb64,0xbb64
.long 0xbc00,0xbc00,0x39a8,0x39a8,0x8000,0x0,0x361f,0x361f
.long 0x39a80000,0xb9a80000,0x38720000,0xb8720000,0xb9a80000,0x39a80000,0xbbd90000,0x3bd90000
.long 0xb9a80000,0x39a80000,0x323e0000,0xb23e0000,0x39a80000,0xb9a80000,0x3aa70000,0xbaa70000
.long 0x39a80000,0xb9a80000,0xbaa70000,0x3aa70000,0xb9a80000,0x39a80000,0xb23e0000,0x323e0000
.long 0xb9a80000,0x39a80000,0x3bd90000,0xbbd90000,0x39a80000,0xb9a80000,0xb8720000,0x38720000
.long 0x3800,0x3800,0x3800,0x3800,0xb9a8,0xb9a8,0xbb64,0xbb64
.long 0x8000,0x0,0x39a8,0x39a8,0x39a8,0x39a8,0xb61f,0xb61f
.long 0xbc00,0xbc00,0x8000,0x0,0x39a8,0x39a8,0x361f,0x361f
.long 0x0,0x8000,0xb9a8,0xb9a8,0xb9a8,0xb9a8,0x3b64,0x3b64
.long 0x361f0000,0xb61f0000,0x323e0000,0xb23e0000,0xbb640000,0x3b640000,0xb8720000,0x38720000
.long 0x3b640000,0xbb640000,0x3aa70000,0xbaa70000,0xb61f0000,0x361f0000,0xbbd90000,0x3bd90000
.long 0xb61f0000,0x361f0000,0x3bd90000,0xbbd90000,0x3b640000,0xbb640000,0xbaa70000,0x3aa70000
.long 0xbb640000,0x3b640000,0x38720000,0xb8720000,0x361f0000,0xb61f0000,0xb23e0000,0x323e0000
.long 0x3800,0x3800,0xb800,0xb800,0x8000,0x8000,0xb61f,0x361f
.long 0x8000,0x8000,0xb9a8,0x39a8,0x8000,0x8000,0xbb64,0x3b64
.long 0x8000,0x8000,0xbc00,0x3c00,0x8000,0x8000,0xbb64,0x3b64
.long 0x8000,0x8000,0xb9a8,0x39a8,0x8000,0x8000,0xb61f,0x361f
.long 0x80000000,0xbc000000,0xb23e0000,0xb23e0000,0x80000000,0x3c000000,0xb8720000,0xb8720000
.long 0x80000000,0xbc000000,0xbaa70000,0xbaa70000,0x80000000,0x3c000000,0xbbd90000,0xbbd90000
.long 0x80000000,0xbc000000,0xbbd90000,0xbbd90000,0x80000000,0x3c000000,0xbaa70000,0xbaa70000
.long 0x80000000,0xbc000000,0xb8720000,0xb8720000,0x80000000,0x3c000000,0xb23e0000,0xb23e0000
.long 0x3800,0x3800,0xb800,0xb800,0xb9a8,0x39a8,0xbb64,0x3b64
.long 0xbc00,0x3c00,0xb9a8,0x39a8,0xb9a8,0x39a8,0x361f,0xb61f
.long 0x8000,0x8000,0x3c00,0xbc00,0x39a8,0xb9a8,0x361f,0xb61f
.long 0x3c00,0xbc00,0xb9a8,0x39a8,0x39a8,0xb9a8,0xbb64,0x3b64
.long 0xb61f0000,0xb61f0000,0xb8720000,0xb8720000,0xbb640000,0xbb640000,0xbbd90000,0xbbd90000
.long 0xbb640000,0xbb640000,0xb23e0000,0xb23e0000,0xb61f0000,0xb61f0000,0x3aa70000,0x3aa70000
.long 0x361f0000,0x361f0000,0x3aa70000,0x3aa70000,0x3b640000,0x3b640000,0xb23e0000,0xb23e0000
.long 0x3b640000,0x3b640000,0xbbd90000,0xbbd90000,0x361f0000,0x361f0000,0xb8720000,0xb8720000
.long 0x3800,0x3800,0xb800,0xb800,0xbc00,0x3c00,0xbb64,0x3b64
.long 0x8000,0x8000,0x39a8,0xb9a8,0x3c00,0xbc00,0x361f,0xb61f
.long 0x8000,0x8000,0xbc00,0x3c00,0xbc00,0x3c00,0x361f,0xb61f
.long 0x8000,0x8000,0x39a8,0xb9a8,0x3c00,0xbc00,0xbb64,0x3b64
.long 0xb9a80000,0xb9a80000,0xbaa70000,0xbaa70000,0xb9a80000,0xb9a80000,0xb23e0000,0xb23e0000
.long 0x39a80000,0x39a80000,0x3bd90000,0x3bd90000,0x39a80000,0x39a80000,0xb8720000,0xb8720000
.long 0xb9a80000,0xb9a80000,0xb8720000,0xb8720000,0xb9a80000,0xb9a80000,0x3bd90000,0x3bd90000
.long 0x39a80000,0x39a80000,0xb23e0000,0xb23e0000,0x39a80000,0x39a80000,0xbaa70000,0xbaa70000
.long 0x3800,0x3800,0xb800,0xb800,0xb9a8,0x39a8,0xb61f,0x361f
.long 0x3c00,0xbc00,0x39a8,0xb9a8,0xb9a8,0x39a8,0xbb64,0x3b64
.long 0x8000,0x8000,0x3c00,0xbc00,0x39a8,0xb9a8,0xbb64,0x3b64
.long 0xbc00,0x3c00,0x39a8,0xb9a8,0x39a8,0xb9a8,0xb61f,0x361f
.long 0xbb640000,0xbb640000,0xbbd90000,0xbbd90000,0x361f0000,0x361f0000,0x3aa70000,0x3aa70000
.long 0x361f0000,0x361f0000,0xb8720000,0xb8720000,0xbb640000,0xbb640000,0x323e0000,0x323e0000
.long 0x3b640000,0x3b640000,0x323e0000,0x323e0000,0xb61f0000,0xb61f0000,0xb8720000,0xb8720000
.long 0xb61f0000,0xb61f0000,0x3aa70000,0x3aa70000,0x3b640000,0x3b640000,0xbbd90000,0xbbd90000
tab_end:
.size tables, 36864
.section .rodata,"a"
.p2align 6
.amdhsa_kernel adaLN_cond__spectral_fnet__moe_arch_mod__prompt_kernel
  .amdhsa_next_free_vgpr 256
  .amdhsa_next_free_sgpr 102
  .amdhsa_accum_offset 256
  .amdhsa_group_segment_fixed_size 0
  .amdhsa_kernarg_size 120
  .amdhsa_user_sgpr_count 2
  .amdhsa_user_sgpr_kernarg_segment_ptr 1
  .amdhsa_system_sgpr_workgroup_id_x 1
  .amdhsa_float_denorm_mode_32 3
  .amdhsa_float_denorm_mode_16_64 3
.end_amdhsa_kernel
```

```asm
; @launch grid=(256,1,1) block=(512,1,1) lds=139264
.amdgcn_target "amdgcn-amd-amdhsa--gfx950"
.text
.globl adaLN_cond__spectral_fnet__moe_arch_mod__prompt_kernel
.p2align 8
.type adaLN_cond__spectral_fnet__moe_arch_mod__prompt_kernel,@function
adaLN_cond__spectral_fnet__moe_arch_mod__prompt_kernel:
    s_cmp_ge_u32 s2, 256
    s_cbranch_scc1 k_done
    s_load_dwordx2 s[4:5], s[0:1], 0
    s_load_dwordx8 s[20:27], s[0:1], 80
    s_load_dwordx2 s[6:7], s[0:1], 112
    s_load_dwordx8 s[48:55], s[0:1], 48
    s_getpc_b64 s[62:63]
k_pc:
    v_lshrrev_b32 v1, 6, v0
    v_and_b32 v2, 63, v0
    v_readfirstlane_b32 s16, v1
    v_lshlrev_b32 v3, 4, v2
    s_and_b32 s34, s2, 7
    s_lshr_b32 s35, s2, 4
    s_bitcmp1_b32 s2, 3
    s_cbranch_scc0 f_start
    s_lshl_b32 s40, s35, 3
    s_add_u32 s40, s40, s16
    s_lshl_b32 s40, s40, 9
    v_lshl_add_u32 v4, v2, 7, s40
    v_min_u32 v4, tab_end-k_pc-4, v4
    s_mov_b64 exec, 15
    global_load_dword v250, v4, s[62:63]
    s_mov_b64 exec, -1
    v_bfe_u32 v7, v0, 4, 2
    v_lshlrev_b32 v4, 1, v7
    v_xor_b32 v4, v4, v0
    v_and_b32 v4, 15, v4
    v_lshlrev_b32 v4, 4, v4
    s_movk_i32 s42, 12288
    v_mad_u32_u24 v4, v7, s42, v4
    v_xor_b32 v31, 0x80, v4
    s_and_b32 s17, s35, 7
    s_lshr_b32 s41, s35, 3
    s_lshl_b32 s18, s34, 3
    s_add_u32 s18, s18, s16
    s_mul_i32 s18, s18, 196608
    s_lshl_b32 s68, s16, 12
    s_xor_b32 s70, s35, 8
    s_lshl_b32 s70, s70, 8
    s_add_u32 s70, s70, s18
    s_mov_b32 s10, 12582912
    s_mov_b32 s11, 0x00020000
    s_mov_b32 m0, s68
    s_waitcnt lgkmcnt(0)
    s_mov_b32 s8, s22
    s_mov_b32 s9, s23
    buffer_load_dwordx4 v4, s[8:11], s70 offen offset:0  lds
    s_add_u32 s70, s70, 48128
    buffer_load_dwordx4 v4, s[8:11], s70 offen offset:1024  lds
    s_add_u32 s70, s70, 48128
    buffer_load_dwordx4 v31, s[8:11], s70 offen offset:2048  lds
    s_add_u32 s70, s70, 48128
    buffer_load_dwordx4 v31, s[8:11], s70 offen offset:3072  lds
    s_branch g_start
f_start:
    s_add_u32 s62, s62, tables-k_pc
    s_addc_u32 s63, s63, 0
    s_lshl_b32 s43, s16, 11
    v_add_u32 v79, s43, v3
    s_add_u32 s40, s43, 33280
    s_lshl_b32 s42, s16, 10
    s_add_u32 s43, s42, 16384
    s_cmp_eq_u32 s34, 0
    s_cselect_b32 s68, 8192, 0
    s_add_u32 s43, s43, s68
    v_add_u32 v77, s43, v3
    s_or_b32 s69, s34, s16
    s_cselect_b32 s68, 0, 2048
    s_add_u32 s68, s68, 32768
    v_add_u32 v78, s68, v3
    s_sub_u32 s17, 16, s34
    s_cmp_eq_u32 s34, 0
    s_cselect_b32 s17, 8, s17
    s_bitcmp1_b32 s35, 0
    s_cselect_b32 s17, s17, s34
    s_lshr_b32 s36, s35, 1
    s_lshl_b32 s36, s36, 4
    s_add_u32 s17, s17, s36
    s_lshl_b32 s36, s16, 8
    s_add_u32 s36, s36, s17
    s_lshl_b32 s36, s36, 11
    s_add_u32 s37, s36, 262144
    s_mov_b32 s10, 4194304
    s_mov_b32 s11, 0x00020000
    v_and_b32 v170, 15, v0
    v_bfe_u32 v171, v0, 4, 2
    v_lshrrev_b32 v72, 1, v170
    v_and_b32 v73, 1, v0
    v_cmp_eq_u32 vcc, 1, v170
    v_mov_b32 v74, s17
    s_nop 0
    v_cndmask_b32_e64 v72, v72, 8, vcc
    v_cndmask_b32_e64 v74, v74, 0, vcc
    v_cndmask_b32_e64 v73, v73, 0, vcc
    v_lshl_add_u32 v74, v171, 9, v74
    s_waitcnt lgkmcnt(0)
    s_mov_b32 s8, s4
    s_mov_b32 s9, s5
    buffer_load_dwordx4 v[32:35], v3, s[8:11], s36 offen offset:0
    buffer_load_dwordx4 v[40:43], v3, s[8:11], s37 offen offset:0
    buffer_load_dwordx4 v[36:39], v3, s[8:11], s36 offen offset:1024
    buffer_load_dwordx4 v[44:47], v3, s[8:11], s37 offen offset:1024
    s_mov_b32 s43, 6619136
    s_load_dword s101, s[6:7], s43
    s_mov_b32 s12, s6
    s_mov_b32 s13, s7
    s_mov_b32 s14, 268435456
    s_mov_b32 s15, 0x00020000
    s_mov_b32 s20, s52
    s_mov_b32 s21, s53
    s_mov_b32 s22, 7340032
    s_mov_b32 s23, 0x00020000
    s_mov_b32 s26, 4194304
    s_mov_b32 s27, 0x00020000
    s_getreg_b32 s39, hwreg(HW_REG_XCC_ID)
    s_and_b32 s39, s39, 7
    v_mul_u32_u24 v74, v72, v74
    v_lshl_add_u32 v74, v73, 9, v74
    v_lshlrev_b32 v72, 7, v72
    v_and_b32 v48, 2047, v74
    v_add_u32 v74, v74, v72
    v_and_b32 v49, 2047, v74
    v_add_u32 v74, v74, v72
    v_and_b32 v50, 2047, v74
    v_add_u32 v74, v74, v72
    v_and_b32 v51, 2047, v74
    v_cvt_f32_u32 v48, v48
    v_cvt_f32_u32 v49, v49
    v_cvt_f32_u32 v50, v50
    v_cvt_f32_u32 v51, v51
    v_mul_f32 v48, 0x3a000000, v48
    v_mul_f32 v49, 0x3a000000, v49
    v_mul_f32 v50, 0x3a000000, v50
    v_mul_f32 v51, 0x3a000000, v51
    v_cos_f32 v48, v48
    v_cos_f32 v49, v49
    v_cos_f32 v50, v50
    v_cos_f32 v51, v51
    v_mul_f32 v48, 0x3d800000, v48
    v_mul_f32 v49, 0x3d800000, v49
    v_mul_f32 v50, 0x3d800000, v50
    v_mul_f32 v51, 0x3d800000, v51
    v_lshlrev_b32 v160, 20, v171
    v_lshl_add_u32 v160, v1, 15, v160
    v_lshl_add_u32 v160, v170, 4, v160
    v_mul_u32_u24 v161, 4128, v1
    v_add_u32 v161, v161, v3
    v_lshrrev_b32 v72, 2, v2
    v_mul_u32_u24 v162, 2064, v72
    v_and_b32 v72, 3, v0
    v_lshl_add_u32 v162, v72, 7, v162
    v_lshl_add_u32 v162, v1, 3, v162
    v_lshlrev_b32 v163, 4, v171
    v_add_u32 v163, 103040, v163
    v_lshlrev_b32 v164, 3, v171
    v_add_u32 v164, 103104, v164
    v_lshrrev_b32 v72, 5, v0
    v_lshlrev_b32 v165, 2, v72
    v_add_u32 v11, 102912, v165
    v_add_u32 v165, 103040, v165
    v_lshlrev_b32 v166, 1, v72
    v_add_u32 v166, 103104, v166
    v_mov_b32 v168, 0
    v_and_b32 v169, 1, v0
    v_lshlrev_b32 v169, 3, v169
    s_lshl_b32 s3, s34, 4
    s_and_b32 s64, s35, 1
    s_lshl_b32 s64, s64, 3
    s_lshr_b32 s65, s35, 1
    s_add_u32 s64, s64, s65
    s_and_b32 s65, s16, 3
    s_xor_b32 s64, s64, s65
    s_add_u32 s64, s64, s3
    s_add_u32 s3, s3, s35
    s_lshl_b32 s64, s64, 8
    s_add_u32 s64, s64, 0
    s_add_u32 s65, s64, 262144
    s_add_u32 s66, s64, 524288
    s_add_u32 s67, s64, 786432
    s_mov_b32 s44, 0x3f803f80
    s_mov_b32 s46, 0x3a800000
    s_mov_b32 s33, 196611
    s_lshl_b32 s60, s35, 3
    s_add_u32 s60, s60, s16
    s_lshl_b32 s30, s60, 4
    s_add_u32 s30, s30, s34
    s_cmp_lg_u32 s34, 0
    s_cbranch_scc1 f_g1
    s_cmp_ge_u32 s16, 4
    s_cselect_b32 s31, 56, 0
    s_sub_u32 s30, s30, s31
    s_cmp_lg_u32 s16, 0
    s_cbranch_scc1 f_g1
    s_cmp_ge_u32 s35, 8
    s_cselect_b32 s31, 960, 0
    s_sub_u32 s30, s30, s31
f_g1:
    s_sub_u32 s31, 2048, s30
    s_cmp_eq_u32 s30, 0
    s_cselect_b32 s31, 1024, s31
    s_lshl_b32 s18, s30, 11
    s_lshl_b32 s19, s31, 11
    s_lshl_b32 s61, s34, 19
    s_add_u32 s61, s61, 0
    s_lshl_b32 s28, s60, 8
    s_add_u32 s28, s28, s61
    s_add_u32 s29, s28, 131072
    s_add_u32 s50, s28, 262144
    s_add_u32 s51, s28, 393216
    s_lshl_b32 s73, s35, 15
    s_add_u32 s73, s73, s61
    s_lshl_b32 s42, s16, 12
    s_add_u32 s72, s73, s42
    s_add_u32 s45, s42, 49664
    s_lshl_b32 s42, s16, 8
    s_add_u32 s74, s73, s42
    s_add_u32 s75, s74, 4096
    s_lshl_b32 s76, s34, 7
    s_add_u32 s77, s76, 6509568
    s_add_u32 s76, s76, 6508544
    s_lshl_b32 s78, s35, 3
    s_add_u32 s79, s78, s77
    s_add_u32 s78, s78, s76
    s_lshl_b32 s80, s3, 4
    s_add_u32 s80, s80, 4947968
    s_lshl_b32 s81, s34, 12
    s_add_u32 s81, s81, 4947968
    s_lshl_b32 s82, s35, 11
    s_add_u32 s82, s82, 6291456
    v_cvt_f32_u32 v75, v170
    s_lshl_b32 s42, s35, 2
    s_and_b32 s43, s16, 3
    s_add_u32 s42, s42, s43
    v_lshl_add_u32 v76, v171, 8, s42
    v_mul_f32 v75, 0x3a800000, v75
    v_cvt_f32_u32 v76, v76
    v_mul_f32 v60, v76, v75
    v_fmamk_f32 v61, v75, 0x42800000, v60
    v_fmamk_f32 v62, v75, 0x43000000, v60
    v_fmamk_f32 v63, v75, 0x43400000, v60
    v_cos_f32 v64, v60
    v_cos_f32 v65, v61
    v_cos_f32 v66, v62
    v_cos_f32 v67, v63
    v_sin_f32 v68, v60
    v_sin_f32 v69, v61
    v_sin_f32 v70, v62
    v_sin_f32 v71, v63
    v_cvt_pk_f16_f32 v144, v64, v68
    v_cvt_pk_f16_f32 v145, v65, v69
    v_cvt_pk_f16_f32 v146, v66, v70
    v_cvt_pk_f16_f32 v147, v67, v71
    s_mov_b32 m0, s40
    s_nop 0
    global_load_lds_dwordx4 v79, s[62:63]
    global_load_lds_dwordx4 v79, s[62:63] offset:1024
    global_load_dwordx4 v[20:23], v77, s[62:63]
    global_load_dwordx4 v[24:27], v78, s[62:63]
    global_load_dwordx4 v[28:31], v78, s[62:63] offset:1024
    s_waitcnt lgkmcnt(0)
    s_mul_i32 s32, s101, 0x9e3779b1
    s_or_b32 s32, s32, 0x101
    s_and_b32 s32, s32, 0xfffefbfb
    s_and_b32 s56, s32, 0xff
    s_bfe_u32 s57, s32, 0x80008
    s_bfe_u32 s58, s32, 0x80010
    s_lshr_b32 s59, s32, 24
    v_lshrrev_b32 v16, v169, s32
    v_lshrrev_b32 v17, 2, v16
    v_lshrrev_b32 v18, 4, v16
    v_lshrrev_b32 v19, 6, v16
    v_mov_b32 v72, s32
    v_mov_b32 v73, s39
    v_mov_b32 v74, 111488
    s_cmp_eq_u32 s16, 0
    s_cselect_b64 exec, 1, 0
    ds_write_b32 v74, v168 offset:4
    buffer_store_dwordx2 v[72:73], v168, s[12:15], s78 offen sc1
    s_mov_b64 exec, -1
    s_waitcnt vmcnt(9)
    ds_write_b128 v161, v[32:35] offset:0
    v_dot2_f32_bf16 v52, v32, s44, 0
    v_dot2_f32_bf16 v54, v32, v32, 0
    v_dot2_f32_bf16 v52, v33, s44, v52
    v_dot2_f32_bf16 v54, v33, v33, v54
    v_dot2_f32_bf16 v52, v34, s44, v52
    v_dot2_f32_bf16 v54, v34, v34, v54
    v_dot2_f32_bf16 v52, v35, s44, v52
    v_dot2_f32_bf16 v54, v35, v35, v54
    s_waitcnt vmcnt(8)
    ds_write_b128 v161, v[40:43] offset:2064
    v_dot2_f32_bf16 v53, v40, s44, 0
    v_dot2_f32_bf16 v55, v40, v40, 0
    v_dot2_f32_bf16 v53, v41, s44, v53
    v_dot2_f32_bf16 v55, v41, v41, v55
    v_dot2_f32_bf16 v53, v42, s44, v53
    v_dot2_f32_bf16 v55, v42, v42, v55
    v_dot2_f32_bf16 v53, v43, s44, v53
    v_dot2_f32_bf16 v55, v43, v43, v55
    s_waitcnt vmcnt(7)
    ds_write_b128 v161, v[36:39] offset:1024
    v_dot2_f32_bf16 v52, v36, s44, v52
    v_dot2_f32_bf16 v54, v36, v36, v54
    v_dot2_f32_bf16 v52, v37, s44, v52
    v_dot2_f32_bf16 v54, v37, v37, v54
    v_dot2_f32_bf16 v52, v38, s44, v52
    v_dot2_f32_bf16 v54, v38, v38, v54
    v_dot2_f32_bf16 v52, v39, s44, v52
    v_dot2_f32_bf16 v54, v39, v39, v54
    s_waitcnt vmcnt(6)
    ds_write_b128 v161, v[44:47] offset:3088
    v_dot2_f32_bf16 v53, v44, s44, v53
    v_dot2_f32_bf16 v55, v44, v44, v55
    v_dot2_f32_bf16 v53, v45, s44, v53
    v_dot2_f32_bf16 v55, v45, v45, v55
    v_dot2_f32_bf16 v53, v46, s44, v53
    v_dot2_f32_bf16 v55, v46, v46, v55
    v_dot2_f32_bf16 v53, v47, s44, v53
    v_dot2_f32_bf16 v55, v47, v47, v55
    s_nop 2
    v_permlane32_swap_b32 v52, v53
    v_permlane32_swap_b32 v54, v55
    v_add_f32 v52, v52, v53
    v_add_f32 v54, v54, v55
    s_nop 0
    v_add_f32_dpp v52, v52, v52 row_ror:8 row_mask:0xf bank_mask:0xf
    v_add_f32_dpp v54, v54, v54 row_ror:8 row_mask:0xf bank_mask:0xf
    s_nop 0
    v_add_f32_dpp v52, v52, v52 row_ror:4 row_mask:0xf bank_mask:0xf
    v_add_f32_dpp v54, v54, v54 row_ror:4 row_mask:0xf bank_mask:0xf
    s_nop 0
    v_add_f32_dpp v52, v52, v52 row_ror:2 row_mask:0xf bank_mask:0xf
    v_add_f32_dpp v54, v54, v54 row_ror:2 row_mask:0xf bank_mask:0xf
    s_nop 0
    v_add_f32_dpp v52, v52, v52 row_ror:1 row_mask:0xf bank_mask:0xf
    v_add_f32_dpp v54, v54, v54 row_ror:1 row_mask:0xf bank_mask:0xf
    s_nop 0
    v_add_f32_dpp v52, v52, v52 row_bcast:15 row_mask:0xa bank_mask:0xf
    v_add_f32_dpp v54, v54, v54 row_bcast:15 row_mask:0xa bank_mask:0xf
    v_mul_f32 v52, s46, v52
    v_mul_f32 v54, s46, v54
    v_mul_f32 v64, v52, v52
    v_cvt_pk_bf16_f32 v56, -v52, -v52
    v_sub_f32 v54, v54, v64
    v_mul_f32 v66, 0x44000000, v54
    v_cmp_gt_f32 vcc, v64, v66
    s_or_b32 s68, vcc_lo, vcc_hi
    s_bitcmp1_b32 s68, 31
    s_cbranch_scc1 f_slowvar
f_var:
    v_cvt_pk_bf16_f32 v54, v54, v54
    v_lshlrev_b32 v54, 16, v54
    v_add_f32 v54, 0x3727c5ac, v54
    v_cvt_pk_bf16_f32 v54, v54, v54
    v_lshlrev_b32 v54, 16, v54
    v_sqrt_f32 v54, v54
    s_nop 0
    v_cvt_pk_bf16_f32 v54, v54, v54
    v_lshlrev_b32 v54, 16, v54
    v_rcp_f32 v54, v54
    s_mov_b32 exec_lo, 0x80000000
    s_mov_b32 exec_hi, 0x80000000
    ds_write_b16 v166, v56
    ds_write_b32 v165, v54
    s_mov_b64 exec, -1
    s_waitcnt lgkmcnt(0)
    s_barrier
    ds_read_b128 v[60:63], v163
    ds_read_b64 v[64:65], v164
    ds_read_b64_tr_b16 v[80:81], v162 offset:0
    ds_read_b64_tr_b16 v[82:83], v162 offset:512
    ds_read_b64_tr_b16 v[84:85], v162 offset:1024
    ds_read_b64_tr_b16 v[86:87], v162 offset:1536
    ds_read_b64_tr_b16 v[88:89], v162 offset:64
    ds_read_b64_tr_b16 v[90:91], v162 offset:576
    ds_read_b64_tr_b16 v[92:93], v162 offset:1088
    ds_read_b64_tr_b16 v[94:95], v162 offset:1600
    s_waitcnt lgkmcnt(8)
    v_pk_mul_f32 v[48:49], v[48:49], v[60:61]
    v_pk_mul_f32 v[50:51], v[50:51], v[62:63]
    v_cvt_pk_bf16_f32 v58, v48, v49
    v_cvt_pk_bf16_f32 v59, v50, v51
    s_nop 1
    v_mfma_f32_16x16x16_bf16 v[96:99], v[58:59], v[64:65], 0
    s_waitcnt lgkmcnt(0)
    v_mfma_f32_16x16x16_bf16 v[100:103], v[58:59], v[80:81], v[96:99]
    v_mfma_f32_16x16x16_bf16 v[104:107], v[58:59], v[82:83], v[96:99]
    v_mfma_f32_16x16x16_bf16 v[108:111], v[58:59], v[84:85], v[96:99]
    v_mfma_f32_16x16x16_bf16 v[112:115], v[58:59], v[86:87], v[96:99]
    v_mfma_f32_16x16x16_bf16 v[116:119], v[58:59], v[88:89], v[96:99]
    v_mfma_f32_16x16x16_bf16 v[120:123], v[58:59], v[90:91], v[96:99]
    v_mfma_f32_16x16x16_bf16 v[124:127], v[58:59], v[92:93], v[96:99]
    v_mfma_f32_16x16x16_bf16 v[128:131], v[58:59], v[94:95], v[96:99]
    s_nop 0
    v_cvt_pk_f16_f32 v176, v100, v101
    v_cvt_pk_f16_f32 v177, v104, v105
    v_cvt_pk_f16_f32 v178, v108, v109
    v_cvt_pk_f16_f32 v179, v112, v113
    v_bfi_b32 v176, s33, v16, v176
    v_bfi_b32 v177, s33, v17, v177
    v_bfi_b32 v178, s33, v18, v178
    v_bfi_b32 v179, s33, v19, v179
    buffer_store_dwordx4 v[176:179], v160, s[12:15], s64 offen sc1
    v_cvt_pk_f16_f32 v180, v102, v103
    v_cvt_pk_f16_f32 v181, v106, v107
    v_cvt_pk_f16_f32 v182, v110, v111
    v_cvt_pk_f16_f32 v183, v114, v115
    v_bfi_b32 v180, s33, v16, v180
    v_bfi_b32 v181, s33, v17, v181
    v_bfi_b32 v182, s33, v18, v182
    v_bfi_b32 v183, s33, v19, v183
    buffer_store_dwordx4 v[180:183], v160, s[12:15], s66 offen sc1
    v_cvt_pk_f16_f32 v184, v116, v117
    v_cvt_pk_f16_f32 v185, v120, v121
    v_cvt_pk_f16_f32 v186, v124, v125
    v_cvt_pk_f16_f32 v187, v128, v129
    v_bfi_b32 v184, s33, v16, v184
    v_bfi_b32 v185, s33, v17, v185
    v_bfi_b32 v186, s33, v18, v186
    v_bfi_b32 v187, s33, v19, v187
    buffer_store_dwordx4 v[184:187], v160, s[12:15], s65 offen sc1
    v_cvt_pk_f16_f32 v188, v118, v119
    v_cvt_pk_f16_f32 v189, v122, v123
    v_cvt_pk_f16_f32 v190, v126, v127
    v_cvt_pk_f16_f32 v191, v130, v131
    v_bfi_b32 v188, s33, v16, v188
    v_bfi_b32 v189, s33, v17, v189
    v_bfi_b32 v190, s33, v18, v190
    v_bfi_b32 v191, s33, v19, v191
    buffer_store_dwordx4 v[188:191], v160, s[12:15], s67 offen sc1
    s_waitcnt vmcnt(4)
    s_barrier
    v_mov_b32 v48, v170
    v_mov_b32 v49, v171
    v_mov_b32 v50, s32
    v_mov_b32 v51, s39
    s_cmp_lg_u32 s16, 0
    s_cbranch_scc1 f_nzl
    s_lshl_b32 s68, s3, 7
    s_add_u32 s68, s68, 6520832
    v_mov_b32 v52, 0
    s_mov_b64 exec, 1
    buffer_store_dwordx2 v[50:51], v52, s[12:15], s68 offen sc1
    s_mov_b64 exec, -1
f_nzl:
    ds_read_b128 v[192:195], v3 offset:33280
    ds_read_b128 v[196:199], v3 offset:34304
    ds_read_b128 v[200:203], v3 offset:35328
    ds_read_b128 v[204:207], v3 offset:36352
    ds_read_b128 v[208:211], v3 offset:37376
    ds_read_b128 v[212:215], v3 offset:38400
    ds_read_b128 v[216:219], v3 offset:39424
    ds_read_b128 v[220:223], v3 offset:40448
    ds_read_b128 v[224:227], v3 offset:41472
    ds_read_b128 v[228:231], v3 offset:42496
    ds_read_b128 v[232:235], v3 offset:43520
    ds_read_b128 v[236:239], v3 offset:44544
    v_lshlrev_b32 v4, 15, v49
    v_lshl_add_u32 v4, v48, 4, v4
    v_lshlrev_b32 v14, 13, v49
    v_lshl_add_u32 v14, v48, 4, v14
    v_lshl_add_u32 v254, v1, 10, v14
    v_xor_b32 v255, 64, v254
    v_lshrrev_b32 v57, 1, v1
    v_lshlrev_b32 v252, 13, v57
    v_and_b32 v57, 1, v1
    v_lshl_add_u32 v252, v57, 3, v252
    v_lshl_add_u32 v252, v49, 11, v252
    v_and_b32 v57, 3, v0
    v_lshl_add_u32 v252, v57, 8, v252
    v_lshrrev_b32 v58, 2, v48
    v_lshl_add_u32 v252, v58, 4, v252
    v_and_b32 v59, 1, v0
    v_lshl_add_u32 v252, v59, 6, v252
    v_xor_b32 v253, 64, v252
    v_lshl_add_u32 v57, v49, 2, v57
    v_lshlrev_b32 v57, 4, v57
    v_lshl_add_u32 v250, v58, 8, v57
    v_add_u32 v5, 82432, v3
    v_sub_u32 v6, 83440, v3
    v_lshl_add_u32 v57, v48, 2, v49
    v_lshl_add_u32 v8, v57, 3, s45
    s_add_u32 s43, s45, 2552
    v_lshlrev_b32 v58, 3, v57
    v_sub_u32 v9, s43, v58
    v_add_u32 v57, 1, v57
    v_and_b32 v58, 3, v57
    v_and_b32 v57, 60, v57
    v_lshl_add_u32 v7, v58, 6, v57
    v_add_u32 v10, s45, v3
    v_lshlrev_b32 v12, 2, v48
    v_add_u32 v12, 102912, v12
    v_lshlrev_b32 v13, 12, v2
    v_and_b32 v251, 0x70, v3
    v_lshlrev_b32 v15, 4, v0
    v_and_b32 v57, 3, v0
    v_bfe_u32 v58, v0, 2, 4
    v_lshl_add_u32 v57, v57, 4, v58
    v_bfe_u32 v58, v0, 6, 2
    v_lshl_add_u32 v57, v58, 6, v57
    v_lshrrev_b32 v58, 8, v0
    v_lshl_add_u32 v57, v58, 9, v57
    v_lshlrev_b32 v57, 4, v57
    v_add_u32 v1, 82432, v57
    s_and_b32 s42, s35, 3
    s_lshl_b32 s42, s42, 8
    v_xor_b32 v249, s42, v3
    s_mov_b32 s44, 131074
    v_and_b32 v16, s33, v16
    v_and_b32 v17, s33, v17
    v_and_b32 v18, s33, v18
    v_and_b32 v19, s33, v19
    v_xor_b32 v16, s44, v16
    v_xor_b32 v17, s44, v17
    v_xor_b32 v18, s44, v18
    v_xor_b32 v19, s44, v19
    s_mov_b32 s41, 6496256
    s_and_b32 s40, s16, 4
    s_lshl_b32 s40, s40, 10
    s_sub_u32 s40, 6504448, s40
    s_lshl_b32 s54, s3, 13
    s_add_u32 s54, s54, 5242880
    s_lshr_b32 s43, s60, 6
    s_and_b32 s55, s60, 63
    s_mul_i32 s55, s55, 5
    s_lshl_b32 s43, s43, 9
    s_add_u32 s55, s55, s43
    s_add_u32 s55, s55, 192
    s_mul_i32 s55, s55, 7168
    s_mul_i32 s43, s34, 896
    s_add_u32 s55, s55, s43
    s_mov_b32 s48, 4294967295
    s_mov_b32 s49, 255
    s_cmp_lt_u32 s16, 0
    s_cselect_b64 s[48:49], 0, s[48:49]
    s_mov_b32 s52, 6488064
    s_mov_b32 s53, 6492160
    s_barrier
    s_mov_b32 m0, s45
    s_add_u32 s43, s45, 2048
    buffer_load_dwordx4 v3, s[8:11], s18 offen lds
    buffer_load_dwordx4 v3, s[8:11], s18 offen offset:1024 lds
    s_mov_b32 m0, s43
    s_nop 0
    buffer_load_dwordx4 v3, s[8:11], s19 offen lds
    buffer_load_dwordx4 v3, s[8:11], s19 offen offset:1024 lds
    buffer_load_dwordx4 v[244:247], v251, s[12:15], s76 offen
    v_add_u32 v248, 103296, v3
    s_mov_b32 s47, 2
    s_mov_b32 s83, 0
    s_cmp_ge_u32 s16, 4
    s_cbranch_scc1 f_s0
    s_sleep 4
    s_cmp_lg_u32 s34, 0
    s_cbranch_scc1 f_ci0
    s_add_u32 s68, s82, 32768
    buffer_load_dwordx4 v[120:123], v250, s[12:15], s68 offen offset:0
    buffer_load_dwordx4 v[124:127], v250, s[12:15], s68 offen offset:1024
f_ci0:
    buffer_load_dwordx4 v[112:115], v250, s[12:15], s82 offen offset:0
    buffer_load_dwordx4 v[116:119], v250, s[12:15], s82 offen offset:1024
    s_mov_b32 s47, 0
    s_waitcnt vmcnt(0)
f_c1:
    v_xor_b32 v112, s56, v112
    v_xor_b32 v113, s57, v113
    v_xor_b32 v114, s58, v114
    v_xor_b32 v115, s59, v115
    v_xor_b32 v116, s56, v116
    v_xor_b32 v117, s57, v117
    v_xor_b32 v118, s58, v118
    v_xor_b32 v119, s59, v119
    v_or3_b32 v48, v112, v113, v114
    v_or3_b32 v48, v48, v115, v116
    v_or3_b32 v48, v48, v117, v118
    v_or_b32 v48, v48, v119
    v_and_b32 v48, 0xff, v48
    v_cmp_ne_u32 vcc, 0, v48
    s_cmp_lg_u32 s34, 0
    s_cbranch_scc1 f_c1n
    s_mov_b64 s[68:69], vcc
    v_xor_b32 v120, s56, v120
    v_xor_b32 v121, s57, v121
    v_xor_b32 v122, s58, v122
    v_xor_b32 v123, s59, v123
    v_xor_b32 v124, s56, v124
    v_xor_b32 v125, s57, v125
    v_xor_b32 v126, s58, v126
    v_xor_b32 v127, s59, v127
    v_or3_b32 v48, v120, v121, v122
    v_or3_b32 v48, v48, v123, v124
    v_or3_b32 v48, v48, v125, v126
    v_or_b32 v48, v48, v127
    v_and_b32 v48, 0xff, v48
    v_cmp_ne_u32 vcc, 0, v48
    s_or_b64 vcc, vcc, s[68:69]
f_c1n:
    s_cbranch_vccnz f_c1bad
f_c1ok:
    v_pk_add_f32 v[112:113], v[112:113], v[116:117]
    v_pk_add_f32 v[114:115], v[114:115], v[118:119]
    s_nop 0
    v_add_f32_dpp v112, v112, v112 row_ror:4 row_mask:0xf bank_mask:0xf
    v_add_f32_dpp v113, v113, v113 row_ror:4 row_mask:0xf bank_mask:0xf
    v_add_f32_dpp v114, v114, v114 row_ror:4 row_mask:0xf bank_mask:0xf
    v_add_f32_dpp v115, v115, v115 row_ror:4 row_mask:0xf bank_mask:0xf
    v_add_f32_dpp v112, v112, v112 row_ror:8 row_mask:0xf bank_mask:0xf
    v_add_f32_dpp v113, v113, v113 row_ror:8 row_mask:0xf bank_mask:0xf
    v_add_f32_dpp v114, v114, v114 row_ror:8 row_mask:0xf bank_mask:0xf
    v_add_f32_dpp v115, v115, v115 row_ror:8 row_mask:0xf bank_mask:0xf
    v_cvt_pk_bf16_f32 v48, v112, v113
    v_lshlrev_b32 v112, 16, v48
    v_and_b32 v113, 0xffff0000, v48
    v_cvt_pk_bf16_f32 v49, v114, v115
    v_lshlrev_b32 v114, 16, v49
    v_and_b32 v115, 0xffff0000, v49
    v_add_f32 v112, 1.0, v112
    v_add_f32 v113, 1.0, v113
    v_add_f32 v114, 1.0, v114
    v_add_f32 v115, 1.0, v115
    v_cvt_pk_bf16_f32 v48, v112, v113
    v_lshlrev_b32 v112, 16, v48
    v_and_b32 v113, 0xffff0000, v48
    v_cvt_pk_bf16_f32 v49, v114, v115
    v_lshlrev_b32 v114, 16, v49
    v_and_b32 v115, 0xffff0000, v49
    v_max_f32_e64 v48, abs(v112), abs(v113)
    v_max3_f32 v48, abs(v114), abs(v115), v48
    s_cmp_lg_u32 s34, 0
    s_cbranch_scc1 f_c1m
    v_mov_b32 v50, v48
    v_pk_add_f32 v[120:121], v[120:121], v[124:125]
    v_pk_add_f32 v[122:123], v[122:123], v[126:127]
    s_nop 0
    v_add_f32_dpp v120, v120, v120 row_ror:4 row_mask:0xf bank_mask:0xf
    v_add_f32_dpp v121, v121, v121 row_ror:4 row_mask:0xf bank_mask:0xf
    v_add_f32_dpp v122, v122, v122 row_ror:4 row_mask:0xf bank_mask:0xf
    v_add_f32_dpp v123, v123, v123 row_ror:4 row_mask:0xf bank_mask:0xf
    v_add_f32_dpp v120, v120, v120 row_ror:8 row_mask:0xf bank_mask:0xf
    v_add_f32_dpp v121, v121, v121 row_ror:8 row_mask:0xf bank_mask:0xf
    v_add_f32_dpp v122, v122, v122 row_ror:8 row_mask:0xf bank_mask:0xf
    v_add_f32_dpp v123, v123, v123 row_ror:8 row_mask:0xf bank_mask:0xf
    v_cvt_pk_bf16_f32 v48, v120, v121
    v_lshlrev_b32 v120, 16, v48
    v_and_b32 v121, 0xffff0000, v48
    v_cvt_pk_bf16_f32 v49, v122, v123
    v_lshlrev_b32 v122, 16, v49
    v_and_b32 v123, 0xffff0000, v49
    v_max3_f32 v48, abs(v120), abs(v121), v50
    v_max3_f32 v48, abs(v122), abs(v123), v48
f_c1m:
    s_nop 1
    v_max_f32_dpp v48, v48, v48 quad_perm:[1,0,3,2] row_mask:0xf bank_mask:0xf
    s_nop 1
    v_max_f32_dpp v48, v48, v48 quad_perm:[2,3,0,1] row_mask:0xf bank_mask:0xf
    s_nop 0
    v_readlane_b32 s68, v48, 0
    v_readlane_b32 s69, v48, 16
    v_readlane_b32 s70, v48, 32
    v_readlane_b32 s71, v48, 48
    s_max_u32 s68, s68, s69
    s_max_u32 s70, s70, s71
    s_max_u32 s68, s68, s70
    s_lshr_b32 s68, s68, 23
    s_sub_u32 s69, s68, 120
    s_sub_i32 s68, s68, 127
    s_max_i32 s68, s68, -100
    s_min_i32 s68, s68, 120
    s_cmp_le_u32 s69, 9
    s_cselect_b32 s68, 2, s68
    s_cselect_b32 s17, 0, 0x20000
    s_sub_i32 s69, 127, s68
    s_lshl_b32 s69, s69, 23
    s_bitcmp1_b32 s16, 0
    s_cselect_b64 s[64:65], -1, 0
    s_bitcmp1_b32 s16, 1
    s_cselect_b64 s[66:67], -1, 0
    s_lshl_b32 s70, s16, 11
    v_cndmask_b32 v112, v112, v113, s[64:65]
    v_cndmask_b32 v114, v114, v115, s[64:65]
    v_cndmask_b32 v112, v112, v114, s[66:67]
    v_mul_f32 v112, s69, v112
    v_add_u32 v53, s70, v248
    v_cvt_pk_f16_f32 v48, v112, v112
    s_nop 0
    s_nop 0
    v_mov_b32_dpp v56, v48 quad_perm:[0,0,0,0] row_mask:0xf bank_mask:0xf
    v_mov_b32_dpp v57, v48 quad_perm:[1,1,1,1] row_mask:0xf bank_mask:0xf
    v_mov_b32_dpp v58, v48 quad_perm:[2,2,2,2] row_mask:0xf bank_mask:0xf
    v_mov_b32_dpp v59, v48 quad_perm:[3,3,3,3] row_mask:0xf bank_mask:0xf
    v_pk_mul_f16 v64, v144, v56
    v_pk_mul_f16 v68, v144, v56 op_sel:[1,0] op_sel_hi:[0,1] neg_lo:[1,0]
    v_pk_mul_f16 v65, v145, v57
    v_pk_mul_f16 v69, v145, v57 op_sel:[1,0] op_sel_hi:[0,1] neg_lo:[1,0]
    v_pk_mul_f16 v66, v146, v58
    v_pk_mul_f16 v70, v146, v58 op_sel:[1,0] op_sel_hi:[0,1] neg_lo:[1,0]
    v_pk_mul_f16 v67, v147, v59
    v_pk_mul_f16 v71, v147, v59 op_sel:[1,0] op_sel_hi:[0,1] neg_lo:[1,0]
    ds_write_b128 v53, v[64:67]
    ds_write_b128 v53, v[68:71] offset:1024
    s_cmp_lg_u32 s16, 0
    s_cbranch_scc1 f_nkr
    v_mov_b32 v54, s17
    s_mov_b32 s61, s68
    s_mov_b64 exec, 1
    ds_write_b32 v248, v54 offset:8192
    s_mov_b64 exec, -1
f_nkr:
    s_cmp_eq_u32 s34, 0
    s_cbranch_scc1 f_sa
f_nsa:
    v_mov_b32 v54, 1
    s_mov_b64 exec, 1
    ds_add_u32 v248, v54 offset:8196
    s_mov_b64 exec, -1
    s_bitset1_b32 s47, 1
    s_bitcmp1_b32 s47, 0
    s_cbranch_scc1 f_bar
    s_branch f_s1
f_s0:
    s_sleep 8
f_s1:
    buffer_load_dwordx4 v[32:35], v249, s[12:15], s72 offen offset:0 sc1
    buffer_load_dwordx4 v[36:39], v249, s[12:15], s72 offen offset:1024 sc1
    buffer_load_dwordx4 v[40:43], v249, s[12:15], s72 offen offset:2048 sc1
    buffer_load_dwordx4 v[44:47], v249, s[12:15], s72 offen offset:3072 sc1
    s_waitcnt vmcnt(4)
    s_mov_b32 s83, 0
    ds_read_b64 v[96:97], v8 offset:0
    ds_read_b64 v[98:99], v8 offset:512
    ds_read_b64 v[100:101], v8 offset:1024
    ds_read_b64 v[102:103], v8 offset:1536
    ds_read_b64 v[104:105], v9 offset:1536
    ds_read_b64 v[106:107], v9 offset:1024
    ds_read_b64 v[108:109], v9 offset:512
    ds_read_b64 v[110:111], v9 offset:0
    v_xor_b32 v2, s32, v244
    v_bitop3_b32 v2, v2, v246, s32 bitop3:0xf6
    v_bitop3_b32 v2, v2, v245, s39 bitop3:0xf6
    v_bitop3_b32 v2, v2, v247, s39 bitop3:0xf6
    v_cmp_ne_u32 vcc, 0, v2
    s_mov_b32 s38, vcc_lo
    v_mov_b32 v244, 111488
    s_waitcnt lgkmcnt(0)
    v_lshlrev_b32 v160, 16, v96
    v_and_b32 v161, 0xffff0000, v96
    v_lshlrev_b32 v162, 16, v97
    v_and_b32 v163, 0xffff0000, v97
    v_lshlrev_b32 v164, 16, v98
    v_and_b32 v165, 0xffff0000, v98
    v_lshlrev_b32 v166, 16, v99
    v_and_b32 v167, 0xffff0000, v99
    v_lshlrev_b32 v168, 16, v100
    v_and_b32 v169, 0xffff0000, v100
    v_lshlrev_b32 v170, 16, v101
    v_and_b32 v171, 0xffff0000, v101
    v_lshlrev_b32 v172, 16, v102
    v_and_b32 v173, 0xffff0000, v102
    v_lshlrev_b32 v174, 16, v103
    v_and_b32 v175, 0xffff0000, v103
    v_lshlrev_b32 v176, 16, v104
    v_and_b32 v177, 0xffff0000, v104
    v_lshlrev_b32 v178, 16, v105
    v_and_b32 v179, 0xffff0000, v105
    v_lshlrev_b32 v180, 16, v106
    v_and_b32 v181, 0xffff0000, v106
    v_lshlrev_b32 v182, 16, v107
    v_and_b32 v183, 0xffff0000, v107
    v_lshlrev_b32 v184, 16, v108
    v_and_b32 v185, 0xffff0000, v108
    v_lshlrev_b32 v186, 16, v109
    v_and_b32 v187, 0xffff0000, v109
    v_lshlrev_b32 v188, 16, v110
    v_and_b32 v189, 0xffff0000, v110
    v_lshlrev_b32 v190, 16, v111
    v_and_b32 v191, 0xffff0000, v111
    ds_read_b32 v246, v244 offset:4
    s_waitcnt lgkmcnt(0)
    v_readfirstlane_b32 s43, v246
    s_cmp_lg_u32 s43, 4
    s_cbranch_scc1 f_t1
    ds_read_b128 v[112:115], v248 offset:0
    ds_read_b128 v[116:119], v248 offset:1024
    ds_read_b128 v[120:123], v248 offset:2048
    ds_read_b128 v[124:127], v248 offset:3072
    ds_read_b128 v[128:131], v248 offset:4096
    ds_read_b128 v[132:135], v248 offset:5120
    ds_read_b128 v[136:139], v248 offset:6144
    ds_read_b128 v[140:143], v248 offset:7168
    ds_read_b32 v245, v244
    s_bitset1_b32 s47, 2
f_t1:
f_z1:
    s_waitcnt vmcnt(2)
    v_xor_b32 v80, v32, v16
    v_xor_b32 v81, v36, v16
    v_xor_b32 v82, v33, v17
    v_xor_b32 v83, v37, v17
    v_xor_b32 v84, v34, v18
    v_xor_b32 v85, v38, v18
    v_xor_b32 v86, v35, v19
    v_xor_b32 v87, v39, v19
    v_mfma_f32_16x16x16_f16 v[48:51], v[20:21], v[80:81], 0
    v_xor_b32 v2, s44, v80
    v_bitop3_b32 v2, v2, v81, s44 bitop3:0xf6
    v_mfma_f32_16x16x16_f16 v[52:55], v[20:21], v[82:83], 0
    v_bitop3_b32 v2, v2, v82, s44 bitop3:0xf6
    v_bitop3_b32 v2, v2, v83, s44 bitop3:0xf6
    v_mfma_f32_16x16x16_f16 v[56:59], v[20:21], v[84:85], 0
    v_bitop3_b32 v2, v2, v84, s44 bitop3:0xf6
    v_bitop3_b32 v2, v2, v85, s44 bitop3:0xf6
    v_mfma_f32_16x16x16_f16 v[60:63], v[20:21], v[86:87], 0
    v_bitop3_b32 v2, v2, v86, s44 bitop3:0xf6
    v_bitop3_b32 v2, v2, v87, s44 bitop3:0xf6
    s_waitcnt vmcnt(0)
    v_xor_b32 v88, v40, v16
    v_xor_b32 v89, v44, v16
    v_xor_b32 v90, v41, v17
    v_xor_b32 v91, v45, v17
    v_xor_b32 v92, v42, v18
    v_xor_b32 v93, v46, v18
    v_xor_b32 v94, v43, v19
    v_xor_b32 v95, v47, v19
    v_mfma_f32_16x16x16_f16 v[64:67], v[22:23], v[88:89], 0
    v_bitop3_b32 v2, v2, v88, s44 bitop3:0xf6
    v_bitop3_b32 v2, v2, v89, s44 bitop3:0xf6
    v_mfma_f32_16x16x16_f16 v[68:71], v[22:23], v[90:91], 0
    v_bitop3_b32 v2, v2, v90, s44 bitop3:0xf6
    v_bitop3_b32 v2, v2, v91, s44 bitop3:0xf6
    v_mfma_f32_16x16x16_f16 v[72:75], v[22:23], v[92:93], 0
    v_bitop3_b32 v2, v2, v92, s44 bitop3:0xf6
    v_bitop3_b32 v2, v2, v93, s44 bitop3:0xf6
    v_mfma_f32_16x16x16_f16 v[76:79], v[22:23], v[94:95], 0
    v_bitop3_b32 v2, v2, v94, s44 bitop3:0xf6
    v_bitop3_b32 v2, v2, v95, s44 bitop3:0xf6
    v_and_b32 v2, s33, v2
    v_cmp_ne_u32 vcc, 0, v2
    s_cbranch_vccnz f_z1bad
f_z1ok:
    v_cvt_pk_f16_f32 v32, v48, v49
    v_cvt_pk_f16_f32 v33, v64, v65
    ds_write_b64 v252, v[32:33] offset:0
    v_cvt_pk_f16_f32 v34, v50, v51
    v_cvt_pk_f16_f32 v35, v66, v67
    ds_write_b64 v252, v[34:35] offset:1024
    v_cvt_pk_f16_f32 v36, v52, v53
    v_cvt_pk_f16_f32 v37, v68, v69
    ds_write_b64 v253, v[36:37] offset:0
    v_cvt_pk_f16_f32 v38, v54, v55
    v_cvt_pk_f16_f32 v39, v70, v71
    ds_write_b64 v253, v[38:39] offset:1024
    v_cvt_pk_f16_f32 v40, v56, v57
    v_cvt_pk_f16_f32 v41, v72, v73
    ds_write_b64 v252, v[40:41] offset:128
    v_cvt_pk_f16_f32 v42, v58, v59
    v_cvt_pk_f16_f32 v43, v74, v75
    ds_write_b64 v252, v[42:43] offset:1152
    v_cvt_pk_f16_f32 v44, v60, v61
    v_cvt_pk_f16_f32 v45, v76, v77
    ds_write_b64 v253, v[44:45] offset:128
    v_cvt_pk_f16_f32 v46, v62, v63
    v_cvt_pk_f16_f32 v47, v78, v79
    ds_write_b64 v253, v[46:47] offset:1152
    s_bitset1_b32 s47, 0
    s_mov_b32 s83, 0
    s_bitcmp1_b32 s47, 1
    s_cbranch_scc0 f_c1
    s_bitcmp1_b32 s47, 2
    s_cbranch_scc1 f_bar
    ds_read_b32 v246, v244 offset:4
    s_waitcnt lgkmcnt(0)
    v_readfirstlane_b32 s43, v246
    s_cmp_lg_u32 s43, 4
    s_cbranch_scc1 f_bar
    ds_read_b128 v[112:115], v248 offset:0
    ds_read_b128 v[116:119], v248 offset:1024
    ds_read_b128 v[120:123], v248 offset:2048
    ds_read_b128 v[124:127], v248 offset:3072
    ds_read_b128 v[128:131], v248 offset:4096
    ds_read_b128 v[132:135], v248 offset:5120
    ds_read_b128 v[136:139], v248 offset:6144
    ds_read_b128 v[140:143], v248 offset:7168
    ds_read_b32 v245, v244
    s_bitset1_b32 s47, 2
f_bar:
    s_waitcnt lgkmcnt(0)
    s_bitcmp1_b32 s47, 2
    s_barrier
    s_cbranch_scc0 f_t3l
f_t3d:
    ds_read_b128 v[32:35], v254 offset:0
    ds_read_b128 v[36:39], v255 offset:256
    ds_read_b128 v[40:43], v254 offset:512
    ds_read_b128 v[44:47], v255 offset:768
    v_xor_b32 v16, 65537, v16
    v_xor_b32 v17, 65537, v17
    v_xor_b32 v18, 65537, v18
    v_xor_b32 v19, 65537, v19
    s_waitcnt lgkmcnt(3)
    v_mfma_f32_16x16x32_f16 v[48:51], v[32:35], v[24:27], 0
    v_mfma_f32_16x16x32_f16 v[52:55], v[32:35], v[28:31], 0
    s_waitcnt lgkmcnt(2)
    v_mfma_f32_16x16x32_f16 v[56:59], v[36:39], v[24:27], 0
    v_mfma_f32_16x16x32_f16 v[60:63], v[36:39], v[28:31], 0
    s_waitcnt lgkmcnt(1)
    v_mfma_f32_16x16x32_f16 v[64:67], v[40:43], v[24:27], 0
    v_mfma_f32_16x16x32_f16 v[68:71], v[40:43], v[28:31], 0
    s_waitcnt lgkmcnt(0)
    v_mfma_f32_16x16x32_f16 v[72:75], v[44:47], v[24:27], 0
    v_mfma_f32_16x16x32_f16 v[76:79], v[44:47], v[28:31], 0
    v_mov_b32 v2, v245
    v_xor_b32 v19, v245, v19
    ds_read_b128 v[240:243], v3 offset:45568
    ds_read_b128 v[244:247], v3 offset:46592
    ds_read_b128 v[248:251], v3 offset:47616
    ds_read_b128 v[252:255], v3 offset:48640
    v_cvt_pk_f16_f32 v144, v48, v52
    v_cvt_pk_f16_f32 v145, v49, v53
    v_cvt_pk_f16_f32 v146, v50, v54
    v_cvt_pk_f16_f32 v147, v51, v55
    v_cvt_pk_f16_f32 v148, v56, v60
    v_cvt_pk_f16_f32 v149, v57, v61
    v_cvt_pk_f16_f32 v150, v58, v62
    v_cvt_pk_f16_f32 v151, v59, v63
    v_mfma_f32_16x16x32_f16 v[80:83], v[144:147], v[112:115], 0
    v_mfma_f32_16x16x32_f16 v[84:87], v[144:147], v[116:119], 0
    v_cvt_pk_f16_f32 v152, v64, v68
    v_cvt_pk_f16_f32 v153, v65, v69
    v_cvt_pk_f16_f32 v154, v66, v70
    v_cvt_pk_f16_f32 v155, v67, v71
    v_mfma_f32_16x16x32_f16 v[88:91], v[148:151], v[120:123], 0
    v_mfma_f32_16x16x32_f16 v[92:95], v[148:151], v[124:127], 0
    v_cvt_pk_f16_f32 v156, v72, v76
    v_cvt_pk_f16_f32 v157, v73, v77
    v_cvt_pk_f16_f32 v158, v74, v78
    v_cvt_pk_f16_f32 v159, v75, v79
    v_mfma_f32_16x16x32_f16 v[96:99], v[152:155], v[128:131], 0
    v_mfma_f32_16x16x32_f16 v[100:103], v[152:155], v[132:135], 0
    v_mfma_f32_16x16x32_f16 v[104:107], v[156:159], v[136:139], 0
    v_mfma_f32_16x16x32_f16 v[108:111], v[156:159], v[140:143], 0
    s_cmp_eq_u32 s16, 0
    s_cbranch_scc1 f_sb
f_nsb:
    buffer_load_dwordx4 v[20:23], v15, s[12:15], s52 offen
    v_cvt_pk_f16_f32 v32, v80, v84
    v_cvt_pk_f16_f32 v36, v81, v85
    v_cvt_pk_f16_f32 v40, v82, v86
    v_cvt_pk_f16_f32 v44, v83, v87
    v_bfi_b32 v32, s33, v16, v32
    v_bfi_b32 v36, s33, v16, v36
    v_bfi_b32 v40, s33, v16, v40
    v_bfi_b32 v44, s33, v16, v44
    v_cvt_pk_f16_f32 v33, v88, v92
    v_cvt_pk_f16_f32 v37, v89, v93
    v_cvt_pk_f16_f32 v41, v90, v94
    v_cvt_pk_f16_f32 v45, v91, v95
    v_bfi_b32 v33, s33, v17, v33
    v_bfi_b32 v37, s33, v17, v37
    v_bfi_b32 v41, s33, v17, v41
    v_bfi_b32 v45, s33, v17, v45
    v_cvt_pk_f16_f32 v34, v96, v100
    v_cvt_pk_f16_f32 v38, v97, v101
    v_cvt_pk_f16_f32 v42, v98, v102
    v_cvt_pk_f16_f32 v46, v99, v103
    v_bfi_b32 v34, s33, v18, v34
    v_bfi_b32 v38, s33, v18, v38
    v_bfi_b32 v42, s33, v18, v42
    v_bfi_b32 v46, s33, v18, v46
    v_cvt_pk_f16_f32 v35, v104, v108
    v_cvt_pk_f16_f32 v39, v105, v109
    v_cvt_pk_f16_f32 v43, v106, v110
    v_cvt_pk_f16_f32 v47, v107, v111
    v_bfi_b32 v35, s33, v19, v35
    v_bfi_b32 v39, s33, v19, v39
    v_bfi_b32 v43, s33, v19, v43
    v_bfi_b32 v47, s33, v19, v47
    s_cmp_lg_u32 s38, 0
    s_cbranch_scc1 f_slowst
    buffer_store_dwordx4 v[32:35], v14, s[12:15], s74 offen offset:0 nt
    buffer_store_dwordx4 v[36:39], v14, s[12:15], s74 offen offset:2048 nt
    buffer_store_dwordx4 v[40:43], v14, s[12:15], s75 offen offset:0 nt
    buffer_store_dwordx4 v[44:47], v14, s[12:15], s75 offen offset:2048 nt
f_std:
    s_mov_b32 s83, 0
    s_waitcnt vmcnt(4)
f_pp:
    v_xor_b32 v20, s56, v20
    v_xor_b32 v21, s57, v21
    v_xor_b32 v22, s58, v22
    v_xor_b32 v23, s59, v23
    v_or3_b32 v48, v20, v21, v22
    v_or_b32 v48, v48, v23
    v_and_b32 v48, 0xff, v48
    v_cmp_ne_u32 vcc, 0, v48
    s_cbranch_vccnz f_ppbad
f_ppok:
    ds_write_b128 v1, v[20:23]
    s_cmp_ge_u32 s16, 4
    s_cbranch_scc1 f_pw
    v_pk_add_f32 v[48:49], v[20:21], v[22:23]
    v_add_f32 v48, v48, v49
    s_nop 1
    v_add_f32_dpp v48, v48, v48 row_ror:8 row_mask:0xf bank_mask:0xf
    s_nop 1
    v_add_f32_dpp v48, v48, v48 row_ror:4 row_mask:0xf bank_mask:0xf
    s_nop 1
    v_add_f32_dpp v48, v48, v48 row_ror:2 row_mask:0xf bank_mask:0xf
    s_nop 1
    v_add_f32_dpp v48, v48, v48 row_ror:1 row_mask:0xf bank_mask:0xf
    s_nop 1
    v_add_f32_dpp v48, v48, v48 row_bcast:15 row_mask:0xa bank_mask:0xf
    s_nop 1
    v_add_f32_dpp v48, v48, v48 row_bcast:31 row_mask:0xc bank_mask:0xf
    s_mov_b32 exec_lo, 0
    s_mov_b32 exec_hi, 0x80000000
    ds_write_b32 v11, v48 offset:64
    s_mov_b64 exec, -1
f_pw:
    s_waitcnt lgkmcnt(0)
    s_barrier
    buffer_load_dwordx4 v[32:35], v4, s[12:15], s28 offen sc1 nt
    buffer_load_dwordx4 v[36:39], v4, s[12:15], s29 offen sc1 nt
    buffer_load_dwordx4 v[40:43], v4, s[12:15], s50 offen sc1 nt
    buffer_load_dwordx4 v[44:47], v4, s[12:15], s51 offen sc1 nt
    ds_read_b128 v[112:115], v5 offset:8192
    ds_read_b128 v[128:131], v6 offset:11264
    ds_read_b128 v[48:51], v5 offset:0
    ds_read_b128 v[64:67], v6 offset:3072
    ds_read_b128 v[116:119], v5 offset:9216
    ds_read_b128 v[132:135], v6 offset:10240
    ds_read_b128 v[52:55], v5 offset:1024
    ds_read_b128 v[68:71], v6 offset:2048
    v_xor_b32 v19, v2, v19
    v_xor_b32 v16, s44, v16
    v_xor_b32 v17, s44, v17
    v_xor_b32 v18, s44, v18
    v_xor_b32 v19, s44, v19
    v_bfe_u32 v20, v0, 3, 3
    v_mul_u32_u24 v20, 7168, v20
    v_and_b32 v151, 7, v0
    v_min_u32 v151, 6, v151
    v_lshl_add_u32 v151, v151, 7, v20
    v_mov_b32 v20, 102976
    v_lshrrev_b32 v23, 5, v0
    v_mov_b32 v22, 0xffffff00
    v_mov_b32 v21, 0x20000
    s_mov_b64 s[70:71], 1
    s_mov_b32 s83, 1
    s_mov_b32 s83, 0
    s_mov_b64 s[72:73], -1
    s_mov_b64 s[74:75], -1
    s_mov_b64 s[78:79], -1
    s_mov_b64 s[36:37], -1
    s_branch f_zp
f_zr:
    s_mov_b64 exec, s[72:73]
    buffer_load_dwordx4 v[32:35], v4, s[12:15], s28 offen sc1 nt
    s_mov_b64 exec, s[74:75]
    buffer_load_dwordx4 v[36:39], v4, s[12:15], s29 offen sc1 nt
    s_mov_b64 exec, s[78:79]
    buffer_load_dwordx4 v[40:43], v4, s[12:15], s50 offen sc1 nt
    s_mov_b64 exec, s[36:37]
    buffer_load_dwordx4 v[44:47], v4, s[12:15], s51 offen sc1 nt
f_zp:
    s_add_u32 s83, s83, 1
    s_cmp_lt_u32 s83, 0x40000
    s_cselect_b64 s[68:69], -1, 0
    s_mov_b64 exec, s[72:73]
    s_waitcnt vmcnt(3)
    v_xor_b32 v32, v32, v16
    v_xor_b32 v33, v33, v17
    v_xor_b32 v34, v34, v18
    v_xor_b32 v35, v35, v19
    v_bitop3_b32 v144, v35, v21, s44 bitop3:0x56
    v_bitop3_b32 v144, v144, v32, s44 bitop3:0xf6
    v_bitop3_b32 v144, v144, v33, s44 bitop3:0xf6
    v_bitop3_b32 v144, v144, v34, s44 bitop3:0xf6
    v_and_b32 v144, s33, v144
    v_cmp_ne_u32 s[72:73], 0, v144
    s_mov_b64 exec, s[74:75]
    s_waitcnt vmcnt(2)
    v_xor_b32 v36, v36, v16
    v_xor_b32 v37, v37, v17
    v_xor_b32 v38, v38, v18
    v_xor_b32 v39, v39, v19
    v_bitop3_b32 v145, v39, v21, s44 bitop3:0x56
    v_bitop3_b32 v145, v145, v36, s44 bitop3:0xf6
    v_bitop3_b32 v145, v145, v37, s44 bitop3:0xf6
    v_bitop3_b32 v145, v145, v38, s44 bitop3:0xf6
    v_and_b32 v145, s33, v145
    v_cmp_ne_u32 s[74:75], 0, v145
    s_mov_b64 exec, s[78:79]
    s_waitcnt vmcnt(1)
    v_xor_b32 v40, v40, v16
    v_xor_b32 v41, v41, v17
    v_xor_b32 v42, v42, v18
    v_xor_b32 v43, v43, v19
    v_bitop3_b32 v146, v43, v21, s44 bitop3:0x56
    v_bitop3_b32 v146, v146, v40, s44 bitop3:0xf6
    v_bitop3_b32 v146, v146, v41, s44 bitop3:0xf6
    v_bitop3_b32 v146, v146, v42, s44 bitop3:0xf6
    v_and_b32 v146, s33, v146
    v_cmp_ne_u32 s[78:79], 0, v146
    s_or_b64 s[64:65], s[72:73], s[74:75]
    s_mov_b64 exec, s[36:37]
    s_waitcnt vmcnt(0)
    v_xor_b32 v44, v44, v16
    v_xor_b32 v45, v45, v17
    v_xor_b32 v46, v46, v18
    v_xor_b32 v47, v47, v19
    v_bitop3_b32 v147, v47, v21, s44 bitop3:0x56
    v_bitop3_b32 v147, v147, v44, s44 bitop3:0xf6
    v_bitop3_b32 v147, v147, v45, s44 bitop3:0xf6
    v_bitop3_b32 v147, v147, v46, s44 bitop3:0xf6
    v_and_b32 v147, s33, v147
    v_cmp_ne_u32 s[36:37], 0, v147
    s_mov_b64 exec, -1
    v_bitop3_b32 v2, v35, v39, v21 bitop3:0x80
    v_bitop3_b32 v2, v2, v43, v47 bitop3:0x80
    v_cmp_eq_u32 vcc, 0, v2
    s_or_b64 s[66:67], s[78:79], s[36:37]
    s_or_b64 s[64:65], s[64:65], s[66:67]
    s_and_b64 s[64:65], s[64:65], s[68:69]
    s_cbranch_scc1 f_zr
    s_cbranch_vccnz f_rare
f_zf:
    v_mfma_f32_16x16x32_f16 v[80:83], v[32:35], v[192:195], 0
    ds_read_b128 v[120:123], v5 offset:10240
    ds_read_b128 v[136:139], v6 offset:9216
    v_mfma_f32_16x16x32_f16 v[80:83], v[36:39], v[196:199], v[80:83]
    ds_read_b128 v[56:59], v5 offset:2048
    ds_read_b128 v[72:75], v6 offset:1024
    v_mfma_f32_16x16x32_f16 v[80:83], v[40:43], v[200:203], v[80:83]
    ds_read_b128 v[124:127], v5 offset:11264
    ds_read_b128 v[140:143], v6 offset:8192
    v_mfma_f32_16x16x32_f16 v[80:83], v[44:47], v[204:207], v[80:83]
    ds_read_b128 v[60:63], v5 offset:3072
    ds_read_b128 v[76:79], v6 offset:0
    v_mfma_f32_16x16x32_f16 v[84:87], v[32:35], v[208:211], 0
    ds_read2_b32 v[28:29], v20 offset0:1 offset1:3
    ds_read2_b32 v[30:31], v20 offset0:5 offset1:7
    v_mfma_f32_16x16x32_f16 v[84:87], v[36:39], v[212:215], v[84:87]
    v_mfma_f32_16x16x32_f16 v[84:87], v[40:43], v[216:219], v[84:87]
    v_mfma_f32_16x16x32_f16 v[84:87], v[44:47], v[220:223], v[84:87]
f_zfok:
    s_waitcnt lgkmcnt(10)
    s_cmp_eq_u32 s30, 0
    s_cbranch_scc1 f_sp
    v_mfma_f32_16x16x32_f16 v[88:91], v[32:35], v[224:227], 0
    v_pk_fma_f32 v[160:161], v[112:113], v[80:81], v[160:161]
    v_pk_fma_f32 v[162:163], v[114:115], v[82:83], v[162:163]
    v_mfma_f32_16x16x32_f16 v[88:91], v[36:39], v[228:231], v[88:91]
    v_fmac_f32 v177, v129, v83
    v_fmac_f32 v178, v130, v82
    v_fmac_f32 v179, v131, v81
    v_mfma_f32_16x16x32_f16 v[88:91], v[40:43], v[232:235], v[88:91]
    v_pk_mul_f32 v[146:147], v[160:161], v[160:161]
    v_pk_mul_f32 v[148:149], v[160:161], v[48:49]
    v_mfma_f32_16x16x32_f16 v[88:91], v[44:47], v[236:239], v[88:91]
    v_pk_fma_f32 v[146:147], v[162:163], v[162:163], v[146:147]
    v_pk_fma_f32 v[148:149], v[162:163], v[50:51], v[148:149]
    v_mfma_f32_16x16x32_f16 v[92:95], v[32:35], v[240:243], 0
    v_cndmask_b32 v100, v80, v84, s[70:71]
    ds_bpermute_b32 v96, v7, v100
    v_pk_fma_f32 v[164:165], v[116:117], v[84:85], v[164:165]
    v_pk_fma_f32 v[166:167], v[118:119], v[86:87], v[166:167]
    v_mfma_f32_16x16x32_f16 v[92:95], v[36:39], v[244:247], v[92:95]
    v_fmac_f32 v181, v133, v87
    v_fmac_f32 v182, v134, v86
    v_fmac_f32 v183, v135, v85
    v_mfma_f32_16x16x32_f16 v[92:95], v[40:43], v[248:251], v[92:95]
    v_pk_fma_f32 v[146:147], v[164:165], v[164:165], v[146:147]
    v_pk_fma_f32 v[148:149], v[164:165], v[52:53], v[148:149]
    v_mfma_f32_16x16x32_f16 v[92:95], v[44:47], v[252:255], v[92:95]
    v_pk_fma_f32 v[146:147], v[166:167], v[166:167], v[146:147]
    v_pk_fma_f32 v[148:149], v[166:167], v[54:55], v[148:149]
    v_pk_mul_f32 v[154:155], v[178:179], v[178:179]
    v_pk_mul_f32 v[156:157], v[178:179], v[66:67]
    v_pk_fma_f32 v[154:155], v[182:183], v[182:183], v[154:155]
    v_pk_fma_f32 v[156:157], v[182:183], v[70:71], v[156:157]
    v_pk_add_f32 v[144:145], v[160:161], v[162:163]
    v_pk_add_f32 v[152:153], v[178:179], v[182:183]
    s_waitcnt lgkmcnt(1)
    v_cndmask_b32 v101, v84, v88, s[70:71]
    ds_bpermute_b32 v97, v7, v101
    v_pk_fma_f32 v[168:169], v[120:121], v[88:89], v[168:169]
    v_pk_fma_f32 v[170:171], v[122:123], v[90:91], v[170:171]
    v_fmac_f32 v185, v137, v91
    v_fmac_f32 v186, v138, v90
    v_fmac_f32 v187, v139, v89
    v_pk_add_f32 v[144:145], v[144:145], v[164:165]
    v_pk_add_f32 v[144:145], v[144:145], v[166:167]
    v_pk_fma_f32 v[146:147], v[168:169], v[168:169], v[146:147]
    v_pk_fma_f32 v[148:149], v[168:169], v[56:57], v[148:149]
    v_pk_fma_f32 v[146:147], v[170:171], v[170:171], v[146:147]
    v_pk_fma_f32 v[148:149], v[170:171], v[58:59], v[148:149]
    v_pk_fma_f32 v[154:155], v[186:187], v[186:187], v[154:155]
    v_pk_fma_f32 v[156:157], v[186:187], v[74:75], v[156:157]
    v_cndmask_b32 v102, v88, v92, s[70:71]
    ds_bpermute_b32 v98, v7, v102
    v_cndmask_b32 v103, v92, v80, s[70:71]
    ds_bpermute_b32 v99, v7, v103
    v_pk_fma_f32 v[172:173], v[124:125], v[92:93], v[172:173]
    v_pk_fma_f32 v[174:175], v[126:127], v[94:95], v[174:175]
    v_fmac_f32 v189, v141, v95
    v_fmac_f32 v190, v142, v94
    v_fmac_f32 v191, v143, v93
    v_pk_fma_f32 v[146:147], v[172:173], v[172:173], v[146:147]
    v_pk_fma_f32 v[148:149], v[172:173], v[60:61], v[148:149]
    v_pk_fma_f32 v[146:147], v[174:175], v[174:175], v[146:147]
    v_pk_fma_f32 v[148:149], v[174:175], v[62:63], v[148:149]
    v_pk_fma_f32 v[154:155], v[190:191], v[190:191], v[154:155]
    v_pk_fma_f32 v[156:157], v[190:191], v[78:79], v[156:157]
    v_pk_add_f32 v[144:145], v[144:145], v[168:169]
    v_pk_add_f32 v[144:145], v[144:145], v[170:171]
    v_pk_add_f32 v[144:145], v[144:145], v[172:173]
    v_pk_add_f32 v[144:145], v[144:145], v[174:175]
    v_pk_add_f32 v[152:153], v[152:153], v[186:187]
    v_pk_add_f32 v[152:153], v[152:153], v[190:191]
    s_waitcnt lgkmcnt(0)
    v_fmac_f32 v176, v128, v96
    v_fmac_f32 v180, v132, v97
    v_fmac_f32 v184, v136, v98
    v_fmac_f32 v188, v140, v99
    v_pk_fma_f32 v[154:155], v[176:177], v[176:177], v[154:155]
    v_pk_fma_f32 v[156:157], v[176:177], v[64:65], v[156:157]
    v_pk_add_f32 v[152:153], v[152:153], v[176:177]
    v_pk_fma_f32 v[154:155], v[180:181], v[180:181], v[154:155]
    v_pk_fma_f32 v[156:157], v[180:181], v[68:69], v[156:157]
    v_pk_add_f32 v[152:153], v[152:153], v[180:181]
    v_pk_fma_f32 v[154:155], v[184:185], v[184:185], v[154:155]
    v_pk_fma_f32 v[156:157], v[184:185], v[72:73], v[156:157]
    v_pk_add_f32 v[152:153], v[152:153], v[184:185]
    v_pk_fma_f32 v[154:155], v[188:189], v[188:189], v[154:155]
    v_pk_fma_f32 v[156:157], v[188:189], v[76:77], v[156:157]
    v_pk_add_f32 v[152:153], v[152:153], v[188:189]
f_join:
    v_pk_add_f32 v[28:29], v[28:29], v[30:31]
    s_mov_b64 exec, s[48:49]
    buffer_load_dword v150, v151, s[20:23], s55 offen
    s_mov_b64 exec, -1
f_ngo:
    v_add_f32 v104, v144, v145
    v_add_f32 v105, v146, v147
    v_add_f32 v106, v148, v149
    v_add_f32 v108, v152, v153
    v_add_f32 v109, v154, v155
    v_add_f32 v110, v156, v157
    v_add_f32 v28, v28, v29
    v_permlane32_swap_b32 v104, v108
    v_permlane32_swap_b32 v105, v109
    v_permlane32_swap_b32 v106, v110
    v_add_f32 v104, v104, v108
    v_add_f32 v105, v105, v109
    v_add_f32 v106, v106, v110
    v_add_f32_dpp v104, v104, v104 row_ror:8 row_mask:0xf bank_mask:0xf
    v_add_f32_dpp v105, v105, v105 row_ror:8 row_mask:0xf bank_mask:0xf
    v_add_f32_dpp v106, v106, v106 row_ror:8 row_mask:0xf bank_mask:0xf
    v_add_f32_dpp v104, v104, v104 row_ror:4 row_mask:0xf bank_mask:0xf
    v_add_f32_dpp v105, v105, v105 row_ror:4 row_mask:0xf bank_mask:0xf
    v_add_f32_dpp v106, v106, v106 row_ror:4 row_mask:0xf bank_mask:0xf
    v_add_f32_dpp v104, v104, v104 row_ror:2 row_mask:0xf bank_mask:0xf
    v_add_f32_dpp v105, v105, v105 row_ror:2 row_mask:0xf bank_mask:0xf
    v_add_f32_dpp v106, v106, v106 row_ror:2 row_mask:0xf bank_mask:0xf
    v_add_f32_dpp v104, v104, v104 row_ror:1 row_mask:0xf bank_mask:0xf
    v_add_f32_dpp v105, v105, v105 row_ror:1 row_mask:0xf bank_mask:0xf
    v_add_f32_dpp v106, v106, v106 row_ror:1 row_mask:0xf bank_mask:0xf
    v_add_f32_dpp v104, v104, v104 row_bcast:15 row_mask:0xa bank_mask:0xf
    v_add_f32_dpp v105, v105, v105 row_bcast:15 row_mask:0xa bank_mask:0xf
    v_add_f32_dpp v106, v106, v106 row_bcast:15 row_mask:0xa bank_mask:0xf
    v_mul_f32 v104, s46, v104
    v_mul_f32 v105, s46, v105
    v_mul_f32 v108, v104, v104
    v_fma_f32 v106, -v104, v28, v106
    v_sub_f32 v105, v105, v108
    v_mul_f32 v109, 4.0, v105
    v_cmp_gt_f32 vcc, v108, v109
    s_or_b32 s42, vcc_lo, vcc_hi
    s_bitcmp1_b32 s42, 31
    s_cbranch_scc1 f_slow2
f_var2:
    v_cvt_pk_bf16_f32 v105, v105, v105
    v_lshlrev_b32 v105, 16, v105
    v_add_f32 v105, 0x3727c5ac, v105
    v_cvt_pk_bf16_f32 v105, v105, v105
    v_lshlrev_b32 v105, 16, v105
    v_sqrt_f32 v105, v105
    s_nop 0
    v_cvt_pk_bf16_f32 v105, v105, v105
    v_lshlrev_b32 v105, 16, v105
    v_rcp_f32 v105, v105
    s_mov_b32 s42, 0x80000000
    s_mov_b32 exec_lo, s42
    s_mov_b32 exec_hi, s42
    v_mul_f32 v106, v106, v105
    v_ashrrev_i32 v108, 31, v106
    v_or_b32 v108, s42, v108
    v_xor_b32 v106, v106, v108
    v_and_or_b32 v106, v106, v22, v23
    ds_write_b32 v11, v106
    s_mov_b64 exec, -1
    s_waitcnt lgkmcnt(0)
    s_barrier
    ds_read_b32 v21, v12
    v_readlane_b32 s60, v106, 31
    v_readlane_b32 s64, v104, 31
    v_readlane_b32 s65, v105, 31
    v_readlane_b32 s61, v106, 63
    v_readlane_b32 s66, v104, 63
    v_readlane_b32 s67, v105, 63
    s_lshl_b32 s42, s3, 1
    s_movk_i32 s43, 0xff00
    v_mov_b32 v30, s32
    v_mov_b32 v31, s32
    s_cmp_lg_u32 s16, 0
    s_waitcnt lgkmcnt(0)
    s_cbranch_scc1 f_nkey
    s_setprio 3
    v_max_u32_dpp v28, v21, v21 row_ror:8 row_mask:0xf bank_mask:0xf
    s_nop 1
    v_max_u32_dpp v28, v28, v28 row_ror:4 row_mask:0xf bank_mask:0xf
    s_nop 1
    v_max_u32_dpp v28, v28, v28 row_ror:2 row_mask:0xf bank_mask:0xf
    s_nop 1
    v_max_u32_dpp v28, v28, v28 row_ror:1 row_mask:0xf bank_mask:0xf
    v_cmp_eq_u32 vcc, v28, v21
    s_nop 1
    v_cndmask_b32_e64 v29, v21, 0, vcc
    v_and_or_b32 v28, v28, v22, s42
    s_add_u32 s42, s42, 1
    v_max_u32_dpp v29, v29, v29 row_ror:8 row_mask:0xf bank_mask:0xf
    s_nop 1
    v_max_u32_dpp v29, v29, v29 row_ror:4 row_mask:0xf bank_mask:0xf
    s_nop 1
    v_max_u32_dpp v29, v29, v29 row_ror:2 row_mask:0xf bank_mask:0xf
    s_nop 1
    v_max_u32_dpp v29, v29, v29 row_ror:1 row_mask:0xf bank_mask:0xf
    v_and_or_b32 v29, v29, v22, s42
    s_mov_b64 exec, 0xff
    buffer_store_dwordx4 v[28:31], v13, s[12:15], s80 offen sc1
    s_mov_b64 exec, -1
    s_setprio 0
f_nkey:
    s_or_b32 s42, s35, s16
    s_cmp_lg_u32 s42, 0
    s_cbranch_scc1 f_ng1
    v_mov_b32 v2, s32
    s_mov_b64 exec, 1
    buffer_store_dword v2, v13, s[12:15], s81 offen offset:2048 sc1
    s_mov_b64 exec, -1
f_ng1:
    s_movk_i32 s62, 0x100
    v_cmp_lt_u32 vcc, s60, v21
    s_and_b32 s42, vcc_lo, 0xffff
    s_bcnt1_i32_b32 s42, s42
    s_cmp_ge_u32 s42, 2
    s_cbranch_scc1 f_nc0
    s_setprio 2
    v_pk_add_f32 v[48:49], v[160:161], s[64:65] op_sel:[0,0] op_sel_hi:[1,0] neg_lo:[0,1] neg_hi:[0,1]
    v_pk_add_f32 v[50:51], v[162:163], s[64:65] op_sel:[0,0] op_sel_hi:[1,0] neg_lo:[0,1] neg_hi:[0,1]
    v_pk_add_f32 v[52:53], v[164:165], s[64:65] op_sel:[0,0] op_sel_hi:[1,0] neg_lo:[0,1] neg_hi:[0,1]
    v_pk_add_f32 v[54:55], v[166:167], s[64:65] op_sel:[0,0] op_sel_hi:[1,0] neg_lo:[0,1] neg_hi:[0,1]
    v_pk_add_f32 v[56:57], v[168:169], s[64:65] op_sel:[0,0] op_sel_hi:[1,0] neg_lo:[0,1] neg_hi:[0,1]
    v_pk_add_f32 v[58:59], v[170:171], s[64:65] op_sel:[0,0] op_sel_hi:[1,0] neg_lo:[0,1] neg_hi:[0,1]
    v_pk_add_f32 v[60:61], v[172:173], s[64:65] op_sel:[0,0] op_sel_hi:[1,0] neg_lo:[0,1] neg_hi:[0,1]
    v_pk_add_f32 v[62:63], v[174:175], s[64:65] op_sel:[0,0] op_sel_hi:[1,0] neg_lo:[0,1] neg_hi:[0,1]
    v_pk_mul_f32 v[48:49], v[48:49], s[64:65] op_sel:[0,1] op_sel_hi:[1,1]
    v_pk_mul_f32 v[50:51], v[50:51], s[64:65] op_sel:[0,1] op_sel_hi:[1,1]
    v_pk_mul_f32 v[52:53], v[52:53], s[64:65] op_sel:[0,1] op_sel_hi:[1,1]
    v_pk_mul_f32 v[54:55], v[54:55], s[64:65] op_sel:[0,1] op_sel_hi:[1,1]
    v_pk_mul_f32 v[56:57], v[56:57], s[64:65] op_sel:[0,1] op_sel_hi:[1,1]
    v_pk_mul_f32 v[58:59], v[58:59], s[64:65] op_sel:[0,1] op_sel_hi:[1,1]
    v_pk_mul_f32 v[60:61], v[60:61], s[64:65] op_sel:[0,1] op_sel_hi:[1,1]
    v_pk_mul_f32 v[62:63], v[62:63], s[64:65] op_sel:[0,1] op_sel_hi:[1,1]
    v_cvt_pk_f16_f32 v80, v48, v49
    v_cvt_pk_f16_f32 v81, v50, v51
    ds_write_b64 v8, v[80:81] offset:0
    v_cvt_pk_f16_f32 v82, v52, v53
    v_cvt_pk_f16_f32 v83, v54, v55
    ds_write_b64 v8, v[82:83] offset:512
    v_cvt_pk_f16_f32 v84, v56, v57
    v_cvt_pk_f16_f32 v85, v58, v59
    ds_write_b64 v8, v[84:85] offset:1024
    v_cvt_pk_f16_f32 v86, v60, v61
    v_cvt_pk_f16_f32 v87, v62, v63
    ds_write_b64 v8, v[86:87] offset:1536
    ds_read_b128 v[88:91], v10 offset:0
    ds_read_b128 v[92:95], v10 offset:1024
    s_lshl_b32 s62, s3, 1
    s_add_u32 s62, s62, s42
    s_lshl_b32 s42, s62, 11
    s_add_u32 s42, s42, 5242880
    s_lshl_b32 s43, s62, 4
    s_add_u32 s43, s43, 6512640
    s_lshl_b32 s68, s30, 8
    s_or_b32 s68, s68, s56
    s_andn2_b32 s69, s64, 0xff
    s_or_b32 s69, s69, s57
    s_andn2_b32 s70, s65, 0xff
    s_or_b32 s70, s70, s58
    s_andn2_b32 s71, s60, 0xff
    s_or_b32 s71, s71, s59
    s_waitcnt lgkmcnt(0)
    v_bfi_b32 v88, s33, v16, v88
    v_bfi_b32 v89, s33, v17, v89
    v_bfi_b32 v90, s33, v18, v90
    v_bfi_b32 v91, s33, v19, v91
    v_bfi_b32 v92, s33, v16, v92
    v_bfi_b32 v93, s33, v17, v93
    v_bfi_b32 v94, s33, v18, v94
    v_bfi_b32 v95, s33, v19, v95
    buffer_store_dwordx4 v[88:91], v3, s[12:15], s42 offen offset:0 sc1
    buffer_store_dwordx4 v[92:95], v3, s[12:15], s42 offen offset:1024 sc1
    v_mov_b32 v24, s68
    v_mov_b32 v25, s69
    v_mov_b32 v26, s70
    v_mov_b32 v27, s71
    s_mov_b64 exec, 1
    buffer_store_dwordx4 v[24:27], v3, s[12:15], s43 offen sc1
    s_mov_b64 exec, -1
    s_setprio 0
f_nc0:
    s_movk_i32 s63, 0x100
    v_cmp_lt_u32 vcc, s61, v21
    s_and_b32 s42, vcc_lo, 0xffff
    s_bcnt1_i32_b32 s42, s42
    s_cmp_ge_u32 s42, 2
    s_cbranch_scc1 f_nc1
    s_setprio 2
    v_pk_add_f32 v[64:65], v[176:177], s[66:67] op_sel:[0,0] op_sel_hi:[1,0] neg_lo:[0,1] neg_hi:[0,1]
    v_pk_add_f32 v[66:67], v[178:179], s[66:67] op_sel:[0,0] op_sel_hi:[1,0] neg_lo:[0,1] neg_hi:[0,1]
    v_pk_add_f32 v[68:69], v[180:181], s[66:67] op_sel:[0,0] op_sel_hi:[1,0] neg_lo:[0,1] neg_hi:[0,1]
    v_pk_add_f32 v[70:71], v[182:183], s[66:67] op_sel:[0,0] op_sel_hi:[1,0] neg_lo:[0,1] neg_hi:[0,1]
    v_pk_add_f32 v[72:73], v[184:185], s[66:67] op_sel:[0,0] op_sel_hi:[1,0] neg_lo:[0,1] neg_hi:[0,1]
    v_pk_add_f32 v[74:75], v[186:187], s[66:67] op_sel:[0,0] op_sel_hi:[1,0] neg_lo:[0,1] neg_hi:[0,1]
    v_pk_add_f32 v[76:77], v[188:189], s[66:67] op_sel:[0,0] op_sel_hi:[1,0] neg_lo:[0,1] neg_hi:[0,1]
    v_pk_add_f32 v[78:79], v[190:191], s[66:67] op_sel:[0,0] op_sel_hi:[1,0] neg_lo:[0,1] neg_hi:[0,1]
    v_pk_mul_f32 v[64:65], v[64:65], s[66:67] op_sel:[0,1] op_sel_hi:[1,1]
    v_pk_mul_f32 v[66:67], v[66:67], s[66:67] op_sel:[0,1] op_sel_hi:[1,1]
    v_pk_mul_f32 v[68:69], v[68:69], s[66:67] op_sel:[0,1] op_sel_hi:[1,1]
    v_pk_mul_f32 v[70:71], v[70:71], s[66:67] op_sel:[0,1] op_sel_hi:[1,1]
    v_pk_mul_f32 v[72:73], v[72:73], s[66:67] op_sel:[0,1] op_sel_hi:[1,1]
    v_pk_mul_f32 v[74:75], v[74:75], s[66:67] op_sel:[0,1] op_sel_hi:[1,1]
    v_pk_mul_f32 v[76:77], v[76:77], s[66:67] op_sel:[0,1] op_sel_hi:[1,1]
    v_pk_mul_f32 v[78:79], v[78:79], s[66:67] op_sel:[0,1] op_sel_hi:[1,1]
    v_cvt_pk_f16_f32 v80, v64, v65
    v_cvt_pk_f16_f32 v81, v66, v67
    ds_write_b64 v9, v[80:81] offset:1536
    v_cvt_pk_f16_f32 v82, v68, v69
    v_cvt_pk_f16_f32 v83, v70, v71
    ds_write_b64 v9, v[82:83] offset:1024
    v_cvt_pk_f16_f32 v84, v72, v73
    v_cvt_pk_f16_f32 v85, v74, v75
    ds_write_b64 v9, v[84:85] offset:512
    v_cvt_pk_f16_f32 v86, v76, v77
    v_cvt_pk_f16_f32 v87, v78, v79
    ds_write_b64 v9, v[86:87] offset:0
    ds_read_b128 v[88:91], v10 offset:2048
    ds_read_b128 v[92:95], v10 offset:3072
    s_lshl_b32 s63, s3, 1
    s_add_u32 s63, s63, s42
    s_lshl_b32 s42, s63, 11
    s_add_u32 s42, s42, 5242880
    s_lshl_b32 s43, s63, 4
    s_add_u32 s43, s43, 6512640
    s_lshl_b32 s68, s31, 8
    s_or_b32 s68, s68, s56
    s_andn2_b32 s69, s66, 0xff
    s_or_b32 s69, s69, s57
    s_andn2_b32 s70, s67, 0xff
    s_or_b32 s70, s70, s58
    s_andn2_b32 s71, s61, 0xff
    s_or_b32 s71, s71, s59
    s_waitcnt lgkmcnt(0)
    v_bfi_b32 v88, s33, v16, v88
    v_bfi_b32 v89, s33, v17, v89
    v_bfi_b32 v90, s33, v18, v90
    v_bfi_b32 v91, s33, v19, v91
    v_bfi_b32 v92, s33, v16, v92
    v_bfi_b32 v93, s33, v17, v93
    v_bfi_b32 v94, s33, v18, v94
    v_bfi_b32 v95, s33, v19, v95
    buffer_store_dwordx4 v[88:91], v3, s[12:15], s42 offen offset:0 sc1
    buffer_store_dwordx4 v[92:95], v3, s[12:15], s42 offen offset:1024 sc1
    v_mov_b32 v24, s68
    v_mov_b32 v25, s69
    v_mov_b32 v26, s70
    v_mov_b32 v27, s71
    s_mov_b64 exec, 1
    buffer_store_dwordx4 v[24:27], v3, s[12:15], s43 offen sc1
    s_mov_b64 exec, -1
    s_setprio 0
f_nc1:
    buffer_load_dwordx4 v[96:99], v15, s[12:15], s41 offen
    buffer_load_dwordx4 v[100:103], v15, s[12:15], s40 offen
    s_cmp_lt_u32 s62, 0x100
    s_cbranch_scc1 f_op0
    v_pk_add_f32 v[48:49], v[160:161], s[64:65] op_sel:[0,0] op_sel_hi:[1,0] neg_lo:[0,1] neg_hi:[0,1]
    v_pk_add_f32 v[50:51], v[162:163], s[64:65] op_sel:[0,0] op_sel_hi:[1,0] neg_lo:[0,1] neg_hi:[0,1]
    v_pk_add_f32 v[52:53], v[164:165], s[64:65] op_sel:[0,0] op_sel_hi:[1,0] neg_lo:[0,1] neg_hi:[0,1]
    v_pk_add_f32 v[54:55], v[166:167], s[64:65] op_sel:[0,0] op_sel_hi:[1,0] neg_lo:[0,1] neg_hi:[0,1]
    v_pk_add_f32 v[56:57], v[168:169], s[64:65] op_sel:[0,0] op_sel_hi:[1,0] neg_lo:[0,1] neg_hi:[0,1]
    v_pk_add_f32 v[58:59], v[170:171], s[64:65] op_sel:[0,0] op_sel_hi:[1,0] neg_lo:[0,1] neg_hi:[0,1]
    v_pk_add_f32 v[60:61], v[172:173], s[64:65] op_sel:[0,0] op_sel_hi:[1,0] neg_lo:[0,1] neg_hi:[0,1]
    v_pk_add_f32 v[62:63], v[174:175], s[64:65] op_sel:[0,0] op_sel_hi:[1,0] neg_lo:[0,1] neg_hi:[0,1]
    v_pk_mul_f32 v[48:49], v[48:49], s[64:65] op_sel:[0,1] op_sel_hi:[1,1]
    v_pk_mul_f32 v[50:51], v[50:51], s[64:65] op_sel:[0,1] op_sel_hi:[1,1]
    v_pk_mul_f32 v[52:53], v[52:53], s[64:65] op_sel:[0,1] op_sel_hi:[1,1]
    v_pk_mul_f32 v[54:55], v[54:55], s[64:65] op_sel:[0,1] op_sel_hi:[1,1]
    v_pk_mul_f32 v[56:57], v[56:57], s[64:65] op_sel:[0,1] op_sel_hi:[1,1]
    v_pk_mul_f32 v[58:59], v[58:59], s[64:65] op_sel:[0,1] op_sel_hi:[1,1]
    v_pk_mul_f32 v[60:61], v[60:61], s[64:65] op_sel:[0,1] op_sel_hi:[1,1]
    v_pk_mul_f32 v[62:63], v[62:63], s[64:65] op_sel:[0,1] op_sel_hi:[1,1]
f_op0:
    s_cmp_lt_u32 s63, 0x100
    s_cbranch_scc1 f_op1
    v_pk_add_f32 v[64:65], v[176:177], s[66:67] op_sel:[0,0] op_sel_hi:[1,0] neg_lo:[0,1] neg_hi:[0,1]
    v_pk_add_f32 v[66:67], v[178:179], s[66:67] op_sel:[0,0] op_sel_hi:[1,0] neg_lo:[0,1] neg_hi:[0,1]
    v_pk_add_f32 v[68:69], v[180:181], s[66:67] op_sel:[0,0] op_sel_hi:[1,0] neg_lo:[0,1] neg_hi:[0,1]
    v_pk_add_f32 v[70:71], v[182:183], s[66:67] op_sel:[0,0] op_sel_hi:[1,0] neg_lo:[0,1] neg_hi:[0,1]
    v_pk_add_f32 v[72:73], v[184:185], s[66:67] op_sel:[0,0] op_sel_hi:[1,0] neg_lo:[0,1] neg_hi:[0,1]
    v_pk_add_f32 v[74:75], v[186:187], s[66:67] op_sel:[0,0] op_sel_hi:[1,0] neg_lo:[0,1] neg_hi:[0,1]
    v_pk_add_f32 v[76:77], v[188:189], s[66:67] op_sel:[0,0] op_sel_hi:[1,0] neg_lo:[0,1] neg_hi:[0,1]
    v_pk_add_f32 v[78:79], v[190:191], s[66:67] op_sel:[0,0] op_sel_hi:[1,0] neg_lo:[0,1] neg_hi:[0,1]
    v_pk_mul_f32 v[64:65], v[64:65], s[66:67] op_sel:[0,1] op_sel_hi:[1,1]
    v_pk_mul_f32 v[66:67], v[66:67], s[66:67] op_sel:[0,1] op_sel_hi:[1,1]
    v_pk_mul_f32 v[68:69], v[68:69], s[66:67] op_sel:[0,1] op_sel_hi:[1,1]
    v_pk_mul_f32 v[70:71], v[70:71], s[66:67] op_sel:[0,1] op_sel_hi:[1,1]
    v_pk_mul_f32 v[72:73], v[72:73], s[66:67] op_sel:[0,1] op_sel_hi:[1,1]
    v_pk_mul_f32 v[74:75], v[74:75], s[66:67] op_sel:[0,1] op_sel_hi:[1,1]
    v_pk_mul_f32 v[76:77], v[76:77], s[66:67] op_sel:[0,1] op_sel_hi:[1,1]
    v_pk_mul_f32 v[78:79], v[78:79], s[66:67] op_sel:[0,1] op_sel_hi:[1,1]
f_op1:
    s_mov_b32 s83, 0
    s_waitcnt vmcnt(0)
f_pb:
    v_xor_b32 v96, s56, v96
    v_xor_b32 v97, s57, v97
    v_xor_b32 v98, s58, v98
    v_xor_b32 v99, s59, v99
    v_xor_b32 v100, s56, v100
    v_xor_b32 v101, s57, v101
    v_xor_b32 v102, s58, v102
    v_xor_b32 v103, s59, v103
    v_or3_b32 v2, v96, v97, v98
    v_or3_b32 v2, v2, v99, v100
    v_or3_b32 v2, v2, v101, v102
    v_or_b32 v2, v2, v103
    v_and_b32 v2, 0xff, v2
    v_cmp_ne_u32 vcc, 0, v2
    s_cbranch_vccnz f_pbbad
f_pbok:
    ds_write_b128 v1, v[96:99] offset:4096
    s_cmp_ge_u32 s16, 4
    s_cbranch_scc1 f_pbx
    ds_write_b128 v1, v[100:103] offset:16384
f_pbx:
    s_waitcnt lgkmcnt(0)
    s_barrier
    ds_read_b128 v[192:195], v5 offset:16384
    ds_read_b128 v[196:199], v5 offset:17408
    ds_read_b128 v[200:203], v5 offset:18432
    ds_read_b128 v[204:207], v5 offset:19456
    ds_read_b128 v[224:227], v5 offset:4096
    ds_read_b128 v[228:231], v5 offset:5120
    ds_read_b128 v[232:235], v5 offset:6144
    ds_read_b128 v[236:239], v5 offset:7168
    ds_read_b128 v[112:115], v5 offset:12288
    ds_read_b128 v[116:119], v5 offset:13312
    ds_read_b128 v[120:123], v5 offset:14336
    ds_read_b128 v[124:127], v5 offset:15360
    s_waitcnt lgkmcnt(4)
    v_pk_fma_f32 v[48:49], v[48:49], v[192:193], v[224:225]
    v_pk_fma_f32 v[50:51], v[50:51], v[194:195], v[226:227]
    v_pk_fma_f32 v[52:53], v[52:53], v[196:197], v[228:229]
    v_pk_fma_f32 v[54:55], v[54:55], v[198:199], v[230:231]
    v_pk_fma_f32 v[56:57], v[56:57], v[200:201], v[232:233]
    v_pk_fma_f32 v[58:59], v[58:59], v[202:203], v[234:235]
    v_pk_fma_f32 v[60:61], v[60:61], v[204:205], v[236:237]
    v_pk_fma_f32 v[62:63], v[62:63], v[206:207], v[238:239]
    s_waitcnt lgkmcnt(0)
    v_pk_fma_f32 v[160:161], v[112:113], v[48:49], v[160:161]
    v_pk_fma_f32 v[162:163], v[114:115], v[50:51], v[162:163]
    v_pk_fma_f32 v[164:165], v[116:117], v[52:53], v[164:165]
    v_pk_fma_f32 v[166:167], v[118:119], v[54:55], v[166:167]
    v_pk_fma_f32 v[168:169], v[120:121], v[56:57], v[168:169]
    v_pk_fma_f32 v[170:171], v[122:123], v[58:59], v[170:171]
    v_pk_fma_f32 v[172:173], v[124:125], v[60:61], v[172:173]
    v_pk_fma_f32 v[174:175], v[126:127], v[62:63], v[174:175]
    v_cvt_pk_bf16_f32 v80, v160, v161
    v_cvt_pk_bf16_f32 v81, v162, v163
    ds_write_b64 v8, v[80:81] offset:0
    v_cvt_pk_bf16_f32 v82, v164, v165
    v_cvt_pk_bf16_f32 v83, v166, v167
    ds_write_b64 v8, v[82:83] offset:512
    v_cvt_pk_bf16_f32 v84, v168, v169
    v_cvt_pk_bf16_f32 v85, v170, v171
    ds_write_b64 v8, v[84:85] offset:1024
    v_cvt_pk_bf16_f32 v86, v172, v173
    v_cvt_pk_bf16_f32 v87, v174, v175
    ds_write_b64 v8, v[86:87] offset:1536
    ds_read_b128 v[32:35], v10 offset:0
    ds_read_b128 v[36:39], v10 offset:1024
    ds_read_b128 v[208:211], v6 offset:19456
    ds_read_b128 v[212:215], v6 offset:18432
    ds_read_b128 v[216:219], v6 offset:17408
    ds_read_b128 v[220:223], v6 offset:16384
    ds_read_b128 v[240:243], v6 offset:7168
    ds_read_b128 v[244:247], v6 offset:6144
    ds_read_b128 v[248:251], v6 offset:5120
    ds_read_b128 v[252:255], v6 offset:4096
    ds_read_b128 v[128:131], v6 offset:15360
    ds_read_b128 v[132:135], v6 offset:14336
    ds_read_b128 v[136:139], v6 offset:13312
    ds_read_b128 v[140:143], v6 offset:12288
    s_waitcnt lgkmcnt(4)
    v_pk_fma_f32 v[64:65], v[64:65], v[208:209], v[240:241]
    v_pk_fma_f32 v[66:67], v[66:67], v[210:211], v[242:243]
    v_pk_fma_f32 v[68:69], v[68:69], v[212:213], v[244:245]
    v_pk_fma_f32 v[70:71], v[70:71], v[214:215], v[246:247]
    v_pk_fma_f32 v[72:73], v[72:73], v[216:217], v[248:249]
    v_pk_fma_f32 v[74:75], v[74:75], v[218:219], v[250:251]
    v_pk_fma_f32 v[76:77], v[76:77], v[220:221], v[252:253]
    v_pk_fma_f32 v[78:79], v[78:79], v[222:223], v[254:255]
    s_waitcnt lgkmcnt(0)
    v_pk_fma_f32 v[176:177], v[128:129], v[64:65], v[176:177]
    v_pk_fma_f32 v[178:179], v[130:131], v[66:67], v[178:179]
    v_pk_fma_f32 v[180:181], v[132:133], v[68:69], v[180:181]
    v_pk_fma_f32 v[182:183], v[134:135], v[70:71], v[182:183]
    v_pk_fma_f32 v[184:185], v[136:137], v[72:73], v[184:185]
    v_pk_fma_f32 v[186:187], v[138:139], v[74:75], v[186:187]
    v_pk_fma_f32 v[188:189], v[140:141], v[76:77], v[188:189]
    v_pk_fma_f32 v[190:191], v[142:143], v[78:79], v[190:191]
    v_cvt_pk_bf16_f32 v80, v176, v177
    v_cvt_pk_bf16_f32 v81, v178, v179
    ds_write_b64 v9, v[80:81] offset:1536
    v_cvt_pk_bf16_f32 v82, v180, v181
    v_cvt_pk_bf16_f32 v83, v182, v183
    ds_write_b64 v9, v[82:83] offset:1024
    v_cvt_pk_bf16_f32 v84, v184, v185
    v_cvt_pk_bf16_f32 v85, v186, v187
    ds_write_b64 v9, v[84:85] offset:512
    v_cvt_pk_bf16_f32 v86, v188, v189
    v_cvt_pk_bf16_f32 v87, v190, v191
    ds_write_b64 v9, v[86:87] offset:0
    ds_read_b128 v[40:43], v10 offset:2048
    ds_read_b128 v[44:47], v10 offset:3072
    v_mov_b32 v21, 103016
    s_cmp_lg_u32 s16, 0
    s_cbranch_scc1 f_nrs
    s_sleep 8
    s_mov_b32 s83, 0
f_kq:
    buffer_load_dwordx4 v[96:99], v3, s[12:15], s81 offen offset:0 sc1
    buffer_load_dwordx4 v[100:103], v3, s[12:15], s81 offen offset:1024 sc1
    s_waitcnt vmcnt(0)
    v_xor_b32 v2, s32, v98
    v_bitop3_b32 v2, v2, v102, s32 bitop3:0xf6
    v_cmp_ne_u32 vcc, 0, v2
    s_cbranch_vccz f_kqx
    s_sleep 4
    s_add_u32 s83, s83, 1
    s_cmp_lt_u32 s83, 0x40000
    s_cbranch_scc1 f_kq
f_kqx:
    v_max_u32 v24, v96, v100
    v_min_u32 v25, v96, v100
    v_max3_u32 v25, v25, v97, v101
    v_mov_b32 v26, v24
    s_nop 1
    v_max_u32_dpp v26, v26, v26 row_ror:8 row_mask:0xf bank_mask:0xf
    s_nop 1
    v_max_u32_dpp v26, v26, v26 row_ror:4 row_mask:0xf bank_mask:0xf
    s_nop 1
    v_max_u32_dpp v26, v26, v26 row_ror:2 row_mask:0xf bank_mask:0xf
    s_nop 1
    v_max_u32_dpp v26, v26, v26 row_ror:1 row_mask:0xf bank_mask:0xf
    s_nop 1
    v_max_u32_dpp v26, v26, v26 row_bcast:15 row_mask:0xa bank_mask:0xf
    s_nop 1
    v_max_u32_dpp v26, v26, v26 row_bcast:31 row_mask:0xc bank_mask:0xf
    s_nop 0
    v_readlane_b32 s40, v26, 63
    s_nop 1
    v_cmp_eq_u32 vcc, s40, v24
    s_nop 1
    v_cndmask_b32 v26, v24, v25, vcc
    s_nop 1
    v_max_u32_dpp v26, v26, v26 row_ror:8 row_mask:0xf bank_mask:0xf
    s_nop 1
    v_max_u32_dpp v26, v26, v26 row_ror:4 row_mask:0xf bank_mask:0xf
    s_nop 1
    v_max_u32_dpp v26, v26, v26 row_ror:2 row_mask:0xf bank_mask:0xf
    s_nop 1
    v_max_u32_dpp v26, v26, v26 row_ror:1 row_mask:0xf bank_mask:0xf
    s_nop 1
    v_max_u32_dpp v26, v26, v26 row_bcast:15 row_mask:0xa bank_mask:0xf
    s_nop 1
    v_max_u32_dpp v26, v26, v26 row_bcast:31 row_mask:0xc bank_mask:0xf
    s_nop 0
    v_readlane_b32 s41, v26, 63
    s_and_b32 s40, s40, 0xff
    s_and_b32 s41, s41, 0xff
    v_mov_b32 v28, s40
    v_mov_b32 v29, s41
    ds_write_b64 v21, v[28:29]
f_nrs:
    s_waitcnt lgkmcnt(0)
    s_barrier
    ds_read_b64 v[28:29], v21
    s_waitcnt lgkmcnt(0)
    v_readfirstlane_b32 s40, v28
    v_readfirstlane_b32 s41, v29
    s_cmp_eq_u32 s62, s40
    s_cbranch_scc1 f_e0
    s_cmp_eq_u32 s62, s41
    s_cbranch_scc1 f_e0
    s_waitcnt vmcnt(1)
    buffer_store_dwordx4 v[32:35], v3, s[24:27], s18 offen offset:0 sc1
    s_waitcnt vmcnt(1)
    buffer_store_dwordx4 v[36:39], v3, s[24:27], s18 offen offset:1024 sc1
f_e0:
    s_cmp_eq_u32 s63, s40
    s_cbranch_scc1 f_e1
    s_cmp_eq_u32 s63, s41
    s_cbranch_scc1 f_e1
    s_waitcnt vmcnt(1)
    buffer_store_dwordx4 v[40:43], v3, s[24:27], s19 offen offset:0 sc1
    s_waitcnt vmcnt(1)
    buffer_store_dwordx4 v[44:47], v3, s[24:27], s19 offen offset:1024 sc1
f_e1:
    s_endpgm
f_t3l:
    ds_read_b128 v[112:115], v248 offset:0
    ds_read_b128 v[116:119], v248 offset:1024
    ds_read_b128 v[120:123], v248 offset:2048
    ds_read_b128 v[124:127], v248 offset:3072
    ds_read_b128 v[128:131], v248 offset:4096
    ds_read_b128 v[132:135], v248 offset:5120
    ds_read_b128 v[136:139], v248 offset:6144
    ds_read_b128 v[140:143], v248 offset:7168
    ds_read_b32 v245, v244
    s_branch f_t3d
f_c1bad:
    s_add_u32 s83, s83, 1
    s_cmp_ge_u32 s83, 0x40000
    s_cbranch_scc1 f_c1ok
    s_bitcmp1_b32 s47, 0
    s_cbranch_scc0 f_c1b2
    s_sleep 3
f_c1b2:
    s_cmp_lg_u32 s34, 0
    s_cbranch_scc1 f_ci1
    s_add_u32 s68, s82, 32768
    buffer_load_dwordx4 v[120:123], v250, s[12:15], s68 offen offset:0 sc1
    buffer_load_dwordx4 v[124:127], v250, s[12:15], s68 offen offset:1024 sc1
f_ci1:
    buffer_load_dwordx4 v[112:115], v250, s[12:15], s82 offen offset:0 sc1
    buffer_load_dwordx4 v[116:119], v250, s[12:15], s82 offen offset:1024 sc1
    s_bitcmp1_b32 s47, 0
    s_cbranch_scc0 f_s1
    s_waitcnt vmcnt(0)
    s_branch f_c1
f_z1bad:
    s_add_u32 s83, s83, 1
    s_cmp_ge_u32 s83, 0x40000
    s_cbranch_scc1 f_z1ok
    s_sleep 4
    buffer_load_dwordx4 v[32:35], v249, s[12:15], s72 offen offset:0 sc1
    buffer_load_dwordx4 v[36:39], v249, s[12:15], s72 offen offset:1024 sc1
    buffer_load_dwordx4 v[40:43], v249, s[12:15], s72 offen offset:2048 sc1
    buffer_load_dwordx4 v[44:47], v249, s[12:15], s72 offen offset:3072 sc1
    s_waitcnt vmcnt(0)
    s_branch f_z1
f_ppbad:
    s_add_u32 s83, s83, 1
    s_cmp_ge_u32 s83, 0x40000
    s_cbranch_scc1 f_ppok
    s_sleep 3
    buffer_load_dwordx4 v[20:23], v15, s[12:15], s52 offen sc1
    s_waitcnt vmcnt(0)
    s_branch f_pp
f_pbbad:
    s_add_u32 s83, s83, 1
    s_cmp_ge_u32 s83, 0x40000
    s_cbranch_scc1 f_pbok
    s_sleep 3
    buffer_load_dwordx4 v[96:99], v15, s[12:15], s41 offen sc1
    buffer_load_dwordx4 v[100:103], v15, s[12:15], s40 offen sc1
    s_waitcnt vmcnt(0)
    s_branch f_pb
f_slowst:
    buffer_store_dwordx4 v[32:35], v14, s[12:15], s74 offen offset:0 sc1
    buffer_store_dwordx4 v[36:39], v14, s[12:15], s74 offen offset:2048 sc1
    buffer_store_dwordx4 v[40:43], v14, s[12:15], s75 offen offset:0 sc1
    buffer_store_dwordx4 v[44:47], v14, s[12:15], s75 offen offset:2048 sc1
    s_branch f_std
f_rare:
    v_or_b32 v35, v21, v35
    v_or_b32 v39, v21, v39
    v_or_b32 v43, v21, v43
    v_or_b32 v47, v21, v47
    v_bfe_u32 v144, v0, 4, 2
    v_lshlrev_b32 v144, 3, v144
    ds_read_b128 v[120:123], v5 offset:10240
    ds_read_b128 v[136:139], v6 offset:9216
    ds_read_b128 v[56:59], v5 offset:2048
    ds_read_b128 v[72:75], v6 offset:1024
    ds_read_b128 v[124:127], v5 offset:11264
    ds_read_b128 v[140:143], v6 offset:8192
    ds_read_b128 v[60:63], v5 offset:3072
    ds_read_b128 v[76:79], v6 offset:0
    ds_read2_b32 v[28:29], v20 offset0:1 offset1:3
    ds_read2_b32 v[30:31], v20 offset0:5 offset1:7
    s_mov_b32 s83, 0
    s_waitcnt lgkmcnt(0)
f_rz:
    buffer_load_dwordx2 v[152:153], v144, s[12:15], s77 offen offset:0 sc1
    buffer_load_dwordx2 v[154:155], v144, s[12:15], s77 offen offset:32 sc1
    buffer_load_dwordx2 v[156:157], v144, s[12:15], s77 offen offset:64 sc1
    buffer_load_dwordx2 v[158:159], v144, s[12:15], s77 offen offset:96 sc1
    s_waitcnt vmcnt(0)
    v_xor_b32 v2, s32, v152
    v_bitop3_b32 v2, v2, v154, s32 bitop3:0xf6
    v_bitop3_b32 v2, v2, v156, s32 bitop3:0xf6
    v_bitop3_b32 v2, v2, v158, s32 bitop3:0xf6
    v_cmp_ne_u32 vcc, 0, v2
    s_cbranch_vccz f_rzx
    s_sleep 2
    s_add_u32 s83, s83, 1
    s_cmp_lt_u32 s83, 0x40000
    s_cbranch_scc1 f_rz
f_rzx:
    v_mov_b32 v148, v153
    v_mov_b32 v149, v155
    v_mov_b32 v150, v157
    v_mov_b32 v151, v159
    v_max_i32 v145, v148, v149
    v_max3_i32 v145, v145, v150, v151
    s_nop 0
    v_readlane_b32 s64, v145, 0
    v_readlane_b32 s65, v145, 16
    v_readlane_b32 s66, v145, 32
    v_readlane_b32 s67, v145, 48
    s_max_i32 s64, s64, s65
    s_max_i32 s66, s66, s67
    s_max_i32 s64, s64, s66
    s_add_i32 s66, s64, 125
    s_lshl_b32 s66, s66, 23
    s_nop 0
    v_subrev_u32 v148, s64, v148
    v_ldexp_f32 v148, 1.0, v148
    v_cvt_pk_f16_f32 v148, v148, v148
    v_subrev_u32 v149, s64, v149
    v_ldexp_f32 v149, 1.0, v149
    v_cvt_pk_f16_f32 v149, v149, v149
    v_subrev_u32 v150, s64, v150
    v_ldexp_f32 v150, 1.0, v150
    v_cvt_pk_f16_f32 v150, v150, v150
    v_subrev_u32 v151, s64, v151
    v_ldexp_f32 v151, 1.0, v151
    v_cvt_pk_f16_f32 v151, v151, v151
    v_pk_mul_f16 v32, v32, v148
    v_pk_mul_f16 v33, v33, v148
    v_pk_mul_f16 v34, v34, v148
    v_pk_mul_f16 v35, v35, v148
    v_pk_mul_f16 v36, v36, v149
    v_pk_mul_f16 v37, v37, v149
    v_pk_mul_f16 v38, v38, v149
    v_pk_mul_f16 v39, v39, v149
    v_pk_mul_f16 v40, v40, v150
    v_pk_mul_f16 v41, v41, v150
    v_pk_mul_f16 v42, v42, v150
    v_pk_mul_f16 v43, v43, v150
    v_pk_mul_f16 v44, v44, v151
    v_pk_mul_f16 v45, v45, v151
    v_pk_mul_f16 v46, v46, v151
    v_pk_mul_f16 v47, v47, v151
    v_pk_mul_f32 v[112:113], v[112:113], s[66:67] op_sel:[0,0] op_sel_hi:[1,0]
    v_pk_mul_f32 v[114:115], v[114:115], s[66:67] op_sel:[0,0] op_sel_hi:[1,0]
    v_pk_mul_f32 v[116:117], v[116:117], s[66:67] op_sel:[0,0] op_sel_hi:[1,0]
    v_pk_mul_f32 v[118:119], v[118:119], s[66:67] op_sel:[0,0] op_sel_hi:[1,0]
    v_pk_mul_f32 v[120:121], v[120:121], s[66:67] op_sel:[0,0] op_sel_hi:[1,0]
    v_pk_mul_f32 v[122:123], v[122:123], s[66:67] op_sel:[0,0] op_sel_hi:[1,0]
    v_pk_mul_f32 v[124:125], v[124:125], s[66:67] op_sel:[0,0] op_sel_hi:[1,0]
    v_pk_mul_f32 v[126:127], v[126:127], s[66:67] op_sel:[0,0] op_sel_hi:[1,0]
    v_pk_mul_f32 v[128:129], v[128:129], s[66:67] op_sel:[0,0] op_sel_hi:[1,0]
    v_pk_mul_f32 v[130:131], v[130:131], s[66:67] op_sel:[0,0] op_sel_hi:[1,0]
    v_pk_mul_f32 v[132:133], v[132:133], s[66:67] op_sel:[0,0] op_sel_hi:[1,0]
    v_pk_mul_f32 v[134:135], v[134:135], s[66:67] op_sel:[0,0] op_sel_hi:[1,0]
    v_pk_mul_f32 v[136:137], v[136:137], s[66:67] op_sel:[0,0] op_sel_hi:[1,0]
    v_pk_mul_f32 v[138:139], v[138:139], s[66:67] op_sel:[0,0] op_sel_hi:[1,0]
    v_pk_mul_f32 v[140:141], v[140:141], s[66:67] op_sel:[0,0] op_sel_hi:[1,0]
    v_pk_mul_f32 v[142:143], v[142:143], s[66:67] op_sel:[0,0] op_sel_hi:[1,0]
    v_mfma_f32_16x16x32_f16 v[80:83], v[32:35], v[192:195], 0
    v_mfma_f32_16x16x32_f16 v[80:83], v[36:39], v[196:199], v[80:83]
    v_mfma_f32_16x16x32_f16 v[80:83], v[40:43], v[200:203], v[80:83]
    v_mfma_f32_16x16x32_f16 v[80:83], v[44:47], v[204:207], v[80:83]
    v_mfma_f32_16x16x32_f16 v[84:87], v[32:35], v[208:211], 0
    v_mfma_f32_16x16x32_f16 v[84:87], v[36:39], v[212:215], v[84:87]
    v_mfma_f32_16x16x32_f16 v[84:87], v[40:43], v[216:219], v[84:87]
    v_mfma_f32_16x16x32_f16 v[84:87], v[44:47], v[220:223], v[84:87]
    s_nop 7
    s_branch f_zfok
f_slow2:
    v_cvt_pk_bf16_f32 v144, v160, v161
    v_lshlrev_b32 v160, 16, v144
    v_and_b32 v161, 0xffff0000, v144
    v_cvt_pk_bf16_f32 v144, v162, v163
    v_lshlrev_b32 v162, 16, v144
    v_and_b32 v163, 0xffff0000, v144
    v_cvt_pk_bf16_f32 v144, v164, v165
    v_lshlrev_b32 v164, 16, v144
    v_and_b32 v165, 0xffff0000, v144
    v_cvt_pk_bf16_f32 v144, v166, v167
    v_lshlrev_b32 v166, 16, v144
    v_and_b32 v167, 0xffff0000, v144
    v_cvt_pk_bf16_f32 v144, v168, v169
    v_lshlrev_b32 v168, 16, v144
    v_and_b32 v169, 0xffff0000, v144
    v_cvt_pk_bf16_f32 v144, v170, v171
    v_lshlrev_b32 v170, 16, v144
    v_and_b32 v171, 0xffff0000, v144
    v_cvt_pk_bf16_f32 v144, v172, v173
    v_lshlrev_b32 v172, 16, v144
    v_and_b32 v173, 0xffff0000, v144
    v_cvt_pk_bf16_f32 v144, v174, v175
    v_lshlrev_b32 v174, 16, v144
    v_and_b32 v175, 0xffff0000, v144
    v_pk_add_f32 v[144:145], v[160:161], v[162:163]
    v_pk_add_f32 v[144:145], v[144:145], v[164:165]
    v_pk_add_f32 v[144:145], v[144:145], v[166:167]
    v_pk_add_f32 v[144:145], v[144:145], v[168:169]
    v_pk_add_f32 v[144:145], v[144:145], v[170:171]
    v_pk_add_f32 v[144:145], v[144:145], v[172:173]
    v_pk_add_f32 v[144:145], v[144:145], v[174:175]
    v_cvt_pk_bf16_f32 v152, v176, v177
    v_lshlrev_b32 v176, 16, v152
    v_and_b32 v177, 0xffff0000, v152
    v_cvt_pk_bf16_f32 v152, v178, v179
    v_lshlrev_b32 v178, 16, v152
    v_and_b32 v179, 0xffff0000, v152
    v_cvt_pk_bf16_f32 v152, v180, v181
    v_lshlrev_b32 v180, 16, v152
    v_and_b32 v181, 0xffff0000, v152
    v_cvt_pk_bf16_f32 v152, v182, v183
    v_lshlrev_b32 v182, 16, v152
    v_and_b32 v183, 0xffff0000, v152
    v_cvt_pk_bf16_f32 v152, v184, v185
    v_lshlrev_b32 v184, 16, v152
    v_and_b32 v185, 0xffff0000, v152
    v_cvt_pk_bf16_f32 v152, v186, v187
    v_lshlrev_b32 v186, 16, v152
    v_and_b32 v187, 0xffff0000, v152
    v_cvt_pk_bf16_f32 v152, v188, v189
    v_lshlrev_b32 v188, 16, v152
    v_and_b32 v189, 0xffff0000, v152
    v_cvt_pk_bf16_f32 v152, v190, v191
    v_lshlrev_b32 v190, 16, v152
    v_and_b32 v191, 0xffff0000, v152
    v_pk_add_f32 v[152:153], v[176:177], v[178:179]
    v_pk_add_f32 v[152:153], v[152:153], v[180:181]
    v_pk_add_f32 v[152:153], v[152:153], v[182:183]
    v_pk_add_f32 v[152:153], v[152:153], v[184:185]
    v_pk_add_f32 v[152:153], v[152:153], v[186:187]
    v_pk_add_f32 v[152:153], v[152:153], v[188:189]
    v_pk_add_f32 v[152:153], v[152:153], v[190:191]
    v_add_f32 v104, v144, v145
    v_add_f32 v108, v152, v153
    s_nop 1
    v_permlane32_swap_b32 v104, v108
    v_add_f32 v104, v104, v108
    s_nop 1
    v_add_f32_dpp v104, v104, v104 row_ror:8 row_mask:0xf bank_mask:0xf
    s_nop 1
    v_add_f32_dpp v104, v104, v104 row_ror:4 row_mask:0xf bank_mask:0xf
    s_nop 1
    v_add_f32_dpp v104, v104, v104 row_ror:2 row_mask:0xf bank_mask:0xf
    s_nop 1
    v_add_f32_dpp v104, v104, v104 row_ror:1 row_mask:0xf bank_mask:0xf
    s_nop 1
    v_add_f32_dpp v104, v104, v104 row_bcast:15 row_mask:0xa bank_mask:0xf
    v_mul_f32 v107, s46, v104
    v_cvt_pk_bf16_f32 v104, v107, v107
    v_lshlrev_b32 v104, 16, v104
    v_sub_f32 v107, v107, v104
    v_readlane_b32 s64, v104, 31
    v_readlane_b32 s66, v104, 63
    s_nop 0
    v_pk_add_f32 v[80:81], v[160:161], s[64:65] op_sel:[0,0] op_sel_hi:[1,0] neg_lo:[0,1] neg_hi:[0,1]
    v_pk_add_f32 v[82:83], v[162:163], s[64:65] op_sel:[0,0] op_sel_hi:[1,0] neg_lo:[0,1] neg_hi:[0,1]
    v_pk_add_f32 v[84:85], v[164:165], s[64:65] op_sel:[0,0] op_sel_hi:[1,0] neg_lo:[0,1] neg_hi:[0,1]
    v_pk_add_f32 v[86:87], v[166:167], s[64:65] op_sel:[0,0] op_sel_hi:[1,0] neg_lo:[0,1] neg_hi:[0,1]
    v_pk_add_f32 v[88:89], v[168:169], s[64:65] op_sel:[0,0] op_sel_hi:[1,0] neg_lo:[0,1] neg_hi:[0,1]
    v_pk_add_f32 v[90:91], v[170:171], s[64:65] op_sel:[0,0] op_sel_hi:[1,0] neg_lo:[0,1] neg_hi:[0,1]
    v_pk_add_f32 v[92:93], v[172:173], s[64:65] op_sel:[0,0] op_sel_hi:[1,0] neg_lo:[0,1] neg_hi:[0,1]
    v_pk_add_f32 v[94:95], v[174:175], s[64:65] op_sel:[0,0] op_sel_hi:[1,0] neg_lo:[0,1] neg_hi:[0,1]
    v_pk_mul_f32 v[146:147], v[80:81], v[80:81]
    v_pk_mul_f32 v[148:149], v[80:81], v[48:49]
    v_pk_fma_f32 v[146:147], v[82:83], v[82:83], v[146:147]
    v_pk_fma_f32 v[148:149], v[82:83], v[50:51], v[148:149]
    v_pk_fma_f32 v[146:147], v[84:85], v[84:85], v[146:147]
    v_pk_fma_f32 v[148:149], v[84:85], v[52:53], v[148:149]
    v_pk_fma_f32 v[146:147], v[86:87], v[86:87], v[146:147]
    v_pk_fma_f32 v[148:149], v[86:87], v[54:55], v[148:149]
    v_pk_fma_f32 v[146:147], v[88:89], v[88:89], v[146:147]
    v_pk_fma_f32 v[148:149], v[88:89], v[56:57], v[148:149]
    v_pk_fma_f32 v[146:147], v[90:91], v[90:91], v[146:147]
    v_pk_fma_f32 v[148:149], v[90:91], v[58:59], v[148:149]
    v_pk_fma_f32 v[146:147], v[92:93], v[92:93], v[146:147]
    v_pk_fma_f32 v[148:149], v[92:93], v[60:61], v[148:149]
    v_pk_fma_f32 v[146:147], v[94:95], v[94:95], v[146:147]
    v_pk_fma_f32 v[148:149], v[94:95], v[62:63], v[148:149]
    v_pk_add_f32 v[32:33], v[176:177], s[66:67] op_sel:[0,0] op_sel_hi:[1,0] neg_lo:[0,1] neg_hi:[0,1]
    v_pk_add_f32 v[34:35], v[178:179], s[66:67] op_sel:[0,0] op_sel_hi:[1,0] neg_lo:[0,1] neg_hi:[0,1]
    v_pk_add_f32 v[36:37], v[180:181], s[66:67] op_sel:[0,0] op_sel_hi:[1,0] neg_lo:[0,1] neg_hi:[0,1]
    v_pk_add_f32 v[38:39], v[182:183], s[66:67] op_sel:[0,0] op_sel_hi:[1,0] neg_lo:[0,1] neg_hi:[0,1]
    v_pk_add_f32 v[40:41], v[184:185], s[66:67] op_sel:[0,0] op_sel_hi:[1,0] neg_lo:[0,1] neg_hi:[0,1]
    v_pk_add_f32 v[42:43], v[186:187], s[66:67] op_sel:[0,0] op_sel_hi:[1,0] neg_lo:[0,1] neg_hi:[0,1]
    v_pk_add_f32 v[44:45], v[188:189], s[66:67] op_sel:[0,0] op_sel_hi:[1,0] neg_lo:[0,1] neg_hi:[0,1]
    v_pk_add_f32 v[46:47], v[190:191], s[66:67] op_sel:[0,0] op_sel_hi:[1,0] neg_lo:[0,1] neg_hi:[0,1]
    v_pk_mul_f32 v[154:155], v[32:33], v[32:33]
    v_pk_mul_f32 v[156:157], v[32:33], v[64:65]
    v_pk_fma_f32 v[154:155], v[34:35], v[34:35], v[154:155]
    v_pk_fma_f32 v[156:157], v[34:35], v[66:67], v[156:157]
    v_pk_fma_f32 v[154:155], v[36:37], v[36:37], v[154:155]
    v_pk_fma_f32 v[156:157], v[36:37], v[68:69], v[156:157]
    v_pk_fma_f32 v[154:155], v[38:39], v[38:39], v[154:155]
    v_pk_fma_f32 v[156:157], v[38:39], v[70:71], v[156:157]
    v_pk_fma_f32 v[154:155], v[40:41], v[40:41], v[154:155]
    v_pk_fma_f32 v[156:157], v[40:41], v[72:73], v[156:157]
    v_pk_fma_f32 v[154:155], v[42:43], v[42:43], v[154:155]
    v_pk_fma_f32 v[156:157], v[42:43], v[74:75], v[156:157]
    v_pk_fma_f32 v[154:155], v[44:45], v[44:45], v[154:155]
    v_pk_fma_f32 v[156:157], v[44:45], v[76:77], v[156:157]
    v_pk_fma_f32 v[154:155], v[46:47], v[46:47], v[154:155]
    v_pk_fma_f32 v[156:157], v[46:47], v[78:79], v[156:157]
    v_add_f32 v105, v146, v147
    v_add_f32 v106, v148, v149
    v_add_f32 v109, v154, v155
    v_add_f32 v110, v156, v157
    s_nop 0
    v_permlane32_swap_b32 v105, v109
    v_permlane32_swap_b32 v106, v110
    v_add_f32 v105, v105, v109
    v_add_f32 v106, v106, v110
    s_nop 0
    v_add_f32_dpp v105, v105, v105 row_ror:8 row_mask:0xf bank_mask:0xf
    v_add_f32_dpp v106, v106, v106 row_ror:8 row_mask:0xf bank_mask:0xf
    s_nop 0
    v_add_f32_dpp v105, v105, v105 row_ror:4 row_mask:0xf bank_mask:0xf
    v_add_f32_dpp v106, v106, v106 row_ror:4 row_mask:0xf bank_mask:0xf
    s_nop 0
    v_add_f32_dpp v105, v105, v105 row_ror:2 row_mask:0xf bank_mask:0xf
    v_add_f32_dpp v106, v106, v106 row_ror:2 row_mask:0xf bank_mask:0xf
    s_nop 0
    v_add_f32_dpp v105, v105, v105 row_ror:1 row_mask:0xf bank_mask:0xf
    v_add_f32_dpp v106, v106, v106 row_ror:1 row_mask:0xf bank_mask:0xf
    s_nop 0
    v_add_f32_dpp v105, v105, v105 row_bcast:15 row_mask:0xa bank_mask:0xf
    v_add_f32_dpp v106, v106, v106 row_bcast:15 row_mask:0xa bank_mask:0xf
    v_mul_f32 v105, s46, v105
    v_fma_f32 v105, -v107, v107, v105
    v_max_f32 v105, 0, v105
    s_branch f_var2
f_slowvar:
    v_lshlrev_b32 v66, 16, v56
    s_nop 0
    v_readlane_b32 s68, v66, 31
    v_readlane_b32 s70, v66, 63
    v_lshlrev_b32 v100, 16, v32
    v_and_b32 v101, 0xffff0000, v32
    v_pk_add_f32 v[100:101], v[100:101], s[68:69] op_sel_hi:[1,0]
    v_pk_mul_f32 v[102:103], v[100:101], v[100:101]
    v_lshlrev_b32 v100, 16, v33
    v_and_b32 v101, 0xffff0000, v33
    v_pk_add_f32 v[100:101], v[100:101], s[68:69] op_sel_hi:[1,0]
    v_pk_fma_f32 v[102:103], v[100:101], v[100:101], v[102:103]
    v_lshlrev_b32 v100, 16, v34
    v_and_b32 v101, 0xffff0000, v34
    v_pk_add_f32 v[100:101], v[100:101], s[68:69] op_sel_hi:[1,0]
    v_pk_fma_f32 v[102:103], v[100:101], v[100:101], v[102:103]
    v_lshlrev_b32 v100, 16, v35
    v_and_b32 v101, 0xffff0000, v35
    v_pk_add_f32 v[100:101], v[100:101], s[68:69] op_sel_hi:[1,0]
    v_pk_fma_f32 v[102:103], v[100:101], v[100:101], v[102:103]
    v_lshlrev_b32 v100, 16, v36
    v_and_b32 v101, 0xffff0000, v36
    v_pk_add_f32 v[100:101], v[100:101], s[68:69] op_sel_hi:[1,0]
    v_pk_fma_f32 v[102:103], v[100:101], v[100:101], v[102:103]
    v_lshlrev_b32 v100, 16, v37
    v_and_b32 v101, 0xffff0000, v37
    v_pk_add_f32 v[100:101], v[100:101], s[68:69] op_sel_hi:[1,0]
    v_pk_fma_f32 v[102:103], v[100:101], v[100:101], v[102:103]
    v_lshlrev_b32 v100, 16, v38
    v_and_b32 v101, 0xffff0000, v38
    v_pk_add_f32 v[100:101], v[100:101], s[68:69] op_sel_hi:[1,0]
    v_pk_fma_f32 v[102:103], v[100:101], v[100:101], v[102:103]
    v_lshlrev_b32 v100, 16, v39
    v_and_b32 v101, 0xffff0000, v39
    v_pk_add_f32 v[100:101], v[100:101], s[68:69] op_sel_hi:[1,0]
    v_pk_fma_f32 v[102:103], v[100:101], v[100:101], v[102:103]
    v_add_f32 v54, v102, v103
    v_lshlrev_b32 v100, 16, v40
    v_and_b32 v101, 0xffff0000, v40
    v_pk_add_f32 v[100:101], v[100:101], s[70:71] op_sel_hi:[1,0]
    v_pk_mul_f32 v[102:103], v[100:101], v[100:101]
    v_lshlrev_b32 v100, 16, v41
    v_and_b32 v101, 0xffff0000, v41
    v_pk_add_f32 v[100:101], v[100:101], s[70:71] op_sel_hi:[1,0]
    v_pk_fma_f32 v[102:103], v[100:101], v[100:101], v[102:103]
    v_lshlrev_b32 v100, 16, v42
    v_and_b32 v101, 0xffff0000, v42
    v_pk_add_f32 v[100:101], v[100:101], s[70:71] op_sel_hi:[1,0]
    v_pk_fma_f32 v[102:103], v[100:101], v[100:101], v[102:103]
    v_lshlrev_b32 v100, 16, v43
    v_and_b32 v101, 0xffff0000, v43
    v_pk_add_f32 v[100:101], v[100:101], s[70:71] op_sel_hi:[1,0]
    v_pk_fma_f32 v[102:103], v[100:101], v[100:101], v[102:103]
    v_lshlrev_b32 v100, 16, v44
    v_and_b32 v101, 0xffff0000, v44
    v_pk_add_f32 v[100:101], v[100:101], s[70:71] op_sel_hi:[1,0]
    v_pk_fma_f32 v[102:103], v[100:101], v[100:101], v[102:103]
    v_lshlrev_b32 v100, 16, v45
    v_and_b32 v101, 0xffff0000, v45
    v_pk_add_f32 v[100:101], v[100:101], s[70:71] op_sel_hi:[1,0]
    v_pk_fma_f32 v[102:103], v[100:101], v[100:101], v[102:103]
    v_lshlrev_b32 v100, 16, v46
    v_and_b32 v101, 0xffff0000, v46
    v_pk_add_f32 v[100:101], v[100:101], s[70:71] op_sel_hi:[1,0]
    v_pk_fma_f32 v[102:103], v[100:101], v[100:101], v[102:103]
    v_lshlrev_b32 v100, 16, v47
    v_and_b32 v101, 0xffff0000, v47
    v_pk_add_f32 v[100:101], v[100:101], s[70:71] op_sel_hi:[1,0]
    v_pk_fma_f32 v[102:103], v[100:101], v[100:101], v[102:103]
    v_add_f32 v55, v102, v103
    v_add_f32 v66, v66, v52
    s_nop 0
    v_permlane32_swap_b32 v54, v55
    v_add_f32 v54, v54, v55
    s_nop 1
    v_add_f32_dpp v54, v54, v54 row_ror:8 row_mask:0xf bank_mask:0xf
    s_nop 1
    v_add_f32_dpp v54, v54, v54 row_ror:4 row_mask:0xf bank_mask:0xf
    s_nop 1
    v_add_f32_dpp v54, v54, v54 row_ror:2 row_mask:0xf bank_mask:0xf
    s_nop 1
    v_add_f32_dpp v54, v54, v54 row_ror:1 row_mask:0xf bank_mask:0xf
    s_nop 1
    v_add_f32_dpp v54, v54, v54 row_bcast:15 row_mask:0xa bank_mask:0xf
    v_mul_f32 v54, s46, v54
    v_fma_f32 v54, -v66, v66, v54
    v_max_f32 v54, 0, v54
    s_branch f_var
f_sa:
    s_add_u32 s69, s69, 50331648
    v_cndmask_b32 v120, v120, v121, s[64:65]
    v_cndmask_b32 v122, v122, v123, s[64:65]
    v_cndmask_b32 v120, v120, v122, s[66:67]
    v_mul_f32 v120, s69, v120
    v_and_b32 v52, 15, v0
    v_cvt_pk_f16_f32 v48, v120, v120
    v_cmp_eq_u32 vcc, 0, v52
    v_mov_b32 v54, 0x3c00
    v_mov_b32 v55, 0xbc000000
    v_cndmask_b32 v54, 0, v54, vcc
    v_cndmask_b32 v55, 0, v55, vcc
    v_mov_b32_dpp v56, v48 quad_perm:[0,0,0,0] row_mask:0xf bank_mask:0xf
    v_mov_b32_dpp v57, v48 quad_perm:[1,1,1,1] row_mask:0xf bank_mask:0xf
    v_mov_b32_dpp v58, v48 quad_perm:[2,2,2,2] row_mask:0xf bank_mask:0xf
    v_mov_b32_dpp v59, v48 quad_perm:[3,3,3,3] row_mask:0xf bank_mask:0xf
    v_pk_mul_f16 v72, v54, v56
    v_pk_mul_f16 v73, v54, v57
    v_pk_mul_f16 v74, v54, v58
    v_pk_mul_f16 v75, v54, v59
    v_pk_mul_f16 v76, v55, v56
    v_pk_mul_f16 v77, v55, v57
    v_pk_mul_f16 v78, v55, v58
    v_pk_mul_f16 v79, v55, v59
    v_mfma_f32_16x16x32_f16 v[112:115], v[72:75], v[144:147], 0
    s_nop 0
    v_mfma_f32_16x16x32_f16 v[116:119], v[76:79], v[144:147], 0
    s_lshl_b32 s70, s16, 7
    v_mov_b32 v53, 8592
    v_add3_u32 v52, s70, v12, v53
    s_mov_b64 exec, 0xffff
    s_nop 3
    ds_write2_b32 v52, v112, v116 offset0:0 offset1:16
    s_mov_b64 exec, -1
    s_branch f_nsa
f_sb:
    v_mov_b32 v48, s32
    v_mov_b32 v49, s61
    v_mov_b32 v50, 0
    s_mov_b64 exec, 1
    buffer_store_dwordx2 v[48:49], v50, s[12:15], s79 offen sc1
    s_mov_b64 exec, -1
    s_cmp_lg_u32 s34, 0
    s_cbranch_scc1 f_sb2
    s_mov_b64 exec, 0xffff
    ds_read_b32 v56, v12 offset:8592
    ds_read_b32 v57, v12 offset:8656
    ds_read_b32 v58, v12 offset:8720
    ds_read_b32 v59, v12 offset:8784
    ds_read_b32 v60, v12 offset:8848
    ds_read_b32 v61, v12 offset:8912
    ds_read_b32 v62, v12 offset:8976
    ds_read_b32 v63, v12 offset:9040
    s_waitcnt lgkmcnt(0)
    v_add_f32 v80, v80, v56
    v_add_f32 v84, v84, v57
    v_add_f32 v88, v88, v58
    v_add_f32 v92, v92, v59
    v_add_f32 v96, v96, v60
    v_add_f32 v100, v100, v61
    v_add_f32 v104, v104, v62
    v_add_f32 v108, v108, v63
    s_mov_b64 exec, -1
f_sb2:
    s_branch f_nsb
f_sp:
    s_waitcnt lgkmcnt(0)
    v_mfma_f32_16x16x32_f16 v[88:91], v[32:35], v[224:227], 0
    v_mfma_f32_16x16x32_f16 v[88:91], v[36:39], v[228:231], v[88:91]
    v_mfma_f32_16x16x32_f16 v[88:91], v[40:43], v[232:235], v[88:91]
    v_mfma_f32_16x16x32_f16 v[88:91], v[44:47], v[236:239], v[88:91]
    v_mfma_f32_16x16x32_f16 v[92:95], v[32:35], v[240:243], 0
    v_mfma_f32_16x16x32_f16 v[92:95], v[36:39], v[244:247], v[92:95]
    v_mfma_f32_16x16x32_f16 v[92:95], v[40:43], v[248:251], v[92:95]
    v_mfma_f32_16x16x32_f16 v[92:95], v[44:47], v[252:255], v[92:95]
    v_pk_mul_f16 v32, v32, 1.0 op_sel:[1,0] op_sel_hi:[0,0] neg_hi:[1,0]
    v_pk_mul_f16 v33, v33, 1.0 op_sel:[1,0] op_sel_hi:[0,0] neg_hi:[1,0]
    v_pk_mul_f16 v34, v34, 1.0 op_sel:[1,0] op_sel_hi:[0,0] neg_hi:[1,0]
    v_pk_mul_f16 v35, v35, 1.0 op_sel:[1,0] op_sel_hi:[0,0] neg_hi:[1,0]
    v_pk_mul_f16 v36, v36, 1.0 op_sel:[1,0] op_sel_hi:[0,0] neg_hi:[1,0]
    v_pk_mul_f16 v37, v37, 1.0 op_sel:[1,0] op_sel_hi:[0,0] neg_hi:[1,0]
    v_pk_mul_f16 v38, v38, 1.0 op_sel:[1,0] op_sel_hi:[0,0] neg_hi:[1,0]
    v_pk_mul_f16 v39, v39, 1.0 op_sel:[1,0] op_sel_hi:[0,0] neg_hi:[1,0]
    v_pk_mul_f16 v40, v40, 1.0 op_sel:[1,0] op_sel_hi:[0,0] neg_hi:[1,0]
    v_pk_mul_f16 v41, v41, 1.0 op_sel:[1,0] op_sel_hi:[0,0] neg_hi:[1,0]
    v_pk_mul_f16 v42, v42, 1.0 op_sel:[1,0] op_sel_hi:[0,0] neg_hi:[1,0]
    v_pk_mul_f16 v43, v43, 1.0 op_sel:[1,0] op_sel_hi:[0,0] neg_hi:[1,0]
    v_pk_mul_f16 v44, v44, 1.0 op_sel:[1,0] op_sel_hi:[0,0] neg_hi:[1,0]
    v_pk_mul_f16 v45, v45, 1.0 op_sel:[1,0] op_sel_hi:[0,0] neg_hi:[1,0]
    v_pk_mul_f16 v46, v46, 1.0 op_sel:[1,0] op_sel_hi:[0,0] neg_hi:[1,0]
    v_pk_mul_f16 v47, v47, 1.0 op_sel:[1,0] op_sel_hi:[0,0] neg_hi:[1,0]
    v_mfma_f32_16x16x32_f16 v[96:99], v[32:35], v[192:195], 0
    v_mfma_f32_16x16x32_f16 v[96:99], v[36:39], v[196:199], v[96:99]
    v_mfma_f32_16x16x32_f16 v[96:99], v[40:43], v[200:203], v[96:99]
    v_mfma_f32_16x16x32_f16 v[96:99], v[44:47], v[204:207], v[96:99]
    v_mfma_f32_16x16x32_f16 v[100:103], v[32:35], v[208:211], 0
    v_mfma_f32_16x16x32_f16 v[100:103], v[36:39], v[212:215], v[100:103]
    v_mfma_f32_16x16x32_f16 v[100:103], v[40:43], v[216:219], v[100:103]
    v_mfma_f32_16x16x32_f16 v[100:103], v[44:47], v[220:223], v[100:103]
    v_mfma_f32_16x16x32_f16 v[104:107], v[32:35], v[224:227], 0
    v_mfma_f32_16x16x32_f16 v[104:107], v[36:39], v[228:231], v[104:107]
    v_mfma_f32_16x16x32_f16 v[104:107], v[40:43], v[232:235], v[104:107]
    v_mfma_f32_16x16x32_f16 v[104:107], v[44:47], v[236:239], v[104:107]
    v_mfma_f32_16x16x32_f16 v[108:111], v[32:35], v[240:243], 0
    v_mfma_f32_16x16x32_f16 v[108:111], v[36:39], v[244:247], v[108:111]
    v_mfma_f32_16x16x32_f16 v[108:111], v[40:43], v[248:251], v[108:111]
    v_mfma_f32_16x16x32_f16 v[108:111], v[44:47], v[252:255], v[108:111]
    v_subrev_u32 v2, s45, v8
    v_lshlrev_b32 v2, 1, v2
    v_add_u32 v20, s45, v2
    s_add_u32 s42, s45, 1008
    v_sub_u32 v21, s42, v2
    ds_write_b128 v20, v[80:83] offset:0
    ds_write_b128 v20, v[84:87] offset:1024
    ds_write_b128 v20, v[88:91] offset:2048
    ds_write_b128 v20, v[92:95] offset:3072
    v_sub_u32 v156, 4096, v2
    v_and_b32 v156, 4095, v156
    v_add_u32 v156, s45, v156
    v_sub_u32 v157, 3072, v2
    v_and_b32 v157, 4095, v157
    v_add_u32 v157, s45, v157
    v_sub_u32 v158, 2048, v2
    v_and_b32 v158, 4095, v158
    v_add_u32 v158, s45, v158
    v_sub_u32 v159, 1024, v2
    v_and_b32 v159, 4095, v159
    v_add_u32 v159, s45, v159
    ds_read_b128 v[32:35], v21 offset:3072
    ds_read_b128 v[36:39], v21 offset:2048
    ds_read_b128 v[40:43], v21 offset:1024
    ds_read_b128 v[44:47], v21 offset:0
    ds_read_b32 v152, v156
    ds_read_b32 v153, v157
    ds_read_b32 v154, v158
    ds_read_b32 v155, v159
    s_waitcnt lgkmcnt(0)
    v_add_f32 v80, v80, v152
    v_add_f32 v81, v81, v35
    v_add_f32 v82, v82, v34
    v_add_f32 v83, v83, v33
    v_add_f32 v84, v84, v153
    v_add_f32 v85, v85, v39
    v_add_f32 v86, v86, v38
    v_add_f32 v87, v87, v37
    v_add_f32 v88, v88, v154
    v_add_f32 v89, v89, v43
    v_add_f32 v90, v90, v42
    v_add_f32 v91, v91, v41
    v_add_f32 v92, v92, v155
    v_add_f32 v93, v93, v47
    v_add_f32 v94, v94, v46
    v_add_f32 v95, v95, v45
    v_pk_fma_f32 v[160:161], v[112:113], v[80:81], v[160:161]
    v_pk_fma_f32 v[162:163], v[114:115], v[82:83], v[162:163]
    v_pk_fma_f32 v[164:165], v[116:117], v[84:85], v[164:165]
    v_pk_fma_f32 v[166:167], v[118:119], v[86:87], v[166:167]
    v_pk_fma_f32 v[168:169], v[120:121], v[88:89], v[168:169]
    v_pk_fma_f32 v[170:171], v[122:123], v[90:91], v[170:171]
    v_pk_fma_f32 v[172:173], v[124:125], v[92:93], v[172:173]
    v_pk_fma_f32 v[174:175], v[126:127], v[94:95], v[174:175]
    ds_write_b128 v20, v[96:99] offset:0
    ds_write_b128 v20, v[100:103] offset:1024
    ds_write_b128 v20, v[104:107] offset:2048
    ds_write_b128 v20, v[108:111] offset:3072
    v_add_u32 v156, 16, v2
    v_and_b32 v156, 4095, v156
    v_add_u32 v156, s45, v156
    v_add_u32 v157, 1040, v2
    v_and_b32 v157, 4095, v157
    v_add_u32 v157, s45, v157
    v_add_u32 v158, 2064, v2
    v_and_b32 v158, 4095, v158
    v_add_u32 v158, s45, v158
    v_add_u32 v159, 3088, v2
    v_and_b32 v159, 4095, v159
    v_add_u32 v159, s45, v159
    ds_read_b128 v[32:35], v21 offset:3072
    ds_read_b128 v[36:39], v21 offset:2048
    ds_read_b128 v[40:43], v21 offset:1024
    ds_read_b128 v[44:47], v21 offset:0
    ds_read_b32 v152, v156
    ds_read_b32 v153, v157
    ds_read_b32 v154, v158
    ds_read_b32 v155, v159
    s_waitcnt lgkmcnt(0)
    v_add_f32 v32, v32, v152
    v_add_f32 v33, v33, v99
    v_add_f32 v34, v34, v98
    v_add_f32 v35, v35, v97
    v_add_f32 v36, v36, v153
    v_add_f32 v37, v37, v103
    v_add_f32 v38, v38, v102
    v_add_f32 v39, v39, v101
    v_add_f32 v40, v40, v154
    v_add_f32 v41, v41, v107
    v_add_f32 v42, v42, v106
    v_add_f32 v43, v43, v105
    v_add_f32 v44, v44, v155
    v_add_f32 v45, v45, v111
    v_add_f32 v46, v46, v110
    v_add_f32 v47, v47, v109
    v_pk_fma_f32 v[176:177], v[128:129], v[32:33], v[176:177]
    v_pk_fma_f32 v[178:179], v[130:131], v[34:35], v[178:179]
    v_pk_fma_f32 v[180:181], v[132:133], v[36:37], v[180:181]
    v_pk_fma_f32 v[182:183], v[134:135], v[38:39], v[182:183]
    v_pk_fma_f32 v[184:185], v[136:137], v[40:41], v[184:185]
    v_pk_fma_f32 v[186:187], v[138:139], v[42:43], v[186:187]
    v_pk_fma_f32 v[188:189], v[140:141], v[44:45], v[188:189]
    v_pk_fma_f32 v[190:191], v[142:143], v[46:47], v[190:191]
    v_pk_mul_f32 v[146:147], v[160:161], v[160:161]
    v_pk_mul_f32 v[148:149], v[160:161], v[48:49]
    v_pk_fma_f32 v[146:147], v[162:163], v[162:163], v[146:147]
    v_pk_fma_f32 v[148:149], v[162:163], v[50:51], v[148:149]
    v_pk_fma_f32 v[146:147], v[164:165], v[164:165], v[146:147]
    v_pk_fma_f32 v[148:149], v[164:165], v[52:53], v[148:149]
    v_pk_fma_f32 v[146:147], v[166:167], v[166:167], v[146:147]
    v_pk_fma_f32 v[148:149], v[166:167], v[54:55], v[148:149]
    v_pk_fma_f32 v[146:147], v[168:169], v[168:169], v[146:147]
    v_pk_fma_f32 v[148:149], v[168:169], v[56:57], v[148:149]
    v_pk_fma_f32 v[146:147], v[170:171], v[170:171], v[146:147]
    v_pk_fma_f32 v[148:149], v[170:171], v[58:59], v[148:149]
    v_pk_fma_f32 v[146:147], v[172:173], v[172:173], v[146:147]
    v_pk_fma_f32 v[148:149], v[172:173], v[60:61], v[148:149]
    v_pk_fma_f32 v[146:147], v[174:175], v[174:175], v[146:147]
    v_pk_fma_f32 v[148:149], v[174:175], v[62:63], v[148:149]
    v_pk_add_f32 v[144:145], v[160:161], v[162:163]
    v_pk_add_f32 v[144:145], v[144:145], v[164:165]
    v_pk_add_f32 v[144:145], v[144:145], v[166:167]
    v_pk_add_f32 v[144:145], v[144:145], v[168:169]
    v_pk_add_f32 v[144:145], v[144:145], v[170:171]
    v_pk_add_f32 v[144:145], v[144:145], v[172:173]
    v_pk_add_f32 v[144:145], v[144:145], v[174:175]
    v_pk_mul_f32 v[154:155], v[176:177], v[176:177]
    v_pk_mul_f32 v[156:157], v[176:177], v[64:65]
    v_pk_fma_f32 v[154:155], v[178:179], v[178:179], v[154:155]
    v_pk_fma_f32 v[156:157], v[178:179], v[66:67], v[156:157]
    v_pk_fma_f32 v[154:155], v[180:181], v[180:181], v[154:155]
    v_pk_fma_f32 v[156:157], v[180:181], v[68:69], v[156:157]
    v_pk_fma_f32 v[154:155], v[182:183], v[182:183], v[154:155]
    v_pk_fma_f32 v[156:157], v[182:183], v[70:71], v[156:157]
    v_pk_fma_f32 v[154:155], v[184:185], v[184:185], v[154:155]
    v_pk_fma_f32 v[156:157], v[184:185], v[72:73], v[156:157]
    v_pk_fma_f32 v[154:155], v[186:187], v[186:187], v[154:155]
    v_pk_fma_f32 v[156:157], v[186:187], v[74:75], v[156:157]
    v_pk_fma_f32 v[154:155], v[188:189], v[188:189], v[154:155]
    v_pk_fma_f32 v[156:157], v[188:189], v[76:77], v[156:157]
    v_pk_fma_f32 v[154:155], v[190:191], v[190:191], v[154:155]
    v_pk_fma_f32 v[156:157], v[190:191], v[78:79], v[156:157]
    v_pk_add_f32 v[152:153], v[176:177], v[178:179]
    v_pk_add_f32 v[152:153], v[152:153], v[180:181]
    v_pk_add_f32 v[152:153], v[152:153], v[182:183]
    v_pk_add_f32 v[152:153], v[152:153], v[184:185]
    v_pk_add_f32 v[152:153], v[152:153], v[186:187]
    v_pk_add_f32 v[152:153], v[152:153], v[188:189]
    v_pk_add_f32 v[152:153], v[152:153], v[190:191]
    s_branch f_join
g_start:
    s_mov_b32 s43, 6619136
    s_load_dword s101, s[6:7], s43
    s_mov_b32 s44, s20
    s_mov_b32 s45, s21
    s_mov_b32 s46, 2048
    s_mov_b32 s47, 0x00020000
    v_and_b32 v6, 127, v0
    v_lshlrev_b32 v6, 1, v6
    s_lshl_b32 s19, s34, 8
    buffer_load_ushort v110, v6, s[44:47], s19 offen
    s_and_b32 s65, s35, 1
    s_lshr_b32 s40, s35, 1
    s_mul_i32 s64, s34, 7
    s_add_u32 s64, s64, s40
    s_cmp_ge_u32 s35, 14
    s_cselect_b32 s66, 1, 0
    s_mov_b32 s40, s34
    v_bfe_u32 v5, v0, 5, 1
    v_lshlrev_b32 v5, 3, v5
    v_bfe_u32 v9, v0, 3, 2
    v_add_u32 v5, v5, v9
    v_lshlrev_b32 v9, 1, v7
    v_xor_b32 v9, v9, v0
    v_and_b32 v9, 7, v9
    v_lshlrev_b32 v9, 4, v9
    s_movk_i32 s42, 7168
    v_mad_u32_u24 v5, v5, s42, v9
    v_mov_b32 v104, -1
    v_mov_b32 v105, -1
    v_mov_b32 v106, -1
    v_mov_b32 v107, -1
    v_mov_b32 v14, 0
    s_lshl_b32 s38, s64, 12
    s_lshl_b32 s42, s16, 9
    s_add_u32 s38, s38, s42
    s_mul_i32 s42, s65, 262144
    s_add_u32 s38, s38, s42
    s_add_u32 s38, s38, 4718592
    s_mov_b32 s12, s6
    s_mov_b32 s13, s7
    s_mov_b32 s14, 268435456
    s_mov_b32 s15, 0x00020000
    s_lshl_b32 s42, s35, 3
    s_add_u32 s42, s42, s34
    s_lshl_b32 s42, s42, 3
    s_add_u32 s42, s42, s16
    s_lshl_b32 s42, s42, 8
    s_add_u32 s42, s42, 6291456
    v_lshlrev_b32 v9, 7, v2
    s_mov_b64 exec, 3
    buffer_load_dword v251, v9, s[12:15], s42 offen
    s_mov_b64 exec, -1
    s_mov_b32 s44, s50
    s_mov_b32 s45, s51
    s_mov_b32 s46, 7340032
    s_mov_b32 s47, 0x00020000
    s_mov_b32 s60, s52
    s_mov_b32 s61, s53
    s_mov_b32 s62, 7340032
    s_mov_b32 s63, 0x00020000
    s_mov_b32 s72, s54
    s_mov_b32 s73, s55
    s_mov_b32 s74, 7340032
    s_mov_b32 s75, 0x00020000
    s_mov_b32 s26, 4194304
    s_mov_b32 s27, 0x00020000
    s_lshl_b32 s67, s65, 4
    s_add_u32 s67, s67, s16
    s_mul_i32 s67, s67, 229376
    s_lshl_b32 s42, s64, 7
    s_add_u32 s67, s67, s42
    s_lshl_b32 s42, s64, 6
    s_and_b32 s43, s16, 3
    s_lshl_b32 s43, s43, 3
    s_add_u32 s42, s42, s43
    s_and_b32 s43, s16, 4
    s_add_u32 s42, s42, s43
    s_lshl_b32 s69, s42, 11
    s_lshl_b32 s43, s65, 10
    s_add_u32 s69, s69, s43
    s_and_b32 s43, s16, 1
    s_lshl_b32 s43, s43, 7
    v_xor_b32 v21, s43, v3
    v_xor_b32 v22, 32, v21
    v_xor_b32 v23, 64, v21
    v_xor_b32 v24, 96, v21
    v_add_u32 v109, 131072, v6
    v_lshrrev_b32 v6, 2, v2
    v_and_b32 v15, 3, v0
    v_bfe_u32 v16, v0, 3, 2
    v_xor_b32 v12, v16, v1
    v_and_b32 v12, 3, v12
    v_lshlrev_b32 v12, 5, v12
    v_lshl_add_u32 v12, v6, 7, v12
    v_lshl_add_u32 v12, v15, 3, v12
    v_lshrrev_b32 v16, 2, v1
    v_lshl_add_u32 v12, v16, 14, v12
    v_add_u32 v25, 65536, v12
    v_and_b32 v17, 7, v6
    v_lshlrev_b32 v8, 2, v1
    v_xor_b32 v8, v8, v17
    v_lshlrev_b32 v8, 5, v8
    v_lshl_add_u32 v8, v6, 10, v8
    v_lshl_add_u32 v8, v15, 3, v8
    v_xor_b32 v9, 32, v8
    v_xor_b32 v10, 64, v8
    v_xor_b32 v11, 96, v8
    v_and_b32 v6, 1, v0
    v_lshlrev_b32 v17, 10, v6
    v_lshl_add_u32 v17, v16, 8, v17
    v_lshl_add_u32 v17, v7, 4, v17
    v_add_u32 v17, 131584, v17
    v_lshlrev_b32 v19, 7, v6
    v_lshl_add_u32 v19, v7, 4, v19
    v_add_u32 v19, 133632, v19
    v_and_b32 v6, 15, v0
    v_lshlrev_b32 v18, 1, v6
    v_lshl_add_u32 v18, v1, 5, v18
    v_lshl_add_u32 v18, v7, 7, v18
    v_add_u32 v18, 133632, v18
    v_lshlrev_b32 v20, 2, v6
    v_lshl_add_u32 v20, v1, 14, v20
    v_lshl_add_u32 v20, v7, 12, v20
    v_lshlrev_b32 v26, 4, v7
    v_add_u32 v27, 131072, v26
    v_lshlrev_b32 v28, 11, v7
    v_bfe_u32 v29, v0, 2, 3
    v_xor_b32 v29, v29, v1
    v_lshl_add_u32 v29, v29, 5, v28
    v_bfe_u32 v30, v0, 2, 2
    v_lshl_add_u32 v29, v30, 8, v29
    v_lshl_add_u32 v29, v15, 3, v29
    v_add_u32 v30, 65536, v29
    s_lshl_b32 s30, s41, 15
    s_and_b32 s42, s16, 3
    s_lshl_b32 s42, s42, 13
    s_add_u32 s30, s30, s42
    s_lshl_b32 s42, s40, 8
    s_add_u32 s30, s30, s42
    s_lshl_b32 s42, s17, 1
    s_lshr_b32 s43, s16, 2
    s_add_u32 s42, s42, s43
    s_lshl_b32 s42, s42, 4
    s_add_u32 s30, s30, s42
    s_add_u32 s30, s30, 6291456
    s_lshl_b32 s31, s41, 5
    s_lshr_b32 s42, s16, 1
    s_add_u32 s31, s31, s42
    s_lshl_b32 s31, s31, 10
    s_lshl_b32 s42, s40, 7
    s_add_u32 s31, s31, s42
    s_and_b32 s42, s16, 1
    s_lshl_b32 s42, s42, 6
    s_add_u32 s31, s31, s42
    s_add_u32 s31, s31, 6356992
    s_movk_i32 s33, 0xff
    s_cmp_eq_u32 s66, 1
    s_cbranch_scc1 x_start
    s_mul_i32 s70, s41, -4096
    s_add_u32 s70, s70, 8192
    s_add_u32 s70, s70, s18
    s_add_u32 s42, s17, 1
    s_and_b32 s42, s42, 7
    s_lshl_b32 s42, s42, 8
    s_add_u32 s70, s70, s42
    s_add_u32 s43, s68, 32768
    s_mov_b32 m0, s43
    s_add_u32 s42, s70, 0
    s_waitcnt vmcnt(5)
    buffer_load_dwordx4 v4, s[8:11], s42 offen  lds
    s_add_u32 s43, s68, 33792
    s_mov_b32 m0, s43
    s_add_u32 s42, s70, 49152
    s_waitcnt vmcnt(5)
    buffer_load_dwordx4 v4, s[8:11], s42 offen  lds
    s_add_u32 s43, s68, 34816
    s_mov_b32 m0, s43
    s_add_u32 s42, s70, 98304
    s_waitcnt vmcnt(5)
    buffer_load_dwordx4 v31, s[8:11], s42 offen  lds
    s_add_u32 s43, s68, 35840
    s_mov_b32 m0, s43
    s_add_u32 s42, s70, 147456
    s_waitcnt vmcnt(5)
    buffer_load_dwordx4 v31, s[8:11], s42 offen  lds
    s_waitcnt vmcnt(5)
    v_lshlrev_b32 v110, 16, v110
    v_mul_f32 v111, 0xbfb8aa3b, v110
    v_exp_f32 v111, v111
    s_nop 0
    v_add_f32 v111, 1.0, v111
    v_rcp_f32 v111, v111
    s_nop 0
    v_mul_f32 v110, v110, v111
    v_cvt_pk_bf16_f32 v110, v110, v110
    ds_write_b16 v109, v110
    s_waitcnt lgkmcnt(0)
    s_barrier
    ds_read_b128 v[128:131], v27 offset:0
    ds_read_b128 v[132:135], v27 offset:64
    ds_read_b128 v[136:139], v27 offset:128
    ds_read_b128 v[140:143], v27 offset:192
    ds_read_b64_tr_b16 v[144:145], v29 offset:0
    ds_read_b64_tr_b16 v[146:147], v29 offset:1024
    ds_read_b64_tr_b16 v[148:149], v29 offset:8192
    ds_read_b64_tr_b16 v[150:151], v29 offset:9216
    ds_read_b64_tr_b16 v[152:153], v29 offset:16384
    ds_read_b64_tr_b16 v[154:155], v29 offset:17408
    ds_read_b64_tr_b16 v[156:157], v29 offset:24576
    ds_read_b64_tr_b16 v[158:159], v29 offset:25600
    s_mul_i32 s32, s101, 0x9e3779b1
    s_or_b32 s32, s32, 0x101
    s_and_b32 s32, s32, 0xfffefbfb
    s_and_b32 s56, s32, 0xff
    s_bfe_u32 s57, s32, 0x80008
    s_bfe_u32 s58, s32, 0x80010
    s_lshr_b32 s59, s32, 24
    v_mov_b32 v164, s56
    v_mov_b32 v165, s57
    v_mov_b32 v166, s58
    v_mov_b32 v167, s59
    s_waitcnt lgkmcnt(6)
    v_mfma_f32_16x16x32_bf16 v[160:163], v[144:147], v[128:131], 0
    s_waitcnt lgkmcnt(4)
    v_mfma_f32_16x16x32_bf16 v[160:163], v[148:151], v[132:135], v[160:163]
    s_waitcnt lgkmcnt(2)
    v_mfma_f32_16x16x32_bf16 v[160:163], v[152:155], v[136:139], v[160:163]
    s_waitcnt lgkmcnt(0)
    v_mfma_f32_16x16x32_bf16 v[160:163], v[156:159], v[140:143], v[160:163]
    s_nop 7
    v_bfi_b32 v160, s33, v164, v160
    v_bfi_b32 v161, s33, v165, v161
    v_bfi_b32 v162, s33, v166, v162
    v_bfi_b32 v163, s33, v167, v163
    s_mov_b32 exec_lo, 0x00010001
    s_mov_b32 exec_hi, 0x00010001
    buffer_store_dwordx4 v[160:163], v28, s[12:15], s30 offen sc1
    s_mov_b64 exec, -1
    s_mul_i32 s70, s41, 4096
    s_add_u32 s70, s70, 6144
    s_add_u32 s70, s70, s18
    s_add_u32 s42, s17, 2
    s_and_b32 s42, s42, 7
    s_lshl_b32 s42, s42, 8
    s_add_u32 s70, s70, s42
    s_add_u32 s43, s68, 65536
    s_mov_b32 m0, s43
    s_add_u32 s42, s70, 0
    s_waitcnt vmcnt(4)
    buffer_load_dwordx4 v4, s[8:11], s42 offen  lds
    s_add_u32 s43, s68, 66560
    s_mov_b32 m0, s43
    s_add_u32 s42, s70, 49152
    s_waitcnt vmcnt(4)
    buffer_load_dwordx4 v4, s[8:11], s42 offen  lds
    s_add_u32 s43, s68, 67584
    s_mov_b32 m0, s43
    s_add_u32 s42, s70, 98304
    s_waitcnt vmcnt(4)
    buffer_load_dwordx4 v31, s[8:11], s42 offen  lds
    s_add_u32 s43, s68, 68608
    s_mov_b32 m0, s43
    s_add_u32 s42, s70, 147456
    s_waitcnt vmcnt(4)
    buffer_load_dwordx4 v31, s[8:11], s42 offen  lds
    s_waitcnt lgkmcnt(0)
    s_barrier
    ds_read_b64_tr_b16 v[144:145], v29 offset:32768
    ds_read_b64_tr_b16 v[146:147], v29 offset:33792
    ds_read_b64_tr_b16 v[148:149], v29 offset:40960
    ds_read_b64_tr_b16 v[150:151], v29 offset:41984
    ds_read_b64_tr_b16 v[152:153], v29 offset:49152
    ds_read_b64_tr_b16 v[154:155], v29 offset:50176
    ds_read_b64_tr_b16 v[156:157], v29 offset:57344
    ds_read_b64_tr_b16 v[158:159], v29 offset:58368
    s_waitcnt lgkmcnt(6)
    v_mfma_f32_16x16x32_bf16 v[160:163], v[144:147], v[128:131], 0
    s_waitcnt lgkmcnt(4)
    v_mfma_f32_16x16x32_bf16 v[160:163], v[148:151], v[132:135], v[160:163]
    s_waitcnt lgkmcnt(2)
    v_mfma_f32_16x16x32_bf16 v[160:163], v[152:155], v[136:139], v[160:163]
    s_waitcnt lgkmcnt(0)
    v_mfma_f32_16x16x32_bf16 v[160:163], v[156:159], v[140:143], v[160:163]
    s_add_u32 s42, s17, 1
    s_and_b32 s42, s42, 7
    s_lshl_b32 s42, s42, 12
    s_add_u32 s42, s42, s31
    s_add_u32 s42, s42, 0
    s_nop 2
    v_bfi_b32 v160, s33, v164, v160
    v_bfi_b32 v161, s33, v165, v161
    v_bfi_b32 v162, s33, v166, v162
    v_bfi_b32 v163, s33, v167, v163
    s_mov_b32 exec_lo, 0x00010001
    s_mov_b32 exec_hi, 0x00010001
    buffer_store_dwordx4 v[160:163], v26, s[12:15], s42 offen sc1
    s_mov_b64 exec, -1
    s_add_u32 s43, s68, 98304
    s_mov_b32 m0, s43
    s_add_u32 s42, s69, 0
    s_waitcnt vmcnt(4)
    buffer_load_dwordx4 v21, s[72:75], s42 offen  lds
    s_add_u32 s43, s68, 99328
    s_mov_b32 m0, s43
    s_add_u32 s42, s69, 2048
    s_waitcnt vmcnt(4)
    buffer_load_dwordx4 v22, s[72:75], s42 offen  lds
    s_add_u32 s43, s68, 100352
    s_mov_b32 m0, s43
    s_add_u32 s42, s69, 4096
    s_waitcnt vmcnt(4)
    buffer_load_dwordx4 v23, s[72:75], s42 offen  lds
    s_add_u32 s43, s68, 101376
    s_mov_b32 m0, s43
    s_add_u32 s42, s69, 6144
    s_waitcnt vmcnt(4)
    buffer_load_dwordx4 v24, s[72:75], s42 offen  lds
    s_waitcnt lgkmcnt(0)
    s_barrier
    ds_read_b64_tr_b16 v[144:145], v30 offset:0
    ds_read_b64_tr_b16 v[146:147], v30 offset:1024
    ds_read_b64_tr_b16 v[148:149], v30 offset:8192
    ds_read_b64_tr_b16 v[150:151], v30 offset:9216
    ds_read_b64_tr_b16 v[152:153], v30 offset:16384
    ds_read_b64_tr_b16 v[154:155], v30 offset:17408
    ds_read_b64_tr_b16 v[156:157], v30 offset:24576
    ds_read_b64_tr_b16 v[158:159], v30 offset:25600
    s_waitcnt lgkmcnt(6)
    v_mfma_f32_16x16x32_bf16 v[160:163], v[144:147], v[128:131], 0
    s_waitcnt lgkmcnt(4)
    v_mfma_f32_16x16x32_bf16 v[160:163], v[148:151], v[132:135], v[160:163]
    s_waitcnt lgkmcnt(2)
    v_mfma_f32_16x16x32_bf16 v[160:163], v[152:155], v[136:139], v[160:163]
    s_waitcnt lgkmcnt(0)
    v_mfma_f32_16x16x32_bf16 v[160:163], v[156:159], v[140:143], v[160:163]
    s_add_u32 s42, s17, 2
    s_and_b32 s42, s42, 7
    s_lshl_b32 s42, s42, 12
    s_add_u32 s42, s42, s31
    s_add_u32 s42, s42, 65536
    s_nop 2
    v_bfi_b32 v160, s33, v164, v160
    v_bfi_b32 v161, s33, v165, v161
    v_bfi_b32 v162, s33, v166, v162
    v_bfi_b32 v163, s33, v167, v163
    s_mov_b32 exec_lo, 0x00010001
    s_mov_b32 exec_hi, 0x00010001
    buffer_store_dwordx4 v[160:163], v26, s[12:15], s42 offen sc1
    s_mov_b64 exec, -1
    s_getreg_b32 s39, hwreg(HW_REG_XCC_ID)
    s_and_b32 s39, s39, 7
    s_lshl_b32 s38, s64, 1
    s_add_u32 s38, s38, s65
    s_lshl_b32 s38, s38, 7
    s_add_u32 s38, s38, 6537216
    s_lshl_b32 s42, s16, 28
    v_mov_b32 v28, s32
    v_mov_b32 v29, s39
    v_mov_b32 v30, s42
    s_mov_b64 exec, 1
    buffer_store_dwordx2 v[28:29], v30, s[12:15], s38 offen sc1
    s_mov_b64 exec, -1
    s_xor_b32 s38, s38, 128
    s_cmp_eq_u32 s65, s65
    s_cselect_b32 s8, s50, s52
    s_cselect_b32 s9, s51, s53
    s_mov_b32 s10, 7340032
    s_lshr_b32 s42, s8, 7
    s_sub_u32 s42, 3, s42
    s_add_u32 s42, s42, s34
    s_and_b32 s42, s42, 7
    s_cmp_eq_u32 s42, 7
    s_cselect_b32 s70, 0x1000000, 0
    s_mul_i32 s43, s34, 7
    s_add_u32 s42, s42, s43
    s_lshl_b32 s42, s42, 7
    s_lshr_b32 s43, s35, 1
    s_lshl_b32 s43, s43, 3
    s_add_u32 s43, s43, s16
    s_mul_i32 s43, s43, 35840
    s_add_u32 s42, s42, s43
    s_add_u32 s42, s42, s70
    s_mul_i32 s43, s65, 3670016
    s_add_u32 s42, s42, s43
    s_add_u32 s42, s42, 1662976
    v_mul_u32_u24 v30, 7168, v2
    s_mov_b64 exec, 31
    buffer_load_dword v252, v30, s[8:11], s42 offen
    s_mov_b64 exec, -1
    v_cmp_eq_u32 s[4:5], 1, v7
    v_cmp_eq_u32 s[6:7], 2, v7
    v_cmp_eq_u32 s[28:29], 3, v7
    v_and_b32 v191, 3, v0
    v_lshlrev_b32 v191, 3, v191
    v_lshrrev_b32 v191, v191, s32
    v_lshlrev_b32 v212, 5, v2
    s_lshl_b32 s36, s65, 11
    s_add_u32 s37, s36, 6496256
    s_add_u32 s36, s36, 6504448
    s_mov_b32 s18, 196611
    s_mov_b32 s19, 0x00020002
    v_and_b32 v208, 1, v0
    v_lshlrev_b32 v208, 3, v208
    s_not_b32 s42, s32
    v_lshrrev_b32 v208, v208, s42
    v_lshrrev_b32 v209, 2, v208
    v_lshrrev_b32 v210, 4, v208
    v_lshrrev_b32 v211, 6, v208
    v_and_b32 v208, s18, v208
    v_and_b32 v209, s18, v209
    v_and_b32 v210, s18, v210
    v_and_b32 v211, s18, v211
    v_mov_b32 v216, s56
    v_mov_b32 v217, s57
    v_mov_b32 v218, s58
    v_mov_b32 v219, s59
    v_add_u32 v13, 131584, v3
    s_lshl_b32 s71, s65, 10
    s_add_u32 s71, s71, 5242880
    s_lshl_b32 s30, s65, 17
    s_lshl_b32 s31, s64, 6
    s_add_u32 s30, s30, s31
    s_add_u32 s30, s30, 4194304
    s_add_u32 s31, s30, 262144
    s_lshl_b32 s79, s64, 2
    s_and_b32 s42, s16, 3
    s_add_u32 s79, s79, s42
    s_lshl_b32 s79, s79, 10
    s_add_u32 s81, s79, 4718592
    s_add_u32 s82, s79, 4980736
    s_lshl_b32 s76, s65, 1
    s_lshr_b32 s42, s16, 2
    s_add_u32 s76, s76, s42
    s_lshl_b32 s76, s76, 8
    s_add_u32 s77, s76, s82
    s_add_u32 s76, s76, s81
    s_lshl_b32 s78, s34, 12
    s_add_u32 s78, s78, 4947968
    s_add_u32 s43, s68, 0
    s_mov_b32 m0, s43
    s_add_u32 s42, s69, 65536
    buffer_load_dwordx4 v21, s[72:75], s42 offen  lds
    s_add_u32 s43, s68, 1024
    s_mov_b32 m0, s43
    s_add_u32 s42, s69, 67584
    buffer_load_dwordx4 v22, s[72:75], s42 offen  lds
    s_add_u32 s43, s68, 2048
    s_mov_b32 m0, s43
    s_add_u32 s42, s69, 69632
    s_waitcnt vmcnt(8)
    buffer_load_dwordx4 v23, s[72:75], s42 offen  lds
    s_add_u32 s43, s68, 3072
    s_mov_b32 m0, s43
    s_add_u32 s42, s69, 71680
    s_waitcnt vmcnt(8)
    buffer_load_dwordx4 v24, s[72:75], s42 offen  lds
    s_add_u32 s43, s68, 32768
    s_mov_b32 m0, s43
    s_add_u32 s42, s67, 0
    s_waitcnt vmcnt(8)
    buffer_load_dwordx4 v5, s[44:47], s42 offen  lds
    s_add_u32 s43, s68, 33792
    s_mov_b32 m0, s43
    s_add_u32 s42, s67, 114688
    s_waitcnt vmcnt(8)
    buffer_load_dwordx4 v5, s[44:47], s42 offen  lds
    s_waitcnt lgkmcnt(0)
    s_barrier
    v_add_u32 v168, 65536, v8
    v_add_u32 v169, 65536, v9
    v_add_u32 v170, 65536, v10
    v_add_u32 v171, 65536, v11
    ds_read_b64_tr_b16 v[32:33], v168 offset:32768
    ds_read_b64_tr_b16 v[34:35], v168 offset:49152
    ds_read_b64_tr_b16 v[36:37], v169 offset:32768
    ds_read_b64_tr_b16 v[38:39], v169 offset:49152
    ds_read_b64_tr_b16 v[40:41], v170 offset:32768
    ds_read_b64_tr_b16 v[42:43], v170 offset:49152
    ds_read_b64_tr_b16 v[44:45], v171 offset:32768
    ds_read_b64_tr_b16 v[46:47], v171 offset:49152
    s_add_u32 s43, s68, 34816
    s_mov_b32 m0, s43
    s_add_u32 s42, s67, 28672
    s_waitcnt vmcnt(5)
    buffer_load_dwordx4 v5, s[44:47], s42 offen  lds
    s_add_u32 s43, s68, 35840
    s_mov_b32 m0, s43
    s_add_u32 s42, s67, 143360
    s_waitcnt vmcnt(5)
    buffer_load_dwordx4 v5, s[44:47], s42 offen  lds
    s_add_u32 s43, s68, 65536
    s_mov_b32 m0, s43
    s_add_u32 s42, s67, 1835008
    s_waitcnt vmcnt(5)
    buffer_load_dwordx4 v5, s[44:47], s42 offen  lds
    s_add_u32 s43, s68, 66560
    s_mov_b32 m0, s43
    s_add_u32 s42, s67, 1949696
    s_waitcnt vmcnt(5)
    buffer_load_dwordx4 v5, s[44:47], s42 offen  lds
    s_waitcnt lgkmcnt(0)
    s_barrier
    ds_read_b64_tr_b16 v[48:49], v8 offset:0
    ds_read_b64_tr_b16 v[50:51], v8 offset:16384
    ds_read_b64_tr_b16 v[52:53], v9 offset:0
    ds_read_b64_tr_b16 v[54:55], v9 offset:16384
    ds_read_b64_tr_b16 v[56:57], v10 offset:0
    ds_read_b64_tr_b16 v[58:59], v10 offset:16384
    ds_read_b64_tr_b16 v[60:61], v11 offset:0
    ds_read_b64_tr_b16 v[62:63], v11 offset:16384
    s_add_u32 s43, s68, 67584
    s_mov_b32 m0, s43
    s_add_u32 s42, s67, 1863680
    s_waitcnt vmcnt(5)
    buffer_load_dwordx4 v5, s[44:47], s42 offen  lds
    s_add_u32 s43, s68, 68608
    s_mov_b32 m0, s43
    s_add_u32 s42, s67, 1978368
    s_waitcnt vmcnt(5)
    buffer_load_dwordx4 v5, s[44:47], s42 offen  lds
    s_add_u32 s43, s68, 98304
    s_mov_b32 m0, s43
    s_add_u32 s42, s67, 0
    s_waitcnt vmcnt(5)
    buffer_load_dwordx4 v5, s[60:63], s42 offen  lds
    s_add_u32 s43, s68, 99328
    s_mov_b32 m0, s43
    s_add_u32 s42, s67, 114688
    s_waitcnt vmcnt(5)
    buffer_load_dwordx4 v5, s[60:63], s42 offen  lds
    s_waitcnt lgkmcnt(0)
    s_barrier
    ds_read_b64_tr_b16 v[64:65], v12 offset:32768
    ds_read_b64_tr_b16 v[66:67], v12 offset:34816
    ds_read_b64_tr_b16 v[68:69], v12 offset:36864
    ds_read_b64_tr_b16 v[70:71], v12 offset:38912
    ds_read_b64_tr_b16 v[72:73], v12 offset:40960
    ds_read_b64_tr_b16 v[74:75], v12 offset:43008
    ds_read_b64_tr_b16 v[76:77], v12 offset:45056
    ds_read_b64_tr_b16 v[78:79], v12 offset:47104
    s_add_u32 s43, s68, 100352
    s_mov_b32 m0, s43
    s_add_u32 s42, s67, 28672
    s_waitcnt vmcnt(5)
    buffer_load_dwordx4 v5, s[60:63], s42 offen  lds
    s_add_u32 s43, s68, 101376
    s_mov_b32 m0, s43
    s_add_u32 s42, s67, 143360
    s_waitcnt vmcnt(5)
    buffer_load_dwordx4 v5, s[60:63], s42 offen  lds
    v_lshlrev_b32 v30, 6, v2
    s_cmp_eq_u32 s16, 0
    s_cselect_b64 exec, -1, 0
    buffer_load_dword v31, v30, s[12:15], s81 offen sc1
    buffer_load_dwordx2 v[188:189], v14, s[12:15], s38 offen sc1
    buffer_load_dwordx4 v[192:195], v212, s[12:15], s36 offen offset:0
    buffer_load_dwordx4 v[196:199], v212, s[12:15], s36 offen offset:16
    buffer_load_dwordx4 v[200:203], v212, s[12:15], s37 offen offset:0
    buffer_load_dwordx4 v[204:207], v212, s[12:15], s37 offen offset:16
    s_mov_b64 exec, -1
    s_add_u32 s43, s68, 0
    s_mov_b32 m0, s43
    s_add_u32 s42, s67, 1835008
    s_waitcnt vmcnt(11)
    buffer_load_dwordx4 v5, s[60:63], s42 offen  lds
    s_add_u32 s43, s68, 1024
    s_mov_b32 m0, s43
    s_add_u32 s42, s67, 1949696
    s_waitcnt vmcnt(11)
    buffer_load_dwordx4 v5, s[60:63], s42 offen  lds
    s_waitcnt lgkmcnt(0)
    s_barrier
    ds_read_b64_tr_b16 v[80:81], v25 offset:0
    ds_read_b64_tr_b16 v[82:83], v25 offset:2048
    ds_read_b64_tr_b16 v[84:85], v25 offset:4096
    ds_read_b64_tr_b16 v[86:87], v25 offset:6144
    ds_read_b64_tr_b16 v[88:89], v25 offset:8192
    ds_read_b64_tr_b16 v[90:91], v25 offset:10240
    ds_read_b64_tr_b16 v[92:93], v25 offset:12288
    ds_read_b64_tr_b16 v[94:95], v25 offset:14336
    s_cmp_eq_u32 s16, 0
    s_cselect_b64 exec, -1, 0
    buffer_load_dword v15, v14, s[12:15], s78 offen offset:2048 sc1
    s_mov_b64 exec, -1
    s_add_u32 s43, s68, 2048
    s_mov_b32 m0, s43
    s_add_u32 s42, s67, 1863680
    s_waitcnt vmcnt(12)
    buffer_load_dwordx4 v5, s[60:63], s42 offen  lds
    s_add_u32 s43, s68, 3072
    s_mov_b32 m0, s43
    s_add_u32 s42, s67, 1978368
    s_waitcnt vmcnt(12)
    buffer_load_dwordx4 v5, s[60:63], s42 offen  lds
    s_waitcnt vmcnt(11)
    s_waitcnt lgkmcnt(0)
    s_barrier
    ds_read_b64_tr_b16 v[96:97], v25 offset:32768
    ds_read_b64_tr_b16 v[98:99], v25 offset:34816
    ds_read_b64_tr_b16 v[100:101], v25 offset:36864
    ds_read_b64_tr_b16 v[102:103], v25 offset:38912
    ds_read_b64_tr_b16 v[104:105], v25 offset:40960
    ds_read_b64_tr_b16 v[106:107], v25 offset:43008
    ds_read_b64_tr_b16 v[108:109], v25 offset:45056
    ds_read_b64_tr_b16 v[110:111], v25 offset:47104
    v_mov_b32 v190, 134656
    s_cmp_lg_u32 s16, 0
    s_cbranch_scc1 m_nk
    s_mov_b32 s83, 0
    s_waitcnt vmcnt(5)
    v_xor_b32 v188, s32, v188
    v_xor_b32 v189, s39, v189
    v_or_b32 v188, v188, v189
    ds_write_b32 v190, v188
m_pm:
    v_xor_b32 v192, s56, v192
    v_xor_b32 v193, s57, v193
    v_xor_b32 v194, s58, v194
    v_xor_b32 v195, s59, v195
    v_xor_b32 v196, s56, v196
    v_xor_b32 v197, s57, v197
    v_xor_b32 v198, s58, v198
    v_xor_b32 v199, s59, v199
    v_xor_b32 v200, s56, v200
    v_xor_b32 v201, s57, v201
    v_xor_b32 v202, s58, v202
    v_xor_b32 v203, s59, v203
    v_xor_b32 v204, s56, v204
    v_xor_b32 v205, s57, v205
    v_xor_b32 v206, s58, v206
    v_xor_b32 v207, s59, v207
    v_or3_b32 v30, v192, v193, v194
    v_or3_b32 v30, v30, v195, v196
    v_or3_b32 v30, v30, v197, v198
    v_or3_b32 v30, v30, v199, v200
    v_or3_b32 v30, v30, v201, v202
    v_or3_b32 v30, v30, v203, v204
    v_or3_b32 v30, v30, v205, v206
    v_or_b32 v30, v30, v207
    v_and_b32 v30, 0xff, v30
    v_cmp_ne_u32 vcc, 0, v30
    s_cbranch_vccz m_pmx
    s_sleep 4
    buffer_load_dwordx4 v[192:195], v212, s[12:15], s36 offen offset:0 sc1
    buffer_load_dwordx4 v[196:199], v212, s[12:15], s36 offen offset:16 sc1
    buffer_load_dwordx4 v[200:203], v212, s[12:15], s37 offen offset:0 sc1
    buffer_load_dwordx4 v[204:207], v212, s[12:15], s37 offen offset:16 sc1
    s_waitcnt vmcnt(0)
    s_add_u32 s83, s83, 1
    s_cmp_lt_u32 s83, 0x40000
    s_cbranch_scc1 m_pm
m_pmx:
    s_mov_b32 s83, 0
    s_waitcnt vmcnt(2)
m_go:
    v_cmp_ne_u32 vcc, s32, v15
    s_cbranch_vccz m_gox
    s_sleep 3
    buffer_load_dword v15, v14, s[12:15], s78 offen offset:2048 sc1
    s_waitcnt vmcnt(0)
    s_add_u32 s83, s83, 1
    s_cmp_lt_u32 s83, 0x40000
    s_cbranch_scc1 m_go
m_gox:
    s_mov_b32 s83, 0
    buffer_load_dwordx4 v[136:139], v3, s[12:15], s78 offen offset:0 sc1
    buffer_load_dwordx4 v[140:143], v3, s[12:15], s78 offen offset:1024 sc1
    s_sleep 4
m_pk:
    buffer_load_dwordx4 v[144:147], v3, s[12:15], s78 offen offset:0 sc1
    buffer_load_dwordx4 v[148:151], v3, s[12:15], s78 offen offset:1024 sc1
    s_add_u32 s83, s83, 1
    s_cmp_lt_u32 s83, 0x40000
    s_cselect_b64 s[20:21], -1, 0
    s_waitcnt vmcnt(2)
    v_max_u32 v28, v136, v140
    v_xor_b32 v31, s32, v138
    v_bitop3_b32 v31, v31, v142, s32 bitop3:0xf6
    v_max_u32_dpp v30, v28, v28 row_ror:8 row_mask:0xf bank_mask:0xf
    v_cmp_ne_u32 vcc, 0, v31
    v_min_u32 v29, v136, v140
    v_max_u32_dpp v30, v30, v30 row_ror:4 row_mask:0xf bank_mask:0xf
    v_max3_u32 v29, v29, v137, v141
    s_and_b64 vcc, vcc, s[20:21]
    v_max_u32_dpp v30, v30, v30 row_ror:2 row_mask:0xf bank_mask:0xf
    s_cbranch_scc0 m_pkx
    buffer_load_dwordx4 v[136:139], v3, s[12:15], s78 offen offset:0 sc1
    buffer_load_dwordx4 v[140:143], v3, s[12:15], s78 offen offset:1024 sc1
    s_waitcnt vmcnt(2)
    v_max_u32 v28, v144, v148
    v_xor_b32 v31, s32, v146
    v_bitop3_b32 v31, v31, v150, s32 bitop3:0xf6
    v_max_u32_dpp v30, v28, v28 row_ror:8 row_mask:0xf bank_mask:0xf
    v_cmp_ne_u32 vcc, 0, v31
    v_min_u32 v29, v144, v148
    v_max_u32_dpp v30, v30, v30 row_ror:4 row_mask:0xf bank_mask:0xf
    v_max3_u32 v29, v29, v145, v149
    s_and_b64 vcc, vcc, s[20:21]
    v_max_u32_dpp v30, v30, v30 row_ror:2 row_mask:0xf bank_mask:0xf
    s_cbranch_scc0 m_pkx
    s_branch m_pk
m_pkx:
    s_nop 0
    v_max_u32_dpp v30, v30, v30 row_ror:1 row_mask:0xf bank_mask:0xf
    s_nop 1
    v_max_u32_dpp v30, v30, v30 row_bcast:15 row_mask:0xa bank_mask:0xf
    s_nop 1
    v_max_u32_dpp v30, v30, v30 row_bcast:31 row_mask:0xc bank_mask:0xf
    s_nop 0
    v_readlane_b32 s40, v30, 63
    s_and_b32 s42, s40, 0xff
    s_lshl_b32 s42, s42, 11
    v_cmp_eq_u32 vcc, s40, v28
    s_add_u32 s42, s42, s71
    buffer_load_dwordx4 v[176:179], v3, s[12:15], s42 offen sc1
    v_cndmask_b32 v30, v28, v29, vcc
    s_nop 1
    v_max_u32_dpp v30, v30, v30 row_ror:8 row_mask:0xf bank_mask:0xf
    s_nop 1
    v_max_u32_dpp v30, v30, v30 row_ror:4 row_mask:0xf bank_mask:0xf
    s_nop 1
    v_max_u32_dpp v30, v30, v30 row_ror:2 row_mask:0xf bank_mask:0xf
    s_nop 1
    v_max_u32_dpp v30, v30, v30 row_ror:1 row_mask:0xf bank_mask:0xf
    s_nop 1
    v_max_u32_dpp v30, v30, v30 row_bcast:15 row_mask:0xa bank_mask:0xf
    s_nop 1
    v_max_u32_dpp v30, v30, v30 row_bcast:31 row_mask:0xc bank_mask:0xf
    s_nop 0
    v_readlane_b32 s41, v30, 63
    s_and_b32 s41, s41, 0xff
    s_lshl_b32 s43, s41, 11
    s_add_u32 s43, s43, s71
    buffer_load_dwordx4 v[180:183], v3, s[12:15], s43 offen sc1
    s_and_b32 s40, s40, 0xff
    s_mov_b32 s83, 0
    s_lshl_b32 s41, s41, 8
    s_or_b32 s40, s40, s41
    v_mov_b32 v28, s40
    v_mov_b32 v29, s32
    s_cmp_eq_u32 s35, 0
    s_cselect_b64 exec, 1, 0
    buffer_store_dwordx2 v[28:29], v14, s[12:15], s78 offen offset:2304 sc1
    s_mov_b64 exec, -1
    s_barrier
    ds_read_b64_tr_b16 v[112:113], v12 offset:0
    ds_read_b64_tr_b16 v[114:115], v12 offset:2048
    ds_read_b64_tr_b16 v[116:117], v12 offset:4096
    ds_read_b64_tr_b16 v[118:119], v12 offset:6144
    ds_read_b64_tr_b16 v[120:121], v12 offset:8192
    ds_read_b64_tr_b16 v[122:123], v12 offset:10240
    ds_read_b64_tr_b16 v[124:125], v12 offset:12288
    ds_read_b64_tr_b16 v[126:127], v12 offset:14336
m_ph:
    s_waitcnt vmcnt(2)
    v_xor_b32 v176, v176, v208
    v_xor_b32 v177, v177, v209
    v_xor_b32 v178, v178, v210
    v_xor_b32 v179, v179, v211
    v_fma_mix_f32 v220, v176, v192, v200 op_sel:[0,0,0] op_sel_hi:[1,0,0]
    v_fma_mix_f32 v221, v176, v193, v201 op_sel:[1,0,0] op_sel_hi:[1,0,0]
    v_fma_mix_f32 v222, v177, v194, v202 op_sel:[0,0,0] op_sel_hi:[1,0,0]
    v_fma_mix_f32 v223, v177, v195, v203 op_sel:[1,0,0] op_sel_hi:[1,0,0]
    v_fma_mix_f32 v224, v178, v196, v204 op_sel:[0,0,0] op_sel_hi:[1,0,0]
    v_fma_mix_f32 v225, v178, v197, v205 op_sel:[1,0,0] op_sel_hi:[1,0,0]
    v_fma_mix_f32 v226, v179, v198, v206 op_sel:[0,0,0] op_sel_hi:[1,0,0]
    v_fma_mix_f32 v227, v179, v199, v207 op_sel:[1,0,0] op_sel_hi:[1,0,0]
    v_cvt_pk_bf16_f32 v236, v220, v221
    v_cvt_pk_bf16_f32 v237, v222, v223
    v_cvt_pk_bf16_f32 v238, v224, v225
    v_cvt_pk_bf16_f32 v239, v226, v227
    ds_write_b128 v13, v[236:239] offset:0
    v_xor_b32 v30, s19, v176
    v_bitop3_b32 v30, v30, v177, s19 bitop3:0xf6
    v_bitop3_b32 v30, v30, v178, s19 bitop3:0xf6
    v_bitop3_b32 v30, v30, v179, s19 bitop3:0xf6
    s_waitcnt vmcnt(1)
    v_xor_b32 v180, v180, v208
    v_xor_b32 v181, v181, v209
    v_xor_b32 v182, v182, v210
    v_xor_b32 v183, v183, v211
    v_fma_mix_f32 v228, v180, v192, v200 op_sel:[0,0,0] op_sel_hi:[1,0,0]
    v_fma_mix_f32 v229, v180, v193, v201 op_sel:[1,0,0] op_sel_hi:[1,0,0]
    v_fma_mix_f32 v230, v181, v194, v202 op_sel:[0,0,0] op_sel_hi:[1,0,0]
    v_fma_mix_f32 v231, v181, v195, v203 op_sel:[1,0,0] op_sel_hi:[1,0,0]
    v_fma_mix_f32 v232, v182, v196, v204 op_sel:[0,0,0] op_sel_hi:[1,0,0]
    v_fma_mix_f32 v233, v182, v197, v205 op_sel:[1,0,0] op_sel_hi:[1,0,0]
    v_fma_mix_f32 v234, v183, v198, v206 op_sel:[0,0,0] op_sel_hi:[1,0,0]
    v_fma_mix_f32 v235, v183, v199, v207 op_sel:[1,0,0] op_sel_hi:[1,0,0]
    v_cvt_pk_bf16_f32 v240, v228, v229
    v_cvt_pk_bf16_f32 v241, v230, v231
    v_cvt_pk_bf16_f32 v242, v232, v233
    v_cvt_pk_bf16_f32 v243, v234, v235
    ds_write_b128 v13, v[240:243] offset:1024
    v_bitop3_b32 v30, v30, v180, s19 bitop3:0xf6
    v_bitop3_b32 v30, v30, v181, s19 bitop3:0xf6
    v_bitop3_b32 v30, v30, v182, s19 bitop3:0xf6
    v_bitop3_b32 v30, v30, v183, s19 bitop3:0xf6
    v_and_b32 v30, s18, v30
    v_cmp_ne_u32 vcc, 0, v30
    s_cbranch_vccnz m_phb
m_phx:
m_nk2:
    s_waitcnt lgkmcnt(0)
    s_barrier
    ds_read_b32 v188, v190
    ds_read_b128 v[128:131], v17 offset:0
    ds_read_b128 v[132:135], v17 offset:64
    ds_read_b128 v[136:139], v17 offset:128
    ds_read_b128 v[140:143], v17 offset:192
    ds_read_b128 v[144:147], v17 offset:512
    ds_read_b128 v[148:151], v17 offset:576
    ds_read_b128 v[152:155], v17 offset:640
    ds_read_b128 v[156:159], v17 offset:704
    s_waitcnt lgkmcnt(7)
    v_mfma_f32_16x16x32_bf16 v[160:163], v[128:131], v[64:67], 0
    v_mfma_f32_16x16x32_bf16 v[164:167], v[128:131], v[96:99], 0
    s_waitcnt lgkmcnt(6)
    v_mfma_f32_16x16x32_bf16 v[160:163], v[132:135], v[68:71], v[160:163]
    v_mfma_f32_16x16x32_bf16 v[164:167], v[132:135], v[100:103], v[164:167]
    s_waitcnt lgkmcnt(5)
    v_mfma_f32_16x16x32_bf16 v[160:163], v[136:139], v[72:75], v[160:163]
    v_mfma_f32_16x16x32_bf16 v[164:167], v[136:139], v[104:107], v[164:167]
    s_waitcnt lgkmcnt(4)
    v_mfma_f32_16x16x32_bf16 v[160:163], v[140:143], v[76:79], v[160:163]
    v_mfma_f32_16x16x32_bf16 v[164:167], v[140:143], v[108:111], v[164:167]
    s_waitcnt lgkmcnt(3)
    v_mfma_f32_16x16x32_bf16 v[160:163], v[144:147], v[80:83], v[160:163]
    v_mfma_f32_16x16x32_bf16 v[164:167], v[144:147], v[112:115], v[164:167]
    s_waitcnt lgkmcnt(2)
    v_mfma_f32_16x16x32_bf16 v[160:163], v[148:151], v[84:87], v[160:163]
    v_mfma_f32_16x16x32_bf16 v[164:167], v[148:151], v[116:119], v[164:167]
    s_waitcnt lgkmcnt(1)
    v_mfma_f32_16x16x32_bf16 v[160:163], v[152:155], v[88:91], v[160:163]
    v_mfma_f32_16x16x32_bf16 v[164:167], v[152:155], v[120:123], v[164:167]
    s_waitcnt lgkmcnt(0)
    v_mfma_f32_16x16x32_bf16 v[160:163], v[156:159], v[92:95], v[160:163]
    v_mfma_f32_16x16x32_bf16 v[164:167], v[156:159], v[124:127], v[164:167]
    v_readfirstlane_b32 s70, v188
    s_mov_b32 s83, 0
    s_cmp_eq_u32 s70, 0
    s_cselect_b32 s82, s81, s82
    s_cselect_b64 s[20:21], 0, 0xffff
    s_nop 1
    v_bfi_b32 v184, s33, v216, v160
    v_bfi_b32 v185, s33, v217, v161
    v_bfi_b32 v186, s33, v218, v164
    v_bfi_b32 v187, s33, v219, v165
    s_mov_b64 exec, 0xffff
    buffer_store_dwordx4 v[184:187], v3, s[12:15], s76 offen
    s_mov_b64 exec, s[20:21]
    buffer_store_dwordx4 v[184:187], v3, s[12:15], s77 offen sc1
    s_mov_b64 exec, -1
    s_cmp_ge_u32 s16, 4
    s_cbranch_scc1 m_na
    s_sleep 2
m_px:
    buffer_load_dwordx4 v[24:27], v3, s[12:15], s81 offen sc1
    s_mov_b32 s42, s81
    s_mov_b32 s81, s82
    s_mov_b32 s82, s42
    s_add_u32 s83, s83, 1
    s_cmp_lt_u32 s83, 0x40000
    s_cselect_b64 s[20:21], -1, 0
    s_waitcnt vmcnt(0)
    v_xor_b32 v24, s56, v24
    v_xor_b32 v25, s57, v25
    v_xor_b32 v26, s58, v26
    v_xor_b32 v27, s59, v27
    v_or3_b32 v9, v24, v25, v26
    v_bitop3_b32 v9, v9, v27, s33 bitop3:0xa8
    v_permlane32_swap_b32 v24, v26
    v_cmp_ne_u32 vcc, 0, v9
    v_permlane32_swap_b32 v25, v27
    s_and_b64 vcc, vcc, s[20:21]
    v_pk_add_f32 v[24:25], v[24:25], v[26:27]
    s_cbranch_scc1 m_px
    s_nop 0
    v_permlane16_swap_b32 v24, v25
    v_add_f32 v24, v24, v25
    v_cvt_pk_bf16_f32 v24, v24, v24
    v_lshlrev_b32 v24, 16, v24
    v_mul_f32 v25, 0xbfb8aa3b, v24
    v_exp_f32 v25, v25
    v_mov_b32 v26, v24
    v_add_f32 v25, 1.0, v25
    v_rcp_f32 v25, v25
    v_mov_b32 v27, v24
    v_mul_f32 v25, v24, v25
    s_nop 0
    v_permlane32_swap_b32 v26, v27
    v_cvt_pk_bf16_f32 v25, v25, v25
    v_lshlrev_b32 v25, 16, v25
    v_mul_f32 v25, v25, v27
    v_cvt_pk_bf16_f32 v25, v25, v25
    ds_write_b16 v18, v25
m_na:
    s_waitcnt lgkmcnt(0)
    s_barrier
    ds_read_b128 v[128:131], v19 offset:0
    ds_read_b128 v[132:135], v19 offset:64
    s_waitcnt lgkmcnt(1)
    v_mfma_f32_16x16x32_bf16 v[160:163], v[128:131], v[32:35], 0
    v_mfma_f32_16x16x32_bf16 v[164:167], v[128:131], v[36:39], 0
    v_mfma_f32_16x16x32_bf16 v[168:171], v[128:131], v[40:43], 0
    v_mfma_f32_16x16x32_bf16 v[172:175], v[128:131], v[44:47], 0
    s_waitcnt lgkmcnt(0)
    v_mfma_f32_16x16x32_bf16 v[160:163], v[132:135], v[48:51], v[160:163]
    v_mfma_f32_16x16x32_bf16 v[164:167], v[132:135], v[52:55], v[164:167]
    v_mfma_f32_16x16x32_bf16 v[168:171], v[132:135], v[56:59], v[168:171]
    v_mfma_f32_16x16x32_bf16 v[172:175], v[132:135], v[60:63], v[172:175]
    s_nop 5
    v_cndmask_b32 v24, v160, v164, s[4:5]
    v_cndmask_b32 v25, v161, v165, s[4:5]
    v_cndmask_b32 v24, v24, v168, s[6:7]
    v_cndmask_b32 v25, v25, v169, s[6:7]
    v_cndmask_b32 v24, v24, v172, s[28:29]
    v_cndmask_b32 v25, v25, v173, s[28:29]
    v_bfi_b32 v24, s33, v191, v24
    v_bfi_b32 v25, s33, v191, v25
    buffer_store_dword v24, v20, s[12:15], s30 offen sc1
    buffer_store_dword v25, v20, s[12:15], s31 offen sc1
    s_endpgm
m_nk:
    s_waitcnt vmcnt(0)
    s_barrier
    ds_read_b64_tr_b16 v[112:113], v12 offset:0
    ds_read_b64_tr_b16 v[114:115], v12 offset:2048
    ds_read_b64_tr_b16 v[116:117], v12 offset:4096
    ds_read_b64_tr_b16 v[118:119], v12 offset:6144
    ds_read_b64_tr_b16 v[120:121], v12 offset:8192
    ds_read_b64_tr_b16 v[122:123], v12 offset:10240
    ds_read_b64_tr_b16 v[124:125], v12 offset:12288
    ds_read_b64_tr_b16 v[126:127], v12 offset:14336
    s_branch m_nk2
m_phb:
    s_add_u32 s83, s83, 1
    s_cmp_ge_u32 s83, 0x40000
    s_cbranch_scc1 m_phx
    buffer_load_dwordx4 v[176:179], v3, s[12:15], s42 offen sc1
    buffer_load_dwordx4 v[180:183], v3, s[12:15], s43 offen sc1
    s_waitcnt vmcnt(0)
    s_branch m_ph
x_start:
    s_lshl_b32 s37, s34, 1
    s_add_u32 s37, s37, s65
    s_lshl_b32 s37, s37, 3
    s_add_u32 s37, s37, s16
    s_lshl_b32 s42, s37, 8
    s_add_u32 s42, s42, 4947968
    s_mov_b64 exec, 0xffff
    buffer_store_dwordx4 v[104:107], v3, s[12:15], s42 offen sc1
    s_mov_b64 exec, -1
    s_lshl_b32 s36, s37, 12
    s_add_u32 s36, s36, 4194304
    s_lshl_b32 s76, s34, 3
    s_add_u32 s76, s76, s16
    s_lshl_b32 s77, s76, 10
    s_add_u32 s77, s77, 6356992
    s_lshl_b32 s79, s76, 7
    s_add_u32 s79, s79, 6488064
    s_lshr_b32 s71, s76, 5
    s_cmp_eq_u32 s71, 0
    s_cselect_b32 s80, 1.0, 0
    s_lshl_b32 s78, s34, 12
    s_add_u32 s78, s78, 4947968
    s_mov_b32 s72, s48
    s_mov_b32 s73, s49
    s_mov_b32 s74, 2048
    s_mov_b32 s75, 0x00020000
    v_and_b32 v10, 7, v0
    v_lshl_add_u32 v10, v10, 2, v7
    v_lshlrev_b32 v10, 1, v10
    s_lshl_b32 s42, s76, 6
    buffer_load_ushort v10, v10, s[72:75], s42 offen
    s_mul_i32 s70, s41, -4096
    s_add_u32 s70, s70, 8192
    s_add_u32 s70, s70, s18
    s_add_u32 s42, s17, 1
    s_and_b32 s42, s42, 7
    s_lshl_b32 s42, s42, 8
    s_add_u32 s70, s70, s42
    s_add_u32 s43, s68, 32768
    s_mov_b32 m0, s43
    s_add_u32 s42, s70, 0
    s_waitcnt vmcnt(7)
    buffer_load_dwordx4 v4, s[8:11], s42 offen  lds
    s_add_u32 s43, s68, 33792
    s_mov_b32 m0, s43
    s_add_u32 s42, s70, 49152
    s_waitcnt vmcnt(7)
    buffer_load_dwordx4 v4, s[8:11], s42 offen  lds
    s_add_u32 s43, s68, 34816
    s_mov_b32 m0, s43
    s_add_u32 s42, s70, 98304
    s_waitcnt vmcnt(7)
    buffer_load_dwordx4 v31, s[8:11], s42 offen  lds
    s_add_u32 s43, s68, 35840
    s_mov_b32 m0, s43
    s_add_u32 s42, s70, 147456
    s_waitcnt vmcnt(7)
    buffer_load_dwordx4 v31, s[8:11], s42 offen  lds
    s_waitcnt vmcnt(7)
    v_lshlrev_b32 v110, 16, v110
    v_mul_f32 v111, 0xbfb8aa3b, v110
    v_exp_f32 v111, v111
    s_nop 0
    v_add_f32 v111, 1.0, v111
    v_rcp_f32 v111, v111
    s_nop 0
    v_mul_f32 v110, v110, v111
    v_cvt_pk_bf16_f32 v110, v110, v110
    ds_write_b16 v109, v110
    s_waitcnt lgkmcnt(0)
    s_barrier
    ds_read_b128 v[128:131], v27 offset:0
    ds_read_b128 v[132:135], v27 offset:64
    ds_read_b128 v[136:139], v27 offset:128
    ds_read_b128 v[140:143], v27 offset:192
    ds_read_b64_tr_b16 v[144:145], v29 offset:0
    ds_read_b64_tr_b16 v[146:147], v29 offset:1024
    ds_read_b64_tr_b16 v[148:149], v29 offset:8192
    ds_read_b64_tr_b16 v[150:151], v29 offset:9216
    ds_read_b64_tr_b16 v[152:153], v29 offset:16384
    ds_read_b64_tr_b16 v[154:155], v29 offset:17408
    ds_read_b64_tr_b16 v[156:157], v29 offset:24576
    ds_read_b64_tr_b16 v[158:159], v29 offset:25600
    s_mul_i32 s32, s101, 0x9e3779b1
    s_or_b32 s32, s32, 0x101
    s_and_b32 s32, s32, 0xfffefbfb
    s_and_b32 s56, s32, 0xff
    s_bfe_u32 s57, s32, 0x80008
    s_bfe_u32 s58, s32, 0x80010
    s_lshr_b32 s59, s32, 24
    v_mov_b32 v164, s56
    v_mov_b32 v165, s57
    v_mov_b32 v166, s58
    v_mov_b32 v167, s59
    s_waitcnt lgkmcnt(6)
    v_mfma_f32_16x16x32_bf16 v[160:163], v[144:147], v[128:131], 0
    s_waitcnt lgkmcnt(4)
    v_mfma_f32_16x16x32_bf16 v[160:163], v[148:151], v[132:135], v[160:163]
    s_waitcnt lgkmcnt(2)
    v_mfma_f32_16x16x32_bf16 v[160:163], v[152:155], v[136:139], v[160:163]
    s_waitcnt lgkmcnt(0)
    v_mfma_f32_16x16x32_bf16 v[160:163], v[156:159], v[140:143], v[160:163]
    s_nop 7
    v_bfi_b32 v160, s33, v164, v160
    v_bfi_b32 v161, s33, v165, v161
    v_bfi_b32 v162, s33, v166, v162
    v_bfi_b32 v163, s33, v167, v163
    s_mov_b32 exec_lo, 0x00010001
    s_mov_b32 exec_hi, 0x00010001
    buffer_store_dwordx4 v[160:163], v28, s[12:15], s30 offen sc1
    s_mov_b64 exec, -1
    s_mul_i32 s70, s41, 4096
    s_add_u32 s70, s70, 6144
    s_add_u32 s70, s70, s18
    s_add_u32 s42, s17, 2
    s_and_b32 s42, s42, 7
    s_lshl_b32 s42, s42, 8
    s_add_u32 s70, s70, s42
    s_add_u32 s43, s68, 65536
    s_mov_b32 m0, s43
    s_add_u32 s42, s70, 0
    s_waitcnt vmcnt(4)
    buffer_load_dwordx4 v4, s[8:11], s42 offen  lds
    s_add_u32 s43, s68, 66560
    s_mov_b32 m0, s43
    s_add_u32 s42, s70, 49152
    s_waitcnt vmcnt(4)
    buffer_load_dwordx4 v4, s[8:11], s42 offen  lds
    s_add_u32 s43, s68, 67584
    s_mov_b32 m0, s43
    s_add_u32 s42, s70, 98304
    s_waitcnt vmcnt(4)
    buffer_load_dwordx4 v31, s[8:11], s42 offen  lds
    s_add_u32 s43, s68, 68608
    s_mov_b32 m0, s43
    s_add_u32 s42, s70, 147456
    s_waitcnt vmcnt(4)
    buffer_load_dwordx4 v31, s[8:11], s42 offen  lds
    s_waitcnt lgkmcnt(0)
    s_barrier
    ds_read_b64_tr_b16 v[144:145], v29 offset:32768
    ds_read_b64_tr_b16 v[146:147], v29 offset:33792
    ds_read_b64_tr_b16 v[148:149], v29 offset:40960
    ds_read_b64_tr_b16 v[150:151], v29 offset:41984
    ds_read_b64_tr_b16 v[152:153], v29 offset:49152
    ds_read_b64_tr_b16 v[154:155], v29 offset:50176
    ds_read_b64_tr_b16 v[156:157], v29 offset:57344
    ds_read_b64_tr_b16 v[158:159], v29 offset:58368
    s_waitcnt lgkmcnt(6)
    v_mfma_f32_16x16x32_bf16 v[160:163], v[144:147], v[128:131], 0
    s_waitcnt lgkmcnt(4)
    v_mfma_f32_16x16x32_bf16 v[160:163], v[148:151], v[132:135], v[160:163]
    s_waitcnt lgkmcnt(2)
    v_mfma_f32_16x16x32_bf16 v[160:163], v[152:155], v[136:139], v[160:163]
    s_waitcnt lgkmcnt(0)
    v_mfma_f32_16x16x32_bf16 v[160:163], v[156:159], v[140:143], v[160:163]
    s_add_u32 s42, s17, 1
    s_and_b32 s42, s42, 7
    s_lshl_b32 s42, s42, 12
    s_add_u32 s42, s42, s31
    s_add_u32 s42, s42, 0
    s_nop 2
    v_bfi_b32 v160, s33, v164, v160
    v_bfi_b32 v161, s33, v165, v161
    v_bfi_b32 v162, s33, v166, v162
    v_bfi_b32 v163, s33, v167, v163
    s_mov_b32 exec_lo, 0x00010001
    s_mov_b32 exec_hi, 0x00010001
    buffer_store_dwordx4 v[160:163], v26, s[12:15], s42 offen sc1
    s_mov_b64 exec, -1
    s_waitcnt vmcnt(1)
    s_waitcnt lgkmcnt(0)
    s_barrier
    ds_read_b64_tr_b16 v[144:145], v30 offset:0
    ds_read_b64_tr_b16 v[146:147], v30 offset:1024
    ds_read_b64_tr_b16 v[148:149], v30 offset:8192
    ds_read_b64_tr_b16 v[150:151], v30 offset:9216
    ds_read_b64_tr_b16 v[152:153], v30 offset:16384
    ds_read_b64_tr_b16 v[154:155], v30 offset:17408
    ds_read_b64_tr_b16 v[156:157], v30 offset:24576
    ds_read_b64_tr_b16 v[158:159], v30 offset:25600
    s_waitcnt lgkmcnt(6)
    v_mfma_f32_16x16x32_bf16 v[160:163], v[144:147], v[128:131], 0
    s_waitcnt lgkmcnt(4)
    v_mfma_f32_16x16x32_bf16 v[160:163], v[148:151], v[132:135], v[160:163]
    s_waitcnt lgkmcnt(2)
    v_mfma_f32_16x16x32_bf16 v[160:163], v[152:155], v[136:139], v[160:163]
    s_waitcnt lgkmcnt(0)
    v_mfma_f32_16x16x32_bf16 v[160:163], v[156:159], v[140:143], v[160:163]
    s_add_u32 s42, s17, 2
    s_and_b32 s42, s42, 7
    s_lshl_b32 s42, s42, 12
    s_add_u32 s42, s42, s31
    s_add_u32 s42, s42, 65536
    s_nop 2
    v_bfi_b32 v160, s33, v164, v160
    v_bfi_b32 v161, s33, v165, v161
    v_bfi_b32 v162, s33, v166, v162
    v_bfi_b32 v163, s33, v167, v163
    s_mov_b32 exec_lo, 0x00010001
    s_mov_b32 exec_hi, 0x00010001
    buffer_store_dwordx4 v[160:163], v26, s[12:15], s42 offen sc1
    s_mov_b64 exec, -1
    s_cmp_eq_u32 s65, 1
    s_cbranch_scc1 x_na
    s_cmp_eq_u32 s80, 0
    s_cselect_b32 s42, 0x42800000, 0
    v_lshl_or_b32 v10, v10, 16, s42
    v_lshlrev_b32 v8, 3, v7
    v_lshrrev_b32 v8, v8, s32
    s_mov_b32 s83, 0
x_pa:
    buffer_load_dwordx4 v[16:19], v3, s[12:15], s77 offen sc1
    s_waitcnt vmcnt(0)
    v_xor_b32 v16, s56, v16
    v_xor_b32 v17, s57, v17
    v_xor_b32 v18, s58, v18
    v_xor_b32 v19, s59, v19
    v_or3_b32 v9, v16, v17, v18
    v_or_b32 v9, v9, v19
    v_and_b32 v9, 0xff, v9
    v_cmp_ne_u32 vcc, 0, v9
    s_cbranch_vccz x_pax
    s_sleep 4
    s_add_u32 s83, s83, 1
    s_cmp_lt_u32 s83, 0x40000
    s_cbranch_scc1 x_pa
x_pax:
    v_permlane32_swap_b32 v16, v18
    v_permlane32_swap_b32 v17, v19
    v_pk_add_f32 v[16:17], v[16:17], v[18:19]
    s_nop 1
    v_permlane16_swap_b32 v16, v17
    v_add_f32 v16, v16, v17
    s_nop 1
    v_add_f32_dpp v16, v16, v16 row_ror:8 row_mask:0xf bank_mask:0xf
    v_cvt_pk_bf16_f32 v16, v16, v16
    v_lshlrev_b32 v16, 16, v16
    v_add_f32 v16, s80, v16
    v_cvt_pk_bf16_f32 v16, v16, v16
    v_lshlrev_b32 v16, 16, v16
    v_mul_f32 v20, v16, v10
    v_bfi_b32 v20, s33, v8, v20
    v_mov_b32 v21, v20
    s_nop 1
    v_permlane16_swap_b32 v20, v21
    v_mov_b32 v22, v20
    v_mov_b32 v23, v21
    s_nop 0
    v_permlane32_swap_b32 v20, v22
    v_permlane32_swap_b32 v21, v23
    s_mov_b64 exec, 0xff
    buffer_store_dwordx4 v[20:23], v3, s[12:15], s79 offen sc1
    s_mov_b64 exec, -1
    s_cmp_eq_u32 s80, 0
    s_cbranch_scc1 x_nc
    s_add_u32 s42, s79, 16384
    v_bfi_b32 v16, s33, v8, v16
    v_mov_b32 v17, v16
    s_nop 1
    v_permlane16_swap_b32 v16, v17
    v_mov_b32 v18, v16
    v_mov_b32 v19, v17
    s_nop 0
    v_permlane32_swap_b32 v16, v18
    v_permlane32_swap_b32 v17, v19
    s_mov_b64 exec, 0xff
    buffer_store_dwordx4 v[16:19], v3, s[12:15], s42 offen sc1
    s_mov_b64 exec, -1
x_nc:
    s_add_u32 s77, s77, 65536
    s_add_u32 s79, s79, 8192
    s_mov_b32 s80, 0
    s_sleep 12
    v_lshlrev_b32 v8, 3, v7
    v_lshrrev_b32 v8, v8, s32
    s_mov_b32 s83, 0
x_pb:
    buffer_load_dwordx4 v[16:19], v3, s[12:15], s77 offen sc1
    s_waitcnt vmcnt(0)
    v_xor_b32 v16, s56, v16
    v_xor_b32 v17, s57, v17
    v_xor_b32 v18, s58, v18
    v_xor_b32 v19, s59, v19
    v_or3_b32 v9, v16, v17, v18
    v_or_b32 v9, v9, v19
    v_and_b32 v9, 0xff, v9
    v_cmp_ne_u32 vcc, 0, v9
    s_cbranch_vccz x_pbx
    s_sleep 4
    s_add_u32 s83, s83, 1
    s_cmp_lt_u32 s83, 0x40000
    s_cbranch_scc1 x_pb
x_pbx:
    v_permlane32_swap_b32 v16, v18
    v_permlane32_swap_b32 v17, v19
    v_pk_add_f32 v[16:17], v[16:17], v[18:19]
    s_nop 1
    v_permlane16_swap_b32 v16, v17
    v_add_f32 v16, v16, v17
    s_nop 1
    v_add_f32_dpp v16, v16, v16 row_ror:8 row_mask:0xf bank_mask:0xf
    v_cvt_pk_bf16_f32 v16, v16, v16
    v_lshlrev_b32 v16, 16, v16
    v_add_f32 v16, s80, v16
    v_cvt_pk_bf16_f32 v16, v16, v16
    v_lshlrev_b32 v16, 16, v16
    v_bfi_b32 v16, s33, v8, v16
    v_mov_b32 v17, v16
    s_nop 1
    v_permlane16_swap_b32 v16, v17
    v_mov_b32 v18, v16
    v_mov_b32 v19, v17
    s_nop 0
    v_permlane32_swap_b32 v16, v18
    v_permlane32_swap_b32 v17, v19
    s_mov_b64 exec, 0xff
    buffer_store_dwordx4 v[16:19], v3, s[12:15], s79 offen sc1
    s_mov_b64 exec, -1
    s_branch x_nb
x_na:
    v_and_b32 v90, 255, v0
    v_lshrrev_b32 v91, 8, v0
    v_lshl_add_u32 v90, v91, 9, v90
    v_mul_u32_u24 v90, 7168, v90
    s_lshr_b32 s42, s60, 7
    s_sub_u32 s42, 3, s42
    s_add_u32 s42, s42, s34
    s_and_b32 s42, s42, 7
    s_cmp_eq_u32 s42, 7
    s_cselect_b32 s70, 0x1000000, 0
    s_mul_i32 s43, s34, 7
    s_add_u32 s42, s42, s43
    s_lshl_b32 s42, s42, 7
    s_add_u32 s42, s42, 0
    s_add_u32 s42, s42, s70
    buffer_load_dword v92, v90, s[60:63], s42 offen
    s_barrier
x_nb:
    s_mov_b32 s17, s37
    s_barrier
    v_lshlrev_b32 v9, 7, v2
    s_mov_b64 exec, 0xfffffff
    buffer_load_dword v251, v9, s[12:15], s36 offen
    s_mov_b64 exec, -1
    s_mov_b32 s8, s48
    s_mov_b32 s9, s49
    s_mov_b32 s10, 2048
    s_mov_b32 s11, 0x00020000
    s_and_b32 s18, s17, 63
    v_and_b32 v5, 3, v0
    v_lshlrev_b32 v5, 3, v5
    v_lshl_add_u32 v5, v7, 1, v5
    v_lshlrev_b32 v6, 1, v5
    v_and_b32 v86, -4, v5
    v_and_b32 v87, 2, v5
    v_lshlrev_b32 v87, 3, v87
    s_lshl_b32 s31, s18, 6
    s_add_u32 s30, s31, 6496256
    s_add_u32 s31, s30, 4096
    s_add_u32 s29, s30, 8192
    s_mov_b32 s28, 6496256
    v_lshlrev_b32 v88, 3, v7
    v_lshrrev_b32 v88, v88, s32
    v_lshrrev_b32 v89, 1, v86
    s_not_b32 s42, s32
    v_lshrrev_b32 v89, v89, s42
    v_and_b32 v89, 196611, v89
    v_lshlrev_b32 v9, 3, v2
    buffer_load_dwordx2 v[40:41], v9, s[8:11], 0 offen offset:0
    buffer_load_dwordx2 v[42:43], v9, s[8:11], 0 offen offset:512
    buffer_load_dwordx2 v[44:45], v9, s[8:11], 0 offen offset:1024
    buffer_load_dwordx2 v[46:47], v9, s[8:11], 0 offen offset:1536
    s_waitcnt vmcnt(0)
    v_lshlrev_b32 v48, 16, v40
    v_and_b32 v49, 0xffff0000, v40
    v_lshlrev_b32 v50, 16, v41
    v_and_b32 v51, 0xffff0000, v41
    v_lshlrev_b32 v52, 16, v42
    v_and_b32 v53, 0xffff0000, v42
    v_lshlrev_b32 v54, 16, v43
    v_and_b32 v55, 0xffff0000, v43
    v_lshlrev_b32 v56, 16, v44
    v_and_b32 v57, 0xffff0000, v44
    v_lshlrev_b32 v58, 16, v45
    v_and_b32 v59, 0xffff0000, v45
    v_lshlrev_b32 v60, 16, v46
    v_and_b32 v61, 0xffff0000, v46
    v_lshlrev_b32 v62, 16, v47
    v_and_b32 v63, 0xffff0000, v47
    s_cmp_lg_u32 s16, 0
    s_cbranch_scc1 x_g1x
    s_mov_b32 s83, 0
x_g1:
    buffer_load_dword v15, v14, s[12:15], s78 offen offset:2048 sc1
    s_waitcnt vmcnt(0)
    v_cmp_ne_u32 vcc, s32, v15
    s_cbranch_vccz x_g1x
    s_sleep 6
    s_add_u32 s83, s83, 1
    s_cmp_lt_u32 s83, 0x40000
    s_cbranch_scc1 x_g1
x_g1x:
    s_barrier
    s_mov_b32 s83, 0
x_pq:
    buffer_load_dwordx4 v[64:67], v3, s[12:15], s28 offen offset:0 sc1
    buffer_load_dwordx4 v[68:71], v3, s[12:15], s28 offen offset:1024 sc1
    buffer_load_dwordx4 v[72:75], v3, s[12:15], s28 offen offset:2048 sc1
    buffer_load_dwordx4 v[76:79], v3, s[12:15], s28 offen offset:3072 sc1
    buffer_load_dword v32, v6, s[12:15], s30 offen sc1
    buffer_load_dword v33, v6, s[12:15], s31 offen sc1
    buffer_load_dword v34, v6, s[12:15], s29 offen sc1
    s_waitcnt vmcnt(0)
    v_xor_b32 v36, v32, v88
    v_bitop3_b32 v36, v36, v33, v88 bitop3:0xf6
    v_bitop3_b32 v36, v36, v34, v88 bitop3:0xf6
    v_and_b32 v36, s33, v36
    v_cmp_ne_u32 s[68:69], 0, v36
    v_xor_b32 v64, s56, v64
    v_xor_b32 v65, s57, v65
    v_xor_b32 v66, s58, v66
    v_xor_b32 v67, s59, v67
    v_xor_b32 v68, s56, v68
    v_xor_b32 v69, s57, v69
    v_xor_b32 v70, s58, v70
    v_xor_b32 v71, s59, v71
    v_xor_b32 v72, s56, v72
    v_xor_b32 v73, s57, v73
    v_xor_b32 v74, s58, v74
    v_xor_b32 v75, s59, v75
    v_xor_b32 v76, s56, v76
    v_xor_b32 v77, s57, v77
    v_xor_b32 v78, s58, v78
    v_xor_b32 v79, s59, v79
    v_or3_b32 v9, v64, v65, v66
    v_or3_b32 v9, v9, v67, v68
    v_or3_b32 v9, v9, v69, v70
    v_or3_b32 v9, v9, v71, v72
    v_or3_b32 v9, v9, v73, v74
    v_or3_b32 v9, v9, v75, v76
    v_or3_b32 v9, v9, v77, v78
    v_or_b32 v9, v9, v79
    v_and_b32 v9, 0xff, v9
    v_cmp_ne_u32 vcc, 0, v9
    s_or_b64 vcc, vcc, s[68:69]
    s_cbranch_vccz x_pqx
    s_sleep 4
    s_add_u32 s83, s83, 1
    s_cmp_lt_u32 s83, 0x40000
    s_cbranch_scc1 x_pq
x_pqx:
    v_and_b32 v32, 0xffff0000, v32
    v_and_b32 v33, 0xffff0000, v33
    v_and_b32 v34, 0xffff0000, v34
    v_pk_mul_f32 v[8:9], v[48:49], v[64:65]
    v_pk_fma_f32 v[8:9], v[50:51], v[66:67], v[8:9]
    v_pk_fma_f32 v[8:9], v[52:53], v[68:69], v[8:9]
    v_pk_fma_f32 v[8:9], v[54:55], v[70:71], v[8:9]
    v_pk_fma_f32 v[8:9], v[56:57], v[72:73], v[8:9]
    v_pk_fma_f32 v[8:9], v[58:59], v[74:75], v[8:9]
    v_pk_fma_f32 v[8:9], v[60:61], v[76:77], v[8:9]
    v_pk_fma_f32 v[8:9], v[62:63], v[78:79], v[8:9]
    v_add_f32 v8, v8, v9
    s_nop 1
    v_add_f32_dpp v8, v8, v8 row_ror:8 row_mask:0xf bank_mask:0xf
    s_nop 1
    v_add_f32_dpp v8, v8, v8 row_ror:4 row_mask:0xf bank_mask:0xf
    s_nop 1
    v_add_f32_dpp v8, v8, v8 row_ror:2 row_mask:0xf bank_mask:0xf
    s_nop 1
    v_add_f32_dpp v8, v8, v8 row_ror:1 row_mask:0xf bank_mask:0xf
    s_nop 1
    v_add_f32_dpp v8, v8, v8 row_bcast:15 row_mask:0xa bank_mask:0xf
    s_nop 1
    v_add_f32_dpp v8, v8, v8 row_bcast:31 row_mask:0xc bank_mask:0xf
    s_cmp_lg_u32 s16, 0
    s_cbranch_scc1 x_ng
    v_mov_b32 v22, 0
    s_mov_b32 s83, 0
x_r0:
    buffer_load_dwordx2 v[16:17], v22, s[12:15], s78 offen offset:2304 sc1
    s_waitcnt vmcnt(0)
    v_readfirstlane_b32 s40, v16
    v_readfirstlane_b32 s41, v17
    s_cmp_eq_u32 s41, s32
    s_cbranch_scc1 x_r0x
    s_sleep 3
    s_add_u32 s83, s83, 1
    s_cmp_lt_u32 s83, 0x40000
    s_cbranch_scc1 x_r0
x_r0x:
    s_lshr_b32 s41, s40, 8
    s_and_b32 s40, s40, 0xff
    s_and_b32 s41, s41, 0xff
x_ng:
    s_barrier
    v_mov_b32 v22, 0
    s_mov_b32 s83, 0
x_r1:
    buffer_load_dwordx2 v[16:17], v22, s[12:15], s78 offen offset:2304 sc1
    s_waitcnt vmcnt(0)
    v_readfirstlane_b32 s40, v16
    v_readfirstlane_b32 s41, v17
    s_cmp_eq_u32 s41, s32
    s_cbranch_scc1 x_r1x
    s_sleep 1
    s_add_u32 s83, s83, 1
    s_cmp_lt_u32 s83, 0x40000
    s_cbranch_scc1 x_r1
x_r1x:
    s_lshr_b32 s41, s40, 8
    s_and_b32 s40, s40, 0xff
    s_and_b32 s41, s41, 0xff
    s_cmp_lt_u32 s17, 64
    s_cselect_b32 s40, s40, s41
    s_lshl_b32 s42, s40, 11
    s_add_u32 s42, s42, 5242880
    s_lshl_b32 s19, s18, 5
    s_add_u32 s43, s42, s19
    s_lshl_b32 s40, s40, 4
    s_add_u32 s40, s40, 6512640
    s_mov_b32 s83, 0
x_ps:
    buffer_load_dwordx4 v[80:83], v14, s[12:15], s40 offen sc1
    buffer_load_dword v40, v86, s[12:15], s43 offen sc1
    s_waitcnt vmcnt(0)
    v_xor_b32 v40, v40, v89
    v_xor_b32 v35, 0x00020002, v40
    v_and_b32 v35, 196611, v35
    v_cmp_ne_u32 s[68:69], 0, v35
    v_xor_b32 v80, s56, v80
    v_xor_b32 v81, s57, v81
    v_xor_b32 v82, s58, v82
    v_xor_b32 v83, s59, v83
    v_or3_b32 v9, v80, v81, v82
    v_or_b32 v9, v9, v83
    v_and_b32 v9, 0xff, v9
    v_cmp_ne_u32 vcc, 0, v9
    s_or_b64 vcc, vcc, s[68:69]
    s_cbranch_vccz x_psx
    s_sleep 2
    s_add_u32 s83, s83, 1
    s_cmp_lt_u32 s83, 0x40000
    s_cbranch_scc1 x_ps
x_psx:
    v_readfirstlane_b32 s41, v80
    s_bfe_u32 s41, s41, 0xb0008
    s_lshl_b32 s41, s41, 11
    s_add_u32 s41, s41, s19
    v_not_b32 v36, v83
    v_ashrrev_i32 v36, 31, v36
    v_or_b32 v36, 0x80000000, v36
    v_xor_b32 v36, v36, v83
    v_add_f32 v8, v8, v36
    v_cvt_pk_bf16_f32 v8, v8, v8
    v_lshlrev_b32 v8, 16, v8
    v_mul_f32 v8, 0xbfb8aa3b, v8
    v_exp_f32 v8, v8
    s_nop 0
    v_add_f32 v8, 1.0, v8
    v_rcp_f32 v8, v8
    s_nop 0
    v_cvt_pk_bf16_f32 v8, v8, v8
    v_lshlrev_b32 v8, 16, v8
    s_nop 0
    v_readlane_b32 s46, v8, 63
    v_lshrrev_b32 v40, v87, v40
    v_cvt_f32_f16 v40, v40
    v_rcp_f32 v82, v82
    v_fma_f32 v36, v40, v34, v32
    v_fma_f32 v44, v40, v82, v81
    v_fmac_f32 v44, v33, v36
    v_mul_f32 v80, s46, v33
    s_sleep 20
    s_mov_b32 s83, 0
    s_mov_b64 s[60:61], -1
    s_mov_b64 s[62:63], -1
    s_mov_b64 s[64:65], -1
    s_mov_b32 s66, -1
    s_mov_b32 s67, 0
    v_mov_b32 v108, 0
    v_mov_b32 v109, 0
    v_mov_b32 v110, 0
    v_mov_b32 v111, 0
    s_mov_b64 exec, s[60:61]
    buffer_load_dwordx4 v[16:19], v3, s[12:15], s36 offen offset:0 sc1
    s_mov_b64 exec, s[62:63]
    buffer_load_dwordx4 v[20:23], v3, s[12:15], s36 offen offset:1024 sc1
    s_mov_b64 exec, s[64:65]
    buffer_load_dwordx4 v[24:27], v3, s[12:15], s36 offen offset:2048 sc1
    s_mov_b64 exec, s[66:67]
    buffer_load_dwordx4 v[28:31], v3, s[12:15], s36 offen offset:3072 sc1
    s_sleep 8
x_p2:
    s_mov_b64 exec, s[60:61]
    buffer_load_dwordx4 v[128:131], v3, s[12:15], s36 offen offset:0 sc1
    s_mov_b64 exec, s[62:63]
    buffer_load_dwordx4 v[132:135], v3, s[12:15], s36 offen offset:1024 sc1
    s_mov_b64 exec, s[64:65]
    buffer_load_dwordx4 v[136:139], v3, s[12:15], s36 offen offset:2048 sc1
    s_mov_b64 exec, s[66:67]
    buffer_load_dwordx4 v[140:143], v3, s[12:15], s36 offen offset:3072 sc1
    s_mov_b64 exec, s[60:61]
    s_waitcnt vmcnt(7)
    v_xor_b32 v96, s56, v16
    v_xor_b32 v97, s57, v17
    v_xor_b32 v98, s58, v18
    v_xor_b32 v99, s59, v19
    v_or3_b32 v12, v96, v97, v98
    v_bitop3_b32 v12, v12, v99, s33 bitop3:0xa8
    v_cmp_ne_u32 s[60:61], 0, v12
    s_mov_b64 exec, s[62:63]
    s_waitcnt vmcnt(6)
    v_xor_b32 v100, s56, v20
    v_xor_b32 v101, s57, v21
    v_xor_b32 v102, s58, v22
    v_xor_b32 v103, s59, v23
    v_or3_b32 v12, v100, v101, v102
    v_bitop3_b32 v12, v12, v103, s33 bitop3:0xa8
    v_cmp_ne_u32 s[62:63], 0, v12
    s_mov_b64 exec, s[64:65]
    s_waitcnt vmcnt(5)
    v_xor_b32 v104, s56, v24
    v_xor_b32 v105, s57, v25
    v_xor_b32 v106, s58, v26
    v_xor_b32 v107, s59, v27
    v_or3_b32 v12, v104, v105, v106
    v_bitop3_b32 v12, v12, v107, s33 bitop3:0xa8
    v_cmp_ne_u32 s[64:65], 0, v12
    s_or_b64 s[70:71], s[60:61], s[62:63]
    s_mov_b64 exec, s[66:67]
    s_waitcnt vmcnt(4)
    v_xor_b32 v108, s56, v28
    v_xor_b32 v109, s57, v29
    v_xor_b32 v110, s58, v30
    v_xor_b32 v111, s59, v31
    v_or3_b32 v12, v108, v109, v110
    v_bitop3_b32 v12, v12, v111, s33 bitop3:0xa8
    v_cmp_ne_u32 s[66:67], 0, v12
    s_mov_b64 exec, -1
    v_pk_add_f32 v[112:113], v[96:97], v[100:101]
    v_pk_add_f32 v[114:115], v[98:99], v[102:103]
    s_or_b64 s[72:73], s[64:65], s[66:67]
    v_pk_add_f32 v[120:121], v[104:105], v[108:109]
    v_pk_add_f32 v[122:123], v[106:107], v[110:111]
    s_or_b64 s[70:71], s[70:71], s[72:73]
    v_pk_add_f32 v[112:113], v[112:113], v[120:121]
    v_pk_add_f32 v[114:115], v[114:115], v[122:123]
    s_cbranch_scc0 x_p3
    s_mov_b64 exec, s[60:61]
    buffer_load_dwordx4 v[16:19], v3, s[12:15], s36 offen offset:0 sc1
    s_mov_b64 exec, s[62:63]
    buffer_load_dwordx4 v[20:23], v3, s[12:15], s36 offen offset:1024 sc1
    s_mov_b64 exec, s[64:65]
    buffer_load_dwordx4 v[24:27], v3, s[12:15], s36 offen offset:2048 sc1
    s_mov_b64 exec, s[66:67]
    buffer_load_dwordx4 v[28:31], v3, s[12:15], s36 offen offset:3072 sc1
    s_add_u32 s83, s83, 1
    s_cmp_lt_u32 s83, 0x40000
    s_cselect_b64 s[68:69], -1, 0
    s_mov_b64 exec, s[60:61]
    s_waitcnt vmcnt(7)
    v_xor_b32 v96, s56, v128
    v_xor_b32 v97, s57, v129
    v_xor_b32 v98, s58, v130
    v_xor_b32 v99, s59, v131
    v_or3_b32 v12, v96, v97, v98
    v_bitop3_b32 v12, v12, v99, s33 bitop3:0xa8
    v_cmp_ne_u32 s[60:61], 0, v12
    s_mov_b64 exec, s[62:63]
    s_waitcnt vmcnt(6)
    v_xor_b32 v100, s56, v132
    v_xor_b32 v101, s57, v133
    v_xor_b32 v102, s58, v134
    v_xor_b32 v103, s59, v135
    v_or3_b32 v12, v100, v101, v102
    v_bitop3_b32 v12, v12, v103, s33 bitop3:0xa8
    v_cmp_ne_u32 s[62:63], 0, v12
    s_mov_b64 exec, s[64:65]
    s_waitcnt vmcnt(5)
    v_xor_b32 v104, s56, v136
    v_xor_b32 v105, s57, v137
    v_xor_b32 v106, s58, v138
    v_xor_b32 v107, s59, v139
    v_or3_b32 v12, v104, v105, v106
    v_bitop3_b32 v12, v12, v107, s33 bitop3:0xa8
    v_cmp_ne_u32 s[64:65], 0, v12
    s_or_b64 s[70:71], s[60:61], s[62:63]
    s_mov_b64 exec, s[66:67]
    s_waitcnt vmcnt(4)
    v_xor_b32 v108, s56, v140
    v_xor_b32 v109, s57, v141
    v_xor_b32 v110, s58, v142
    v_xor_b32 v111, s59, v143
    v_or3_b32 v12, v108, v109, v110
    v_bitop3_b32 v12, v12, v111, s33 bitop3:0xa8
    v_cmp_ne_u32 s[66:67], 0, v12
    s_mov_b64 exec, -1
    v_pk_add_f32 v[112:113], v[96:97], v[100:101]
    v_pk_add_f32 v[114:115], v[98:99], v[102:103]
    s_or_b64 s[72:73], s[64:65], s[66:67]
    v_pk_add_f32 v[120:121], v[104:105], v[108:109]
    v_pk_add_f32 v[122:123], v[106:107], v[110:111]
    s_or_b64 s[70:71], s[70:71], s[72:73]
    s_and_b64 s[70:71], s[70:71], s[68:69]
    v_pk_add_f32 v[112:113], v[112:113], v[120:121]
    v_pk_add_f32 v[114:115], v[114:115], v[122:123]
    s_cbranch_scc1 x_p2
x_p3:
    s_nop 0
    v_permlane32_swap_b32 v112, v114
    v_permlane32_swap_b32 v113, v115
    v_pk_add_f32 v[112:113], v[112:113], v[114:115]
    s_nop 1
    v_permlane16_swap_b32 v112, v113
    v_add_f32 v112, v112, v113
    s_nop 1
    v_add_f32_dpp v112, v112, v112 row_ror:4 row_mask:0xf bank_mask:0xf
    s_nop 1
    v_add_f32_dpp v112, v112, v112 row_ror:8 row_mask:0xf bank_mask:0xf
    v_fmac_f32 v44, v112, v80
    s_mov_b32 exec_lo, 0x000f000f
    s_mov_b32 exec_hi, 0x000f000f
    v_cvt_pk_bf16_f32 v44, v44, v44
    buffer_store_short v44, v5, s[24:27], s41 offen
    s_cmp_lg_u32 s17, 0
    s_cbranch_scc1 x_end
    s_add_u32 s101, s101, 1
    s_mov_b32 s43, 6619136
    v_mov_b32 v8, s101
    s_mov_b64 exec, 1
    buffer_store_dword v8, v14, s[12:15], s43 offen sc1
x_end:
k_done:
    s_endpgm
code_end:
.p2align 8
.type tables,@object
tables:
.long 0x3c00,0x3c00,0x3c00,0x3c00,0x3c00,0x2e463bf6,0x323e3bd9,0x34a53ba8
.long 0x3c00,0x323e3bd9,0x361f3b64,0x38723aa7,0x3c00,0x34a53ba8,0x38723aa7,0x3a2f3913
.long 0x3c00,0x361f3b64,0x39a839a8,0x3b64361f,0x3c00,0x378b3b0e,0x3aa73872,0x3bf62e46
.long 0x3c00,0x38723aa7,0x3b64361f,0x3bd9b23e,0x3c00,0x39133a2f,0x3bd9323e,0x3b0eb78b
.long 0x3c00,0x39a839a8,0x3c000000,0x39a8b9a8,0x3c00,0x3a2f3913,0x3bd9b23e,0x378bbb0e
.long 0x3c00,0x3aa73872,0x3b64b61f,0x323ebbd9,0x3c00,0x3b0e378b,0x3aa7b872,0xae46bbf6
.long 0x3c00,0x3b64361f,0x39a8b9a8,0xb61fbb64,0x3c00,0x3ba834a5,0x3872baa7,0xb913ba2f
.long 0x3c00,0x3bd9323e,0x361fbb64,0xbaa7b872,0x3c00,0x3bf62e46,0x323ebbd9,0xbba8b4a5
.long 0x3c00,0x3c00,0x3c00,0x3c00,0x361f3b64,0x378b3b0e,0x38723aa7,0x39133a2f
.long 0x39a839a8,0x3aa73872,0x3b64361f,0x3bd9323e,0x3b64361f,0x3bf62e46,0x3bd9b23e,0x3b0eb78b
.long 0x3c000000,0x3b64b61f,0x39a8b9a8,0x361fbb64,0x3b64b61f,0x3913ba2f,0x323ebbd9,0xb4a5bba8
.long 0x39a8b9a8,0x323ebbd9,0xb61fbb64,0xbaa7b872,0x361fbb64,0xb4a5bba8,0xbaa7b872,0xbbf62e46
.long 0xbc00,0xb9a8b9a8,0xbc008000,0xb9a839a8,0xb61fbb64,0xbba8b4a5,0xbaa73872,0xae463bf6
.long 0xb9a8b9a8,0xbbd9323e,0xb61f3b64,0x38723aa7,0xbb64b61f,0xba2f3913,0x323e3bd9,0x3ba834a5
.long 0xbc008000,0xb61f3b64,0x39a839a8,0x3b64b61f,0xbb64361f,0x2e463bf6,0x3bd9323e,0x378bbb0e
.long 0xb9a839a8,0x38723aa7,0x3b64b61f,0xb23ebbd9,0xb61f3b64,0x3b0e378b,0x3872baa7,0xba2fb913
.long 0x3c00,0x3c00,0x3c00,0x3c00,0x39a839a8,0x3a2f3913,0x3aa73872,0x3b0e378b
.long 0x3c000000,0x3bd9b23e,0x3b64b61f,0x3aa7b872,0x39a8b9a8,0x378bbb0e,0x323ebbd9,0xae46bbf6
.long 0xbc00,0xb61fbb64,0xb9a8b9a8,0xbb64b61f,0xb9a8b9a8,0xbba8b4a5,0xbbd9323e,0xba2f3913
.long 0xbc008000,0xbaa73872,0xb61f3b64,0x323e3bd9,0xb9a839a8,0xae463bf6,0x38723aa7,0x3ba834a5
.long 0x3c00,0x39a839a8,0x3c000000,0x39a8b9a8,0x39a839a8,0x3bf6ae46,0x3872baa7,0xb4a5bba8
.long 0x3c000000,0x3872baa7,0xb61fbb64,0xbbd9b23e,0x39a8b9a8,0xb4a5bba8,0xbbd9b23e,0xb9133a2f
.long 0xbc00,0xbb64b61f,0xb9a839a8,0x361f3b64,0xb9a8b9a8,0xbb0e378b,0x323e3bd9,0x3bf62e46
.long 0xbc008000,0xb23e3bd9,0x3b64361f,0x3872baa7,0xb9a839a8,0x39133a2f,0x3aa7b872,0xb78bbb0e
.long 0x3c00,0x3c00,0x3c00,0x3c00,0x3b64361f,0x3ba834a5,0x3bd9323e,0x3bf62e46
.long 0x39a8b9a8,0x3872baa7,0x361fbb64,0x323ebbd9,0xb61fbb64,0xb913ba2f,0xbaa7b872,0xbba8b4a5
.long 0xbc008000,0xbb64361f,0xb9a839a8,0xb61f3b64,0xb61f3b64,0x2e463bf6,0x38723aa7,0x3b0e378b
.long 0x39a839a8,0x3bd9323e,0x3b64b61f,0x3872baa7,0x3b64b61f,0x378bbb0e,0xb23ebbd9,0xba2fb913
.long 0xbc00,0xb9a8b9a8,0xbc008000,0xb9a839a8,0xbb64b61f,0xbb0e378b,0xb23e3bd9,0x39133a2f
.long 0xb9a839a8,0x323e3bd9,0x3b64361f,0x3aa7b872,0x361f3b64,0x3bf62e46,0x3872baa7,0xb78bbb0e
.long 0x3c000000,0x361fbb64,0xb9a8b9a8,0xbb64361f,0x361fbb64,0xba2fb913,0xbaa73872,0x34a53ba8
.long 0xb9a8b9a8,0xbaa73872,0x361f3b64,0x3bd9b23e,0xbb64361f,0x34a53ba8,0x3bd9b23e,0xae46bbf6
.long 0x3c00,0x3c00,0x3c00,0x3c00,0x3c000000,0x3bf6ae46,0x3bd9b23e,0x3ba8b4a5
.long 0xbc00,0xb23ebbd9,0xb61fbb64,0xb872baa7,0xbc008000,0xbba834a5,0xbaa73872,0xb9133a2f
.long 0x3c00,0x361f3b64,0x39a839a8,0x3b64361f,0x3c000000,0x3b0eb78b,0x3872baa7,0x2e46bbf6
.long 0xbc00,0xb872baa7,0xbb64b61f,0xbbd9323e,0xbc008000,0xba2f3913,0xb23e3bd9,0x378b3b0e
.long 0x3c00,0x39a839a8,0x3c000000,0x39a8b9a8,0x3c000000,0x3913ba2f,0xb23ebbd9,0xbb0eb78b
.long 0xbc00,0xbaa7b872,0xbb64361f,0xb23e3bd9,0xbc008000,0xb78b3b0e,0x38723aa7,0x3bf6ae46
.long 0x3c00,0x3b64361f,0x39a8b9a8,0xb61fbb64,0x3c000000,0x34a5bba8,0xbaa7b872,0xba2f3913
.long 0xbc00,0xbbd9b23e,0xb61f3b64,0x3aa73872,0xbc008000,0xae463bf6,0x3bd9323e,0x34a5bba8
.long 0x3c00,0x3c00,0x3c00,0x3c00,0x3b64b61f,0x3b0eb78b,0x3aa7b872,0x3a2fb913
.long 0xb9a8b9a8,0xbaa7b872,0xbb64b61f,0xbbd9b23e,0xb61f3b64,0xae463bf6,0x323e3bd9,0x378b3b0e
.long 0x3c000000,0x3b64b61f,0x39a8b9a8,0x361fbb64,0xb61fbb64,0xba2fb913,0xbbd9b23e,0xbba834a5
.long 0xb9a839a8,0xb23e3bd9,0x361f3b64,0x3aa73872,0x3b64361f,0x3ba8b4a5,0x3872baa7,0xae46bbf6
.long 0xbc00,0xb9a8b9a8,0xbc008000,0xb9a839a8,0xbb64361f,0xb4a53ba8,0x38723aa7,0x3bf62e46
.long 0x39a839a8,0x3bd9b23e,0x361fbb64,0xb872baa7,0x361fbb64,0xb913ba2f,0xbbd9323e,0xb4a53ba8
.long 0xbc008000,0xb61f3b64,0x39a839a8,0x3b64b61f,0x361f3b64,0x3bf6ae46,0x323ebbd9,0xbb0eb78b
.long 0x39a8b9a8,0xb872baa7,0xbb64361f,0x323e3bd9,0xbb64b61f,0xb78b3b0e,0x3aa73872,0x3913ba2f
.long 0x3c00,0x3c00,0x3c00,0x3c00,0x39a8b9a8,0x3913ba2f,0x3872baa7,0x378bbb0e
.long 0xbc008000,0xbbd9323e,0xbb64361f,0xbaa73872,0x39a839a8,0x3b0e378b,0x3bd9323e,0x3bf6ae46
.long 0xbc00,0xb61fbb64,0xb9a8b9a8,0xbb64b61f,0xb9a839a8,0xb4a53ba8,0x323e3bd9,0x39133a2f
.long 0x3c000000,0x3aa7b872,0x361fbb64,0xb23ebbd9,0xb9a8b9a8,0xbbf6ae46,0xbaa73872,0xb4a53ba8
.long 0x3c00,0x39a839a8,0x3c000000,0x39a8b9a8,0x39a8b9a8,0xae46bbf6,0xbaa7b872,0xbba834a5
.long 0xbc008000,0xb8723aa7,0x361f3b64,0x3bd9323e,0x39a839a8,0x3ba8b4a5,0x323ebbd9,0xba2fb913
.long 0xbc00,0xbb64b61f,0xb9a839a8,0x361f3b64,0xb9a839a8,0x378b3b0e,0x3bd9b23e,0x2e46bbf6
.long 0x3c000000,0x323ebbd9,0xbb64b61f,0xb8723aa7,0xb9a8b9a8,0xba2f3913,0x38723aa7,0x3b0eb78b
.long 0x3c00,0x3c00,0x3c00,0x3c00,0x361fbb64,0x34a5bba8,0x323ebbd9,0x2e46bbf6
.long 0xb9a839a8,0xb8723aa7,0xb61f3b64,0xb23e3bd9,0x3b64b61f,0x3a2fb913,0x3872baa7,0x34a5bba8
.long 0xbc008000,0xbb64361f,0xb9a839a8,0xb61f3b64,0x3b64361f,0x3bf6ae46,0x3aa7b872,0x378bbb0e
.long 0xb9a8b9a8,0xbbd9b23e,0xbb64361f,0xb8723aa7,0x361f3b64,0x3b0e378b,0x3bd9b23e,0x3913ba2f
.long 0xbc00,0xb9a8b9a8,0xbc008000,0xb9a839a8,0xb61f3b64,0x378b3b0e,0x3bd9323e,0x3a2fb913
.long 0x39a8b9a8,0xb23ebbd9,0xbb64b61f,0xbaa73872,0xbb64361f,0xae463bf6,0x3aa73872,0x3b0eb78b
.long 0x3c000000,0x361fbb64,0xb9a8b9a8,0xbb64361f,0xbb64b61f,0xb9133a2f,0x38723aa7,0x3ba8b4a5
.long 0x39a839a8,0x3aa7b872,0xb61fbb64,0xbbd9323e,0xb61fbb64,0xbba834a5,0x323e3bd9,0x3bf6ae46
.long 0x3c00,0x3c00,0x3c00,0x3c00,0xbc00,0xae46bbf6,0xb23ebbd9,0xb4a5bba8
.long 0x3c00,0x323e3bd9,0x361f3b64,0x38723aa7,0xbc00,0xb4a5bba8,0xb872baa7,0xba2fb913
.long 0x3c00,0x361f3b64,0x39a839a8,0x3b64361f,0xbc00,0xb78bbb0e,0xbaa7b872,0xbbf6ae46
.long 0x3c00,0x38723aa7,0x3b64361f,0x3bd9b23e,0xbc00,0xb913ba2f,0xbbd9b23e,0xbb0e378b
.long 0x3c00,0x39a839a8,0x3c000000,0x39a8b9a8,0xbc00,0xba2fb913,0xbbd9323e,0xb78b3b0e
.long 0x3c00,0x3aa73872,0x3b64b61f,0x323ebbd9,0xbc00,0xbb0eb78b,0xbaa73872,0x2e463bf6
.long 0x3c00,0x3b64361f,0x39a8b9a8,0xb61fbb64,0xbc00,0xbba8b4a5,0xb8723aa7,0x39133a2f
.long 0x3c00,0x3bd9323e,0x361fbb64,0xbaa7b872,0xbc00,0xbbf6ae46,0xb23e3bd9,0x3ba834a5
.long 0x3c00,0x3c00,0x3c00,0x3c00,0xb61fbb64,0xb78bbb0e,0xb872baa7,0xb913ba2f
.long 0x39a839a8,0x3aa73872,0x3b64361f,0x3bd9323e,0xbb64b61f,0xbbf6ae46,0xbbd9323e,0xbb0e378b
.long 0x3c000000,0x3b64b61f,0x39a8b9a8,0x361fbb64,0xbb64361f,0xb9133a2f,0xb23e3bd9,0x34a53ba8
.long 0x39a8b9a8,0x323ebbd9,0xb61fbb64,0xbaa7b872,0xb61f3b64,0x34a53ba8,0x3aa73872,0x3bf6ae46
.long 0xbc00,0xb9a8b9a8,0xbc008000,0xb9a839a8,0x361f3b64,0x3ba834a5,0x3aa7b872,0x2e46bbf6
.long 0xb9a8b9a8,0xbbd9323e,0xb61f3b64,0x38723aa7,0x3b64361f,0x3a2fb913,0xb23ebbd9,0xbba8b4a5
.long 0xbc008000,0xb61f3b64,0x39a839a8,0x3b64b61f,0x3b64b61f,0xae46bbf6,0xbbd9b23e,0xb78b3b0e
.long 0xb9a839a8,0x38723aa7,0x3b64b61f,0xb23ebbd9,0x361fbb64,0xbb0eb78b,0xb8723aa7,0x3a2f3913
.long 0x3c00,0x3c00,0x3c00,0x3c00,0xb9a8b9a8,0xba2fb913,0xbaa7b872,0xbb0eb78b
.long 0x3c000000,0x3bd9b23e,0x3b64b61f,0x3aa7b872,0xb9a839a8,0xb78b3b0e,0xb23e3bd9,0x2e463bf6
.long 0xbc00,0xb61fbb64,0xb9a8b9a8,0xbb64b61f,0x39a839a8,0x3ba834a5,0x3bd9b23e,0x3a2fb913
.long 0xbc008000,0xbaa73872,0xb61f3b64,0x323e3bd9,0x39a8b9a8,0x2e46bbf6,0xb872baa7,0xbba8b4a5
.long 0x3c00,0x39a839a8,0x3c000000,0x39a8b9a8,0xb9a8b9a8,0xbbf62e46,0xb8723aa7,0x34a53ba8
.long 0x3c000000,0x3872baa7,0xb61fbb64,0xbbd9b23e,0xb9a839a8,0x34a53ba8,0x3bd9323e,0x3913ba2f
.long 0xbc00,0xbb64b61f,0xb9a839a8,0x361f3b64,0x39a839a8,0x3b0eb78b,0xb23ebbd9,0xbbf6ae46
.long 0xbc008000,0xb23e3bd9,0x3b64361f,0x3872baa7,0x39a8b9a8,0xb913ba2f,0xbaa73872,0x378b3b0e
.long 0x3c00,0x3c00,0x3c00,0x3c00,0xbb64b61f,0xbba8b4a5,0xbbd9b23e,0xbbf6ae46
.long 0x39a8b9a8,0x3872baa7,0x361fbb64,0x323ebbd9,0x361f3b64,0x39133a2f,0x3aa73872,0x3ba834a5
.long 0xbc008000,0xbb64361f,0xb9a839a8,0xb61f3b64,0x361fbb64,0xae46bbf6,0xb872baa7,0xbb0eb78b
.long 0x39a839a8,0x3bd9323e,0x3b64b61f,0x3872baa7,0xbb64361f,0xb78b3b0e,0x323e3bd9,0x3a2f3913
.long 0xbc00,0xb9a8b9a8,0xbc008000,0xb9a839a8,0x3b64361f,0x3b0eb78b,0x323ebbd9,0xb913ba2f
.long 0xb9a839a8,0x323e3bd9,0x3b64361f,0x3aa7b872,0xb61fbb64,0xbbf6ae46,0xb8723aa7,0x378b3b0e
.long 0x3c000000,0x361fbb64,0xb9a8b9a8,0xbb64361f,0xb61f3b64,0x3a2f3913,0x3aa7b872,0xb4a5bba8
.long 0xb9a8b9a8,0xbaa73872,0x361f3b64,0x3bd9b23e,0x3b64b61f,0xb4a5bba8,0xbbd9323e,0x2e463bf6
.long 0x3c00,0x3c00,0x3c00,0x3c00,0xbc008000,0xbbf62e46,0xbbd9323e,0xbba834a5
.long 0xbc00,0xb23ebbd9,0xb61fbb64,0xb872baa7,0x3c000000,0x3ba8b4a5,0x3aa7b872,0x3913ba2f
.long 0x3c00,0x361f3b64,0x39a839a8,0x3b64361f,0xbc008000,0xbb0e378b,0xb8723aa7,0xae463bf6
.long 0xbc00,0xb872baa7,0xbb64b61f,0xbbd9323e,0x3c000000,0x3a2fb913,0x323ebbd9,0xb78bbb0e
.long 0x3c00,0x39a839a8,0x3c000000,0x39a8b9a8,0xbc008000,0xb9133a2f,0x323e3bd9,0x3b0e378b
.long 0xbc00,0xbaa7b872,0xbb64361f,0xb23e3bd9,0x3c000000,0x378bbb0e,0xb872baa7,0xbbf62e46
.long 0x3c00,0x3b64361f,0x39a8b9a8,0xb61fbb64,0xbc008000,0xb4a53ba8,0x3aa73872,0x3a2fb913
.long 0xbc00,0xbbd9b23e,0xb61f3b64,0x3aa73872,0x3c000000,0x2e46bbf6,0xbbd9b23e,0xb4a53ba8
.long 0x3c00,0x3c00,0x3c00,0x3c00,0xbb64361f,0xbb0e378b,0xbaa73872,0xba2f3913
.long 0xb9a8b9a8,0xbaa7b872,0xbb64b61f,0xbbd9b23e,0x361fbb64,0x2e46bbf6,0xb23ebbd9,0xb78bbb0e
.long 0x3c000000,0x3b64b61f,0x39a8b9a8,0x361fbb64,0x361f3b64,0x3a2f3913,0x3bd9323e,0x3ba8b4a5
.long 0xb9a839a8,0xb23e3bd9,0x361f3b64,0x3aa73872,0xbb64b61f,0xbba834a5,0xb8723aa7,0x2e463bf6
.long 0xbc00,0xb9a8b9a8,0xbc008000,0xb9a839a8,0x3b64b61f,0x34a5bba8,0xb872baa7,0xbbf6ae46
.long 0x39a839a8,0x3bd9b23e,0x361fbb64,0xb872baa7,0xb61f3b64,0x39133a2f,0x3bd9b23e,0x34a5bba8
.long 0xbc008000,0xb61f3b64,0x39a839a8,0x3b64b61f,0xb61fbb64,0xbbf62e46,0xb23e3bd9,0x3b0e378b
.long 0x39a8b9a8,0xb872baa7,0xbb64361f,0x323e3bd9,0x3b64361f,0x378bbb0e,0xbaa7b872,0xb9133a2f
.long 0x3c00,0x3c00,0x3c00,0x3c00,0xb9a839a8,0xb9133a2f,0xb8723aa7,0xb78b3b0e
.long 0xbc008000,0xbbd9323e,0xbb64361f,0xbaa73872,0xb9a8b9a8,0xbb0eb78b,0xbbd9b23e,0xbbf62e46
.long 0xbc00,0xb61fbb64,0xb9a8b9a8,0xbb64b61f,0x39a8b9a8,0x34a5bba8,0xb23ebbd9,0xb913ba2f
.long 0x3c000000,0x3aa7b872,0x361fbb64,0xb23ebbd9,0x39a839a8,0x3bf62e46,0x3aa7b872,0x34a5bba8
.long 0x3c00,0x39a839a8,0x3c000000,0x39a8b9a8,0xb9a839a8,0x2e463bf6,0x3aa73872,0x3ba8b4a5
.long 0xbc008000,0xb8723aa7,0x361f3b64,0x3bd9323e,0xb9a8b9a8,0xbba834a5,0xb23e3bd9,0x3a2f3913
.long 0xbc00,0xbb64b61f,0xb9a839a8,0x361f3b64,0x39a8b9a8,0xb78bbb0e,0xbbd9323e,0xae463bf6
.long 0x3c000000,0x323ebbd9,0xbb64b61f,0xb8723aa7,0x39a839a8,0x3a2fb913,0xb872baa7,0xbb0e378b
.long 0x3c00,0x3c00,0x3c00,0x3c00,0xb61f3b64,0xb4a53ba8,0xb23e3bd9,0xae463bf6
.long 0xb9a839a8,0xb8723aa7,0xb61f3b64,0xb23e3bd9,0xbb64361f,0xba2f3913,0xb8723aa7,0xb4a53ba8
.long 0xbc008000,0xbb64361f,0xb9a839a8,0xb61f3b64,0xbb64b61f,0xbbf62e46,0xbaa73872,0xb78b3b0e
.long 0xb9a8b9a8,0xbbd9b23e,0xbb64361f,0xb8723aa7,0xb61fbb64,0xbb0eb78b,0xbbd9323e,0xb9133a2f
.long 0xbc00,0xb9a8b9a8,0xbc008000,0xb9a839a8,0x361fbb64,0xb78bbb0e,0xbbd9b23e,0xba2f3913
.long 0x39a8b9a8,0xb23ebbd9,0xbb64b61f,0xbaa73872,0x3b64b61f,0x2e46bbf6,0xbaa7b872,0xbb0e378b
.long 0x3c000000,0x361fbb64,0xb9a8b9a8,0xbb64361f,0x3b64361f,0x3913ba2f,0xb872baa7,0xbba834a5
.long 0x39a839a8,0x3aa7b872,0xb61fbb64,0xbbd9323e,0x361f3b64,0x3ba8b4a5,0xb23ebbd9,0xbbf62e46
.long 0x3c00,0x3c000000,0xbc00,0xbc008000,0x3c00,0x3bf6ae46,0xb23ebbd9,0xbba834a5
.long 0x3c00,0x3bd9b23e,0xb61fbb64,0xbaa73872,0x3c00,0x3ba8b4a5,0xb872baa7,0xb9133a2f
.long 0x3c00,0x3b64b61f,0xb9a8b9a8,0xb61f3b64,0x3c00,0x3b0eb78b,0xbaa7b872,0xae463bf6
.long 0x3c00,0x3aa7b872,0xbb64b61f,0x323e3bd9,0x3c00,0x3a2fb913,0xbbd9b23e,0x378b3b0e
.long 0x3c00,0x39a8b9a8,0xbc008000,0x39a839a8,0x3c00,0x3913ba2f,0xbbd9323e,0x3b0e378b
.long 0x3c00,0x3872baa7,0xbb64361f,0x3bd9323e,0x3c00,0x378bbb0e,0xbaa73872,0x3bf6ae46
.long 0x3c00,0x361fbb64,0xb9a839a8,0x3b64b61f,0x3c00,0x34a5bba8,0xb8723aa7,0x3a2fb913
.long 0x3c00,0x323ebbd9,0xb61f3b64,0x3872baa7,0x3c00,0x2e46bbf6,0xb23e3bd9,0x34a5bba8
.long 0x3c00,0x3c000000,0xbc00,0xbc008000,0x361f3b64,0x3b0eb78b,0xb872baa7,0xba2f3913
.long 0x39a839a8,0x3872baa7,0xbb64b61f,0xb23e3bd9,0x3b64361f,0x2e46bbf6,0xbbd9323e,0x378b3b0e
.long 0x3c000000,0xb61fbb64,0xb9a839a8,0x3b64361f,0x3b64b61f,0xba2fb913,0xb23e3bd9,0x3ba8b4a5
.long 0x39a8b9a8,0xbbd9b23e,0x361f3b64,0x3872baa7,0x361fbb64,0xbba834a5,0x3aa73872,0xae46bbf6
.long 0xbc00,0xb9a839a8,0x3c000000,0xb9a8b9a8,0xb61fbb64,0xb4a53ba8,0x3aa7b872,0xbbf6ae46
.long 0xb9a8b9a8,0x323e3bd9,0x361fbb64,0xbaa73872,0xbb64b61f,0x39133a2f,0xb23ebbd9,0xb4a53ba8
.long 0xbc008000,0x3b64361f,0xb9a8b9a8,0x361f3b64,0xbb64361f,0x3bf6ae46,0xbbd9b23e,0x3b0e378b
.long 0xb9a839a8,0x3aa7b872,0xbb64361f,0x3bd9b23e,0xb61f3b64,0x378bbb0e,0xb8723aa7,0x3913ba2f
.long 0x3c00,0x3c000000,0xbc00,0xbc008000,0x39a839a8,0x3913ba2f,0xbaa7b872,0xb78b3b0e
.long 0x3c000000,0xb23ebbd9,0xbb64361f,0x38723aa7,0x39a8b9a8,0xbb0eb78b,0xb23e3bd9,0x3bf6ae46
.long 0xbc00,0xbb64361f,0x39a839a8,0x361fbb64,0xb9a8b9a8,0xb4a53ba8,0x3bd9b23e,0xb913ba2f
.long 0xbc008000,0x38723aa7,0x361fbb64,0xbbd9323e,0xb9a839a8,0x3bf62e46,0xb872baa7,0xb4a53ba8
.long 0x3c00,0x39a8b9a8,0xbc008000,0x39a839a8,0x39a839a8,0xae46bbf6,0xb8723aa7,0x3ba8b4a5
.long 0x3c000000,0xbaa7b872,0x361f3b64,0x323ebbd9,0x39a8b9a8,0xbba834a5,0x3bd9323e,0xba2fb913
.long 0xbc00,0xb61f3b64,0x39a8b9a8,0xbb64361f,0xb9a8b9a8,0x378b3b0e,0xb23ebbd9,0xae463bf6
.long 0xbc008000,0x3bd9323e,0xbb64b61f,0x3aa73872,0xb9a839a8,0x3a2fb913,0xbaa73872,0x3b0eb78b
.long 0x3c00,0x3c000000,0xbc00,0xbc008000,0x3b64361f,0x34a5bba8,0xbbd9b23e,0xae463bf6
.long 0x39a8b9a8,0xbaa7b872,0xb61f3b64,0x3bd9323e,0xb61fbb64,0xba2f3913,0x3aa73872,0x34a5bba8
.long 0xbc008000,0x361f3b64,0x39a8b9a8,0xbb64b61f,0xb61f3b64,0x3bf6ae46,0xb872baa7,0xb78b3b0e
.long 0x39a839a8,0x323ebbd9,0xbb64361f,0x3aa73872,0x3b64b61f,0xbb0eb78b,0x323e3bd9,0x3913ba2f
.long 0xbc00,0xb9a839a8,0x3c000000,0xb9a8b9a8,0xbb64b61f,0x378b3b0e,0x323ebbd9,0xba2f3913
.long 0xb9a839a8,0x3bd9b23e,0xbb64b61f,0x38723aa7,0x361f3b64,0x2e46bbf6,0xb8723aa7,0x3b0eb78b
.long 0x3c000000,0xbb64b61f,0x39a839a8,0xb61fbb64,0x361fbb64,0xb9133a2f,0x3aa7b872,0xbba834a5
.long 0xb9a8b9a8,0x38723aa7,0xb61fbb64,0x323e3bd9,0xbb64361f,0x3ba8b4a5,0xbbd9323e,0x3bf6ae46
.long 0x3c00,0x3c000000,0xbc00,0xbc008000,0x3c000000,0xae46bbf6,0xbbd9323e,0x34a53ba8
.long 0xbc00,0xbbd9323e,0x361f3b64,0x3aa7b872,0xbc008000,0x34a53ba8,0x3aa7b872,0xba2fb913
.long 0x3c00,0x3b64b61f,0xb9a8b9a8,0xb61f3b64,0x3c000000,0xb78bbb0e,0xb8723aa7,0x3bf62e46
.long 0xbc00,0xbaa73872,0x3b64361f,0xb23ebbd9,0xbc008000,0x39133a2f,0x323ebbd9,0xbb0e378b
.long 0x3c00,0x39a8b9a8,0xbc008000,0x39a839a8,0x3c000000,0xba2fb913,0x323e3bd9,0x378bbb0e
.long 0xbc00,0xb8723aa7,0x3b64b61f,0xbbd9b23e,0xbc008000,0x3b0e378b,0xb872baa7,0x2e463bf6
.long 0x3c00,0x361fbb64,0xb9a839a8,0x3b64b61f,0x3c000000,0xbba8b4a5,0x3aa73872,0xb913ba2f
.long 0xbc00,0xb23e3bd9,0x361fbb64,0xb8723aa7,0xbc008000,0x3bf62e46,0xbbd9b23e,0x3ba834a5
.long 0x3c00,0x3c000000,0xbc00,0xbc008000,0x3b64b61f,0xb78bbb0e,0xbaa73872,0x39133a2f
.long 0xb9a8b9a8,0xb8723aa7,0x3b64361f,0x323ebbd9,0xb61f3b64,0x3bf62e46,0xb23ebbd9,0xbb0e378b
.long 0x3c000000,0xb61fbb64,0xb9a839a8,0x3b64361f,0xb61fbb64,0xb9133a2f,0x3bd9323e,0xb4a5bba8
.long 0xb9a839a8,0x3bd9323e,0xb61fbb64,0xb8723aa7,0x3b64361f,0xb4a5bba8,0xb8723aa7,0x3bf6ae46
.long 0xbc00,0xb9a839a8,0x3c000000,0xb9a8b9a8,0xbb64361f,0x3ba834a5,0xb872baa7,0xae463bf6
.long 0x39a839a8,0xb23ebbd9,0xb61f3b64,0x3aa7b872,0x361fbb64,0xba2f3913,0x3bd9b23e,0xbba8b4a5
.long 0xbc008000,0x3b64361f,0xb9a8b9a8,0x361f3b64,0x361f3b64,0xae46bbf6,0xb23e3bd9,0x378bbb0e
.long 0x39a8b9a8,0xbaa73872,0x3b64b61f,0xbbd9323e,0xbb64b61f,0x3b0e378b,0xbaa7b872,0x3a2f3913
.long 0x3c00,0x3c000000,0xbc00,0xbc008000,0x39a8b9a8,0xba2fb913,0xb8723aa7,0x3b0e378b
.long 0xbc008000,0x323e3bd9,0x3b64b61f,0xb872baa7,0x39a839a8,0x378bbb0e,0xbbd9b23e,0x2e463bf6
.long 0xbc00,0xbb64361f,0x39a839a8,0x361fbb64,0xb9a839a8,0x3ba834a5,0xb23ebbd9,0xba2f3913
.long 0x3c000000,0xb872baa7,0xb61f3b64,0x3bd9b23e,0xb9a8b9a8,0xae463bf6,0x3aa7b872,0xbba8b4a5
.long 0x3c00,0x39a8b9a8,0xbc008000,0x39a839a8,0x39a8b9a8,0xbbf62e46,0x3aa73872,0xb4a5bba8
.long 0xbc008000,0x3aa73872,0xb61fbb64,0xb23e3bd9,0x39a839a8,0xb4a5bba8,0xb23e3bd9,0x3913ba2f
.long 0xbc00,0xb61f3b64,0x39a8b9a8,0xbb64361f,0xb9a839a8,0x3b0eb78b,0xbbd9323e,0x3bf62e46
.long 0x3c000000,0xbbd9b23e,0x3b64361f,0xbaa7b872,0xb9a8b9a8,0x39133a2f,0xb872baa7,0x378b3b0e
.long 0x3c00,0x3c000000,0xbc00,0xbc008000,0x361fbb64,0xbba8b4a5,0xb23e3bd9,0x3bf62e46
.long 0xb9a839a8,0x3aa73872,0x361fbb64,0xbbd9b23e,0x3b64b61f,0xb913ba2f,0xb8723aa7,0x3ba834a5
.long 0xbc008000,0x361f3b64,0x39a8b9a8,0xbb64b61f,0x3b64361f,0xae46bbf6,0xbaa73872,0x3b0e378b
.long 0xb9a8b9a8,0xb23e3bd9,0x3b64b61f,0xbaa7b872,0x361f3b64,0x378bbb0e,0xbbd9323e,0x3a2f3913
.long 0xbc00,0xb9a839a8,0x3c000000,0xb9a8b9a8,0xb61f3b64,0x3b0eb78b,0xbbd9b23e,0x39133a2f
.long 0x39a8b9a8,0xbbd9323e,0x3b64361f,0xb872baa7,0xbb64361f,0x3bf62e46,0xbaa7b872,0x378b3b0e
.long 0x3c000000,0xbb64b61f,0x39a839a8,0xb61fbb64,0xbb64b61f,0x3a2f3913,0xb872baa7,0x34a53ba8
.long 0x39a839a8,0xb872baa7,0x361f3b64,0xb23ebbd9,0xb61fbb64,0x34a53ba8,0xb23ebbd9,0x2e463bf6
.long 0x3c00,0x3c000000,0xbc00,0xbc008000,0xbc00,0xbbf62e46,0x323e3bd9,0x3ba8b4a5
.long 0x3c00,0x3bd9b23e,0xb61fbb64,0xbaa73872,0xbc00,0xbba834a5,0x38723aa7,0x3913ba2f
.long 0x3c00,0x3b64b61f,0xb9a8b9a8,0xb61f3b64,0xbc00,0xbb0e378b,0x3aa73872,0x2e46bbf6
.long 0x3c00,0x3aa7b872,0xbb64b61f,0x323e3bd9,0xbc00,0xba2f3913,0x3bd9323e,0xb78bbb0e
.long 0x3c00,0x39a8b9a8,0xbc008000,0x39a839a8,0xbc00,0xb9133a2f,0x3bd9b23e,0xbb0eb78b
.long 0x3c00,0x3872baa7,0xbb64361f,0x3bd9323e,0xbc00,0xb78b3b0e,0x3aa7b872,0xbbf62e46
.long 0x3c00,0x361fbb64,0xb9a839a8,0x3b64b61f,0xbc00,0xb4a53ba8,0x3872baa7,0xba2f3913
.long 0x3c00,0x323ebbd9,0xb61f3b64,0x3872baa7,0xbc00,0xae463bf6,0x323ebbd9,0xb4a53ba8
.long 0x3c00,0x3c000000,0xbc00,0xbc008000,0xb61fbb64,0xbb0e378b,0x38723aa7,0x3a2fb913
.long 0x39a839a8,0x3872baa7,0xbb64b61f,0xb23e3bd9,0xbb64b61f,0xae463bf6,0x3bd9b23e,0xb78bbb0e
.long 0x3c000000,0xb61fbb64,0xb9a839a8,0x3b64361f,0xbb64361f,0x3a2f3913,0x323ebbd9,0xbba834a5
.long 0x39a8b9a8,0xbbd9b23e,0x361f3b64,0x3872baa7,0xb61f3b64,0x3ba8b4a5,0xbaa7b872,0x2e463bf6
.long 0xbc00,0xb9a839a8,0x3c000000,0xb9a8b9a8,0x361f3b64,0x34a5bba8,0xbaa73872,0x3bf62e46
.long 0xb9a8b9a8,0x323e3bd9,0x361fbb64,0xbaa73872,0x3b64361f,0xb913ba2f,0x323e3bd9,0x34a5bba8
.long 0xbc008000,0x3b64361f,0xb9a8b9a8,0x361f3b64,0x3b64b61f,0xbbf62e46,0x3bd9323e,0xbb0eb78b
.long 0xb9a839a8,0x3aa7b872,0xbb64361f,0x3bd9b23e,0x361fbb64,0xb78b3b0e,0x3872baa7,0xb9133a2f
.long 0x3c00,0x3c000000,0xbc00,0xbc008000,0xb9a8b9a8,0xb9133a2f,0x3aa73872,0x378bbb0e
.long 0x3c000000,0xb23ebbd9,0xbb64361f,0x38723aa7,0xb9a839a8,0x3b0e378b,0x323ebbd9,0xbbf62e46
.long 0xbc00,0xbb64361f,0x39a839a8,0x361fbb64,0x39a839a8,0x34a5bba8,0xbbd9323e,0x39133a2f
.long 0xbc008000,0x38723aa7,0x361fbb64,0xbbd9323e,0x39a8b9a8,0xbbf6ae46,0x38723aa7,0x34a5bba8
.long 0x3c00,0x39a8b9a8,0xbc008000,0x39a839a8,0xb9a8b9a8,0x2e463bf6,0x3872baa7,0xbba834a5
.long 0x3c000000,0xbaa7b872,0x361f3b64,0x323ebbd9,0xb9a839a8,0x3ba8b4a5,0xbbd9b23e,0x3a2f3913
.long 0xbc00,0xb61f3b64,0x39a8b9a8,0xbb64361f,0x39a839a8,0xb78bbb0e,0x323e3bd9,0x2e46bbf6
.long 0xbc008000,0x3bd9323e,0xbb64b61f,0x3aa73872,0x39a8b9a8,0xba2f3913,0x3aa7b872,0xbb0e378b
.long 0x3c00,0x3c000000,0xbc00,0xbc008000,0xbb64b61f,0xb4a53ba8,0x3bd9323e,0x2e46bbf6
.long 0x39a8b9a8,0xbaa7b872,0xb61f3b64,0x3bd9323e,0x361f3b64,0x3a2fb913,0xbaa7b872,0xb4a53ba8
.long 0xbc008000,0x361f3b64,0x39a8b9a8,0xbb64b61f,0x361fbb64,0xbbf62e46,0x38723aa7,0x378bbb0e
.long 0x39a839a8,0x323ebbd9,0xbb64361f,0x3aa73872,0xbb64361f,0x3b0e378b,0xb23ebbd9,0xb9133a2f
.long 0xbc00,0xb9a839a8,0x3c000000,0xb9a8b9a8,0x3b64361f,0xb78bbb0e,0xb23e3bd9,0x3a2fb913
.long 0xb9a839a8,0x3bd9b23e,0xbb64b61f,0x38723aa7,0xb61fbb64,0xae463bf6,0x3872baa7,0xbb0e378b
.long 0x3c000000,0xbb64b61f,0x39a839a8,0xb61fbb64,0xb61f3b64,0x3913ba2f,0xbaa73872,0x3ba8b4a5
.long 0xb9a8b9a8,0x38723aa7,0xb61fbb64,0x323e3bd9,0x3b64b61f,0xbba834a5,0x3bd9b23e,0xbbf62e46
.long 0x3c00,0x3c000000,0xbc00,0xbc008000,0xbc008000,0x2e463bf6,0x3bd9b23e,0xb4a5bba8
.long 0xbc00,0xbbd9323e,0x361f3b64,0x3aa7b872,0x3c000000,0xb4a5bba8,0xbaa73872,0x3a2f3913
.long 0x3c00,0x3b64b61f,0xb9a8b9a8,0xb61f3b64,0xbc008000,0x378b3b0e,0x3872baa7,0xbbf6ae46
.long 0xbc00,0xbaa73872,0x3b64361f,0xb23ebbd9,0x3c000000,0xb913ba2f,0xb23e3bd9,0x3b0eb78b
.long 0x3c00,0x39a8b9a8,0xbc008000,0x39a839a8,0xbc008000,0x3a2f3913,0xb23ebbd9,0xb78b3b0e
.long 0xbc00,0xb8723aa7,0x3b64b61f,0xbbd9b23e,0x3c000000,0xbb0eb78b,0x38723aa7,0xae46bbf6
.long 0x3c00,0x361fbb64,0xb9a839a8,0x3b64b61f,0xbc008000,0x3ba834a5,0xbaa7b872,0x39133a2f
.long 0xbc00,0xb23e3bd9,0x361fbb64,0xb8723aa7,0x3c000000,0xbbf6ae46,0x3bd9323e,0xbba8b4a5
.long 0x3c00,0x3c000000,0xbc00,0xbc008000,0xbb64361f,0x378b3b0e,0x3aa7b872,0xb913ba2f
.long 0xb9a8b9a8,0xb8723aa7,0x3b64361f,0x323ebbd9,0x361fbb64,0xbbf6ae46,0x323e3bd9,0x3b0eb78b
.long 0x3c000000,0xb61fbb64,0xb9a839a8,0x3b64361f,0x361f3b64,0x3913ba2f,0xbbd9b23e,0x34a53ba8
.long 0xb9a839a8,0x3bd9323e,0xb61fbb64,0xb8723aa7,0xbb64b61f,0x34a53ba8,0x3872baa7,0xbbf62e46
.long 0xbc00,0xb9a839a8,0x3c000000,0xb9a8b9a8,0x3b64b61f,0xbba8b4a5,0x38723aa7,0x2e46bbf6
.long 0x39a839a8,0xb23ebbd9,0xb61f3b64,0x3aa7b872,0xb61f3b64,0x3a2fb913,0xbbd9323e,0x3ba834a5
.long 0xbc008000,0x3b64361f,0xb9a8b9a8,0x361f3b64,0xb61fbb64,0x2e463bf6,0x323ebbd9,0xb78b3b0e
.long 0x39a8b9a8,0xbaa73872,0x3b64b61f,0xbbd9323e,0x3b64361f,0xbb0eb78b,0x3aa73872,0xba2fb913
.long 0x3c00,0x3c000000,0xbc00,0xbc008000,0xb9a839a8,0x3a2f3913,0x3872baa7,0xbb0eb78b
.long 0xbc008000,0x323e3bd9,0x3b64b61f,0xb872baa7,0xb9a8b9a8,0xb78b3b0e,0x3bd9323e,0xae46bbf6
.long 0xbc00,0xbb64361f,0x39a839a8,0x361fbb64,0x39a8b9a8,0xbba8b4a5,0x323e3bd9,0x3a2fb913
.long 0x3c000000,0xb872baa7,0xb61f3b64,0x3bd9b23e,0x39a839a8,0x2e46bbf6,0xbaa73872,0x3ba834a5
.long 0x3c00,0x39a8b9a8,0xbc008000,0x39a839a8,0xb9a839a8,0x3bf6ae46,0xbaa7b872,0x34a53ba8
.long 0xbc008000,0x3aa73872,0xb61fbb64,0xb23e3bd9,0xb9a8b9a8,0x34a53ba8,0x323ebbd9,0xb9133a2f
.long 0xbc00,0xb61f3b64,0x39a8b9a8,0xbb64361f,0x39a8b9a8,0xbb0e378b,0x3bd9b23e,0xbbf6ae46
.long 0x3c000000,0xbbd9b23e,0x3b64361f,0xbaa7b872,0x39a839a8,0xb913ba2f,0x38723aa7,0xb78bbb0e
.long 0x3c00,0x3c000000,0xbc00,0xbc008000,0xb61f3b64,0x3ba834a5,0x323ebbd9,0xbbf6ae46
.long 0xb9a839a8,0x3aa73872,0x361fbb64,0xbbd9b23e,0xbb64361f,0x39133a2f,0x3872baa7,0xbba8b4a5
.long 0xbc008000,0x361f3b64,0x39a8b9a8,0xbb64b61f,0xbb64b61f,0x2e463bf6,0x3aa7b872,0xbb0eb78b
.long 0xb9a8b9a8,0xb23e3bd9,0x3b64b61f,0xbaa7b872,0xb61fbb64,0xb78b3b0e,0x3bd9b23e,0xba2fb913
.long 0xbc00,0xb9a839a8,0x3c000000,0xb9a8b9a8,0x361fbb64,0xbb0e378b,0x3bd9323e,0xb913ba2f
.long 0x39a8b9a8,0xbbd9323e,0x3b64361f,0xb872baa7,0x3b64b61f,0xbbf6ae46,0x3aa73872,0xb78bbb0e
.long 0x3c000000,0xbb64b61f,0x39a839a8,0xb61fbb64,0x3b64361f,0xba2fb913,0x38723aa7,0xb4a5bba8
.long 0x39a839a8,0xb872baa7,0x361f3b64,0xb23ebbd9,0x361f3b64,0xb4a5bba8,0x323e3bd9,0xae46bbf6
.long 0x3c00,0xbc00,0x3c00,0xbc00,0x3c00,0xae46bbf6,0x323e3bd9,0xb4a5bba8
.long 0x3c00,0xb23ebbd9,0x361f3b64,0xb872baa7,0x3c00,0xb4a5bba8,0x38723aa7,0xba2fb913
.long 0x3c00,0xb61fbb64,0x39a839a8,0xbb64b61f,0x3c00,0xb78bbb0e,0x3aa73872,0xbbf6ae46
.long 0x3c00,0xb872baa7,0x3b64361f,0xbbd9323e,0x3c00,0xb913ba2f,0x3bd9323e,0xbb0e378b
.long 0x3c00,0xb9a8b9a8,0x3c000000,0xb9a839a8,0x3c00,0xba2fb913,0x3bd9b23e,0xb78b3b0e
.long 0x3c00,0xbaa7b872,0x3b64b61f,0xb23e3bd9,0x3c00,0xbb0eb78b,0x3aa7b872,0x2e463bf6
.long 0x3c00,0xbb64b61f,0x39a8b9a8,0x361f3b64,0x3c00,0xbba8b4a5,0x3872baa7,0x39133a2f
.long 0x3c00,0xbbd9b23e,0x361fbb64,0x3aa73872,0x3c00,0xbbf6ae46,0x323ebbd9,0x3ba834a5
.long 0x3c00,0xbc00,0x3c00,0xbc00,0x361f3b64,0xb78bbb0e,0x38723aa7,0xb913ba2f
.long 0x39a839a8,0xbaa7b872,0x3b64361f,0xbbd9b23e,0x3b64361f,0xbbf6ae46,0x3bd9b23e,0xbb0e378b
.long 0x3c000000,0xbb64361f,0x39a8b9a8,0xb61f3b64,0x3b64b61f,0xb9133a2f,0x323ebbd9,0x34a53ba8
.long 0x39a8b9a8,0xb23e3bd9,0xb61fbb64,0x3aa73872,0x361fbb64,0x34a53ba8,0xbaa7b872,0x3bf6ae46
.long 0xbc00,0x39a839a8,0xbc008000,0x39a8b9a8,0xb61fbb64,0x3ba834a5,0xbaa73872,0x2e46bbf6
.long 0xb9a8b9a8,0x3bd9b23e,0xb61f3b64,0xb872baa7,0xbb64b61f,0x3a2fb913,0x323e3bd9,0xbba8b4a5
.long 0xbc008000,0x361fbb64,0x39a839a8,0xbb64361f,0xbb64361f,0xae46bbf6,0x3bd9323e,0xb78b3b0e
.long 0xb9a839a8,0xb872baa7,0x3b64b61f,0x323e3bd9,0xb61f3b64,0xbb0eb78b,0x3872baa7,0x3a2f3913
.long 0x3c00,0xbc00,0x3c00,0xbc00,0x39a839a8,0xba2fb913,0x3aa73872,0xbb0eb78b
.long 0x3c000000,0xbbd9323e,0x3b64b61f,0xbaa73872,0x39a8b9a8,0xb78b3b0e,0x323ebbd9,0x2e463bf6
.long 0xbc00,0x361f3b64,0xb9a8b9a8,0x3b64361f,0xb9a8b9a8,0x3ba834a5,0xbbd9323e,0x3a2fb913
.long 0xbc008000,0x3aa7b872,0xb61f3b64,0xb23ebbd9,0xb9a839a8,0x2e46bbf6,0x38723aa7,0xbba8b4a5
.long 0x3c00,0xb9a8b9a8,0x3c000000,0xb9a839a8,0x39a839a8,0xbbf62e46,0x3872baa7,0x34a53ba8
.long 0x3c000000,0xb8723aa7,0xb61fbb64,0x3bd9323e,0x39a8b9a8,0x34a53ba8,0xbbd9b23e,0x3913ba2f
.long 0xbc00,0x3b64361f,0xb9a839a8,0xb61fbb64,0xb9a8b9a8,0x3b0eb78b,0x323e3bd9,0xbbf6ae46
.long 0xbc008000,0x323ebbd9,0x3b64361f,0xb8723aa7,0xb9a839a8,0xb913ba2f,0x3aa7b872,0x378b3b0e
.long 0x3c00,0xbc00,0x3c00,0xbc00,0x3b64361f,0xbba8b4a5,0x3bd9323e,0xbbf6ae46
.long 0x39a8b9a8,0xb8723aa7,0x361fbb64,0xb23e3bd9,0xb61fbb64,0x39133a2f,0xbaa7b872,0x3ba834a5
.long 0xbc008000,0x3b64b61f,0xb9a839a8,0x361fbb64,0xb61f3b64,0xae46bbf6,0x38723aa7,0xbb0eb78b
.long 0x39a839a8,0xbbd9b23e,0x3b64b61f,0xb8723aa7,0x3b64b61f,0xb78b3b0e,0xb23ebbd9,0x3a2f3913
.long 0xbc00,0x39a839a8,0xbc008000,0x39a8b9a8,0xbb64b61f,0x3b0eb78b,0xb23e3bd9,0xb913ba2f
.long 0xb9a839a8,0xb23ebbd9,0x3b64361f,0xbaa73872,0x361f3b64,0xbbf6ae46,0x3872baa7,0x378b3b0e
.long 0x3c000000,0xb61f3b64,0xb9a8b9a8,0x3b64b61f,0x361fbb64,0x3a2f3913,0xbaa73872,0xb4a5bba8
.long 0xb9a8b9a8,0x3aa7b872,0x361f3b64,0xbbd9323e,0xbb64361f,0xb4a5bba8,0x3bd9b23e,0x2e463bf6
.long 0x3c00,0xbc00,0x3c00,0xbc00,0x3c000000,0xbbf62e46,0x3bd9b23e,0xbba834a5
.long 0xbc00,0x323e3bd9,0xb61fbb64,0x38723aa7,0xbc008000,0x3ba8b4a5,0xbaa73872,0x3913ba2f
.long 0x3c00,0xb61fbb64,0x39a839a8,0xbb64b61f,0x3c000000,0xbb0e378b,0x3872baa7,0xae463bf6
.long 0xbc00,0x38723aa7,0xbb64b61f,0x3bd9b23e,0xbc008000,0x3a2fb913,0xb23e3bd9,0xb78bbb0e
.long 0x3c00,0xb9a8b9a8,0x3c000000,0xb9a839a8,0x3c000000,0xb9133a2f,0xb23ebbd9,0x3b0e378b
.long 0xbc00,0x3aa73872,0xbb64361f,0x323ebbd9,0xbc008000,0x378bbb0e,0x38723aa7,0xbbf62e46
.long 0x3c00,0xbb64b61f,0x39a8b9a8,0x361f3b64,0x3c000000,0xb4a53ba8,0xbaa7b872,0x3a2fb913
.long 0xbc00,0x3bd9323e,0xb61f3b64,0xbaa7b872,0xbc008000,0x2e46bbf6,0x3bd9323e,0xb4a53ba8
.long 0x3c00,0xbc00,0x3c00,0xbc00,0x3b64b61f,0xbb0e378b,0x3aa7b872,0xba2f3913
.long 0xb9a8b9a8,0x3aa73872,0xbb64b61f,0x3bd9323e,0xb61f3b64,0x2e46bbf6,0x323e3bd9,0xb78bbb0e
.long 0x3c000000,0xbb64361f,0x39a8b9a8,0xb61f3b64,0xb61fbb64,0x3a2f3913,0xbbd9b23e,0x3ba8b4a5
.long 0xb9a839a8,0x323ebbd9,0x361f3b64,0xbaa7b872,0x3b64361f,0xbba834a5,0x3872baa7,0x2e463bf6
.long 0xbc00,0x39a839a8,0xbc008000,0x39a8b9a8,0xbb64361f,0x34a5bba8,0x38723aa7,0xbbf6ae46
.long 0x39a839a8,0xbbd9323e,0x361fbb64,0x38723aa7,0x361fbb64,0x39133a2f,0xbbd9323e,0x34a5bba8
.long 0xbc008000,0x361fbb64,0x39a839a8,0xbb64361f,0x361f3b64,0xbbf62e46,0x323ebbd9,0x3b0e378b
.long 0x39a8b9a8,0x38723aa7,0xbb64361f,0xb23ebbd9,0xbb64b61f,0x378bbb0e,0x3aa73872,0xb9133a2f
.long 0x3c00,0xbc00,0x3c00,0xbc00,0x39a8b9a8,0xb9133a2f,0x3872baa7,0xb78b3b0e
.long 0xbc008000,0x3bd9b23e,0xbb64361f,0x3aa7b872,0x39a839a8,0xbb0eb78b,0x3bd9323e,0xbbf62e46
.long 0xbc00,0x361f3b64,0xb9a8b9a8,0x3b64361f,0xb9a839a8,0x34a5bba8,0x323e3bd9,0xb913ba2f
.long 0x3c000000,0xbaa73872,0x361fbb64,0x323e3bd9,0xb9a8b9a8,0x3bf62e46,0xbaa73872,0x34a5bba8
.long 0x3c00,0xb9a8b9a8,0x3c000000,0xb9a839a8,0x39a8b9a8,0x2e463bf6,0xbaa7b872,0x3ba8b4a5
.long 0xbc008000,0x3872baa7,0x361f3b64,0xbbd9b23e,0x39a839a8,0xbba834a5,0x323ebbd9,0x3a2f3913
.long 0xbc00,0x3b64361f,0xb9a839a8,0xb61fbb64,0xb9a839a8,0xb78bbb0e,0x3bd9b23e,0xae463bf6
.long 0x3c000000,0xb23e3bd9,0xbb64b61f,0x3872baa7,0xb9a8b9a8,0x3a2fb913,0x38723aa7,0xbb0e378b
.long 0x3c00,0xbc00,0x3c00,0xbc00,0x361fbb64,0xb4a53ba8,0x323ebbd9,0xae463bf6
.long 0xb9a839a8,0x3872baa7,0xb61f3b64,0x323ebbd9,0x3b64b61f,0xba2f3913,0x3872baa7,0xb4a53ba8
.long 0xbc008000,0x3b64b61f,0xb9a839a8,0x361fbb64,0x3b64361f,0xbbf62e46,0x3aa7b872,0xb78b3b0e
.long 0xb9a8b9a8,0x3bd9323e,0xbb64361f,0x3872baa7,0x361f3b64,0xbb0eb78b,0x3bd9b23e,0xb9133a2f
.long 0xbc00,0x39a839a8,0xbc008000,0x39a8b9a8,0xb61f3b64,0xb78bbb0e,0x3bd9323e,0xba2f3913
.long 0x39a8b9a8,0x323e3bd9,0xbb64b61f,0x3aa7b872,0xbb64361f,0x2e46bbf6,0x3aa73872,0xbb0e378b
.long 0x3c000000,0xb61f3b64,0xb9a8b9a8,0x3b64b61f,0xbb64b61f,0x3913ba2f,0x38723aa7,0xbba834a5
.long 0x39a839a8,0xbaa73872,0xb61fbb64,0x3bd9b23e,0xb61fbb64,0x3ba8b4a5,0x323e3bd9,0xbbf62e46
.long 0x3c00,0xbc00,0x3c00,0xbc00,0xbc00,0x2e463bf6,0xb23ebbd9,0x34a53ba8
.long 0x3c00,0xb23ebbd9,0x361f3b64,0xb872baa7,0xbc00,0x34a53ba8,0xb872baa7,0x3a2f3913
.long 0x3c00,0xb61fbb64,0x39a839a8,0xbb64b61f,0xbc00,0x378b3b0e,0xbaa7b872,0x3bf62e46
.long 0x3c00,0xb872baa7,0x3b64361f,0xbbd9323e,0xbc00,0x39133a2f,0xbbd9b23e,0x3b0eb78b
.long 0x3c00,0xb9a8b9a8,0x3c000000,0xb9a839a8,0xbc00,0x3a2f3913,0xbbd9323e,0x378bbb0e
.long 0x3c00,0xbaa7b872,0x3b64b61f,0xb23e3bd9,0xbc00,0x3b0e378b,0xbaa73872,0xae46bbf6
.long 0x3c00,0xbb64b61f,0x39a8b9a8,0x361f3b64,0xbc00,0x3ba834a5,0xb8723aa7,0xb913ba2f
.long 0x3c00,0xbbd9b23e,0x361fbb64,0x3aa73872,0xbc00,0x3bf62e46,0xb23e3bd9,0xbba8b4a5
.long 0x3c00,0xbc00,0x3c00,0xbc00,0xb61fbb64,0x378b3b0e,0xb872baa7,0x39133a2f
.long 0x39a839a8,0xbaa7b872,0x3b64361f,0xbbd9b23e,0xbb64b61f,0x3bf62e46,0xbbd9323e,0x3b0eb78b
.long 0x3c000000,0xbb64361f,0x39a8b9a8,0xb61f3b64,0xbb64361f,0x3913ba2f,0xb23e3bd9,0xb4a5bba8
.long 0x39a8b9a8,0xb23e3bd9,0xb61fbb64,0x3aa73872,0xb61f3b64,0xb4a5bba8,0x3aa73872,0xbbf62e46
.long 0xbc00,0x39a839a8,0xbc008000,0x39a8b9a8,0x361f3b64,0xbba8b4a5,0x3aa7b872,0xae463bf6
.long 0xb9a8b9a8,0x3bd9b23e,0xb61f3b64,0xb872baa7,0x3b64361f,0xba2f3913,0xb23ebbd9,0x3ba834a5
.long 0xbc008000,0x361fbb64,0x39a839a8,0xbb64361f,0x3b64b61f,0x2e463bf6,0xbbd9b23e,0x378bbb0e
.long 0xb9a839a8,0xb872baa7,0x3b64b61f,0x323e3bd9,0x361fbb64,0x3b0e378b,0xb8723aa7,0xba2fb913
.long 0x3c00,0xbc00,0x3c00,0xbc00,0xb9a8b9a8,0x3a2f3913,0xbaa7b872,0x3b0e378b
.long 0x3c000000,0xbbd9323e,0x3b64b61f,0xbaa73872,0xb9a839a8,0x378bbb0e,0xb23e3bd9,0xae46bbf6
.long 0xbc00,0x361f3b64,0xb9a8b9a8,0x3b64361f,0x39a839a8,0xbba8b4a5,0x3bd9b23e,0xba2f3913
.long 0xbc008000,0x3aa7b872,0xb61f3b64,0xb23ebbd9,0x39a8b9a8,0xae463bf6,0xb872baa7,0x3ba834a5
.long 0x3c00,0xb9a8b9a8,0x3c000000,0xb9a839a8,0xb9a8b9a8,0x3bf6ae46,0xb8723aa7,0xb4a5bba8
.long 0x3c000000,0xb8723aa7,0xb61fbb64,0x3bd9323e,0xb9a839a8,0xb4a5bba8,0x3bd9323e,0xb9133a2f
.long 0xbc00,0x3b64361f,0xb9a839a8,0xb61fbb64,0x39a839a8,0xbb0e378b,0xb23ebbd9,0x3bf62e46
.long 0xbc008000,0x323ebbd9,0x3b64361f,0xb8723aa7,0x39a8b9a8,0x39133a2f,0xbaa73872,0xb78bbb0e
.long 0x3c00,0xbc00,0x3c00,0xbc00,0xbb64b61f,0x3ba834a5,0xbbd9b23e,0x3bf62e46
.long 0x39a8b9a8,0xb8723aa7,0x361fbb64,0xb23e3bd9,0x361f3b64,0xb913ba2f,0x3aa73872,0xbba8b4a5
.long 0xbc008000,0x3b64b61f,0xb9a839a8,0x361fbb64,0x361fbb64,0x2e463bf6,0xb872baa7,0x3b0e378b
.long 0x39a839a8,0xbbd9b23e,0x3b64b61f,0xb8723aa7,0xbb64361f,0x378bbb0e,0x323e3bd9,0xba2fb913
.long 0xbc00,0x39a839a8,0xbc008000,0x39a8b9a8,0x3b64361f,0xbb0e378b,0x323ebbd9,0x39133a2f
.long 0xb9a839a8,0xb23ebbd9,0x3b64361f,0xbaa73872,0xb61fbb64,0x3bf62e46,0xb8723aa7,0xb78bbb0e
.long 0x3c000000,0xb61f3b64,0xb9a8b9a8,0x3b64b61f,0xb61f3b64,0xba2fb913,0x3aa7b872,0x34a53ba8
.long 0xb9a8b9a8,0x3aa7b872,0x361f3b64,0xbbd9323e,0x3b64b61f,0x34a53ba8,0xbbd9323e,0xae46bbf6
.long 0x3c00,0xbc00,0x3c00,0xbc00,0xbc008000,0x3bf6ae46,0xbbd9323e,0x3ba8b4a5
.long 0xbc00,0x323e3bd9,0xb61fbb64,0x38723aa7,0x3c000000,0xbba834a5,0x3aa7b872,0xb9133a2f
.long 0x3c00,0xb61fbb64,0x39a839a8,0xbb64b61f,0xbc008000,0x3b0eb78b,0xb8723aa7,0x2e46bbf6
.long 0xbc00,0x38723aa7,0xbb64b61f,0x3bd9b23e,0x3c000000,0xba2f3913,0x323ebbd9,0x378b3b0e
.long 0x3c00,0xb9a8b9a8,0x3c000000,0xb9a839a8,0xbc008000,0x3913ba2f,0x323e3bd9,0xbb0eb78b
.long 0xbc00,0x3aa73872,0xbb64361f,0x323ebbd9,0x3c000000,0xb78b3b0e,0xb872baa7,0x3bf6ae46
.long 0x3c00,0xbb64b61f,0x39a8b9a8,0x361f3b64,0xbc008000,0x34a5bba8,0x3aa73872,0xba2f3913
.long 0xbc00,0x3bd9323e,0xb61f3b64,0xbaa7b872,0x3c000000,0xae463bf6,0xbbd9b23e,0x34a5bba8
.long 0x3c00,0xbc00,0x3c00,0xbc00,0xbb64361f,0x3b0eb78b,0xbaa73872,0x3a2fb913
.long 0xb9a8b9a8,0x3aa73872,0xbb64b61f,0x3bd9323e,0x361fbb64,0xae463bf6,0xb23ebbd9,0x378b3b0e
.long 0x3c000000,0xbb64361f,0x39a8b9a8,0xb61f3b64,0x361f3b64,0xba2fb913,0x3bd9323e,0xbba834a5
.long 0xb9a839a8,0x323ebbd9,0x361f3b64,0xbaa7b872,0xbb64b61f,0x3ba8b4a5,0xb8723aa7,0xae46bbf6
.long 0xbc00,0x39a839a8,0xbc008000,0x39a8b9a8,0x3b64b61f,0xb4a53ba8,0xb872baa7,0x3bf62e46
.long 0x39a839a8,0xbbd9323e,0x361fbb64,0x38723aa7,0xb61f3b64,0xb913ba2f,0x3bd9b23e,0xb4a53ba8
.long 0xbc008000,0x361fbb64,0x39a839a8,0xbb64361f,0xb61fbb64,0x3bf6ae46,0xb23e3bd9,0xbb0eb78b
.long 0x39a8b9a8,0x38723aa7,0xbb64361f,0xb23ebbd9,0x3b64361f,0xb78b3b0e,0xbaa7b872,0x3913ba2f
.long 0x3c00,0xbc00,0x3c00,0xbc00,0xb9a839a8,0x3913ba2f,0xb8723aa7,0x378bbb0e
.long 0xbc008000,0x3bd9b23e,0xbb64361f,0x3aa7b872,0xb9a8b9a8,0x3b0e378b,0xbbd9b23e,0x3bf6ae46
.long 0xbc00,0x361f3b64,0xb9a8b9a8,0x3b64361f,0x39a8b9a8,0xb4a53ba8,0xb23ebbd9,0x39133a2f
.long 0x3c000000,0xbaa73872,0x361fbb64,0x323e3bd9,0x39a839a8,0xbbf6ae46,0x3aa7b872,0xb4a53ba8
.long 0x3c00,0xb9a8b9a8,0x3c000000,0xb9a839a8,0xb9a839a8,0xae46bbf6,0x3aa73872,0xbba834a5
.long 0xbc008000,0x3872baa7,0x361f3b64,0xbbd9b23e,0xb9a8b9a8,0x3ba8b4a5,0xb23e3bd9,0xba2fb913
.long 0xbc00,0x3b64361f,0xb9a839a8,0xb61fbb64,0x39a8b9a8,0x378b3b0e,0xbbd9323e,0x2e46bbf6
.long 0x3c000000,0xb23e3bd9,0xbb64b61f,0x3872baa7,0x39a839a8,0xba2f3913,0xb872baa7,0x3b0eb78b
.long 0x3c00,0xbc00,0x3c00,0xbc00,0xb61f3b64,0x34a5bba8,0xb23e3bd9,0x2e46bbf6
.long 0xb9a839a8,0x3872baa7,0xb61f3b64,0x323ebbd9,0xbb64361f,0x3a2fb913,0xb8723aa7,0x34a5bba8
.long 0xbc008000,0x3b64b61f,0xb9a839a8,0x361fbb64,0xbb64b61f,0x3bf6ae46,0xbaa73872,0x378bbb0e
.long 0xb9a8b9a8,0x3bd9323e,0xbb64361f,0x3872baa7,0xb61fbb64,0x3b0e378b,0xbbd9323e,0x3913ba2f
.long 0xbc00,0x39a839a8,0xbc008000,0x39a8b9a8,0x361fbb64,0x378b3b0e,0xbbd9b23e,0x3a2fb913
.long 0x39a8b9a8,0x323e3bd9,0xbb64b61f,0x3aa7b872,0x3b64b61f,0xae463bf6,0xbaa7b872,0x3b0eb78b
.long 0x3c000000,0xb61f3b64,0xb9a8b9a8,0x3b64b61f,0x3b64361f,0xb9133a2f,0xb872baa7,0x3ba8b4a5
.long 0x39a839a8,0xbaa73872,0xb61fbb64,0x3bd9b23e,0x361f3b64,0xbba834a5,0xb23ebbd9,0x3bf6ae46
.long 0x3c00,0xbc008000,0xbc00,0x3c000000,0x3c00,0xbbf62e46,0xb23ebbd9,0x3ba8b4a5
.long 0x3c00,0xbbd9323e,0xb61fbb64,0x3aa7b872,0x3c00,0xbba834a5,0xb872baa7,0x3913ba2f
.long 0x3c00,0xbb64361f,0xb9a8b9a8,0x361fbb64,0x3c00,0xbb0e378b,0xbaa7b872,0x2e46bbf6
.long 0x3c00,0xbaa73872,0xbb64b61f,0xb23ebbd9,0x3c00,0xba2f3913,0xbbd9b23e,0xb78bbb0e
.long 0x3c00,0xb9a839a8,0xbc008000,0xb9a8b9a8,0x3c00,0xb9133a2f,0xbbd9323e,0xbb0eb78b
.long 0x3c00,0xb8723aa7,0xbb64361f,0xbbd9b23e,0x3c00,0xb78b3b0e,0xbaa73872,0xbbf62e46
.long 0x3c00,0xb61f3b64,0xb9a839a8,0xbb64361f,0x3c00,0xb4a53ba8,0xb8723aa7,0xba2f3913
.long 0x3c00,0xb23e3bd9,0xb61f3b64,0xb8723aa7,0x3c00,0xae463bf6,0xb23e3bd9,0xb4a53ba8
.long 0x3c00,0xbc008000,0xbc00,0x3c000000,0x361f3b64,0xbb0e378b,0xb872baa7,0x3a2fb913
.long 0x39a839a8,0xb8723aa7,0xbb64b61f,0x323ebbd9,0x3b64361f,0xae463bf6,0xbbd9323e,0xb78bbb0e
.long 0x3c000000,0x361f3b64,0xb9a839a8,0xbb64b61f,0x3b64b61f,0x3a2f3913,0xb23e3bd9,0xbba834a5
.long 0x39a8b9a8,0x3bd9323e,0x361f3b64,0xb8723aa7,0x361fbb64,0x3ba8b4a5,0x3aa73872,0x2e463bf6
.long 0xbc00,0x39a8b9a8,0x3c000000,0x39a839a8,0xb61fbb64,0x34a5bba8,0x3aa7b872,0x3bf62e46
.long 0xb9a8b9a8,0xb23ebbd9,0x361fbb64,0x3aa7b872,0xbb64b61f,0xb913ba2f,0xb23ebbd9,0x34a5bba8
.long 0xbc008000,0xbb64b61f,0xb9a8b9a8,0xb61fbb64,0xbb64361f,0xbbf62e46,0xbbd9b23e,0xbb0eb78b
.long 0xb9a839a8,0xbaa73872,0xbb64361f,0xbbd9323e,0xb61f3b64,0xb78b3b0e,0xb8723aa7,0xb9133a2f
.long 0x3c00,0xbc008000,0xbc00,0x3c000000,0x39a839a8,0xb9133a2f,0xbaa7b872,0x378bbb0e
.long 0x3c000000,0x323e3bd9,0xbb64361f,0xb872baa7,0x39a8b9a8,0x3b0e378b,0xb23e3bd9,0xbbf62e46
.long 0xbc00,0x3b64b61f,0x39a839a8,0xb61f3b64,0xb9a8b9a8,0x34a5bba8,0x3bd9b23e,0x39133a2f
.long 0xbc008000,0xb872baa7,0x361fbb64,0x3bd9b23e,0xb9a839a8,0xbbf6ae46,0xb872baa7,0x34a5bba8
.long 0x3c00,0xb9a839a8,0xbc008000,0xb9a8b9a8,0x39a839a8,0x2e463bf6,0xb8723aa7,0xbba834a5
.long 0x3c000000,0x3aa73872,0x361f3b64,0xb23e3bd9,0x39a8b9a8,0x3ba8b4a5,0x3bd9323e,0x3a2f3913
.long 0xbc00,0x361fbb64,0x39a8b9a8,0x3b64b61f,0xb9a8b9a8,0xb78bbb0e,0xb23ebbd9,0x2e46bbf6
.long 0xbc008000,0xbbd9b23e,0xbb64b61f,0xbaa7b872,0xb9a839a8,0xba2f3913,0xbaa73872,0xbb0e378b
.long 0x3c00,0xbc008000,0xbc00,0x3c000000,0x3b64361f,0xb4a53ba8,0xbbd9b23e,0x2e46bbf6
.long 0x39a8b9a8,0x3aa73872,0xb61f3b64,0xbbd9b23e,0xb61fbb64,0x3a2fb913,0x3aa73872,0xb4a53ba8
.long 0xbc008000,0xb61fbb64,0x39a8b9a8,0x3b64361f,0xb61f3b64,0xbbf62e46,0xb872baa7,0x378bbb0e
.long 0x39a839a8,0xb23e3bd9,0xbb64361f,0xbaa7b872,0x3b64b61f,0x3b0e378b,0x323e3bd9,0xb9133a2f
.long 0xbc00,0x39a8b9a8,0x3c000000,0x39a839a8,0xbb64b61f,0xb78bbb0e,0x323ebbd9,0x3a2fb913
.long 0xb9a839a8,0xbbd9323e,0xbb64b61f,0xb872baa7,0x361f3b64,0xae463bf6,0xb8723aa7,0xbb0e378b
.long 0x3c000000,0x3b64361f,0x39a839a8,0x361f3b64,0x361fbb64,0x3913ba2f,0x3aa7b872,0x3ba8b4a5
.long 0xb9a8b9a8,0xb872baa7,0xb61fbb64,0xb23ebbd9,0xbb64361f,0xbba834a5,0xbbd9323e,0xbbf62e46
.long 0x3c00,0xbc008000,0xbc00,0x3c000000,0x3c000000,0x2e463bf6,0xbbd9323e,0xb4a5bba8
.long 0xbc00,0x3bd9b23e,0x361f3b64,0xbaa73872,0xbc008000,0xb4a5bba8,0x3aa7b872,0x3a2f3913
.long 0x3c00,0xbb64361f,0xb9a8b9a8,0x361fbb64,0x3c000000,0x378b3b0e,0xb8723aa7,0xbbf6ae46
.long 0xbc00,0x3aa7b872,0x3b64361f,0x323e3bd9,0xbc008000,0xb913ba2f,0x323ebbd9,0x3b0eb78b
.long 0x3c00,0xb9a839a8,0xbc008000,0xb9a8b9a8,0x3c000000,0x3a2f3913,0x323e3bd9,0xb78b3b0e
.long 0xbc00,0x3872baa7,0x3b64b61f,0x3bd9323e,0xbc008000,0xbb0eb78b,0xb872baa7,0xae46bbf6
.long 0x3c00,0xb61f3b64,0xb9a839a8,0xbb64361f,0x3c000000,0x3ba834a5,0x3aa73872,0x39133a2f
.long 0xbc00,0x323ebbd9,0x361fbb64,0x3872baa7,0xbc008000,0xbbf6ae46,0xbbd9b23e,0xbba8b4a5
.long 0x3c00,0xbc008000,0xbc00,0x3c000000,0x3b64b61f,0x378b3b0e,0xbaa73872,0xb913ba2f
.long 0xb9a8b9a8,0x3872baa7,0x3b64361f,0xb23e3bd9,0xb61f3b64,0xbbf6ae46,0xb23ebbd9,0x3b0eb78b
.long 0x3c000000,0x361f3b64,0xb9a839a8,0xbb64b61f,0xb61fbb64,0x3913ba2f,0x3bd9323e,0x34a53ba8
.long 0xb9a839a8,0xbbd9b23e,0xb61fbb64,0x3872baa7,0x3b64361f,0x34a53ba8,0xb8723aa7,0xbbf62e46
.long 0xbc00,0x39a8b9a8,0x3c000000,0x39a839a8,0xbb64361f,0xbba8b4a5,0xb872baa7,0x2e46bbf6
.long 0x39a839a8,0x323e3bd9,0xb61f3b64,0xbaa73872,0x361fbb64,0x3a2fb913,0x3bd9b23e,0x3ba834a5
.long 0xbc008000,0xbb64b61f,0xb9a8b9a8,0xb61fbb64,0x361f3b64,0x2e463bf6,0xb23e3bd9,0xb78b3b0e
.long 0x39a8b9a8,0x3aa7b872,0x3b64b61f,0x3bd9b23e,0xbb64b61f,0xbb0eb78b,0xbaa7b872,0xba2fb913
.long 0x3c00,0xbc008000,0xbc00,0x3c000000,0x39a8b9a8,0x3a2f3913,0xb8723aa7,0xbb0eb78b
.long 0xbc008000,0xb23ebbd9,0x3b64b61f,0x38723aa7,0x39a839a8,0xb78b3b0e,0xbbd9b23e,0xae46bbf6
.long 0xbc00,0x3b64b61f,0x39a839a8,0xb61f3b64,0xb9a839a8,0xbba8b4a5,0xb23ebbd9,0x3a2fb913
.long 0x3c000000,0x38723aa7,0xb61f3b64,0xbbd9323e,0xb9a8b9a8,0x2e46bbf6,0x3aa7b872,0x3ba834a5
.long 0x3c00,0xb9a839a8,0xbc008000,0xb9a8b9a8,0x39a8b9a8,0x3bf6ae46,0x3aa73872,0x34a53ba8
.long 0xbc008000,0xbaa7b872,0xb61fbb64,0x323ebbd9,0x39a839a8,0x34a53ba8,0xb23e3bd9,0xb9133a2f
.long 0xbc00,0x361fbb64,0x39a8b9a8,0x3b64b61f,0xb9a839a8,0xbb0e378b,0xbbd9323e,0xbbf6ae46
.long 0x3c000000,0x3bd9323e,0x3b64361f,0x3aa73872,0xb9a8b9a8,0xb913ba2f,0xb872baa7,0xb78bbb0e
.long 0x3c00,0xbc008000,0xbc00,0x3c000000,0x361fbb64,0x3ba834a5,0xb23e3bd9,0xbbf6ae46
.long 0xb9a839a8,0xbaa7b872,0x361fbb64,0x3bd9323e,0x3b64b61f,0x39133a2f,0xb8723aa7,0xbba8b4a5
.long 0xbc008000,0xb61fbb64,0x39a8b9a8,0x3b64361f,0x3b64361f,0x2e463bf6,0xbaa73872,0xbb0eb78b
.long 0xb9a8b9a8,0x323ebbd9,0x3b64b61f,0x3aa73872,0x361f3b64,0xb78b3b0e,0xbbd9323e,0xba2fb913
.long 0xbc00,0x39a8b9a8,0x3c000000,0x39a839a8,0xb61f3b64,0xbb0e378b,0xbbd9b23e,0xb913ba2f
.long 0x39a8b9a8,0x3bd9b23e,0x3b64361f,0x38723aa7,0xbb64361f,0xbbf6ae46,0xbaa7b872,0xb78bbb0e
.long 0x3c000000,0x3b64361f,0x39a839a8,0x361f3b64,0xbb64b61f,0xba2fb913,0xb872baa7,0xb4a5bba8
.long 0x39a839a8,0x38723aa7,0x361f3b64,0x323e3bd9,0xb61fbb64,0xb4a5bba8,0xb23ebbd9,0xae46bbf6
.long 0x3c00,0xbc008000,0xbc00,0x3c000000,0xbc00,0x3bf6ae46,0x323e3bd9,0xbba834a5
.long 0x3c00,0xbbd9323e,0xb61fbb64,0x3aa7b872,0xbc00,0x3ba8b4a5,0x38723aa7,0xb9133a2f
.long 0x3c00,0xbb64361f,0xb9a8b9a8,0x361fbb64,0xbc00,0x3b0eb78b,0x3aa73872,0xae463bf6
.long 0x3c00,0xbaa73872,0xbb64b61f,0xb23ebbd9,0xbc00,0x3a2fb913,0x3bd9323e,0x378b3b0e
.long 0x3c00,0xb9a839a8,0xbc008000,0xb9a8b9a8,0xbc00,0x3913ba2f,0x3bd9b23e,0x3b0e378b
.long 0x3c00,0xb8723aa7,0xbb64361f,0xbbd9b23e,0xbc00,0x378bbb0e,0x3aa7b872,0x3bf6ae46
.long 0x3c00,0xb61f3b64,0xb9a839a8,0xbb64361f,0xbc00,0x34a5bba8,0x3872baa7,0x3a2fb913
.long 0x3c00,0xb23e3bd9,0xb61f3b64,0xb8723aa7,0xbc00,0x2e46bbf6,0x323ebbd9,0x34a5bba8
.long 0x3c00,0xbc008000,0xbc00,0x3c000000,0xb61fbb64,0x3b0eb78b,0x38723aa7,0xba2f3913
.long 0x39a839a8,0xb8723aa7,0xbb64b61f,0x323ebbd9,0xbb64b61f,0x2e46bbf6,0x3bd9b23e,0x378b3b0e
.long 0x3c000000,0x361f3b64,0xb9a839a8,0xbb64b61f,0xbb64361f,0xba2fb913,0x323ebbd9,0x3ba8b4a5
.long 0x39a8b9a8,0x3bd9323e,0x361f3b64,0xb8723aa7,0xb61f3b64,0xbba834a5,0xbaa7b872,0xae46bbf6
.long 0xbc00,0x39a8b9a8,0x3c000000,0x39a839a8,0x361f3b64,0xb4a53ba8,0xbaa73872,0xbbf6ae46
.long 0xb9a8b9a8,0xb23ebbd9,0x361fbb64,0x3aa7b872,0x3b64361f,0x39133a2f,0x323e3bd9,0xb4a53ba8
.long 0xbc008000,0xbb64b61f,0xb9a8b9a8,0xb61fbb64,0x3b64b61f,0x3bf6ae46,0x3bd9323e,0x3b0e378b
.long 0xb9a839a8,0xbaa73872,0xbb64361f,0xbbd9323e,0x361fbb64,0x378bbb0e,0x3872baa7,0x3913ba2f
.long 0x3c00,0xbc008000,0xbc00,0x3c000000,0xb9a8b9a8,0x3913ba2f,0x3aa73872,0xb78b3b0e
.long 0x3c000000,0x323e3bd9,0xbb64361f,0xb872baa7,0xb9a839a8,0xbb0eb78b,0x323ebbd9,0x3bf6ae46
.long 0xbc00,0x3b64b61f,0x39a839a8,0xb61f3b64,0x39a839a8,0xb4a53ba8,0xbbd9323e,0xb913ba2f
.long 0xbc008000,0xb872baa7,0x361fbb64,0x3bd9b23e,0x39a8b9a8,0x3bf62e46,0x38723aa7,0xb4a53ba8
.long 0x3c00,0xb9a839a8,0xbc008000,0xb9a8b9a8,0xb9a8b9a8,0xae46bbf6,0x3872baa7,0x3ba8b4a5
.long 0x3c000000,0x3aa73872,0x361f3b64,0xb23e3bd9,0xb9a839a8,0xbba834a5,0xbbd9b23e,0xba2fb913
.long 0xbc00,0x361fbb64,0x39a8b9a8,0x3b64b61f,0x39a839a8,0x378b3b0e,0x323e3bd9,0xae463bf6
.long 0xbc008000,0xbbd9b23e,0xbb64b61f,0xbaa7b872,0x39a8b9a8,0x3a2fb913,0x3aa7b872,0x3b0eb78b
.long 0x3c00,0xbc008000,0xbc00,0x3c000000,0xbb64b61f,0x34a5bba8,0x3bd9323e,0xae463bf6
.long 0x39a8b9a8,0x3aa73872,0xb61f3b64,0xbbd9b23e,0x361f3b64,0xba2f3913,0xbaa7b872,0x34a5bba8
.long 0xbc008000,0xb61fbb64,0x39a8b9a8,0x3b64361f,0x361fbb64,0x3bf6ae46,0x38723aa7,0xb78b3b0e
.long 0x39a839a8,0xb23e3bd9,0xbb64361f,0xbaa7b872,0xbb64361f,0xbb0eb78b,0xb23ebbd9,0x3913ba2f
.long 0xbc00,0x39a8b9a8,0x3c000000,0x39a839a8,0x3b64361f,0x378b3b0e,0xb23e3bd9,0xba2f3913
.long 0xb9a839a8,0xbbd9323e,0xbb64b61f,0xb872baa7,0xb61fbb64,0x2e46bbf6,0x3872baa7,0x3b0eb78b
.long 0x3c000000,0x3b64361f,0x39a839a8,0x361f3b64,0xb61f3b64,0xb9133a2f,0xbaa73872,0xbba834a5
.long 0xb9a8b9a8,0xb872baa7,0xb61fbb64,0xb23ebbd9,0x3b64b61f,0x3ba8b4a5,0x3bd9b23e,0x3bf6ae46
.long 0x3c00,0xbc008000,0xbc00,0x3c000000,0xbc008000,0xae46bbf6,0x3bd9b23e,0x34a53ba8
.long 0xbc00,0x3bd9b23e,0x361f3b64,0xbaa73872,0x3c000000,0x34a53ba8,0xbaa73872,0xba2fb913
.long 0x3c00,0xbb64361f,0xb9a8b9a8,0x361fbb64,0xbc008000,0xb78bbb0e,0x3872baa7,0x3bf62e46
.long 0xbc00,0x3aa7b872,0x3b64361f,0x323e3bd9,0x3c000000,0x39133a2f,0xb23e3bd9,0xbb0e378b
.long 0x3c00,0xb9a839a8,0xbc008000,0xb9a8b9a8,0xbc008000,0xba2fb913,0xb23ebbd9,0x378bbb0e
.long 0xbc00,0x3872baa7,0x3b64b61f,0x3bd9323e,0x3c000000,0x3b0e378b,0x38723aa7,0x2e463bf6
.long 0x3c00,0xb61f3b64,0xb9a839a8,0xbb64361f,0xbc008000,0xbba8b4a5,0xbaa7b872,0xb913ba2f
.long 0xbc00,0x323ebbd9,0x361fbb64,0x3872baa7,0x3c000000,0x3bf62e46,0x3bd9323e,0x3ba834a5
.long 0x3c00,0xbc008000,0xbc00,0x3c000000,0xbb64361f,0xb78bbb0e,0x3aa7b872,0x39133a2f
.long 0xb9a8b9a8,0x3872baa7,0x3b64361f,0xb23e3bd9,0x361fbb64,0x3bf62e46,0x323e3bd9,0xbb0e378b
.long 0x3c000000,0x361f3b64,0xb9a839a8,0xbb64b61f,0x361f3b64,0xb9133a2f,0xbbd9b23e,0xb4a5bba8
.long 0xb9a839a8,0xbbd9b23e,0xb61fbb64,0x3872baa7,0xbb64b61f,0xb4a5bba8,0x3872baa7,0x3bf6ae46
.long 0xbc00,0x39a8b9a8,0x3c000000,0x39a839a8,0x3b64b61f,0x3ba834a5,0x38723aa7,0xae463bf6
.long 0x39a839a8,0x323e3bd9,0xb61f3b64,0xbaa73872,0xb61f3b64,0xba2f3913,0xbbd9323e,0xbba8b4a5
.long 0xbc008000,0xbb64b61f,0xb9a8b9a8,0xb61fbb64,0xb61fbb64,0xae46bbf6,0x323ebbd9,0x378bbb0e
.long 0x39a8b9a8,0x3aa7b872,0x3b64b61f,0x3bd9b23e,0x3b64361f,0x3b0e378b,0x3aa73872,0x3a2f3913
.long 0x3c00,0xbc008000,0xbc00,0x3c000000,0xb9a839a8,0xba2fb913,0x3872baa7,0x3b0e378b
.long 0xbc008000,0xb23ebbd9,0x3b64b61f,0x38723aa7,0xb9a8b9a8,0x378bbb0e,0x3bd9323e,0x2e463bf6
.long 0xbc00,0x3b64b61f,0x39a839a8,0xb61f3b64,0x39a8b9a8,0x3ba834a5,0x323e3bd9,0xba2f3913
.long 0x3c000000,0x38723aa7,0xb61f3b64,0xbbd9323e,0x39a839a8,0xae463bf6,0xbaa73872,0xbba8b4a5
.long 0x3c00,0xb9a839a8,0xbc008000,0xb9a8b9a8,0xb9a839a8,0xbbf62e46,0xbaa7b872,0xb4a5bba8
.long 0xbc008000,0xbaa7b872,0xb61fbb64,0x323ebbd9,0xb9a8b9a8,0xb4a5bba8,0x323ebbd9,0x3913ba2f
.long 0xbc00,0x361fbb64,0x39a8b9a8,0x3b64b61f,0x39a8b9a8,0x3b0eb78b,0x3bd9b23e,0x3bf62e46
.long 0x3c000000,0x3bd9323e,0x3b64361f,0x3aa73872,0x39a839a8,0x39133a2f,0x38723aa7,0x378b3b0e
.long 0x3c00,0xbc008000,0xbc00,0x3c000000,0xb61f3b64,0xbba8b4a5,0x323ebbd9,0x3bf62e46
.long 0xb9a839a8,0xbaa7b872,0x361fbb64,0x3bd9323e,0xbb64361f,0xb913ba2f,0x3872baa7,0x3ba834a5
.long 0xbc008000,0xb61fbb64,0x39a8b9a8,0x3b64361f,0xbb64b61f,0xae46bbf6,0x3aa7b872,0x3b0e378b
.long 0xb9a8b9a8,0x323ebbd9,0x3b64b61f,0x3aa73872,0xb61fbb64,0x378bbb0e,0x3bd9b23e,0x3a2f3913
.long 0xbc00,0x39a8b9a8,0x3c000000,0x39a839a8,0x361fbb64,0x3b0eb78b,0x3bd9323e,0x39133a2f
.long 0x39a8b9a8,0x3bd9b23e,0x3b64361f,0x38723aa7,0x3b64b61f,0x3bf62e46,0x3aa73872,0x378b3b0e
.long 0x3c000000,0x3b64361f,0x39a839a8,0x361f3b64,0x3b64361f,0x3a2f3913,0x38723aa7,0x34a53ba8
.long 0x39a839a8,0x38723aa7,0x361f3b64,0x323e3bd9,0x361f3b64,0x34a53ba8,0x323e3bd9,0x2e463bf6
.long 0x3c00,0x3c00,0x3c00,0x3c00,0x3c008000,0x3c008000,0x3c008000,0x3c008000
.long 0x3c00,0xbc00,0x361f3b64,0xb61fbb64,0x3c008000,0xbc008000,0x3b64b61f,0xbb64361f
.long 0x3c00,0x3c00,0x39a839a8,0x39a839a8,0x3c008000,0x3c008000,0x39a8b9a8,0x39a8b9a8
.long 0x3c00,0xbc00,0x3b64361f,0xbb64b61f,0x3c008000,0xbc008000,0x361fbb64,0xb61f3b64
.long 0x3c00,0x3c00,0x3c000000,0x3c000000,0x3c008000,0x3c008000,0xbc00,0xbc00
.long 0x3c00,0xbc00,0x3b64b61f,0xbb64361f,0x3c008000,0xbc008000,0xb61fbb64,0x361f3b64
.long 0x3c00,0x3c00,0x39a8b9a8,0x39a8b9a8,0x3c008000,0x3c008000,0xb9a8b9a8,0xb9a8b9a8
.long 0x3c00,0xbc00,0x361fbb64,0xb61f3b64,0x3c008000,0xbc008000,0xbb64b61f,0x3b64361f
.long 0x3c00,0x3c00,0x3c00,0x3c00,0x3c008000,0x3c008000,0x3c008000,0x3c008000
.long 0x39a839a8,0xb9a8b9a8,0x3b64361f,0xbb64b61f,0x39a8b9a8,0xb9a839a8,0x361fbb64,0xb61f3b64
.long 0x3c000000,0x3c000000,0x39a8b9a8,0x39a8b9a8,0xbc00,0xbc00,0xb9a8b9a8,0xb9a8b9a8
.long 0x39a8b9a8,0xb9a839a8,0xb61fbb64,0x361f3b64,0xb9a8b9a8,0x39a839a8,0xbb64361f,0x3b64b61f
.long 0xbc00,0xbc00,0xbc008000,0xbc008000,0xbc008000,0xbc008000,0x80003c00,0x80003c00
.long 0xb9a8b9a8,0x39a839a8,0xb61f3b64,0x361fbb64,0xb9a839a8,0x39a8b9a8,0x3b64361f,0xbb64b61f
.long 0xbc008000,0xbc008000,0x39a839a8,0x39a839a8,0x80003c00,0x80003c00,0x39a8b9a8,0x39a8b9a8
.long 0xb9a839a8,0x39a8b9a8,0x3b64b61f,0xbb64361f,0x39a839a8,0xb9a8b9a8,0xb61fbb64,0x361f3b64
.long 0x3c00,0x3c00,0x3c00,0x3c00,0x3c008000,0x3c008000,0x3c008000,0x3c008000
.long 0x3c000000,0xbc008000,0x3b64b61f,0xbb64361f,0xbc00,0x80003c00,0xb61fbb64,0x361f3b64
.long 0xbc00,0xbc00,0xb9a8b9a8,0xb9a8b9a8,0xbc008000,0xbc008000,0xb9a839a8,0xb9a839a8
.long 0xbc008000,0x3c000000,0xb61f3b64,0x361fbb64,0x80003c00,0xbc00,0x3b64361f,0xbb64b61f
.long 0x3c00,0x3c00,0x3c000000,0x3c000000,0x3c008000,0x3c008000,0xbc00,0xbc00
.long 0x3c000000,0xbc008000,0xb61fbb64,0x361f3b64,0xbc00,0x80003c00,0xbb64361f,0x3b64b61f
.long 0xbc00,0xbc00,0xb9a839a8,0xb9a839a8,0xbc008000,0xbc008000,0x39a839a8,0x39a839a8
.long 0xbc008000,0x3c000000,0x3b64361f,0xbb64b61f,0x80003c00,0xbc00,0x361fbb64,0xb61f3b64
.long 0x3c00,0x3c00,0x3c00,0x3c00,0x3c008000,0x3c008000,0x3c008000,0x3c008000
.long 0x39a8b9a8,0xb9a839a8,0x361fbb64,0xb61f3b64,0xb9a8b9a8,0x39a839a8,0xbb64b61f,0x3b64361f
.long 0xbc008000,0xbc008000,0xb9a839a8,0xb9a839a8,0x80003c00,0x80003c00,0x39a839a8,0x39a839a8
.long 0x39a839a8,0xb9a8b9a8,0x3b64b61f,0xbb64361f,0x39a8b9a8,0xb9a839a8,0xb61fbb64,0x361f3b64
.long 0xbc00,0xbc00,0xbc008000,0xbc008000,0xbc008000,0xbc008000,0x80003c00,0x80003c00
.long 0xb9a839a8,0x39a8b9a8,0x3b64361f,0xbb64b61f,0x39a839a8,0xb9a8b9a8,0x361fbb64,0xb61f3b64
.long 0x3c000000,0x3c000000,0xb9a8b9a8,0xb9a8b9a8,0xbc00,0xbc00,0xb9a839a8,0xb9a839a8
.long 0xb9a8b9a8,0x39a839a8,0x361f3b64,0xb61fbb64,0xb9a839a8,0x39a8b9a8,0x3b64b61f,0xbb64361f
.long 0x3c00,0x3c00,0x3c00,0x3c00,0x3c008000,0x3c008000,0x3c008000,0x3c008000
.long 0x2a483bfe,0xaa48bbfe,0x395f39ed,0xb95fb9ed,0x3bfeaa48,0xbbfe2a48,0x39edb95f,0xb9ed395f
.long 0x2e463bf6,0x2e463bf6,0x3bf62e46,0x3bf62e46,0x3bf6ae46,0x3bf6ae46,0x2e46bbf6,0x2e46bbf6
.long 0x30b23bea,0xb0b2bbea,0x3a6db8c4,0xba6d38c4,0x3beab0b2,0xbbea30b2,0xb8c4ba6d,0x38c43a6d
.long 0x323e3bd9,0x323e3bd9,0x323ebbd9,0x323ebbd9,0x3bd9b23e,0x3bd9b23e,0xbbd9b23e,0xbbd9b23e
.long 0x33c63bc3,0xb3c6bbc3,0xb81dbadd,0x381d3add,0x3bc3b3c6,0xbbc333c6,0xbadd381d,0x3addb81d
.long 0x34a53ba8,0x34a53ba8,0xbba8b4a5,0xbba8b4a5,0x3ba8b4a5,0x3ba8b4a5,0xb4a53ba8,0xb4a53ba8
.long 0x35643b88,0xb564bb88,0xbb3b36d7,0x3b3bb6d7,0x3b88b564,0xbb883564,0x36d73b3b,0xb6d7bb3b
.long 0x3c00,0x3c00,0x3c00,0x3c00,0x3c008000,0x3c008000,0x3c008000,0x3c008000
.long 0x39ed395f,0xb9edb95f,0x3bfe2a48,0xbbfeaa48,0x395fb9ed,0xb95f39ed,0x2a48bbfe,0xaa483bfe
.long 0x3bf6ae46,0x3bf6ae46,0x2e46bbf6,0x2e46bbf6,0xae46bbf6,0xae46bbf6,0xbbf6ae46,0xbbf6ae46
.long 0x38c4ba6d,0xb8c43a6d,0xbbeab0b2,0x3bea30b2,0xba6db8c4,0x3a6d38c4,0xb0b23bea,0x30b2bbea
.long 0xb23ebbd9,0xb23ebbd9,0xb23e3bd9,0xb23e3bd9,0xbbd9323e,0xbbd9323e,0x3bd9323e,0x3bd9323e
.long 0xbaddb81d,0x3add381d,0x3bc333c6,0xbbc3b3c6,0xb81d3add,0x381dbadd,0x33c6bbc3,0xb3c63bc3
.long 0xbba834a5,0xbba834a5,0x34a5bba8,0x34a5bba8,0x34a53ba8,0x34a53ba8,0xbba8b4a5,0xbba8b4a5
.long 0xb6d73b3b,0x36d7bb3b,0xbb88b564,0x3b883564,0x3b3b36d7,0xbb3bb6d7,0xb5643b88,0x3564bb88
.long 0x3c00,0x3c00,0x3c00,0x3c00,0x3c008000,0x3c008000,0x3c008000,0x3c008000
.long 0x3bfeaa48,0xbbfe2a48,0x39edb95f,0xb9ed395f,0xaa48bbfe,0x2a483bfe,0xb95fb9ed,0x395f39ed
.long 0xae46bbf6,0xae46bbf6,0xbbf6ae46,0xbbf6ae46,0xbbf62e46,0xbbf62e46,0xae463bf6,0xae463bf6
.long 0xbbea30b2,0x3beab0b2,0x38c43a6d,0xb8c4ba6d,0x30b23bea,0xb0b2bbea,0x3a6db8c4,0xba6d38c4
.long 0x323e3bd9,0x323e3bd9,0x323ebbd9,0x323ebbd9,0x3bd9b23e,0x3bd9b23e,0xbbd9b23e,0xbbd9b23e
.long 0x3bc3b3c6,0xbbc333c6,0xbadd381d,0x3addb81d,0xb3c6bbc3,0x33c63bc3,0x381d3add,0xb81dbadd
.long 0xb4a5bba8,0xb4a5bba8,0x3ba834a5,0x3ba834a5,0xbba834a5,0xbba834a5,0x34a5bba8,0x34a5bba8
.long 0xbb883564,0x3b88b564,0xb6d7bb3b,0x36d73b3b,0x35643b88,0xb564bb88,0xbb3b36d7,0x3b3bb6d7
.long 0x3c00,0x3c00,0x3c00,0x3c00,0x3c008000,0x3c008000,0x3c008000,0x3c008000
.long 0x395fb9ed,0xb95f39ed,0x2a48bbfe,0xaa483bfe,0xb9edb95f,0x39ed395f,0xbbfeaa48,0x3bfe2a48
.long 0xbbf62e46,0xbbf62e46,0xae463bf6,0xae463bf6,0x2e463bf6,0x2e463bf6,0x3bf62e46,0x3bf62e46
.long 0x3a6d38c4,0xba6db8c4,0x30b2bbea,0xb0b23bea,0x38c4ba6d,0xb8c43a6d,0xbbeab0b2,0x3bea30b2
.long 0xb23ebbd9,0xb23ebbd9,0xb23e3bd9,0xb23e3bd9,0xbbd9323e,0xbbd9323e,0x3bd9323e,0x3bd9323e
.long 0xb81d3add,0x381dbadd,0x33c6bbc3,0xb3c63bc3,0x3add381d,0xbaddb81d,0xbbc3b3c6,0x3bc333c6
.long 0x3ba8b4a5,0x3ba8b4a5,0xb4a53ba8,0xb4a53ba8,0xb4a5bba8,0xb4a5bba8,0x3ba834a5,0x3ba834a5
.long 0xbb3bb6d7,0x3b3b36d7,0x3564bb88,0xb5643b88,0xb6d73b3b,0x36d7bb3b,0xbb88b564,0x3b883564
.long 0x3c00,0x3c00,0x3c00,0x3c00,0x3c008000,0x3c008000,0x3c008000,0x3c008000
.long 0x2e463bf6,0xae46bbf6,0x39133a2f,0xb913ba2f,0x3bf6ae46,0xbbf62e46,0x3a2fb913,0xba2f3913
.long 0x323e3bd9,0x323e3bd9,0x3bd9323e,0x3bd9323e,0x3bd9b23e,0x3bd9b23e,0x323ebbd9,0x323ebbd9
.long 0x34a53ba8,0xb4a5bba8,0x3b0eb78b,0xbb0e378b,0x3ba8b4a5,0xbba834a5,0xb78bbb0e,0x378b3b0e
.long 0x361f3b64,0x361f3b64,0x361fbb64,0x361fbb64,0x3b64b61f,0x3b64b61f,0xbb64b61f,0xbb64b61f
.long 0x378b3b0e,0xb78bbb0e,0xb4a5bba8,0x34a53ba8,0x3b0eb78b,0xbb0e378b,0xbba834a5,0x3ba8b4a5
.long 0x38723aa7,0x38723aa7,0xbaa7b872,0xbaa7b872,0x3aa7b872,0x3aa7b872,0xb8723aa7,0xb8723aa7
.long 0x39133a2f,0xb913ba2f,0xbbf62e46,0x3bf6ae46,0x3a2fb913,0xba2f3913,0x2e463bf6,0xae46bbf6
.long 0x3c00,0x3c00,0x3c00,0x3c00,0x3c008000,0x3c008000,0x3c008000,0x3c008000
.long 0x3a2f3913,0xba2fb913,0x3bf62e46,0xbbf6ae46,0x3913ba2f,0xb9133a2f,0x2e46bbf6,0xae463bf6
.long 0x3bd9b23e,0x3bd9b23e,0x323ebbd9,0x323ebbd9,0xb23ebbd9,0xb23ebbd9,0xbbd9b23e,0xbbd9b23e
.long 0x378bbb0e,0xb78b3b0e,0xbba8b4a5,0x3ba834a5,0xbb0eb78b,0x3b0e378b,0xb4a53ba8,0x34a5bba8
.long 0xb61fbb64,0xb61fbb64,0xb61f3b64,0xb61f3b64,0xbb64361f,0xbb64361f,0x3b64361f,0x3b64361f
.long 0xbba8b4a5,0x3ba834a5,0x3b0e378b,0xbb0eb78b,0xb4a53ba8,0x34a5bba8,0x378bbb0e,0xb78b3b0e
.long 0xbaa73872,0xbaa73872,0x3872baa7,0x3872baa7,0x38723aa7,0x38723aa7,0xbaa7b872,0xbaa7b872
.long 0xae463bf6,0x2e46bbf6,0xba2fb913,0x3a2f3913,0x3bf62e46,0xbbf6ae46,0xb9133a2f,0x3913ba2f
.long 0x3c00,0x3c00,0x3c00,0x3c00,0x3c008000,0x3c008000,0x3c008000,0x3c008000
.long 0x3bf6ae46,0xbbf62e46,0x3a2fb913,0xba2f3913,0xae46bbf6,0x2e463bf6,0xb913ba2f,0x39133a2f
.long 0xb23ebbd9,0xb23ebbd9,0xbbd9b23e,0xbbd9b23e,0xbbd9323e,0xbbd9323e,0xb23e3bd9,0xb23e3bd9
.long 0xbba834a5,0x3ba8b4a5,0x378b3b0e,0xb78bbb0e,0x34a53ba8,0xb4a5bba8,0x3b0eb78b,0xbb0e378b
.long 0x361f3b64,0x361f3b64,0x361fbb64,0x361fbb64,0x3b64b61f,0x3b64b61f,0xbb64b61f,0xbb64b61f
.long 0x3b0eb78b,0xbb0e378b,0xbba834a5,0x3ba8b4a5,0xb78bbb0e,0x378b3b0e,0x34a53ba8,0xb4a5bba8
.long 0xb872baa7,0xb872baa7,0x3aa73872,0x3aa73872,0xbaa73872,0xbaa73872,0x3872baa7,0x3872baa7
.long 0xba2f3913,0x3a2fb913,0xae46bbf6,0x2e463bf6,0x39133a2f,0xb913ba2f,0xbbf62e46,0x3bf6ae46
.long 0x3c00,0x3c00,0x3c00,0x3c00,0x3c008000,0x3c008000,0x3c008000,0x3c008000
.long 0x3913ba2f,0xb9133a2f,0x2e46bbf6,0xae463bf6,0xba2fb913,0x3a2f3913,0xbbf6ae46,0x3bf62e46
.long 0xbbd9323e,0xbbd9323e,0xb23e3bd9,0xb23e3bd9,0x323e3bd9,0x323e3bd9,0x3bd9323e,0x3bd9323e
.long 0x3b0e378b,0xbb0eb78b,0x34a5bba8,0xb4a53ba8,0x378bbb0e,0xb78b3b0e,0xbba8b4a5,0x3ba834a5
.long 0xb61fbb64,0xb61fbb64,0xb61f3b64,0xb61f3b64,0xbb64361f,0xbb64361f,0x3b64361f,0x3b64361f
.long 0xb4a53ba8,0x34a5bba8,0x378bbb0e,0xb78b3b0e,0x3ba834a5,0xbba8b4a5,0xbb0eb78b,0x3b0e378b
.long 0x3aa7b872,0x3aa7b872,0xb8723aa7,0xb8723aa7,0xb872baa7,0xb872baa7,0x3aa73872,0x3aa73872
.long 0xbbf6ae46,0x3bf62e46,0x3913ba2f,0xb9133a2f,0xae463bf6,0x2e46bbf6,0xba2fb913,0x3a2f3913
.long 0x3c00,0x3c00,0x3c00,0x3c00,0x3c008000,0x3c008000,0x3c008000,0x3c008000
.long 0x30b23bea,0xb0b2bbea,0x38c43a6d,0xb8c4ba6d,0x3beab0b2,0xbbea30b2,0x3a6db8c4,0xba6d38c4
.long 0x34a53ba8,0x34a53ba8,0x3ba834a5,0x3ba834a5,0x3ba8b4a5,0x3ba8b4a5,0x34a5bba8,0x34a5bba8
.long 0x36d73b3b,0xb6d7bb3b,0x3b88b564,0xbb883564,0x3b3bb6d7,0xbb3b36d7,0xb564bb88,0x35643b88
.long 0x38723aa7,0x38723aa7,0x3872baa7,0x3872baa7,0x3aa7b872,0x3aa7b872,0xbaa7b872,0xbaa7b872
.long 0x395f39ed,0xb95fb9ed,0xaa48bbfe,0x2a483bfe,0x39edb95f,0xb9ed395f,0xbbfe2a48,0x3bfeaa48
.long 0x3a2f3913,0x3a2f3913,0xb913ba2f,0xb913ba2f,0x3913ba2f,0x3913ba2f,0xba2f3913,0xba2f3913
.long 0x3add381d,0xbaddb81d,0xbbc3b3c6,0x3bc333c6,0x381dbadd,0xb81d3add,0xb3c63bc3,0x33c6bbc3
.long 0x3c00,0x3c00,0x3c00,0x3c00,0x3c008000,0x3c008000,0x3c008000,0x3c008000
.long 0x3a6d38c4,0xba6db8c4,0x3bea30b2,0xbbeab0b2,0x38c4ba6d,0xb8c43a6d,0x30b2bbea,0xb0b23bea
.long 0x3ba8b4a5,0x3ba8b4a5,0x34a5bba8,0x34a5bba8,0xb4a5bba8,0xb4a5bba8,0xbba8b4a5,0xbba8b4a5
.long 0x3564bb88,0xb5643b88,0xbb3bb6d7,0x3b3b36d7,0xbb88b564,0x3b883564,0xb6d73b3b,0x36d7bb3b
.long 0xb872baa7,0xb872baa7,0xb8723aa7,0xb8723aa7,0xbaa73872,0xbaa73872,0x3aa73872,0x3aa73872
.long 0xbbfeaa48,0x3bfe2a48,0x39ed395f,0xb9edb95f,0xaa483bfe,0x2a48bbfe,0x395fb9ed,0xb95f39ed
.long 0xb9133a2f,0xb9133a2f,0x3a2fb913,0x3a2fb913,0x3a2f3913,0x3a2f3913,0xb913ba2f,0xb913ba2f
.long 0x33c63bc3,0xb3c6bbc3,0xb81dbadd,0x381d3add,0x3bc3b3c6,0xbbc333c6,0xbadd381d,0x3addb81d
.long 0x3c00,0x3c00,0x3c00,0x3c00,0x3c008000,0x3c008000,0x3c008000,0x3c008000
.long 0x3beab0b2,0xbbea30b2,0x3a6db8c4,0xba6d38c4,0xb0b2bbea,0x30b23bea,0xb8c4ba6d,0x38c43a6d
.long 0xb4a5bba8,0xb4a5bba8,0xbba8b4a5,0xbba8b4a5,0xbba834a5,0xbba834a5,0xb4a53ba8,0xb4a53ba8
.long 0xbb3b36d7,0x3b3bb6d7,0x35643b88,0xb564bb88,0x36d73b3b,0xb6d7bb3b,0x3b88b564,0xbb883564
.long 0x38723aa7,0x38723aa7,0x3872baa7,0x3872baa7,0x3aa7b872,0x3aa7b872,0xbaa7b872,0xbaa7b872
.long 0x39edb95f,0xb9ed395f,0xbbfe2a48,0x3bfeaa48,0xb95fb9ed,0x395f39ed,0x2a483bfe,0xaa48bbfe
.long 0xba2fb913,0xba2fb913,0x39133a2f,0x39133a2f,0xb9133a2f,0xb9133a2f,0x3a2fb913,0x3a2fb913
.long 0xb81d3add,0x381dbadd,0x33c6bbc3,0xb3c63bc3,0x3add381d,0xbaddb81d,0xbbc3b3c6,0x3bc333c6
.long 0x3c00,0x3c00,0x3c00,0x3c00,0x3c008000,0x3c008000,0x3c008000,0x3c008000
.long 0x38c4ba6d,0xb8c43a6d,0x30b2bbea,0xb0b23bea,0xba6db8c4,0x3a6d38c4,0xbbeab0b2,0x3bea30b2
.long 0xbba834a5,0xbba834a5,0xb4a53ba8,0xb4a53ba8,0x34a53ba8,0x34a53ba8,0x3ba834a5,0x3ba834a5
.long 0x3b883564,0xbb88b564,0x36d7bb3b,0xb6d73b3b,0x3564bb88,0xb5643b88,0xbb3bb6d7,0x3b3b36d7
.long 0xb872baa7,0xb872baa7,0xb8723aa7,0xb8723aa7,0xbaa73872,0xbaa73872,0x3aa73872,0x3aa73872
.long 0xaa483bfe,0x2a48bbfe,0x395fb9ed,0xb95f39ed,0x3bfe2a48,0xbbfeaa48,0xb9edb95f,0x39ed395f
.long 0x3913ba2f,0x3913ba2f,0xba2f3913,0xba2f3913,0xba2fb913,0xba2fb913,0x39133a2f,0x39133a2f
.long 0xbbc333c6,0x3bc3b3c6,0x3addb81d,0xbadd381d,0x33c63bc3,0xb3c6bbc3,0xb81dbadd,0x381d3add
.long 0x3c00,0x3c00,0x3c00,0x3c00,0x3c008000,0x3c008000,0x3c008000,0x3c008000
.long 0x323e3bd9,0xb23ebbd9,0x38723aa7,0xb872baa7,0x3bd9b23e,0xbbd9323e,0x3aa7b872,0xbaa73872
.long 0x361f3b64,0x361f3b64,0x3b64361f,0x3b64361f,0x3b64b61f,0x3b64b61f,0x361fbb64,0x361fbb64
.long 0x38723aa7,0xb872baa7,0x3bd9b23e,0xbbd9323e,0x3aa7b872,0xbaa73872,0xb23ebbd9,0x323e3bd9
.long 0x39a839a8,0x39a839a8,0x39a8b9a8,0x39a8b9a8,0x39a8b9a8,0x39a8b9a8,0xb9a8b9a8,0xb9a8b9a8
.long 0x3aa73872,0xbaa7b872,0x323ebbd9,0xb23e3bd9,0x3872baa7,0xb8723aa7,0xbbd9b23e,0x3bd9323e
.long 0x3b64361f,0x3b64361f,0xb61fbb64,0xb61fbb64,0x361fbb64,0x361fbb64,0xbb64361f,0xbb64361f
.long 0x3bd9323e,0xbbd9b23e,0xbaa7b872,0x3aa73872,0x323ebbd9,0xb23e3bd9,0xb8723aa7,0x3872baa7
.long 0x3c00,0x3c00,0x3c00,0x3c00,0x3c008000,0x3c008000,0x3c008000,0x3c008000
.long 0x3aa73872,0xbaa7b872,0x3bd9323e,0xbbd9b23e,0x3872baa7,0xb8723aa7,0x323ebbd9,0xb23e3bd9
.long 0x3b64b61f,0x3b64b61f,0x361fbb64,0x361fbb64,0xb61fbb64,0xb61fbb64,0xbb64b61f,0xbb64b61f
.long 0x323ebbd9,0xb23e3bd9,0xbaa7b872,0x3aa73872,0xbbd9b23e,0x3bd9323e,0xb8723aa7,0x3872baa7
.long 0xb9a8b9a8,0xb9a8b9a8,0xb9a839a8,0xb9a839a8,0xb9a839a8,0xb9a839a8,0x39a839a8,0x39a839a8
.long 0xbbd9323e,0x3bd9b23e,0x38723aa7,0xb872baa7,0x323e3bd9,0xb23ebbd9,0x3aa7b872,0xbaa73872
.long 0xb61f3b64,0xb61f3b64,0x3b64b61f,0x3b64b61f,0x3b64361f,0x3b64361f,0xb61fbb64,0xb61fbb64
.long 0x38723aa7,0xb872baa7,0xb23ebbd9,0x323e3bd9,0x3aa7b872,0xbaa73872,0xbbd9323e,0x3bd9b23e
.long 0x3c00,0x3c00,0x3c00,0x3c00,0x3c008000,0x3c008000,0x3c008000,0x3c008000
.long 0x3bd9b23e,0xbbd9323e,0x3aa7b872,0xbaa73872,0xb23ebbd9,0x323e3bd9,0xb872baa7,0x38723aa7
.long 0xb61fbb64,0xb61fbb64,0xbb64b61f,0xbb64b61f,0xbb64361f,0xbb64361f,0xb61f3b64,0xb61f3b64
.long 0xbaa73872,0x3aa7b872,0x323e3bd9,0xb23ebbd9,0x38723aa7,0xb872baa7,0x3bd9b23e,0xbbd9323e
.long 0x39a839a8,0x39a839a8,0x39a8b9a8,0x39a8b9a8,0x39a8b9a8,0x39a8b9a8,0xb9a8b9a8,0xb9a8b9a8
.long 0x3872baa7,0xb8723aa7,0xbbd9b23e,0x3bd9323e,0xbaa7b872,0x3aa73872,0xb23e3bd9,0x323ebbd9
.long 0xbb64b61f,0xbb64b61f,0x361f3b64,0x361f3b64,0xb61f3b64,0xb61f3b64,0x3b64b61f,0x3b64b61f
.long 0xb23e3bd9,0x323ebbd9,0x3872baa7,0xb8723aa7,0x3bd9323e,0xbbd9b23e,0xbaa7b872,0x3aa73872
.long 0x3c00,0x3c00,0x3c00,0x3c00,0x3c008000,0x3c008000,0x3c008000,0x3c008000
.long 0x3872baa7,0xb8723aa7,0x323ebbd9,0xb23e3bd9,0xbaa7b872,0x3aa73872,0xbbd9b23e,0x3bd9323e
.long 0xbb64361f,0xbb64361f,0xb61f3b64,0xb61f3b64,0x361f3b64,0x361f3b64,0x3b64361f,0x3b64361f
.long 0x3bd9323e,0xbbd9b23e,0x3872baa7,0xb8723aa7,0x323ebbd9,0xb23e3bd9,0xbaa7b872,0x3aa73872
.long 0xb9a8b9a8,0xb9a8b9a8,0xb9a839a8,0xb9a839a8,0xb9a839a8,0xb9a839a8,0x39a839a8,0x39a839a8
.long 0x323e3bd9,0xb23ebbd9,0x3aa7b872,0xbaa73872,0x3bd9b23e,0xbbd9323e,0xb872baa7,0x38723aa7
.long 0x361fbb64,0x361fbb64,0xbb64361f,0xbb64361f,0xbb64b61f,0xbb64b61f,0x361f3b64,0x361f3b64
.long 0xbaa73872,0x3aa7b872,0x3bd9b23e,0xbbd9323e,0x38723aa7,0xb872baa7,0xb23ebbd9,0x323e3bd9
.long 0x3c00,0x3c00,0x3c00,0x3c00,0x3c008000,0x3c008000,0x3c008000,0x3c008000
.long 0x33c63bc3,0xb3c6bbc3,0x381d3add,0xb81dbadd,0x3bc3b3c6,0xbbc333c6,0x3addb81d,0xbadd381d
.long 0x378b3b0e,0x378b3b0e,0x3b0e378b,0x3b0e378b,0x3b0eb78b,0x3b0eb78b,0x378bbb0e,0x378bbb0e
.long 0x395f39ed,0xb95fb9ed,0x3bfeaa48,0xbbfe2a48,0x39edb95f,0xb9ed395f,0xaa48bbfe,0x2a483bfe
.long 0x3aa73872,0x3aa73872,0x3aa7b872,0x3aa7b872,0x3872baa7,0x3872baa7,0xb872baa7,0xb872baa7
.long 0x3b883564,0xbb88b564,0x36d7bb3b,0xb6d73b3b,0x3564bb88,0xb5643b88,0xbb3bb6d7,0x3b3b36d7
.long 0x3bf62e46,0x3bf62e46,0xae46bbf6,0xae46bbf6,0x2e46bbf6,0x2e46bbf6,0xbbf62e46,0xbbf62e46
.long 0x3beab0b2,0xbbea30b2,0xb8c4ba6d,0x38c43a6d,0xb0b2bbea,0x30b23bea,0xba6d38c4,0x3a6db8c4
.long 0x3c00,0x3c00,0x3c00,0x3c00,0x3c008000,0x3c008000,0x3c008000,0x3c008000
.long 0x3add381d,0xbaddb81d,0x3bc333c6,0xbbc3b3c6,0x381dbadd,0xb81d3add,0x33c6bbc3,0xb3c63bc3
.long 0x3b0eb78b,0x3b0eb78b,0x378bbb0e,0x378bbb0e,0xb78bbb0e,0xb78bbb0e,0xbb0eb78b,0xbb0eb78b
.long 0x2a48bbfe,0xaa483bfe,0xb9edb95f,0x39ed395f,0xbbfeaa48,0x3bfe2a48,0xb95f39ed,0x395fb9ed
.long 0xbaa7b872,0xbaa7b872,0xbaa73872,0xbaa73872,0xb8723aa7,0xb8723aa7,0x38723aa7,0x38723aa7
.long 0xbb3b36d7,0x3b3bb6d7,0x35643b88,0xb564bb88,0x36d73b3b,0xb6d7bb3b,0x3b88b564,0xbb883564
.long 0xae463bf6,0xae463bf6,0x3bf6ae46,0x3bf6ae46,0x3bf62e46,0x3bf62e46,0xae46bbf6,0xae46bbf6
.long 0x3a6d38c4,0xba6db8c4,0x30b2bbea,0xb0b23bea,0x38c4ba6d,0xb8c43a6d,0xbbeab0b2,0x3bea30b2
.long 0x3c00,0x3c00,0x3c00,0x3c00,0x3c008000,0x3c008000,0x3c008000,0x3c008000
.long 0x3bc3b3c6,0xbbc333c6,0x3addb81d,0xbadd381d,0xb3c6bbc3,0x33c63bc3,0xb81dbadd,0x381d3add
.long 0xb78bbb0e,0xb78bbb0e,0xbb0eb78b,0xbb0eb78b,0xbb0e378b,0xbb0e378b,0xb78b3b0e,0xb78b3b0e
.long 0xb9ed395f,0x39edb95f,0x2a483bfe,0xaa48bbfe,0x395f39ed,0xb95fb9ed,0x3bfeaa48,0xbbfe2a48
.long 0x3aa73872,0x3aa73872,0x3aa7b872,0x3aa7b872,0x3872baa7,0x3872baa7,0xb872baa7,0xb872baa7
.long 0x3564bb88,0xb5643b88,0xbb3bb6d7,0x3b3b36d7,0xbb88b564,0x3b883564,0xb6d73b3b,0x36d7bb3b
.long 0xbbf6ae46,0xbbf6ae46,0x2e463bf6,0x2e463bf6,0xae463bf6,0xae463bf6,0x3bf6ae46,0x3bf6ae46
.long 0x30b23bea,0xb0b2bbea,0x3a6db8c4,0xba6d38c4,0x3beab0b2,0xbbea30b2,0xb8c4ba6d,0x38c43a6d
.long 0x3c00,0x3c00,0x3c00,0x3c00,0x3c008000,0x3c008000,0x3c008000,0x3c008000
.long 0x381dbadd,0xb81d3add,0x33c6bbc3,0xb3c63bc3,0xbaddb81d,0x3add381d,0xbbc3b3c6,0x3bc333c6
.long 0xbb0e378b,0xbb0e378b,0xb78b3b0e,0xb78b3b0e,0x378b3b0e,0x378b3b0e,0x3b0e378b,0x3b0e378b
.long 0x3bfe2a48,0xbbfeaa48,0x395fb9ed,0xb95f39ed,0x2a48bbfe,0xaa483bfe,0xb9edb95f,0x39ed395f
.long 0xbaa7b872,0xbaa7b872,0xbaa73872,0xbaa73872,0xb8723aa7,0xb8723aa7,0x38723aa7,0x38723aa7
.long 0x36d73b3b,0xb6d7bb3b,0x3b88b564,0xbb883564,0x3b3bb6d7,0xbb3b36d7,0xb564bb88,0x35643b88
.long 0x2e46bbf6,0x2e46bbf6,0xbbf62e46,0xbbf62e46,0xbbf6ae46,0xbbf6ae46,0x2e463bf6,0x2e463bf6
.long 0xb8c43a6d,0x38c4ba6d,0x3bea30b2,0xbbeab0b2,0x3a6d38c4,0xba6db8c4,0x30b2bbea,0xb0b23bea
.long 0x3c00,0x3c00,0x3c00,0x3c00,0x3c008000,0x3c008000,0x3c008000,0x3c008000
.long 0x34a53ba8,0xb4a5bba8,0x378b3b0e,0xb78bbb0e,0x3ba8b4a5,0xbba834a5,0x3b0eb78b,0xbb0e378b
.long 0x38723aa7,0x38723aa7,0x3aa73872,0x3aa73872,0x3aa7b872,0x3aa7b872,0x3872baa7,0x3872baa7
.long 0x3a2f3913,0xba2fb913,0x3bf62e46,0xbbf6ae46,0x3913ba2f,0xb9133a2f,0x2e46bbf6,0xae463bf6
.long 0x3b64361f,0x3b64361f,0x3b64b61f,0x3b64b61f,0x361fbb64,0x361fbb64,0xb61fbb64,0xb61fbb64
.long 0x3bf62e46,0xbbf6ae46,0x3913ba2f,0xb9133a2f,0x2e46bbf6,0xae463bf6,0xba2fb913,0x3a2f3913
.long 0x3bd9b23e,0x3bd9b23e,0x323ebbd9,0x323ebbd9,0xb23ebbd9,0xb23ebbd9,0xbbd9b23e,0xbbd9b23e
.long 0x3b0eb78b,0xbb0e378b,0xb4a5bba8,0x34a53ba8,0xb78bbb0e,0x378b3b0e,0xbba834a5,0x3ba8b4a5
.long 0x3c00,0x3c00,0x3c00,0x3c00,0x3c008000,0x3c008000,0x3c008000,0x3c008000
.long 0x3b0e378b,0xbb0eb78b,0x3ba834a5,0xbba8b4a5,0x378bbb0e,0xb78b3b0e,0x34a5bba8,0xb4a53ba8
.long 0x3aa7b872,0x3aa7b872,0x3872baa7,0x3872baa7,0xb872baa7,0xb872baa7,0xbaa7b872,0xbaa7b872
.long 0xae46bbf6,0x2e463bf6,0xb913ba2f,0x39133a2f,0xbbf62e46,0x3bf6ae46,0xba2f3913,0x3a2fb913
.long 0xbb64b61f,0xbb64b61f,0xbb64361f,0xbb64361f,0xb61f3b64,0xb61f3b64,0x361f3b64,0x361f3b64
.long 0xba2f3913,0x3a2fb913,0x2e463bf6,0xae46bbf6,0x39133a2f,0xb913ba2f,0x3bf6ae46,0xbbf62e46
.long 0x323e3bd9,0x323e3bd9,0x3bd9323e,0x3bd9323e,0x3bd9b23e,0x3bd9b23e,0x323ebbd9,0x323ebbd9
.long 0x3ba834a5,0xbba8b4a5,0x378bbb0e,0xb78b3b0e,0x34a5bba8,0xb4a53ba8,0xbb0eb78b,0x3b0e378b
.long 0x3c00,0x3c00,0x3c00,0x3c00,0x3c008000,0x3c008000,0x3c008000,0x3c008000
.long 0x3ba8b4a5,0xbba834a5,0x3b0eb78b,0xbb0e378b,0xb4a5bba8,0x34a53ba8,0xb78bbb0e,0x378b3b0e
.long 0xb872baa7,0xb872baa7,0xbaa7b872,0xbaa7b872,0xbaa73872,0xbaa73872,0xb8723aa7,0xb8723aa7
.long 0xb9133a2f,0x3913ba2f,0xae463bf6,0x2e46bbf6,0x3a2f3913,0xba2fb913,0x3bf62e46,0xbbf6ae46
.long 0x3b64361f,0x3b64361f,0x3b64b61f,0x3b64b61f,0x361fbb64,0x361fbb64,0xb61fbb64,0xb61fbb64
.long 0x2e46bbf6,0xae463bf6,0xba2fb913,0x3a2f3913,0xbbf6ae46,0x3bf62e46,0xb9133a2f,0x3913ba2f
.long 0xbbd9323e,0xbbd9323e,0xb23e3bd9,0xb23e3bd9,0x323e3bd9,0x323e3bd9,0x3bd9323e,0x3bd9323e
.long 0x378b3b0e,0xb78bbb0e,0x3ba8b4a5,0xbba834a5,0x3b0eb78b,0xbb0e378b,0xb4a5bba8,0x34a53ba8
.long 0x3c00,0x3c00,0x3c00,0x3c00,0x3c008000,0x3c008000,0x3c008000,0x3c008000
.long 0x378bbb0e,0xb78b3b0e,0x34a5bba8,0xb4a53ba8,0xbb0eb78b,0x3b0e378b,0xbba8b4a5,0x3ba834a5
.long 0xbaa73872,0xbaa73872,0xb8723aa7,0xb8723aa7,0x38723aa7,0x38723aa7,0x3aa73872,0x3aa73872
.long 0x3bf6ae46,0xbbf62e46,0x3a2fb913,0xba2f3913,0xae46bbf6,0x2e463bf6,0xb913ba2f,0x39133a2f
.long 0xbb64b61f,0xbb64b61f,0xbb64361f,0xbb64361f,0xb61f3b64,0xb61f3b64,0x361f3b64,0x361f3b64
.long 0x39133a2f,0xb913ba2f,0x3bf6ae46,0xbbf62e46,0x3a2fb913,0xba2f3913,0xae46bbf6,0x2e463bf6
.long 0xb23ebbd9,0xb23ebbd9,0xbbd9b23e,0xbbd9b23e,0xbbd9323e,0xbbd9323e,0xb23e3bd9,0xb23e3bd9
.long 0xb4a53ba8,0x34a5bba8,0x3b0e378b,0xbb0eb78b,0x3ba834a5,0xbba8b4a5,0x378bbb0e,0xb78b3b0e
.long 0x3c00,0x3c00,0x3c00,0x3c00,0x3c008000,0x3c008000,0x3c008000,0x3c008000
.long 0x35643b88,0xb564bb88,0x36d73b3b,0xb6d7bb3b,0x3b88b564,0xbb883564,0x3b3bb6d7,0xbb3b36d7
.long 0x39133a2f,0x39133a2f,0x3a2f3913,0x3a2f3913,0x3a2fb913,0x3a2fb913,0x3913ba2f,0x3913ba2f
.long 0x3add381d,0xbaddb81d,0x3bc333c6,0xbbc3b3c6,0x381dbadd,0xb81d3add,0x33c6bbc3,0xb3c63bc3
.long 0x3bd9323e,0x3bd9323e,0x3bd9b23e,0x3bd9b23e,0x323ebbd9,0x323ebbd9,0xb23ebbd9,0xb23ebbd9
.long 0x3beab0b2,0xbbea30b2,0x3a6db8c4,0xba6d38c4,0xb0b2bbea,0x30b23bea,0xb8c4ba6d,0x38c43a6d
.long 0x3b0eb78b,0x3b0eb78b,0x378bbb0e,0x378bbb0e,0xb78bbb0e,0xb78bbb0e,0xbb0eb78b,0xbb0eb78b
.long 0x395fb9ed,0xb95f39ed,0x2a48bbfe,0xaa483bfe,0xb9edb95f,0x39ed395f,0xbbfeaa48,0x3bfe2a48
.long 0x3c00,0x3c00,0x3c00,0x3c00,0x3c008000,0x3c008000,0x3c008000,0x3c008000
.long 0x3b3b36d7,0xbb3bb6d7,0x3b883564,0xbb88b564,0x36d7bb3b,0xb6d73b3b,0x3564bb88,0xb5643b88
.long 0x3a2fb913,0x3a2fb913,0x3913ba2f,0x3913ba2f,0xb913ba2f,0xb913ba2f,0xba2fb913,0xba2fb913
.long 0xb3c6bbc3,0x33c63bc3,0xb81dbadd,0x381d3add,0xbbc333c6,0x3bc3b3c6,0xbadd381d,0x3addb81d
.long 0xbbd9b23e,0xbbd9b23e,0xbbd9323e,0xbbd9323e,0xb23e3bd9,0xb23e3bd9,0x323e3bd9,0x323e3bd9
.long 0xb8c43a6d,0x38c4ba6d,0xb0b23bea,0x30b2bbea,0x3a6d38c4,0xba6db8c4,0x3bea30b2,0xbbeab0b2
.long 0x378b3b0e,0x378b3b0e,0x3b0e378b,0x3b0e378b,0x3b0eb78b,0x3b0eb78b,0x378bbb0e,0x378bbb0e
.long 0x3bfeaa48,0xbbfe2a48,0x39edb95f,0xb9ed395f,0xaa48bbfe,0x2a483bfe,0xb95fb9ed,0x395f39ed
.long 0x3c00,0x3c00,0x3c00,0x3c00,0x3c008000,0x3c008000,0x3c008000,0x3c008000
.long 0x3b88b564,0xbb883564,0x3b3bb6d7,0xbb3b36d7,0xb564bb88,0x35643b88,0xb6d7bb3b,0x36d73b3b
.long 0xb913ba2f,0xb913ba2f,0xba2fb913,0xba2fb913,0xba2f3913,0xba2f3913,0xb9133a2f,0xb9133a2f
.long 0xb81d3add,0x381dbadd,0xb3c63bc3,0x33c6bbc3,0x3add381d,0xbaddb81d,0x3bc333c6,0xbbc3b3c6
.long 0x3bd9323e,0x3bd9323e,0x3bd9b23e,0x3bd9b23e,0x323ebbd9,0x323ebbd9,0xb23ebbd9,0xb23ebbd9
.long 0xb0b2bbea,0x30b23bea,0xb8c4ba6d,0x38c43a6d,0xbbea30b2,0x3beab0b2,0xba6d38c4,0x3a6db8c4
.long 0xbb0e378b,0xbb0e378b,0xb78b3b0e,0xb78b3b0e,0x378b3b0e,0x378b3b0e,0x3b0e378b,0x3b0e378b
.long 0x39ed395f,0xb9edb95f,0x3bfe2a48,0xbbfeaa48,0x395fb9ed,0xb95f39ed,0x2a48bbfe,0xaa483bfe
.long 0x3c00,0x3c00,0x3c00,0x3c00,0x3c008000,0x3c008000,0x3c008000,0x3c008000
.long 0x36d7bb3b,0xb6d73b3b,0x3564bb88,0xb5643b88,0xbb3bb6d7,0x3b3b36d7,0xbb88b564,0x3b883564
.long 0xba2f3913,0xba2f3913,0xb9133a2f,0xb9133a2f,0x39133a2f,0x39133a2f,0x3a2f3913,0x3a2f3913
.long 0x3bc3b3c6,0xbbc333c6,0x3addb81d,0xbadd381d,0xb3c6bbc3,0x33c63bc3,0xb81dbadd,0x381d3add
.long 0xbbd9b23e,0xbbd9b23e,0xbbd9323e,0xbbd9323e,0xb23e3bd9,0xb23e3bd9,0x323e3bd9,0x323e3bd9
.long 0x3a6d38c4,0xba6db8c4,0x3bea30b2,0xbbeab0b2,0x38c4ba6d,0xb8c43a6d,0x30b2bbea,0xb0b23bea
.long 0xb78bbb0e,0xb78bbb0e,0xbb0eb78b,0xbb0eb78b,0xbb0e378b,0xbb0e378b,0xb78b3b0e,0xb78b3b0e
.long 0x2a483bfe,0xaa48bbfe,0x395f39ed,0xb95fb9ed,0x3bfeaa48,0xbbfe2a48,0x39edb95f,0xb9ed395f
.long 0x3c00,0x3c00,0x3c00,0x3c00,0x3c00,0x3c00,0x3c00,0x3c00
.long 0x3c00,0xbc00,0x3b64,0xbb64,0x8000,0x8000,0xb61f,0x361f
.long 0x3c00,0x3c00,0x39a8,0x39a8,0x8000,0x8000,0xb9a8,0xb9a8
.long 0x3c00,0xbc00,0x361f,0xb61f,0x8000,0x8000,0xbb64,0x3b64
.long 0x3c000000,0x0,0x3bd90000,0xb23e0000,0x80000000,0xbc000000,0xb23e0000,0xbbd90000
.long 0x3c000000,0x80000000,0x3aa70000,0x38720000,0x80000000,0x3c000000,0xb8720000,0x3aa70000
.long 0x3c000000,0x0,0x38720000,0xbaa70000,0x80000000,0xbc000000,0xbaa70000,0xb8720000
.long 0x3c000000,0x80000000,0x323e0000,0x3bd90000,0x80000000,0x3c000000,0xbbd90000,0x323e0000
.long 0x3c00,0x3c00,0x3c00,0x3c00,0xbc00,0xbc00,0xbc00,0xbc00
.long 0x39a8,0xb9a8,0x361f,0xb61f,0xb9a8,0x39a8,0xbb64,0x3b64
.long 0x0,0x0,0xb9a8,0xb9a8,0xbc00,0xbc00,0xb9a8,0xb9a8
.long 0xb9a8,0x39a8,0xbb64,0x3b64,0xb9a8,0x39a8,0x361f,0xb61f
.long 0x3b640000,0xb61f0000,0x3aa70000,0xb8720000,0xb61f0000,0xbb640000,0xb8720000,0xbaa70000
.long 0x361f0000,0x3b640000,0xb23e0000,0x3bd90000,0xbb640000,0x361f0000,0xbbd90000,0xb23e0000
.long 0xb61f0000,0xbb640000,0xbbd90000,0xb23e0000,0xbb640000,0x361f0000,0xb23e0000,0x3bd90000
.long 0xbb640000,0x361f0000,0xb8720000,0xbaa70000,0xb61f0000,0xbb640000,0x3aa70000,0xb8720000
.long 0x3c00,0x3c00,0x3c00,0x3c00,0x3c00,0x3c00,0x3c00,0x3c00
.long 0x0,0x8000,0xb61f,0x361f,0xbc00,0x3c00,0xbb64,0x3b64
.long 0xbc00,0xbc00,0xb9a8,0xb9a8,0x8000,0x8000,0x39a8,0x39a8
.long 0x8000,0x0,0x3b64,0xbb64,0x3c00,0xbc00,0x361f,0xb61f
.long 0x39a80000,0xb9a80000,0x38720000,0xbaa70000,0xb9a80000,0xb9a80000,0xbaa70000,0xb8720000
.long 0xb9a80000,0x39a80000,0xbbd90000,0x323e0000,0xb9a80000,0xb9a80000,0xb23e0000,0xbbd90000
.long 0xb9a80000,0x39a80000,0x323e0000,0x3bd90000,0x39a80000,0x39a80000,0x3bd90000,0xb23e0000
.long 0x39a80000,0xb9a80000,0x3aa70000,0x38720000,0x39a80000,0x39a80000,0xb8720000,0x3aa70000
.long 0x3c00,0x3c00,0x3c00,0x3c00,0xbc00,0xbc00,0xbc00,0xbc00
.long 0xb9a8,0x39a8,0xbb64,0x3b64,0xb9a8,0x39a8,0xb61f,0x361f
.long 0x8000,0x8000,0x39a8,0x39a8,0x3c00,0x3c00,0x39a8,0x39a8
.long 0x39a8,0xb9a8,0xb61f,0x361f,0xb9a8,0x39a8,0xbb64,0x3b64
.long 0x361f0000,0xbb640000,0x323e0000,0xbbd90000,0xbb640000,0xb61f0000,0xbbd90000,0xb23e0000
.long 0xbb640000,0xb61f0000,0xb8720000,0xbaa70000,0x361f0000,0xbb640000,0x3aa70000,0xb8720000
.long 0x3b640000,0x361f0000,0x3aa70000,0xb8720000,0x361f0000,0xbb640000,0xb8720000,0xbaa70000
.long 0xb61f0000,0x3b640000,0xbbd90000,0xb23e0000,0xbb640000,0xb61f0000,0x323e0000,0xbbd90000
.long 0x3c00,0x3c00,0x3c00,0x3c00,0x3c00,0x3c00,0x3c00,0x3c00
.long 0x3bfe,0xbbfe,0x39ed,0xb9ed,0xaa48,0x2a48,0xb95f,0x395f
.long 0x3bf6,0x3bf6,0x2e46,0x2e46,0xae46,0xae46,0xbbf6,0xbbf6
.long 0x3bea,0xbbea,0xb8c4,0x38c4,0xb0b2,0x30b2,0xba6d,0x3a6d
.long 0x3bff0000,0xa6480000,0x3b770000,0xb5c20000,0xa6480000,0xbbff0000,0xb5c20000,0xbb770000
.long 0x3bfa0000,0x2cb50000,0x37320000,0x3b250000,0xacb50000,0x3bfa0000,0xbb250000,0x37320000
.long 0x3bf10000,0xafd60000,0xb4440000,0xbbb60000,0xafd60000,0xbbf10000,0xbbb60000,0x34440000
.long 0x3be20000,0x31790000,0xbac20000,0x38480000,0xb1790000,0x3be20000,0xb8480000,0xbac20000
.long 0x3c00,0x3c00,0x3c00,0x3c00,0xbc00,0xbc00,0xbc00,0xbc00
.long 0x395f,0xb95f,0x2a48,0xaa48,0xb9ed,0x39ed,0xbbfe,0x3bfe
.long 0xae46,0xae46,0xbbf6,0xbbf6,0xbbf6,0xbbf6,0xae46,0xae46
.long 0xba6d,0x3a6d,0xb0b2,0x30b2,0xb8c4,0x38c4,0x3bea,0xbbea
.long 0x3b500000,0xb67c0000,0x39cb0000,0xb9840000,0xb67c0000,0xbb500000,0xb9840000,0xb9cb0000
.long 0x35050000,0x3b990000,0xb93a0000,0x3a0f0000,0xbb990000,0x35050000,0xba0f0000,0xb93a0000
.long 0xb7e30000,0xbaf60000,0xba4f0000,0x38ec0000,0xbaf60000,0x37e30000,0x38ec0000,0x3a4f0000
.long 0xbbce0000,0x33030000,0x389b0000,0xba8a0000,0xb3030000,0xbbce0000,0x3a8a0000,0x389b0000
.long 0x3c00,0x3c00,0x3c00,0x3c00,0x3c00,0x3c00,0x3c00,0x3c00
.long 0xaa48,0x2a48,0xb95f,0x395f,0xbbfe,0x3bfe,0xb9ed,0x39ed
.long 0xbbf6,0xbbf6,0xae46,0xae46,0x2e46,0x2e46,0x3bf6,0x3bf6
.long 0x30b2,0xb0b2,0x3a6d,0xba6d,0x3bea,0xbbea,0xb8c4,0x38c4
.long 0x39840000,0xb9cb0000,0x367c0000,0xbb500000,0xb9cb0000,0xb9840000,0xbb500000,0xb67c0000
.long 0xba0f0000,0x393a0000,0xbb990000,0xb5050000,0xb93a0000,0xba0f0000,0x35050000,0xbb990000
.long 0xb8ec0000,0x3a4f0000,0x3af60000,0x37e30000,0x3a4f0000,0x38ec0000,0x37e30000,0xbaf60000
.long 0x3a8a0000,0xb89b0000,0xb3030000,0x3bce0000,0x389b0000,0x3a8a0000,0xbbce0000,0xb3030000
.long 0x3c00,0x3c00,0x3c00,0x3c00,0xbc00,0xbc00,0xbc00,0xbc00
.long 0xb9ed,0x39ed,0xbbfe,0x3bfe,0xb95f,0x395f,0xaa48,0x2a48
.long 0x2e46,0x2e46,0x3bf6,0x3bf6,0x3bf6,0x3bf6,0x2e46,0x2e46
.long 0x38c4,0xb8c4,0xbbea,0x3bea,0xba6d,0x3a6d,0xb0b2,0x30b2
.long 0x35c20000,0xbb770000,0x26480000,0xbbff0000,0xbb770000,0xb5c20000,0xbbff0000,0xa6480000
.long 0xbb250000,0xb7320000,0xacb50000,0xbbfa0000,0x37320000,0xbb250000,0x3bfa0000,0xacb50000
.long 0x3bb60000,0x34440000,0x2fd60000,0xbbf10000,0x34440000,0xbbb60000,0xbbf10000,0xafd60000
.long 0xb8480000,0x3ac20000,0xb1790000,0xbbe20000,0xbac20000,0xb8480000,0x3be20000,0xb1790000
.long 0x3c00,0x3c00,0x3c00,0x3c00,0x3c00,0x3c00,0x3c00,0x3c00
.long 0x3bf6,0xbbf6,0x3a2f,0xba2f,0xae46,0x2e46,0xb913,0x3913
.long 0x3bd9,0x3bd9,0x323e,0x323e,0xb23e,0xb23e,0xbbd9,0xbbd9
.long 0x3ba8,0xbba8,0xb78b,0x378b,0xb4a5,0x34a5,0xbb0e,0x3b0e
.long 0x3bfe0000,0xaa480000,0x3b880000,0xb5640000,0xaa480000,0xbbfe0000,0xb5640000,0xbb880000
.long 0x3bea0000,0x30b20000,0x381d0000,0x3add0000,0xb0b20000,0x3bea0000,0xbadd0000,0x381d0000
.long 0x3bc30000,0xb3c60000,0xb0b20000,0xbbea0000,0xb3c60000,0xbbc30000,0xbbea0000,0x30b20000
.long 0x3b880000,0x35640000,0xb9ed0000,0x395f0000,0xb5640000,0x3b880000,0xb95f0000,0xb9ed0000
.long 0x3c00,0x3c00,0x3c00,0x3c00,0xbc00,0xbc00,0xbc00,0xbc00
.long 0x3913,0xb913,0x2e46,0xae46,0xba2f,0x3a2f,0xbbf6,0x3bf6
.long 0xb23e,0xb23e,0xbbd9,0xbbd9,0xbbd9,0xbbd9,0xb23e,0xb23e
.long 0xbb0e,0x3b0e,0xb4a5,0x34a5,0xb78b,0x378b,0x3ba8,0xbba8
.long 0x3b3b0000,0xb6d70000,0x39ed0000,0xb95f0000,0xb6d70000,0xbb3b0000,0xb95f0000,0xb9ed0000
.long 0x33c60000,0x3bc30000,0xb8c40000,0x3a6d0000,0xbbc30000,0x33c60000,0xba6d0000,0xb8c40000
.long 0xb8c40000,0xba6d0000,0xbadd0000,0x381d0000,0xba6d0000,0x38c40000,0x381d0000,0x3add0000
.long 0xbbfe0000,0x2a480000,0x36d70000,0xbb3b0000,0xaa480000,0xbbfe0000,0x3b3b0000,0x36d70000
.long 0x3c00,0x3c00,0x3c00,0x3c00,0x3c00,0x3c00,0x3c00,0x3c00
.long 0xae46,0x2e46,0xb913,0x3913,0xbbf6,0x3bf6,0xba2f,0x3a2f
.long 0xbbd9,0xbbd9,0xb23e,0xb23e,0x323e,0x323e,0x3bd9,0x3bd9
.long 0x34a5,0xb4a5,0x3b0e,0xbb0e,0x3ba8,0xbba8,0xb78b,0x378b
.long 0x395f0000,0xb9ed0000,0x36d70000,0xbb3b0000,0xb9ed0000,0xb95f0000,0xbb3b0000,0xb6d70000
.long 0xba6d0000,0x38c40000,0xbbc30000,0xb3c60000,0xb8c40000,0xba6d0000,0x33c60000,0xbbc30000
.long 0xb81d0000,0x3add0000,0x3a6d0000,0x38c40000,0x3add0000,0x381d0000,0x38c40000,0xba6d0000
.long 0x3b3b0000,0xb6d70000,0xaa480000,0x3bfe0000,0x36d70000,0x3b3b0000,0xbbfe0000,0xaa480000
.long 0x3c00,0x3c00,0x3c00,0x3c00,0xbc00,0xbc00,0xbc00,0xbc00
.long 0xba2f,0x3a2f,0xbbf6,0x3bf6,0xb913,0x3913,0xae46,0x2e46
.long 0x323e,0x323e,0x3bd9,0x3bd9,0x3bd9,0x3bd9,0x323e,0x323e
.long 0x378b,0xb78b,0xbba8,0x3ba8,0xbb0e,0x3b0e,0xb4a5,0x34a5
.long 0x35640000,0xbb880000,0x2a480000,0xbbfe0000,0xbb880000,0xb5640000,0xbbfe0000,0xaa480000
.long 0xbadd0000,0xb81d0000,0xb0b20000,0xbbea0000,0x381d0000,0xbadd0000,0x3bea0000,0xb0b20000
.long 0x3bea0000,0x30b20000,0x33c60000,0xbbc30000,0x30b20000,0xbbea0000,0xbbc30000,0xb3c60000
.long 0xb95f0000,0x39ed0000,0xb5640000,0xbb880000,0xb9ed0000,0xb95f0000,0x3b880000,0xb5640000
.long 0x3c00,0x3c00,0x3c00,0x3c00,0x3c00,0x3c00,0x3c00,0x3c00
.long 0x3bea,0xbbea,0x3a6d,0xba6d,0xb0b2,0x30b2,0xb8c4,0x38c4
.long 0x3ba8,0x3ba8,0x34a5,0x34a5,0xb4a5,0xb4a5,0xbba8,0xbba8
.long 0x3b3b,0xbb3b,0xb564,0x3564,0xb6d7,0x36d7,0xbb88,0x3b88
.long 0x3bfa0000,0xacb50000,0x3b990000,0xb5050000,0xacb50000,0xbbfa0000,0xb5050000,0xbb990000
.long 0x3bce0000,0x33030000,0x389b0000,0x3a8a0000,0xb3030000,0x3bce0000,0xba8a0000,0x389b0000
.long 0x3b770000,0xb5c20000,0xa6480000,0xbbff0000,0xb5c20000,0xbb770000,0xbbff0000,0x26480000
.long 0x3af60000,0x37e30000,0xb8ec0000,0x3a4f0000,0xb7e30000,0x3af60000,0xba4f0000,0xb8ec0000
.long 0x3c00,0x3c00,0x3c00,0x3c00,0xbc00,0xbc00,0xbc00,0xbc00
.long 0x38c4,0xb8c4,0x30b2,0xb0b2,0xba6d,0x3a6d,0xbbea,0x3bea
.long 0xb4a5,0xb4a5,0xbba8,0xbba8,0xbba8,0xbba8,0xb4a5,0xb4a5
.long 0xbb88,0x3b88,0xb6d7,0x36d7,0xb564,0x3564,0x3b3b,0xbb3b
.long 0x3b250000,0xb7320000,0x3a0f0000,0xb93a0000,0xb7320000,0xbb250000,0xb93a0000,0xba0f0000
.long 0x31790000,0x3be20000,0xb8480000,0x3ac20000,0xbbe20000,0x31790000,0xbac20000,0xb8480000
.long 0xb9840000,0xb9cb0000,0xbb500000,0x367c0000,0xb9cb0000,0x39840000,0x367c0000,0x3b500000
.long 0xbbf10000,0xafd60000,0x34440000,0xbbb60000,0x2fd60000,0xbbf10000,0x3bb60000,0x34440000
.long 0x3c00,0x3c00,0x3c00,0x3c00,0x3c00,0x3c00,0x3c00,0x3c00
.long 0xb0b2,0x30b2,0xb8c4,0x38c4,0xbbea,0x3bea,0xba6d,0x3a6d
.long 0xbba8,0xbba8,0xb4a5,0xb4a5,0x34a5,0x34a5,0x3ba8,0x3ba8
.long 0x36d7,0xb6d7,0x3b88,0xbb88,0x3b3b,0xbb3b,0xb564,0x3564
.long 0x393a0000,0xba0f0000,0x37320000,0xbb250000,0xba0f0000,0xb93a0000,0xbb250000,0xb7320000
.long 0xbac20000,0x38480000,0xbbe20000,0xb1790000,0xb8480000,0xbac20000,0x31790000,0xbbe20000
.long 0xb67c0000,0x3b500000,0x39cb0000,0x39840000,0x3b500000,0x367c0000,0x39840000,0xb9cb0000
.long 0x3bb60000,0xb4440000,0x2fd60000,0x3bf10000,0x34440000,0x3bb60000,0xbbf10000,0x2fd60000
.long 0x3c00,0x3c00,0x3c00,0x3c00,0xbc00,0xbc00,0xbc00,0xbc00
.long 0xba6d,0x3a6d,0xbbea,0x3bea,0xb8c4,0x38c4,0xb0b2,0x30b2
.long 0x34a5,0x34a5,0x3ba8,0x3ba8,0x3ba8,0x3ba8,0x34a5,0x34a5
.long 0x3564,0xb564,0xbb3b,0x3b3b,0xbb88,0x3b88,0xb6d7,0x36d7
.long 0x35050000,0xbb990000,0x2cb50000,0xbbfa0000,0xbb990000,0xb5050000,0xbbfa0000,0xacb50000
.long 0xba8a0000,0xb89b0000,0xb3030000,0xbbce0000,0x389b0000,0xba8a0000,0x3bce0000,0xb3030000
.long 0x3bff0000,0x26480000,0x35c20000,0xbb770000,0x26480000,0xbbff0000,0xbb770000,0xb5c20000
.long 0xba4f0000,0x38ec0000,0xb7e30000,0xbaf60000,0xb8ec0000,0xba4f0000,0x3af60000,0xb7e30000
.long 0x3c00,0x3c00,0x3c00,0x3c00,0x3c00,0x3c00,0x3c00,0x3c00
.long 0x3bd9,0xbbd9,0x3aa7,0xbaa7,0xb23e,0x323e,0xb872,0x3872
.long 0x3b64,0x3b64,0x361f,0x361f,0xb61f,0xb61f,0xbb64,0xbb64
.long 0x3aa7,0xbaa7,0xb23e,0x323e,0xb872,0x3872,0xbbd9,0x3bd9
.long 0x3bf60000,0xae460000,0x3ba80000,0xb4a50000,0xae460000,0xbbf60000,0xb4a50000,0xbba80000
.long 0x3ba80000,0x34a50000,0x39130000,0x3a2f0000,0xb4a50000,0x3ba80000,0xba2f0000,0x39130000
.long 0x3b0e0000,0xb78b0000,0x2e460000,0xbbf60000,0xb78b0000,0xbb0e0000,0xbbf60000,0xae460000
.long 0x3a2f0000,0x39130000,0xb78b0000,0x3b0e0000,0xb9130000,0x3a2f0000,0xbb0e0000,0xb78b0000
.long 0x3c00,0x3c00,0x3c00,0x3c00,0xbc00,0xbc00,0xbc00,0xbc00
.long 0x3872,0xb872,0x323e,0xb23e,0xbaa7,0x3aa7,0xbbd9,0x3bd9
.long 0xb61f,0xb61f,0xbb64,0xbb64,0xbb64,0xbb64,0xb61f,0xb61f
.long 0xbbd9,0x3bd9,0xb872,0x3872,0xb23e,0x323e,0x3aa7,0xbaa7
.long 0x3b0e0000,0xb78b0000,0x3a2f0000,0xb9130000,0xb78b0000,0xbb0e0000,0xb9130000,0xba2f0000
.long 0x2e460000,0x3bf60000,0xb78b0000,0x3b0e0000,0xbbf60000,0x2e460000,0xbb0e0000,0xb78b0000
.long 0xba2f0000,0xb9130000,0xbba80000,0x34a50000,0xb9130000,0x3a2f0000,0x34a50000,0x3ba80000
.long 0xbba80000,0xb4a50000,0x2e460000,0xbbf60000,0x34a50000,0xbba80000,0x3bf60000,0x2e460000
.long 0x3c00,0x3c00,0x3c00,0x3c00,0x3c00,0x3c00,0x3c00,0x3c00
.long 0xb23e,0x323e,0xb872,0x3872,0xbbd9,0x3bd9,0xbaa7,0x3aa7
.long 0xbb64,0xbb64,0xb61f,0xb61f,0x361f,0x361f,0x3b64,0x3b64
.long 0x3872,0xb872,0x3bd9,0xbbd9,0x3aa7,0xbaa7,0xb23e,0x323e
.long 0x39130000,0xba2f0000,0x378b0000,0xbb0e0000,0xba2f0000,0xb9130000,0xbb0e0000,0xb78b0000
.long 0xbb0e0000,0x378b0000,0xbbf60000,0xae460000,0xb78b0000,0xbb0e0000,0x2e460000,0xbbf60000
.long 0xb4a50000,0x3ba80000,0x39130000,0x3a2f0000,0x3ba80000,0x34a50000,0x3a2f0000,0xb9130000
.long 0x3bf60000,0xae460000,0x34a50000,0x3ba80000,0x2e460000,0x3bf60000,0xbba80000,0x34a50000
.long 0x3c00,0x3c00,0x3c00,0x3c00,0xbc00,0xbc00,0xbc00,0xbc00
.long 0xbaa7,0x3aa7,0xbbd9,0x3bd9,0xb872,0x3872,0xb23e,0x323e
.long 0x361f,0x361f,0x3b64,0x3b64,0x3b64,0x3b64,0x361f,0x361f
.long 0x323e,0xb23e,0xbaa7,0x3aa7,0xbbd9,0x3bd9,0xb872,0x3872
.long 0x34a50000,0xbba80000,0x2e460000,0xbbf60000,0xbba80000,0xb4a50000,0xbbf60000,0xae460000
.long 0xba2f0000,0xb9130000,0xb4a50000,0xbba80000,0x39130000,0xba2f0000,0x3ba80000,0xb4a50000
.long 0x3bf60000,0xae460000,0x378b0000,0xbb0e0000,0xae460000,0xbbf60000,0xbb0e0000,0xb78b0000
.long 0xbb0e0000,0x378b0000,0xb9130000,0xba2f0000,0xb78b0000,0xbb0e0000,0x3a2f0000,0xb9130000
.long 0x3c00,0x3c00,0x3c00,0x3c00,0x3c00,0x3c00,0x3c00,0x3c00
.long 0x3bc3,0xbbc3,0x3add,0xbadd,0xb3c6,0x33c6,0xb81d,0x381d
.long 0x3b0e,0x3b0e,0x378b,0x378b,0xb78b,0xb78b,0xbb0e,0xbb0e
.long 0x39ed,0xb9ed,0xaa48,0x2a48,0xb95f,0x395f,0xbbfe,0x3bfe
.long 0x3bf10000,0xafd60000,0x3bb60000,0xb4440000,0xafd60000,0xbbf10000,0xb4440000,0xbbb60000
.long 0x3b770000,0x35c20000,0x39840000,0x39cb0000,0xb5c20000,0x3b770000,0xb9cb0000,0x39840000
.long 0x3a8a0000,0xb89b0000,0x33030000,0xbbce0000,0xb89b0000,0xba8a0000,0xbbce0000,0xb3030000
.long 0x393a0000,0x3a0f0000,0xb5050000,0x3b990000,0xba0f0000,0x393a0000,0xbb990000,0xb5050000
.long 0x3c00,0x3c00,0x3c00,0x3c00,0xbc00,0xbc00,0xbc00,0xbc00
.long 0x381d,0xb81d,0x33c6,0xb3c6,0xbadd,0x3add,0xbbc3,0x3bc3
.long 0xb78b,0xb78b,0xbb0e,0xbb0e,0xbb0e,0xbb0e,0xb78b,0xb78b
.long 0xbbfe,0x3bfe,0xb95f,0x395f,0xaa48,0x2a48,0x39ed,0xb9ed
.long 0x3af60000,0xb7e30000,0x3a4f0000,0xb8ec0000,0xb7e30000,0xbaf60000,0xb8ec0000,0xba4f0000
.long 0x26480000,0x3bff0000,0xb67c0000,0x3b500000,0xbbff0000,0x26480000,0xbb500000,0xb67c0000
.long 0xbac20000,0xb8480000,0xbbe20000,0x31790000,0xb8480000,0x3ac20000,0x31790000,0x3be20000
.long 0xbb250000,0xb7320000,0xacb50000,0xbbfa0000,0x37320000,0xbb250000,0x3bfa0000,0xacb50000
.long 0x3c00,0x3c00,0x3c00,0x3c00,0x3c00,0x3c00,0x3c00,0x3c00
.long 0xb3c6,0x33c6,0xb81d,0x381d,0xbbc3,0x3bc3,0xbadd,0x3add
.long 0xbb0e,0xbb0e,0xb78b,0xb78b,0x378b,0x378b,0x3b0e,0x3b0e
.long 0x395f,0xb95f,0x3bfe,0xbbfe,0x39ed,0xb9ed,0xaa48,0x2a48
.long 0x38ec0000,0xba4f0000,0x37e30000,0xbaf60000,0xba4f0000,0xb8ec0000,0xbaf60000,0xb7e30000
.long 0xbb500000,0x367c0000,0xbbff0000,0xa6480000,0xb67c0000,0xbb500000,0x26480000,0xbbff0000
.long 0xb1790000,0x3be20000,0x38480000,0x3ac20000,0x3be20000,0x31790000,0x3ac20000,0xb8480000
.long 0x3bfa0000,0x2cb50000,0x37320000,0x3b250000,0xacb50000,0x3bfa0000,0xbb250000,0x37320000
.long 0x3c00,0x3c00,0x3c00,0x3c00,0xbc00,0xbc00,0xbc00,0xbc00
.long 0xbadd,0x3add,0xbbc3,0x3bc3,0xb81d,0x381d,0xb3c6,0x33c6
.long 0x378b,0x378b,0x3b0e,0x3b0e,0x3b0e,0x3b0e,0x378b,0x378b
.long 0x2a48,0xaa48,0xb9ed,0x39ed,0xbbfe,0x3bfe,0xb95f,0x395f
.long 0x34440000,0xbbb60000,0x2fd60000,0xbbf10000,0xbbb60000,0xb4440000,0xbbf10000,0xafd60000
.long 0xb9cb0000,0xb9840000,0xb5c20000,0xbb770000,0x39840000,0xb9cb0000,0x3b770000,0xb5c20000
.long 0x3bce0000,0xb3030000,0x389b0000,0xba8a0000,0xb3030000,0xbbce0000,0xba8a0000,0xb89b0000
.long 0xbb990000,0x35050000,0xba0f0000,0xb93a0000,0xb5050000,0xbb990000,0x393a0000,0xba0f0000
.long 0x3c00,0x3c00,0x3c00,0x3c00,0x3c00,0x3c00,0x3c00,0x3c00
.long 0x3ba8,0xbba8,0x3b0e,0xbb0e,0xb4a5,0x34a5,0xb78b,0x378b
.long 0x3aa7,0x3aa7,0x3872,0x3872,0xb872,0xb872,0xbaa7,0xbaa7
.long 0x3913,0xb913,0x2e46,0xae46,0xba2f,0x3a2f,0xbbf6,0x3bf6
.long 0x3bea0000,0xb0b20000,0x3bc30000,0xb3c60000,0xb0b20000,0xbbea0000,0xb3c60000,0xbbc30000
.long 0x3b3b0000,0x36d70000,0x39ed0000,0x395f0000,0xb6d70000,0x3b3b0000,0xb95f0000,0x39ed0000
.long 0x39ed0000,0xb95f0000,0x35640000,0xbb880000,0xb95f0000,0xb9ed0000,0xbb880000,0xb5640000
.long 0x381d0000,0x3add0000,0xb0b20000,0x3bea0000,0xbadd0000,0x381d0000,0xbbea0000,0xb0b20000
.long 0x3c00,0x3c00,0x3c00,0x3c00,0xbc00,0xbc00,0xbc00,0xbc00
.long 0x378b,0xb78b,0x34a5,0xb4a5,0xbb0e,0x3b0e,0xbba8,0x3ba8
.long 0xb872,0xb872,0xbaa7,0xbaa7,0xbaa7,0xbaa7,0xb872,0xb872
.long 0xbbf6,0x3bf6,0xba2f,0x3a2f,0x2e46,0xae46,0x3913,0xb913
.long 0x3add0000,0xb81d0000,0x3a6d0000,0xb8c40000,0xb81d0000,0xbadd0000,0xb8c40000,0xba6d0000
.long 0xaa480000,0x3bfe0000,0xb5640000,0x3b880000,0xbbfe0000,0xaa480000,0xbb880000,0xb5640000
.long 0xbb3b0000,0xb6d70000,0xbbfe0000,0x2a480000,0xb6d70000,0x3b3b0000,0x2a480000,0x3bfe0000
.long 0xba6d0000,0xb8c40000,0xb3c60000,0xbbc30000,0x38c40000,0xba6d0000,0x3bc30000,0xb3c60000
.long 0x3c00,0x3c00,0x3c00,0x3c00,0x3c00,0x3c00,0x3c00,0x3c00
.long 0xb4a5,0x34a5,0xb78b,0x378b,0xbba8,0x3ba8,0xbb0e,0x3b0e
.long 0xbaa7,0xbaa7,0xb872,0xb872,0x3872,0x3872,0x3aa7,0x3aa7
.long 0x3a2f,0xba2f,0x3bf6,0xbbf6,0x3913,0xb913,0x2e46,0xae46
.long 0x38c40000,0xba6d0000,0x381d0000,0xbadd0000,0xba6d0000,0xb8c40000,0xbadd0000,0xb81d0000
.long 0xbb880000,0x35640000,0xbbfe0000,0x2a480000,0xb5640000,0xbb880000,0xaa480000,0xbbfe0000
.long 0xaa480000,0x3bfe0000,0x36d70000,0x3b3b0000,0x3bfe0000,0x2a480000,0x3b3b0000,0xb6d70000
.long 0x3bc30000,0x33c60000,0x38c40000,0x3a6d0000,0xb3c60000,0x3bc30000,0xba6d0000,0x38c40000
.long 0x3c00,0x3c00,0x3c00,0x3c00,0xbc00,0xbc00,0xbc00,0xbc00
.long 0xbb0e,0x3b0e,0xbba8,0x3ba8,0xb78b,0x378b,0xb4a5,0x34a5
.long 0x3872,0x3872,0x3aa7,0x3aa7,0x3aa7,0x3aa7,0x3872,0x3872
.long 0xae46,0x2e46,0xb913,0x3913,0xbbf6,0x3bf6,0xba2f,0x3a2f
.long 0x33c60000,0xbbc30000,0x30b20000,0xbbea0000,0xbbc30000,0xb3c60000,0xbbea0000,0xb0b20000
.long 0xb95f0000,0xb9ed0000,0xb6d70000,0xbb3b0000,0x39ed0000,0xb95f0000,0x3b3b0000,0xb6d70000
.long 0x3b880000,0xb5640000,0x395f0000,0xb9ed0000,0xb5640000,0xbb880000,0xb9ed0000,0xb95f0000
.long 0xbbea0000,0x30b20000,0xbadd0000,0xb81d0000,0xb0b20000,0xbbea0000,0x381d0000,0xbadd0000
.long 0x3c00,0x3c00,0x3c00,0x3c00,0x3c00,0x3c00,0x3c00,0x3c00
.long 0x3b88,0xbb88,0x3b3b,0xbb3b,0xb564,0x3564,0xb6d7,0x36d7
.long 0x3a2f,0x3a2f,0x3913,0x3913,0xb913,0xb913,0xba2f,0xba2f
.long 0x381d,0xb81d,0x33c6,0xb3c6,0xbadd,0x3add,0xbbc3,0x3bc3
.long 0x3be20000,0xb1790000,0x3bce0000,0xb3030000,0xb1790000,0xbbe20000,0xb3030000,0xbbce0000
.long 0x3af60000,0x37e30000,0x3a4f0000,0x38ec0000,0xb7e30000,0x3af60000,0xb8ec0000,0x3a4f0000
.long 0x393a0000,0xba0f0000,0x37320000,0xbb250000,0xba0f0000,0xb93a0000,0xbb250000,0xb7320000
.long 0x35c20000,0x3b770000,0x26480000,0x3bff0000,0xbb770000,0x35c20000,0xbbff0000,0x26480000
.long 0x3c00,0x3c00,0x3c00,0x3c00,0xbc00,0xbc00,0xbc00,0xbc00
.long 0x36d7,0xb6d7,0x3564,0xb564,0xbb3b,0x3b3b,0xbb88,0x3b88
.long 0xb913,0xb913,0xba2f,0xba2f,0xba2f,0xba2f,0xb913,0xb913
.long 0xbbc3,0x3bc3,0xbadd,0x3add,0x33c6,0xb3c6,0x381d,0xb81d
.long 0x3ac20000,0xb8480000,0x3a8a0000,0xb89b0000,0xb8480000,0xbac20000,0xb89b0000,0xba8a0000
.long 0xafd60000,0x3bf10000,0xb4440000,0x3bb60000,0xbbf10000,0xafd60000,0xbbb60000,0xb4440000
.long 0xbb990000,0xb5050000,0xbbfa0000,0xacb50000,0xb5050000,0x3b990000,0xacb50000,0x3bfa0000
.long 0xb9840000,0xb9cb0000,0xb67c0000,0xbb500000,0x39cb0000,0xb9840000,0x3b500000,0xb67c0000
.long 0x3c00,0x3c00,0x3c00,0x3c00,0x3c00,0x3c00,0x3c00,0x3c00
.long 0xb564,0x3564,0xb6d7,0x36d7,0xbb88,0x3b88,0xbb3b,0x3b3b
.long 0xba2f,0xba2f,0xb913,0xb913,0x3913,0x3913,0x3a2f,0x3a2f
.long 0x3add,0xbadd,0x3bc3,0xbbc3,0x381d,0xb81d,0x33c6,0xb3c6
.long 0x389b0000,0xba8a0000,0x38480000,0xbac20000,0xba8a0000,0xb89b0000,0xbac20000,0xb8480000
.long 0xbbb60000,0x34440000,0xbbf10000,0x2fd60000,0xb4440000,0xbbb60000,0xafd60000,0xbbf10000
.long 0x2cb50000,0x3bfa0000,0x35050000,0x3b990000,0x3bfa0000,0xacb50000,0x3b990000,0xb5050000
.long 0x3b500000,0x367c0000,0x39cb0000,0x39840000,0xb67c0000,0x3b500000,0xb9840000,0x39cb0000
.long 0x3c00,0x3c00,0x3c00,0x3c00,0xbc00,0xbc00,0xbc00,0xbc00
.long 0xbb3b,0x3b3b,0xbb88,0x3b88,0xb6d7,0x36d7,0xb564,0x3564
.long 0x3913,0x3913,0x3a2f,0x3a2f,0x3a2f,0x3a2f,0x3913,0x3913
.long 0xb3c6,0x33c6,0xb81d,0x381d,0xbbc3,0x3bc3,0xbadd,0x3add
.long 0x33030000,0xbbce0000,0x31790000,0xbbe20000,0xbbce0000,0xb3030000,0xbbe20000,0xb1790000
.long 0xb8ec0000,0xba4f0000,0xb7e30000,0xbaf60000,0x3a4f0000,0xb8ec0000,0x3af60000,0xb7e30000
.long 0x3b250000,0xb7320000,0x3a0f0000,0xb93a0000,0xb7320000,0xbb250000,0xb93a0000,0xba0f0000
.long 0xbbff0000,0xa6480000,0xbb770000,0xb5c20000,0x26480000,0xbbff0000,0x35c20000,0xbb770000
.long 0x3c00,0x3c00,0x3c00,0x3c00,0x3c00,0xbc00,0x361f3b64,0xb61f3b64
.long 0x3c00,0x3c00,0x39a839a8,0xb9a839a8,0x3c00,0xbc00,0x3b64361f,0xbb64361f
.long 0x3c00,0x3c00,0x3c000000,0xbc008000,0x3c00,0xbc00,0x3b64b61f,0xbb64b61f
.long 0x3c00,0x3c00,0x39a8b9a8,0xb9a8b9a8,0x3c00,0xbc00,0x361fbb64,0xb61fbb64
.long 0x3c00,0x3c00,0xbc00,0xbc00,0x3c00,0xbc00,0xb61fbb64,0x361fbb64
.long 0x3c00,0x3c00,0xb9a8b9a8,0x39a8b9a8,0x3c00,0xbc00,0xbb64b61f,0x3b64b61f
.long 0x3c00,0x3c00,0xbc008000,0x3c000000,0x3c00,0xbc00,0xbb64361f,0x3b64361f
.long 0x3c00,0x3c00,0xb9a839a8,0x39a839a8,0x3c00,0xbc00,0xb61f3b64,0x361f3b64
.long 0x3c00,0x3c00,0x3c00,0x3c00,0x39a839a8,0xb9a839a8,0x3b64361f,0xbb64361f
.long 0x3c000000,0xbc008000,0x39a8b9a8,0xb9a8b9a8,0x39a8b9a8,0xb9a8b9a8,0xb61fbb64,0x361fbb64
.long 0xbc00,0xbc00,0xbc008000,0x3c000000,0xb9a8b9a8,0x39a8b9a8,0xb61f3b64,0x361f3b64
.long 0xbc008000,0x3c000000,0x39a839a8,0xb9a839a8,0xb9a839a8,0x39a839a8,0x3b64b61f,0xbb64b61f
.long 0x3c00,0x3c00,0xbc00,0xbc00,0x39a839a8,0xb9a839a8,0xbb64b61f,0x3b64b61f
.long 0x3c000000,0xbc008000,0xb9a839a8,0x39a839a8,0x39a8b9a8,0xb9a8b9a8,0x361f3b64,0xb61f3b64
.long 0xbc00,0xbc00,0x3c000000,0xbc008000,0xb9a8b9a8,0x39a8b9a8,0x361fbb64,0xb61fbb64
.long 0xbc008000,0x3c000000,0xb9a8b9a8,0x39a8b9a8,0xb9a839a8,0x39a839a8,0xbb64361f,0x3b64361f
.long 0x3c00,0x3c00,0x3c00,0x3c00,0x3c000000,0xbc008000,0x3b64b61f,0xbb64b61f
.long 0xbc00,0xbc00,0xb9a8b9a8,0x39a8b9a8,0xbc008000,0x3c000000,0xb61f3b64,0x361f3b64
.long 0x3c00,0x3c00,0x3c000000,0xbc008000,0x3c000000,0xbc008000,0xb61fbb64,0x361fbb64
.long 0xbc00,0xbc00,0xb9a839a8,0x39a839a8,0xbc008000,0x3c000000,0x3b64361f,0xbb64361f
.long 0x3c00,0x3c00,0xbc00,0xbc00,0x3c000000,0xbc008000,0xbb64361f,0x3b64361f
.long 0xbc00,0xbc00,0x39a839a8,0xb9a839a8,0xbc008000,0x3c000000,0x361fbb64,0xb61fbb64
.long 0x3c00,0x3c00,0xbc008000,0x3c000000,0x3c000000,0xbc008000,0x361f3b64,0xb61f3b64
.long 0xbc00,0xbc00,0x39a8b9a8,0xb9a8b9a8,0xbc008000,0x3c000000,0xbb64b61f,0x3b64b61f
.long 0x3c00,0x3c00,0x3c00,0x3c00,0x39a8b9a8,0xb9a8b9a8,0x361fbb64,0xb61fbb64
.long 0xbc008000,0x3c000000,0xb9a839a8,0x39a839a8,0x39a839a8,0xb9a839a8,0x3b64b61f,0xbb64b61f
.long 0xbc00,0xbc00,0xbc008000,0x3c000000,0xb9a839a8,0x39a839a8,0x3b64361f,0xbb64361f
.long 0x3c000000,0xbc008000,0xb9a8b9a8,0x39a8b9a8,0xb9a8b9a8,0x39a8b9a8,0x361f3b64,0xb61f3b64
.long 0x3c00,0x3c00,0xbc00,0xbc00,0x39a8b9a8,0xb9a8b9a8,0xb61f3b64,0x361f3b64
.long 0xbc008000,0x3c000000,0x39a8b9a8,0xb9a8b9a8,0x39a839a8,0xb9a839a8,0xbb64361f,0x3b64361f
.long 0xbc00,0xbc00,0x3c000000,0xbc008000,0xb9a839a8,0x39a839a8,0xbb64b61f,0x3b64b61f
.long 0x3c000000,0xbc008000,0x39a839a8,0xb9a839a8,0xb9a8b9a8,0x39a8b9a8,0xb61fbb64,0x361fbb64
.long 0x3c008000,0x3c008000,0x3c008000,0x3c008000,0x3c008000,0xbc008000,0x3b64b61f,0x3b64361f
.long 0x3c008000,0x3c008000,0x39a8b9a8,0x39a839a8,0x3c008000,0xbc008000,0x361fbb64,0x361f3b64
.long 0x3c008000,0x3c008000,0xbc00,0x80003c00,0x3c008000,0xbc008000,0xb61fbb64,0xb61f3b64
.long 0x3c008000,0x3c008000,0xb9a8b9a8,0xb9a839a8,0x3c008000,0xbc008000,0xbb64b61f,0xbb64361f
.long 0x3c008000,0x3c008000,0xbc008000,0xbc008000,0x3c008000,0xbc008000,0xbb64361f,0xbb64b61f
.long 0x3c008000,0x3c008000,0xb9a839a8,0xb9a8b9a8,0x3c008000,0xbc008000,0xb61f3b64,0xb61fbb64
.long 0x3c008000,0x3c008000,0x80003c00,0xbc00,0x3c008000,0xbc008000,0x361f3b64,0x361fbb64
.long 0x3c008000,0x3c008000,0x39a839a8,0x39a8b9a8,0x3c008000,0xbc008000,0x3b64361f,0x3b64b61f
.long 0x3c008000,0x3c008000,0x3c008000,0x3c008000,0x39a8b9a8,0x39a839a8,0x361fbb64,0x361f3b64
.long 0xbc00,0x80003c00,0xb9a8b9a8,0xb9a839a8,0xb9a8b9a8,0xb9a839a8,0xbb64361f,0xbb64b61f
.long 0xbc008000,0xbc008000,0x80003c00,0xbc00,0xb9a839a8,0xb9a8b9a8,0x3b64361f,0x3b64b61f
.long 0x80003c00,0xbc00,0x39a8b9a8,0x39a839a8,0x39a839a8,0x39a8b9a8,0xb61fbb64,0xb61f3b64
.long 0x3c008000,0x3c008000,0xbc008000,0xbc008000,0x39a8b9a8,0x39a839a8,0xb61f3b64,0xb61fbb64
.long 0xbc00,0x80003c00,0x39a839a8,0x39a8b9a8,0xb9a8b9a8,0xb9a839a8,0x3b64b61f,0x3b64361f
.long 0xbc008000,0xbc008000,0xbc00,0x80003c00,0xb9a839a8,0xb9a8b9a8,0xbb64b61f,0xbb64361f
.long 0x80003c00,0xbc00,0xb9a839a8,0xb9a8b9a8,0x39a839a8,0x39a8b9a8,0x361f3b64,0x361fbb64
.long 0x3c008000,0x3c008000,0x3c008000,0x3c008000,0xbc00,0x80003c00,0xb61fbb64,0xb61f3b64
.long 0xbc008000,0xbc008000,0xb9a839a8,0xb9a8b9a8,0x80003c00,0xbc00,0x3b64361f,0x3b64b61f
.long 0x3c008000,0x3c008000,0xbc00,0x80003c00,0xbc00,0x80003c00,0xbb64361f,0xbb64b61f
.long 0xbc008000,0xbc008000,0x39a839a8,0x39a8b9a8,0x80003c00,0xbc00,0x361fbb64,0x361f3b64
.long 0x3c008000,0x3c008000,0xbc008000,0xbc008000,0xbc00,0x80003c00,0x361f3b64,0x361fbb64
.long 0xbc008000,0xbc008000,0x39a8b9a8,0x39a839a8,0x80003c00,0xbc00,0xbb64b61f,0xbb64361f
.long 0x3c008000,0x3c008000,0x80003c00,0xbc00,0xbc00,0x80003c00,0x3b64b61f,0x3b64361f
.long 0xbc008000,0xbc008000,0xb9a8b9a8,0xb9a839a8,0x80003c00,0xbc00,0xb61f3b64,0xb61fbb64
.long 0x3c008000,0x3c008000,0x3c008000,0x3c008000,0xb9a8b9a8,0xb9a839a8,0xbb64b61f,0xbb64361f
.long 0x80003c00,0xbc00,0x39a839a8,0x39a8b9a8,0x39a8b9a8,0x39a839a8,0xb61fbb64,0xb61f3b64
.long 0xbc008000,0xbc008000,0x80003c00,0xbc00,0x39a839a8,0x39a8b9a8,0x361fbb64,0x361f3b64
.long 0xbc00,0x80003c00,0xb9a839a8,0xb9a8b9a8,0xb9a839a8,0xb9a8b9a8,0x3b64b61f,0x3b64361f
.long 0x3c008000,0x3c008000,0xbc008000,0xbc008000,0xb9a8b9a8,0xb9a839a8,0x3b64361f,0x3b64b61f
.long 0x80003c00,0xbc00,0xb9a8b9a8,0xb9a839a8,0x39a8b9a8,0x39a839a8,0x361f3b64,0x361fbb64
.long 0xbc008000,0xbc008000,0xbc00,0x80003c00,0x39a839a8,0x39a8b9a8,0xb61f3b64,0xb61fbb64
.long 0xbc00,0x80003c00,0x39a8b9a8,0x39a839a8,0xb9a839a8,0xb9a8b9a8,0xbb64361f,0xbb64b61f
.long 0x3800,0x3800,0x3800,0x3800,0x3c00,0xbc00,0x3b64,0x3b64
.long 0x3c00,0x3c00,0x39a8,0x39a8,0x3c00,0xbc00,0x361f,0x361f
.long 0x3c00,0x3c00,0x0,0x8000,0x3c00,0xbc00,0xb61f,0xb61f
.long 0x3c00,0x3c00,0xb9a8,0xb9a8,0x3c00,0xbc00,0xbb64,0xbb64
.long 0x3c000000,0x0,0x3bd90000,0xbbd90000,0x3c000000,0x80000000,0x3aa70000,0xbaa70000
.long 0x3c000000,0x0,0x38720000,0xb8720000,0x3c000000,0x80000000,0x323e0000,0xb23e0000
.long 0x3c000000,0x0,0xb23e0000,0x323e0000,0x3c000000,0x80000000,0xb8720000,0x38720000
.long 0x3c000000,0x0,0xbaa70000,0x3aa70000,0x3c000000,0x80000000,0xbbd90000,0x3bd90000
.long 0x3800,0x3800,0x3800,0x3800,0x39a8,0x39a8,0x361f,0x361f
.long 0x0,0x8000,0xb9a8,0xb9a8,0xb9a8,0xb9a8,0xbb64,0xbb64
.long 0xbc00,0xbc00,0x8000,0x0,0xb9a8,0xb9a8,0x3b64,0x3b64
.long 0x8000,0x0,0x39a8,0x39a8,0x39a8,0x39a8,0xb61f,0xb61f
.long 0x3b640000,0xbb640000,0x3aa70000,0xbaa70000,0x361f0000,0xb61f0000,0xb23e0000,0x323e0000
.long 0xb61f0000,0x361f0000,0xbbd90000,0x3bd90000,0xbb640000,0x3b640000,0xb8720000,0x38720000
.long 0xbb640000,0x3b640000,0x38720000,0xb8720000,0xb61f0000,0x361f0000,0x3bd90000,0xbbd90000
.long 0x361f0000,0xb61f0000,0x323e0000,0xb23e0000,0x3b640000,0xbb640000,0xbaa70000,0x3aa70000
.long 0x3800,0x3800,0x3800,0x3800,0x0,0x8000,0xb61f,0xb61f
.long 0xbc00,0xbc00,0xb9a8,0xb9a8,0x8000,0x0,0x3b64,0x3b64
.long 0x3c00,0x3c00,0x0,0x8000,0x0,0x8000,0xbb64,0xbb64
.long 0xbc00,0xbc00,0x39a8,0x39a8,0x8000,0x0,0x361f,0x361f
.long 0x39a80000,0xb9a80000,0x38720000,0xb8720000,0xb9a80000,0x39a80000,0xbbd90000,0x3bd90000
.long 0xb9a80000,0x39a80000,0x323e0000,0xb23e0000,0x39a80000,0xb9a80000,0x3aa70000,0xbaa70000
.long 0x39a80000,0xb9a80000,0xbaa70000,0x3aa70000,0xb9a80000,0x39a80000,0xb23e0000,0x323e0000
.long 0xb9a80000,0x39a80000,0x3bd90000,0xbbd90000,0x39a80000,0xb9a80000,0xb8720000,0x38720000
.long 0x3800,0x3800,0x3800,0x3800,0xb9a8,0xb9a8,0xbb64,0xbb64
.long 0x8000,0x0,0x39a8,0x39a8,0x39a8,0x39a8,0xb61f,0xb61f
.long 0xbc00,0xbc00,0x8000,0x0,0x39a8,0x39a8,0x361f,0x361f
.long 0x0,0x8000,0xb9a8,0xb9a8,0xb9a8,0xb9a8,0x3b64,0x3b64
.long 0x361f0000,0xb61f0000,0x323e0000,0xb23e0000,0xbb640000,0x3b640000,0xb8720000,0x38720000
.long 0x3b640000,0xbb640000,0x3aa70000,0xbaa70000,0xb61f0000,0x361f0000,0xbbd90000,0x3bd90000
.long 0xb61f0000,0x361f0000,0x3bd90000,0xbbd90000,0x3b640000,0xbb640000,0xbaa70000,0x3aa70000
.long 0xbb640000,0x3b640000,0x38720000,0xb8720000,0x361f0000,0xb61f0000,0xb23e0000,0x323e0000
.long 0x3800,0x3800,0xb800,0xb800,0x8000,0x8000,0xb61f,0x361f
.long 0x8000,0x8000,0xb9a8,0x39a8,0x8000,0x8000,0xbb64,0x3b64
.long 0x8000,0x8000,0xbc00,0x3c00,0x8000,0x8000,0xbb64,0x3b64
.long 0x8000,0x8000,0xb9a8,0x39a8,0x8000,0x8000,0xb61f,0x361f
.long 0x80000000,0xbc000000,0xb23e0000,0xb23e0000,0x80000000,0x3c000000,0xb8720000,0xb8720000
.long 0x80000000,0xbc000000,0xbaa70000,0xbaa70000,0x80000000,0x3c000000,0xbbd90000,0xbbd90000
.long 0x80000000,0xbc000000,0xbbd90000,0xbbd90000,0x80000000,0x3c000000,0xbaa70000,0xbaa70000
.long 0x80000000,0xbc000000,0xb8720000,0xb8720000,0x80000000,0x3c000000,0xb23e0000,0xb23e0000
.long 0x3800,0x3800,0xb800,0xb800,0xb9a8,0x39a8,0xbb64,0x3b64
.long 0xbc00,0x3c00,0xb9a8,0x39a8,0xb9a8,0x39a8,0x361f,0xb61f
.long 0x8000,0x8000,0x3c00,0xbc00,0x39a8,0xb9a8,0x361f,0xb61f
.long 0x3c00,0xbc00,0xb9a8,0x39a8,0x39a8,0xb9a8,0xbb64,0x3b64
.long 0xb61f0000,0xb61f0000,0xb8720000,0xb8720000,0xbb640000,0xbb640000,0xbbd90000,0xbbd90000
.long 0xbb640000,0xbb640000,0xb23e0000,0xb23e0000,0xb61f0000,0xb61f0000,0x3aa70000,0x3aa70000
.long 0x361f0000,0x361f0000,0x3aa70000,0x3aa70000,0x3b640000,0x3b640000,0xb23e0000,0xb23e0000
.long 0x3b640000,0x3b640000,0xbbd90000,0xbbd90000,0x361f0000,0x361f0000,0xb8720000,0xb8720000
.long 0x3800,0x3800,0xb800,0xb800,0xbc00,0x3c00,0xbb64,0x3b64
.long 0x8000,0x8000,0x39a8,0xb9a8,0x3c00,0xbc00,0x361f,0xb61f
.long 0x8000,0x8000,0xbc00,0x3c00,0xbc00,0x3c00,0x361f,0xb61f
.long 0x8000,0x8000,0x39a8,0xb9a8,0x3c00,0xbc00,0xbb64,0x3b64
.long 0xb9a80000,0xb9a80000,0xbaa70000,0xbaa70000,0xb9a80000,0xb9a80000,0xb23e0000,0xb23e0000
.long 0x39a80000,0x39a80000,0x3bd90000,0x3bd90000,0x39a80000,0x39a80000,0xb8720000,0xb8720000
.long 0xb9a80000,0xb9a80000,0xb8720000,0xb8720000,0xb9a80000,0xb9a80000,0x3bd90000,0x3bd90000
.long 0x39a80000,0x39a80000,0xb23e0000,0xb23e0000,0x39a80000,0x39a80000,0xbaa70000,0xbaa70000
.long 0x3800,0x3800,0xb800,0xb800,0xb9a8,0x39a8,0xb61f,0x361f
.long 0x3c00,0xbc00,0x39a8,0xb9a8,0xb9a8,0x39a8,0xbb64,0x3b64
.long 0x8000,0x8000,0x3c00,0xbc00,0x39a8,0xb9a8,0xbb64,0x3b64
.long 0xbc00,0x3c00,0x39a8,0xb9a8,0x39a8,0xb9a8,0xb61f,0x361f
.long 0xbb640000,0xbb640000,0xbbd90000,0xbbd90000,0x361f0000,0x361f0000,0x3aa70000,0x3aa70000
.long 0x361f0000,0x361f0000,0xb8720000,0xb8720000,0xbb640000,0xbb640000,0x323e0000,0x323e0000
.long 0x3b640000,0x3b640000,0x323e0000,0x323e0000,0xb61f0000,0xb61f0000,0xb8720000,0xb8720000
.long 0xb61f0000,0xb61f0000,0x3aa70000,0x3aa70000,0x3b640000,0x3b640000,0xbbd90000,0xbbd90000
tab_end:
.size tables, 36864
.section .rodata,"a"
.p2align 6
.amdhsa_kernel adaLN_cond__spectral_fnet__moe_arch_mod__prompt_kernel
  .amdhsa_next_free_vgpr 256
  .amdhsa_next_free_sgpr 102
  .amdhsa_accum_offset 256
  .amdhsa_group_segment_fixed_size 0
  .amdhsa_kernarg_size 120
  .amdhsa_user_sgpr_count 2
  .amdhsa_user_sgpr_kernarg_segment_ptr 1
  .amdhsa_system_sgpr_workgroup_id_x 1
  .amdhsa_float_denorm_mode_32 3
  .amdhsa_float_denorm_mode_16_64 3
.end_amdhsa_kernel
```

```asm
; @launch grid=(256,1,1) block=(512,1,1) lds=139264
.amdgcn_target "amdgcn-amd-amdhsa--gfx950"
.text
.globl adaLN_cond__spectral_fnet__moe_arch_mod__prompt_kernel
.p2align 8
.type adaLN_cond__spectral_fnet__moe_arch_mod__prompt_kernel,@function
adaLN_cond__spectral_fnet__moe_arch_mod__prompt_kernel:
    s_cmp_ge_u32 s2, 256
    s_cbranch_scc1 k_done
    s_load_dwordx2 s[4:5], s[0:1], 0
    s_load_dwordx8 s[20:27], s[0:1], 80
    s_load_dwordx2 s[6:7], s[0:1], 112
    s_load_dwordx8 s[48:55], s[0:1], 48
    s_getpc_b64 s[62:63]
k_pc:
    v_lshrrev_b32 v1, 6, v0
    v_and_b32 v2, 63, v0
    v_readfirstlane_b32 s16, v1
    v_lshlrev_b32 v3, 4, v2
    s_and_b32 s34, s2, 7
    s_lshr_b32 s35, s2, 4
    s_bitcmp1_b32 s2, 3
    s_cbranch_scc0 f_start
    s_lshl_b32 s40, s35, 3
    s_add_u32 s40, s40, s16
    s_lshl_b32 s40, s40, 9
    v_lshl_add_u32 v4, v2, 7, s40
    v_min_u32 v4, tab_end-k_pc-4, v4
    s_mov_b64 exec, 15
    global_load_dword v250, v4, s[62:63]
    s_mov_b64 exec, -1
    v_bfe_u32 v7, v0, 4, 2
    v_lshlrev_b32 v4, 1, v7
    v_xor_b32 v4, v4, v0
    v_and_b32 v4, 15, v4
    v_lshlrev_b32 v4, 4, v4
    s_movk_i32 s42, 12288
    v_mad_u32_u24 v4, v7, s42, v4
    v_xor_b32 v31, 0x80, v4
    s_and_b32 s17, s35, 7
    s_lshr_b32 s41, s35, 3
    s_lshl_b32 s18, s34, 3
    s_add_u32 s18, s18, s16
    s_mul_i32 s18, s18, 196608
    s_lshl_b32 s68, s16, 12
    s_xor_b32 s70, s35, 8
    s_lshl_b32 s70, s70, 8
    s_add_u32 s70, s70, s18
    s_mov_b32 s10, 12582912
    s_mov_b32 s11, 0x00020000
    s_mov_b32 m0, s68
    s_waitcnt lgkmcnt(0)
    s_mov_b32 s8, s22
    s_mov_b32 s9, s23
    buffer_load_dwordx4 v4, s[8:11], s70 offen offset:0  lds
    s_add_u32 s70, s70, 48128
    buffer_load_dwordx4 v4, s[8:11], s70 offen offset:1024  lds
    s_add_u32 s70, s70, 48128
    buffer_load_dwordx4 v31, s[8:11], s70 offen offset:2048  lds
    s_add_u32 s70, s70, 48128
    buffer_load_dwordx4 v31, s[8:11], s70 offen offset:3072  lds
    s_branch g_start
f_start:
    s_add_u32 s62, s62, tables-k_pc
    s_addc_u32 s63, s63, 0
    s_lshl_b32 s43, s16, 11
    v_add_u32 v79, s43, v3
    s_add_u32 s40, s43, 33280
    s_lshl_b32 s42, s16, 10
    s_add_u32 s43, s42, 16384
    s_cmp_eq_u32 s34, 0
    s_cselect_b32 s68, 8192, 0
    s_add_u32 s43, s43, s68
    v_add_u32 v77, s43, v3
    s_or_b32 s69, s34, s16
    s_cselect_b32 s68, 0, 2048
    s_add_u32 s68, s68, 32768
    v_add_u32 v78, s68, v3
    s_sub_u32 s17, 16, s34
    s_cmp_eq_u32 s34, 0
    s_cselect_b32 s17, 8, s17
    s_bitcmp1_b32 s35, 0
    s_cselect_b32 s17, s17, s34
    s_lshr_b32 s36, s35, 1
    s_lshl_b32 s36, s36, 4
    s_add_u32 s17, s17, s36
    s_lshl_b32 s36, s16, 8
    s_add_u32 s36, s36, s17
    s_lshl_b32 s36, s36, 11
    s_add_u32 s37, s36, 262144
    s_mov_b32 s10, 4194304
    s_mov_b32 s11, 0x00020000
    v_and_b32 v170, 15, v0
    v_bfe_u32 v171, v0, 4, 2
    v_lshrrev_b32 v72, 1, v170
    v_and_b32 v73, 1, v0
    v_cmp_eq_u32 vcc, 1, v170
    v_mov_b32 v74, s17
    s_nop 0
    v_cndmask_b32_e64 v72, v72, 8, vcc
    v_cndmask_b32_e64 v74, v74, 0, vcc
    v_cndmask_b32_e64 v73, v73, 0, vcc
    v_lshl_add_u32 v74, v171, 9, v74
    s_waitcnt lgkmcnt(0)
    s_mov_b32 s8, s4
    s_mov_b32 s9, s5
    buffer_load_dwordx4 v[32:35], v3, s[8:11], s36 offen offset:0
    buffer_load_dwordx4 v[40:43], v3, s[8:11], s37 offen offset:0
    buffer_load_dwordx4 v[36:39], v3, s[8:11], s36 offen offset:1024
    buffer_load_dwordx4 v[44:47], v3, s[8:11], s37 offen offset:1024
    s_mov_b32 s43, 6619136
    s_load_dword s101, s[6:7], s43
    s_mov_b32 s12, s6
    s_mov_b32 s13, s7
    s_mov_b32 s14, 268435456
    s_mov_b32 s15, 0x00020000
    s_mov_b32 s20, s52
    s_mov_b32 s21, s53
    s_mov_b32 s22, 7340032
    s_mov_b32 s23, 0x00020000
    s_mov_b32 s26, 4194304
    s_mov_b32 s27, 0x00020000
    s_getreg_b32 s39, hwreg(HW_REG_XCC_ID)
    s_and_b32 s39, s39, 7
    v_mul_u32_u24 v74, v72, v74
    v_lshl_add_u32 v74, v73, 9, v74
    v_lshlrev_b32 v72, 7, v72
    v_and_b32 v48, 2047, v74
    v_add_u32 v74, v74, v72
    v_and_b32 v49, 2047, v74
    v_add_u32 v74, v74, v72
    v_and_b32 v50, 2047, v74
    v_add_u32 v74, v74, v72
    v_and_b32 v51, 2047, v74
    v_cvt_f32_u32 v48, v48
    v_cvt_f32_u32 v49, v49
    v_cvt_f32_u32 v50, v50
    v_cvt_f32_u32 v51, v51
    v_mul_f32 v48, 0x3a000000, v48
    v_mul_f32 v49, 0x3a000000, v49
    v_mul_f32 v50, 0x3a000000, v50
    v_mul_f32 v51, 0x3a000000, v51
    v_cos_f32 v48, v48
    v_cos_f32 v49, v49
    v_cos_f32 v50, v50
    v_cos_f32 v51, v51
    v_mul_f32 v48, 0x3d800000, v48
    v_mul_f32 v49, 0x3d800000, v49
    v_mul_f32 v50, 0x3d800000, v50
    v_mul_f32 v51, 0x3d800000, v51
    v_lshlrev_b32 v160, 20, v171
    v_lshl_add_u32 v160, v1, 15, v160
    v_lshl_add_u32 v160, v170, 4, v160
    v_mul_u32_u24 v161, 4128, v1
    v_add_u32 v161, v161, v3
    v_lshrrev_b32 v72, 2, v2
    v_mul_u32_u24 v162, 2064, v72
    v_and_b32 v72, 3, v0
    v_lshl_add_u32 v162, v72, 7, v162
    v_lshl_add_u32 v162, v1, 3, v162
    v_lshlrev_b32 v163, 4, v171
    v_add_u32 v163, 103040, v163
    v_lshlrev_b32 v164, 3, v171
    v_add_u32 v164, 103104, v164
    v_lshrrev_b32 v72, 5, v0
    v_lshlrev_b32 v165, 2, v72
    v_add_u32 v11, 102912, v165
    v_add_u32 v165, 103040, v165
    v_lshlrev_b32 v166, 1, v72
    v_add_u32 v166, 103104, v166
    v_mov_b32 v168, 0
    v_and_b32 v169, 1, v0
    v_lshlrev_b32 v169, 3, v169
    s_lshl_b32 s3, s34, 4
    s_and_b32 s64, s35, 1
    s_lshl_b32 s64, s64, 3
    s_lshr_b32 s65, s35, 1
    s_add_u32 s64, s64, s65
    s_and_b32 s65, s16, 3
    s_xor_b32 s64, s64, s65
    s_add_u32 s64, s64, s3
    s_add_u32 s3, s3, s35
    s_lshl_b32 s64, s64, 8
    s_add_u32 s64, s64, 0
    s_add_u32 s65, s64, 262144
    s_add_u32 s66, s64, 524288
    s_add_u32 s67, s64, 786432
    s_mov_b32 s44, 0x3f803f80
    s_mov_b32 s46, 0x3a800000
    s_mov_b32 s33, 196611
    s_lshl_b32 s60, s35, 3
    s_add_u32 s60, s60, s16
    s_lshl_b32 s30, s60, 4
    s_add_u32 s30, s30, s34
    s_cmp_lg_u32 s34, 0
    s_cbranch_scc1 f_g1
    s_cmp_ge_u32 s16, 4
    s_cselect_b32 s31, 56, 0
    s_sub_u32 s30, s30, s31
    s_cmp_lg_u32 s16, 0
    s_cbranch_scc1 f_g1
    s_cmp_ge_u32 s35, 8
    s_cselect_b32 s31, 960, 0
    s_sub_u32 s30, s30, s31
f_g1:
    s_sub_u32 s31, 2048, s30
    s_cmp_eq_u32 s30, 0
    s_cselect_b32 s31, 1024, s31
    s_lshl_b32 s18, s30, 11
    s_lshl_b32 s19, s31, 11
    s_lshl_b32 s61, s34, 19
    s_add_u32 s61, s61, 0
    s_lshl_b32 s28, s60, 8
    s_add_u32 s28, s28, s61
    s_add_u32 s29, s28, 131072
    s_add_u32 s50, s28, 262144
    s_add_u32 s51, s28, 393216
    s_lshl_b32 s73, s35, 15
    s_add_u32 s73, s73, s61
    s_lshl_b32 s42, s16, 12
    s_add_u32 s72, s73, s42
    s_add_u32 s45, s42, 49664
    s_lshl_b32 s42, s16, 8
    s_add_u32 s74, s73, s42
    s_add_u32 s75, s74, 4096
    s_lshl_b32 s76, s34, 7
    s_add_u32 s77, s76, 6509568
    s_add_u32 s76, s76, 6508544
    s_lshl_b32 s78, s35, 3
    s_add_u32 s79, s78, s77
    s_add_u32 s78, s78, s76
    s_lshl_b32 s80, s3, 4
    s_add_u32 s80, s80, 4947968
    s_lshl_b32 s81, s34, 12
    s_add_u32 s81, s81, 4947968
    s_lshl_b32 s82, s35, 11
    s_add_u32 s82, s82, 6291456
    v_cvt_f32_u32 v75, v170
    s_lshl_b32 s42, s35, 2
    s_and_b32 s43, s16, 3
    s_add_u32 s42, s42, s43
    v_lshl_add_u32 v76, v171, 8, s42
    v_mul_f32 v75, 0x3a800000, v75
    v_cvt_f32_u32 v76, v76
    v_mul_f32 v60, v76, v75
    v_fmamk_f32 v61, v75, 0x42800000, v60
    v_fmamk_f32 v62, v75, 0x43000000, v60
    v_fmamk_f32 v63, v75, 0x43400000, v60
    v_cos_f32 v64, v60
    v_cos_f32 v65, v61
    v_cos_f32 v66, v62
    v_cos_f32 v67, v63
    v_sin_f32 v68, v60
    v_sin_f32 v69, v61
    v_sin_f32 v70, v62
    v_sin_f32 v71, v63
    v_cvt_pk_f16_f32 v144, v64, v68
    v_cvt_pk_f16_f32 v145, v65, v69
    v_cvt_pk_f16_f32 v146, v66, v70
    v_cvt_pk_f16_f32 v147, v67, v71
    s_mov_b32 m0, s40
    s_nop 0
    global_load_lds_dwordx4 v79, s[62:63]
    global_load_lds_dwordx4 v79, s[62:63] offset:1024
    global_load_dwordx4 v[20:23], v77, s[62:63]
    global_load_dwordx4 v[24:27], v78, s[62:63]
    global_load_dwordx4 v[28:31], v78, s[62:63] offset:1024
    s_waitcnt lgkmcnt(0)
    s_mul_i32 s32, s101, 0x9e3779b1
    s_or_b32 s32, s32, 0x101
    s_and_b32 s32, s32, 0xfffefbfb
    s_and_b32 s56, s32, 0xff
    s_bfe_u32 s57, s32, 0x80008
    s_bfe_u32 s58, s32, 0x80010
    s_lshr_b32 s59, s32, 24
    v_lshrrev_b32 v16, v169, s32
    v_lshrrev_b32 v17, 2, v16
    v_lshrrev_b32 v18, 4, v16
    v_lshrrev_b32 v19, 6, v16
    v_mov_b32 v72, s32
    v_mov_b32 v73, s39
    v_mov_b32 v74, 111488
    s_cmp_eq_u32 s16, 0
    s_cselect_b64 exec, 1, 0
    ds_write_b32 v74, v168 offset:4
    buffer_store_dwordx2 v[72:73], v168, s[12:15], s78 offen sc1
    s_mov_b64 exec, -1
    v_mov_b32 v72, -1
    ds_write_b32 v11, v72 offset:64
    s_waitcnt vmcnt(9)
    ds_write_b128 v161, v[32:35] offset:0
    v_dot2_f32_bf16 v52, v32, s44, 0
    v_dot2_f32_bf16 v54, v32, v32, 0
    v_dot2_f32_bf16 v52, v33, s44, v52
    v_dot2_f32_bf16 v54, v33, v33, v54
    v_dot2_f32_bf16 v52, v34, s44, v52
    v_dot2_f32_bf16 v54, v34, v34, v54
    v_dot2_f32_bf16 v52, v35, s44, v52
    v_dot2_f32_bf16 v54, v35, v35, v54
    s_waitcnt vmcnt(8)
    ds_write_b128 v161, v[40:43] offset:2064
    v_dot2_f32_bf16 v53, v40, s44, 0
    v_dot2_f32_bf16 v55, v40, v40, 0
    v_dot2_f32_bf16 v53, v41, s44, v53
    v_dot2_f32_bf16 v55, v41, v41, v55
    v_dot2_f32_bf16 v53, v42, s44, v53
    v_dot2_f32_bf16 v55, v42, v42, v55
    v_dot2_f32_bf16 v53, v43, s44, v53
    v_dot2_f32_bf16 v55, v43, v43, v55
    s_waitcnt vmcnt(7)
    ds_write_b128 v161, v[36:39] offset:1024
    v_dot2_f32_bf16 v52, v36, s44, v52
    v_dot2_f32_bf16 v54, v36, v36, v54
    v_dot2_f32_bf16 v52, v37, s44, v52
    v_dot2_f32_bf16 v54, v37, v37, v54
    v_dot2_f32_bf16 v52, v38, s44, v52
    v_dot2_f32_bf16 v54, v38, v38, v54
    v_dot2_f32_bf16 v52, v39, s44, v52
    v_dot2_f32_bf16 v54, v39, v39, v54
    s_waitcnt vmcnt(6)
    ds_write_b128 v161, v[44:47] offset:3088
    v_dot2_f32_bf16 v53, v44, s44, v53
    v_dot2_f32_bf16 v55, v44, v44, v55
    v_dot2_f32_bf16 v53, v45, s44, v53
    v_dot2_f32_bf16 v55, v45, v45, v55
    v_dot2_f32_bf16 v53, v46, s44, v53
    v_dot2_f32_bf16 v55, v46, v46, v55
    v_dot2_f32_bf16 v53, v47, s44, v53
    v_dot2_f32_bf16 v55, v47, v47, v55
    s_nop 2
    v_permlane32_swap_b32 v52, v53
    v_permlane32_swap_b32 v54, v55
    v_add_f32 v52, v52, v53
    v_add_f32 v54, v54, v55
    s_nop 0
    v_add_f32_dpp v52, v52, v52 row_ror:8 row_mask:0xf bank_mask:0xf
    v_add_f32_dpp v54, v54, v54 row_ror:8 row_mask:0xf bank_mask:0xf
    s_nop 0
    v_add_f32_dpp v52, v52, v52 row_ror:4 row_mask:0xf bank_mask:0xf
    v_add_f32_dpp v54, v54, v54 row_ror:4 row_mask:0xf bank_mask:0xf
    s_nop 0
    v_add_f32_dpp v52, v52, v52 row_ror:2 row_mask:0xf bank_mask:0xf
    v_add_f32_dpp v54, v54, v54 row_ror:2 row_mask:0xf bank_mask:0xf
    s_nop 0
    v_add_f32_dpp v52, v52, v52 row_ror:1 row_mask:0xf bank_mask:0xf
    v_add_f32_dpp v54, v54, v54 row_ror:1 row_mask:0xf bank_mask:0xf
    s_nop 0
    v_add_f32_dpp v52, v52, v52 row_bcast:15 row_mask:0xa bank_mask:0xf
    v_add_f32_dpp v54, v54, v54 row_bcast:15 row_mask:0xa bank_mask:0xf
    v_mul_f32 v52, s46, v52
    v_mul_f32 v54, s46, v54
    v_mul_f32 v64, v52, v52
    v_cvt_pk_bf16_f32 v56, -v52, -v52
    v_sub_f32 v54, v54, v64
    v_mul_f32 v66, 0x44000000, v54
    v_cmp_gt_f32 vcc, v64, v66
    s_or_b32 s68, vcc_lo, vcc_hi
    s_bitcmp1_b32 s68, 31
    s_cbranch_scc1 f_slowvar
f_var:
    v_cvt_pk_bf16_f32 v54, v54, v54
    v_lshlrev_b32 v54, 16, v54
    v_add_f32 v54, 0x3727c5ac, v54
    v_cvt_pk_bf16_f32 v54, v54, v54
    v_lshlrev_b32 v54, 16, v54
    v_sqrt_f32 v54, v54
    s_nop 0
    v_cvt_pk_bf16_f32 v54, v54, v54
    v_lshlrev_b32 v54, 16, v54
    v_rcp_f32 v54, v54
    s_mov_b32 exec_lo, 0x80000000
    s_mov_b32 exec_hi, 0x80000000
    ds_write_b16 v166, v56
    ds_write_b32 v165, v54
    s_mov_b64 exec, -1
    s_waitcnt lgkmcnt(0)
    s_barrier
    ds_read_b128 v[60:63], v163
    ds_read_b64 v[64:65], v164
    ds_read_b64_tr_b16 v[80:81], v162 offset:0
    ds_read_b64_tr_b16 v[82:83], v162 offset:512
    ds_read_b64_tr_b16 v[84:85], v162 offset:1024
    ds_read_b64_tr_b16 v[86:87], v162 offset:1536
    ds_read_b64_tr_b16 v[88:89], v162 offset:64
    ds_read_b64_tr_b16 v[90:91], v162 offset:576
    ds_read_b64_tr_b16 v[92:93], v162 offset:1088
    ds_read_b64_tr_b16 v[94:95], v162 offset:1600
    s_waitcnt lgkmcnt(8)
    v_pk_mul_f32 v[48:49], v[48:49], v[60:61]
    v_pk_mul_f32 v[50:51], v[50:51], v[62:63]
    v_cvt_pk_bf16_f32 v58, v48, v49
    v_cvt_pk_bf16_f32 v59, v50, v51
    s_nop 1
    v_mfma_f32_16x16x16_bf16 v[96:99], v[58:59], v[64:65], 0
    s_waitcnt lgkmcnt(0)
    v_mfma_f32_16x16x16_bf16 v[100:103], v[58:59], v[80:81], v[96:99]
    v_mfma_f32_16x16x16_bf16 v[104:107], v[58:59], v[82:83], v[96:99]
    v_mfma_f32_16x16x16_bf16 v[108:111], v[58:59], v[84:85], v[96:99]
    v_mfma_f32_16x16x16_bf16 v[112:115], v[58:59], v[86:87], v[96:99]
    v_mfma_f32_16x16x16_bf16 v[116:119], v[58:59], v[88:89], v[96:99]
    v_mfma_f32_16x16x16_bf16 v[120:123], v[58:59], v[90:91], v[96:99]
    v_mfma_f32_16x16x16_bf16 v[124:127], v[58:59], v[92:93], v[96:99]
    v_mfma_f32_16x16x16_bf16 v[128:131], v[58:59], v[94:95], v[96:99]
    s_nop 0
    v_cvt_pk_f16_f32 v176, v100, v101
    v_cvt_pk_f16_f32 v177, v104, v105
    v_cvt_pk_f16_f32 v178, v108, v109
    v_cvt_pk_f16_f32 v179, v112, v113
    v_bfi_b32 v176, s33, v16, v176
    v_bfi_b32 v177, s33, v17, v177
    v_bfi_b32 v178, s33, v18, v178
    v_bfi_b32 v179, s33, v19, v179
    buffer_store_dwordx4 v[176:179], v160, s[12:15], s64 offen sc1
    v_cvt_pk_f16_f32 v180, v102, v103
    v_cvt_pk_f16_f32 v181, v106, v107
    v_cvt_pk_f16_f32 v182, v110, v111
    v_cvt_pk_f16_f32 v183, v114, v115
    v_bfi_b32 v180, s33, v16, v180
    v_bfi_b32 v181, s33, v17, v181
    v_bfi_b32 v182, s33, v18, v182
    v_bfi_b32 v183, s33, v19, v183
    buffer_store_dwordx4 v[180:183], v160, s[12:15], s66 offen sc1
    v_cvt_pk_f16_f32 v184, v116, v117
    v_cvt_pk_f16_f32 v185, v120, v121
    v_cvt_pk_f16_f32 v186, v124, v125
    v_cvt_pk_f16_f32 v187, v128, v129
    v_bfi_b32 v184, s33, v16, v184
    v_bfi_b32 v185, s33, v17, v185
    v_bfi_b32 v186, s33, v18, v186
    v_bfi_b32 v187, s33, v19, v187
    buffer_store_dwordx4 v[184:187], v160, s[12:15], s65 offen sc1
    v_cvt_pk_f16_f32 v188, v118, v119
    v_cvt_pk_f16_f32 v189, v122, v123
    v_cvt_pk_f16_f32 v190, v126, v127
    v_cvt_pk_f16_f32 v191, v130, v131
    v_bfi_b32 v188, s33, v16, v188
    v_bfi_b32 v189, s33, v17, v189
    v_bfi_b32 v190, s33, v18, v190
    v_bfi_b32 v191, s33, v19, v191
    buffer_store_dwordx4 v[188:191], v160, s[12:15], s67 offen sc1
    s_waitcnt vmcnt(4)
    s_barrier
    v_mov_b32 v48, v170
    v_mov_b32 v49, v171
    v_mov_b32 v50, s32
    v_mov_b32 v51, s39
    s_cmp_lg_u32 s16, 0
    s_cbranch_scc1 f_nzl
    s_lshl_b32 s68, s3, 7
    s_add_u32 s68, s68, 6520832
    v_mov_b32 v52, 0
    s_mov_b64 exec, 1
    buffer_store_dwordx2 v[50:51], v52, s[12:15], s68 offen sc1
    s_mov_b64 exec, -1
f_nzl:
    ds_read_b128 v[192:195], v3 offset:33280
    ds_read_b128 v[196:199], v3 offset:34304
    ds_read_b128 v[200:203], v3 offset:35328
    ds_read_b128 v[204:207], v3 offset:36352
    ds_read_b128 v[208:211], v3 offset:37376
    ds_read_b128 v[212:215], v3 offset:38400
    ds_read_b128 v[216:219], v3 offset:39424
    ds_read_b128 v[220:223], v3 offset:40448
    ds_read_b128 v[224:227], v3 offset:41472
    ds_read_b128 v[228:231], v3 offset:42496
    ds_read_b128 v[232:235], v3 offset:43520
    ds_read_b128 v[236:239], v3 offset:44544
    v_lshlrev_b32 v4, 15, v49
    v_lshl_add_u32 v4, v48, 4, v4
    v_lshlrev_b32 v14, 13, v49
    v_lshl_add_u32 v14, v48, 4, v14
    v_lshl_add_u32 v254, v1, 10, v14
    v_xor_b32 v255, 64, v254
    v_lshrrev_b32 v57, 1, v1
    v_lshlrev_b32 v252, 13, v57
    v_and_b32 v57, 1, v1
    v_lshl_add_u32 v252, v57, 3, v252
    v_lshl_add_u32 v252, v49, 11, v252
    v_and_b32 v57, 3, v0
    v_lshl_add_u32 v252, v57, 8, v252
    v_lshrrev_b32 v58, 2, v48
    v_lshl_add_u32 v252, v58, 4, v252
    v_and_b32 v59, 1, v0
    v_lshl_add_u32 v252, v59, 6, v252
    v_xor_b32 v253, 64, v252
    v_lshl_add_u32 v57, v49, 2, v57
    v_lshlrev_b32 v57, 4, v57
    v_lshl_add_u32 v250, v58, 8, v57
    v_add_u32 v5, 82432, v3
    v_sub_u32 v6, 83440, v3
    v_lshl_add_u32 v57, v48, 2, v49
    v_lshl_add_u32 v8, v57, 3, s45
    s_add_u32 s43, s45, 2552
    v_lshlrev_b32 v58, 3, v57
    v_sub_u32 v9, s43, v58
    v_add_u32 v57, 1, v57
    v_and_b32 v58, 3, v57
    v_and_b32 v57, 60, v57
    v_lshl_add_u32 v7, v58, 6, v57
    v_add_u32 v10, s45, v3
    v_lshlrev_b32 v12, 2, v48
    v_add_u32 v12, 102912, v12
    v_lshlrev_b32 v13, 12, v2
    v_and_b32 v251, 0x70, v3
    v_lshlrev_b32 v15, 4, v0
    v_and_b32 v57, 3, v0
    v_bfe_u32 v58, v0, 2, 4
    v_lshl_add_u32 v57, v57, 4, v58
    v_bfe_u32 v58, v0, 6, 2
    v_lshl_add_u32 v57, v58, 6, v57
    v_lshrrev_b32 v58, 8, v0
    v_lshl_add_u32 v57, v58, 9, v57
    v_lshlrev_b32 v57, 4, v57
    v_add_u32 v1, 82432, v57
    s_and_b32 s42, s35, 3
    s_lshl_b32 s42, s42, 8
    v_xor_b32 v249, s42, v3
    s_mov_b32 s44, 131074
    v_and_b32 v16, s33, v16
    v_and_b32 v17, s33, v17
    v_and_b32 v18, s33, v18
    v_and_b32 v19, s33, v19
    v_xor_b32 v16, s44, v16
    v_xor_b32 v17, s44, v17
    v_xor_b32 v18, s44, v18
    v_xor_b32 v19, s44, v19
    s_mov_b32 s41, 6496256
    s_and_b32 s40, s16, 4
    s_lshl_b32 s40, s40, 10
    s_sub_u32 s40, 6504448, s40
    s_lshl_b32 s54, s3, 13
    s_add_u32 s54, s54, 5242880
    s_lshr_b32 s43, s60, 6
    s_and_b32 s55, s60, 63
    s_mul_i32 s55, s55, 5
    s_lshl_b32 s43, s43, 9
    s_add_u32 s55, s55, s43
    s_add_u32 s55, s55, 192
    s_mul_i32 s55, s55, 7168
    s_mul_i32 s43, s34, 896
    s_add_u32 s55, s55, s43
    s_mov_b32 s48, 4294967295
    s_mov_b32 s49, 255
    s_cmp_lt_u32 s16, 0
    s_cselect_b64 s[48:49], 0, s[48:49]
    s_mov_b32 s52, 6488064
    s_mov_b32 s53, 6492160
    s_barrier
    s_mov_b32 m0, s45
    s_add_u32 s43, s45, 2048
    buffer_load_dwordx4 v3, s[8:11], s18 offen lds
    buffer_load_dwordx4 v3, s[8:11], s18 offen offset:1024 lds
    s_mov_b32 m0, s43
    s_nop 0
    buffer_load_dwordx4 v3, s[8:11], s19 offen lds
    buffer_load_dwordx4 v3, s[8:11], s19 offen offset:1024 lds
    buffer_load_dwordx4 v[244:247], v251, s[12:15], s76 offen
    v_add_u32 v248, 103296, v3
    s_mov_b32 s47, 2
    s_mov_b32 s4, 0
    s_mov_b32 s83, 0
    s_cmp_ge_u32 s16, 4
    s_cbranch_scc1 f_s0
    s_sleep 4
    s_cmp_lg_u32 s34, 0
    s_cbranch_scc1 f_ci0
    s_add_u32 s68, s82, 32768
    buffer_load_dwordx4 v[120:123], v250, s[12:15], s68 offen offset:0
    buffer_load_dwordx4 v[124:127], v250, s[12:15], s68 offen offset:1024
f_ci0:
    buffer_load_dwordx4 v[112:115], v250, s[12:15], s82 offen offset:0
    buffer_load_dwordx4 v[116:119], v250, s[12:15], s82 offen offset:1024
    s_mov_b32 s47, 0
    s_waitcnt vmcnt(0)
f_c1:
    v_xor_b32 v112, s56, v112
    v_xor_b32 v113, s57, v113
    v_xor_b32 v114, s58, v114
    v_xor_b32 v115, s59, v115
    v_xor_b32 v116, s56, v116
    v_xor_b32 v117, s57, v117
    v_xor_b32 v118, s58, v118
    v_xor_b32 v119, s59, v119
    v_or3_b32 v48, v112, v113, v114
    v_or3_b32 v48, v48, v115, v116
    v_or3_b32 v48, v48, v117, v118
    v_or_b32 v48, v48, v119
    v_and_b32 v48, 0xff, v48
    v_cmp_ne_u32 vcc, 0, v48
    s_cmp_lg_u32 s34, 0
    s_cbranch_scc1 f_c1n
    s_mov_b64 s[68:69], vcc
    v_xor_b32 v120, s56, v120
    v_xor_b32 v121, s57, v121
    v_xor_b32 v122, s58, v122
    v_xor_b32 v123, s59, v123
    v_xor_b32 v124, s56, v124
    v_xor_b32 v125, s57, v125
    v_xor_b32 v126, s58, v126
    v_xor_b32 v127, s59, v127
    v_or3_b32 v48, v120, v121, v122
    v_or3_b32 v48, v48, v123, v124
    v_or3_b32 v48, v48, v125, v126
    v_or_b32 v48, v48, v127
    v_and_b32 v48, 0xff, v48
    v_cmp_ne_u32 vcc, 0, v48
    s_or_b64 vcc, vcc, s[68:69]
f_c1n:
    s_cbranch_vccnz f_c1bad
f_c1ok:
    v_pk_add_f32 v[112:113], v[112:113], v[116:117]
    v_pk_add_f32 v[114:115], v[114:115], v[118:119]
    s_nop 0
    v_add_f32_dpp v112, v112, v112 row_ror:4 row_mask:0xf bank_mask:0xf
    v_add_f32_dpp v113, v113, v113 row_ror:4 row_mask:0xf bank_mask:0xf
    v_add_f32_dpp v114, v114, v114 row_ror:4 row_mask:0xf bank_mask:0xf
    v_add_f32_dpp v115, v115, v115 row_ror:4 row_mask:0xf bank_mask:0xf
    v_add_f32_dpp v112, v112, v112 row_ror:8 row_mask:0xf bank_mask:0xf
    v_add_f32_dpp v113, v113, v113 row_ror:8 row_mask:0xf bank_mask:0xf
    v_add_f32_dpp v114, v114, v114 row_ror:8 row_mask:0xf bank_mask:0xf
    v_add_f32_dpp v115, v115, v115 row_ror:8 row_mask:0xf bank_mask:0xf
    v_cvt_pk_bf16_f32 v48, v112, v113
    v_lshlrev_b32 v112, 16, v48
    v_and_b32 v113, 0xffff0000, v48
    v_cvt_pk_bf16_f32 v49, v114, v115
    v_lshlrev_b32 v114, 16, v49
    v_and_b32 v115, 0xffff0000, v49
    v_add_f32 v112, 1.0, v112
    v_add_f32 v113, 1.0, v113
    v_add_f32 v114, 1.0, v114
    v_add_f32 v115, 1.0, v115
    v_cvt_pk_bf16_f32 v48, v112, v113
    v_lshlrev_b32 v112, 16, v48
    v_and_b32 v113, 0xffff0000, v48
    v_cvt_pk_bf16_f32 v49, v114, v115
    v_lshlrev_b32 v114, 16, v49
    v_and_b32 v115, 0xffff0000, v49
    v_max_f32_e64 v48, abs(v112), abs(v113)
    v_max3_f32 v48, abs(v114), abs(v115), v48
    s_cmp_lg_u32 s34, 0
    s_cbranch_scc1 f_c1m
    v_mov_b32 v50, v48
    v_pk_add_f32 v[120:121], v[120:121], v[124:125]
    v_pk_add_f32 v[122:123], v[122:123], v[126:127]
    s_nop 0
    v_add_f32_dpp v120, v120, v120 row_ror:4 row_mask:0xf bank_mask:0xf
    v_add_f32_dpp v121, v121, v121 row_ror:4 row_mask:0xf bank_mask:0xf
    v_add_f32_dpp v122, v122, v122 row_ror:4 row_mask:0xf bank_mask:0xf
    v_add_f32_dpp v123, v123, v123 row_ror:4 row_mask:0xf bank_mask:0xf
    v_add_f32_dpp v120, v120, v120 row_ror:8 row_mask:0xf bank_mask:0xf
    v_add_f32_dpp v121, v121, v121 row_ror:8 row_mask:0xf bank_mask:0xf
    v_add_f32_dpp v122, v122, v122 row_ror:8 row_mask:0xf bank_mask:0xf
    v_add_f32_dpp v123, v123, v123 row_ror:8 row_mask:0xf bank_mask:0xf
    v_cvt_pk_bf16_f32 v48, v120, v121
    v_lshlrev_b32 v120, 16, v48
    v_and_b32 v121, 0xffff0000, v48
    v_cvt_pk_bf16_f32 v49, v122, v123
    v_lshlrev_b32 v122, 16, v49
    v_and_b32 v123, 0xffff0000, v49
    v_max3_f32 v48, abs(v120), abs(v121), v50
    v_max3_f32 v48, abs(v122), abs(v123), v48
f_c1m:
    s_nop 1
    v_max_f32_dpp v48, v48, v48 quad_perm:[1,0,3,2] row_mask:0xf bank_mask:0xf
    s_nop 1
    v_max_f32_dpp v48, v48, v48 quad_perm:[2,3,0,1] row_mask:0xf bank_mask:0xf
    s_nop 0
    v_readlane_b32 s68, v48, 0
    v_readlane_b32 s69, v48, 16
    v_readlane_b32 s70, v48, 32
    v_readlane_b32 s71, v48, 48
    s_max_u32 s68, s68, s69
    s_max_u32 s70, s70, s71
    s_max_u32 s68, s68, s70
    s_lshr_b32 s68, s68, 23
    s_sub_u32 s69, s68, 120
    s_sub_i32 s68, s68, 127
    s_max_i32 s68, s68, -100
    s_min_i32 s68, s68, 120
    s_cmp_le_u32 s69, 9
    s_cselect_b32 s68, 2, s68
    s_cselect_b32 s17, 0, 0x20000
    s_sub_i32 s69, 127, s68
    s_lshl_b32 s69, s69, 23
    s_bitcmp1_b32 s16, 0
    s_cselect_b64 s[64:65], -1, 0
    s_bitcmp1_b32 s16, 1
    s_cselect_b64 s[66:67], -1, 0
    s_lshl_b32 s70, s16, 11
    v_cndmask_b32 v112, v112, v113, s[64:65]
    v_cndmask_b32 v114, v114, v115, s[64:65]
    v_cndmask_b32 v112, v112, v114, s[66:67]
    v_mul_f32 v112, s69, v112
    v_add_u32 v53, s70, v248
    v_cvt_pk_f16_f32 v48, v112, v112
    s_nop 0
    s_nop 0
    v_mov_b32_dpp v56, v48 quad_perm:[0,0,0,0] row_mask:0xf bank_mask:0xf
    v_mov_b32_dpp v57, v48 quad_perm:[1,1,1,1] row_mask:0xf bank_mask:0xf
    v_mov_b32_dpp v58, v48 quad_perm:[2,2,2,2] row_mask:0xf bank_mask:0xf
    v_mov_b32_dpp v59, v48 quad_perm:[3,3,3,3] row_mask:0xf bank_mask:0xf
    v_pk_mul_f16 v64, v144, v56
    v_pk_mul_f16 v68, v144, v56 op_sel:[1,0] op_sel_hi:[0,1] neg_lo:[1,0]
    v_pk_mul_f16 v65, v145, v57
    v_pk_mul_f16 v69, v145, v57 op_sel:[1,0] op_sel_hi:[0,1] neg_lo:[1,0]
    v_pk_mul_f16 v66, v146, v58
    v_pk_mul_f16 v70, v146, v58 op_sel:[1,0] op_sel_hi:[0,1] neg_lo:[1,0]
    v_pk_mul_f16 v67, v147, v59
    v_pk_mul_f16 v71, v147, v59 op_sel:[1,0] op_sel_hi:[0,1] neg_lo:[1,0]
    ds_write_b128 v53, v[64:67]
    ds_write_b128 v53, v[68:71] offset:1024
    s_cmp_lg_u32 s16, 0
    s_cbranch_scc1 f_nkr
    v_mov_b32 v54, s17
    s_mov_b32 s61, s68
    s_cmp_eq_u32 s34, 0
    s_cselect_b32 s4, 1, s17
    s_mov_b64 exec, 1
    ds_write_b32 v248, v54 offset:8192
    s_mov_b64 exec, -1
f_nkr:
    s_cmp_eq_u32 s34, 0
    s_cbranch_scc1 f_sa
f_nsa:
    v_mov_b32 v54, 1
    s_mov_b64 exec, 1
    ds_add_u32 v248, v54 offset:8196
    s_mov_b64 exec, -1
    s_bitset1_b32 s47, 1
    s_bitcmp1_b32 s47, 0
    s_cbranch_scc1 f_bar
    s_branch f_s1
f_s0:
    s_sleep 8
f_s1:
    buffer_load_dwordx4 v[32:35], v249, s[12:15], s72 offen offset:0 sc1
    buffer_load_dwordx4 v[36:39], v249, s[12:15], s72 offen offset:1024 sc1
    buffer_load_dwordx4 v[40:43], v249, s[12:15], s72 offen offset:2048 sc1
    buffer_load_dwordx4 v[44:47], v249, s[12:15], s72 offen offset:3072 sc1
    s_waitcnt vmcnt(4)
    s_mov_b32 s83, 0
    ds_read_b64 v[96:97], v8 offset:0
    ds_read_b64 v[98:99], v8 offset:512
    ds_read_b64 v[100:101], v8 offset:1024
    ds_read_b64 v[102:103], v8 offset:1536
    ds_read_b64 v[104:105], v9 offset:1536
    ds_read_b64 v[106:107], v9 offset:1024
    ds_read_b64 v[108:109], v9 offset:512
    ds_read_b64 v[110:111], v9 offset:0
    v_xor_b32 v2, s32, v244
    v_bitop3_b32 v2, v2, v246, s32 bitop3:0xf6
    v_bitop3_b32 v2, v2, v245, s39 bitop3:0xf6
    v_bitop3_b32 v2, v2, v247, s39 bitop3:0xf6
    v_cmp_ne_u32 vcc, 0, v2
    s_mov_b32 s38, vcc_lo
    v_mov_b32 v244, 111488
    s_waitcnt lgkmcnt(0)
    v_lshlrev_b32 v160, 16, v96
    v_and_b32 v161, 0xffff0000, v96
    v_lshlrev_b32 v162, 16, v97
    v_and_b32 v163, 0xffff0000, v97
    v_lshlrev_b32 v164, 16, v98
    v_and_b32 v165, 0xffff0000, v98
    v_lshlrev_b32 v166, 16, v99
    v_and_b32 v167, 0xffff0000, v99
    v_lshlrev_b32 v168, 16, v100
    v_and_b32 v169, 0xffff0000, v100
    v_lshlrev_b32 v170, 16, v101
    v_and_b32 v171, 0xffff0000, v101
    v_lshlrev_b32 v172, 16, v102
    v_and_b32 v173, 0xffff0000, v102
    v_lshlrev_b32 v174, 16, v103
    v_and_b32 v175, 0xffff0000, v103
    v_lshlrev_b32 v176, 16, v104
    v_and_b32 v177, 0xffff0000, v104
    v_lshlrev_b32 v178, 16, v105
    v_and_b32 v179, 0xffff0000, v105
    v_lshlrev_b32 v180, 16, v106
    v_and_b32 v181, 0xffff0000, v106
    v_lshlrev_b32 v182, 16, v107
    v_and_b32 v183, 0xffff0000, v107
    v_lshlrev_b32 v184, 16, v108
    v_and_b32 v185, 0xffff0000, v108
    v_lshlrev_b32 v186, 16, v109
    v_and_b32 v187, 0xffff0000, v109
    v_lshlrev_b32 v188, 16, v110
    v_and_b32 v189, 0xffff0000, v110
    v_lshlrev_b32 v190, 16, v111
    v_and_b32 v191, 0xffff0000, v111
    ds_read_b32 v246, v244 offset:4
    s_waitcnt lgkmcnt(0)
    v_readfirstlane_b32 s43, v246
    s_cmp_lg_u32 s43, 4
    s_cbranch_scc1 f_t1
    ds_read_b128 v[112:115], v248 offset:0
    ds_read_b128 v[116:119], v248 offset:1024
    ds_read_b128 v[120:123], v248 offset:2048
    ds_read_b128 v[124:127], v248 offset:3072
    ds_read_b128 v[128:131], v248 offset:4096
    ds_read_b128 v[132:135], v248 offset:5120
    ds_read_b128 v[136:139], v248 offset:6144
    ds_read_b128 v[140:143], v248 offset:7168
    ds_read_b32 v245, v244
    s_bitset1_b32 s47, 2
f_t1:
f_z1:
    s_waitcnt vmcnt(2)
    v_xor_b32 v80, v32, v16
    v_xor_b32 v81, v36, v16
    v_xor_b32 v82, v33, v17
    v_xor_b32 v83, v37, v17
    v_xor_b32 v84, v34, v18
    v_xor_b32 v85, v38, v18
    v_xor_b32 v86, v35, v19
    v_xor_b32 v87, v39, v19
    v_mfma_f32_16x16x16_f16 v[48:51], v[20:21], v[80:81], 0
    v_xor_b32 v2, s44, v80
    v_bitop3_b32 v2, v2, v81, s44 bitop3:0xf6
    v_mfma_f32_16x16x16_f16 v[52:55], v[20:21], v[82:83], 0
    v_bitop3_b32 v2, v2, v82, s44 bitop3:0xf6
    v_bitop3_b32 v2, v2, v83, s44 bitop3:0xf6
    v_mfma_f32_16x16x16_f16 v[56:59], v[20:21], v[84:85], 0
    v_bitop3_b32 v2, v2, v84, s44 bitop3:0xf6
    v_bitop3_b32 v2, v2, v85, s44 bitop3:0xf6
    v_mfma_f32_16x16x16_f16 v[60:63], v[20:21], v[86:87], 0
    v_bitop3_b32 v2, v2, v86, s44 bitop3:0xf6
    v_bitop3_b32 v2, v2, v87, s44 bitop3:0xf6
    s_waitcnt vmcnt(0)
    v_xor_b32 v88, v40, v16
    v_xor_b32 v89, v44, v16
    v_xor_b32 v90, v41, v17
    v_xor_b32 v91, v45, v17
    v_xor_b32 v92, v42, v18
    v_xor_b32 v93, v46, v18
    v_xor_b32 v94, v43, v19
    v_xor_b32 v95, v47, v19
    v_mfma_f32_16x16x16_f16 v[64:67], v[22:23], v[88:89], 0
    v_bitop3_b32 v2, v2, v88, s44 bitop3:0xf6
    v_bitop3_b32 v2, v2, v89, s44 bitop3:0xf6
    v_mfma_f32_16x16x16_f16 v[68:71], v[22:23], v[90:91], 0
    v_bitop3_b32 v2, v2, v90, s44 bitop3:0xf6
    v_bitop3_b32 v2, v2, v91, s44 bitop3:0xf6
    v_mfma_f32_16x16x16_f16 v[72:75], v[22:23], v[92:93], 0
    v_bitop3_b32 v2, v2, v92, s44 bitop3:0xf6
    v_bitop3_b32 v2, v2, v93, s44 bitop3:0xf6
    v_mfma_f32_16x16x16_f16 v[76:79], v[22:23], v[94:95], 0
    v_bitop3_b32 v2, v2, v94, s44 bitop3:0xf6
    v_bitop3_b32 v2, v2, v95, s44 bitop3:0xf6
    v_and_b32 v2, s33, v2
    v_cmp_ne_u32 vcc, 0, v2
    s_cbranch_vccnz f_z1bad
f_z1ok:
    v_cvt_pk_f16_f32 v32, v48, v49
    v_cvt_pk_f16_f32 v33, v64, v65
    ds_write_b64 v252, v[32:33] offset:0
    v_cvt_pk_f16_f32 v34, v50, v51
    v_cvt_pk_f16_f32 v35, v66, v67
    ds_write_b64 v252, v[34:35] offset:1024
    v_cvt_pk_f16_f32 v36, v52, v53
    v_cvt_pk_f16_f32 v37, v68, v69
    ds_write_b64 v253, v[36:37] offset:0
    v_cvt_pk_f16_f32 v38, v54, v55
    v_cvt_pk_f16_f32 v39, v70, v71
    ds_write_b64 v253, v[38:39] offset:1024
    v_cvt_pk_f16_f32 v40, v56, v57
    v_cvt_pk_f16_f32 v41, v72, v73
    ds_write_b64 v252, v[40:41] offset:128
    v_cvt_pk_f16_f32 v42, v58, v59
    v_cvt_pk_f16_f32 v43, v74, v75
    ds_write_b64 v252, v[42:43] offset:1152
    v_cvt_pk_f16_f32 v44, v60, v61
    v_cvt_pk_f16_f32 v45, v76, v77
    ds_write_b64 v253, v[44:45] offset:128
    v_cvt_pk_f16_f32 v46, v62, v63
    v_cvt_pk_f16_f32 v47, v78, v79
    ds_write_b64 v253, v[46:47] offset:1152
    s_bitset1_b32 s47, 0
    s_mov_b32 s83, 0
    s_bitcmp1_b32 s47, 1
    s_cbranch_scc0 f_c1
    s_bitcmp1_b32 s47, 2
    s_cbranch_scc1 f_bar
    ds_read_b32 v246, v244 offset:4
    s_waitcnt lgkmcnt(0)
    v_readfirstlane_b32 s43, v246
    s_cmp_lg_u32 s43, 4
    s_cbranch_scc1 f_bar
    ds_read_b128 v[112:115], v248 offset:0
    ds_read_b128 v[116:119], v248 offset:1024
    ds_read_b128 v[120:123], v248 offset:2048
    ds_read_b128 v[124:127], v248 offset:3072
    ds_read_b128 v[128:131], v248 offset:4096
    ds_read_b128 v[132:135], v248 offset:5120
    ds_read_b128 v[136:139], v248 offset:6144
    ds_read_b128 v[140:143], v248 offset:7168
    ds_read_b32 v245, v244
    s_bitset1_b32 s47, 2
f_bar:
    s_waitcnt lgkmcnt(0)
    s_bitcmp1_b32 s47, 2
    s_barrier
    s_cbranch_scc0 f_t3l
f_t3d:
    ds_read_b128 v[32:35], v254 offset:0
    ds_read_b128 v[36:39], v255 offset:256
    ds_read_b128 v[40:43], v254 offset:512
    ds_read_b128 v[44:47], v255 offset:768
    v_xor_b32 v16, 65537, v16
    v_xor_b32 v17, 65537, v17
    v_xor_b32 v18, 65537, v18
    v_xor_b32 v19, 65537, v19
    s_waitcnt lgkmcnt(3)
    v_mfma_f32_16x16x32_f16 v[48:51], v[32:35], v[24:27], 0
    v_mfma_f32_16x16x32_f16 v[52:55], v[32:35], v[28:31], 0
    s_waitcnt lgkmcnt(2)
    v_mfma_f32_16x16x32_f16 v[56:59], v[36:39], v[24:27], 0
    v_mfma_f32_16x16x32_f16 v[60:63], v[36:39], v[28:31], 0
    s_waitcnt lgkmcnt(1)
    v_mfma_f32_16x16x32_f16 v[64:67], v[40:43], v[24:27], 0
    v_mfma_f32_16x16x32_f16 v[68:71], v[40:43], v[28:31], 0
    s_waitcnt lgkmcnt(0)
    v_mfma_f32_16x16x32_f16 v[72:75], v[44:47], v[24:27], 0
    v_mfma_f32_16x16x32_f16 v[76:79], v[44:47], v[28:31], 0
    v_mov_b32 v2, v245
    v_xor_b32 v19, v245, v19
    ds_read_b128 v[244:247], v3 offset:46592
    ds_read_b128 v[248:251], v3 offset:47616
    ds_read_b128 v[252:255], v3 offset:48640
    s_cmp_lt_u32 s16, 4
    s_cselect_b64 exec, -1, 0
    buffer_load_dwordx4 v[20:23], v15, s[12:15], s52 offen
    buffer_load_dwordx4 v[240:243], v15, s[12:15], s53 offen
    s_mov_b64 exec, -1
    v_cvt_pk_f16_f32 v144, v48, v52
    v_cvt_pk_f16_f32 v145, v49, v53
    v_cvt_pk_f16_f32 v146, v50, v54
    v_cvt_pk_f16_f32 v147, v51, v55
    v_cvt_pk_f16_f32 v148, v56, v60
    v_cvt_pk_f16_f32 v149, v57, v61
    v_cvt_pk_f16_f32 v150, v58, v62
    v_cvt_pk_f16_f32 v151, v59, v63
    v_mfma_f32_16x16x32_f16 v[80:83], v[144:147], v[112:115], 0
    v_mfma_f32_16x16x32_f16 v[84:87], v[144:147], v[116:119], 0
    v_cvt_pk_f16_f32 v152, v64, v68
    v_cvt_pk_f16_f32 v153, v65, v69
    v_cvt_pk_f16_f32 v154, v66, v70
    v_cvt_pk_f16_f32 v155, v67, v71
    v_mfma_f32_16x16x32_f16 v[88:91], v[148:151], v[120:123], 0
    v_mfma_f32_16x16x32_f16 v[92:95], v[148:151], v[124:127], 0
    v_cvt_pk_f16_f32 v156, v72, v76
    v_cvt_pk_f16_f32 v157, v73, v77
    v_cvt_pk_f16_f32 v158, v74, v78
    v_cvt_pk_f16_f32 v159, v75, v79
    v_mfma_f32_16x16x32_f16 v[96:99], v[152:155], v[128:131], 0
    v_mfma_f32_16x16x32_f16 v[100:103], v[152:155], v[132:135], 0
    v_mfma_f32_16x16x32_f16 v[104:107], v[156:159], v[136:139], 0
    v_mfma_f32_16x16x32_f16 v[108:111], v[156:159], v[140:143], 0
    s_cmp_lg_u32 s4, 0
    s_cbranch_scc1 f_sb
f_nsb:
    v_cvt_pk_f16_f32 v32, v80, v84
    v_cvt_pk_f16_f32 v36, v81, v85
    v_cvt_pk_f16_f32 v40, v82, v86
    v_cvt_pk_f16_f32 v44, v83, v87
    v_bfi_b32 v32, s33, v16, v32
    v_bfi_b32 v36, s33, v16, v36
    v_bfi_b32 v40, s33, v16, v40
    v_bfi_b32 v44, s33, v16, v44
    v_cvt_pk_f16_f32 v33, v88, v92
    v_cvt_pk_f16_f32 v37, v89, v93
    v_cvt_pk_f16_f32 v41, v90, v94
    v_cvt_pk_f16_f32 v45, v91, v95
    v_bfi_b32 v33, s33, v17, v33
    v_bfi_b32 v37, s33, v17, v37
    v_bfi_b32 v41, s33, v17, v41
    v_bfi_b32 v45, s33, v17, v45
    v_cvt_pk_f16_f32 v34, v96, v100
    v_cvt_pk_f16_f32 v38, v97, v101
    v_cvt_pk_f16_f32 v42, v98, v102
    v_cvt_pk_f16_f32 v46, v99, v103
    v_bfi_b32 v34, s33, v18, v34
    v_bfi_b32 v38, s33, v18, v38
    v_bfi_b32 v42, s33, v18, v42
    v_bfi_b32 v46, s33, v18, v46
    v_cvt_pk_f16_f32 v35, v104, v108
    v_cvt_pk_f16_f32 v39, v105, v109
    v_cvt_pk_f16_f32 v43, v106, v110
    v_cvt_pk_f16_f32 v47, v107, v111
    v_bfi_b32 v35, s33, v19, v35
    v_bfi_b32 v39, s33, v19, v39
    v_bfi_b32 v43, s33, v19, v43
    v_bfi_b32 v47, s33, v19, v47
    s_cmp_lg_u32 s38, 0
    s_cbranch_scc1 f_slowst
    buffer_store_dwordx4 v[32:35], v14, s[12:15], s74 offen offset:0 nt
    buffer_store_dwordx4 v[36:39], v14, s[12:15], s74 offen offset:2048 nt
    buffer_store_dwordx4 v[40:43], v14, s[12:15], s75 offen offset:0 nt
    buffer_store_dwordx4 v[44:47], v14, s[12:15], s75 offen offset:2048 nt
f_std:
    s_cmp_ge_u32 s16, 4
    s_cbranch_scc1 f_pw2
    s_mov_b32 s83, 0
    s_waitcnt vmcnt(4)
f_pp:
    v_xor_b32 v20, s56, v20
    v_xor_b32 v21, s57, v21
    v_xor_b32 v22, s58, v22
    v_xor_b32 v23, s59, v23
    v_xor_b32 v240, s56, v240
    v_xor_b32 v241, s57, v241
    v_xor_b32 v242, s58, v242
    v_xor_b32 v243, s59, v243
    v_or3_b32 v48, v20, v21, v22
    v_or3_b32 v48, v48, v23, v240
    v_or3_b32 v48, v48, v241, v242
    v_or_b32 v48, v48, v243
    v_and_b32 v48, 0xff, v48
    v_cmp_ne_u32 vcc, 0, v48
    s_cbranch_vccnz f_ppbad
f_ppok:
    ds_write_b128 v1, v[20:23]
    ds_write_b128 v1, v[240:243] offset:8192
f_pw:
    s_waitcnt lgkmcnt(0)
f_pw2:
    s_barrier
    buffer_load_dwordx4 v[32:35], v4, s[12:15], s28 offen sc1 nt
    buffer_load_dwordx4 v[36:39], v4, s[12:15], s29 offen sc1 nt
    buffer_load_dwordx4 v[40:43], v4, s[12:15], s50 offen sc1 nt
    buffer_load_dwordx4 v[44:47], v4, s[12:15], s51 offen sc1 nt
    ds_read_b128 v[240:243], v3 offset:45568
    ds_read_b128 v[112:115], v5 offset:8192
    ds_read_b128 v[128:131], v6 offset:11264
    ds_read_b128 v[48:51], v5 offset:0
    ds_read_b128 v[64:67], v6 offset:3072
    ds_read_b128 v[116:119], v5 offset:9216
    ds_read_b128 v[132:135], v6 offset:10240
    ds_read_b128 v[52:55], v5 offset:1024
    ds_read_b128 v[68:71], v6 offset:2048
    v_pk_add_f32 v[152:153], v[20:21], v[22:23]
    v_add_f32 v152, v152, v153
    s_nop 1
    v_add_f32_dpp v152, v152, v152 row_ror:8 row_mask:0xf bank_mask:0xf
    s_nop 1
    v_add_f32_dpp v152, v152, v152 row_ror:4 row_mask:0xf bank_mask:0xf
    s_nop 1
    v_add_f32_dpp v152, v152, v152 row_ror:2 row_mask:0xf bank_mask:0xf
    s_nop 1
    v_add_f32_dpp v152, v152, v152 row_ror:1 row_mask:0xf bank_mask:0xf
    s_nop 1
    v_add_f32_dpp v152, v152, v152 row_bcast:15 row_mask:0xa bank_mask:0xf
    s_nop 1
    v_add_f32_dpp v152, v152, v152 row_bcast:31 row_mask:0xc bank_mask:0xf
    v_min_u32 v152, -2, v152
    s_mov_b32 exec_lo, 0
    s_mov_b32 exec_hi, 0x80000000
    ds_write_b32 v11, v152 offset:64
    s_mov_b64 exec, -1
    v_xor_b32 v19, v2, v19
    v_xor_b32 v16, s44, v16
    v_xor_b32 v17, s44, v17
    v_xor_b32 v18, s44, v18
    v_xor_b32 v19, s44, v19
    v_bfe_u32 v20, v0, 3, 3
    v_mul_u32_u24 v20, 7168, v20
    v_and_b32 v151, 7, v0
    v_min_u32 v151, 6, v151
    v_lshl_add_u32 v151, v151, 7, v20
    v_mov_b32 v20, 102976
    v_lshrrev_b32 v23, 5, v0
    v_mov_b32 v22, 0xffffff00
    v_mov_b32 v21, 0x20000
    s_mov_b64 s[70:71], 1
    s_mov_b32 s83, 1
    s_mov_b32 s83, 0
    s_mov_b64 s[72:73], -1
    s_mov_b64 s[74:75], -1
    s_mov_b64 s[78:79], -1
    s_mov_b64 s[36:37], -1
    s_branch f_zp
f_zr:
    s_mov_b64 exec, s[72:73]
    buffer_load_dwordx4 v[32:35], v4, s[12:15], s28 offen sc1 nt
    s_mov_b64 exec, s[74:75]
    buffer_load_dwordx4 v[36:39], v4, s[12:15], s29 offen sc1 nt
    s_mov_b64 exec, s[78:79]
    buffer_load_dwordx4 v[40:43], v4, s[12:15], s50 offen sc1 nt
    s_mov_b64 exec, s[36:37]
    buffer_load_dwordx4 v[44:47], v4, s[12:15], s51 offen sc1 nt
f_zp:
    s_add_u32 s83, s83, 1
    s_cmp_lt_u32 s83, 0x40000
    s_cselect_b64 s[68:69], -1, 0
    s_mov_b64 exec, s[72:73]
    s_waitcnt vmcnt(3)
    v_xor_b32 v32, v32, v16
    v_xor_b32 v33, v33, v17
    v_xor_b32 v34, v34, v18
    v_xor_b32 v35, v35, v19
    v_bitop3_b32 v144, v35, v21, s44 bitop3:0x56
    v_bitop3_b32 v144, v144, v32, s44 bitop3:0xf6
    v_bitop3_b32 v144, v144, v33, s44 bitop3:0xf6
    v_bitop3_b32 v144, v144, v34, s44 bitop3:0xf6
    v_and_b32 v144, s33, v144
    v_cmp_ne_u32 s[72:73], 0, v144
    s_mov_b64 exec, s[74:75]
    s_waitcnt vmcnt(2)
    v_xor_b32 v36, v36, v16
    v_xor_b32 v37, v37, v17
    v_xor_b32 v38, v38, v18
    v_xor_b32 v39, v39, v19
    v_bitop3_b32 v145, v39, v21, s44 bitop3:0x56
    v_bitop3_b32 v145, v145, v36, s44 bitop3:0xf6
    v_bitop3_b32 v145, v145, v37, s44 bitop3:0xf6
    v_bitop3_b32 v145, v145, v38, s44 bitop3:0xf6
    v_and_b32 v145, s33, v145
    v_cmp_ne_u32 s[74:75], 0, v145
    s_mov_b64 exec, s[78:79]
    s_waitcnt vmcnt(1)
    v_xor_b32 v40, v40, v16
    v_xor_b32 v41, v41, v17
    v_xor_b32 v42, v42, v18
    v_xor_b32 v43, v43, v19
    v_bitop3_b32 v146, v43, v21, s44 bitop3:0x56
    v_bitop3_b32 v146, v146, v40, s44 bitop3:0xf6
    v_bitop3_b32 v146, v146, v41, s44 bitop3:0xf6
    v_bitop3_b32 v146, v146, v42, s44 bitop3:0xf6
    v_and_b32 v146, s33, v146
    v_cmp_ne_u32 s[78:79], 0, v146
    s_or_b64 s[64:65], s[72:73], s[74:75]
    s_mov_b64 exec, s[36:37]
    s_waitcnt vmcnt(0)
    v_xor_b32 v44, v44, v16
    v_xor_b32 v45, v45, v17
    v_xor_b32 v46, v46, v18
    v_xor_b32 v47, v47, v19
    v_bitop3_b32 v147, v47, v21, s44 bitop3:0x56
    v_bitop3_b32 v147, v147, v44, s44 bitop3:0xf6
    v_bitop3_b32 v147, v147, v45, s44 bitop3:0xf6
    v_bitop3_b32 v147, v147, v46, s44 bitop3:0xf6
    v_and_b32 v147, s33, v147
    v_cmp_ne_u32 s[36:37], 0, v147
    s_mov_b64 exec, -1
    v_bitop3_b32 v2, v35, v39, v21 bitop3:0x80
    v_bitop3_b32 v2, v2, v43, v47 bitop3:0x80
    v_cmp_eq_u32 vcc, 0, v2
    s_or_b64 s[66:67], s[78:79], s[36:37]
    s_or_b64 s[64:65], s[64:65], s[66:67]
    s_and_b64 s[64:65], s[64:65], s[68:69]
    s_cbranch_scc1 f_zr
    s_cbranch_vccnz f_rare
f_zf:
    v_mfma_f32_16x16x32_f16 v[80:83], v[32:35], v[192:195], 0
    ds_read_b128 v[120:123], v5 offset:10240
    ds_read_b128 v[136:139], v6 offset:9216
    v_mfma_f32_16x16x32_f16 v[80:83], v[36:39], v[196:199], v[80:83]
    ds_read_b128 v[56:59], v5 offset:2048
    ds_read_b128 v[72:75], v6 offset:1024
    v_mfma_f32_16x16x32_f16 v[80:83], v[40:43], v[200:203], v[80:83]
    ds_read_b128 v[124:127], v5 offset:11264
    ds_read_b128 v[140:143], v6 offset:8192
    v_mfma_f32_16x16x32_f16 v[80:83], v[44:47], v[204:207], v[80:83]
    ds_read_b128 v[60:63], v5 offset:3072
    ds_read_b128 v[76:79], v6 offset:0
    v_mfma_f32_16x16x32_f16 v[84:87], v[32:35], v[208:211], 0
    ds_read2_b32 v[28:29], v20 offset0:1 offset1:3
    ds_read2_b32 v[30:31], v20 offset0:5 offset1:7
    v_mfma_f32_16x16x32_f16 v[84:87], v[36:39], v[212:215], v[84:87]
    v_mfma_f32_16x16x32_f16 v[84:87], v[40:43], v[216:219], v[84:87]
    v_mfma_f32_16x16x32_f16 v[84:87], v[44:47], v[220:223], v[84:87]
f_zfok:
    s_waitcnt lgkmcnt(10)
    s_cmp_eq_u32 s30, 0
    s_cbranch_scc1 f_sp
    v_mfma_f32_16x16x32_f16 v[88:91], v[32:35], v[224:227], 0
    v_pk_fma_f32 v[160:161], v[112:113], v[80:81], v[160:161]
    v_pk_fma_f32 v[162:163], v[114:115], v[82:83], v[162:163]
    v_mfma_f32_16x16x32_f16 v[88:91], v[36:39], v[228:231], v[88:91]
    v_fmac_f32 v177, v129, v83
    v_fmac_f32 v178, v130, v82
    v_fmac_f32 v179, v131, v81
    v_mfma_f32_16x16x32_f16 v[88:91], v[40:43], v[232:235], v[88:91]
    v_pk_mul_f32 v[146:147], v[160:161], v[160:161]
    v_pk_mul_f32 v[148:149], v[160:161], v[48:49]
    v_mfma_f32_16x16x32_f16 v[88:91], v[44:47], v[236:239], v[88:91]
    v_pk_fma_f32 v[146:147], v[162:163], v[162:163], v[146:147]
    v_pk_fma_f32 v[148:149], v[162:163], v[50:51], v[148:149]
    v_mfma_f32_16x16x32_f16 v[92:95], v[32:35], v[240:243], 0
    v_cndmask_b32 v100, v80, v84, s[70:71]
    ds_bpermute_b32 v96, v7, v100
    v_pk_fma_f32 v[164:165], v[116:117], v[84:85], v[164:165]
    v_pk_fma_f32 v[166:167], v[118:119], v[86:87], v[166:167]
    v_mfma_f32_16x16x32_f16 v[92:95], v[36:39], v[244:247], v[92:95]
    v_fmac_f32 v181, v133, v87
    v_fmac_f32 v182, v134, v86
    v_fmac_f32 v183, v135, v85
    v_mfma_f32_16x16x32_f16 v[92:95], v[40:43], v[248:251], v[92:95]
    v_pk_fma_f32 v[146:147], v[164:165], v[164:165], v[146:147]
    v_pk_fma_f32 v[148:149], v[164:165], v[52:53], v[148:149]
    v_mfma_f32_16x16x32_f16 v[92:95], v[44:47], v[252:255], v[92:95]
    v_pk_fma_f32 v[146:147], v[166:167], v[166:167], v[146:147]
    v_pk_fma_f32 v[148:149], v[166:167], v[54:55], v[148:149]
    v_pk_mul_f32 v[154:155], v[178:179], v[178:179]
    v_pk_mul_f32 v[156:157], v[178:179], v[66:67]
    v_pk_fma_f32 v[154:155], v[182:183], v[182:183], v[154:155]
    v_pk_fma_f32 v[156:157], v[182:183], v[70:71], v[156:157]
    v_pk_add_f32 v[144:145], v[160:161], v[162:163]
    v_pk_add_f32 v[152:153], v[178:179], v[182:183]
    s_waitcnt lgkmcnt(1)
    v_cndmask_b32 v101, v84, v88, s[70:71]
    ds_bpermute_b32 v97, v7, v101
    v_pk_fma_f32 v[168:169], v[120:121], v[88:89], v[168:169]
    v_pk_fma_f32 v[170:171], v[122:123], v[90:91], v[170:171]
    v_fmac_f32 v185, v137, v91
    v_fmac_f32 v186, v138, v90
    v_fmac_f32 v187, v139, v89
    v_pk_add_f32 v[144:145], v[144:145], v[164:165]
    v_pk_add_f32 v[144:145], v[144:145], v[166:167]
    v_pk_fma_f32 v[146:147], v[168:169], v[168:169], v[146:147]
    v_pk_fma_f32 v[148:149], v[168:169], v[56:57], v[148:149]
    v_pk_fma_f32 v[146:147], v[170:171], v[170:171], v[146:147]
    v_pk_fma_f32 v[148:149], v[170:171], v[58:59], v[148:149]
    v_pk_fma_f32 v[154:155], v[186:187], v[186:187], v[154:155]
    v_pk_fma_f32 v[156:157], v[186:187], v[74:75], v[156:157]
    v_cndmask_b32 v102, v88, v92, s[70:71]
    ds_bpermute_b32 v98, v7, v102
    v_cndmask_b32 v103, v92, v80, s[70:71]
    ds_bpermute_b32 v99, v7, v103
    v_pk_fma_f32 v[172:173], v[124:125], v[92:93], v[172:173]
    v_pk_fma_f32 v[174:175], v[126:127], v[94:95], v[174:175]
    v_fmac_f32 v189, v141, v95
    v_fmac_f32 v190, v142, v94
    v_fmac_f32 v191, v143, v93
    v_pk_fma_f32 v[146:147], v[172:173], v[172:173], v[146:147]
    v_pk_fma_f32 v[148:149], v[172:173], v[60:61], v[148:149]
    v_pk_fma_f32 v[146:147], v[174:175], v[174:175], v[146:147]
    v_pk_fma_f32 v[148:149], v[174:175], v[62:63], v[148:149]
    v_pk_fma_f32 v[154:155], v[190:191], v[190:191], v[154:155]
    v_pk_fma_f32 v[156:157], v[190:191], v[78:79], v[156:157]
    v_pk_add_f32 v[144:145], v[144:145], v[168:169]
    v_pk_add_f32 v[144:145], v[144:145], v[170:171]
    v_pk_add_f32 v[144:145], v[144:145], v[172:173]
    v_pk_add_f32 v[144:145], v[144:145], v[174:175]
    v_pk_add_f32 v[152:153], v[152:153], v[186:187]
    v_pk_add_f32 v[152:153], v[152:153], v[190:191]
    s_waitcnt lgkmcnt(0)
    v_fmac_f32 v176, v128, v96
    v_fmac_f32 v180, v132, v97
    v_fmac_f32 v184, v136, v98
    v_fmac_f32 v188, v140, v99
    v_pk_fma_f32 v[154:155], v[176:177], v[176:177], v[154:155]
    v_pk_fma_f32 v[156:157], v[176:177], v[64:65], v[156:157]
    v_pk_add_f32 v[152:153], v[152:153], v[176:177]
    v_pk_fma_f32 v[154:155], v[180:181], v[180:181], v[154:155]
    v_pk_fma_f32 v[156:157], v[180:181], v[68:69], v[156:157]
    v_pk_add_f32 v[152:153], v[152:153], v[180:181]
    v_pk_fma_f32 v[154:155], v[184:185], v[184:185], v[154:155]
    v_pk_fma_f32 v[156:157], v[184:185], v[72:73], v[156:157]
    v_pk_add_f32 v[152:153], v[152:153], v[184:185]
    v_pk_fma_f32 v[154:155], v[188:189], v[188:189], v[154:155]
    v_pk_fma_f32 v[156:157], v[188:189], v[76:77], v[156:157]
    v_pk_add_f32 v[152:153], v[152:153], v[188:189]
f_join:
f_q:
    v_max3_u32 v2, v28, v29, v30
    v_max_u32 v2, v2, v31
    v_cmp_eq_u32 vcc, -1, v2
    s_cbranch_vccnz f_qbad
    v_pk_add_f32 v[28:29], v[28:29], v[30:31]
    s_mov_b64 exec, s[48:49]
    buffer_load_dword v150, v151, s[20:23], s55 offen
    s_mov_b64 exec, -1
f_ngo:
    v_add_f32 v104, v144, v145
    v_add_f32 v105, v146, v147
    v_add_f32 v106, v148, v149
    v_add_f32 v108, v152, v153
    v_add_f32 v109, v154, v155
    v_add_f32 v110, v156, v157
    v_add_f32 v28, v28, v29
    v_permlane32_swap_b32 v104, v108
    v_permlane32_swap_b32 v105, v109
    v_permlane32_swap_b32 v106, v110
    v_add_f32 v104, v104, v108
    v_add_f32 v105, v105, v109
    v_add_f32 v106, v106, v110
    v_add_f32_dpp v104, v104, v104 row_ror:8 row_mask:0xf bank_mask:0xf
    v_add_f32_dpp v105, v105, v105 row_ror:8 row_mask:0xf bank_mask:0xf
    v_add_f32_dpp v106, v106, v106 row_ror:8 row_mask:0xf bank_mask:0xf
    v_add_f32_dpp v104, v104, v104 row_ror:4 row_mask:0xf bank_mask:0xf
    v_add_f32_dpp v105, v105, v105 row_ror:4 row_mask:0xf bank_mask:0xf
    v_add_f32_dpp v106, v106, v106 row_ror:4 row_mask:0xf bank_mask:0xf
    v_add_f32_dpp v104, v104, v104 row_ror:2 row_mask:0xf bank_mask:0xf
    v_add_f32_dpp v105, v105, v105 row_ror:2 row_mask:0xf bank_mask:0xf
    v_add_f32_dpp v106, v106, v106 row_ror:2 row_mask:0xf bank_mask:0xf
    v_add_f32_dpp v104, v104, v104 row_ror:1 row_mask:0xf bank_mask:0xf
    v_add_f32_dpp v105, v105, v105 row_ror:1 row_mask:0xf bank_mask:0xf
    v_add_f32_dpp v106, v106, v106 row_ror:1 row_mask:0xf bank_mask:0xf
    v_add_f32_dpp v104, v104, v104 row_bcast:15 row_mask:0xa bank_mask:0xf
    v_add_f32_dpp v105, v105, v105 row_bcast:15 row_mask:0xa bank_mask:0xf
    v_add_f32_dpp v106, v106, v106 row_bcast:15 row_mask:0xa bank_mask:0xf
    v_mul_f32 v104, s46, v104
    v_mul_f32 v105, s46, v105
    v_mul_f32 v108, v104, v104
    v_fma_f32 v106, -v104, v28, v106
    v_sub_f32 v105, v105, v108
    v_mul_f32 v109, 4.0, v105
    v_cmp_gt_f32 vcc, v108, v109
    s_or_b32 s42, vcc_lo, vcc_hi
    s_bitcmp1_b32 s42, 31
    s_cbranch_scc1 f_slow2
f_var2:
    v_cvt_pk_bf16_f32 v105, v105, v105
    v_lshlrev_b32 v105, 16, v105
    v_add_f32 v105, 0x3727c5ac, v105
    v_cvt_pk_bf16_f32 v105, v105, v105
    v_lshlrev_b32 v105, 16, v105
    v_sqrt_f32 v105, v105
    s_nop 0
    v_cvt_pk_bf16_f32 v105, v105, v105
    v_lshlrev_b32 v105, 16, v105
    v_rcp_f32 v105, v105
    s_mov_b32 s42, 0x80000000
    s_mov_b32 exec_lo, s42
    s_mov_b32 exec_hi, s42
    v_mul_f32 v106, v106, v105
    v_ashrrev_i32 v108, 31, v106
    v_or_b32 v108, s42, v108
    v_xor_b32 v106, v106, v108
    v_and_or_b32 v106, v106, v22, v23
    ds_write_b32 v11, v106
    s_mov_b64 exec, -1
    s_waitcnt lgkmcnt(0)
    s_barrier
    ds_read_b32 v21, v12
    v_readlane_b32 s60, v106, 31
    v_readlane_b32 s64, v104, 31
    v_readlane_b32 s65, v105, 31
    v_readlane_b32 s61, v106, 63
    v_readlane_b32 s66, v104, 63
    v_readlane_b32 s67, v105, 63
    s_lshl_b32 s42, s3, 1
    s_movk_i32 s43, 0xff00
    v_mov_b32 v30, s32
    v_mov_b32 v31, s32
    s_cmp_lg_u32 s16, 0
    s_waitcnt lgkmcnt(0)
    s_cbranch_scc1 f_nkey
    s_setprio 3
    v_max_u32_dpp v28, v21, v21 row_ror:8 row_mask:0xf bank_mask:0xf
    s_nop 1
    v_max_u32_dpp v28, v28, v28 row_ror:4 row_mask:0xf bank_mask:0xf
    s_nop 1
    v_max_u32_dpp v28, v28, v28 row_ror:2 row_mask:0xf bank_mask:0xf
    s_nop 1
    v_max_u32_dpp v28, v28, v28 row_ror:1 row_mask:0xf bank_mask:0xf
    v_cmp_eq_u32 vcc, v28, v21
    s_nop 1
    v_cndmask_b32_e64 v29, v21, 0, vcc
    v_and_or_b32 v28, v28, v22, s42
    s_add_u32 s42, s42, 1
    v_max_u32_dpp v29, v29, v29 row_ror:8 row_mask:0xf bank_mask:0xf
    s_nop 1
    v_max_u32_dpp v29, v29, v29 row_ror:4 row_mask:0xf bank_mask:0xf
    s_nop 1
    v_max_u32_dpp v29, v29, v29 row_ror:2 row_mask:0xf bank_mask:0xf
    s_nop 1
    v_max_u32_dpp v29, v29, v29 row_ror:1 row_mask:0xf bank_mask:0xf
    v_and_or_b32 v29, v29, v22, s42
    s_mov_b64 exec, 0xff
    buffer_store_dwordx4 v[28:31], v13, s[12:15], s80 offen sc1
    s_mov_b64 exec, -1
    s_setprio 0
f_nkey:
    s_or_b32 s42, s35, s16
    s_cmp_lg_u32 s42, 0
    s_cbranch_scc1 f_ng1
    v_mov_b32 v2, s32
    s_mov_b64 exec, 1
    buffer_store_dword v2, v13, s[12:15], s81 offen offset:2048 sc1
    s_mov_b64 exec, -1
f_ng1:
    s_movk_i32 s62, 0x100
    v_cmp_lt_u32 vcc, s60, v21
    s_and_b32 s42, vcc_lo, 0xffff
    s_bcnt1_i32_b32 s42, s42
    s_cmp_ge_u32 s42, 2
    s_cbranch_scc1 f_nc0
    s_setprio 2
    v_pk_add_f32 v[48:49], v[160:161], s[64:65] op_sel:[0,0] op_sel_hi:[1,0] neg_lo:[0,1] neg_hi:[0,1]
    v_pk_add_f32 v[50:51], v[162:163], s[64:65] op_sel:[0,0] op_sel_hi:[1,0] neg_lo:[0,1] neg_hi:[0,1]
    v_pk_add_f32 v[52:53], v[164:165], s[64:65] op_sel:[0,0] op_sel_hi:[1,0] neg_lo:[0,1] neg_hi:[0,1]
    v_pk_add_f32 v[54:55], v[166:167], s[64:65] op_sel:[0,0] op_sel_hi:[1,0] neg_lo:[0,1] neg_hi:[0,1]
    v_pk_add_f32 v[56:57], v[168:169], s[64:65] op_sel:[0,0] op_sel_hi:[1,0] neg_lo:[0,1] neg_hi:[0,1]
    v_pk_add_f32 v[58:59], v[170:171], s[64:65] op_sel:[0,0] op_sel_hi:[1,0] neg_lo:[0,1] neg_hi:[0,1]
    v_pk_add_f32 v[60:61], v[172:173], s[64:65] op_sel:[0,0] op_sel_hi:[1,0] neg_lo:[0,1] neg_hi:[0,1]
    v_pk_add_f32 v[62:63], v[174:175], s[64:65] op_sel:[0,0] op_sel_hi:[1,0] neg_lo:[0,1] neg_hi:[0,1]
    v_pk_mul_f32 v[48:49], v[48:49], s[64:65] op_sel:[0,1] op_sel_hi:[1,1]
    v_pk_mul_f32 v[50:51], v[50:51], s[64:65] op_sel:[0,1] op_sel_hi:[1,1]
    v_pk_mul_f32 v[52:53], v[52:53], s[64:65] op_sel:[0,1] op_sel_hi:[1,1]
    v_pk_mul_f32 v[54:55], v[54:55], s[64:65] op_sel:[0,1] op_sel_hi:[1,1]
    v_pk_mul_f32 v[56:57], v[56:57], s[64:65] op_sel:[0,1] op_sel_hi:[1,1]
    v_pk_mul_f32 v[58:59], v[58:59], s[64:65] op_sel:[0,1] op_sel_hi:[1,1]
    v_pk_mul_f32 v[60:61], v[60:61], s[64:65] op_sel:[0,1] op_sel_hi:[1,1]
    v_pk_mul_f32 v[62:63], v[62:63], s[64:65] op_sel:[0,1] op_sel_hi:[1,1]
    v_cvt_pk_f16_f32 v80, v48, v49
    v_cvt_pk_f16_f32 v81, v50, v51
    ds_write_b64 v8, v[80:81] offset:0
    v_cvt_pk_f16_f32 v82, v52, v53
    v_cvt_pk_f16_f32 v83, v54, v55
    ds_write_b64 v8, v[82:83] offset:512
    v_cvt_pk_f16_f32 v84, v56, v57
    v_cvt_pk_f16_f32 v85, v58, v59
    ds_write_b64 v8, v[84:85] offset:1024
    v_cvt_pk_f16_f32 v86, v60, v61
    v_cvt_pk_f16_f32 v87, v62, v63
    ds_write_b64 v8, v[86:87] offset:1536
    ds_read_b128 v[88:91], v10 offset:0
    ds_read_b128 v[92:95], v10 offset:1024
    s_lshl_b32 s62, s3, 1
    s_add_u32 s62, s62, s42
    s_lshl_b32 s42, s62, 11
    s_add_u32 s42, s42, 5242880
    s_lshl_b32 s43, s62, 4
    s_add_u32 s43, s43, 6512640
    s_lshl_b32 s68, s30, 8
    s_or_b32 s68, s68, s56
    s_andn2_b32 s69, s64, 0xff
    s_or_b32 s69, s69, s57
    s_andn2_b32 s70, s65, 0xff
    s_or_b32 s70, s70, s58
    s_andn2_b32 s71, s60, 0xff
    s_or_b32 s71, s71, s59
    s_waitcnt lgkmcnt(0)
    v_bfi_b32 v88, s33, v16, v88
    v_bfi_b32 v89, s33, v17, v89
    v_bfi_b32 v90, s33, v18, v90
    v_bfi_b32 v91, s33, v19, v91
    v_bfi_b32 v92, s33, v16, v92
    v_bfi_b32 v93, s33, v17, v93
    v_bfi_b32 v94, s33, v18, v94
    v_bfi_b32 v95, s33, v19, v95
    buffer_store_dwordx4 v[88:91], v3, s[12:15], s42 offen offset:0 sc1
    buffer_store_dwordx4 v[92:95], v3, s[12:15], s42 offen offset:1024 sc1
    v_mov_b32 v24, s68
    v_mov_b32 v25, s69
    v_mov_b32 v26, s70
    v_mov_b32 v27, s71
    s_mov_b64 exec, 1
    buffer_store_dwordx4 v[24:27], v3, s[12:15], s43 offen sc1
    s_mov_b64 exec, -1
    s_setprio 0
f_nc0:
    s_movk_i32 s63, 0x100
    v_cmp_lt_u32 vcc, s61, v21
    s_and_b32 s42, vcc_lo, 0xffff
    s_bcnt1_i32_b32 s42, s42
    s_cmp_ge_u32 s42, 2
    s_cbranch_scc1 f_nc1
    s_setprio 2
    v_pk_add_f32 v[64:65], v[176:177], s[66:67] op_sel:[0,0] op_sel_hi:[1,0] neg_lo:[0,1] neg_hi:[0,1]
    v_pk_add_f32 v[66:67], v[178:179], s[66:67] op_sel:[0,0] op_sel_hi:[1,0] neg_lo:[0,1] neg_hi:[0,1]
    v_pk_add_f32 v[68:69], v[180:181], s[66:67] op_sel:[0,0] op_sel_hi:[1,0] neg_lo:[0,1] neg_hi:[0,1]
    v_pk_add_f32 v[70:71], v[182:183], s[66:67] op_sel:[0,0] op_sel_hi:[1,0] neg_lo:[0,1] neg_hi:[0,1]
    v_pk_add_f32 v[72:73], v[184:185], s[66:67] op_sel:[0,0] op_sel_hi:[1,0] neg_lo:[0,1] neg_hi:[0,1]
    v_pk_add_f32 v[74:75], v[186:187], s[66:67] op_sel:[0,0] op_sel_hi:[1,0] neg_lo:[0,1] neg_hi:[0,1]
    v_pk_add_f32 v[76:77], v[188:189], s[66:67] op_sel:[0,0] op_sel_hi:[1,0] neg_lo:[0,1] neg_hi:[0,1]
    v_pk_add_f32 v[78:79], v[190:191], s[66:67] op_sel:[0,0] op_sel_hi:[1,0] neg_lo:[0,1] neg_hi:[0,1]
    v_pk_mul_f32 v[64:65], v[64:65], s[66:67] op_sel:[0,1] op_sel_hi:[1,1]
    v_pk_mul_f32 v[66:67], v[66:67], s[66:67] op_sel:[0,1] op_sel_hi:[1,1]
    v_pk_mul_f32 v[68:69], v[68:69], s[66:67] op_sel:[0,1] op_sel_hi:[1,1]
    v_pk_mul_f32 v[70:71], v[70:71], s[66:67] op_sel:[0,1] op_sel_hi:[1,1]
    v_pk_mul_f32 v[72:73], v[72:73], s[66:67] op_sel:[0,1] op_sel_hi:[1,1]
    v_pk_mul_f32 v[74:75], v[74:75], s[66:67] op_sel:[0,1] op_sel_hi:[1,1]
    v_pk_mul_f32 v[76:77], v[76:77], s[66:67] op_sel:[0,1] op_sel_hi:[1,1]
    v_pk_mul_f32 v[78:79], v[78:79], s[66:67] op_sel:[0,1] op_sel_hi:[1,1]
    v_cvt_pk_f16_f32 v80, v64, v65
    v_cvt_pk_f16_f32 v81, v66, v67
    ds_write_b64 v9, v[80:81] offset:1536
    v_cvt_pk_f16_f32 v82, v68, v69
    v_cvt_pk_f16_f32 v83, v70, v71
    ds_write_b64 v9, v[82:83] offset:1024
    v_cvt_pk_f16_f32 v84, v72, v73
    v_cvt_pk_f16_f32 v85, v74, v75
    ds_write_b64 v9, v[84:85] offset:512
    v_cvt_pk_f16_f32 v86, v76, v77
    v_cvt_pk_f16_f32 v87, v78, v79
    ds_write_b64 v9, v[86:87] offset:0
    ds_read_b128 v[88:91], v10 offset:2048
    ds_read_b128 v[92:95], v10 offset:3072
    s_lshl_b32 s63, s3, 1
    s_add_u32 s63, s63, s42
    s_lshl_b32 s42, s63, 11
    s_add_u32 s42, s42, 5242880
    s_lshl_b32 s43, s63, 4
    s_add_u32 s43, s43, 6512640
    s_lshl_b32 s68, s31, 8
    s_or_b32 s68, s68, s56
    s_andn2_b32 s69, s66, 0xff
    s_or_b32 s69, s69, s57
    s_andn2_b32 s70, s67, 0xff
    s_or_b32 s70, s70, s58
    s_andn2_b32 s71, s61, 0xff
    s_or_b32 s71, s71, s59
    s_waitcnt lgkmcnt(0)
    v_bfi_b32 v88, s33, v16, v88
    v_bfi_b32 v89, s33, v17, v89
    v_bfi_b32 v90, s33, v18, v90
    v_bfi_b32 v91, s33, v19, v91
    v_bfi_b32 v92, s33, v16, v92
    v_bfi_b32 v93, s33, v17, v93
    v_bfi_b32 v94, s33, v18, v94
    v_bfi_b32 v95, s33, v19, v95
    buffer_store_dwordx4 v[88:91], v3, s[12:15], s42 offen offset:0 sc1
    buffer_store_dwordx4 v[92:95], v3, s[12:15], s42 offen offset:1024 sc1
    v_mov_b32 v24, s68
    v_mov_b32 v25, s69
    v_mov_b32 v26, s70
    v_mov_b32 v27, s71
    s_mov_b64 exec, 1
    buffer_store_dwordx4 v[24:27], v3, s[12:15], s43 offen sc1
    s_mov_b64 exec, -1
    s_setprio 0
f_nc1:
    buffer_load_dwordx4 v[96:99], v15, s[12:15], s41 offen
    buffer_load_dwordx4 v[100:103], v15, s[12:15], s40 offen
    s_cmp_lt_u32 s62, 0x100
    s_cbranch_scc1 f_op0
    v_pk_add_f32 v[48:49], v[160:161], s[64:65] op_sel:[0,0] op_sel_hi:[1,0] neg_lo:[0,1] neg_hi:[0,1]
    v_pk_add_f32 v[50:51], v[162:163], s[64:65] op_sel:[0,0] op_sel_hi:[1,0] neg_lo:[0,1] neg_hi:[0,1]
    v_pk_add_f32 v[52:53], v[164:165], s[64:65] op_sel:[0,0] op_sel_hi:[1,0] neg_lo:[0,1] neg_hi:[0,1]
    v_pk_add_f32 v[54:55], v[166:167], s[64:65] op_sel:[0,0] op_sel_hi:[1,0] neg_lo:[0,1] neg_hi:[0,1]
    v_pk_add_f32 v[56:57], v[168:169], s[64:65] op_sel:[0,0] op_sel_hi:[1,0] neg_lo:[0,1] neg_hi:[0,1]
    v_pk_add_f32 v[58:59], v[170:171], s[64:65] op_sel:[0,0] op_sel_hi:[1,0] neg_lo:[0,1] neg_hi:[0,1]
    v_pk_add_f32 v[60:61], v[172:173], s[64:65] op_sel:[0,0] op_sel_hi:[1,0] neg_lo:[0,1] neg_hi:[0,1]
    v_pk_add_f32 v[62:63], v[174:175], s[64:65] op_sel:[0,0] op_sel_hi:[1,0] neg_lo:[0,1] neg_hi:[0,1]
    v_pk_mul_f32 v[48:49], v[48:49], s[64:65] op_sel:[0,1] op_sel_hi:[1,1]
    v_pk_mul_f32 v[50:51], v[50:51], s[64:65] op_sel:[0,1] op_sel_hi:[1,1]
    v_pk_mul_f32 v[52:53], v[52:53], s[64:65] op_sel:[0,1] op_sel_hi:[1,1]
    v_pk_mul_f32 v[54:55], v[54:55], s[64:65] op_sel:[0,1] op_sel_hi:[1,1]
    v_pk_mul_f32 v[56:57], v[56:57], s[64:65] op_sel:[0,1] op_sel_hi:[1,1]
    v_pk_mul_f32 v[58:59], v[58:59], s[64:65] op_sel:[0,1] op_sel_hi:[1,1]
    v_pk_mul_f32 v[60:61], v[60:61], s[64:65] op_sel:[0,1] op_sel_hi:[1,1]
    v_pk_mul_f32 v[62:63], v[62:63], s[64:65] op_sel:[0,1] op_sel_hi:[1,1]
f_op0:
    s_cmp_lt_u32 s63, 0x100
    s_cbranch_scc1 f_op1
    v_pk_add_f32 v[64:65], v[176:177], s[66:67] op_sel:[0,0] op_sel_hi:[1,0] neg_lo:[0,1] neg_hi:[0,1]
    v_pk_add_f32 v[66:67], v[178:179], s[66:67] op_sel:[0,0] op_sel_hi:[1,0] neg_lo:[0,1] neg_hi:[0,1]
    v_pk_add_f32 v[68:69], v[180:181], s[66:67] op_sel:[0,0] op_sel_hi:[1,0] neg_lo:[0,1] neg_hi:[0,1]
    v_pk_add_f32 v[70:71], v[182:183], s[66:67] op_sel:[0,0] op_sel_hi:[1,0] neg_lo:[0,1] neg_hi:[0,1]
    v_pk_add_f32 v[72:73], v[184:185], s[66:67] op_sel:[0,0] op_sel_hi:[1,0] neg_lo:[0,1] neg_hi:[0,1]
    v_pk_add_f32 v[74:75], v[186:187], s[66:67] op_sel:[0,0] op_sel_hi:[1,0] neg_lo:[0,1] neg_hi:[0,1]
    v_pk_add_f32 v[76:77], v[188:189], s[66:67] op_sel:[0,0] op_sel_hi:[1,0] neg_lo:[0,1] neg_hi:[0,1]
    v_pk_add_f32 v[78:79], v[190:191], s[66:67] op_sel:[0,0] op_sel_hi:[1,0] neg_lo:[0,1] neg_hi:[0,1]
    v_pk_mul_f32 v[64:65], v[64:65], s[66:67] op_sel:[0,1] op_sel_hi:[1,1]
    v_pk_mul_f32 v[66:67], v[66:67], s[66:67] op_sel:[0,1] op_sel_hi:[1,1]
    v_pk_mul_f32 v[68:69], v[68:69], s[66:67] op_sel:[0,1] op_sel_hi:[1,1]
    v_pk_mul_f32 v[70:71], v[70:71], s[66:67] op_sel:[0,1] op_sel_hi:[1,1]
    v_pk_mul_f32 v[72:73], v[72:73], s[66:67] op_sel:[0,1] op_sel_hi:[1,1]
    v_pk_mul_f32 v[74:75], v[74:75], s[66:67] op_sel:[0,1] op_sel_hi:[1,1]
    v_pk_mul_f32 v[76:77], v[76:77], s[66:67] op_sel:[0,1] op_sel_hi:[1,1]
    v_pk_mul_f32 v[78:79], v[78:79], s[66:67] op_sel:[0,1] op_sel_hi:[1,1]
f_op1:
    s_mov_b32 s83, 0
    s_waitcnt vmcnt(0)
f_pb:
    v_xor_b32 v96, s56, v96
    v_xor_b32 v97, s57, v97
    v_xor_b32 v98, s58, v98
    v_xor_b32 v99, s59, v99
    v_xor_b32 v100, s56, v100
    v_xor_b32 v101, s57, v101
    v_xor_b32 v102, s58, v102
    v_xor_b32 v103, s59, v103
    v_or3_b32 v2, v96, v97, v98
    v_or3_b32 v2, v2, v99, v100
    v_or3_b32 v2, v2, v101, v102
    v_or_b32 v2, v2, v103
    v_and_b32 v2, 0xff, v2
    v_cmp_ne_u32 vcc, 0, v2
    s_cbranch_vccnz f_pbbad
f_pbok:
    ds_write_b128 v1, v[96:99] offset:4096
    s_cmp_ge_u32 s16, 4
    s_cbranch_scc1 f_pbx
    ds_write_b128 v1, v[100:103] offset:16384
f_pbx:
    s_waitcnt lgkmcnt(0)
    s_barrier
    ds_read_b128 v[192:195], v5 offset:16384
    ds_read_b128 v[196:199], v5 offset:17408
    ds_read_b128 v[200:203], v5 offset:18432
    ds_read_b128 v[204:207], v5 offset:19456
    ds_read_b128 v[224:227], v5 offset:4096
    ds_read_b128 v[228:231], v5 offset:5120
    ds_read_b128 v[232:235], v5 offset:6144
    ds_read_b128 v[236:239], v5 offset:7168
    ds_read_b128 v[112:115], v5 offset:12288
    ds_read_b128 v[116:119], v5 offset:13312
    ds_read_b128 v[120:123], v5 offset:14336
    ds_read_b128 v[124:127], v5 offset:15360
    s_waitcnt lgkmcnt(4)
    v_pk_fma_f32 v[48:49], v[48:49], v[192:193], v[224:225]
    v_pk_fma_f32 v[50:51], v[50:51], v[194:195], v[226:227]
    v_pk_fma_f32 v[52:53], v[52:53], v[196:197], v[228:229]
    v_pk_fma_f32 v[54:55], v[54:55], v[198:199], v[230:231]
    v_pk_fma_f32 v[56:57], v[56:57], v[200:201], v[232:233]
    v_pk_fma_f32 v[58:59], v[58:59], v[202:203], v[234:235]
    v_pk_fma_f32 v[60:61], v[60:61], v[204:205], v[236:237]
    v_pk_fma_f32 v[62:63], v[62:63], v[206:207], v[238:239]
    s_waitcnt lgkmcnt(0)
    v_pk_fma_f32 v[160:161], v[112:113], v[48:49], v[160:161]
    v_pk_fma_f32 v[162:163], v[114:115], v[50:51], v[162:163]
    v_pk_fma_f32 v[164:165], v[116:117], v[52:53], v[164:165]
    v_pk_fma_f32 v[166:167], v[118:119], v[54:55], v[166:167]
    v_pk_fma_f32 v[168:169], v[120:121], v[56:57], v[168:169]
    v_pk_fma_f32 v[170:171], v[122:123], v[58:59], v[170:171]
    v_pk_fma_f32 v[172:173], v[124:125], v[60:61], v[172:173]
    v_pk_fma_f32 v[174:175], v[126:127], v[62:63], v[174:175]
    v_cvt_pk_bf16_f32 v80, v160, v161
    v_cvt_pk_bf16_f32 v81, v162, v163
    ds_write_b64 v8, v[80:81] offset:0
    v_cvt_pk_bf16_f32 v82, v164, v165
    v_cvt_pk_bf16_f32 v83, v166, v167
    ds_write_b64 v8, v[82:83] offset:512
    v_cvt_pk_bf16_f32 v84, v168, v169
    v_cvt_pk_bf16_f32 v85, v170, v171
    ds_write_b64 v8, v[84:85] offset:1024
    v_cvt_pk_bf16_f32 v86, v172, v173
    v_cvt_pk_bf16_f32 v87, v174, v175
    ds_write_b64 v8, v[86:87] offset:1536
    ds_read_b128 v[32:35], v10 offset:0
    ds_read_b128 v[36:39], v10 offset:1024
    ds_read_b128 v[208:211], v6 offset:19456
    ds_read_b128 v[212:215], v6 offset:18432
    ds_read_b128 v[216:219], v6 offset:17408
    ds_read_b128 v[220:223], v6 offset:16384
    ds_read_b128 v[240:243], v6 offset:7168
    ds_read_b128 v[244:247], v6 offset:6144
    ds_read_b128 v[248:251], v6 offset:5120
    ds_read_b128 v[252:255], v6 offset:4096
    ds_read_b128 v[128:131], v6 offset:15360
    ds_read_b128 v[132:135], v6 offset:14336
    ds_read_b128 v[136:139], v6 offset:13312
    ds_read_b128 v[140:143], v6 offset:12288
    s_waitcnt lgkmcnt(4)
    v_pk_fma_f32 v[64:65], v[64:65], v[208:209], v[240:241]
    v_pk_fma_f32 v[66:67], v[66:67], v[210:211], v[242:243]
    v_pk_fma_f32 v[68:69], v[68:69], v[212:213], v[244:245]
    v_pk_fma_f32 v[70:71], v[70:71], v[214:215], v[246:247]
    v_pk_fma_f32 v[72:73], v[72:73], v[216:217], v[248:249]
    v_pk_fma_f32 v[74:75], v[74:75], v[218:219], v[250:251]
    v_pk_fma_f32 v[76:77], v[76:77], v[220:221], v[252:253]
    v_pk_fma_f32 v[78:79], v[78:79], v[222:223], v[254:255]
    s_waitcnt lgkmcnt(0)
    v_pk_fma_f32 v[176:177], v[128:129], v[64:65], v[176:177]
    v_pk_fma_f32 v[178:179], v[130:131], v[66:67], v[178:179]
    v_pk_fma_f32 v[180:181], v[132:133], v[68:69], v[180:181]
    v_pk_fma_f32 v[182:183], v[134:135], v[70:71], v[182:183]
    v_pk_fma_f32 v[184:185], v[136:137], v[72:73], v[184:185]
    v_pk_fma_f32 v[186:187], v[138:139], v[74:75], v[186:187]
    v_pk_fma_f32 v[188:189], v[140:141], v[76:77], v[188:189]
    v_pk_fma_f32 v[190:191], v[142:143], v[78:79], v[190:191]
    v_cvt_pk_bf16_f32 v80, v176, v177
    v_cvt_pk_bf16_f32 v81, v178, v179
    ds_write_b64 v9, v[80:81] offset:1536
    v_cvt_pk_bf16_f32 v82, v180, v181
    v_cvt_pk_bf16_f32 v83, v182, v183
    ds_write_b64 v9, v[82:83] offset:1024
    v_cvt_pk_bf16_f32 v84, v184, v185
    v_cvt_pk_bf16_f32 v85, v186, v187
    ds_write_b64 v9, v[84:85] offset:512
    v_cvt_pk_bf16_f32 v86, v188, v189
    v_cvt_pk_bf16_f32 v87, v190, v191
    ds_write_b64 v9, v[86:87] offset:0
    ds_read_b128 v[40:43], v10 offset:2048
    ds_read_b128 v[44:47], v10 offset:3072
    v_mov_b32 v21, 103168
    s_cmp_lg_u32 s16, 0
    s_cbranch_scc1 f_nrs
    s_sleep 8
    s_mov_b32 s83, 0
f_kq:
    buffer_load_dwordx4 v[96:99], v3, s[12:15], s81 offen offset:0 sc1
    buffer_load_dwordx4 v[100:103], v3, s[12:15], s81 offen offset:1024 sc1
    s_waitcnt vmcnt(0)
    v_xor_b32 v2, s32, v98
    v_bitop3_b32 v2, v2, v102, s32 bitop3:0xf6
    v_cmp_ne_u32 vcc, 0, v2
    s_cbranch_vccz f_kqx
    s_sleep 4
    s_add_u32 s83, s83, 1
    s_cmp_lt_u32 s83, 0x40000
    s_cbranch_scc1 f_kq
f_kqx:
    v_max_u32 v24, v96, v100
    v_min_u32 v25, v96, v100
    v_max3_u32 v25, v25, v97, v101
    v_mov_b32 v26, v24
    s_nop 1
    v_max_u32_dpp v26, v26, v26 row_ror:8 row_mask:0xf bank_mask:0xf
    s_nop 1
    v_max_u32_dpp v26, v26, v26 row_ror:4 row_mask:0xf bank_mask:0xf
    s_nop 1
    v_max_u32_dpp v26, v26, v26 row_ror:2 row_mask:0xf bank_mask:0xf
    s_nop 1
    v_max_u32_dpp v26, v26, v26 row_ror:1 row_mask:0xf bank_mask:0xf
    s_nop 1
    v_max_u32_dpp v26, v26, v26 row_bcast:15 row_mask:0xa bank_mask:0xf
    s_nop 1
    v_max_u32_dpp v26, v26, v26 row_bcast:31 row_mask:0xc bank_mask:0xf
    s_nop 0
    v_readlane_b32 s40, v26, 63
    s_nop 1
    v_cmp_eq_u32 vcc, s40, v24
    s_nop 1
    v_cndmask_b32 v26, v24, v25, vcc
    s_nop 1
    v_max_u32_dpp v26, v26, v26 row_ror:8 row_mask:0xf bank_mask:0xf
    s_nop 1
    v_max_u32_dpp v26, v26, v26 row_ror:4 row_mask:0xf bank_mask:0xf
    s_nop 1
    v_max_u32_dpp v26, v26, v26 row_ror:2 row_mask:0xf bank_mask:0xf
    s_nop 1
    v_max_u32_dpp v26, v26, v26 row_ror:1 row_mask:0xf bank_mask:0xf
    s_nop 1
    v_max_u32_dpp v26, v26, v26 row_bcast:15 row_mask:0xa bank_mask:0xf
    s_nop 1
    v_max_u32_dpp v26, v26, v26 row_bcast:31 row_mask:0xc bank_mask:0xf
    s_nop 0
    v_readlane_b32 s41, v26, 63
    s_and_b32 s40, s40, 0xff
    s_and_b32 s41, s41, 0xff
    v_mov_b32 v28, s40
    v_mov_b32 v29, s41
    ds_write_b64 v21, v[28:29]
f_nrs:
    s_waitcnt lgkmcnt(0)
    s_barrier
    ds_read_b64 v[28:29], v21
    s_waitcnt lgkmcnt(0)
    v_readfirstlane_b32 s40, v28
    v_readfirstlane_b32 s41, v29
    s_cmp_eq_u32 s62, s40
    s_cbranch_scc1 f_e0
    s_cmp_eq_u32 s62, s41
    s_cbranch_scc1 f_e0
    s_waitcnt vmcnt(1)
    buffer_store_dwordx4 v[32:35], v3, s[24:27], s18 offen offset:0 sc1
    s_waitcnt vmcnt(1)
    buffer_store_dwordx4 v[36:39], v3, s[24:27], s18 offen offset:1024 sc1
f_e0:
    s_cmp_eq_u32 s63, s40
    s_cbranch_scc1 f_e1
    s_cmp_eq_u32 s63, s41
    s_cbranch_scc1 f_e1
    s_waitcnt vmcnt(1)
    buffer_store_dwordx4 v[40:43], v3, s[24:27], s19 offen offset:0 sc1
    s_waitcnt vmcnt(1)
    buffer_store_dwordx4 v[44:47], v3, s[24:27], s19 offen offset:1024 sc1
f_e1:
    s_endpgm
f_qbad:
    v_mov_b32 v2, 102976
    ds_read2_b32 v[28:29], v2 offset0:1 offset1:3
    ds_read2_b32 v[30:31], v2 offset0:5 offset1:7
    s_waitcnt lgkmcnt(0)
    s_branch f_q
f_t3l:
    ds_read_b128 v[112:115], v248 offset:0
    ds_read_b128 v[116:119], v248 offset:1024
    ds_read_b128 v[120:123], v248 offset:2048
    ds_read_b128 v[124:127], v248 offset:3072
    ds_read_b128 v[128:131], v248 offset:4096
    ds_read_b128 v[132:135], v248 offset:5120
    ds_read_b128 v[136:139], v248 offset:6144
    ds_read_b128 v[140:143], v248 offset:7168
    ds_read_b32 v245, v244
    s_branch f_t3d
f_c1bad:
    s_add_u32 s83, s83, 1
    s_cmp_ge_u32 s83, 0x40000
    s_cbranch_scc1 f_c1ok
    s_bitcmp1_b32 s47, 0
    s_cbranch_scc0 f_c1b2
    s_sleep 3
f_c1b2:
    s_cmp_lg_u32 s34, 0
    s_cbranch_scc1 f_ci1
    s_add_u32 s68, s82, 32768
    buffer_load_dwordx4 v[120:123], v250, s[12:15], s68 offen offset:0 sc1
    buffer_load_dwordx4 v[124:127], v250, s[12:15], s68 offen offset:1024 sc1
f_ci1:
    buffer_load_dwordx4 v[112:115], v250, s[12:15], s82 offen offset:0 sc1
    buffer_load_dwordx4 v[116:119], v250, s[12:15], s82 offen offset:1024 sc1
    s_bitcmp1_b32 s47, 0
    s_cbranch_scc0 f_s1
    s_waitcnt vmcnt(0)
    s_branch f_c1
f_z1bad:
    s_add_u32 s83, s83, 1
    s_cmp_ge_u32 s83, 0x40000
    s_cbranch_scc1 f_z1ok
    s_sleep 4
    buffer_load_dwordx4 v[32:35], v249, s[12:15], s72 offen offset:0 sc1
    buffer_load_dwordx4 v[36:39], v249, s[12:15], s72 offen offset:1024 sc1
    buffer_load_dwordx4 v[40:43], v249, s[12:15], s72 offen offset:2048 sc1
    buffer_load_dwordx4 v[44:47], v249, s[12:15], s72 offen offset:3072 sc1
    s_waitcnt vmcnt(0)
    s_branch f_z1
f_ppbad:
    s_add_u32 s83, s83, 1
    s_cmp_ge_u32 s83, 0x40000
    s_cbranch_scc1 f_ppok
    s_sleep 3
    s_cmp_lt_u32 s16, 4
    s_cselect_b64 exec, -1, 0
    buffer_load_dwordx4 v[20:23], v15, s[12:15], s52 offen sc1
    buffer_load_dwordx4 v[240:243], v15, s[12:15], s53 offen sc1
    s_mov_b64 exec, -1
    s_waitcnt vmcnt(0)
    s_branch f_pp
f_pbbad:
    s_add_u32 s83, s83, 1
    s_cmp_ge_u32 s83, 0x40000
    s_cbranch_scc1 f_pbok
    s_sleep 3
    buffer_load_dwordx4 v[96:99], v15, s[12:15], s41 offen sc1
    buffer_load_dwordx4 v[100:103], v15, s[12:15], s40 offen sc1
    s_waitcnt vmcnt(0)
    s_branch f_pb
f_slowst:
    buffer_store_dwordx4 v[32:35], v14, s[12:15], s74 offen offset:0 sc1
    buffer_store_dwordx4 v[36:39], v14, s[12:15], s74 offen offset:2048 sc1
    buffer_store_dwordx4 v[40:43], v14, s[12:15], s75 offen offset:0 sc1
    buffer_store_dwordx4 v[44:47], v14, s[12:15], s75 offen offset:2048 sc1
    s_branch f_std
f_rare:
    v_and_b32 v2, v21, v35
    v_cmp_eq_u32 s[72:73], 0, v2
    v_and_b32 v2, v21, v39
    v_cmp_eq_u32 s[74:75], 0, v2
    v_and_b32 v2, v21, v43
    v_cmp_eq_u32 s[78:79], 0, v2
    v_and_b32 v2, v21, v47
    v_cmp_eq_u32 s[36:37], 0, v2
    v_or_b32 v35, v21, v35
    v_or_b32 v39, v21, v39
    v_or_b32 v43, v21, v43
    v_or_b32 v47, v21, v47
    v_bfe_u32 v144, v0, 4, 2
    v_lshlrev_b32 v144, 3, v144
    ds_read_b128 v[120:123], v5 offset:10240
    ds_read_b128 v[136:139], v6 offset:9216
    ds_read_b128 v[56:59], v5 offset:2048
    ds_read_b128 v[72:75], v6 offset:1024
    ds_read_b128 v[124:127], v5 offset:11264
    ds_read_b128 v[140:143], v6 offset:8192
    ds_read_b128 v[60:63], v5 offset:3072
    ds_read_b128 v[76:79], v6 offset:0
    ds_read2_b32 v[28:29], v20 offset0:1 offset1:3
    ds_read2_b32 v[30:31], v20 offset0:5 offset1:7
    s_mov_b32 s83, 0
    s_waitcnt lgkmcnt(0)
f_rz:
    buffer_load_dwordx2 v[152:153], v144, s[12:15], s77 offen offset:0 sc1
    buffer_load_dwordx2 v[154:155], v144, s[12:15], s77 offen offset:32 sc1
    buffer_load_dwordx2 v[156:157], v144, s[12:15], s77 offen offset:64 sc1
    buffer_load_dwordx2 v[158:159], v144, s[12:15], s77 offen offset:96 sc1
    s_waitcnt vmcnt(0)
    v_mov_b32 v145, s32
    v_cndmask_b32 v152, v145, v152, s[72:73]
    v_cndmask_b32 v154, v145, v154, s[74:75]
    v_cndmask_b32 v156, v145, v156, s[78:79]
    v_cndmask_b32 v158, v145, v158, s[36:37]
    v_xor_b32 v2, s32, v152
    v_bitop3_b32 v2, v2, v154, s32 bitop3:0xf6
    v_bitop3_b32 v2, v2, v156, s32 bitop3:0xf6
    v_bitop3_b32 v2, v2, v158, s32 bitop3:0xf6
    v_cmp_ne_u32 vcc, 0, v2
    s_cbranch_vccz f_rzx
    s_sleep 2
    s_add_u32 s83, s83, 1
    s_cmp_lt_u32 s83, 0x40000
    s_cbranch_scc1 f_rz
f_rzx:
    v_cndmask_b32 v148, 2, v153, s[72:73]
    v_cndmask_b32 v149, 2, v155, s[74:75]
    v_cndmask_b32 v150, 2, v157, s[78:79]
    v_cndmask_b32 v151, 2, v159, s[36:37]
    v_max_i32 v145, v148, v149
    v_max3_i32 v145, v145, v150, v151
    s_nop 0
    v_readlane_b32 s64, v145, 0
    v_readlane_b32 s65, v145, 16
    v_readlane_b32 s66, v145, 32
    v_readlane_b32 s67, v145, 48
    s_max_i32 s64, s64, s65
    s_max_i32 s66, s66, s67
    s_max_i32 s64, s64, s66
    s_add_i32 s66, s64, 125
    s_lshl_b32 s66, s66, 23
    s_nop 0
    v_subrev_u32 v148, s64, v148
    v_ldexp_f32 v148, 1.0, v148
    v_cvt_pk_f16_f32 v148, v148, v148
    v_subrev_u32 v149, s64, v149
    v_ldexp_f32 v149, 1.0, v149
    v_cvt_pk_f16_f32 v149, v149, v149
    v_subrev_u32 v150, s64, v150
    v_ldexp_f32 v150, 1.0, v150
    v_cvt_pk_f16_f32 v150, v150, v150
    v_subrev_u32 v151, s64, v151
    v_ldexp_f32 v151, 1.0, v151
    v_cvt_pk_f16_f32 v151, v151, v151
    v_pk_mul_f16 v32, v32, v148
    v_pk_mul_f16 v33, v33, v148
    v_pk_mul_f16 v34, v34, v148
    v_pk_mul_f16 v35, v35, v148
    v_pk_mul_f16 v36, v36, v149
    v_pk_mul_f16 v37, v37, v149
    v_pk_mul_f16 v38, v38, v149
    v_pk_mul_f16 v39, v39, v149
    v_pk_mul_f16 v40, v40, v150
    v_pk_mul_f16 v41, v41, v150
    v_pk_mul_f16 v42, v42, v150
    v_pk_mul_f16 v43, v43, v150
    v_pk_mul_f16 v44, v44, v151
    v_pk_mul_f16 v45, v45, v151
    v_pk_mul_f16 v46, v46, v151
    v_pk_mul_f16 v47, v47, v151
    v_pk_mul_f32 v[112:113], v[112:113], s[66:67] op_sel:[0,0] op_sel_hi:[1,0]
    v_pk_mul_f32 v[114:115], v[114:115], s[66:67] op_sel:[0,0] op_sel_hi:[1,0]
    v_pk_mul_f32 v[116:117], v[116:117], s[66:67] op_sel:[0,0] op_sel_hi:[1,0]
    v_pk_mul_f32 v[118:119], v[118:119], s[66:67] op_sel:[0,0] op_sel_hi:[1,0]
    v_pk_mul_f32 v[120:121], v[120:121], s[66:67] op_sel:[0,0] op_sel_hi:[1,0]
    v_pk_mul_f32 v[122:123], v[122:123], s[66:67] op_sel:[0,0] op_sel_hi:[1,0]
    v_pk_mul_f32 v[124:125], v[124:125], s[66:67] op_sel:[0,0] op_sel_hi:[1,0]
    v_pk_mul_f32 v[126:127], v[126:127], s[66:67] op_sel:[0,0] op_sel_hi:[1,0]
    v_pk_mul_f32 v[128:129], v[128:129], s[66:67] op_sel:[0,0] op_sel_hi:[1,0]
    v_pk_mul_f32 v[130:131], v[130:131], s[66:67] op_sel:[0,0] op_sel_hi:[1,0]
    v_pk_mul_f32 v[132:133], v[132:133], s[66:67] op_sel:[0,0] op_sel_hi:[1,0]
    v_pk_mul_f32 v[134:135], v[134:135], s[66:67] op_sel:[0,0] op_sel_hi:[1,0]
    v_pk_mul_f32 v[136:137], v[136:137], s[66:67] op_sel:[0,0] op_sel_hi:[1,0]
    v_pk_mul_f32 v[138:139], v[138:139], s[66:67] op_sel:[0,0] op_sel_hi:[1,0]
    v_pk_mul_f32 v[140:141], v[140:141], s[66:67] op_sel:[0,0] op_sel_hi:[1,0]
    v_pk_mul_f32 v[142:143], v[142:143], s[66:67] op_sel:[0,0] op_sel_hi:[1,0]
    v_mfma_f32_16x16x32_f16 v[80:83], v[32:35], v[192:195], 0
    v_mfma_f32_16x16x32_f16 v[80:83], v[36:39], v[196:199], v[80:83]
    v_mfma_f32_16x16x32_f16 v[80:83], v[40:43], v[200:203], v[80:83]
    v_mfma_f32_16x16x32_f16 v[80:83], v[44:47], v[204:207], v[80:83]
    v_mfma_f32_16x16x32_f16 v[84:87], v[32:35], v[208:211], 0
    v_mfma_f32_16x16x32_f16 v[84:87], v[36:39], v[212:215], v[84:87]
    v_mfma_f32_16x16x32_f16 v[84:87], v[40:43], v[216:219], v[84:87]
    v_mfma_f32_16x16x32_f16 v[84:87], v[44:47], v[220:223], v[84:87]
    s_nop 7
    s_branch f_zfok
f_slow2:
    v_cvt_pk_bf16_f32 v144, v160, v161
    v_lshlrev_b32 v160, 16, v144
    v_and_b32 v161, 0xffff0000, v144
    v_cvt_pk_bf16_f32 v144, v162, v163
    v_lshlrev_b32 v162, 16, v144
    v_and_b32 v163, 0xffff0000, v144
    v_cvt_pk_bf16_f32 v144, v164, v165
    v_lshlrev_b32 v164, 16, v144
    v_and_b32 v165, 0xffff0000, v144
    v_cvt_pk_bf16_f32 v144, v166, v167
    v_lshlrev_b32 v166, 16, v144
    v_and_b32 v167, 0xffff0000, v144
    v_cvt_pk_bf16_f32 v144, v168, v169
    v_lshlrev_b32 v168, 16, v144
    v_and_b32 v169, 0xffff0000, v144
    v_cvt_pk_bf16_f32 v144, v170, v171
    v_lshlrev_b32 v170, 16, v144
    v_and_b32 v171, 0xffff0000, v144
    v_cvt_pk_bf16_f32 v144, v172, v173
    v_lshlrev_b32 v172, 16, v144
    v_and_b32 v173, 0xffff0000, v144
    v_cvt_pk_bf16_f32 v144, v174, v175
    v_lshlrev_b32 v174, 16, v144
    v_and_b32 v175, 0xffff0000, v144
    v_pk_add_f32 v[144:145], v[160:161], v[162:163]
    v_pk_add_f32 v[144:145], v[144:145], v[164:165]
    v_pk_add_f32 v[144:145], v[144:145], v[166:167]
    v_pk_add_f32 v[144:145], v[144:145], v[168:169]
    v_pk_add_f32 v[144:145], v[144:145], v[170:171]
    v_pk_add_f32 v[144:145], v[144:145], v[172:173]
    v_pk_add_f32 v[144:145], v[144:145], v[174:175]
    v_cvt_pk_bf16_f32 v152, v176, v177
    v_lshlrev_b32 v176, 16, v152
    v_and_b32 v177, 0xffff0000, v152
    v_cvt_pk_bf16_f32 v152, v178, v179
    v_lshlrev_b32 v178, 16, v152
    v_and_b32 v179, 0xffff0000, v152
    v_cvt_pk_bf16_f32 v152, v180, v181
    v_lshlrev_b32 v180, 16, v152
    v_and_b32 v181, 0xffff0000, v152
    v_cvt_pk_bf16_f32 v152, v182, v183
    v_lshlrev_b32 v182, 16, v152
    v_and_b32 v183, 0xffff0000, v152
    v_cvt_pk_bf16_f32 v152, v184, v185
    v_lshlrev_b32 v184, 16, v152
    v_and_b32 v185, 0xffff0000, v152
    v_cvt_pk_bf16_f32 v152, v186, v187
    v_lshlrev_b32 v186, 16, v152
    v_and_b32 v187, 0xffff0000, v152
    v_cvt_pk_bf16_f32 v152, v188, v189
    v_lshlrev_b32 v188, 16, v152
    v_and_b32 v189, 0xffff0000, v152
    v_cvt_pk_bf16_f32 v152, v190, v191
    v_lshlrev_b32 v190, 16, v152
    v_and_b32 v191, 0xffff0000, v152
    v_pk_add_f32 v[152:153], v[176:177], v[178:179]
    v_pk_add_f32 v[152:153], v[152:153], v[180:181]
    v_pk_add_f32 v[152:153], v[152:153], v[182:183]
    v_pk_add_f32 v[152:153], v[152:153], v[184:185]
    v_pk_add_f32 v[152:153], v[152:153], v[186:187]
    v_pk_add_f32 v[152:153], v[152:153], v[188:189]
    v_pk_add_f32 v[152:153], v[152:153], v[190:191]
    v_add_f32 v104, v144, v145
    v_add_f32 v108, v152, v153
    s_nop 1
    v_permlane32_swap_b32 v104, v108
    v_add_f32 v104, v104, v108
    s_nop 1
    v_add_f32_dpp v104, v104, v104 row_ror:8 row_mask:0xf bank_mask:0xf
    s_nop 1
    v_add_f32_dpp v104, v104, v104 row_ror:4 row_mask:0xf bank_mask:0xf
    s_nop 1
    v_add_f32_dpp v104, v104, v104 row_ror:2 row_mask:0xf bank_mask:0xf
    s_nop 1
    v_add_f32_dpp v104, v104, v104 row_ror:1 row_mask:0xf bank_mask:0xf
    s_nop 1
    v_add_f32_dpp v104, v104, v104 row_bcast:15 row_mask:0xa bank_mask:0xf
    v_mul_f32 v107, s46, v104
    v_cvt_pk_bf16_f32 v104, v107, v107
    v_lshlrev_b32 v104, 16, v104
    v_sub_f32 v107, v107, v104
    v_readlane_b32 s64, v104, 31
    v_readlane_b32 s66, v104, 63
    s_nop 0
    v_pk_add_f32 v[80:81], v[160:161], s[64:65] op_sel:[0,0] op_sel_hi:[1,0] neg_lo:[0,1] neg_hi:[0,1]
    v_pk_add_f32 v[82:83], v[162:163], s[64:65] op_sel:[0,0] op_sel_hi:[1,0] neg_lo:[0,1] neg_hi:[0,1]
    v_pk_add_f32 v[84:85], v[164:165], s[64:65] op_sel:[0,0] op_sel_hi:[1,0] neg_lo:[0,1] neg_hi:[0,1]
    v_pk_add_f32 v[86:87], v[166:167], s[64:65] op_sel:[0,0] op_sel_hi:[1,0] neg_lo:[0,1] neg_hi:[0,1]
    v_pk_add_f32 v[88:89], v[168:169], s[64:65] op_sel:[0,0] op_sel_hi:[1,0] neg_lo:[0,1] neg_hi:[0,1]
    v_pk_add_f32 v[90:91], v[170:171], s[64:65] op_sel:[0,0] op_sel_hi:[1,0] neg_lo:[0,1] neg_hi:[0,1]
    v_pk_add_f32 v[92:93], v[172:173], s[64:65] op_sel:[0,0] op_sel_hi:[1,0] neg_lo:[0,1] neg_hi:[0,1]
    v_pk_add_f32 v[94:95], v[174:175], s[64:65] op_sel:[0,0] op_sel_hi:[1,0] neg_lo:[0,1] neg_hi:[0,1]
    v_pk_mul_f32 v[146:147], v[80:81], v[80:81]
    v_pk_mul_f32 v[148:149], v[80:81], v[48:49]
    v_pk_fma_f32 v[146:147], v[82:83], v[82:83], v[146:147]
    v_pk_fma_f32 v[148:149], v[82:83], v[50:51], v[148:149]
    v_pk_fma_f32 v[146:147], v[84:85], v[84:85], v[146:147]
    v_pk_fma_f32 v[148:149], v[84:85], v[52:53], v[148:149]
    v_pk_fma_f32 v[146:147], v[86:87], v[86:87], v[146:147]
    v_pk_fma_f32 v[148:149], v[86:87], v[54:55], v[148:149]
    v_pk_fma_f32 v[146:147], v[88:89], v[88:89], v[146:147]
    v_pk_fma_f32 v[148:149], v[88:89], v[56:57], v[148:149]
    v_pk_fma_f32 v[146:147], v[90:91], v[90:91], v[146:147]
    v_pk_fma_f32 v[148:149], v[90:91], v[58:59], v[148:149]
    v_pk_fma_f32 v[146:147], v[92:93], v[92:93], v[146:147]
    v_pk_fma_f32 v[148:149], v[92:93], v[60:61], v[148:149]
    v_pk_fma_f32 v[146:147], v[94:95], v[94:95], v[146:147]
    v_pk_fma_f32 v[148:149], v[94:95], v[62:63], v[148:149]
    v_pk_add_f32 v[32:33], v[176:177], s[66:67] op_sel:[0,0] op_sel_hi:[1,0] neg_lo:[0,1] neg_hi:[0,1]
    v_pk_add_f32 v[34:35], v[178:179], s[66:67] op_sel:[0,0] op_sel_hi:[1,0] neg_lo:[0,1] neg_hi:[0,1]
    v_pk_add_f32 v[36:37], v[180:181], s[66:67] op_sel:[0,0] op_sel_hi:[1,0] neg_lo:[0,1] neg_hi:[0,1]
    v_pk_add_f32 v[38:39], v[182:183], s[66:67] op_sel:[0,0] op_sel_hi:[1,0] neg_lo:[0,1] neg_hi:[0,1]
    v_pk_add_f32 v[40:41], v[184:185], s[66:67] op_sel:[0,0] op_sel_hi:[1,0] neg_lo:[0,1] neg_hi:[0,1]
    v_pk_add_f32 v[42:43], v[186:187], s[66:67] op_sel:[0,0] op_sel_hi:[1,0] neg_lo:[0,1] neg_hi:[0,1]
    v_pk_add_f32 v[44:45], v[188:189], s[66:67] op_sel:[0,0] op_sel_hi:[1,0] neg_lo:[0,1] neg_hi:[0,1]
    v_pk_add_f32 v[46:47], v[190:191], s[66:67] op_sel:[0,0] op_sel_hi:[1,0] neg_lo:[0,1] neg_hi:[0,1]
    v_pk_mul_f32 v[154:155], v[32:33], v[32:33]
    v_pk_mul_f32 v[156:157], v[32:33], v[64:65]
    v_pk_fma_f32 v[154:155], v[34:35], v[34:35], v[154:155]
    v_pk_fma_f32 v[156:157], v[34:35], v[66:67], v[156:157]
    v_pk_fma_f32 v[154:155], v[36:37], v[36:37], v[154:155]
    v_pk_fma_f32 v[156:157], v[36:37], v[68:69], v[156:157]
    v_pk_fma_f32 v[154:155], v[38:39], v[38:39], v[154:155]
    v_pk_fma_f32 v[156:157], v[38:39], v[70:71], v[156:157]
    v_pk_fma_f32 v[154:155], v[40:41], v[40:41], v[154:155]
    v_pk_fma_f32 v[156:157], v[40:41], v[72:73], v[156:157]
    v_pk_fma_f32 v[154:155], v[42:43], v[42:43], v[154:155]
    v_pk_fma_f32 v[156:157], v[42:43], v[74:75], v[156:157]
    v_pk_fma_f32 v[154:155], v[44:45], v[44:45], v[154:155]
    v_pk_fma_f32 v[156:157], v[44:45], v[76:77], v[156:157]
    v_pk_fma_f32 v[154:155], v[46:47], v[46:47], v[154:155]
    v_pk_fma_f32 v[156:157], v[46:47], v[78:79], v[156:157]
    v_add_f32 v105, v146, v147
    v_add_f32 v106, v148, v149
    v_add_f32 v109, v154, v155
    v_add_f32 v110, v156, v157
    s_nop 0
    v_permlane32_swap_b32 v105, v109
    v_permlane32_swap_b32 v106, v110
    v_add_f32 v105, v105, v109
    v_add_f32 v106, v106, v110
    s_nop 0
    v_add_f32_dpp v105, v105, v105 row_ror:8 row_mask:0xf bank_mask:0xf
    v_add_f32_dpp v106, v106, v106 row_ror:8 row_mask:0xf bank_mask:0xf
    s_nop 0
    v_add_f32_dpp v105, v105, v105 row_ror:4 row_mask:0xf bank_mask:0xf
    v_add_f32_dpp v106, v106, v106 row_ror:4 row_mask:0xf bank_mask:0xf
    s_nop 0
    v_add_f32_dpp v105, v105, v105 row_ror:2 row_mask:0xf bank_mask:0xf
    v_add_f32_dpp v106, v106, v106 row_ror:2 row_mask:0xf bank_mask:0xf
    s_nop 0
    v_add_f32_dpp v105, v105, v105 row_ror:1 row_mask:0xf bank_mask:0xf
    v_add_f32_dpp v106, v106, v106 row_ror:1 row_mask:0xf bank_mask:0xf
    s_nop 0
    v_add_f32_dpp v105, v105, v105 row_bcast:15 row_mask:0xa bank_mask:0xf
    v_add_f32_dpp v106, v106, v106 row_bcast:15 row_mask:0xa bank_mask:0xf
    v_mul_f32 v105, s46, v105
    v_fma_f32 v105, -v107, v107, v105
    v_max_f32 v105, 0, v105
    s_branch f_var2
f_slowvar:
    v_lshlrev_b32 v66, 16, v56
    s_nop 0
    v_readlane_b32 s68, v66, 31
    v_readlane_b32 s70, v66, 63
    v_lshlrev_b32 v100, 16, v32
    v_and_b32 v101, 0xffff0000, v32
    v_pk_add_f32 v[100:101], v[100:101], s[68:69] op_sel_hi:[1,0]
    v_pk_mul_f32 v[102:103], v[100:101], v[100:101]
    v_lshlrev_b32 v100, 16, v33
    v_and_b32 v101, 0xffff0000, v33
    v_pk_add_f32 v[100:101], v[100:101], s[68:69] op_sel_hi:[1,0]
    v_pk_fma_f32 v[102:103], v[100:101], v[100:101], v[102:103]
    v_lshlrev_b32 v100, 16, v34
    v_and_b32 v101, 0xffff0000, v34
    v_pk_add_f32 v[100:101], v[100:101], s[68:69] op_sel_hi:[1,0]
    v_pk_fma_f32 v[102:103], v[100:101], v[100:101], v[102:103]
    v_lshlrev_b32 v100, 16, v35
    v_and_b32 v101, 0xffff0000, v35
    v_pk_add_f32 v[100:101], v[100:101], s[68:69] op_sel_hi:[1,0]
    v_pk_fma_f32 v[102:103], v[100:101], v[100:101], v[102:103]
    v_lshlrev_b32 v100, 16, v36
    v_and_b32 v101, 0xffff0000, v36
    v_pk_add_f32 v[100:101], v[100:101], s[68:69] op_sel_hi:[1,0]
    v_pk_fma_f32 v[102:103], v[100:101], v[100:101], v[102:103]
    v_lshlrev_b32 v100, 16, v37
    v_and_b32 v101, 0xffff0000, v37
    v_pk_add_f32 v[100:101], v[100:101], s[68:69] op_sel_hi:[1,0]
    v_pk_fma_f32 v[102:103], v[100:101], v[100:101], v[102:103]
    v_lshlrev_b32 v100, 16, v38
    v_and_b32 v101, 0xffff0000, v38
    v_pk_add_f32 v[100:101], v[100:101], s[68:69] op_sel_hi:[1,0]
    v_pk_fma_f32 v[102:103], v[100:101], v[100:101], v[102:103]
    v_lshlrev_b32 v100, 16, v39
    v_and_b32 v101, 0xffff0000, v39
    v_pk_add_f32 v[100:101], v[100:101], s[68:69] op_sel_hi:[1,0]
    v_pk_fma_f32 v[102:103], v[100:101], v[100:101], v[102:103]
    v_add_f32 v54, v102, v103
    v_lshlrev_b32 v100, 16, v40
    v_and_b32 v101, 0xffff0000, v40
    v_pk_add_f32 v[100:101], v[100:101], s[70:71] op_sel_hi:[1,0]
    v_pk_mul_f32 v[102:103], v[100:101], v[100:101]
    v_lshlrev_b32 v100, 16, v41
    v_and_b32 v101, 0xffff0000, v41
    v_pk_add_f32 v[100:101], v[100:101], s[70:71] op_sel_hi:[1,0]
    v_pk_fma_f32 v[102:103], v[100:101], v[100:101], v[102:103]
    v_lshlrev_b32 v100, 16, v42
    v_and_b32 v101, 0xffff0000, v42
    v_pk_add_f32 v[100:101], v[100:101], s[70:71] op_sel_hi:[1,0]
    v_pk_fma_f32 v[102:103], v[100:101], v[100:101], v[102:103]
    v_lshlrev_b32 v100, 16, v43
    v_and_b32 v101, 0xffff0000, v43
    v_pk_add_f32 v[100:101], v[100:101], s[70:71] op_sel_hi:[1,0]
    v_pk_fma_f32 v[102:103], v[100:101], v[100:101], v[102:103]
    v_lshlrev_b32 v100, 16, v44
    v_and_b32 v101, 0xffff0000, v44
    v_pk_add_f32 v[100:101], v[100:101], s[70:71] op_sel_hi:[1,0]
    v_pk_fma_f32 v[102:103], v[100:101], v[100:101], v[102:103]
    v_lshlrev_b32 v100, 16, v45
    v_and_b32 v101, 0xffff0000, v45
    v_pk_add_f32 v[100:101], v[100:101], s[70:71] op_sel_hi:[1,0]
    v_pk_fma_f32 v[102:103], v[100:101], v[100:101], v[102:103]
    v_lshlrev_b32 v100, 16, v46
    v_and_b32 v101, 0xffff0000, v46
    v_pk_add_f32 v[100:101], v[100:101], s[70:71] op_sel_hi:[1,0]
    v_pk_fma_f32 v[102:103], v[100:101], v[100:101], v[102:103]
    v_lshlrev_b32 v100, 16, v47
    v_and_b32 v101, 0xffff0000, v47
    v_pk_add_f32 v[100:101], v[100:101], s[70:71] op_sel_hi:[1,0]
    v_pk_fma_f32 v[102:103], v[100:101], v[100:101], v[102:103]
    v_add_f32 v55, v102, v103
    v_add_f32 v66, v66, v52
    s_nop 0
    v_permlane32_swap_b32 v54, v55
    v_add_f32 v54, v54, v55
    s_nop 1
    v_add_f32_dpp v54, v54, v54 row_ror:8 row_mask:0xf bank_mask:0xf
    s_nop 1
    v_add_f32_dpp v54, v54, v54 row_ror:4 row_mask:0xf bank_mask:0xf
    s_nop 1
    v_add_f32_dpp v54, v54, v54 row_ror:2 row_mask:0xf bank_mask:0xf
    s_nop 1
    v_add_f32_dpp v54, v54, v54 row_ror:1 row_mask:0xf bank_mask:0xf
    s_nop 1
    v_add_f32_dpp v54, v54, v54 row_bcast:15 row_mask:0xa bank_mask:0xf
    v_mul_f32 v54, s46, v54
    v_fma_f32 v54, -v66, v66, v54
    v_max_f32 v54, 0, v54
    s_branch f_var
f_sa:
    s_add_u32 s69, s69, 50331648
    v_cndmask_b32 v120, v120, v121, s[64:65]
    v_cndmask_b32 v122, v122, v123, s[64:65]
    v_cndmask_b32 v120, v120, v122, s[66:67]
    v_mul_f32 v120, s69, v120
    v_and_b32 v52, 15, v0
    v_cvt_pk_f16_f32 v48, v120, v120
    v_cmp_eq_u32 vcc, 0, v52
    v_mov_b32 v54, 0x3c00
    v_mov_b32 v55, 0xbc000000
    v_cndmask_b32 v54, 0, v54, vcc
    v_cndmask_b32 v55, 0, v55, vcc
    v_mov_b32_dpp v56, v48 quad_perm:[0,0,0,0] row_mask:0xf bank_mask:0xf
    v_mov_b32_dpp v57, v48 quad_perm:[1,1,1,1] row_mask:0xf bank_mask:0xf
    v_mov_b32_dpp v58, v48 quad_perm:[2,2,2,2] row_mask:0xf bank_mask:0xf
    v_mov_b32_dpp v59, v48 quad_perm:[3,3,3,3] row_mask:0xf bank_mask:0xf
    v_pk_mul_f16 v72, v54, v56
    v_pk_mul_f16 v73, v54, v57
    v_pk_mul_f16 v74, v54, v58
    v_pk_mul_f16 v75, v54, v59
    v_pk_mul_f16 v76, v55, v56
    v_pk_mul_f16 v77, v55, v57
    v_pk_mul_f16 v78, v55, v58
    v_pk_mul_f16 v79, v55, v59
    v_mfma_f32_16x16x32_f16 v[112:115], v[72:75], v[144:147], 0
    s_nop 0
    v_mfma_f32_16x16x32_f16 v[116:119], v[76:79], v[144:147], 0
    s_lshl_b32 s70, s16, 7
    v_mov_b32 v53, 8592
    v_add3_u32 v52, s70, v12, v53
    s_mov_b64 exec, 0xffff
    s_nop 3
    ds_write2_b32 v52, v112, v116 offset0:0 offset1:16
    s_mov_b64 exec, -1
    s_branch f_nsa
f_sb:
    v_mov_b32 v48, s32
    v_mov_b32 v49, s61
    v_mov_b32 v50, 0
    s_cmp_lg_u32 s17, 0
    s_cselect_b64 exec, 1, 0
    buffer_store_dwordx2 v[48:49], v50, s[12:15], s79 offen sc1
    s_mov_b64 exec, -1
    s_cmp_lg_u32 s34, 0
    s_cbranch_scc1 f_sb2
    s_mov_b64 exec, 0xffff
    ds_read_b32 v56, v12 offset:8592
    ds_read_b32 v57, v12 offset:8656
    ds_read_b32 v58, v12 offset:8720
    ds_read_b32 v59, v12 offset:8784
    ds_read_b32 v60, v12 offset:8848
    ds_read_b32 v61, v12 offset:8912
    ds_read_b32 v62, v12 offset:8976
    ds_read_b32 v63, v12 offset:9040
    s_waitcnt lgkmcnt(0)
    v_add_f32 v80, v80, v56
    v_add_f32 v84, v84, v57
    v_add_f32 v88, v88, v58
    v_add_f32 v92, v92, v59
    v_add_f32 v96, v96, v60
    v_add_f32 v100, v100, v61
    v_add_f32 v104, v104, v62
    v_add_f32 v108, v108, v63
    s_mov_b64 exec, -1
f_sb2:
    s_branch f_nsb
f_sp:
    s_waitcnt lgkmcnt(0)
    v_mfma_f32_16x16x32_f16 v[88:91], v[32:35], v[224:227], 0
    v_mfma_f32_16x16x32_f16 v[88:91], v[36:39], v[228:231], v[88:91]
    v_mfma_f32_16x16x32_f16 v[88:91], v[40:43], v[232:235], v[88:91]
    v_mfma_f32_16x16x32_f16 v[88:91], v[44:47], v[236:239], v[88:91]
    v_mfma_f32_16x16x32_f16 v[92:95], v[32:35], v[240:243], 0
    v_mfma_f32_16x16x32_f16 v[92:95], v[36:39], v[244:247], v[92:95]
    v_mfma_f32_16x16x32_f16 v[92:95], v[40:43], v[248:251], v[92:95]
    v_mfma_f32_16x16x32_f16 v[92:95], v[44:47], v[252:255], v[92:95]
    v_pk_mul_f16 v32, v32, 1.0 op_sel:[1,0] op_sel_hi:[0,0] neg_hi:[1,0]
    v_pk_mul_f16 v33, v33, 1.0 op_sel:[1,0] op_sel_hi:[0,0] neg_hi:[1,0]
    v_pk_mul_f16 v34, v34, 1.0 op_sel:[1,0] op_sel_hi:[0,0] neg_hi:[1,0]
    v_pk_mul_f16 v35, v35, 1.0 op_sel:[1,0] op_sel_hi:[0,0] neg_hi:[1,0]
    v_pk_mul_f16 v36, v36, 1.0 op_sel:[1,0] op_sel_hi:[0,0] neg_hi:[1,0]
    v_pk_mul_f16 v37, v37, 1.0 op_sel:[1,0] op_sel_hi:[0,0] neg_hi:[1,0]
    v_pk_mul_f16 v38, v38, 1.0 op_sel:[1,0] op_sel_hi:[0,0] neg_hi:[1,0]
    v_pk_mul_f16 v39, v39, 1.0 op_sel:[1,0] op_sel_hi:[0,0] neg_hi:[1,0]
    v_pk_mul_f16 v40, v40, 1.0 op_sel:[1,0] op_sel_hi:[0,0] neg_hi:[1,0]
    v_pk_mul_f16 v41, v41, 1.0 op_sel:[1,0] op_sel_hi:[0,0] neg_hi:[1,0]
    v_pk_mul_f16 v42, v42, 1.0 op_sel:[1,0] op_sel_hi:[0,0] neg_hi:[1,0]
    v_pk_mul_f16 v43, v43, 1.0 op_sel:[1,0] op_sel_hi:[0,0] neg_hi:[1,0]
    v_pk_mul_f16 v44, v44, 1.0 op_sel:[1,0] op_sel_hi:[0,0] neg_hi:[1,0]
    v_pk_mul_f16 v45, v45, 1.0 op_sel:[1,0] op_sel_hi:[0,0] neg_hi:[1,0]
    v_pk_mul_f16 v46, v46, 1.0 op_sel:[1,0] op_sel_hi:[0,0] neg_hi:[1,0]
    v_pk_mul_f16 v47, v47, 1.0 op_sel:[1,0] op_sel_hi:[0,0] neg_hi:[1,0]
    v_mfma_f32_16x16x32_f16 v[96:99], v[32:35], v[192:195], 0
    v_mfma_f32_16x16x32_f16 v[96:99], v[36:39], v[196:199], v[96:99]
    v_mfma_f32_16x16x32_f16 v[96:99], v[40:43], v[200:203], v[96:99]
    v_mfma_f32_16x16x32_f16 v[96:99], v[44:47], v[204:207], v[96:99]
    v_mfma_f32_16x16x32_f16 v[100:103], v[32:35], v[208:211], 0
    v_mfma_f32_16x16x32_f16 v[100:103], v[36:39], v[212:215], v[100:103]
    v_mfma_f32_16x16x32_f16 v[100:103], v[40:43], v[216:219], v[100:103]
    v_mfma_f32_16x16x32_f16 v[100:103], v[44:47], v[220:223], v[100:103]
    v_mfma_f32_16x16x32_f16 v[104:107], v[32:35], v[224:227], 0
    v_mfma_f32_16x16x32_f16 v[104:107], v[36:39], v[228:231], v[104:107]
    v_mfma_f32_16x16x32_f16 v[104:107], v[40:43], v[232:235], v[104:107]
    v_mfma_f32_16x16x32_f16 v[104:107], v[44:47], v[236:239], v[104:107]
    v_mfma_f32_16x16x32_f16 v[108:111], v[32:35], v[240:243], 0
    v_mfma_f32_16x16x32_f16 v[108:111], v[36:39], v[244:247], v[108:111]
    v_mfma_f32_16x16x32_f16 v[108:111], v[40:43], v[248:251], v[108:111]
    v_mfma_f32_16x16x32_f16 v[108:111], v[44:47], v[252:255], v[108:111]
    v_subrev_u32 v2, s45, v8
    v_lshlrev_b32 v2, 1, v2
    v_add_u32 v20, s45, v2
    s_add_u32 s42, s45, 1008
    v_sub_u32 v21, s42, v2
    ds_write_b128 v20, v[80:83] offset:0
    ds_write_b128 v20, v[84:87] offset:1024
    ds_write_b128 v20, v[88:91] offset:2048
    ds_write_b128 v20, v[92:95] offset:3072
    v_sub_u32 v156, 4096, v2
    v_and_b32 v156, 4095, v156
    v_add_u32 v156, s45, v156
    v_sub_u32 v157, 3072, v2
    v_and_b32 v157, 4095, v157
    v_add_u32 v157, s45, v157
    v_sub_u32 v158, 2048, v2
    v_and_b32 v158, 4095, v158
    v_add_u32 v158, s45, v158
    v_sub_u32 v159, 1024, v2
    v_and_b32 v159, 4095, v159
    v_add_u32 v159, s45, v159
    ds_read_b128 v[32:35], v21 offset:3072
    ds_read_b128 v[36:39], v21 offset:2048
    ds_read_b128 v[40:43], v21 offset:1024
    ds_read_b128 v[44:47], v21 offset:0
    ds_read_b32 v152, v156
    ds_read_b32 v153, v157
    ds_read_b32 v154, v158
    ds_read_b32 v155, v159
    s_waitcnt lgkmcnt(0)
    v_add_f32 v80, v80, v152
    v_add_f32 v81, v81, v35
    v_add_f32 v82, v82, v34
    v_add_f32 v83, v83, v33
    v_add_f32 v84, v84, v153
    v_add_f32 v85, v85, v39
    v_add_f32 v86, v86, v38
    v_add_f32 v87, v87, v37
    v_add_f32 v88, v88, v154
    v_add_f32 v89, v89, v43
    v_add_f32 v90, v90, v42
    v_add_f32 v91, v91, v41
    v_add_f32 v92, v92, v155
    v_add_f32 v93, v93, v47
    v_add_f32 v94, v94, v46
    v_add_f32 v95, v95, v45
    v_pk_fma_f32 v[160:161], v[112:113], v[80:81], v[160:161]
    v_pk_fma_f32 v[162:163], v[114:115], v[82:83], v[162:163]
    v_pk_fma_f32 v[164:165], v[116:117], v[84:85], v[164:165]
    v_pk_fma_f32 v[166:167], v[118:119], v[86:87], v[166:167]
    v_pk_fma_f32 v[168:169], v[120:121], v[88:89], v[168:169]
    v_pk_fma_f32 v[170:171], v[122:123], v[90:91], v[170:171]
    v_pk_fma_f32 v[172:173], v[124:125], v[92:93], v[172:173]
    v_pk_fma_f32 v[174:175], v[126:127], v[94:95], v[174:175]
    ds_write_b128 v20, v[96:99] offset:0
    ds_write_b128 v20, v[100:103] offset:1024
    ds_write_b128 v20, v[104:107] offset:2048
    ds_write_b128 v20, v[108:111] offset:3072
    v_add_u32 v156, 16, v2
    v_and_b32 v156, 4095, v156
    v_add_u32 v156, s45, v156
    v_add_u32 v157, 1040, v2
    v_and_b32 v157, 4095, v157
    v_add_u32 v157, s45, v157
    v_add_u32 v158, 2064, v2
    v_and_b32 v158, 4095, v158
    v_add_u32 v158, s45, v158
    v_add_u32 v159, 3088, v2
    v_and_b32 v159, 4095, v159
    v_add_u32 v159, s45, v159
    ds_read_b128 v[32:35], v21 offset:3072
    ds_read_b128 v[36:39], v21 offset:2048
    ds_read_b128 v[40:43], v21 offset:1024
    ds_read_b128 v[44:47], v21 offset:0
    ds_read_b32 v152, v156
    ds_read_b32 v153, v157
    ds_read_b32 v154, v158
    ds_read_b32 v155, v159
    s_waitcnt lgkmcnt(0)
    v_add_f32 v32, v32, v152
    v_add_f32 v33, v33, v99
    v_add_f32 v34, v34, v98
    v_add_f32 v35, v35, v97
    v_add_f32 v36, v36, v153
    v_add_f32 v37, v37, v103
    v_add_f32 v38, v38, v102
    v_add_f32 v39, v39, v101
    v_add_f32 v40, v40, v154
    v_add_f32 v41, v41, v107
    v_add_f32 v42, v42, v106
    v_add_f32 v43, v43, v105
    v_add_f32 v44, v44, v155
    v_add_f32 v45, v45, v111
    v_add_f32 v46, v46, v110
    v_add_f32 v47, v47, v109
    v_pk_fma_f32 v[176:177], v[128:129], v[32:33], v[176:177]
    v_pk_fma_f32 v[178:179], v[130:131], v[34:35], v[178:179]
    v_pk_fma_f32 v[180:181], v[132:133], v[36:37], v[180:181]
    v_pk_fma_f32 v[182:183], v[134:135], v[38:39], v[182:183]
    v_pk_fma_f32 v[184:185], v[136:137], v[40:41], v[184:185]
    v_pk_fma_f32 v[186:187], v[138:139], v[42:43], v[186:187]
    v_pk_fma_f32 v[188:189], v[140:141], v[44:45], v[188:189]
    v_pk_fma_f32 v[190:191], v[142:143], v[46:47], v[190:191]
    v_pk_mul_f32 v[146:147], v[160:161], v[160:161]
    v_pk_mul_f32 v[148:149], v[160:161], v[48:49]
    v_pk_fma_f32 v[146:147], v[162:163], v[162:163], v[146:147]
    v_pk_fma_f32 v[148:149], v[162:163], v[50:51], v[148:149]
    v_pk_fma_f32 v[146:147], v[164:165], v[164:165], v[146:147]
    v_pk_fma_f32 v[148:149], v[164:165], v[52:53], v[148:149]
    v_pk_fma_f32 v[146:147], v[166:167], v[166:167], v[146:147]
    v_pk_fma_f32 v[148:149], v[166:167], v[54:55], v[148:149]
    v_pk_fma_f32 v[146:147], v[168:169], v[168:169], v[146:147]
    v_pk_fma_f32 v[148:149], v[168:169], v[56:57], v[148:149]
    v_pk_fma_f32 v[146:147], v[170:171], v[170:171], v[146:147]
    v_pk_fma_f32 v[148:149], v[170:171], v[58:59], v[148:149]
    v_pk_fma_f32 v[146:147], v[172:173], v[172:173], v[146:147]
    v_pk_fma_f32 v[148:149], v[172:173], v[60:61], v[148:149]
    v_pk_fma_f32 v[146:147], v[174:175], v[174:175], v[146:147]
    v_pk_fma_f32 v[148:149], v[174:175], v[62:63], v[148:149]
    v_pk_add_f32 v[144:145], v[160:161], v[162:163]
    v_pk_add_f32 v[144:145], v[144:145], v[164:165]
    v_pk_add_f32 v[144:145], v[144:145], v[166:167]
    v_pk_add_f32 v[144:145], v[144:145], v[168:169]
    v_pk_add_f32 v[144:145], v[144:145], v[170:171]
    v_pk_add_f32 v[144:145], v[144:145], v[172:173]
    v_pk_add_f32 v[144:145], v[144:145], v[174:175]
    v_pk_mul_f32 v[154:155], v[176:177], v[176:177]
    v_pk_mul_f32 v[156:157], v[176:177], v[64:65]
    v_pk_fma_f32 v[154:155], v[178:179], v[178:179], v[154:155]
    v_pk_fma_f32 v[156:157], v[178:179], v[66:67], v[156:157]
    v_pk_fma_f32 v[154:155], v[180:181], v[180:181], v[154:155]
    v_pk_fma_f32 v[156:157], v[180:181], v[68:69], v[156:157]
    v_pk_fma_f32 v[154:155], v[182:183], v[182:183], v[154:155]
    v_pk_fma_f32 v[156:157], v[182:183], v[70:71], v[156:157]
    v_pk_fma_f32 v[154:155], v[184:185], v[184:185], v[154:155]
    v_pk_fma_f32 v[156:157], v[184:185], v[72:73], v[156:157]
    v_pk_fma_f32 v[154:155], v[186:187], v[186:187], v[154:155]
    v_pk_fma_f32 v[156:157], v[186:187], v[74:75], v[156:157]
    v_pk_fma_f32 v[154:155], v[188:189], v[188:189], v[154:155]
    v_pk_fma_f32 v[156:157], v[188:189], v[76:77], v[156:157]
    v_pk_fma_f32 v[154:155], v[190:191], v[190:191], v[154:155]
    v_pk_fma_f32 v[156:157], v[190:191], v[78:79], v[156:157]
    v_pk_add_f32 v[152:153], v[176:177], v[178:179]
    v_pk_add_f32 v[152:153], v[152:153], v[180:181]
    v_pk_add_f32 v[152:153], v[152:153], v[182:183]
    v_pk_add_f32 v[152:153], v[152:153], v[184:185]
    v_pk_add_f32 v[152:153], v[152:153], v[186:187]
    v_pk_add_f32 v[152:153], v[152:153], v[188:189]
    v_pk_add_f32 v[152:153], v[152:153], v[190:191]
    s_branch f_join
g_start:
    s_mov_b32 s43, 6619136
    s_load_dword s101, s[6:7], s43
    s_mov_b32 s44, s20
    s_mov_b32 s45, s21
    s_mov_b32 s46, 2048
    s_mov_b32 s47, 0x00020000
    v_and_b32 v6, 127, v0
    v_lshlrev_b32 v6, 1, v6
    s_lshl_b32 s19, s34, 8
    buffer_load_ushort v110, v6, s[44:47], s19 offen
    s_and_b32 s65, s35, 1
    s_lshr_b32 s40, s35, 1
    s_mul_i32 s64, s34, 7
    s_add_u32 s64, s64, s40
    s_cmp_ge_u32 s35, 14
    s_cselect_b32 s66, 1, 0
    s_mov_b32 s40, s34
    v_bfe_u32 v5, v0, 5, 1
    v_lshlrev_b32 v5, 3, v5
    v_bfe_u32 v9, v0, 3, 2
    v_add_u32 v5, v5, v9
    v_lshlrev_b32 v9, 1, v7
    v_xor_b32 v9, v9, v0
    v_and_b32 v9, 7, v9
    v_lshlrev_b32 v9, 4, v9
    s_movk_i32 s42, 7168
    v_mad_u32_u24 v5, v5, s42, v9
    v_mov_b32 v104, -1
    v_mov_b32 v105, -1
    v_mov_b32 v106, -1
    v_mov_b32 v107, -1
    v_mov_b32 v14, 0
    s_lshl_b32 s38, s64, 12
    s_lshl_b32 s42, s16, 9
    s_add_u32 s38, s38, s42
    s_mul_i32 s42, s65, 262144
    s_add_u32 s38, s38, s42
    s_add_u32 s38, s38, 4718592
    s_mov_b32 s12, s6
    s_mov_b32 s13, s7
    s_mov_b32 s14, 268435456
    s_mov_b32 s15, 0x00020000
    s_lshl_b32 s42, s35, 3
    s_add_u32 s42, s42, s34
    s_lshl_b32 s42, s42, 3
    s_add_u32 s42, s42, s16
    s_lshl_b32 s42, s42, 8
    s_add_u32 s42, s42, 6291456
    v_lshlrev_b32 v9, 7, v2
    s_mov_b64 exec, 3
    buffer_load_dword v251, v9, s[12:15], s42 offen
    s_mov_b64 exec, -1
    s_mov_b32 s44, s50
    s_mov_b32 s45, s51
    s_mov_b32 s46, 7340032
    s_mov_b32 s47, 0x00020000
    s_mov_b32 s60, s52
    s_mov_b32 s61, s53
    s_mov_b32 s62, 7340032
    s_mov_b32 s63, 0x00020000
    s_mov_b32 s72, s54
    s_mov_b32 s73, s55
    s_mov_b32 s74, 7340032
    s_mov_b32 s75, 0x00020000
    s_mov_b32 s26, 4194304
    s_mov_b32 s27, 0x00020000
    s_lshl_b32 s67, s65, 4
    s_add_u32 s67, s67, s16
    s_mul_i32 s67, s67, 229376
    s_lshl_b32 s42, s64, 7
    s_add_u32 s67, s67, s42
    s_lshl_b32 s42, s64, 6
    s_and_b32 s43, s16, 3
    s_lshl_b32 s43, s43, 3
    s_add_u32 s42, s42, s43
    s_and_b32 s43, s16, 4
    s_add_u32 s42, s42, s43
    s_lshl_b32 s69, s42, 11
    s_lshl_b32 s43, s65, 10
    s_add_u32 s69, s69, s43
    s_and_b32 s43, s16, 1
    s_lshl_b32 s43, s43, 7
    v_xor_b32 v21, s43, v3
    v_xor_b32 v22, 32, v21
    v_xor_b32 v23, 64, v21
    v_xor_b32 v24, 96, v21
    v_add_u32 v109, 131072, v6
    v_lshrrev_b32 v6, 2, v2
    v_and_b32 v15, 3, v0
    v_bfe_u32 v16, v0, 3, 2
    v_xor_b32 v12, v16, v1
    v_and_b32 v12, 3, v12
    v_lshlrev_b32 v12, 5, v12
    v_lshl_add_u32 v12, v6, 7, v12
    v_lshl_add_u32 v12, v15, 3, v12
    v_lshrrev_b32 v16, 2, v1
    v_lshl_add_u32 v12, v16, 14, v12
    v_add_u32 v25, 65536, v12
    v_and_b32 v17, 7, v6
    v_lshlrev_b32 v8, 2, v1
    v_xor_b32 v8, v8, v17
    v_lshlrev_b32 v8, 5, v8
    v_lshl_add_u32 v8, v6, 10, v8
    v_lshl_add_u32 v8, v15, 3, v8
    v_xor_b32 v9, 32, v8
    v_xor_b32 v10, 64, v8
    v_xor_b32 v11, 96, v8
    v_and_b32 v6, 1, v0
    v_lshlrev_b32 v17, 10, v6
    v_lshl_add_u32 v17, v16, 8, v17
    v_bfe_u32 v18, v0, 1, 1
    v_lshlrev_b32 v19, 4, v18
    v_lshl_add_u32 v19, v7, 5, v19
    v_add_u32 v17, v17, v19
    v_add_u32 v17, 131584, v17
    v_lshl_add_u32 v19, v6, 7, v19
    v_add_u32 v19, 133632, v19
    v_mul_u32_u24 v213, 0xaaaa, v18
    v_add_u32 v213, 0x4444, v213
    v_lshlrev_b32 v18, 4, v18
    v_lshl_add_u32 v18, v6, 1, v18
    v_and_b32 v6, 12, v0
    v_add_u32 v18, v18, v6
    v_and_b32 v6, 15, v0
    v_lshl_add_u32 v18, v1, 5, v18
    v_lshl_add_u32 v18, v7, 7, v18
    v_add_u32 v18, 133632, v18
    v_lshlrev_b32 v20, 2, v6
    v_lshl_add_u32 v20, v1, 14, v20
    v_lshl_add_u32 v20, v7, 12, v20
    v_lshlrev_b32 v26, 4, v7
    v_add_u32 v27, 131072, v26
    v_lshlrev_b32 v28, 11, v7
    v_bfe_u32 v29, v0, 2, 3
    v_xor_b32 v29, v29, v1
    v_lshl_add_u32 v29, v29, 5, v28
    v_bfe_u32 v30, v0, 2, 2
    v_lshl_add_u32 v29, v30, 8, v29
    v_lshl_add_u32 v29, v15, 3, v29
    v_add_u32 v30, 65536, v29
    s_lshl_b32 s30, s41, 15
    s_and_b32 s42, s16, 3
    s_lshl_b32 s42, s42, 13
    s_add_u32 s30, s30, s42
    s_lshl_b32 s42, s40, 8
    s_add_u32 s30, s30, s42
    s_lshl_b32 s42, s17, 1
    s_lshr_b32 s43, s16, 2
    s_add_u32 s42, s42, s43
    s_lshl_b32 s42, s42, 4
    s_add_u32 s30, s30, s42
    s_add_u32 s30, s30, 6291456
    s_lshl_b32 s31, s41, 5
    s_lshr_b32 s42, s16, 1
    s_add_u32 s31, s31, s42
    s_lshl_b32 s31, s31, 10
    s_lshl_b32 s42, s40, 7
    s_add_u32 s31, s31, s42
    s_and_b32 s42, s16, 1
    s_lshl_b32 s42, s42, 6
    s_add_u32 s31, s31, s42
    s_add_u32 s31, s31, 6356992
    s_movk_i32 s33, 0xff
    s_cmp_eq_u32 s66, 1
    s_cbranch_scc1 x_start
    s_mul_i32 s70, s41, -4096
    s_add_u32 s70, s70, 8192
    s_add_u32 s70, s70, s18
    s_add_u32 s42, s17, 1
    s_and_b32 s42, s42, 7
    s_lshl_b32 s42, s42, 8
    s_add_u32 s70, s70, s42
    s_add_u32 s43, s68, 32768
    s_mov_b32 m0, s43
    s_add_u32 s42, s70, 0
    s_waitcnt vmcnt(5)
    buffer_load_dwordx4 v4, s[8:11], s42 offen  lds
    s_add_u32 s43, s68, 33792
    s_mov_b32 m0, s43
    s_add_u32 s42, s70, 49152
    s_waitcnt vmcnt(5)
    buffer_load_dwordx4 v4, s[8:11], s42 offen  lds
    s_add_u32 s43, s68, 34816
    s_mov_b32 m0, s43
    s_add_u32 s42, s70, 98304
    s_waitcnt vmcnt(5)
    buffer_load_dwordx4 v31, s[8:11], s42 offen  lds
    s_add_u32 s43, s68, 35840
    s_mov_b32 m0, s43
    s_add_u32 s42, s70, 147456
    s_waitcnt vmcnt(5)
    buffer_load_dwordx4 v31, s[8:11], s42 offen  lds
    s_waitcnt vmcnt(5)
    v_lshlrev_b32 v110, 16, v110
    v_mul_f32 v111, 0xbfb8aa3b, v110
    v_exp_f32 v111, v111
    s_nop 0
    v_add_f32 v111, 1.0, v111
    v_rcp_f32 v111, v111
    s_nop 0
    v_mul_f32 v110, v110, v111
    v_cvt_pk_bf16_f32 v110, v110, v110
    ds_write_b16 v109, v110
    s_waitcnt lgkmcnt(0)
    s_barrier
    ds_read_b128 v[128:131], v27 offset:0
    ds_read_b128 v[132:135], v27 offset:64
    ds_read_b128 v[136:139], v27 offset:128
    ds_read_b128 v[140:143], v27 offset:192
    ds_read_b64_tr_b16 v[144:145], v29 offset:0
    ds_read_b64_tr_b16 v[146:147], v29 offset:1024
    ds_read_b64_tr_b16 v[148:149], v29 offset:8192
    ds_read_b64_tr_b16 v[150:151], v29 offset:9216
    ds_read_b64_tr_b16 v[152:153], v29 offset:16384
    ds_read_b64_tr_b16 v[154:155], v29 offset:17408
    ds_read_b64_tr_b16 v[156:157], v29 offset:24576
    ds_read_b64_tr_b16 v[158:159], v29 offset:25600
    s_mul_i32 s32, s101, 0x9e3779b1
    s_or_b32 s32, s32, 0x101
    s_and_b32 s32, s32, 0xfffefbfb
    s_and_b32 s56, s32, 0xff
    s_bfe_u32 s57, s32, 0x80008
    s_bfe_u32 s58, s32, 0x80010
    s_lshr_b32 s59, s32, 24
    v_mov_b32 v164, s56
    v_mov_b32 v165, s57
    v_mov_b32 v166, s58
    v_mov_b32 v167, s59
    s_waitcnt lgkmcnt(6)
    v_mfma_f32_16x16x32_bf16 v[160:163], v[144:147], v[128:131], 0
    s_waitcnt lgkmcnt(4)
    v_mfma_f32_16x16x32_bf16 v[160:163], v[148:151], v[132:135], v[160:163]
    s_waitcnt lgkmcnt(2)
    v_mfma_f32_16x16x32_bf16 v[160:163], v[152:155], v[136:139], v[160:163]
    s_waitcnt lgkmcnt(0)
    v_mfma_f32_16x16x32_bf16 v[160:163], v[156:159], v[140:143], v[160:163]
    s_nop 7
    v_bfi_b32 v160, s33, v164, v160
    v_bfi_b32 v161, s33, v165, v161
    v_bfi_b32 v162, s33, v166, v162
    v_bfi_b32 v163, s33, v167, v163
    s_mov_b32 exec_lo, 0x00010001
    s_mov_b32 exec_hi, 0x00010001
    buffer_store_dwordx4 v[160:163], v28, s[12:15], s30 offen sc1
    s_mov_b64 exec, -1
    s_mul_i32 s70, s41, 4096
    s_add_u32 s70, s70, 6144
    s_add_u32 s70, s70, s18
    s_add_u32 s42, s17, 2
    s_and_b32 s42, s42, 7
    s_lshl_b32 s42, s42, 8
    s_add_u32 s70, s70, s42
    s_add_u32 s43, s68, 65536
    s_mov_b32 m0, s43
    s_add_u32 s42, s70, 0
    s_waitcnt vmcnt(4)
    buffer_load_dwordx4 v4, s[8:11], s42 offen  lds
    s_add_u32 s43, s68, 66560
    s_mov_b32 m0, s43
    s_add_u32 s42, s70, 49152
    s_waitcnt vmcnt(4)
    buffer_load_dwordx4 v4, s[8:11], s42 offen  lds
    s_add_u32 s43, s68, 67584
    s_mov_b32 m0, s43
    s_add_u32 s42, s70, 98304
    s_waitcnt vmcnt(4)
    buffer_load_dwordx4 v31, s[8:11], s42 offen  lds
    s_add_u32 s43, s68, 68608
    s_mov_b32 m0, s43
    s_add_u32 s42, s70, 147456
    s_waitcnt vmcnt(4)
    buffer_load_dwordx4 v31, s[8:11], s42 offen  lds
    s_waitcnt lgkmcnt(0)
    s_barrier
    ds_read_b64_tr_b16 v[144:145], v29 offset:32768
    ds_read_b64_tr_b16 v[146:147], v29 offset:33792
    ds_read_b64_tr_b16 v[148:149], v29 offset:40960
    ds_read_b64_tr_b16 v[150:151], v29 offset:41984
    ds_read_b64_tr_b16 v[152:153], v29 offset:49152
    ds_read_b64_tr_b16 v[154:155], v29 offset:50176
    ds_read_b64_tr_b16 v[156:157], v29 offset:57344
    ds_read_b64_tr_b16 v[158:159], v29 offset:58368
    s_waitcnt lgkmcnt(6)
    v_mfma_f32_16x16x32_bf16 v[160:163], v[144:147], v[128:131], 0
    s_waitcnt lgkmcnt(4)
    v_mfma_f32_16x16x32_bf16 v[160:163], v[148:151], v[132:135], v[160:163]
    s_waitcnt lgkmcnt(2)
    v_mfma_f32_16x16x32_bf16 v[160:163], v[152:155], v[136:139], v[160:163]
    s_waitcnt lgkmcnt(0)
    v_mfma_f32_16x16x32_bf16 v[160:163], v[156:159], v[140:143], v[160:163]
    s_add_u32 s42, s17, 1
    s_and_b32 s42, s42, 7
    s_lshl_b32 s42, s42, 12
    s_add_u32 s42, s42, s31
    s_add_u32 s42, s42, 0
    s_nop 2
    v_bfi_b32 v160, s33, v164, v160
    v_bfi_b32 v161, s33, v165, v161
    v_bfi_b32 v162, s33, v166, v162
    v_bfi_b32 v163, s33, v167, v163
    s_mov_b32 exec_lo, 0x00010001
    s_mov_b32 exec_hi, 0x00010001
    buffer_store_dwordx4 v[160:163], v26, s[12:15], s42 offen sc1
    s_mov_b64 exec, -1
    s_add_u32 s43, s68, 98304
    s_mov_b32 m0, s43
    s_add_u32 s42, s69, 0
    s_waitcnt vmcnt(4)
    buffer_load_dwordx4 v21, s[72:75], s42 offen  lds
    s_add_u32 s43, s68, 99328
    s_mov_b32 m0, s43
    s_add_u32 s42, s69, 2048
    s_waitcnt vmcnt(4)
    buffer_load_dwordx4 v22, s[72:75], s42 offen  lds
    s_add_u32 s43, s68, 100352
    s_mov_b32 m0, s43
    s_add_u32 s42, s69, 4096
    s_waitcnt vmcnt(4)
    buffer_load_dwordx4 v23, s[72:75], s42 offen  lds
    s_add_u32 s43, s68, 101376
    s_mov_b32 m0, s43
    s_add_u32 s42, s69, 6144
    s_waitcnt vmcnt(4)
    buffer_load_dwordx4 v24, s[72:75], s42 offen  lds
    s_waitcnt lgkmcnt(0)
    s_barrier
    ds_read_b64_tr_b16 v[144:145], v30 offset:0
    ds_read_b64_tr_b16 v[146:147], v30 offset:1024
    ds_read_b64_tr_b16 v[148:149], v30 offset:8192
    ds_read_b64_tr_b16 v[150:151], v30 offset:9216
    ds_read_b64_tr_b16 v[152:153], v30 offset:16384
    ds_read_b64_tr_b16 v[154:155], v30 offset:17408
    ds_read_b64_tr_b16 v[156:157], v30 offset:24576
    ds_read_b64_tr_b16 v[158:159], v30 offset:25600
    s_waitcnt lgkmcnt(6)
    v_mfma_f32_16x16x32_bf16 v[160:163], v[144:147], v[128:131], 0
    s_waitcnt lgkmcnt(4)
    v_mfma_f32_16x16x32_bf16 v[160:163], v[148:151], v[132:135], v[160:163]
    s_waitcnt lgkmcnt(2)
    v_mfma_f32_16x16x32_bf16 v[160:163], v[152:155], v[136:139], v[160:163]
    s_waitcnt lgkmcnt(0)
    v_mfma_f32_16x16x32_bf16 v[160:163], v[156:159], v[140:143], v[160:163]
    s_add_u32 s42, s17, 2
    s_and_b32 s42, s42, 7
    s_lshl_b32 s42, s42, 12
    s_add_u32 s42, s42, s31
    s_add_u32 s42, s42, 65536
    s_nop 2
    v_bfi_b32 v160, s33, v164, v160
    v_bfi_b32 v161, s33, v165, v161
    v_bfi_b32 v162, s33, v166, v162
    v_bfi_b32 v163, s33, v167, v163
    s_mov_b32 exec_lo, 0x00010001
    s_mov_b32 exec_hi, 0x00010001
    buffer_store_dwordx4 v[160:163], v26, s[12:15], s42 offen sc1
    s_mov_b64 exec, -1
    s_getreg_b32 s39, hwreg(HW_REG_XCC_ID)
    s_and_b32 s39, s39, 7
    s_lshl_b32 s38, s64, 1
    s_add_u32 s38, s38, s65
    s_lshl_b32 s38, s38, 7
    s_add_u32 s38, s38, 6537216
    s_lshl_b32 s42, s16, 28
    v_mov_b32 v28, s32
    v_mov_b32 v29, s39
    v_mov_b32 v30, s42
    s_mov_b64 exec, 1
    buffer_store_dwordx2 v[28:29], v30, s[12:15], s38 offen sc1
    s_mov_b64 exec, -1
    s_xor_b32 s38, s38, 128
    s_cmp_eq_u32 s65, s65
    s_cselect_b32 s8, s50, s52
    s_cselect_b32 s9, s51, s53
    s_mov_b32 s10, 7340032
    s_lshr_b32 s42, s8, 7
    s_sub_u32 s42, 3, s42
    s_add_u32 s42, s42, s34
    s_and_b32 s42, s42, 7
    s_cmp_eq_u32 s42, 7
    s_cselect_b32 s70, 0x1000000, 0
    s_mul_i32 s43, s34, 7
    s_add_u32 s42, s42, s43
    s_lshl_b32 s42, s42, 7
    s_lshr_b32 s43, s35, 1
    s_lshl_b32 s43, s43, 3
    s_add_u32 s43, s43, s16
    s_mul_i32 s43, s43, 35840
    s_add_u32 s42, s42, s43
    s_add_u32 s42, s42, s70
    s_mul_i32 s43, s65, 3670016
    s_add_u32 s42, s42, s43
    s_add_u32 s42, s42, 1662976
    v_mul_u32_u24 v30, 7168, v2
    s_mov_b64 exec, 31
    buffer_load_dword v252, v30, s[8:11], s42 offen
    s_mov_b64 exec, -1
    v_and_b32 v191, 3, v0
    v_lshlrev_b32 v191, 3, v191
    v_lshrrev_b32 v191, v191, s32
    v_lshlrev_b32 v212, 5, v2
    s_lshl_b32 s36, s65, 11
    s_add_u32 s37, s36, 6496256
    s_add_u32 s36, s36, 6504448
    s_mov_b32 s18, 196611
    s_mov_b32 s19, 0x00020002
    v_and_b32 v208, 1, v0
    v_lshlrev_b32 v208, 3, v208
    s_not_b32 s42, s32
    v_lshrrev_b32 v208, v208, s42
    v_lshrrev_b32 v209, 2, v208
    v_lshrrev_b32 v210, 4, v208
    v_lshrrev_b32 v211, 6, v208
    v_and_b32 v208, s18, v208
    v_and_b32 v209, s18, v209
    v_and_b32 v210, s18, v210
    v_and_b32 v211, s18, v211
    v_mov_b32 v216, s56
    v_mov_b32 v217, s57
    v_mov_b32 v218, s58
    v_mov_b32 v219, s59
    v_and_b32 v13, 1, v0
    v_lshlrev_b32 v13, 3, v13
    v_sub_u32 v13, v3, v13
    v_add_u32 v13, 131584, v13
    s_lshl_b32 s71, s65, 10
    s_add_u32 s71, s71, 5242880
    s_lshl_b32 s30, s65, 17
    s_lshl_b32 s31, s64, 6
    s_add_u32 s30, s30, s31
    s_add_u32 s30, s30, 4194304
    s_add_u32 s31, s30, 262144
    s_lshl_b32 s79, s64, 2
    s_and_b32 s42, s16, 3
    s_add_u32 s79, s79, s42
    s_lshl_b32 s79, s79, 10
    s_add_u32 s81, s79, 4718592
    s_add_u32 s82, s79, 4980736
    s_lshl_b32 s76, s65, 1
    s_lshr_b32 s42, s16, 2
    s_add_u32 s76, s76, s42
    s_lshl_b32 s76, s76, 8
    s_add_u32 s77, s76, s82
    s_add_u32 s76, s76, s81
    s_lshl_b32 s78, s34, 12
    s_add_u32 s78, s78, 4947968
    s_add_u32 s43, s68, 0
    s_mov_b32 m0, s43
    s_add_u32 s42, s69, 65536
    buffer_load_dwordx4 v21, s[72:75], s42 offen  lds
    s_add_u32 s43, s68, 1024
    s_mov_b32 m0, s43
    s_add_u32 s42, s69, 67584
    buffer_load_dwordx4 v22, s[72:75], s42 offen  lds
    s_add_u32 s43, s68, 2048
    s_mov_b32 m0, s43
    s_add_u32 s42, s69, 69632
    s_waitcnt vmcnt(8)
    buffer_load_dwordx4 v23, s[72:75], s42 offen  lds
    s_add_u32 s43, s68, 3072
    s_mov_b32 m0, s43
    s_add_u32 s42, s69, 71680
    s_waitcnt vmcnt(8)
    buffer_load_dwordx4 v24, s[72:75], s42 offen  lds
    s_add_u32 s43, s68, 32768
    s_mov_b32 m0, s43
    s_add_u32 s42, s67, 0
    s_waitcnt vmcnt(8)
    buffer_load_dwordx4 v5, s[44:47], s42 offen  lds
    s_add_u32 s43, s68, 33792
    s_mov_b32 m0, s43
    s_add_u32 s42, s67, 114688
    s_waitcnt vmcnt(8)
    buffer_load_dwordx4 v5, s[44:47], s42 offen  lds
    s_waitcnt lgkmcnt(0)
    s_barrier
    v_add_u32 v168, 65536, v8
    v_add_u32 v169, 65536, v9
    v_add_u32 v170, 65536, v10
    v_add_u32 v171, 65536, v11
    ds_read_b64_tr_b16 v[32:33], v168 offset:32768
    ds_read_b64_tr_b16 v[34:35], v168 offset:49152
    ds_read_b64_tr_b16 v[40:41], v169 offset:32768
    ds_read_b64_tr_b16 v[42:43], v169 offset:49152
    ds_read_b64_tr_b16 v[48:49], v170 offset:32768
    ds_read_b64_tr_b16 v[50:51], v170 offset:49152
    ds_read_b64_tr_b16 v[56:57], v171 offset:32768
    ds_read_b64_tr_b16 v[58:59], v171 offset:49152
    s_add_u32 s43, s68, 34816
    s_mov_b32 m0, s43
    s_add_u32 s42, s67, 28672
    s_waitcnt vmcnt(5)
    buffer_load_dwordx4 v5, s[44:47], s42 offen  lds
    s_add_u32 s43, s68, 35840
    s_mov_b32 m0, s43
    s_add_u32 s42, s67, 143360
    s_waitcnt vmcnt(5)
    buffer_load_dwordx4 v5, s[44:47], s42 offen  lds
    s_add_u32 s43, s68, 65536
    s_mov_b32 m0, s43
    s_add_u32 s42, s67, 1835008
    s_waitcnt vmcnt(5)
    buffer_load_dwordx4 v5, s[44:47], s42 offen  lds
    s_add_u32 s43, s68, 66560
    s_mov_b32 m0, s43
    s_add_u32 s42, s67, 1949696
    s_waitcnt vmcnt(5)
    buffer_load_dwordx4 v5, s[44:47], s42 offen  lds
    s_waitcnt lgkmcnt(0)
    s_barrier
    ds_read_b64_tr_b16 v[36:37], v8 offset:0
    ds_read_b64_tr_b16 v[38:39], v8 offset:16384
    ds_read_b64_tr_b16 v[44:45], v9 offset:0
    ds_read_b64_tr_b16 v[46:47], v9 offset:16384
    ds_read_b64_tr_b16 v[52:53], v10 offset:0
    ds_read_b64_tr_b16 v[54:55], v10 offset:16384
    ds_read_b64_tr_b16 v[60:61], v11 offset:0
    ds_read_b64_tr_b16 v[62:63], v11 offset:16384
    s_add_u32 s43, s68, 67584
    s_mov_b32 m0, s43
    s_add_u32 s42, s67, 1863680
    s_waitcnt vmcnt(5)
    buffer_load_dwordx4 v5, s[44:47], s42 offen  lds
    s_add_u32 s43, s68, 68608
    s_mov_b32 m0, s43
    s_add_u32 s42, s67, 1978368
    s_waitcnt vmcnt(5)
    buffer_load_dwordx4 v5, s[44:47], s42 offen  lds
    s_add_u32 s43, s68, 98304
    s_mov_b32 m0, s43
    s_add_u32 s42, s67, 0
    s_waitcnt vmcnt(5)
    buffer_load_dwordx4 v5, s[60:63], s42 offen  lds
    s_add_u32 s43, s68, 99328
    s_mov_b32 m0, s43
    s_add_u32 s42, s67, 114688
    s_waitcnt vmcnt(5)
    buffer_load_dwordx4 v5, s[60:63], s42 offen  lds
    s_waitcnt lgkmcnt(0)
    s_barrier
    ds_read_b64_tr_b16 v[64:65], v12 offset:32768
    ds_read_b64_tr_b16 v[66:67], v12 offset:34816
    ds_read_b64_tr_b16 v[68:69], v12 offset:36864
    ds_read_b64_tr_b16 v[70:71], v12 offset:38912
    ds_read_b64_tr_b16 v[72:73], v12 offset:40960
    ds_read_b64_tr_b16 v[74:75], v12 offset:43008
    ds_read_b64_tr_b16 v[76:77], v12 offset:45056
    ds_read_b64_tr_b16 v[78:79], v12 offset:47104
    s_add_u32 s43, s68, 100352
    s_mov_b32 m0, s43
    s_add_u32 s42, s67, 28672
    s_waitcnt vmcnt(5)
    buffer_load_dwordx4 v5, s[60:63], s42 offen  lds
    s_add_u32 s43, s68, 101376
    s_mov_b32 m0, s43
    s_add_u32 s42, s67, 143360
    s_waitcnt vmcnt(5)
    buffer_load_dwordx4 v5, s[60:63], s42 offen  lds
    v_lshlrev_b32 v30, 6, v2
    s_cmp_eq_u32 s16, 0
    s_cselect_b64 exec, -1, 0
    buffer_load_dword v31, v30, s[12:15], s81 offen sc1
    buffer_load_dwordx2 v[188:189], v14, s[12:15], s38 offen sc1
    buffer_load_dwordx4 v[192:195], v212, s[12:15], s36 offen offset:0
    buffer_load_dwordx4 v[196:199], v212, s[12:15], s36 offen offset:16
    buffer_load_dwordx4 v[200:203], v212, s[12:15], s37 offen offset:0
    buffer_load_dwordx4 v[204:207], v212, s[12:15], s37 offen offset:16
    s_mov_b64 exec, -1
    s_add_u32 s43, s68, 0
    s_mov_b32 m0, s43
    s_add_u32 s42, s67, 1835008
    s_waitcnt vmcnt(11)
    buffer_load_dwordx4 v5, s[60:63], s42 offen  lds
    s_add_u32 s43, s68, 1024
    s_mov_b32 m0, s43
    s_add_u32 s42, s67, 1949696
    s_waitcnt vmcnt(11)
    buffer_load_dwordx4 v5, s[60:63], s42 offen  lds
    s_waitcnt lgkmcnt(0)
    s_barrier
    ds_read_b64_tr_b16 v[80:81], v25 offset:0
    ds_read_b64_tr_b16 v[82:83], v25 offset:2048
    ds_read_b64_tr_b16 v[84:85], v25 offset:4096
    ds_read_b64_tr_b16 v[86:87], v25 offset:6144
    ds_read_b64_tr_b16 v[88:89], v25 offset:8192
    ds_read_b64_tr_b16 v[90:91], v25 offset:10240
    ds_read_b64_tr_b16 v[92:93], v25 offset:12288
    ds_read_b64_tr_b16 v[94:95], v25 offset:14336
    s_cmp_eq_u32 s16, 0
    s_cselect_b64 exec, -1, 0
    buffer_load_dword v15, v14, s[12:15], s78 offen offset:2048 sc1
    s_mov_b64 exec, -1
    s_add_u32 s43, s68, 2048
    s_mov_b32 m0, s43
    s_add_u32 s42, s67, 1863680
    s_waitcnt vmcnt(12)
    buffer_load_dwordx4 v5, s[60:63], s42 offen  lds
    s_add_u32 s43, s68, 3072
    s_mov_b32 m0, s43
    s_add_u32 s42, s67, 1978368
    s_waitcnt vmcnt(12)
    buffer_load_dwordx4 v5, s[60:63], s42 offen  lds
    s_waitcnt vmcnt(11)
    s_waitcnt lgkmcnt(0)
    s_barrier
    ds_read_b64_tr_b16 v[96:97], v25 offset:32768
    ds_read_b64_tr_b16 v[98:99], v25 offset:34816
    ds_read_b64_tr_b16 v[100:101], v25 offset:36864
    ds_read_b64_tr_b16 v[102:103], v25 offset:38912
    ds_read_b64_tr_b16 v[104:105], v25 offset:40960
    ds_read_b64_tr_b16 v[106:107], v25 offset:43008
    ds_read_b64_tr_b16 v[108:109], v25 offset:45056
    ds_read_b64_tr_b16 v[110:111], v25 offset:47104
    v_mov_b32 v160, 0
    v_mov_b32 v161, 0
    v_mov_b32 v162, 0
    v_mov_b32 v163, 0
    v_mov_b32 v164, 0
    v_mov_b32 v165, 0
    v_mov_b32 v166, 0
    v_mov_b32 v167, 0
    v_mov_b32 v168, 0
    v_mov_b32 v169, 0
    v_mov_b32 v170, 0
    v_mov_b32 v171, 0
    v_mov_b32 v190, 134656
    s_cmp_lg_u32 s16, 0
    s_cbranch_scc1 m_nk
    s_mov_b32 s83, 0
    s_waitcnt vmcnt(5)
    v_xor_b32 v188, s32, v188
    v_xor_b32 v189, s39, v189
    v_or_b32 v188, v188, v189
    ds_write_b32 v190, v188
m_pm:
    v_xor_b32 v192, s56, v192
    v_xor_b32 v193, s57, v193
    v_xor_b32 v194, s58, v194
    v_xor_b32 v195, s59, v195
    v_xor_b32 v196, s56, v196
    v_xor_b32 v197, s57, v197
    v_xor_b32 v198, s58, v198
    v_xor_b32 v199, s59, v199
    v_xor_b32 v200, s56, v200
    v_xor_b32 v201, s57, v201
    v_xor_b32 v202, s58, v202
    v_xor_b32 v203, s59, v203
    v_xor_b32 v204, s56, v204
    v_xor_b32 v205, s57, v205
    v_xor_b32 v206, s58, v206
    v_xor_b32 v207, s59, v207
    v_or3_b32 v30, v192, v193, v194
    v_or3_b32 v30, v30, v195, v196
    v_or3_b32 v30, v30, v197, v198
    v_or3_b32 v30, v30, v199, v200
    v_or3_b32 v30, v30, v201, v202
    v_or3_b32 v30, v30, v203, v204
    v_or3_b32 v30, v30, v205, v206
    v_or_b32 v30, v30, v207
    v_and_b32 v30, 0xff, v30
    v_cmp_ne_u32 vcc, 0, v30
    s_cbranch_vccz m_pmx
    s_sleep 4
    buffer_load_dwordx4 v[192:195], v212, s[12:15], s36 offen offset:0 sc1
    buffer_load_dwordx4 v[196:199], v212, s[12:15], s36 offen offset:16 sc1
    buffer_load_dwordx4 v[200:203], v212, s[12:15], s37 offen offset:0 sc1
    buffer_load_dwordx4 v[204:207], v212, s[12:15], s37 offen offset:16 sc1
    s_waitcnt vmcnt(0)
    s_add_u32 s83, s83, 1
    s_cmp_lt_u32 s83, 0x40000
    s_cbranch_scc1 m_pm
m_pmx:
    s_mov_b32 s83, 0
    s_waitcnt vmcnt(2)
m_go:
    v_cmp_ne_u32 vcc, s32, v15
    s_cbranch_vccz m_gox
    s_sleep 3
    buffer_load_dword v15, v14, s[12:15], s78 offen offset:2048 sc1
    s_waitcnt vmcnt(0)
    s_add_u32 s83, s83, 1
    s_cmp_lt_u32 s83, 0x40000
    s_cbranch_scc1 m_go
m_gox:
    s_mov_b32 s83, 0
    buffer_load_dwordx4 v[136:139], v3, s[12:15], s78 offen offset:0 sc1
    buffer_load_dwordx4 v[140:143], v3, s[12:15], s78 offen offset:1024 sc1
    s_sleep 4
m_pk:
    buffer_load_dwordx4 v[144:147], v3, s[12:15], s78 offen offset:0 sc1
    buffer_load_dwordx4 v[148:151], v3, s[12:15], s78 offen offset:1024 sc1
    s_add_u32 s83, s83, 1
    s_cmp_lt_u32 s83, 0x40000
    s_cselect_b64 s[20:21], -1, 0
    s_waitcnt vmcnt(2)
    v_max_u32 v28, v136, v140
    v_xor_b32 v31, s32, v138
    v_bitop3_b32 v31, v31, v142, s32 bitop3:0xf6
    v_max_u32_dpp v30, v28, v28 row_ror:8 row_mask:0xf bank_mask:0xf
    v_cmp_ne_u32 vcc, 0, v31
    v_min_u32 v29, v136, v140
    v_max_u32_dpp v30, v30, v30 row_ror:4 row_mask:0xf bank_mask:0xf
    v_max3_u32 v29, v29, v137, v141
    s_and_b64 vcc, vcc, s[20:21]
    v_max_u32_dpp v30, v30, v30 row_ror:2 row_mask:0xf bank_mask:0xf
    s_cbranch_scc0 m_pkx
    buffer_load_dwordx4 v[136:139], v3, s[12:15], s78 offen offset:0 sc1
    buffer_load_dwordx4 v[140:143], v3, s[12:15], s78 offen offset:1024 sc1
    s_waitcnt vmcnt(2)
    v_max_u32 v28, v144, v148
    v_xor_b32 v31, s32, v146
    v_bitop3_b32 v31, v31, v150, s32 bitop3:0xf6
    v_max_u32_dpp v30, v28, v28 row_ror:8 row_mask:0xf bank_mask:0xf
    v_cmp_ne_u32 vcc, 0, v31
    v_min_u32 v29, v144, v148
    v_max_u32_dpp v30, v30, v30 row_ror:4 row_mask:0xf bank_mask:0xf
    v_max3_u32 v29, v29, v145, v149
    s_and_b64 vcc, vcc, s[20:21]
    v_max_u32_dpp v30, v30, v30 row_ror:2 row_mask:0xf bank_mask:0xf
    s_cbranch_scc0 m_pkx
    s_branch m_pk
m_pkx:
    s_nop 0
    v_max_u32_dpp v30, v30, v30 row_ror:1 row_mask:0xf bank_mask:0xf
    s_nop 1
    v_max_u32_dpp v30, v30, v30 row_bcast:15 row_mask:0xa bank_mask:0xf
    s_nop 1
    v_max_u32_dpp v30, v30, v30 row_bcast:31 row_mask:0xc bank_mask:0xf
    s_nop 0
    v_readlane_b32 s40, v30, 63
    s_and_b32 s42, s40, 0xff
    s_lshl_b32 s42, s42, 11
    v_cmp_eq_u32 vcc, s40, v28
    s_add_u32 s42, s42, s71
    buffer_load_dwordx4 v[176:179], v3, s[12:15], s42 offen sc1
    v_cndmask_b32 v30, v28, v29, vcc
    s_nop 1
    v_max_u32_dpp v30, v30, v30 row_ror:8 row_mask:0xf bank_mask:0xf
    s_nop 1
    v_max_u32_dpp v30, v30, v30 row_ror:4 row_mask:0xf bank_mask:0xf
    s_nop 1
    v_max_u32_dpp v30, v30, v30 row_ror:2 row_mask:0xf bank_mask:0xf
    s_nop 1
    v_max_u32_dpp v30, v30, v30 row_ror:1 row_mask:0xf bank_mask:0xf
    s_nop 1
    v_max_u32_dpp v30, v30, v30 row_bcast:15 row_mask:0xa bank_mask:0xf
    s_nop 1
    v_max_u32_dpp v30, v30, v30 row_bcast:31 row_mask:0xc bank_mask:0xf
    s_nop 0
    v_readlane_b32 s41, v30, 63
    s_and_b32 s41, s41, 0xff
    s_lshl_b32 s43, s41, 11
    s_add_u32 s43, s43, s71
    buffer_load_dwordx4 v[180:183], v3, s[12:15], s43 offen sc1
    s_and_b32 s40, s40, 0xff
    s_mov_b32 s83, 0
    s_lshl_b32 s41, s41, 8
    s_or_b32 s40, s40, s41
    v_mov_b32 v28, s40
    v_mov_b32 v29, s32
    s_cmp_eq_u32 s35, 0
    s_cselect_b64 exec, 1, 0
    buffer_store_dwordx2 v[28:29], v14, s[12:15], s78 offen offset:2304 sc1
    s_mov_b64 exec, -1
    s_barrier
    ds_read_b64_tr_b16 v[112:113], v12 offset:0
    ds_read_b64_tr_b16 v[114:115], v12 offset:2048
    ds_read_b64_tr_b16 v[116:117], v12 offset:4096
    ds_read_b64_tr_b16 v[118:119], v12 offset:6144
    ds_read_b64_tr_b16 v[120:121], v12 offset:8192
    ds_read_b64_tr_b16 v[122:123], v12 offset:10240
    ds_read_b64_tr_b16 v[124:125], v12 offset:12288
    ds_read_b64_tr_b16 v[126:127], v12 offset:14336
m_ph:
    s_waitcnt vmcnt(2)
    v_xor_b32 v176, v176, v208
    v_xor_b32 v177, v177, v209
    v_xor_b32 v178, v178, v210
    v_xor_b32 v179, v179, v211
    v_fma_mix_f32 v220, v176, v192, v200 op_sel:[0,0,0] op_sel_hi:[1,0,0]
    v_fma_mix_f32 v221, v176, v193, v201 op_sel:[1,0,0] op_sel_hi:[1,0,0]
    v_fma_mix_f32 v222, v177, v194, v202 op_sel:[0,0,0] op_sel_hi:[1,0,0]
    v_fma_mix_f32 v223, v177, v195, v203 op_sel:[1,0,0] op_sel_hi:[1,0,0]
    v_fma_mix_f32 v224, v178, v196, v204 op_sel:[0,0,0] op_sel_hi:[1,0,0]
    v_fma_mix_f32 v225, v178, v197, v205 op_sel:[1,0,0] op_sel_hi:[1,0,0]
    v_fma_mix_f32 v226, v179, v198, v206 op_sel:[0,0,0] op_sel_hi:[1,0,0]
    v_fma_mix_f32 v227, v179, v199, v207 op_sel:[1,0,0] op_sel_hi:[1,0,0]
    v_cvt_pk_bf16_f32 v236, v220, v221
    v_cvt_pk_bf16_f32 v238, v222, v223
    v_cvt_pk_bf16_f32 v237, v224, v225
    v_cvt_pk_bf16_f32 v239, v226, v227
    ds_write2_b64 v13, v[236:237], v[238:239] offset0:0 offset1:2
    v_xor_b32 v30, s19, v176
    v_bitop3_b32 v30, v30, v177, s19 bitop3:0xf6
    v_bitop3_b32 v30, v30, v178, s19 bitop3:0xf6
    v_bitop3_b32 v30, v30, v179, s19 bitop3:0xf6
    s_waitcnt vmcnt(1)
    v_xor_b32 v180, v180, v208
    v_xor_b32 v181, v181, v209
    v_xor_b32 v182, v182, v210
    v_xor_b32 v183, v183, v211
    v_fma_mix_f32 v228, v180, v192, v200 op_sel:[0,0,0] op_sel_hi:[1,0,0]
    v_fma_mix_f32 v229, v180, v193, v201 op_sel:[1,0,0] op_sel_hi:[1,0,0]
    v_fma_mix_f32 v230, v181, v194, v202 op_sel:[0,0,0] op_sel_hi:[1,0,0]
    v_fma_mix_f32 v231, v181, v195, v203 op_sel:[1,0,0] op_sel_hi:[1,0,0]
    v_fma_mix_f32 v232, v182, v196, v204 op_sel:[0,0,0] op_sel_hi:[1,0,0]
    v_fma_mix_f32 v233, v182, v197, v205 op_sel:[1,0,0] op_sel_hi:[1,0,0]
    v_fma_mix_f32 v234, v183, v198, v206 op_sel:[0,0,0] op_sel_hi:[1,0,0]
    v_fma_mix_f32 v235, v183, v199, v207 op_sel:[1,0,0] op_sel_hi:[1,0,0]
    v_cvt_pk_bf16_f32 v240, v228, v229
    v_cvt_pk_bf16_f32 v242, v230, v231
    v_cvt_pk_bf16_f32 v241, v232, v233
    v_cvt_pk_bf16_f32 v243, v234, v235
    ds_write2_b64 v13, v[240:241], v[242:243] offset0:128 offset1:130
    v_bitop3_b32 v30, v30, v180, s19 bitop3:0xf6
    v_bitop3_b32 v30, v30, v181, s19 bitop3:0xf6
    v_bitop3_b32 v30, v30, v182, s19 bitop3:0xf6
    v_bitop3_b32 v30, v30, v183, s19 bitop3:0xf6
    v_and_b32 v30, s18, v30
    v_cmp_ne_u32 vcc, 0, v30
    s_cbranch_vccnz m_phb
m_phx:
m_nk2:
    s_waitcnt lgkmcnt(0)
    s_barrier
    ds_read_b32 v188, v190
    ds_read_b128 v[128:131], v17 offset:0
    ds_read_b128 v[132:135], v17 offset:128
    ds_read_b128 v[136:139], v17 offset:512
    ds_read_b128 v[140:143], v17 offset:640
    s_waitcnt lgkmcnt(3)
    v_smfmac_f32_16x16x64_bf16 v[160:163], v[128:131], v[64:71], v213
    v_smfmac_f32_16x16x64_bf16 v[164:167], v[128:131], v[96:103], v213
    s_waitcnt lgkmcnt(2)
    v_smfmac_f32_16x16x64_bf16 v[160:163], v[132:135], v[72:79], v213
    v_smfmac_f32_16x16x64_bf16 v[164:167], v[132:135], v[104:111], v213
    s_waitcnt lgkmcnt(1)
    v_smfmac_f32_16x16x64_bf16 v[160:163], v[136:139], v[80:87], v213
    v_smfmac_f32_16x16x64_bf16 v[164:167], v[136:139], v[112:119], v213
    s_waitcnt lgkmcnt(0)
    v_smfmac_f32_16x16x64_bf16 v[160:163], v[140:143], v[88:95], v213
    v_smfmac_f32_16x16x64_bf16 v[164:167], v[140:143], v[120:127], v213
    v_readfirstlane_b32 s70, v188
    s_mov_b32 s83, 0
    s_cmp_eq_u32 s70, 0
    s_cselect_b32 s82, s81, s82
    s_cselect_b64 s[20:21], 0, 0xffff
    s_nop 1
    v_pk_add_f32 v[160:161], v[160:161], v[162:163]
    v_pk_add_f32 v[164:165], v[164:165], v[166:167]
    v_bfi_b32 v184, s33, v216, v160
    v_bfi_b32 v185, s33, v217, v161
    v_bfi_b32 v186, s33, v218, v164
    v_bfi_b32 v187, s33, v219, v165
    s_mov_b64 exec, 0xffff
    buffer_store_dwordx4 v[184:187], v3, s[12:15], s76 offen
    s_mov_b64 exec, s[20:21]
    buffer_store_dwordx4 v[184:187], v3, s[12:15], s77 offen sc1
    s_mov_b64 exec, -1
    v_mov_b32 v144, 0
    v_mov_b32 v145, 0
    v_mov_b32 v146, 0
    v_mov_b32 v147, 0
    v_mov_b32 v148, 0
    v_mov_b32 v149, 0
    v_mov_b32 v150, 0
    v_mov_b32 v151, 0
    v_mov_b32 v152, 0
    v_mov_b32 v153, 0
    v_mov_b32 v154, 0
    v_mov_b32 v155, 0
    v_mov_b32 v156, 0
    v_mov_b32 v157, 0
    v_mov_b32 v158, 0
    v_mov_b32 v159, 0
    s_cmp_ge_u32 s16, 4
    s_cbranch_scc1 m_na
    s_sleep 1
m_px:
    buffer_load_dwordx4 v[24:27], v3, s[12:15], s81 offen sc1
    s_mov_b32 s42, s81
    s_mov_b32 s81, s82
    s_mov_b32 s82, s42
    s_add_u32 s83, s83, 1
    s_cmp_lt_u32 s83, 0x40000
    s_cselect_b64 s[20:21], -1, 0
    s_waitcnt vmcnt(0)
    v_xor_b32 v24, s56, v24
    v_xor_b32 v25, s57, v25
    v_xor_b32 v26, s58, v26
    v_xor_b32 v27, s59, v27
    v_or3_b32 v9, v24, v25, v26
    v_bitop3_b32 v9, v9, v27, s33 bitop3:0xa8
    v_permlane32_swap_b32 v24, v26
    v_cmp_ne_u32 vcc, 0, v9
    v_permlane32_swap_b32 v25, v27
    s_and_b64 vcc, vcc, s[20:21]
    v_pk_add_f32 v[24:25], v[24:25], v[26:27]
    s_cbranch_scc1 m_px
    s_nop 0
    v_permlane16_swap_b32 v24, v25
    v_add_f32 v24, v24, v25
    v_cvt_pk_bf16_f32 v24, v24, v24
    v_lshlrev_b32 v24, 16, v24
    v_mul_f32 v25, 0xbfb8aa3b, v24
    v_exp_f32 v25, v25
    v_mov_b32 v26, v24
    v_add_f32 v25, 1.0, v25
    v_rcp_f32 v25, v25
    v_mov_b32 v27, v24
    v_mul_f32 v25, v24, v25
    s_nop 0
    v_permlane32_swap_b32 v26, v27
    v_cvt_pk_bf16_f32 v25, v25, v25
    v_lshlrev_b32 v25, 16, v25
    v_mul_f32 v25, v25, v27
    v_cvt_pk_bf16_f32 v25, v25, v25
    ds_write_b16 v18, v25
m_na:
    s_waitcnt lgkmcnt(0)
    s_barrier
    s_mov_b32 exec_lo, 0xf000f
    s_mov_b32 exec_hi, 0xf000f
    ds_read_b128 v[144:147], v19
    s_mov_b32 exec_lo, 0xf000f0
    s_mov_b32 exec_hi, 0xf000f0
    ds_read_b128 v[148:151], v19
    s_mov_b32 exec_lo, 0xf000f00
    s_mov_b32 exec_hi, 0xf000f00
    ds_read_b128 v[152:155], v19
    s_mov_b32 exec_lo, 0xf000f000
    s_mov_b32 exec_hi, 0xf000f000
    ds_read_b128 v[156:159], v19
    s_mov_b64 exec, -1
    s_waitcnt lgkmcnt(3)
    v_smfmac_f32_16x16x64_bf16 v[168:171], v[144:147], v[32:39], v213
    s_waitcnt lgkmcnt(2)
    v_smfmac_f32_16x16x64_bf16 v[168:171], v[148:151], v[40:47], v213
    s_waitcnt lgkmcnt(1)
    v_smfmac_f32_16x16x64_bf16 v[168:171], v[152:155], v[48:55], v213
    s_waitcnt lgkmcnt(0)
    v_smfmac_f32_16x16x64_bf16 v[168:171], v[156:159], v[56:63], v213
    s_nop 7
    v_pk_add_f32 v[24:25], v[168:169], v[170:171]
    v_bfi_b32 v24, s33, v191, v24
    v_bfi_b32 v25, s33, v191, v25
    buffer_store_dword v24, v20, s[12:15], s30 offen sc1
    buffer_store_dword v25, v20, s[12:15], s31 offen sc1
    s_endpgm
m_nk:
    s_waitcnt vmcnt(0)
    s_barrier
    ds_read_b64_tr_b16 v[112:113], v12 offset:0
    ds_read_b64_tr_b16 v[114:115], v12 offset:2048
    ds_read_b64_tr_b16 v[116:117], v12 offset:4096
    ds_read_b64_tr_b16 v[118:119], v12 offset:6144
    ds_read_b64_tr_b16 v[120:121], v12 offset:8192
    ds_read_b64_tr_b16 v[122:123], v12 offset:10240
    ds_read_b64_tr_b16 v[124:125], v12 offset:12288
    ds_read_b64_tr_b16 v[126:127], v12 offset:14336
    s_branch m_nk2
m_phb:
    s_add_u32 s83, s83, 1
    s_cmp_ge_u32 s83, 0x40000
    s_cbranch_scc1 m_phx
    buffer_load_dwordx4 v[176:179], v3, s[12:15], s42 offen sc1
    buffer_load_dwordx4 v[180:183], v3, s[12:15], s43 offen sc1
    s_waitcnt vmcnt(0)
    s_branch m_ph
x_start:
    s_lshl_b32 s37, s34, 1
    s_add_u32 s37, s37, s65
    s_lshl_b32 s37, s37, 3
    s_add_u32 s37, s37, s16
    s_lshl_b32 s42, s37, 8
    s_add_u32 s42, s42, 4947968
    s_mov_b64 exec, 0xffff
    buffer_store_dwordx4 v[104:107], v3, s[12:15], s42 offen sc1
    s_mov_b64 exec, -1
    s_lshl_b32 s36, s37, 12
    s_add_u32 s36, s36, 4194304
    s_lshl_b32 s76, s16, 3
    s_add_u32 s76, s76, s34
    s_lshl_b32 s77, s76, 10
    s_add_u32 s77, s77, 6356992
    s_lshl_b32 s79, s76, 7
    s_add_u32 s79, s79, 6488064
    s_lshr_b32 s71, s76, 5
    s_cmp_eq_u32 s71, 0
    s_cselect_b32 s80, 1.0, 0
    s_lshl_b32 s78, s34, 12
    s_add_u32 s78, s78, 4947968
    s_mov_b32 s72, s48
    s_mov_b32 s73, s49
    s_mov_b32 s74, 2048
    s_mov_b32 s75, 0x00020000
    v_and_b32 v10, 7, v0
    v_lshl_add_u32 v10, v10, 2, v7
    v_lshlrev_b32 v10, 1, v10
    s_lshl_b32 s42, s76, 6
    buffer_load_ushort v10, v10, s[72:75], s42 offen
    s_mul_i32 s70, s41, -4096
    s_add_u32 s70, s70, 8192
    s_add_u32 s70, s70, s18
    s_add_u32 s42, s17, 1
    s_and_b32 s42, s42, 7
    s_lshl_b32 s42, s42, 8
    s_add_u32 s70, s70, s42
    s_add_u32 s43, s68, 32768
    s_mov_b32 m0, s43
    s_add_u32 s42, s70, 0
    s_waitcnt vmcnt(7)
    buffer_load_dwordx4 v4, s[8:11], s42 offen  lds
    s_add_u32 s43, s68, 33792
    s_mov_b32 m0, s43
    s_add_u32 s42, s70, 49152
    s_waitcnt vmcnt(7)
    buffer_load_dwordx4 v4, s[8:11], s42 offen  lds
    s_add_u32 s43, s68, 34816
    s_mov_b32 m0, s43
    s_add_u32 s42, s70, 98304
    s_waitcnt vmcnt(7)
    buffer_load_dwordx4 v31, s[8:11], s42 offen  lds
    s_add_u32 s43, s68, 35840
    s_mov_b32 m0, s43
    s_add_u32 s42, s70, 147456
    s_waitcnt vmcnt(7)
    buffer_load_dwordx4 v31, s[8:11], s42 offen  lds
    s_waitcnt vmcnt(7)
    v_lshlrev_b32 v110, 16, v110
    v_mul_f32 v111, 0xbfb8aa3b, v110
    v_exp_f32 v111, v111
    s_nop 0
    v_add_f32 v111, 1.0, v111
    v_rcp_f32 v111, v111
    s_nop 0
    v_mul_f32 v110, v110, v111
    v_cvt_pk_bf16_f32 v110, v110, v110
    ds_write_b16 v109, v110
    s_waitcnt lgkmcnt(0)
    s_barrier
    ds_read_b128 v[128:131], v27 offset:0
    ds_read_b128 v[132:135], v27 offset:64
    ds_read_b128 v[136:139], v27 offset:128
    ds_read_b128 v[140:143], v27 offset:192
    ds_read_b64_tr_b16 v[144:145], v29 offset:0
    ds_read_b64_tr_b16 v[146:147], v29 offset:1024
    ds_read_b64_tr_b16 v[148:149], v29 offset:8192
    ds_read_b64_tr_b16 v[150:151], v29 offset:9216
    ds_read_b64_tr_b16 v[152:153], v29 offset:16384
    ds_read_b64_tr_b16 v[154:155], v29 offset:17408
    ds_read_b64_tr_b16 v[156:157], v29 offset:24576
    ds_read_b64_tr_b16 v[158:159], v29 offset:25600
    s_mul_i32 s32, s101, 0x9e3779b1
    s_or_b32 s32, s32, 0x101
    s_and_b32 s32, s32, 0xfffefbfb
    s_and_b32 s56, s32, 0xff
    s_bfe_u32 s57, s32, 0x80008
    s_bfe_u32 s58, s32, 0x80010
    s_lshr_b32 s59, s32, 24
    v_mov_b32 v164, s56
    v_mov_b32 v165, s57
    v_mov_b32 v166, s58
    v_mov_b32 v167, s59
    s_waitcnt lgkmcnt(6)
    v_mfma_f32_16x16x32_bf16 v[160:163], v[144:147], v[128:131], 0
    s_waitcnt lgkmcnt(4)
    v_mfma_f32_16x16x32_bf16 v[160:163], v[148:151], v[132:135], v[160:163]
    s_waitcnt lgkmcnt(2)
    v_mfma_f32_16x16x32_bf16 v[160:163], v[152:155], v[136:139], v[160:163]
    s_waitcnt lgkmcnt(0)
    v_mfma_f32_16x16x32_bf16 v[160:163], v[156:159], v[140:143], v[160:163]
    s_nop 7
    v_bfi_b32 v160, s33, v164, v160
    v_bfi_b32 v161, s33, v165, v161
    v_bfi_b32 v162, s33, v166, v162
    v_bfi_b32 v163, s33, v167, v163
    s_mov_b32 exec_lo, 0x00010001
    s_mov_b32 exec_hi, 0x00010001
    buffer_store_dwordx4 v[160:163], v28, s[12:15], s30 offen sc1
    s_mov_b64 exec, -1
    s_mul_i32 s70, s41, 4096
    s_add_u32 s70, s70, 6144
    s_add_u32 s70, s70, s18
    s_add_u32 s42, s17, 2
    s_and_b32 s42, s42, 7
    s_lshl_b32 s42, s42, 8
    s_add_u32 s70, s70, s42
    s_add_u32 s43, s68, 65536
    s_mov_b32 m0, s43
    s_add_u32 s42, s70, 0
    s_waitcnt vmcnt(4)
    buffer_load_dwordx4 v4, s[8:11], s42 offen  lds
    s_add_u32 s43, s68, 66560
    s_mov_b32 m0, s43
    s_add_u32 s42, s70, 49152
    s_waitcnt vmcnt(4)
    buffer_load_dwordx4 v4, s[8:11], s42 offen  lds
    s_add_u32 s43, s68, 67584
    s_mov_b32 m0, s43
    s_add_u32 s42, s70, 98304
    s_waitcnt vmcnt(4)
    buffer_load_dwordx4 v31, s[8:11], s42 offen  lds
    s_add_u32 s43, s68, 68608
    s_mov_b32 m0, s43
    s_add_u32 s42, s70, 147456
    s_waitcnt vmcnt(4)
    buffer_load_dwordx4 v31, s[8:11], s42 offen  lds
    s_waitcnt lgkmcnt(0)
    s_barrier
    ds_read_b64_tr_b16 v[144:145], v29 offset:32768
    ds_read_b64_tr_b16 v[146:147], v29 offset:33792
    ds_read_b64_tr_b16 v[148:149], v29 offset:40960
    ds_read_b64_tr_b16 v[150:151], v29 offset:41984
    ds_read_b64_tr_b16 v[152:153], v29 offset:49152
    ds_read_b64_tr_b16 v[154:155], v29 offset:50176
    ds_read_b64_tr_b16 v[156:157], v29 offset:57344
    ds_read_b64_tr_b16 v[158:159], v29 offset:58368
    s_waitcnt lgkmcnt(6)
    v_mfma_f32_16x16x32_bf16 v[160:163], v[144:147], v[128:131], 0
    s_waitcnt lgkmcnt(4)
    v_mfma_f32_16x16x32_bf16 v[160:163], v[148:151], v[132:135], v[160:163]
    s_waitcnt lgkmcnt(2)
    v_mfma_f32_16x16x32_bf16 v[160:163], v[152:155], v[136:139], v[160:163]
    s_waitcnt lgkmcnt(0)
    v_mfma_f32_16x16x32_bf16 v[160:163], v[156:159], v[140:143], v[160:163]
    s_add_u32 s42, s17, 1
    s_and_b32 s42, s42, 7
    s_lshl_b32 s42, s42, 12
    s_add_u32 s42, s42, s31
    s_add_u32 s42, s42, 0
    s_nop 2
    v_bfi_b32 v160, s33, v164, v160
    v_bfi_b32 v161, s33, v165, v161
    v_bfi_b32 v162, s33, v166, v162
    v_bfi_b32 v163, s33, v167, v163
    s_mov_b32 exec_lo, 0x00010001
    s_mov_b32 exec_hi, 0x00010001
    buffer_store_dwordx4 v[160:163], v26, s[12:15], s42 offen sc1
    s_mov_b64 exec, -1
    s_waitcnt vmcnt(1)
    s_waitcnt lgkmcnt(0)
    s_barrier
    ds_read_b64_tr_b16 v[144:145], v30 offset:0
    ds_read_b64_tr_b16 v[146:147], v30 offset:1024
    ds_read_b64_tr_b16 v[148:149], v30 offset:8192
    ds_read_b64_tr_b16 v[150:151], v30 offset:9216
    ds_read_b64_tr_b16 v[152:153], v30 offset:16384
    ds_read_b64_tr_b16 v[154:155], v30 offset:17408
    ds_read_b64_tr_b16 v[156:157], v30 offset:24576
    ds_read_b64_tr_b16 v[158:159], v30 offset:25600
    s_waitcnt lgkmcnt(6)
    v_mfma_f32_16x16x32_bf16 v[160:163], v[144:147], v[128:131], 0
    s_waitcnt lgkmcnt(4)
    v_mfma_f32_16x16x32_bf16 v[160:163], v[148:151], v[132:135], v[160:163]
    s_waitcnt lgkmcnt(2)
    v_mfma_f32_16x16x32_bf16 v[160:163], v[152:155], v[136:139], v[160:163]
    s_waitcnt lgkmcnt(0)
    v_mfma_f32_16x16x32_bf16 v[160:163], v[156:159], v[140:143], v[160:163]
    s_add_u32 s42, s17, 2
    s_and_b32 s42, s42, 7
    s_lshl_b32 s42, s42, 12
    s_add_u32 s42, s42, s31
    s_add_u32 s42, s42, 65536
    s_nop 2
    v_bfi_b32 v160, s33, v164, v160
    v_bfi_b32 v161, s33, v165, v161
    v_bfi_b32 v162, s33, v166, v162
    v_bfi_b32 v163, s33, v167, v163
    s_mov_b32 exec_lo, 0x00010001
    s_mov_b32 exec_hi, 0x00010001
    buffer_store_dwordx4 v[160:163], v26, s[12:15], s42 offen sc1
    s_mov_b64 exec, -1
    s_cmp_eq_u32 s65, 1
    s_cbranch_scc1 x_na
    s_cmp_eq_u32 s80, 0
    s_cselect_b32 s42, 0x42800000, 0
    v_lshl_or_b32 v10, v10, 16, s42
    v_lshlrev_b32 v8, 3, v7
    v_lshrrev_b32 v8, v8, s32
    s_mov_b32 s83, 0
x_pa:
    buffer_load_dwordx4 v[16:19], v3, s[12:15], s77 offen sc1
    s_waitcnt vmcnt(0)
    v_xor_b32 v16, s56, v16
    v_xor_b32 v17, s57, v17
    v_xor_b32 v18, s58, v18
    v_xor_b32 v19, s59, v19
    v_or3_b32 v9, v16, v17, v18
    v_or_b32 v9, v9, v19
    v_and_b32 v9, 0xff, v9
    v_cmp_ne_u32 vcc, 0, v9
    s_cbranch_vccz x_pax
    s_sleep 4
    s_add_u32 s83, s83, 1
    s_cmp_lt_u32 s83, 0x40000
    s_cbranch_scc1 x_pa
x_pax:
    v_permlane32_swap_b32 v16, v18
    v_permlane32_swap_b32 v17, v19
    v_pk_add_f32 v[16:17], v[16:17], v[18:19]
    s_nop 1
    v_permlane16_swap_b32 v16, v17
    v_add_f32 v16, v16, v17
    s_nop 1
    v_add_f32_dpp v16, v16, v16 row_ror:8 row_mask:0xf bank_mask:0xf
    v_cvt_pk_bf16_f32 v16, v16, v16
    v_lshlrev_b32 v16, 16, v16
    v_add_f32 v16, s80, v16
    v_cvt_pk_bf16_f32 v16, v16, v16
    v_lshlrev_b32 v16, 16, v16
    v_mul_f32 v20, v16, v10
    v_bfi_b32 v20, s33, v8, v20
    v_mov_b32 v21, v20
    s_nop 1
    v_permlane16_swap_b32 v20, v21
    v_mov_b32 v22, v20
    v_mov_b32 v23, v21
    s_nop 0
    v_permlane32_swap_b32 v20, v22
    v_permlane32_swap_b32 v21, v23
    s_mov_b64 exec, 0xff
    buffer_store_dwordx4 v[20:23], v3, s[12:15], s79 offen sc1
    s_mov_b64 exec, -1
    s_cmp_eq_u32 s80, 0
    s_cbranch_scc1 x_nc
    s_add_u32 s42, s79, 16384
    v_bfi_b32 v16, s33, v8, v16
    v_mov_b32 v17, v16
    s_nop 1
    v_permlane16_swap_b32 v16, v17
    v_mov_b32 v18, v16
    v_mov_b32 v19, v17
    s_nop 0
    v_permlane32_swap_b32 v16, v18
    v_permlane32_swap_b32 v17, v19
    s_mov_b64 exec, 0xff
    buffer_store_dwordx4 v[16:19], v3, s[12:15], s42 offen sc1
    s_mov_b64 exec, -1
x_nc:
    s_add_u32 s77, s77, 65536
    s_add_u32 s79, s79, 8192
    s_mov_b32 s80, 0
    s_sleep 12
    v_lshlrev_b32 v8, 3, v7
    v_lshrrev_b32 v8, v8, s32
    s_mov_b32 s83, 0
x_pb:
    buffer_load_dwordx4 v[16:19], v3, s[12:15], s77 offen sc1
    s_waitcnt vmcnt(0)
    v_xor_b32 v16, s56, v16
    v_xor_b32 v17, s57, v17
    v_xor_b32 v18, s58, v18
    v_xor_b32 v19, s59, v19
    v_or3_b32 v9, v16, v17, v18
    v_or_b32 v9, v9, v19
    v_and_b32 v9, 0xff, v9
    v_cmp_ne_u32 vcc, 0, v9
    s_cbranch_vccz x_pbx
    s_sleep 4
    s_add_u32 s83, s83, 1
    s_cmp_lt_u32 s83, 0x40000
    s_cbranch_scc1 x_pb
x_pbx:
    v_permlane32_swap_b32 v16, v18
    v_permlane32_swap_b32 v17, v19
    v_pk_add_f32 v[16:17], v[16:17], v[18:19]
    s_nop 1
    v_permlane16_swap_b32 v16, v17
    v_add_f32 v16, v16, v17
    s_nop 1
    v_add_f32_dpp v16, v16, v16 row_ror:8 row_mask:0xf bank_mask:0xf
    v_cvt_pk_bf16_f32 v16, v16, v16
    v_lshlrev_b32 v16, 16, v16
    v_add_f32 v16, s80, v16
    v_cvt_pk_bf16_f32 v16, v16, v16
    v_lshlrev_b32 v16, 16, v16
    v_bfi_b32 v16, s33, v8, v16
    v_mov_b32 v17, v16
    s_nop 1
    v_permlane16_swap_b32 v16, v17
    v_mov_b32 v18, v16
    v_mov_b32 v19, v17
    s_nop 0
    v_permlane32_swap_b32 v16, v18
    v_permlane32_swap_b32 v17, v19
    s_mov_b64 exec, 0xff
    buffer_store_dwordx4 v[16:19], v3, s[12:15], s79 offen sc1
    s_mov_b64 exec, -1
    s_branch x_nb
x_na:
    v_and_b32 v90, 255, v0
    v_lshrrev_b32 v91, 8, v0
    v_lshl_add_u32 v90, v91, 9, v90
    v_mul_u32_u24 v90, 7168, v90
    s_lshr_b32 s42, s60, 7
    s_sub_u32 s42, 3, s42
    s_add_u32 s42, s42, s34
    s_and_b32 s42, s42, 7
    s_cmp_eq_u32 s42, 7
    s_cselect_b32 s70, 0x1000000, 0
    s_mul_i32 s43, s34, 7
    s_add_u32 s42, s42, s43
    s_lshl_b32 s42, s42, 7
    s_add_u32 s42, s42, 0
    s_add_u32 s42, s42, s70
    buffer_load_dword v92, v90, s[60:63], s42 offen
    s_barrier
x_nb:
    s_mov_b32 s17, s37
    s_barrier
    v_lshlrev_b32 v9, 7, v2
    s_mov_b64 exec, 268435455
    buffer_load_dword v251, v9, s[12:15], s36 offen
    s_mov_b64 exec, -1
    s_mov_b32 s8, s48
    s_mov_b32 s9, s49
    s_mov_b32 s10, 2048
    s_mov_b32 s11, 0x00020000
    s_and_b32 s18, s17, 63
    v_and_b32 v5, 3, v0
    v_lshlrev_b32 v5, 3, v5
    v_lshl_add_u32 v5, v7, 1, v5
    v_lshlrev_b32 v6, 1, v5
    v_and_b32 v86, -4, v5
    v_and_b32 v87, 2, v5
    v_lshlrev_b32 v87, 3, v87
    s_lshl_b32 s31, s18, 6
    s_add_u32 s30, s31, 6496256
    s_add_u32 s31, s30, 4096
    s_add_u32 s29, s30, 8192
    s_mov_b32 s28, 6496256
    v_lshlrev_b32 v88, 3, v7
    v_lshrrev_b32 v88, v88, s32
    v_lshrrev_b32 v89, 1, v86
    s_not_b32 s42, s32
    v_lshrrev_b32 v89, v89, s42
    v_and_b32 v89, 196611, v89
    v_lshlrev_b32 v9, 3, v2
    buffer_load_dwordx2 v[40:41], v9, s[8:11], 0 offen offset:0
    buffer_load_dwordx2 v[42:43], v9, s[8:11], 0 offen offset:512
    buffer_load_dwordx2 v[44:45], v9, s[8:11], 0 offen offset:1024
    buffer_load_dwordx2 v[46:47], v9, s[8:11], 0 offen offset:1536
    s_waitcnt vmcnt(0)
    v_lshlrev_b32 v48, 16, v40
    v_and_b32 v49, 0xffff0000, v40
    v_lshlrev_b32 v50, 16, v41
    v_and_b32 v51, 0xffff0000, v41
    v_lshlrev_b32 v52, 16, v42
    v_and_b32 v53, 0xffff0000, v42
    v_lshlrev_b32 v54, 16, v43
    v_and_b32 v55, 0xffff0000, v43
    v_lshlrev_b32 v56, 16, v44
    v_and_b32 v57, 0xffff0000, v44
    v_lshlrev_b32 v58, 16, v45
    v_and_b32 v59, 0xffff0000, v45
    v_lshlrev_b32 v60, 16, v46
    v_and_b32 v61, 0xffff0000, v46
    v_lshlrev_b32 v62, 16, v47
    v_and_b32 v63, 0xffff0000, v47
    s_cmp_lg_u32 s16, 0
    s_cbranch_scc1 x_g1x
    s_mov_b32 s83, 0
x_g1:
    buffer_load_dword v15, v14, s[12:15], s78 offen offset:2048 sc1
    s_waitcnt vmcnt(0)
    v_cmp_ne_u32 vcc, s32, v15
    s_cbranch_vccz x_g1x
    s_sleep 6
    s_add_u32 s83, s83, 1
    s_cmp_lt_u32 s83, 0x40000
    s_cbranch_scc1 x_g1
x_g1x:
    s_barrier
    s_mov_b32 s83, 0
x_pq:
    buffer_load_dwordx4 v[64:67], v3, s[12:15], s28 offen offset:0 sc1
    buffer_load_dwordx4 v[68:71], v3, s[12:15], s28 offen offset:1024 sc1
    buffer_load_dwordx4 v[72:75], v3, s[12:15], s28 offen offset:2048 sc1
    buffer_load_dwordx4 v[76:79], v3, s[12:15], s28 offen offset:3072 sc1
    buffer_load_dword v32, v6, s[12:15], s30 offen sc1
    buffer_load_dword v33, v6, s[12:15], s31 offen sc1
    buffer_load_dword v34, v6, s[12:15], s29 offen sc1
    s_waitcnt vmcnt(0)
    v_xor_b32 v36, v32, v88
    v_bitop3_b32 v36, v36, v33, v88 bitop3:0xf6
    v_bitop3_b32 v36, v36, v34, v88 bitop3:0xf6
    v_and_b32 v36, s33, v36
    v_cmp_ne_u32 s[68:69], 0, v36
    v_xor_b32 v64, s56, v64
    v_xor_b32 v65, s57, v65
    v_xor_b32 v66, s58, v66
    v_xor_b32 v67, s59, v67
    v_xor_b32 v68, s56, v68
    v_xor_b32 v69, s57, v69
    v_xor_b32 v70, s58, v70
    v_xor_b32 v71, s59, v71
    v_xor_b32 v72, s56, v72
    v_xor_b32 v73, s57, v73
    v_xor_b32 v74, s58, v74
    v_xor_b32 v75, s59, v75
    v_xor_b32 v76, s56, v76
    v_xor_b32 v77, s57, v77
    v_xor_b32 v78, s58, v78
    v_xor_b32 v79, s59, v79
    v_or3_b32 v9, v64, v65, v66
    v_or3_b32 v9, v9, v67, v68
    v_or3_b32 v9, v9, v69, v70
    v_or3_b32 v9, v9, v71, v72
    v_or3_b32 v9, v9, v73, v74
    v_or3_b32 v9, v9, v75, v76
    v_or3_b32 v9, v9, v77, v78
    v_or_b32 v9, v9, v79
    v_and_b32 v9, 0xff, v9
    v_cmp_ne_u32 vcc, 0, v9
    s_or_b64 vcc, vcc, s[68:69]
    s_cbranch_vccz x_pqx
    s_sleep 4
    s_add_u32 s83, s83, 1
    s_cmp_lt_u32 s83, 0x40000
    s_cbranch_scc1 x_pq
x_pqx:
    v_and_b32 v32, 0xffff0000, v32
    v_and_b32 v33, 0xffff0000, v33
    v_and_b32 v34, 0xffff0000, v34
    v_pk_mul_f32 v[8:9], v[48:49], v[64:65]
    v_pk_fma_f32 v[8:9], v[50:51], v[66:67], v[8:9]
    v_pk_fma_f32 v[8:9], v[52:53], v[68:69], v[8:9]
    v_pk_fma_f32 v[8:9], v[54:55], v[70:71], v[8:9]
    v_pk_fma_f32 v[8:9], v[56:57], v[72:73], v[8:9]
    v_pk_fma_f32 v[8:9], v[58:59], v[74:75], v[8:9]
    v_pk_fma_f32 v[8:9], v[60:61], v[76:77], v[8:9]
    v_pk_fma_f32 v[8:9], v[62:63], v[78:79], v[8:9]
    v_add_f32 v8, v8, v9
    s_nop 1
    v_add_f32_dpp v8, v8, v8 row_ror:8 row_mask:0xf bank_mask:0xf
    s_nop 1
    v_add_f32_dpp v8, v8, v8 row_ror:4 row_mask:0xf bank_mask:0xf
    s_nop 1
    v_add_f32_dpp v8, v8, v8 row_ror:2 row_mask:0xf bank_mask:0xf
    s_nop 1
    v_add_f32_dpp v8, v8, v8 row_ror:1 row_mask:0xf bank_mask:0xf
    s_nop 1
    v_add_f32_dpp v8, v8, v8 row_bcast:15 row_mask:0xa bank_mask:0xf
    s_nop 1
    v_add_f32_dpp v8, v8, v8 row_bcast:31 row_mask:0xc bank_mask:0xf
    s_cmp_lg_u32 s16, 0
    s_cbranch_scc1 x_ng
    v_mov_b32 v22, 0
    s_mov_b32 s83, 0
x_r0:
    buffer_load_dwordx2 v[16:17], v22, s[12:15], s78 offen offset:2304 sc1
    s_waitcnt vmcnt(0)
    v_readfirstlane_b32 s40, v16
    v_readfirstlane_b32 s41, v17
    s_cmp_eq_u32 s41, s32
    s_cbranch_scc1 x_r0x
    s_sleep 3
    s_add_u32 s83, s83, 1
    s_cmp_lt_u32 s83, 0x40000
    s_cbranch_scc1 x_r0
x_r0x:
    s_lshr_b32 s41, s40, 8
    s_and_b32 s40, s40, 0xff
    s_and_b32 s41, s41, 0xff
x_ng:
    s_barrier
    v_mov_b32 v22, 0
    s_mov_b32 s83, 0
x_r1:
    buffer_load_dwordx2 v[16:17], v22, s[12:15], s78 offen offset:2304 sc1
    s_waitcnt vmcnt(0)
    v_readfirstlane_b32 s40, v16
    v_readfirstlane_b32 s41, v17
    s_cmp_eq_u32 s41, s32
    s_cbranch_scc1 x_r1x
    s_sleep 1
    s_add_u32 s83, s83, 1
    s_cmp_lt_u32 s83, 0x40000
    s_cbranch_scc1 x_r1
x_r1x:
    s_lshr_b32 s41, s40, 8
    s_and_b32 s40, s40, 0xff
    s_and_b32 s41, s41, 0xff
    s_cmp_lt_u32 s17, 64
    s_cselect_b32 s40, s40, s41
    s_lshl_b32 s42, s40, 11
    s_add_u32 s42, s42, 5242880
    s_lshl_b32 s19, s18, 5
    s_add_u32 s43, s42, s19
    s_lshl_b32 s40, s40, 4
    s_add_u32 s40, s40, 6512640
    s_mov_b32 s83, 0
x_ps:
    buffer_load_dwordx4 v[80:83], v14, s[12:15], s40 offen sc1
    buffer_load_dword v40, v86, s[12:15], s43 offen sc1
    s_waitcnt vmcnt(0)
    v_xor_b32 v40, v40, v89
    v_xor_b32 v35, 0x00020002, v40
    v_and_b32 v35, 196611, v35
    v_cmp_ne_u32 s[68:69], 0, v35
    v_xor_b32 v80, s56, v80
    v_xor_b32 v81, s57, v81
    v_xor_b32 v82, s58, v82
    v_xor_b32 v83, s59, v83
    v_or3_b32 v9, v80, v81, v82
    v_or_b32 v9, v9, v83
    v_and_b32 v9, 0xff, v9
    v_cmp_ne_u32 vcc, 0, v9
    s_or_b64 vcc, vcc, s[68:69]
    s_cbranch_vccz x_psx
    s_sleep 2
    s_add_u32 s83, s83, 1
    s_cmp_lt_u32 s83, 0x40000
    s_cbranch_scc1 x_ps
x_psx:
    v_readfirstlane_b32 s41, v80
    s_bfe_u32 s41, s41, 0xb0008
    s_lshl_b32 s41, s41, 11
    s_add_u32 s41, s41, s19
    v_not_b32 v36, v83
    v_ashrrev_i32 v36, 31, v36
    v_or_b32 v36, 0x80000000, v36
    v_xor_b32 v36, v36, v83
    v_add_f32 v8, v8, v36
    v_cvt_pk_bf16_f32 v8, v8, v8
    v_lshlrev_b32 v8, 16, v8
    v_mul_f32 v8, 0xbfb8aa3b, v8
    v_exp_f32 v8, v8
    s_nop 0
    v_add_f32 v8, 1.0, v8
    v_rcp_f32 v8, v8
    s_nop 0
    v_cvt_pk_bf16_f32 v8, v8, v8
    v_lshlrev_b32 v8, 16, v8
    s_nop 0
    v_readlane_b32 s46, v8, 63
    v_lshrrev_b32 v40, v87, v40
    v_cvt_f32_f16 v40, v40
    v_rcp_f32 v82, v82
    v_fma_f32 v36, v40, v34, v32
    v_fma_f32 v44, v40, v82, v81
    v_fmac_f32 v44, v33, v36
    v_mul_f32 v80, s46, v33
    s_sleep 14
    s_mov_b32 s83, 0
    s_mov_b64 s[60:61], -1
    s_mov_b64 s[62:63], -1
    s_mov_b64 s[64:65], -1
    s_mov_b32 s66, -1
    s_mov_b32 s67, 0
    v_mov_b32 v108, 0
    v_mov_b32 v109, 0
    v_mov_b32 v110, 0
    v_mov_b32 v111, 0
    s_mov_b64 exec, s[60:61]
    buffer_load_dwordx4 v[16:19], v3, s[12:15], s36 offen offset:0 sc1
    s_mov_b64 exec, s[62:63]
    buffer_load_dwordx4 v[20:23], v3, s[12:15], s36 offen offset:1024 sc1
    s_mov_b64 exec, s[64:65]
    buffer_load_dwordx4 v[24:27], v3, s[12:15], s36 offen offset:2048 sc1
    s_mov_b64 exec, s[66:67]
    buffer_load_dwordx4 v[28:31], v3, s[12:15], s36 offen offset:3072 sc1
    s_sleep 8
x_p2:
    s_mov_b64 exec, s[60:61]
    buffer_load_dwordx4 v[128:131], v3, s[12:15], s36 offen offset:0 sc1
    s_mov_b64 exec, s[62:63]
    buffer_load_dwordx4 v[132:135], v3, s[12:15], s36 offen offset:1024 sc1
    s_mov_b64 exec, s[64:65]
    buffer_load_dwordx4 v[136:139], v3, s[12:15], s36 offen offset:2048 sc1
    s_mov_b64 exec, s[66:67]
    buffer_load_dwordx4 v[140:143], v3, s[12:15], s36 offen offset:3072 sc1
    s_mov_b64 exec, s[60:61]
    s_waitcnt vmcnt(7)
    v_xor_b32 v96, s56, v16
    v_xor_b32 v97, s57, v17
    v_xor_b32 v98, s58, v18
    v_xor_b32 v99, s59, v19
    v_or3_b32 v12, v96, v97, v98
    v_bitop3_b32 v12, v12, v99, s33 bitop3:0xa8
    v_cmp_ne_u32 s[60:61], 0, v12
    s_mov_b64 exec, s[62:63]
    s_waitcnt vmcnt(6)
    v_xor_b32 v100, s56, v20
    v_xor_b32 v101, s57, v21
    v_xor_b32 v102, s58, v22
    v_xor_b32 v103, s59, v23
    v_or3_b32 v12, v100, v101, v102
    v_bitop3_b32 v12, v12, v103, s33 bitop3:0xa8
    v_cmp_ne_u32 s[62:63], 0, v12
    s_mov_b64 exec, s[64:65]
    s_waitcnt vmcnt(5)
    v_xor_b32 v104, s56, v24
    v_xor_b32 v105, s57, v25
    v_xor_b32 v106, s58, v26
    v_xor_b32 v107, s59, v27
    v_or3_b32 v12, v104, v105, v106
    v_bitop3_b32 v12, v12, v107, s33 bitop3:0xa8
    v_cmp_ne_u32 s[64:65], 0, v12
    s_or_b64 s[70:71], s[60:61], s[62:63]
    s_mov_b64 exec, s[66:67]
    s_waitcnt vmcnt(4)
    v_xor_b32 v108, s56, v28
    v_xor_b32 v109, s57, v29
    v_xor_b32 v110, s58, v30
    v_xor_b32 v111, s59, v31
    v_or3_b32 v12, v108, v109, v110
    v_bitop3_b32 v12, v12, v111, s33 bitop3:0xa8
    v_cmp_ne_u32 s[66:67], 0, v12
    s_mov_b64 exec, -1
    v_pk_add_f32 v[112:113], v[96:97], v[100:101]
    v_pk_add_f32 v[114:115], v[98:99], v[102:103]
    s_or_b64 s[72:73], s[64:65], s[66:67]
    v_pk_add_f32 v[120:121], v[104:105], v[108:109]
    v_pk_add_f32 v[122:123], v[106:107], v[110:111]
    s_or_b64 s[70:71], s[70:71], s[72:73]
    v_pk_add_f32 v[112:113], v[112:113], v[120:121]
    v_pk_add_f32 v[114:115], v[114:115], v[122:123]
    s_cbranch_scc0 x_p3
    s_mov_b64 exec, s[60:61]
    buffer_load_dwordx4 v[16:19], v3, s[12:15], s36 offen offset:0 sc1
    s_mov_b64 exec, s[62:63]
    buffer_load_dwordx4 v[20:23], v3, s[12:15], s36 offen offset:1024 sc1
    s_mov_b64 exec, s[64:65]
    buffer_load_dwordx4 v[24:27], v3, s[12:15], s36 offen offset:2048 sc1
    s_mov_b64 exec, s[66:67]
    buffer_load_dwordx4 v[28:31], v3, s[12:15], s36 offen offset:3072 sc1
    s_add_u32 s83, s83, 1
    s_cmp_lt_u32 s83, 0x40000
    s_cselect_b64 s[68:69], -1, 0
    s_mov_b64 exec, s[60:61]
    s_waitcnt vmcnt(7)
    v_xor_b32 v96, s56, v128
    v_xor_b32 v97, s57, v129
    v_xor_b32 v98, s58, v130
    v_xor_b32 v99, s59, v131
    v_or3_b32 v12, v96, v97, v98
    v_bitop3_b32 v12, v12, v99, s33 bitop3:0xa8
    v_cmp_ne_u32 s[60:61], 0, v12
    s_mov_b64 exec, s[62:63]
    s_waitcnt vmcnt(6)
    v_xor_b32 v100, s56, v132
    v_xor_b32 v101, s57, v133
    v_xor_b32 v102, s58, v134
    v_xor_b32 v103, s59, v135
    v_or3_b32 v12, v100, v101, v102
    v_bitop3_b32 v12, v12, v103, s33 bitop3:0xa8
    v_cmp_ne_u32 s[62:63], 0, v12
    s_mov_b64 exec, s[64:65]
    s_waitcnt vmcnt(5)
    v_xor_b32 v104, s56, v136
    v_xor_b32 v105, s57, v137
    v_xor_b32 v106, s58, v138
    v_xor_b32 v107, s59, v139
    v_or3_b32 v12, v104, v105, v106
    v_bitop3_b32 v12, v12, v107, s33 bitop3:0xa8
    v_cmp_ne_u32 s[64:65], 0, v12
    s_or_b64 s[70:71], s[60:61], s[62:63]
    s_mov_b64 exec, s[66:67]
    s_waitcnt vmcnt(4)
    v_xor_b32 v108, s56, v140
    v_xor_b32 v109, s57, v141
    v_xor_b32 v110, s58, v142
    v_xor_b32 v111, s59, v143
    v_or3_b32 v12, v108, v109, v110
    v_bitop3_b32 v12, v12, v111, s33 bitop3:0xa8
    v_cmp_ne_u32 s[66:67], 0, v12
    s_mov_b64 exec, -1
    v_pk_add_f32 v[112:113], v[96:97], v[100:101]
    v_pk_add_f32 v[114:115], v[98:99], v[102:103]
    s_or_b64 s[72:73], s[64:65], s[66:67]
    v_pk_add_f32 v[120:121], v[104:105], v[108:109]
    v_pk_add_f32 v[122:123], v[106:107], v[110:111]
    s_or_b64 s[70:71], s[70:71], s[72:73]
    s_and_b64 s[70:71], s[70:71], s[68:69]
    v_pk_add_f32 v[112:113], v[112:113], v[120:121]
    v_pk_add_f32 v[114:115], v[114:115], v[122:123]
    s_cbranch_scc1 x_p2
x_p3:
    s_nop 0
    v_permlane32_swap_b32 v112, v114
    v_permlane32_swap_b32 v113, v115
    v_pk_add_f32 v[112:113], v[112:113], v[114:115]
    s_nop 1
    v_permlane16_swap_b32 v112, v113
    v_add_f32 v112, v112, v113
    s_nop 1
    v_add_f32_dpp v112, v112, v112 row_ror:4 row_mask:0xf bank_mask:0xf
    s_nop 1
    v_add_f32_dpp v112, v112, v112 row_ror:8 row_mask:0xf bank_mask:0xf
    v_fmac_f32 v44, v112, v80
    s_mov_b32 exec_lo, 0x000f000f
    s_mov_b32 exec_hi, 0x000f000f
    v_cvt_pk_bf16_f32 v44, v44, v44
    buffer_store_short v44, v5, s[24:27], s41 offen
    s_cmp_lg_u32 s17, 0
    s_cbranch_scc1 x_end
    s_add_u32 s101, s101, 1
    s_mov_b32 s43, 6619136
    v_mov_b32 v8, s101
    s_mov_b64 exec, 1
    buffer_store_dword v8, v14, s[12:15], s43 offen sc1
x_end:
k_done:
    s_endpgm
code_end:
.p2align 8
.type tables,@object
tables:
.long 0x3c00,0x3c00,0x3c00,0x3c00,0x3c00,0x2e463bf6,0x323e3bd9,0x34a53ba8
.long 0x3c00,0x323e3bd9,0x361f3b64,0x38723aa7,0x3c00,0x34a53ba8,0x38723aa7,0x3a2f3913
.long 0x3c00,0x361f3b64,0x39a839a8,0x3b64361f,0x3c00,0x378b3b0e,0x3aa73872,0x3bf62e46
.long 0x3c00,0x38723aa7,0x3b64361f,0x3bd9b23e,0x3c00,0x39133a2f,0x3bd9323e,0x3b0eb78b
.long 0x3c00,0x39a839a8,0x3c000000,0x39a8b9a8,0x3c00,0x3a2f3913,0x3bd9b23e,0x378bbb0e
.long 0x3c00,0x3aa73872,0x3b64b61f,0x323ebbd9,0x3c00,0x3b0e378b,0x3aa7b872,0xae46bbf6
.long 0x3c00,0x3b64361f,0x39a8b9a8,0xb61fbb64,0x3c00,0x3ba834a5,0x3872baa7,0xb913ba2f
.long 0x3c00,0x3bd9323e,0x361fbb64,0xbaa7b872,0x3c00,0x3bf62e46,0x323ebbd9,0xbba8b4a5
.long 0x3c00,0x3c00,0x3c00,0x3c00,0x361f3b64,0x378b3b0e,0x38723aa7,0x39133a2f
.long 0x39a839a8,0x3aa73872,0x3b64361f,0x3bd9323e,0x3b64361f,0x3bf62e46,0x3bd9b23e,0x3b0eb78b
.long 0x3c000000,0x3b64b61f,0x39a8b9a8,0x361fbb64,0x3b64b61f,0x3913ba2f,0x323ebbd9,0xb4a5bba8
.long 0x39a8b9a8,0x323ebbd9,0xb61fbb64,0xbaa7b872,0x361fbb64,0xb4a5bba8,0xbaa7b872,0xbbf62e46
.long 0xbc00,0xb9a8b9a8,0xbc008000,0xb9a839a8,0xb61fbb64,0xbba8b4a5,0xbaa73872,0xae463bf6
.long 0xb9a8b9a8,0xbbd9323e,0xb61f3b64,0x38723aa7,0xbb64b61f,0xba2f3913,0x323e3bd9,0x3ba834a5
.long 0xbc008000,0xb61f3b64,0x39a839a8,0x3b64b61f,0xbb64361f,0x2e463bf6,0x3bd9323e,0x378bbb0e
.long 0xb9a839a8,0x38723aa7,0x3b64b61f,0xb23ebbd9,0xb61f3b64,0x3b0e378b,0x3872baa7,0xba2fb913
.long 0x3c00,0x3c00,0x3c00,0x3c00,0x39a839a8,0x3a2f3913,0x3aa73872,0x3b0e378b
.long 0x3c000000,0x3bd9b23e,0x3b64b61f,0x3aa7b872,0x39a8b9a8,0x378bbb0e,0x323ebbd9,0xae46bbf6
.long 0xbc00,0xb61fbb64,0xb9a8b9a8,0xbb64b61f,0xb9a8b9a8,0xbba8b4a5,0xbbd9323e,0xba2f3913
.long 0xbc008000,0xbaa73872,0xb61f3b64,0x323e3bd9,0xb9a839a8,0xae463bf6,0x38723aa7,0x3ba834a5
.long 0x3c00,0x39a839a8,0x3c000000,0x39a8b9a8,0x39a839a8,0x3bf6ae46,0x3872baa7,0xb4a5bba8
.long 0x3c000000,0x3872baa7,0xb61fbb64,0xbbd9b23e,0x39a8b9a8,0xb4a5bba8,0xbbd9b23e,0xb9133a2f
.long 0xbc00,0xbb64b61f,0xb9a839a8,0x361f3b64,0xb9a8b9a8,0xbb0e378b,0x323e3bd9,0x3bf62e46
.long 0xbc008000,0xb23e3bd9,0x3b64361f,0x3872baa7,0xb9a839a8,0x39133a2f,0x3aa7b872,0xb78bbb0e
.long 0x3c00,0x3c00,0x3c00,0x3c00,0x3b64361f,0x3ba834a5,0x3bd9323e,0x3bf62e46
.long 0x39a8b9a8,0x3872baa7,0x361fbb64,0x323ebbd9,0xb61fbb64,0xb913ba2f,0xbaa7b872,0xbba8b4a5
.long 0xbc008000,0xbb64361f,0xb9a839a8,0xb61f3b64,0xb61f3b64,0x2e463bf6,0x38723aa7,0x3b0e378b
.long 0x39a839a8,0x3bd9323e,0x3b64b61f,0x3872baa7,0x3b64b61f,0x378bbb0e,0xb23ebbd9,0xba2fb913
.long 0xbc00,0xb9a8b9a8,0xbc008000,0xb9a839a8,0xbb64b61f,0xbb0e378b,0xb23e3bd9,0x39133a2f
.long 0xb9a839a8,0x323e3bd9,0x3b64361f,0x3aa7b872,0x361f3b64,0x3bf62e46,0x3872baa7,0xb78bbb0e
.long 0x3c000000,0x361fbb64,0xb9a8b9a8,0xbb64361f,0x361fbb64,0xba2fb913,0xbaa73872,0x34a53ba8
.long 0xb9a8b9a8,0xbaa73872,0x361f3b64,0x3bd9b23e,0xbb64361f,0x34a53ba8,0x3bd9b23e,0xae46bbf6
.long 0x3c00,0x3c00,0x3c00,0x3c00,0x3c000000,0x3bf6ae46,0x3bd9b23e,0x3ba8b4a5
.long 0xbc00,0xb23ebbd9,0xb61fbb64,0xb872baa7,0xbc008000,0xbba834a5,0xbaa73872,0xb9133a2f
.long 0x3c00,0x361f3b64,0x39a839a8,0x3b64361f,0x3c000000,0x3b0eb78b,0x3872baa7,0x2e46bbf6
.long 0xbc00,0xb872baa7,0xbb64b61f,0xbbd9323e,0xbc008000,0xba2f3913,0xb23e3bd9,0x378b3b0e
.long 0x3c00,0x39a839a8,0x3c000000,0x39a8b9a8,0x3c000000,0x3913ba2f,0xb23ebbd9,0xbb0eb78b
.long 0xbc00,0xbaa7b872,0xbb64361f,0xb23e3bd9,0xbc008000,0xb78b3b0e,0x38723aa7,0x3bf6ae46
.long 0x3c00,0x3b64361f,0x39a8b9a8,0xb61fbb64,0x3c000000,0x34a5bba8,0xbaa7b872,0xba2f3913
.long 0xbc00,0xbbd9b23e,0xb61f3b64,0x3aa73872,0xbc008000,0xae463bf6,0x3bd9323e,0x34a5bba8
.long 0x3c00,0x3c00,0x3c00,0x3c00,0x3b64b61f,0x3b0eb78b,0x3aa7b872,0x3a2fb913
.long 0xb9a8b9a8,0xbaa7b872,0xbb64b61f,0xbbd9b23e,0xb61f3b64,0xae463bf6,0x323e3bd9,0x378b3b0e
.long 0x3c000000,0x3b64b61f,0x39a8b9a8,0x361fbb64,0xb61fbb64,0xba2fb913,0xbbd9b23e,0xbba834a5
.long 0xb9a839a8,0xb23e3bd9,0x361f3b64,0x3aa73872,0x3b64361f,0x3ba8b4a5,0x3872baa7,0xae46bbf6
.long 0xbc00,0xb9a8b9a8,0xbc008000,0xb9a839a8,0xbb64361f,0xb4a53ba8,0x38723aa7,0x3bf62e46
.long 0x39a839a8,0x3bd9b23e,0x361fbb64,0xb872baa7,0x361fbb64,0xb913ba2f,0xbbd9323e,0xb4a53ba8
.long 0xbc008000,0xb61f3b64,0x39a839a8,0x3b64b61f,0x361f3b64,0x3bf6ae46,0x323ebbd9,0xbb0eb78b
.long 0x39a8b9a8,0xb872baa7,0xbb64361f,0x323e3bd9,0xbb64b61f,0xb78b3b0e,0x3aa73872,0x3913ba2f
.long 0x3c00,0x3c00,0x3c00,0x3c00,0x39a8b9a8,0x3913ba2f,0x3872baa7,0x378bbb0e
.long 0xbc008000,0xbbd9323e,0xbb64361f,0xbaa73872,0x39a839a8,0x3b0e378b,0x3bd9323e,0x3bf6ae46
.long 0xbc00,0xb61fbb64,0xb9a8b9a8,0xbb64b61f,0xb9a839a8,0xb4a53ba8,0x323e3bd9,0x39133a2f
.long 0x3c000000,0x3aa7b872,0x361fbb64,0xb23ebbd9,0xb9a8b9a8,0xbbf6ae46,0xbaa73872,0xb4a53ba8
.long 0x3c00,0x39a839a8,0x3c000000,0x39a8b9a8,0x39a8b9a8,0xae46bbf6,0xbaa7b872,0xbba834a5
.long 0xbc008000,0xb8723aa7,0x361f3b64,0x3bd9323e,0x39a839a8,0x3ba8b4a5,0x323ebbd9,0xba2fb913
.long 0xbc00,0xbb64b61f,0xb9a839a8,0x361f3b64,0xb9a839a8,0x378b3b0e,0x3bd9b23e,0x2e46bbf6
.long 0x3c000000,0x323ebbd9,0xbb64b61f,0xb8723aa7,0xb9a8b9a8,0xba2f3913,0x38723aa7,0x3b0eb78b
.long 0x3c00,0x3c00,0x3c00,0x3c00,0x361fbb64,0x34a5bba8,0x323ebbd9,0x2e46bbf6
.long 0xb9a839a8,0xb8723aa7,0xb61f3b64,0xb23e3bd9,0x3b64b61f,0x3a2fb913,0x3872baa7,0x34a5bba8
.long 0xbc008000,0xbb64361f,0xb9a839a8,0xb61f3b64,0x3b64361f,0x3bf6ae46,0x3aa7b872,0x378bbb0e
.long 0xb9a8b9a8,0xbbd9b23e,0xbb64361f,0xb8723aa7,0x361f3b64,0x3b0e378b,0x3bd9b23e,0x3913ba2f
.long 0xbc00,0xb9a8b9a8,0xbc008000,0xb9a839a8,0xb61f3b64,0x378b3b0e,0x3bd9323e,0x3a2fb913
.long 0x39a8b9a8,0xb23ebbd9,0xbb64b61f,0xbaa73872,0xbb64361f,0xae463bf6,0x3aa73872,0x3b0eb78b
.long 0x3c000000,0x361fbb64,0xb9a8b9a8,0xbb64361f,0xbb64b61f,0xb9133a2f,0x38723aa7,0x3ba8b4a5
.long 0x39a839a8,0x3aa7b872,0xb61fbb64,0xbbd9323e,0xb61fbb64,0xbba834a5,0x323e3bd9,0x3bf6ae46
.long 0x3c00,0x3c00,0x3c00,0x3c00,0xbc00,0xae46bbf6,0xb23ebbd9,0xb4a5bba8
.long 0x3c00,0x323e3bd9,0x361f3b64,0x38723aa7,0xbc00,0xb4a5bba8,0xb872baa7,0xba2fb913
.long 0x3c00,0x361f3b64,0x39a839a8,0x3b64361f,0xbc00,0xb78bbb0e,0xbaa7b872,0xbbf6ae46
.long 0x3c00,0x38723aa7,0x3b64361f,0x3bd9b23e,0xbc00,0xb913ba2f,0xbbd9b23e,0xbb0e378b
.long 0x3c00,0x39a839a8,0x3c000000,0x39a8b9a8,0xbc00,0xba2fb913,0xbbd9323e,0xb78b3b0e
.long 0x3c00,0x3aa73872,0x3b64b61f,0x323ebbd9,0xbc00,0xbb0eb78b,0xbaa73872,0x2e463bf6
.long 0x3c00,0x3b64361f,0x39a8b9a8,0xb61fbb64,0xbc00,0xbba8b4a5,0xb8723aa7,0x39133a2f
.long 0x3c00,0x3bd9323e,0x361fbb64,0xbaa7b872,0xbc00,0xbbf6ae46,0xb23e3bd9,0x3ba834a5
.long 0x3c00,0x3c00,0x3c00,0x3c00,0xb61fbb64,0xb78bbb0e,0xb872baa7,0xb913ba2f
.long 0x39a839a8,0x3aa73872,0x3b64361f,0x3bd9323e,0xbb64b61f,0xbbf6ae46,0xbbd9323e,0xbb0e378b
.long 0x3c000000,0x3b64b61f,0x39a8b9a8,0x361fbb64,0xbb64361f,0xb9133a2f,0xb23e3bd9,0x34a53ba8
.long 0x39a8b9a8,0x323ebbd9,0xb61fbb64,0xbaa7b872,0xb61f3b64,0x34a53ba8,0x3aa73872,0x3bf6ae46
.long 0xbc00,0xb9a8b9a8,0xbc008000,0xb9a839a8,0x361f3b64,0x3ba834a5,0x3aa7b872,0x2e46bbf6
.long 0xb9a8b9a8,0xbbd9323e,0xb61f3b64,0x38723aa7,0x3b64361f,0x3a2fb913,0xb23ebbd9,0xbba8b4a5
.long 0xbc008000,0xb61f3b64,0x39a839a8,0x3b64b61f,0x3b64b61f,0xae46bbf6,0xbbd9b23e,0xb78b3b0e
.long 0xb9a839a8,0x38723aa7,0x3b64b61f,0xb23ebbd9,0x361fbb64,0xbb0eb78b,0xb8723aa7,0x3a2f3913
.long 0x3c00,0x3c00,0x3c00,0x3c00,0xb9a8b9a8,0xba2fb913,0xbaa7b872,0xbb0eb78b
.long 0x3c000000,0x3bd9b23e,0x3b64b61f,0x3aa7b872,0xb9a839a8,0xb78b3b0e,0xb23e3bd9,0x2e463bf6
.long 0xbc00,0xb61fbb64,0xb9a8b9a8,0xbb64b61f,0x39a839a8,0x3ba834a5,0x3bd9b23e,0x3a2fb913
.long 0xbc008000,0xbaa73872,0xb61f3b64,0x323e3bd9,0x39a8b9a8,0x2e46bbf6,0xb872baa7,0xbba8b4a5
.long 0x3c00,0x39a839a8,0x3c000000,0x39a8b9a8,0xb9a8b9a8,0xbbf62e46,0xb8723aa7,0x34a53ba8
.long 0x3c000000,0x3872baa7,0xb61fbb64,0xbbd9b23e,0xb9a839a8,0x34a53ba8,0x3bd9323e,0x3913ba2f
.long 0xbc00,0xbb64b61f,0xb9a839a8,0x361f3b64,0x39a839a8,0x3b0eb78b,0xb23ebbd9,0xbbf6ae46
.long 0xbc008000,0xb23e3bd9,0x3b64361f,0x3872baa7,0x39a8b9a8,0xb913ba2f,0xbaa73872,0x378b3b0e
.long 0x3c00,0x3c00,0x3c00,0x3c00,0xbb64b61f,0xbba8b4a5,0xbbd9b23e,0xbbf6ae46
.long 0x39a8b9a8,0x3872baa7,0x361fbb64,0x323ebbd9,0x361f3b64,0x39133a2f,0x3aa73872,0x3ba834a5
.long 0xbc008000,0xbb64361f,0xb9a839a8,0xb61f3b64,0x361fbb64,0xae46bbf6,0xb872baa7,0xbb0eb78b
.long 0x39a839a8,0x3bd9323e,0x3b64b61f,0x3872baa7,0xbb64361f,0xb78b3b0e,0x323e3bd9,0x3a2f3913
.long 0xbc00,0xb9a8b9a8,0xbc008000,0xb9a839a8,0x3b64361f,0x3b0eb78b,0x323ebbd9,0xb913ba2f
.long 0xb9a839a8,0x323e3bd9,0x3b64361f,0x3aa7b872,0xb61fbb64,0xbbf6ae46,0xb8723aa7,0x378b3b0e
.long 0x3c000000,0x361fbb64,0xb9a8b9a8,0xbb64361f,0xb61f3b64,0x3a2f3913,0x3aa7b872,0xb4a5bba8
.long 0xb9a8b9a8,0xbaa73872,0x361f3b64,0x3bd9b23e,0x3b64b61f,0xb4a5bba8,0xbbd9323e,0x2e463bf6
.long 0x3c00,0x3c00,0x3c00,0x3c00,0xbc008000,0xbbf62e46,0xbbd9323e,0xbba834a5
.long 0xbc00,0xb23ebbd9,0xb61fbb64,0xb872baa7,0x3c000000,0x3ba8b4a5,0x3aa7b872,0x3913ba2f
.long 0x3c00,0x361f3b64,0x39a839a8,0x3b64361f,0xbc008000,0xbb0e378b,0xb8723aa7,0xae463bf6
.long 0xbc00,0xb872baa7,0xbb64b61f,0xbbd9323e,0x3c000000,0x3a2fb913,0x323ebbd9,0xb78bbb0e
.long 0x3c00,0x39a839a8,0x3c000000,0x39a8b9a8,0xbc008000,0xb9133a2f,0x323e3bd9,0x3b0e378b
.long 0xbc00,0xbaa7b872,0xbb64361f,0xb23e3bd9,0x3c000000,0x378bbb0e,0xb872baa7,0xbbf62e46
.long 0x3c00,0x3b64361f,0x39a8b9a8,0xb61fbb64,0xbc008000,0xb4a53ba8,0x3aa73872,0x3a2fb913
.long 0xbc00,0xbbd9b23e,0xb61f3b64,0x3aa73872,0x3c000000,0x2e46bbf6,0xbbd9b23e,0xb4a53ba8
.long 0x3c00,0x3c00,0x3c00,0x3c00,0xbb64361f,0xbb0e378b,0xbaa73872,0xba2f3913
.long 0xb9a8b9a8,0xbaa7b872,0xbb64b61f,0xbbd9b23e,0x361fbb64,0x2e46bbf6,0xb23ebbd9,0xb78bbb0e
.long 0x3c000000,0x3b64b61f,0x39a8b9a8,0x361fbb64,0x361f3b64,0x3a2f3913,0x3bd9323e,0x3ba8b4a5
.long 0xb9a839a8,0xb23e3bd9,0x361f3b64,0x3aa73872,0xbb64b61f,0xbba834a5,0xb8723aa7,0x2e463bf6
.long 0xbc00,0xb9a8b9a8,0xbc008000,0xb9a839a8,0x3b64b61f,0x34a5bba8,0xb872baa7,0xbbf6ae46
.long 0x39a839a8,0x3bd9b23e,0x361fbb64,0xb872baa7,0xb61f3b64,0x39133a2f,0x3bd9b23e,0x34a5bba8
.long 0xbc008000,0xb61f3b64,0x39a839a8,0x3b64b61f,0xb61fbb64,0xbbf62e46,0xb23e3bd9,0x3b0e378b
.long 0x39a8b9a8,0xb872baa7,0xbb64361f,0x323e3bd9,0x3b64361f,0x378bbb0e,0xbaa7b872,0xb9133a2f
.long 0x3c00,0x3c00,0x3c00,0x3c00,0xb9a839a8,0xb9133a2f,0xb8723aa7,0xb78b3b0e
.long 0xbc008000,0xbbd9323e,0xbb64361f,0xbaa73872,0xb9a8b9a8,0xbb0eb78b,0xbbd9b23e,0xbbf62e46
.long 0xbc00,0xb61fbb64,0xb9a8b9a8,0xbb64b61f,0x39a8b9a8,0x34a5bba8,0xb23ebbd9,0xb913ba2f
.long 0x3c000000,0x3aa7b872,0x361fbb64,0xb23ebbd9,0x39a839a8,0x3bf62e46,0x3aa7b872,0x34a5bba8
.long 0x3c00,0x39a839a8,0x3c000000,0x39a8b9a8,0xb9a839a8,0x2e463bf6,0x3aa73872,0x3ba8b4a5
.long 0xbc008000,0xb8723aa7,0x361f3b64,0x3bd9323e,0xb9a8b9a8,0xbba834a5,0xb23e3bd9,0x3a2f3913
.long 0xbc00,0xbb64b61f,0xb9a839a8,0x361f3b64,0x39a8b9a8,0xb78bbb0e,0xbbd9323e,0xae463bf6
.long 0x3c000000,0x323ebbd9,0xbb64b61f,0xb8723aa7,0x39a839a8,0x3a2fb913,0xb872baa7,0xbb0e378b
.long 0x3c00,0x3c00,0x3c00,0x3c00,0xb61f3b64,0xb4a53ba8,0xb23e3bd9,0xae463bf6
.long 0xb9a839a8,0xb8723aa7,0xb61f3b64,0xb23e3bd9,0xbb64361f,0xba2f3913,0xb8723aa7,0xb4a53ba8
.long 0xbc008000,0xbb64361f,0xb9a839a8,0xb61f3b64,0xbb64b61f,0xbbf62e46,0xbaa73872,0xb78b3b0e
.long 0xb9a8b9a8,0xbbd9b23e,0xbb64361f,0xb8723aa7,0xb61fbb64,0xbb0eb78b,0xbbd9323e,0xb9133a2f
.long 0xbc00,0xb9a8b9a8,0xbc008000,0xb9a839a8,0x361fbb64,0xb78bbb0e,0xbbd9b23e,0xba2f3913
.long 0x39a8b9a8,0xb23ebbd9,0xbb64b61f,0xbaa73872,0x3b64b61f,0x2e46bbf6,0xbaa7b872,0xbb0e378b
.long 0x3c000000,0x361fbb64,0xb9a8b9a8,0xbb64361f,0x3b64361f,0x3913ba2f,0xb872baa7,0xbba834a5
.long 0x39a839a8,0x3aa7b872,0xb61fbb64,0xbbd9323e,0x361f3b64,0x3ba8b4a5,0xb23ebbd9,0xbbf62e46
.long 0x3c00,0x3c000000,0xbc00,0xbc008000,0x3c00,0x3bf6ae46,0xb23ebbd9,0xbba834a5
.long 0x3c00,0x3bd9b23e,0xb61fbb64,0xbaa73872,0x3c00,0x3ba8b4a5,0xb872baa7,0xb9133a2f
.long 0x3c00,0x3b64b61f,0xb9a8b9a8,0xb61f3b64,0x3c00,0x3b0eb78b,0xbaa7b872,0xae463bf6
.long 0x3c00,0x3aa7b872,0xbb64b61f,0x323e3bd9,0x3c00,0x3a2fb913,0xbbd9b23e,0x378b3b0e
.long 0x3c00,0x39a8b9a8,0xbc008000,0x39a839a8,0x3c00,0x3913ba2f,0xbbd9323e,0x3b0e378b
.long 0x3c00,0x3872baa7,0xbb64361f,0x3bd9323e,0x3c00,0x378bbb0e,0xbaa73872,0x3bf6ae46
.long 0x3c00,0x361fbb64,0xb9a839a8,0x3b64b61f,0x3c00,0x34a5bba8,0xb8723aa7,0x3a2fb913
.long 0x3c00,0x323ebbd9,0xb61f3b64,0x3872baa7,0x3c00,0x2e46bbf6,0xb23e3bd9,0x34a5bba8
.long 0x3c00,0x3c000000,0xbc00,0xbc008000,0x361f3b64,0x3b0eb78b,0xb872baa7,0xba2f3913
.long 0x39a839a8,0x3872baa7,0xbb64b61f,0xb23e3bd9,0x3b64361f,0x2e46bbf6,0xbbd9323e,0x378b3b0e
.long 0x3c000000,0xb61fbb64,0xb9a839a8,0x3b64361f,0x3b64b61f,0xba2fb913,0xb23e3bd9,0x3ba8b4a5
.long 0x39a8b9a8,0xbbd9b23e,0x361f3b64,0x3872baa7,0x361fbb64,0xbba834a5,0x3aa73872,0xae46bbf6
.long 0xbc00,0xb9a839a8,0x3c000000,0xb9a8b9a8,0xb61fbb64,0xb4a53ba8,0x3aa7b872,0xbbf6ae46
.long 0xb9a8b9a8,0x323e3bd9,0x361fbb64,0xbaa73872,0xbb64b61f,0x39133a2f,0xb23ebbd9,0xb4a53ba8
.long 0xbc008000,0x3b64361f,0xb9a8b9a8,0x361f3b64,0xbb64361f,0x3bf6ae46,0xbbd9b23e,0x3b0e378b
.long 0xb9a839a8,0x3aa7b872,0xbb64361f,0x3bd9b23e,0xb61f3b64,0x378bbb0e,0xb8723aa7,0x3913ba2f
.long 0x3c00,0x3c000000,0xbc00,0xbc008000,0x39a839a8,0x3913ba2f,0xbaa7b872,0xb78b3b0e
.long 0x3c000000,0xb23ebbd9,0xbb64361f,0x38723aa7,0x39a8b9a8,0xbb0eb78b,0xb23e3bd9,0x3bf6ae46
.long 0xbc00,0xbb64361f,0x39a839a8,0x361fbb64,0xb9a8b9a8,0xb4a53ba8,0x3bd9b23e,0xb913ba2f
.long 0xbc008000,0x38723aa7,0x361fbb64,0xbbd9323e,0xb9a839a8,0x3bf62e46,0xb872baa7,0xb4a53ba8
.long 0x3c00,0x39a8b9a8,0xbc008000,0x39a839a8,0x39a839a8,0xae46bbf6,0xb8723aa7,0x3ba8b4a5
.long 0x3c000000,0xbaa7b872,0x361f3b64,0x323ebbd9,0x39a8b9a8,0xbba834a5,0x3bd9323e,0xba2fb913
.long 0xbc00,0xb61f3b64,0x39a8b9a8,0xbb64361f,0xb9a8b9a8,0x378b3b0e,0xb23ebbd9,0xae463bf6
.long 0xbc008000,0x3bd9323e,0xbb64b61f,0x3aa73872,0xb9a839a8,0x3a2fb913,0xbaa73872,0x3b0eb78b
.long 0x3c00,0x3c000000,0xbc00,0xbc008000,0x3b64361f,0x34a5bba8,0xbbd9b23e,0xae463bf6
.long 0x39a8b9a8,0xbaa7b872,0xb61f3b64,0x3bd9323e,0xb61fbb64,0xba2f3913,0x3aa73872,0x34a5bba8
.long 0xbc008000,0x361f3b64,0x39a8b9a8,0xbb64b61f,0xb61f3b64,0x3bf6ae46,0xb872baa7,0xb78b3b0e
.long 0x39a839a8,0x323ebbd9,0xbb64361f,0x3aa73872,0x3b64b61f,0xbb0eb78b,0x323e3bd9,0x3913ba2f
.long 0xbc00,0xb9a839a8,0x3c000000,0xb9a8b9a8,0xbb64b61f,0x378b3b0e,0x323ebbd9,0xba2f3913
.long 0xb9a839a8,0x3bd9b23e,0xbb64b61f,0x38723aa7,0x361f3b64,0x2e46bbf6,0xb8723aa7,0x3b0eb78b
.long 0x3c000000,0xbb64b61f,0x39a839a8,0xb61fbb64,0x361fbb64,0xb9133a2f,0x3aa7b872,0xbba834a5
.long 0xb9a8b9a8,0x38723aa7,0xb61fbb64,0x323e3bd9,0xbb64361f,0x3ba8b4a5,0xbbd9323e,0x3bf6ae46
.long 0x3c00,0x3c000000,0xbc00,0xbc008000,0x3c000000,0xae46bbf6,0xbbd9323e,0x34a53ba8
.long 0xbc00,0xbbd9323e,0x361f3b64,0x3aa7b872,0xbc008000,0x34a53ba8,0x3aa7b872,0xba2fb913
.long 0x3c00,0x3b64b61f,0xb9a8b9a8,0xb61f3b64,0x3c000000,0xb78bbb0e,0xb8723aa7,0x3bf62e46
.long 0xbc00,0xbaa73872,0x3b64361f,0xb23ebbd9,0xbc008000,0x39133a2f,0x323ebbd9,0xbb0e378b
.long 0x3c00,0x39a8b9a8,0xbc008000,0x39a839a8,0x3c000000,0xba2fb913,0x323e3bd9,0x378bbb0e
.long 0xbc00,0xb8723aa7,0x3b64b61f,0xbbd9b23e,0xbc008000,0x3b0e378b,0xb872baa7,0x2e463bf6
.long 0x3c00,0x361fbb64,0xb9a839a8,0x3b64b61f,0x3c000000,0xbba8b4a5,0x3aa73872,0xb913ba2f
.long 0xbc00,0xb23e3bd9,0x361fbb64,0xb8723aa7,0xbc008000,0x3bf62e46,0xbbd9b23e,0x3ba834a5
.long 0x3c00,0x3c000000,0xbc00,0xbc008000,0x3b64b61f,0xb78bbb0e,0xbaa73872,0x39133a2f
.long 0xb9a8b9a8,0xb8723aa7,0x3b64361f,0x323ebbd9,0xb61f3b64,0x3bf62e46,0xb23ebbd9,0xbb0e378b
.long 0x3c000000,0xb61fbb64,0xb9a839a8,0x3b64361f,0xb61fbb64,0xb9133a2f,0x3bd9323e,0xb4a5bba8
.long 0xb9a839a8,0x3bd9323e,0xb61fbb64,0xb8723aa7,0x3b64361f,0xb4a5bba8,0xb8723aa7,0x3bf6ae46
.long 0xbc00,0xb9a839a8,0x3c000000,0xb9a8b9a8,0xbb64361f,0x3ba834a5,0xb872baa7,0xae463bf6
.long 0x39a839a8,0xb23ebbd9,0xb61f3b64,0x3aa7b872,0x361fbb64,0xba2f3913,0x3bd9b23e,0xbba8b4a5
.long 0xbc008000,0x3b64361f,0xb9a8b9a8,0x361f3b64,0x361f3b64,0xae46bbf6,0xb23e3bd9,0x378bbb0e
.long 0x39a8b9a8,0xbaa73872,0x3b64b61f,0xbbd9323e,0xbb64b61f,0x3b0e378b,0xbaa7b872,0x3a2f3913
.long 0x3c00,0x3c000000,0xbc00,0xbc008000,0x39a8b9a8,0xba2fb913,0xb8723aa7,0x3b0e378b
.long 0xbc008000,0x323e3bd9,0x3b64b61f,0xb872baa7,0x39a839a8,0x378bbb0e,0xbbd9b23e,0x2e463bf6
.long 0xbc00,0xbb64361f,0x39a839a8,0x361fbb64,0xb9a839a8,0x3ba834a5,0xb23ebbd9,0xba2f3913
.long 0x3c000000,0xb872baa7,0xb61f3b64,0x3bd9b23e,0xb9a8b9a8,0xae463bf6,0x3aa7b872,0xbba8b4a5
.long 0x3c00,0x39a8b9a8,0xbc008000,0x39a839a8,0x39a8b9a8,0xbbf62e46,0x3aa73872,0xb4a5bba8
.long 0xbc008000,0x3aa73872,0xb61fbb64,0xb23e3bd9,0x39a839a8,0xb4a5bba8,0xb23e3bd9,0x3913ba2f
.long 0xbc00,0xb61f3b64,0x39a8b9a8,0xbb64361f,0xb9a839a8,0x3b0eb78b,0xbbd9323e,0x3bf62e46
.long 0x3c000000,0xbbd9b23e,0x3b64361f,0xbaa7b872,0xb9a8b9a8,0x39133a2f,0xb872baa7,0x378b3b0e
.long 0x3c00,0x3c000000,0xbc00,0xbc008000,0x361fbb64,0xbba8b4a5,0xb23e3bd9,0x3bf62e46
.long 0xb9a839a8,0x3aa73872,0x361fbb64,0xbbd9b23e,0x3b64b61f,0xb913ba2f,0xb8723aa7,0x3ba834a5
.long 0xbc008000,0x361f3b64,0x39a8b9a8,0xbb64b61f,0x3b64361f,0xae46bbf6,0xbaa73872,0x3b0e378b
.long 0xb9a8b9a8,0xb23e3bd9,0x3b64b61f,0xbaa7b872,0x361f3b64,0x378bbb0e,0xbbd9323e,0x3a2f3913
.long 0xbc00,0xb9a839a8,0x3c000000,0xb9a8b9a8,0xb61f3b64,0x3b0eb78b,0xbbd9b23e,0x39133a2f
.long 0x39a8b9a8,0xbbd9323e,0x3b64361f,0xb872baa7,0xbb64361f,0x3bf62e46,0xbaa7b872,0x378b3b0e
.long 0x3c000000,0xbb64b61f,0x39a839a8,0xb61fbb64,0xbb64b61f,0x3a2f3913,0xb872baa7,0x34a53ba8
.long 0x39a839a8,0xb872baa7,0x361f3b64,0xb23ebbd9,0xb61fbb64,0x34a53ba8,0xb23ebbd9,0x2e463bf6
.long 0x3c00,0x3c000000,0xbc00,0xbc008000,0xbc00,0xbbf62e46,0x323e3bd9,0x3ba8b4a5
.long 0x3c00,0x3bd9b23e,0xb61fbb64,0xbaa73872,0xbc00,0xbba834a5,0x38723aa7,0x3913ba2f
.long 0x3c00,0x3b64b61f,0xb9a8b9a8,0xb61f3b64,0xbc00,0xbb0e378b,0x3aa73872,0x2e46bbf6
.long 0x3c00,0x3aa7b872,0xbb64b61f,0x323e3bd9,0xbc00,0xba2f3913,0x3bd9323e,0xb78bbb0e
.long 0x3c00,0x39a8b9a8,0xbc008000,0x39a839a8,0xbc00,0xb9133a2f,0x3bd9b23e,0xbb0eb78b
.long 0x3c00,0x3872baa7,0xbb64361f,0x3bd9323e,0xbc00,0xb78b3b0e,0x3aa7b872,0xbbf62e46
.long 0x3c00,0x361fbb64,0xb9a839a8,0x3b64b61f,0xbc00,0xb4a53ba8,0x3872baa7,0xba2f3913
.long 0x3c00,0x323ebbd9,0xb61f3b64,0x3872baa7,0xbc00,0xae463bf6,0x323ebbd9,0xb4a53ba8
.long 0x3c00,0x3c000000,0xbc00,0xbc008000,0xb61fbb64,0xbb0e378b,0x38723aa7,0x3a2fb913
.long 0x39a839a8,0x3872baa7,0xbb64b61f,0xb23e3bd9,0xbb64b61f,0xae463bf6,0x3bd9b23e,0xb78bbb0e
.long 0x3c000000,0xb61fbb64,0xb9a839a8,0x3b64361f,0xbb64361f,0x3a2f3913,0x323ebbd9,0xbba834a5
.long 0x39a8b9a8,0xbbd9b23e,0x361f3b64,0x3872baa7,0xb61f3b64,0x3ba8b4a5,0xbaa7b872,0x2e463bf6
.long 0xbc00,0xb9a839a8,0x3c000000,0xb9a8b9a8,0x361f3b64,0x34a5bba8,0xbaa73872,0x3bf62e46
.long 0xb9a8b9a8,0x323e3bd9,0x361fbb64,0xbaa73872,0x3b64361f,0xb913ba2f,0x323e3bd9,0x34a5bba8
.long 0xbc008000,0x3b64361f,0xb9a8b9a8,0x361f3b64,0x3b64b61f,0xbbf62e46,0x3bd9323e,0xbb0eb78b
.long 0xb9a839a8,0x3aa7b872,0xbb64361f,0x3bd9b23e,0x361fbb64,0xb78b3b0e,0x3872baa7,0xb9133a2f
.long 0x3c00,0x3c000000,0xbc00,0xbc008000,0xb9a8b9a8,0xb9133a2f,0x3aa73872,0x378bbb0e
.long 0x3c000000,0xb23ebbd9,0xbb64361f,0x38723aa7,0xb9a839a8,0x3b0e378b,0x323ebbd9,0xbbf62e46
.long 0xbc00,0xbb64361f,0x39a839a8,0x361fbb64,0x39a839a8,0x34a5bba8,0xbbd9323e,0x39133a2f
.long 0xbc008000,0x38723aa7,0x361fbb64,0xbbd9323e,0x39a8b9a8,0xbbf6ae46,0x38723aa7,0x34a5bba8
.long 0x3c00,0x39a8b9a8,0xbc008000,0x39a839a8,0xb9a8b9a8,0x2e463bf6,0x3872baa7,0xbba834a5
.long 0x3c000000,0xbaa7b872,0x361f3b64,0x323ebbd9,0xb9a839a8,0x3ba8b4a5,0xbbd9b23e,0x3a2f3913
.long 0xbc00,0xb61f3b64,0x39a8b9a8,0xbb64361f,0x39a839a8,0xb78bbb0e,0x323e3bd9,0x2e46bbf6
.long 0xbc008000,0x3bd9323e,0xbb64b61f,0x3aa73872,0x39a8b9a8,0xba2f3913,0x3aa7b872,0xbb0e378b
.long 0x3c00,0x3c000000,0xbc00,0xbc008000,0xbb64b61f,0xb4a53ba8,0x3bd9323e,0x2e46bbf6
.long 0x39a8b9a8,0xbaa7b872,0xb61f3b64,0x3bd9323e,0x361f3b64,0x3a2fb913,0xbaa7b872,0xb4a53ba8
.long 0xbc008000,0x361f3b64,0x39a8b9a8,0xbb64b61f,0x361fbb64,0xbbf62e46,0x38723aa7,0x378bbb0e
.long 0x39a839a8,0x323ebbd9,0xbb64361f,0x3aa73872,0xbb64361f,0x3b0e378b,0xb23ebbd9,0xb9133a2f
.long 0xbc00,0xb9a839a8,0x3c000000,0xb9a8b9a8,0x3b64361f,0xb78bbb0e,0xb23e3bd9,0x3a2fb913
.long 0xb9a839a8,0x3bd9b23e,0xbb64b61f,0x38723aa7,0xb61fbb64,0xae463bf6,0x3872baa7,0xbb0e378b
.long 0x3c000000,0xbb64b61f,0x39a839a8,0xb61fbb64,0xb61f3b64,0x3913ba2f,0xbaa73872,0x3ba8b4a5
.long 0xb9a8b9a8,0x38723aa7,0xb61fbb64,0x323e3bd9,0x3b64b61f,0xbba834a5,0x3bd9b23e,0xbbf62e46
.long 0x3c00,0x3c000000,0xbc00,0xbc008000,0xbc008000,0x2e463bf6,0x3bd9b23e,0xb4a5bba8
.long 0xbc00,0xbbd9323e,0x361f3b64,0x3aa7b872,0x3c000000,0xb4a5bba8,0xbaa73872,0x3a2f3913
.long 0x3c00,0x3b64b61f,0xb9a8b9a8,0xb61f3b64,0xbc008000,0x378b3b0e,0x3872baa7,0xbbf6ae46
.long 0xbc00,0xbaa73872,0x3b64361f,0xb23ebbd9,0x3c000000,0xb913ba2f,0xb23e3bd9,0x3b0eb78b
.long 0x3c00,0x39a8b9a8,0xbc008000,0x39a839a8,0xbc008000,0x3a2f3913,0xb23ebbd9,0xb78b3b0e
.long 0xbc00,0xb8723aa7,0x3b64b61f,0xbbd9b23e,0x3c000000,0xbb0eb78b,0x38723aa7,0xae46bbf6
.long 0x3c00,0x361fbb64,0xb9a839a8,0x3b64b61f,0xbc008000,0x3ba834a5,0xbaa7b872,0x39133a2f
.long 0xbc00,0xb23e3bd9,0x361fbb64,0xb8723aa7,0x3c000000,0xbbf6ae46,0x3bd9323e,0xbba8b4a5
.long 0x3c00,0x3c000000,0xbc00,0xbc008000,0xbb64361f,0x378b3b0e,0x3aa7b872,0xb913ba2f
.long 0xb9a8b9a8,0xb8723aa7,0x3b64361f,0x323ebbd9,0x361fbb64,0xbbf6ae46,0x323e3bd9,0x3b0eb78b
.long 0x3c000000,0xb61fbb64,0xb9a839a8,0x3b64361f,0x361f3b64,0x3913ba2f,0xbbd9b23e,0x34a53ba8
.long 0xb9a839a8,0x3bd9323e,0xb61fbb64,0xb8723aa7,0xbb64b61f,0x34a53ba8,0x3872baa7,0xbbf62e46
.long 0xbc00,0xb9a839a8,0x3c000000,0xb9a8b9a8,0x3b64b61f,0xbba8b4a5,0x38723aa7,0x2e46bbf6
.long 0x39a839a8,0xb23ebbd9,0xb61f3b64,0x3aa7b872,0xb61f3b64,0x3a2fb913,0xbbd9323e,0x3ba834a5
.long 0xbc008000,0x3b64361f,0xb9a8b9a8,0x361f3b64,0xb61fbb64,0x2e463bf6,0x323ebbd9,0xb78b3b0e
.long 0x39a8b9a8,0xbaa73872,0x3b64b61f,0xbbd9323e,0x3b64361f,0xbb0eb78b,0x3aa73872,0xba2fb913
.long 0x3c00,0x3c000000,0xbc00,0xbc008000,0xb9a839a8,0x3a2f3913,0x3872baa7,0xbb0eb78b
.long 0xbc008000,0x323e3bd9,0x3b64b61f,0xb872baa7,0xb9a8b9a8,0xb78b3b0e,0x3bd9323e,0xae46bbf6
.long 0xbc00,0xbb64361f,0x39a839a8,0x361fbb64,0x39a8b9a8,0xbba8b4a5,0x323e3bd9,0x3a2fb913
.long 0x3c000000,0xb872baa7,0xb61f3b64,0x3bd9b23e,0x39a839a8,0x2e46bbf6,0xbaa73872,0x3ba834a5
.long 0x3c00,0x39a8b9a8,0xbc008000,0x39a839a8,0xb9a839a8,0x3bf6ae46,0xbaa7b872,0x34a53ba8
.long 0xbc008000,0x3aa73872,0xb61fbb64,0xb23e3bd9,0xb9a8b9a8,0x34a53ba8,0x323ebbd9,0xb9133a2f
.long 0xbc00,0xb61f3b64,0x39a8b9a8,0xbb64361f,0x39a8b9a8,0xbb0e378b,0x3bd9b23e,0xbbf6ae46
.long 0x3c000000,0xbbd9b23e,0x3b64361f,0xbaa7b872,0x39a839a8,0xb913ba2f,0x38723aa7,0xb78bbb0e
.long 0x3c00,0x3c000000,0xbc00,0xbc008000,0xb61f3b64,0x3ba834a5,0x323ebbd9,0xbbf6ae46
.long 0xb9a839a8,0x3aa73872,0x361fbb64,0xbbd9b23e,0xbb64361f,0x39133a2f,0x3872baa7,0xbba8b4a5
.long 0xbc008000,0x361f3b64,0x39a8b9a8,0xbb64b61f,0xbb64b61f,0x2e463bf6,0x3aa7b872,0xbb0eb78b
.long 0xb9a8b9a8,0xb23e3bd9,0x3b64b61f,0xbaa7b872,0xb61fbb64,0xb78b3b0e,0x3bd9b23e,0xba2fb913
.long 0xbc00,0xb9a839a8,0x3c000000,0xb9a8b9a8,0x361fbb64,0xbb0e378b,0x3bd9323e,0xb913ba2f
.long 0x39a8b9a8,0xbbd9323e,0x3b64361f,0xb872baa7,0x3b64b61f,0xbbf6ae46,0x3aa73872,0xb78bbb0e
.long 0x3c000000,0xbb64b61f,0x39a839a8,0xb61fbb64,0x3b64361f,0xba2fb913,0x38723aa7,0xb4a5bba8
.long 0x39a839a8,0xb872baa7,0x361f3b64,0xb23ebbd9,0x361f3b64,0xb4a5bba8,0x323e3bd9,0xae46bbf6
.long 0x3c00,0xbc00,0x3c00,0xbc00,0x3c00,0xae46bbf6,0x323e3bd9,0xb4a5bba8
.long 0x3c00,0xb23ebbd9,0x361f3b64,0xb872baa7,0x3c00,0xb4a5bba8,0x38723aa7,0xba2fb913
.long 0x3c00,0xb61fbb64,0x39a839a8,0xbb64b61f,0x3c00,0xb78bbb0e,0x3aa73872,0xbbf6ae46
.long 0x3c00,0xb872baa7,0x3b64361f,0xbbd9323e,0x3c00,0xb913ba2f,0x3bd9323e,0xbb0e378b
.long 0x3c00,0xb9a8b9a8,0x3c000000,0xb9a839a8,0x3c00,0xba2fb913,0x3bd9b23e,0xb78b3b0e
.long 0x3c00,0xbaa7b872,0x3b64b61f,0xb23e3bd9,0x3c00,0xbb0eb78b,0x3aa7b872,0x2e463bf6
.long 0x3c00,0xbb64b61f,0x39a8b9a8,0x361f3b64,0x3c00,0xbba8b4a5,0x3872baa7,0x39133a2f
.long 0x3c00,0xbbd9b23e,0x361fbb64,0x3aa73872,0x3c00,0xbbf6ae46,0x323ebbd9,0x3ba834a5
.long 0x3c00,0xbc00,0x3c00,0xbc00,0x361f3b64,0xb78bbb0e,0x38723aa7,0xb913ba2f
.long 0x39a839a8,0xbaa7b872,0x3b64361f,0xbbd9b23e,0x3b64361f,0xbbf6ae46,0x3bd9b23e,0xbb0e378b
.long 0x3c000000,0xbb64361f,0x39a8b9a8,0xb61f3b64,0x3b64b61f,0xb9133a2f,0x323ebbd9,0x34a53ba8
.long 0x39a8b9a8,0xb23e3bd9,0xb61fbb64,0x3aa73872,0x361fbb64,0x34a53ba8,0xbaa7b872,0x3bf6ae46
.long 0xbc00,0x39a839a8,0xbc008000,0x39a8b9a8,0xb61fbb64,0x3ba834a5,0xbaa73872,0x2e46bbf6
.long 0xb9a8b9a8,0x3bd9b23e,0xb61f3b64,0xb872baa7,0xbb64b61f,0x3a2fb913,0x323e3bd9,0xbba8b4a5
.long 0xbc008000,0x361fbb64,0x39a839a8,0xbb64361f,0xbb64361f,0xae46bbf6,0x3bd9323e,0xb78b3b0e
.long 0xb9a839a8,0xb872baa7,0x3b64b61f,0x323e3bd9,0xb61f3b64,0xbb0eb78b,0x3872baa7,0x3a2f3913
.long 0x3c00,0xbc00,0x3c00,0xbc00,0x39a839a8,0xba2fb913,0x3aa73872,0xbb0eb78b
.long 0x3c000000,0xbbd9323e,0x3b64b61f,0xbaa73872,0x39a8b9a8,0xb78b3b0e,0x323ebbd9,0x2e463bf6
.long 0xbc00,0x361f3b64,0xb9a8b9a8,0x3b64361f,0xb9a8b9a8,0x3ba834a5,0xbbd9323e,0x3a2fb913
.long 0xbc008000,0x3aa7b872,0xb61f3b64,0xb23ebbd9,0xb9a839a8,0x2e46bbf6,0x38723aa7,0xbba8b4a5
.long 0x3c00,0xb9a8b9a8,0x3c000000,0xb9a839a8,0x39a839a8,0xbbf62e46,0x3872baa7,0x34a53ba8
.long 0x3c000000,0xb8723aa7,0xb61fbb64,0x3bd9323e,0x39a8b9a8,0x34a53ba8,0xbbd9b23e,0x3913ba2f
.long 0xbc00,0x3b64361f,0xb9a839a8,0xb61fbb64,0xb9a8b9a8,0x3b0eb78b,0x323e3bd9,0xbbf6ae46
.long 0xbc008000,0x323ebbd9,0x3b64361f,0xb8723aa7,0xb9a839a8,0xb913ba2f,0x3aa7b872,0x378b3b0e
.long 0x3c00,0xbc00,0x3c00,0xbc00,0x3b64361f,0xbba8b4a5,0x3bd9323e,0xbbf6ae46
.long 0x39a8b9a8,0xb8723aa7,0x361fbb64,0xb23e3bd9,0xb61fbb64,0x39133a2f,0xbaa7b872,0x3ba834a5
.long 0xbc008000,0x3b64b61f,0xb9a839a8,0x361fbb64,0xb61f3b64,0xae46bbf6,0x38723aa7,0xbb0eb78b
.long 0x39a839a8,0xbbd9b23e,0x3b64b61f,0xb8723aa7,0x3b64b61f,0xb78b3b0e,0xb23ebbd9,0x3a2f3913
.long 0xbc00,0x39a839a8,0xbc008000,0x39a8b9a8,0xbb64b61f,0x3b0eb78b,0xb23e3bd9,0xb913ba2f
.long 0xb9a839a8,0xb23ebbd9,0x3b64361f,0xbaa73872,0x361f3b64,0xbbf6ae46,0x3872baa7,0x378b3b0e
.long 0x3c000000,0xb61f3b64,0xb9a8b9a8,0x3b64b61f,0x361fbb64,0x3a2f3913,0xbaa73872,0xb4a5bba8
.long 0xb9a8b9a8,0x3aa7b872,0x361f3b64,0xbbd9323e,0xbb64361f,0xb4a5bba8,0x3bd9b23e,0x2e463bf6
.long 0x3c00,0xbc00,0x3c00,0xbc00,0x3c000000,0xbbf62e46,0x3bd9b23e,0xbba834a5
.long 0xbc00,0x323e3bd9,0xb61fbb64,0x38723aa7,0xbc008000,0x3ba8b4a5,0xbaa73872,0x3913ba2f
.long 0x3c00,0xb61fbb64,0x39a839a8,0xbb64b61f,0x3c000000,0xbb0e378b,0x3872baa7,0xae463bf6
.long 0xbc00,0x38723aa7,0xbb64b61f,0x3bd9b23e,0xbc008000,0x3a2fb913,0xb23e3bd9,0xb78bbb0e
.long 0x3c00,0xb9a8b9a8,0x3c000000,0xb9a839a8,0x3c000000,0xb9133a2f,0xb23ebbd9,0x3b0e378b
.long 0xbc00,0x3aa73872,0xbb64361f,0x323ebbd9,0xbc008000,0x378bbb0e,0x38723aa7,0xbbf62e46
.long 0x3c00,0xbb64b61f,0x39a8b9a8,0x361f3b64,0x3c000000,0xb4a53ba8,0xbaa7b872,0x3a2fb913
.long 0xbc00,0x3bd9323e,0xb61f3b64,0xbaa7b872,0xbc008000,0x2e46bbf6,0x3bd9323e,0xb4a53ba8
.long 0x3c00,0xbc00,0x3c00,0xbc00,0x3b64b61f,0xbb0e378b,0x3aa7b872,0xba2f3913
.long 0xb9a8b9a8,0x3aa73872,0xbb64b61f,0x3bd9323e,0xb61f3b64,0x2e46bbf6,0x323e3bd9,0xb78bbb0e
.long 0x3c000000,0xbb64361f,0x39a8b9a8,0xb61f3b64,0xb61fbb64,0x3a2f3913,0xbbd9b23e,0x3ba8b4a5
.long 0xb9a839a8,0x323ebbd9,0x361f3b64,0xbaa7b872,0x3b64361f,0xbba834a5,0x3872baa7,0x2e463bf6
.long 0xbc00,0x39a839a8,0xbc008000,0x39a8b9a8,0xbb64361f,0x34a5bba8,0x38723aa7,0xbbf6ae46
.long 0x39a839a8,0xbbd9323e,0x361fbb64,0x38723aa7,0x361fbb64,0x39133a2f,0xbbd9323e,0x34a5bba8
.long 0xbc008000,0x361fbb64,0x39a839a8,0xbb64361f,0x361f3b64,0xbbf62e46,0x323ebbd9,0x3b0e378b
.long 0x39a8b9a8,0x38723aa7,0xbb64361f,0xb23ebbd9,0xbb64b61f,0x378bbb0e,0x3aa73872,0xb9133a2f
.long 0x3c00,0xbc00,0x3c00,0xbc00,0x39a8b9a8,0xb9133a2f,0x3872baa7,0xb78b3b0e
.long 0xbc008000,0x3bd9b23e,0xbb64361f,0x3aa7b872,0x39a839a8,0xbb0eb78b,0x3bd9323e,0xbbf62e46
.long 0xbc00,0x361f3b64,0xb9a8b9a8,0x3b64361f,0xb9a839a8,0x34a5bba8,0x323e3bd9,0xb913ba2f
.long 0x3c000000,0xbaa73872,0x361fbb64,0x323e3bd9,0xb9a8b9a8,0x3bf62e46,0xbaa73872,0x34a5bba8
.long 0x3c00,0xb9a8b9a8,0x3c000000,0xb9a839a8,0x39a8b9a8,0x2e463bf6,0xbaa7b872,0x3ba8b4a5
.long 0xbc008000,0x3872baa7,0x361f3b64,0xbbd9b23e,0x39a839a8,0xbba834a5,0x323ebbd9,0x3a2f3913
.long 0xbc00,0x3b64361f,0xb9a839a8,0xb61fbb64,0xb9a839a8,0xb78bbb0e,0x3bd9b23e,0xae463bf6
.long 0x3c000000,0xb23e3bd9,0xbb64b61f,0x3872baa7,0xb9a8b9a8,0x3a2fb913,0x38723aa7,0xbb0e378b
.long 0x3c00,0xbc00,0x3c00,0xbc00,0x361fbb64,0xb4a53ba8,0x323ebbd9,0xae463bf6
.long 0xb9a839a8,0x3872baa7,0xb61f3b64,0x323ebbd9,0x3b64b61f,0xba2f3913,0x3872baa7,0xb4a53ba8
.long 0xbc008000,0x3b64b61f,0xb9a839a8,0x361fbb64,0x3b64361f,0xbbf62e46,0x3aa7b872,0xb78b3b0e
.long 0xb9a8b9a8,0x3bd9323e,0xbb64361f,0x3872baa7,0x361f3b64,0xbb0eb78b,0x3bd9b23e,0xb9133a2f
.long 0xbc00,0x39a839a8,0xbc008000,0x39a8b9a8,0xb61f3b64,0xb78bbb0e,0x3bd9323e,0xba2f3913
.long 0x39a8b9a8,0x323e3bd9,0xbb64b61f,0x3aa7b872,0xbb64361f,0x2e46bbf6,0x3aa73872,0xbb0e378b
.long 0x3c000000,0xb61f3b64,0xb9a8b9a8,0x3b64b61f,0xbb64b61f,0x3913ba2f,0x38723aa7,0xbba834a5
.long 0x39a839a8,0xbaa73872,0xb61fbb64,0x3bd9b23e,0xb61fbb64,0x3ba8b4a5,0x323e3bd9,0xbbf62e46
.long 0x3c00,0xbc00,0x3c00,0xbc00,0xbc00,0x2e463bf6,0xb23ebbd9,0x34a53ba8
.long 0x3c00,0xb23ebbd9,0x361f3b64,0xb872baa7,0xbc00,0x34a53ba8,0xb872baa7,0x3a2f3913
.long 0x3c00,0xb61fbb64,0x39a839a8,0xbb64b61f,0xbc00,0x378b3b0e,0xbaa7b872,0x3bf62e46
.long 0x3c00,0xb872baa7,0x3b64361f,0xbbd9323e,0xbc00,0x39133a2f,0xbbd9b23e,0x3b0eb78b
.long 0x3c00,0xb9a8b9a8,0x3c000000,0xb9a839a8,0xbc00,0x3a2f3913,0xbbd9323e,0x378bbb0e
.long 0x3c00,0xbaa7b872,0x3b64b61f,0xb23e3bd9,0xbc00,0x3b0e378b,0xbaa73872,0xae46bbf6
.long 0x3c00,0xbb64b61f,0x39a8b9a8,0x361f3b64,0xbc00,0x3ba834a5,0xb8723aa7,0xb913ba2f
.long 0x3c00,0xbbd9b23e,0x361fbb64,0x3aa73872,0xbc00,0x3bf62e46,0xb23e3bd9,0xbba8b4a5
.long 0x3c00,0xbc00,0x3c00,0xbc00,0xb61fbb64,0x378b3b0e,0xb872baa7,0x39133a2f
.long 0x39a839a8,0xbaa7b872,0x3b64361f,0xbbd9b23e,0xbb64b61f,0x3bf62e46,0xbbd9323e,0x3b0eb78b
.long 0x3c000000,0xbb64361f,0x39a8b9a8,0xb61f3b64,0xbb64361f,0x3913ba2f,0xb23e3bd9,0xb4a5bba8
.long 0x39a8b9a8,0xb23e3bd9,0xb61fbb64,0x3aa73872,0xb61f3b64,0xb4a5bba8,0x3aa73872,0xbbf62e46
.long 0xbc00,0x39a839a8,0xbc008000,0x39a8b9a8,0x361f3b64,0xbba8b4a5,0x3aa7b872,0xae463bf6
.long 0xb9a8b9a8,0x3bd9b23e,0xb61f3b64,0xb872baa7,0x3b64361f,0xba2f3913,0xb23ebbd9,0x3ba834a5
.long 0xbc008000,0x361fbb64,0x39a839a8,0xbb64361f,0x3b64b61f,0x2e463bf6,0xbbd9b23e,0x378bbb0e
.long 0xb9a839a8,0xb872baa7,0x3b64b61f,0x323e3bd9,0x361fbb64,0x3b0e378b,0xb8723aa7,0xba2fb913
.long 0x3c00,0xbc00,0x3c00,0xbc00,0xb9a8b9a8,0x3a2f3913,0xbaa7b872,0x3b0e378b
.long 0x3c000000,0xbbd9323e,0x3b64b61f,0xbaa73872,0xb9a839a8,0x378bbb0e,0xb23e3bd9,0xae46bbf6
.long 0xbc00,0x361f3b64,0xb9a8b9a8,0x3b64361f,0x39a839a8,0xbba8b4a5,0x3bd9b23e,0xba2f3913
.long 0xbc008000,0x3aa7b872,0xb61f3b64,0xb23ebbd9,0x39a8b9a8,0xae463bf6,0xb872baa7,0x3ba834a5
.long 0x3c00,0xb9a8b9a8,0x3c000000,0xb9a839a8,0xb9a8b9a8,0x3bf6ae46,0xb8723aa7,0xb4a5bba8
.long 0x3c000000,0xb8723aa7,0xb61fbb64,0x3bd9323e,0xb9a839a8,0xb4a5bba8,0x3bd9323e,0xb9133a2f
.long 0xbc00,0x3b64361f,0xb9a839a8,0xb61fbb64,0x39a839a8,0xbb0e378b,0xb23ebbd9,0x3bf62e46
.long 0xbc008000,0x323ebbd9,0x3b64361f,0xb8723aa7,0x39a8b9a8,0x39133a2f,0xbaa73872,0xb78bbb0e
.long 0x3c00,0xbc00,0x3c00,0xbc00,0xbb64b61f,0x3ba834a5,0xbbd9b23e,0x3bf62e46
.long 0x39a8b9a8,0xb8723aa7,0x361fbb64,0xb23e3bd9,0x361f3b64,0xb913ba2f,0x3aa73872,0xbba8b4a5
.long 0xbc008000,0x3b64b61f,0xb9a839a8,0x361fbb64,0x361fbb64,0x2e463bf6,0xb872baa7,0x3b0e378b
.long 0x39a839a8,0xbbd9b23e,0x3b64b61f,0xb8723aa7,0xbb64361f,0x378bbb0e,0x323e3bd9,0xba2fb913
.long 0xbc00,0x39a839a8,0xbc008000,0x39a8b9a8,0x3b64361f,0xbb0e378b,0x323ebbd9,0x39133a2f
.long 0xb9a839a8,0xb23ebbd9,0x3b64361f,0xbaa73872,0xb61fbb64,0x3bf62e46,0xb8723aa7,0xb78bbb0e
.long 0x3c000000,0xb61f3b64,0xb9a8b9a8,0x3b64b61f,0xb61f3b64,0xba2fb913,0x3aa7b872,0x34a53ba8
.long 0xb9a8b9a8,0x3aa7b872,0x361f3b64,0xbbd9323e,0x3b64b61f,0x34a53ba8,0xbbd9323e,0xae46bbf6
.long 0x3c00,0xbc00,0x3c00,0xbc00,0xbc008000,0x3bf6ae46,0xbbd9323e,0x3ba8b4a5
.long 0xbc00,0x323e3bd9,0xb61fbb64,0x38723aa7,0x3c000000,0xbba834a5,0x3aa7b872,0xb9133a2f
.long 0x3c00,0xb61fbb64,0x39a839a8,0xbb64b61f,0xbc008000,0x3b0eb78b,0xb8723aa7,0x2e46bbf6
.long 0xbc00,0x38723aa7,0xbb64b61f,0x3bd9b23e,0x3c000000,0xba2f3913,0x323ebbd9,0x378b3b0e
.long 0x3c00,0xb9a8b9a8,0x3c000000,0xb9a839a8,0xbc008000,0x3913ba2f,0x323e3bd9,0xbb0eb78b
.long 0xbc00,0x3aa73872,0xbb64361f,0x323ebbd9,0x3c000000,0xb78b3b0e,0xb872baa7,0x3bf6ae46
.long 0x3c00,0xbb64b61f,0x39a8b9a8,0x361f3b64,0xbc008000,0x34a5bba8,0x3aa73872,0xba2f3913
.long 0xbc00,0x3bd9323e,0xb61f3b64,0xbaa7b872,0x3c000000,0xae463bf6,0xbbd9b23e,0x34a5bba8
.long 0x3c00,0xbc00,0x3c00,0xbc00,0xbb64361f,0x3b0eb78b,0xbaa73872,0x3a2fb913
.long 0xb9a8b9a8,0x3aa73872,0xbb64b61f,0x3bd9323e,0x361fbb64,0xae463bf6,0xb23ebbd9,0x378b3b0e
.long 0x3c000000,0xbb64361f,0x39a8b9a8,0xb61f3b64,0x361f3b64,0xba2fb913,0x3bd9323e,0xbba834a5
.long 0xb9a839a8,0x323ebbd9,0x361f3b64,0xbaa7b872,0xbb64b61f,0x3ba8b4a5,0xb8723aa7,0xae46bbf6
.long 0xbc00,0x39a839a8,0xbc008000,0x39a8b9a8,0x3b64b61f,0xb4a53ba8,0xb872baa7,0x3bf62e46
.long 0x39a839a8,0xbbd9323e,0x361fbb64,0x38723aa7,0xb61f3b64,0xb913ba2f,0x3bd9b23e,0xb4a53ba8
.long 0xbc008000,0x361fbb64,0x39a839a8,0xbb64361f,0xb61fbb64,0x3bf6ae46,0xb23e3bd9,0xbb0eb78b
.long 0x39a8b9a8,0x38723aa7,0xbb64361f,0xb23ebbd9,0x3b64361f,0xb78b3b0e,0xbaa7b872,0x3913ba2f
.long 0x3c00,0xbc00,0x3c00,0xbc00,0xb9a839a8,0x3913ba2f,0xb8723aa7,0x378bbb0e
.long 0xbc008000,0x3bd9b23e,0xbb64361f,0x3aa7b872,0xb9a8b9a8,0x3b0e378b,0xbbd9b23e,0x3bf6ae46
.long 0xbc00,0x361f3b64,0xb9a8b9a8,0x3b64361f,0x39a8b9a8,0xb4a53ba8,0xb23ebbd9,0x39133a2f
.long 0x3c000000,0xbaa73872,0x361fbb64,0x323e3bd9,0x39a839a8,0xbbf6ae46,0x3aa7b872,0xb4a53ba8
.long 0x3c00,0xb9a8b9a8,0x3c000000,0xb9a839a8,0xb9a839a8,0xae46bbf6,0x3aa73872,0xbba834a5
.long 0xbc008000,0x3872baa7,0x361f3b64,0xbbd9b23e,0xb9a8b9a8,0x3ba8b4a5,0xb23e3bd9,0xba2fb913
.long 0xbc00,0x3b64361f,0xb9a839a8,0xb61fbb64,0x39a8b9a8,0x378b3b0e,0xbbd9323e,0x2e46bbf6
.long 0x3c000000,0xb23e3bd9,0xbb64b61f,0x3872baa7,0x39a839a8,0xba2f3913,0xb872baa7,0x3b0eb78b
.long 0x3c00,0xbc00,0x3c00,0xbc00,0xb61f3b64,0x34a5bba8,0xb23e3bd9,0x2e46bbf6
.long 0xb9a839a8,0x3872baa7,0xb61f3b64,0x323ebbd9,0xbb64361f,0x3a2fb913,0xb8723aa7,0x34a5bba8
.long 0xbc008000,0x3b64b61f,0xb9a839a8,0x361fbb64,0xbb64b61f,0x3bf6ae46,0xbaa73872,0x378bbb0e
.long 0xb9a8b9a8,0x3bd9323e,0xbb64361f,0x3872baa7,0xb61fbb64,0x3b0e378b,0xbbd9323e,0x3913ba2f
.long 0xbc00,0x39a839a8,0xbc008000,0x39a8b9a8,0x361fbb64,0x378b3b0e,0xbbd9b23e,0x3a2fb913
.long 0x39a8b9a8,0x323e3bd9,0xbb64b61f,0x3aa7b872,0x3b64b61f,0xae463bf6,0xbaa7b872,0x3b0eb78b
.long 0x3c000000,0xb61f3b64,0xb9a8b9a8,0x3b64b61f,0x3b64361f,0xb9133a2f,0xb872baa7,0x3ba8b4a5
.long 0x39a839a8,0xbaa73872,0xb61fbb64,0x3bd9b23e,0x361f3b64,0xbba834a5,0xb23ebbd9,0x3bf6ae46
.long 0x3c00,0xbc008000,0xbc00,0x3c000000,0x3c00,0xbbf62e46,0xb23ebbd9,0x3ba8b4a5
.long 0x3c00,0xbbd9323e,0xb61fbb64,0x3aa7b872,0x3c00,0xbba834a5,0xb872baa7,0x3913ba2f
.long 0x3c00,0xbb64361f,0xb9a8b9a8,0x361fbb64,0x3c00,0xbb0e378b,0xbaa7b872,0x2e46bbf6
.long 0x3c00,0xbaa73872,0xbb64b61f,0xb23ebbd9,0x3c00,0xba2f3913,0xbbd9b23e,0xb78bbb0e
.long 0x3c00,0xb9a839a8,0xbc008000,0xb9a8b9a8,0x3c00,0xb9133a2f,0xbbd9323e,0xbb0eb78b
.long 0x3c00,0xb8723aa7,0xbb64361f,0xbbd9b23e,0x3c00,0xb78b3b0e,0xbaa73872,0xbbf62e46
.long 0x3c00,0xb61f3b64,0xb9a839a8,0xbb64361f,0x3c00,0xb4a53ba8,0xb8723aa7,0xba2f3913
.long 0x3c00,0xb23e3bd9,0xb61f3b64,0xb8723aa7,0x3c00,0xae463bf6,0xb23e3bd9,0xb4a53ba8
.long 0x3c00,0xbc008000,0xbc00,0x3c000000,0x361f3b64,0xbb0e378b,0xb872baa7,0x3a2fb913
.long 0x39a839a8,0xb8723aa7,0xbb64b61f,0x323ebbd9,0x3b64361f,0xae463bf6,0xbbd9323e,0xb78bbb0e
.long 0x3c000000,0x361f3b64,0xb9a839a8,0xbb64b61f,0x3b64b61f,0x3a2f3913,0xb23e3bd9,0xbba834a5
.long 0x39a8b9a8,0x3bd9323e,0x361f3b64,0xb8723aa7,0x361fbb64,0x3ba8b4a5,0x3aa73872,0x2e463bf6
.long 0xbc00,0x39a8b9a8,0x3c000000,0x39a839a8,0xb61fbb64,0x34a5bba8,0x3aa7b872,0x3bf62e46
.long 0xb9a8b9a8,0xb23ebbd9,0x361fbb64,0x3aa7b872,0xbb64b61f,0xb913ba2f,0xb23ebbd9,0x34a5bba8
.long 0xbc008000,0xbb64b61f,0xb9a8b9a8,0xb61fbb64,0xbb64361f,0xbbf62e46,0xbbd9b23e,0xbb0eb78b
.long 0xb9a839a8,0xbaa73872,0xbb64361f,0xbbd9323e,0xb61f3b64,0xb78b3b0e,0xb8723aa7,0xb9133a2f
.long 0x3c00,0xbc008000,0xbc00,0x3c000000,0x39a839a8,0xb9133a2f,0xbaa7b872,0x378bbb0e
.long 0x3c000000,0x323e3bd9,0xbb64361f,0xb872baa7,0x39a8b9a8,0x3b0e378b,0xb23e3bd9,0xbbf62e46
.long 0xbc00,0x3b64b61f,0x39a839a8,0xb61f3b64,0xb9a8b9a8,0x34a5bba8,0x3bd9b23e,0x39133a2f
.long 0xbc008000,0xb872baa7,0x361fbb64,0x3bd9b23e,0xb9a839a8,0xbbf6ae46,0xb872baa7,0x34a5bba8
.long 0x3c00,0xb9a839a8,0xbc008000,0xb9a8b9a8,0x39a839a8,0x2e463bf6,0xb8723aa7,0xbba834a5
.long 0x3c000000,0x3aa73872,0x361f3b64,0xb23e3bd9,0x39a8b9a8,0x3ba8b4a5,0x3bd9323e,0x3a2f3913
.long 0xbc00,0x361fbb64,0x39a8b9a8,0x3b64b61f,0xb9a8b9a8,0xb78bbb0e,0xb23ebbd9,0x2e46bbf6
.long 0xbc008000,0xbbd9b23e,0xbb64b61f,0xbaa7b872,0xb9a839a8,0xba2f3913,0xbaa73872,0xbb0e378b
.long 0x3c00,0xbc008000,0xbc00,0x3c000000,0x3b64361f,0xb4a53ba8,0xbbd9b23e,0x2e46bbf6
.long 0x39a8b9a8,0x3aa73872,0xb61f3b64,0xbbd9b23e,0xb61fbb64,0x3a2fb913,0x3aa73872,0xb4a53ba8
.long 0xbc008000,0xb61fbb64,0x39a8b9a8,0x3b64361f,0xb61f3b64,0xbbf62e46,0xb872baa7,0x378bbb0e
.long 0x39a839a8,0xb23e3bd9,0xbb64361f,0xbaa7b872,0x3b64b61f,0x3b0e378b,0x323e3bd9,0xb9133a2f
.long 0xbc00,0x39a8b9a8,0x3c000000,0x39a839a8,0xbb64b61f,0xb78bbb0e,0x323ebbd9,0x3a2fb913
.long 0xb9a839a8,0xbbd9323e,0xbb64b61f,0xb872baa7,0x361f3b64,0xae463bf6,0xb8723aa7,0xbb0e378b
.long 0x3c000000,0x3b64361f,0x39a839a8,0x361f3b64,0x361fbb64,0x3913ba2f,0x3aa7b872,0x3ba8b4a5
.long 0xb9a8b9a8,0xb872baa7,0xb61fbb64,0xb23ebbd9,0xbb64361f,0xbba834a5,0xbbd9323e,0xbbf62e46
.long 0x3c00,0xbc008000,0xbc00,0x3c000000,0x3c000000,0x2e463bf6,0xbbd9323e,0xb4a5bba8
.long 0xbc00,0x3bd9b23e,0x361f3b64,0xbaa73872,0xbc008000,0xb4a5bba8,0x3aa7b872,0x3a2f3913
.long 0x3c00,0xbb64361f,0xb9a8b9a8,0x361fbb64,0x3c000000,0x378b3b0e,0xb8723aa7,0xbbf6ae46
.long 0xbc00,0x3aa7b872,0x3b64361f,0x323e3bd9,0xbc008000,0xb913ba2f,0x323ebbd9,0x3b0eb78b
.long 0x3c00,0xb9a839a8,0xbc008000,0xb9a8b9a8,0x3c000000,0x3a2f3913,0x323e3bd9,0xb78b3b0e
.long 0xbc00,0x3872baa7,0x3b64b61f,0x3bd9323e,0xbc008000,0xbb0eb78b,0xb872baa7,0xae46bbf6
.long 0x3c00,0xb61f3b64,0xb9a839a8,0xbb64361f,0x3c000000,0x3ba834a5,0x3aa73872,0x39133a2f
.long 0xbc00,0x323ebbd9,0x361fbb64,0x3872baa7,0xbc008000,0xbbf6ae46,0xbbd9b23e,0xbba8b4a5
.long 0x3c00,0xbc008000,0xbc00,0x3c000000,0x3b64b61f,0x378b3b0e,0xbaa73872,0xb913ba2f
.long 0xb9a8b9a8,0x3872baa7,0x3b64361f,0xb23e3bd9,0xb61f3b64,0xbbf6ae46,0xb23ebbd9,0x3b0eb78b
.long 0x3c000000,0x361f3b64,0xb9a839a8,0xbb64b61f,0xb61fbb64,0x3913ba2f,0x3bd9323e,0x34a53ba8
.long 0xb9a839a8,0xbbd9b23e,0xb61fbb64,0x3872baa7,0x3b64361f,0x34a53ba8,0xb8723aa7,0xbbf62e46
.long 0xbc00,0x39a8b9a8,0x3c000000,0x39a839a8,0xbb64361f,0xbba8b4a5,0xb872baa7,0x2e46bbf6
.long 0x39a839a8,0x323e3bd9,0xb61f3b64,0xbaa73872,0x361fbb64,0x3a2fb913,0x3bd9b23e,0x3ba834a5
.long 0xbc008000,0xbb64b61f,0xb9a8b9a8,0xb61fbb64,0x361f3b64,0x2e463bf6,0xb23e3bd9,0xb78b3b0e
.long 0x39a8b9a8,0x3aa7b872,0x3b64b61f,0x3bd9b23e,0xbb64b61f,0xbb0eb78b,0xbaa7b872,0xba2fb913
.long 0x3c00,0xbc008000,0xbc00,0x3c000000,0x39a8b9a8,0x3a2f3913,0xb8723aa7,0xbb0eb78b
.long 0xbc008000,0xb23ebbd9,0x3b64b61f,0x38723aa7,0x39a839a8,0xb78b3b0e,0xbbd9b23e,0xae46bbf6
.long 0xbc00,0x3b64b61f,0x39a839a8,0xb61f3b64,0xb9a839a8,0xbba8b4a5,0xb23ebbd9,0x3a2fb913
.long 0x3c000000,0x38723aa7,0xb61f3b64,0xbbd9323e,0xb9a8b9a8,0x2e46bbf6,0x3aa7b872,0x3ba834a5
.long 0x3c00,0xb9a839a8,0xbc008000,0xb9a8b9a8,0x39a8b9a8,0x3bf6ae46,0x3aa73872,0x34a53ba8
.long 0xbc008000,0xbaa7b872,0xb61fbb64,0x323ebbd9,0x39a839a8,0x34a53ba8,0xb23e3bd9,0xb9133a2f
.long 0xbc00,0x361fbb64,0x39a8b9a8,0x3b64b61f,0xb9a839a8,0xbb0e378b,0xbbd9323e,0xbbf6ae46
.long 0x3c000000,0x3bd9323e,0x3b64361f,0x3aa73872,0xb9a8b9a8,0xb913ba2f,0xb872baa7,0xb78bbb0e
.long 0x3c00,0xbc008000,0xbc00,0x3c000000,0x361fbb64,0x3ba834a5,0xb23e3bd9,0xbbf6ae46
.long 0xb9a839a8,0xbaa7b872,0x361fbb64,0x3bd9323e,0x3b64b61f,0x39133a2f,0xb8723aa7,0xbba8b4a5
.long 0xbc008000,0xb61fbb64,0x39a8b9a8,0x3b64361f,0x3b64361f,0x2e463bf6,0xbaa73872,0xbb0eb78b
.long 0xb9a8b9a8,0x323ebbd9,0x3b64b61f,0x3aa73872,0x361f3b64,0xb78b3b0e,0xbbd9323e,0xba2fb913
.long 0xbc00,0x39a8b9a8,0x3c000000,0x39a839a8,0xb61f3b64,0xbb0e378b,0xbbd9b23e,0xb913ba2f
.long 0x39a8b9a8,0x3bd9b23e,0x3b64361f,0x38723aa7,0xbb64361f,0xbbf6ae46,0xbaa7b872,0xb78bbb0e
.long 0x3c000000,0x3b64361f,0x39a839a8,0x361f3b64,0xbb64b61f,0xba2fb913,0xb872baa7,0xb4a5bba8
.long 0x39a839a8,0x38723aa7,0x361f3b64,0x323e3bd9,0xb61fbb64,0xb4a5bba8,0xb23ebbd9,0xae46bbf6
.long 0x3c00,0xbc008000,0xbc00,0x3c000000,0xbc00,0x3bf6ae46,0x323e3bd9,0xbba834a5
.long 0x3c00,0xbbd9323e,0xb61fbb64,0x3aa7b872,0xbc00,0x3ba8b4a5,0x38723aa7,0xb9133a2f
.long 0x3c00,0xbb64361f,0xb9a8b9a8,0x361fbb64,0xbc00,0x3b0eb78b,0x3aa73872,0xae463bf6
.long 0x3c00,0xbaa73872,0xbb64b61f,0xb23ebbd9,0xbc00,0x3a2fb913,0x3bd9323e,0x378b3b0e
.long 0x3c00,0xb9a839a8,0xbc008000,0xb9a8b9a8,0xbc00,0x3913ba2f,0x3bd9b23e,0x3b0e378b
.long 0x3c00,0xb8723aa7,0xbb64361f,0xbbd9b23e,0xbc00,0x378bbb0e,0x3aa7b872,0x3bf6ae46
.long 0x3c00,0xb61f3b64,0xb9a839a8,0xbb64361f,0xbc00,0x34a5bba8,0x3872baa7,0x3a2fb913
.long 0x3c00,0xb23e3bd9,0xb61f3b64,0xb8723aa7,0xbc00,0x2e46bbf6,0x323ebbd9,0x34a5bba8
.long 0x3c00,0xbc008000,0xbc00,0x3c000000,0xb61fbb64,0x3b0eb78b,0x38723aa7,0xba2f3913
.long 0x39a839a8,0xb8723aa7,0xbb64b61f,0x323ebbd9,0xbb64b61f,0x2e46bbf6,0x3bd9b23e,0x378b3b0e
.long 0x3c000000,0x361f3b64,0xb9a839a8,0xbb64b61f,0xbb64361f,0xba2fb913,0x323ebbd9,0x3ba8b4a5
.long 0x39a8b9a8,0x3bd9323e,0x361f3b64,0xb8723aa7,0xb61f3b64,0xbba834a5,0xbaa7b872,0xae46bbf6
.long 0xbc00,0x39a8b9a8,0x3c000000,0x39a839a8,0x361f3b64,0xb4a53ba8,0xbaa73872,0xbbf6ae46
.long 0xb9a8b9a8,0xb23ebbd9,0x361fbb64,0x3aa7b872,0x3b64361f,0x39133a2f,0x323e3bd9,0xb4a53ba8
.long 0xbc008000,0xbb64b61f,0xb9a8b9a8,0xb61fbb64,0x3b64b61f,0x3bf6ae46,0x3bd9323e,0x3b0e378b
.long 0xb9a839a8,0xbaa73872,0xbb64361f,0xbbd9323e,0x361fbb64,0x378bbb0e,0x3872baa7,0x3913ba2f
.long 0x3c00,0xbc008000,0xbc00,0x3c000000,0xb9a8b9a8,0x3913ba2f,0x3aa73872,0xb78b3b0e
.long 0x3c000000,0x323e3bd9,0xbb64361f,0xb872baa7,0xb9a839a8,0xbb0eb78b,0x323ebbd9,0x3bf6ae46
.long 0xbc00,0x3b64b61f,0x39a839a8,0xb61f3b64,0x39a839a8,0xb4a53ba8,0xbbd9323e,0xb913ba2f
.long 0xbc008000,0xb872baa7,0x361fbb64,0x3bd9b23e,0x39a8b9a8,0x3bf62e46,0x38723aa7,0xb4a53ba8
.long 0x3c00,0xb9a839a8,0xbc008000,0xb9a8b9a8,0xb9a8b9a8,0xae46bbf6,0x3872baa7,0x3ba8b4a5
.long 0x3c000000,0x3aa73872,0x361f3b64,0xb23e3bd9,0xb9a839a8,0xbba834a5,0xbbd9b23e,0xba2fb913
.long 0xbc00,0x361fbb64,0x39a8b9a8,0x3b64b61f,0x39a839a8,0x378b3b0e,0x323e3bd9,0xae463bf6
.long 0xbc008000,0xbbd9b23e,0xbb64b61f,0xbaa7b872,0x39a8b9a8,0x3a2fb913,0x3aa7b872,0x3b0eb78b
.long 0x3c00,0xbc008000,0xbc00,0x3c000000,0xbb64b61f,0x34a5bba8,0x3bd9323e,0xae463bf6
.long 0x39a8b9a8,0x3aa73872,0xb61f3b64,0xbbd9b23e,0x361f3b64,0xba2f3913,0xbaa7b872,0x34a5bba8
.long 0xbc008000,0xb61fbb64,0x39a8b9a8,0x3b64361f,0x361fbb64,0x3bf6ae46,0x38723aa7,0xb78b3b0e
.long 0x39a839a8,0xb23e3bd9,0xbb64361f,0xbaa7b872,0xbb64361f,0xbb0eb78b,0xb23ebbd9,0x3913ba2f
.long 0xbc00,0x39a8b9a8,0x3c000000,0x39a839a8,0x3b64361f,0x378b3b0e,0xb23e3bd9,0xba2f3913
.long 0xb9a839a8,0xbbd9323e,0xbb64b61f,0xb872baa7,0xb61fbb64,0x2e46bbf6,0x3872baa7,0x3b0eb78b
.long 0x3c000000,0x3b64361f,0x39a839a8,0x361f3b64,0xb61f3b64,0xb9133a2f,0xbaa73872,0xbba834a5
.long 0xb9a8b9a8,0xb872baa7,0xb61fbb64,0xb23ebbd9,0x3b64b61f,0x3ba8b4a5,0x3bd9b23e,0x3bf6ae46
.long 0x3c00,0xbc008000,0xbc00,0x3c000000,0xbc008000,0xae46bbf6,0x3bd9b23e,0x34a53ba8
.long 0xbc00,0x3bd9b23e,0x361f3b64,0xbaa73872,0x3c000000,0x34a53ba8,0xbaa73872,0xba2fb913
.long 0x3c00,0xbb64361f,0xb9a8b9a8,0x361fbb64,0xbc008000,0xb78bbb0e,0x3872baa7,0x3bf62e46
.long 0xbc00,0x3aa7b872,0x3b64361f,0x323e3bd9,0x3c000000,0x39133a2f,0xb23e3bd9,0xbb0e378b
.long 0x3c00,0xb9a839a8,0xbc008000,0xb9a8b9a8,0xbc008000,0xba2fb913,0xb23ebbd9,0x378bbb0e
.long 0xbc00,0x3872baa7,0x3b64b61f,0x3bd9323e,0x3c000000,0x3b0e378b,0x38723aa7,0x2e463bf6
.long 0x3c00,0xb61f3b64,0xb9a839a8,0xbb64361f,0xbc008000,0xbba8b4a5,0xbaa7b872,0xb913ba2f
.long 0xbc00,0x323ebbd9,0x361fbb64,0x3872baa7,0x3c000000,0x3bf62e46,0x3bd9323e,0x3ba834a5
.long 0x3c00,0xbc008000,0xbc00,0x3c000000,0xbb64361f,0xb78bbb0e,0x3aa7b872,0x39133a2f
.long 0xb9a8b9a8,0x3872baa7,0x3b64361f,0xb23e3bd9,0x361fbb64,0x3bf62e46,0x323e3bd9,0xbb0e378b
.long 0x3c000000,0x361f3b64,0xb9a839a8,0xbb64b61f,0x361f3b64,0xb9133a2f,0xbbd9b23e,0xb4a5bba8
.long 0xb9a839a8,0xbbd9b23e,0xb61fbb64,0x3872baa7,0xbb64b61f,0xb4a5bba8,0x3872baa7,0x3bf6ae46
.long 0xbc00,0x39a8b9a8,0x3c000000,0x39a839a8,0x3b64b61f,0x3ba834a5,0x38723aa7,0xae463bf6
.long 0x39a839a8,0x323e3bd9,0xb61f3b64,0xbaa73872,0xb61f3b64,0xba2f3913,0xbbd9323e,0xbba8b4a5
.long 0xbc008000,0xbb64b61f,0xb9a8b9a8,0xb61fbb64,0xb61fbb64,0xae46bbf6,0x323ebbd9,0x378bbb0e
.long 0x39a8b9a8,0x3aa7b872,0x3b64b61f,0x3bd9b23e,0x3b64361f,0x3b0e378b,0x3aa73872,0x3a2f3913
.long 0x3c00,0xbc008000,0xbc00,0x3c000000,0xb9a839a8,0xba2fb913,0x3872baa7,0x3b0e378b
.long 0xbc008000,0xb23ebbd9,0x3b64b61f,0x38723aa7,0xb9a8b9a8,0x378bbb0e,0x3bd9323e,0x2e463bf6
.long 0xbc00,0x3b64b61f,0x39a839a8,0xb61f3b64,0x39a8b9a8,0x3ba834a5,0x323e3bd9,0xba2f3913
.long 0x3c000000,0x38723aa7,0xb61f3b64,0xbbd9323e,0x39a839a8,0xae463bf6,0xbaa73872,0xbba8b4a5
.long 0x3c00,0xb9a839a8,0xbc008000,0xb9a8b9a8,0xb9a839a8,0xbbf62e46,0xbaa7b872,0xb4a5bba8
.long 0xbc008000,0xbaa7b872,0xb61fbb64,0x323ebbd9,0xb9a8b9a8,0xb4a5bba8,0x323ebbd9,0x3913ba2f
.long 0xbc00,0x361fbb64,0x39a8b9a8,0x3b64b61f,0x39a8b9a8,0x3b0eb78b,0x3bd9b23e,0x3bf62e46
.long 0x3c000000,0x3bd9323e,0x3b64361f,0x3aa73872,0x39a839a8,0x39133a2f,0x38723aa7,0x378b3b0e
.long 0x3c00,0xbc008000,0xbc00,0x3c000000,0xb61f3b64,0xbba8b4a5,0x323ebbd9,0x3bf62e46
.long 0xb9a839a8,0xbaa7b872,0x361fbb64,0x3bd9323e,0xbb64361f,0xb913ba2f,0x3872baa7,0x3ba834a5
.long 0xbc008000,0xb61fbb64,0x39a8b9a8,0x3b64361f,0xbb64b61f,0xae46bbf6,0x3aa7b872,0x3b0e378b
.long 0xb9a8b9a8,0x323ebbd9,0x3b64b61f,0x3aa73872,0xb61fbb64,0x378bbb0e,0x3bd9b23e,0x3a2f3913
.long 0xbc00,0x39a8b9a8,0x3c000000,0x39a839a8,0x361fbb64,0x3b0eb78b,0x3bd9323e,0x39133a2f
.long 0x39a8b9a8,0x3bd9b23e,0x3b64361f,0x38723aa7,0x3b64b61f,0x3bf62e46,0x3aa73872,0x378b3b0e
.long 0x3c000000,0x3b64361f,0x39a839a8,0x361f3b64,0x3b64361f,0x3a2f3913,0x38723aa7,0x34a53ba8
.long 0x39a839a8,0x38723aa7,0x361f3b64,0x323e3bd9,0x361f3b64,0x34a53ba8,0x323e3bd9,0x2e463bf6
.long 0x3c00,0x3c00,0x3c00,0x3c00,0x3c008000,0x3c008000,0x3c008000,0x3c008000
.long 0x3c00,0xbc00,0x361f3b64,0xb61fbb64,0x3c008000,0xbc008000,0x3b64b61f,0xbb64361f
.long 0x3c00,0x3c00,0x39a839a8,0x39a839a8,0x3c008000,0x3c008000,0x39a8b9a8,0x39a8b9a8
.long 0x3c00,0xbc00,0x3b64361f,0xbb64b61f,0x3c008000,0xbc008000,0x361fbb64,0xb61f3b64
.long 0x3c00,0x3c00,0x3c000000,0x3c000000,0x3c008000,0x3c008000,0xbc00,0xbc00
.long 0x3c00,0xbc00,0x3b64b61f,0xbb64361f,0x3c008000,0xbc008000,0xb61fbb64,0x361f3b64
.long 0x3c00,0x3c00,0x39a8b9a8,0x39a8b9a8,0x3c008000,0x3c008000,0xb9a8b9a8,0xb9a8b9a8
.long 0x3c00,0xbc00,0x361fbb64,0xb61f3b64,0x3c008000,0xbc008000,0xbb64b61f,0x3b64361f
.long 0x3c00,0x3c00,0x3c00,0x3c00,0x3c008000,0x3c008000,0x3c008000,0x3c008000
.long 0x39a839a8,0xb9a8b9a8,0x3b64361f,0xbb64b61f,0x39a8b9a8,0xb9a839a8,0x361fbb64,0xb61f3b64
.long 0x3c000000,0x3c000000,0x39a8b9a8,0x39a8b9a8,0xbc00,0xbc00,0xb9a8b9a8,0xb9a8b9a8
.long 0x39a8b9a8,0xb9a839a8,0xb61fbb64,0x361f3b64,0xb9a8b9a8,0x39a839a8,0xbb64361f,0x3b64b61f
.long 0xbc00,0xbc00,0xbc008000,0xbc008000,0xbc008000,0xbc008000,0x80003c00,0x80003c00
.long 0xb9a8b9a8,0x39a839a8,0xb61f3b64,0x361fbb64,0xb9a839a8,0x39a8b9a8,0x3b64361f,0xbb64b61f
.long 0xbc008000,0xbc008000,0x39a839a8,0x39a839a8,0x80003c00,0x80003c00,0x39a8b9a8,0x39a8b9a8
.long 0xb9a839a8,0x39a8b9a8,0x3b64b61f,0xbb64361f,0x39a839a8,0xb9a8b9a8,0xb61fbb64,0x361f3b64
.long 0x3c00,0x3c00,0x3c00,0x3c00,0x3c008000,0x3c008000,0x3c008000,0x3c008000
.long 0x3c000000,0xbc008000,0x3b64b61f,0xbb64361f,0xbc00,0x80003c00,0xb61fbb64,0x361f3b64
.long 0xbc00,0xbc00,0xb9a8b9a8,0xb9a8b9a8,0xbc008000,0xbc008000,0xb9a839a8,0xb9a839a8
.long 0xbc008000,0x3c000000,0xb61f3b64,0x361fbb64,0x80003c00,0xbc00,0x3b64361f,0xbb64b61f
.long 0x3c00,0x3c00,0x3c000000,0x3c000000,0x3c008000,0x3c008000,0xbc00,0xbc00
.long 0x3c000000,0xbc008000,0xb61fbb64,0x361f3b64,0xbc00,0x80003c00,0xbb64361f,0x3b64b61f
.long 0xbc00,0xbc00,0xb9a839a8,0xb9a839a8,0xbc008000,0xbc008000,0x39a839a8,0x39a839a8
.long 0xbc008000,0x3c000000,0x3b64361f,0xbb64b61f,0x80003c00,0xbc00,0x361fbb64,0xb61f3b64
.long 0x3c00,0x3c00,0x3c00,0x3c00,0x3c008000,0x3c008000,0x3c008000,0x3c008000
.long 0x39a8b9a8,0xb9a839a8,0x361fbb64,0xb61f3b64,0xb9a8b9a8,0x39a839a8,0xbb64b61f,0x3b64361f
.long 0xbc008000,0xbc008000,0xb9a839a8,0xb9a839a8,0x80003c00,0x80003c00,0x39a839a8,0x39a839a8
.long 0x39a839a8,0xb9a8b9a8,0x3b64b61f,0xbb64361f,0x39a8b9a8,0xb9a839a8,0xb61fbb64,0x361f3b64
.long 0xbc00,0xbc00,0xbc008000,0xbc008000,0xbc008000,0xbc008000,0x80003c00,0x80003c00
.long 0xb9a839a8,0x39a8b9a8,0x3b64361f,0xbb64b61f,0x39a839a8,0xb9a8b9a8,0x361fbb64,0xb61f3b64
.long 0x3c000000,0x3c000000,0xb9a8b9a8,0xb9a8b9a8,0xbc00,0xbc00,0xb9a839a8,0xb9a839a8
.long 0xb9a8b9a8,0x39a839a8,0x361f3b64,0xb61fbb64,0xb9a839a8,0x39a8b9a8,0x3b64b61f,0xbb64361f
.long 0x3c00,0x3c00,0x3c00,0x3c00,0x3c008000,0x3c008000,0x3c008000,0x3c008000
.long 0x2a483bfe,0xaa48bbfe,0x395f39ed,0xb95fb9ed,0x3bfeaa48,0xbbfe2a48,0x39edb95f,0xb9ed395f
.long 0x2e463bf6,0x2e463bf6,0x3bf62e46,0x3bf62e46,0x3bf6ae46,0x3bf6ae46,0x2e46bbf6,0x2e46bbf6
.long 0x30b23bea,0xb0b2bbea,0x3a6db8c4,0xba6d38c4,0x3beab0b2,0xbbea30b2,0xb8c4ba6d,0x38c43a6d
.long 0x323e3bd9,0x323e3bd9,0x323ebbd9,0x323ebbd9,0x3bd9b23e,0x3bd9b23e,0xbbd9b23e,0xbbd9b23e
.long 0x33c63bc3,0xb3c6bbc3,0xb81dbadd,0x381d3add,0x3bc3b3c6,0xbbc333c6,0xbadd381d,0x3addb81d
.long 0x34a53ba8,0x34a53ba8,0xbba8b4a5,0xbba8b4a5,0x3ba8b4a5,0x3ba8b4a5,0xb4a53ba8,0xb4a53ba8
.long 0x35643b88,0xb564bb88,0xbb3b36d7,0x3b3bb6d7,0x3b88b564,0xbb883564,0x36d73b3b,0xb6d7bb3b
.long 0x3c00,0x3c00,0x3c00,0x3c00,0x3c008000,0x3c008000,0x3c008000,0x3c008000
.long 0x39ed395f,0xb9edb95f,0x3bfe2a48,0xbbfeaa48,0x395fb9ed,0xb95f39ed,0x2a48bbfe,0xaa483bfe
.long 0x3bf6ae46,0x3bf6ae46,0x2e46bbf6,0x2e46bbf6,0xae46bbf6,0xae46bbf6,0xbbf6ae46,0xbbf6ae46
.long 0x38c4ba6d,0xb8c43a6d,0xbbeab0b2,0x3bea30b2,0xba6db8c4,0x3a6d38c4,0xb0b23bea,0x30b2bbea
.long 0xb23ebbd9,0xb23ebbd9,0xb23e3bd9,0xb23e3bd9,0xbbd9323e,0xbbd9323e,0x3bd9323e,0x3bd9323e
.long 0xbaddb81d,0x3add381d,0x3bc333c6,0xbbc3b3c6,0xb81d3add,0x381dbadd,0x33c6bbc3,0xb3c63bc3
.long 0xbba834a5,0xbba834a5,0x34a5bba8,0x34a5bba8,0x34a53ba8,0x34a53ba8,0xbba8b4a5,0xbba8b4a5
.long 0xb6d73b3b,0x36d7bb3b,0xbb88b564,0x3b883564,0x3b3b36d7,0xbb3bb6d7,0xb5643b88,0x3564bb88
.long 0x3c00,0x3c00,0x3c00,0x3c00,0x3c008000,0x3c008000,0x3c008000,0x3c008000
.long 0x3bfeaa48,0xbbfe2a48,0x39edb95f,0xb9ed395f,0xaa48bbfe,0x2a483bfe,0xb95fb9ed,0x395f39ed
.long 0xae46bbf6,0xae46bbf6,0xbbf6ae46,0xbbf6ae46,0xbbf62e46,0xbbf62e46,0xae463bf6,0xae463bf6
.long 0xbbea30b2,0x3beab0b2,0x38c43a6d,0xb8c4ba6d,0x30b23bea,0xb0b2bbea,0x3a6db8c4,0xba6d38c4
.long 0x323e3bd9,0x323e3bd9,0x323ebbd9,0x323ebbd9,0x3bd9b23e,0x3bd9b23e,0xbbd9b23e,0xbbd9b23e
.long 0x3bc3b3c6,0xbbc333c6,0xbadd381d,0x3addb81d,0xb3c6bbc3,0x33c63bc3,0x381d3add,0xb81dbadd
.long 0xb4a5bba8,0xb4a5bba8,0x3ba834a5,0x3ba834a5,0xbba834a5,0xbba834a5,0x34a5bba8,0x34a5bba8
.long 0xbb883564,0x3b88b564,0xb6d7bb3b,0x36d73b3b,0x35643b88,0xb564bb88,0xbb3b36d7,0x3b3bb6d7
.long 0x3c00,0x3c00,0x3c00,0x3c00,0x3c008000,0x3c008000,0x3c008000,0x3c008000
.long 0x395fb9ed,0xb95f39ed,0x2a48bbfe,0xaa483bfe,0xb9edb95f,0x39ed395f,0xbbfeaa48,0x3bfe2a48
.long 0xbbf62e46,0xbbf62e46,0xae463bf6,0xae463bf6,0x2e463bf6,0x2e463bf6,0x3bf62e46,0x3bf62e46
.long 0x3a6d38c4,0xba6db8c4,0x30b2bbea,0xb0b23bea,0x38c4ba6d,0xb8c43a6d,0xbbeab0b2,0x3bea30b2
.long 0xb23ebbd9,0xb23ebbd9,0xb23e3bd9,0xb23e3bd9,0xbbd9323e,0xbbd9323e,0x3bd9323e,0x3bd9323e
.long 0xb81d3add,0x381dbadd,0x33c6bbc3,0xb3c63bc3,0x3add381d,0xbaddb81d,0xbbc3b3c6,0x3bc333c6
.long 0x3ba8b4a5,0x3ba8b4a5,0xb4a53ba8,0xb4a53ba8,0xb4a5bba8,0xb4a5bba8,0x3ba834a5,0x3ba834a5
.long 0xbb3bb6d7,0x3b3b36d7,0x3564bb88,0xb5643b88,0xb6d73b3b,0x36d7bb3b,0xbb88b564,0x3b883564
.long 0x3c00,0x3c00,0x3c00,0x3c00,0x3c008000,0x3c008000,0x3c008000,0x3c008000
.long 0x2e463bf6,0xae46bbf6,0x39133a2f,0xb913ba2f,0x3bf6ae46,0xbbf62e46,0x3a2fb913,0xba2f3913
.long 0x323e3bd9,0x323e3bd9,0x3bd9323e,0x3bd9323e,0x3bd9b23e,0x3bd9b23e,0x323ebbd9,0x323ebbd9
.long 0x34a53ba8,0xb4a5bba8,0x3b0eb78b,0xbb0e378b,0x3ba8b4a5,0xbba834a5,0xb78bbb0e,0x378b3b0e
.long 0x361f3b64,0x361f3b64,0x361fbb64,0x361fbb64,0x3b64b61f,0x3b64b61f,0xbb64b61f,0xbb64b61f
.long 0x378b3b0e,0xb78bbb0e,0xb4a5bba8,0x34a53ba8,0x3b0eb78b,0xbb0e378b,0xbba834a5,0x3ba8b4a5
.long 0x38723aa7,0x38723aa7,0xbaa7b872,0xbaa7b872,0x3aa7b872,0x3aa7b872,0xb8723aa7,0xb8723aa7
.long 0x39133a2f,0xb913ba2f,0xbbf62e46,0x3bf6ae46,0x3a2fb913,0xba2f3913,0x2e463bf6,0xae46bbf6
.long 0x3c00,0x3c00,0x3c00,0x3c00,0x3c008000,0x3c008000,0x3c008000,0x3c008000
.long 0x3a2f3913,0xba2fb913,0x3bf62e46,0xbbf6ae46,0x3913ba2f,0xb9133a2f,0x2e46bbf6,0xae463bf6
.long 0x3bd9b23e,0x3bd9b23e,0x323ebbd9,0x323ebbd9,0xb23ebbd9,0xb23ebbd9,0xbbd9b23e,0xbbd9b23e
.long 0x378bbb0e,0xb78b3b0e,0xbba8b4a5,0x3ba834a5,0xbb0eb78b,0x3b0e378b,0xb4a53ba8,0x34a5bba8
.long 0xb61fbb64,0xb61fbb64,0xb61f3b64,0xb61f3b64,0xbb64361f,0xbb64361f,0x3b64361f,0x3b64361f
.long 0xbba8b4a5,0x3ba834a5,0x3b0e378b,0xbb0eb78b,0xb4a53ba8,0x34a5bba8,0x378bbb0e,0xb78b3b0e
.long 0xbaa73872,0xbaa73872,0x3872baa7,0x3872baa7,0x38723aa7,0x38723aa7,0xbaa7b872,0xbaa7b872
.long 0xae463bf6,0x2e46bbf6,0xba2fb913,0x3a2f3913,0x3bf62e46,0xbbf6ae46,0xb9133a2f,0x3913ba2f
.long 0x3c00,0x3c00,0x3c00,0x3c00,0x3c008000,0x3c008000,0x3c008000,0x3c008000
.long 0x3bf6ae46,0xbbf62e46,0x3a2fb913,0xba2f3913,0xae46bbf6,0x2e463bf6,0xb913ba2f,0x39133a2f
.long 0xb23ebbd9,0xb23ebbd9,0xbbd9b23e,0xbbd9b23e,0xbbd9323e,0xbbd9323e,0xb23e3bd9,0xb23e3bd9
.long 0xbba834a5,0x3ba8b4a5,0x378b3b0e,0xb78bbb0e,0x34a53ba8,0xb4a5bba8,0x3b0eb78b,0xbb0e378b
.long 0x361f3b64,0x361f3b64,0x361fbb64,0x361fbb64,0x3b64b61f,0x3b64b61f,0xbb64b61f,0xbb64b61f
.long 0x3b0eb78b,0xbb0e378b,0xbba834a5,0x3ba8b4a5,0xb78bbb0e,0x378b3b0e,0x34a53ba8,0xb4a5bba8
.long 0xb872baa7,0xb872baa7,0x3aa73872,0x3aa73872,0xbaa73872,0xbaa73872,0x3872baa7,0x3872baa7
.long 0xba2f3913,0x3a2fb913,0xae46bbf6,0x2e463bf6,0x39133a2f,0xb913ba2f,0xbbf62e46,0x3bf6ae46
.long 0x3c00,0x3c00,0x3c00,0x3c00,0x3c008000,0x3c008000,0x3c008000,0x3c008000
.long 0x3913ba2f,0xb9133a2f,0x2e46bbf6,0xae463bf6,0xba2fb913,0x3a2f3913,0xbbf6ae46,0x3bf62e46
.long 0xbbd9323e,0xbbd9323e,0xb23e3bd9,0xb23e3bd9,0x323e3bd9,0x323e3bd9,0x3bd9323e,0x3bd9323e
.long 0x3b0e378b,0xbb0eb78b,0x34a5bba8,0xb4a53ba8,0x378bbb0e,0xb78b3b0e,0xbba8b4a5,0x3ba834a5
.long 0xb61fbb64,0xb61fbb64,0xb61f3b64,0xb61f3b64,0xbb64361f,0xbb64361f,0x3b64361f,0x3b64361f
.long 0xb4a53ba8,0x34a5bba8,0x378bbb0e,0xb78b3b0e,0x3ba834a5,0xbba8b4a5,0xbb0eb78b,0x3b0e378b
.long 0x3aa7b872,0x3aa7b872,0xb8723aa7,0xb8723aa7,0xb872baa7,0xb872baa7,0x3aa73872,0x3aa73872
.long 0xbbf6ae46,0x3bf62e46,0x3913ba2f,0xb9133a2f,0xae463bf6,0x2e46bbf6,0xba2fb913,0x3a2f3913
.long 0x3c00,0x3c00,0x3c00,0x3c00,0x3c008000,0x3c008000,0x3c008000,0x3c008000
.long 0x30b23bea,0xb0b2bbea,0x38c43a6d,0xb8c4ba6d,0x3beab0b2,0xbbea30b2,0x3a6db8c4,0xba6d38c4
.long 0x34a53ba8,0x34a53ba8,0x3ba834a5,0x3ba834a5,0x3ba8b4a5,0x3ba8b4a5,0x34a5bba8,0x34a5bba8
.long 0x36d73b3b,0xb6d7bb3b,0x3b88b564,0xbb883564,0x3b3bb6d7,0xbb3b36d7,0xb564bb88,0x35643b88
.long 0x38723aa7,0x38723aa7,0x3872baa7,0x3872baa7,0x3aa7b872,0x3aa7b872,0xbaa7b872,0xbaa7b872
.long 0x395f39ed,0xb95fb9ed,0xaa48bbfe,0x2a483bfe,0x39edb95f,0xb9ed395f,0xbbfe2a48,0x3bfeaa48
.long 0x3a2f3913,0x3a2f3913,0xb913ba2f,0xb913ba2f,0x3913ba2f,0x3913ba2f,0xba2f3913,0xba2f3913
.long 0x3add381d,0xbaddb81d,0xbbc3b3c6,0x3bc333c6,0x381dbadd,0xb81d3add,0xb3c63bc3,0x33c6bbc3
.long 0x3c00,0x3c00,0x3c00,0x3c00,0x3c008000,0x3c008000,0x3c008000,0x3c008000
.long 0x3a6d38c4,0xba6db8c4,0x3bea30b2,0xbbeab0b2,0x38c4ba6d,0xb8c43a6d,0x30b2bbea,0xb0b23bea
.long 0x3ba8b4a5,0x3ba8b4a5,0x34a5bba8,0x34a5bba8,0xb4a5bba8,0xb4a5bba8,0xbba8b4a5,0xbba8b4a5
.long 0x3564bb88,0xb5643b88,0xbb3bb6d7,0x3b3b36d7,0xbb88b564,0x3b883564,0xb6d73b3b,0x36d7bb3b
.long 0xb872baa7,0xb872baa7,0xb8723aa7,0xb8723aa7,0xbaa73872,0xbaa73872,0x3aa73872,0x3aa73872
.long 0xbbfeaa48,0x3bfe2a48,0x39ed395f,0xb9edb95f,0xaa483bfe,0x2a48bbfe,0x395fb9ed,0xb95f39ed
.long 0xb9133a2f,0xb9133a2f,0x3a2fb913,0x3a2fb913,0x3a2f3913,0x3a2f3913,0xb913ba2f,0xb913ba2f
.long 0x33c63bc3,0xb3c6bbc3,0xb81dbadd,0x381d3add,0x3bc3b3c6,0xbbc333c6,0xbadd381d,0x3addb81d
.long 0x3c00,0x3c00,0x3c00,0x3c00,0x3c008000,0x3c008000,0x3c008000,0x3c008000
.long 0x3beab0b2,0xbbea30b2,0x3a6db8c4,0xba6d38c4,0xb0b2bbea,0x30b23bea,0xb8c4ba6d,0x38c43a6d
.long 0xb4a5bba8,0xb4a5bba8,0xbba8b4a5,0xbba8b4a5,0xbba834a5,0xbba834a5,0xb4a53ba8,0xb4a53ba8
.long 0xbb3b36d7,0x3b3bb6d7,0x35643b88,0xb564bb88,0x36d73b3b,0xb6d7bb3b,0x3b88b564,0xbb883564
.long 0x38723aa7,0x38723aa7,0x3872baa7,0x3872baa7,0x3aa7b872,0x3aa7b872,0xbaa7b872,0xbaa7b872
.long 0x39edb95f,0xb9ed395f,0xbbfe2a48,0x3bfeaa48,0xb95fb9ed,0x395f39ed,0x2a483bfe,0xaa48bbfe
.long 0xba2fb913,0xba2fb913,0x39133a2f,0x39133a2f,0xb9133a2f,0xb9133a2f,0x3a2fb913,0x3a2fb913
.long 0xb81d3add,0x381dbadd,0x33c6bbc3,0xb3c63bc3,0x3add381d,0xbaddb81d,0xbbc3b3c6,0x3bc333c6
.long 0x3c00,0x3c00,0x3c00,0x3c00,0x3c008000,0x3c008000,0x3c008000,0x3c008000
.long 0x38c4ba6d,0xb8c43a6d,0x30b2bbea,0xb0b23bea,0xba6db8c4,0x3a6d38c4,0xbbeab0b2,0x3bea30b2
.long 0xbba834a5,0xbba834a5,0xb4a53ba8,0xb4a53ba8,0x34a53ba8,0x34a53ba8,0x3ba834a5,0x3ba834a5
.long 0x3b883564,0xbb88b564,0x36d7bb3b,0xb6d73b3b,0x3564bb88,0xb5643b88,0xbb3bb6d7,0x3b3b36d7
.long 0xb872baa7,0xb872baa7,0xb8723aa7,0xb8723aa7,0xbaa73872,0xbaa73872,0x3aa73872,0x3aa73872
.long 0xaa483bfe,0x2a48bbfe,0x395fb9ed,0xb95f39ed,0x3bfe2a48,0xbbfeaa48,0xb9edb95f,0x39ed395f
.long 0x3913ba2f,0x3913ba2f,0xba2f3913,0xba2f3913,0xba2fb913,0xba2fb913,0x39133a2f,0x39133a2f
.long 0xbbc333c6,0x3bc3b3c6,0x3addb81d,0xbadd381d,0x33c63bc3,0xb3c6bbc3,0xb81dbadd,0x381d3add
.long 0x3c00,0x3c00,0x3c00,0x3c00,0x3c008000,0x3c008000,0x3c008000,0x3c008000
.long 0x323e3bd9,0xb23ebbd9,0x38723aa7,0xb872baa7,0x3bd9b23e,0xbbd9323e,0x3aa7b872,0xbaa73872
.long 0x361f3b64,0x361f3b64,0x3b64361f,0x3b64361f,0x3b64b61f,0x3b64b61f,0x361fbb64,0x361fbb64
.long 0x38723aa7,0xb872baa7,0x3bd9b23e,0xbbd9323e,0x3aa7b872,0xbaa73872,0xb23ebbd9,0x323e3bd9
.long 0x39a839a8,0x39a839a8,0x39a8b9a8,0x39a8b9a8,0x39a8b9a8,0x39a8b9a8,0xb9a8b9a8,0xb9a8b9a8
.long 0x3aa73872,0xbaa7b872,0x323ebbd9,0xb23e3bd9,0x3872baa7,0xb8723aa7,0xbbd9b23e,0x3bd9323e
.long 0x3b64361f,0x3b64361f,0xb61fbb64,0xb61fbb64,0x361fbb64,0x361fbb64,0xbb64361f,0xbb64361f
.long 0x3bd9323e,0xbbd9b23e,0xbaa7b872,0x3aa73872,0x323ebbd9,0xb23e3bd9,0xb8723aa7,0x3872baa7
.long 0x3c00,0x3c00,0x3c00,0x3c00,0x3c008000,0x3c008000,0x3c008000,0x3c008000
.long 0x3aa73872,0xbaa7b872,0x3bd9323e,0xbbd9b23e,0x3872baa7,0xb8723aa7,0x323ebbd9,0xb23e3bd9
.long 0x3b64b61f,0x3b64b61f,0x361fbb64,0x361fbb64,0xb61fbb64,0xb61fbb64,0xbb64b61f,0xbb64b61f
.long 0x323ebbd9,0xb23e3bd9,0xbaa7b872,0x3aa73872,0xbbd9b23e,0x3bd9323e,0xb8723aa7,0x3872baa7
.long 0xb9a8b9a8,0xb9a8b9a8,0xb9a839a8,0xb9a839a8,0xb9a839a8,0xb9a839a8,0x39a839a8,0x39a839a8
.long 0xbbd9323e,0x3bd9b23e,0x38723aa7,0xb872baa7,0x323e3bd9,0xb23ebbd9,0x3aa7b872,0xbaa73872
.long 0xb61f3b64,0xb61f3b64,0x3b64b61f,0x3b64b61f,0x3b64361f,0x3b64361f,0xb61fbb64,0xb61fbb64
.long 0x38723aa7,0xb872baa7,0xb23ebbd9,0x323e3bd9,0x3aa7b872,0xbaa73872,0xbbd9323e,0x3bd9b23e
.long 0x3c00,0x3c00,0x3c00,0x3c00,0x3c008000,0x3c008000,0x3c008000,0x3c008000
.long 0x3bd9b23e,0xbbd9323e,0x3aa7b872,0xbaa73872,0xb23ebbd9,0x323e3bd9,0xb872baa7,0x38723aa7
.long 0xb61fbb64,0xb61fbb64,0xbb64b61f,0xbb64b61f,0xbb64361f,0xbb64361f,0xb61f3b64,0xb61f3b64
.long 0xbaa73872,0x3aa7b872,0x323e3bd9,0xb23ebbd9,0x38723aa7,0xb872baa7,0x3bd9b23e,0xbbd9323e
.long 0x39a839a8,0x39a839a8,0x39a8b9a8,0x39a8b9a8,0x39a8b9a8,0x39a8b9a8,0xb9a8b9a8,0xb9a8b9a8
.long 0x3872baa7,0xb8723aa7,0xbbd9b23e,0x3bd9323e,0xbaa7b872,0x3aa73872,0xb23e3bd9,0x323ebbd9
.long 0xbb64b61f,0xbb64b61f,0x361f3b64,0x361f3b64,0xb61f3b64,0xb61f3b64,0x3b64b61f,0x3b64b61f
.long 0xb23e3bd9,0x323ebbd9,0x3872baa7,0xb8723aa7,0x3bd9323e,0xbbd9b23e,0xbaa7b872,0x3aa73872
.long 0x3c00,0x3c00,0x3c00,0x3c00,0x3c008000,0x3c008000,0x3c008000,0x3c008000
.long 0x3872baa7,0xb8723aa7,0x323ebbd9,0xb23e3bd9,0xbaa7b872,0x3aa73872,0xbbd9b23e,0x3bd9323e
.long 0xbb64361f,0xbb64361f,0xb61f3b64,0xb61f3b64,0x361f3b64,0x361f3b64,0x3b64361f,0x3b64361f
.long 0x3bd9323e,0xbbd9b23e,0x3872baa7,0xb8723aa7,0x323ebbd9,0xb23e3bd9,0xbaa7b872,0x3aa73872
.long 0xb9a8b9a8,0xb9a8b9a8,0xb9a839a8,0xb9a839a8,0xb9a839a8,0xb9a839a8,0x39a839a8,0x39a839a8
.long 0x323e3bd9,0xb23ebbd9,0x3aa7b872,0xbaa73872,0x3bd9b23e,0xbbd9323e,0xb872baa7,0x38723aa7
.long 0x361fbb64,0x361fbb64,0xbb64361f,0xbb64361f,0xbb64b61f,0xbb64b61f,0x361f3b64,0x361f3b64
.long 0xbaa73872,0x3aa7b872,0x3bd9b23e,0xbbd9323e,0x38723aa7,0xb872baa7,0xb23ebbd9,0x323e3bd9
.long 0x3c00,0x3c00,0x3c00,0x3c00,0x3c008000,0x3c008000,0x3c008000,0x3c008000
.long 0x33c63bc3,0xb3c6bbc3,0x381d3add,0xb81dbadd,0x3bc3b3c6,0xbbc333c6,0x3addb81d,0xbadd381d
.long 0x378b3b0e,0x378b3b0e,0x3b0e378b,0x3b0e378b,0x3b0eb78b,0x3b0eb78b,0x378bbb0e,0x378bbb0e
.long 0x395f39ed,0xb95fb9ed,0x3bfeaa48,0xbbfe2a48,0x39edb95f,0xb9ed395f,0xaa48bbfe,0x2a483bfe
.long 0x3aa73872,0x3aa73872,0x3aa7b872,0x3aa7b872,0x3872baa7,0x3872baa7,0xb872baa7,0xb872baa7
.long 0x3b883564,0xbb88b564,0x36d7bb3b,0xb6d73b3b,0x3564bb88,0xb5643b88,0xbb3bb6d7,0x3b3b36d7
.long 0x3bf62e46,0x3bf62e46,0xae46bbf6,0xae46bbf6,0x2e46bbf6,0x2e46bbf6,0xbbf62e46,0xbbf62e46
.long 0x3beab0b2,0xbbea30b2,0xb8c4ba6d,0x38c43a6d,0xb0b2bbea,0x30b23bea,0xba6d38c4,0x3a6db8c4
.long 0x3c00,0x3c00,0x3c00,0x3c00,0x3c008000,0x3c008000,0x3c008000,0x3c008000
.long 0x3add381d,0xbaddb81d,0x3bc333c6,0xbbc3b3c6,0x381dbadd,0xb81d3add,0x33c6bbc3,0xb3c63bc3
.long 0x3b0eb78b,0x3b0eb78b,0x378bbb0e,0x378bbb0e,0xb78bbb0e,0xb78bbb0e,0xbb0eb78b,0xbb0eb78b
.long 0x2a48bbfe,0xaa483bfe,0xb9edb95f,0x39ed395f,0xbbfeaa48,0x3bfe2a48,0xb95f39ed,0x395fb9ed
.long 0xbaa7b872,0xbaa7b872,0xbaa73872,0xbaa73872,0xb8723aa7,0xb8723aa7,0x38723aa7,0x38723aa7
.long 0xbb3b36d7,0x3b3bb6d7,0x35643b88,0xb564bb88,0x36d73b3b,0xb6d7bb3b,0x3b88b564,0xbb883564
.long 0xae463bf6,0xae463bf6,0x3bf6ae46,0x3bf6ae46,0x3bf62e46,0x3bf62e46,0xae46bbf6,0xae46bbf6
.long 0x3a6d38c4,0xba6db8c4,0x30b2bbea,0xb0b23bea,0x38c4ba6d,0xb8c43a6d,0xbbeab0b2,0x3bea30b2
.long 0x3c00,0x3c00,0x3c00,0x3c00,0x3c008000,0x3c008000,0x3c008000,0x3c008000
.long 0x3bc3b3c6,0xbbc333c6,0x3addb81d,0xbadd381d,0xb3c6bbc3,0x33c63bc3,0xb81dbadd,0x381d3add
.long 0xb78bbb0e,0xb78bbb0e,0xbb0eb78b,0xbb0eb78b,0xbb0e378b,0xbb0e378b,0xb78b3b0e,0xb78b3b0e
.long 0xb9ed395f,0x39edb95f,0x2a483bfe,0xaa48bbfe,0x395f39ed,0xb95fb9ed,0x3bfeaa48,0xbbfe2a48
.long 0x3aa73872,0x3aa73872,0x3aa7b872,0x3aa7b872,0x3872baa7,0x3872baa7,0xb872baa7,0xb872baa7
.long 0x3564bb88,0xb5643b88,0xbb3bb6d7,0x3b3b36d7,0xbb88b564,0x3b883564,0xb6d73b3b,0x36d7bb3b
.long 0xbbf6ae46,0xbbf6ae46,0x2e463bf6,0x2e463bf6,0xae463bf6,0xae463bf6,0x3bf6ae46,0x3bf6ae46
.long 0x30b23bea,0xb0b2bbea,0x3a6db8c4,0xba6d38c4,0x3beab0b2,0xbbea30b2,0xb8c4ba6d,0x38c43a6d
.long 0x3c00,0x3c00,0x3c00,0x3c00,0x3c008000,0x3c008000,0x3c008000,0x3c008000
.long 0x381dbadd,0xb81d3add,0x33c6bbc3,0xb3c63bc3,0xbaddb81d,0x3add381d,0xbbc3b3c6,0x3bc333c6
.long 0xbb0e378b,0xbb0e378b,0xb78b3b0e,0xb78b3b0e,0x378b3b0e,0x378b3b0e,0x3b0e378b,0x3b0e378b
.long 0x3bfe2a48,0xbbfeaa48,0x395fb9ed,0xb95f39ed,0x2a48bbfe,0xaa483bfe,0xb9edb95f,0x39ed395f
.long 0xbaa7b872,0xbaa7b872,0xbaa73872,0xbaa73872,0xb8723aa7,0xb8723aa7,0x38723aa7,0x38723aa7
.long 0x36d73b3b,0xb6d7bb3b,0x3b88b564,0xbb883564,0x3b3bb6d7,0xbb3b36d7,0xb564bb88,0x35643b88
.long 0x2e46bbf6,0x2e46bbf6,0xbbf62e46,0xbbf62e46,0xbbf6ae46,0xbbf6ae46,0x2e463bf6,0x2e463bf6
.long 0xb8c43a6d,0x38c4ba6d,0x3bea30b2,0xbbeab0b2,0x3a6d38c4,0xba6db8c4,0x30b2bbea,0xb0b23bea
.long 0x3c00,0x3c00,0x3c00,0x3c00,0x3c008000,0x3c008000,0x3c008000,0x3c008000
.long 0x34a53ba8,0xb4a5bba8,0x378b3b0e,0xb78bbb0e,0x3ba8b4a5,0xbba834a5,0x3b0eb78b,0xbb0e378b
.long 0x38723aa7,0x38723aa7,0x3aa73872,0x3aa73872,0x3aa7b872,0x3aa7b872,0x3872baa7,0x3872baa7
.long 0x3a2f3913,0xba2fb913,0x3bf62e46,0xbbf6ae46,0x3913ba2f,0xb9133a2f,0x2e46bbf6,0xae463bf6
.long 0x3b64361f,0x3b64361f,0x3b64b61f,0x3b64b61f,0x361fbb64,0x361fbb64,0xb61fbb64,0xb61fbb64
.long 0x3bf62e46,0xbbf6ae46,0x3913ba2f,0xb9133a2f,0x2e46bbf6,0xae463bf6,0xba2fb913,0x3a2f3913
.long 0x3bd9b23e,0x3bd9b23e,0x323ebbd9,0x323ebbd9,0xb23ebbd9,0xb23ebbd9,0xbbd9b23e,0xbbd9b23e
.long 0x3b0eb78b,0xbb0e378b,0xb4a5bba8,0x34a53ba8,0xb78bbb0e,0x378b3b0e,0xbba834a5,0x3ba8b4a5
.long 0x3c00,0x3c00,0x3c00,0x3c00,0x3c008000,0x3c008000,0x3c008000,0x3c008000
.long 0x3b0e378b,0xbb0eb78b,0x3ba834a5,0xbba8b4a5,0x378bbb0e,0xb78b3b0e,0x34a5bba8,0xb4a53ba8
.long 0x3aa7b872,0x3aa7b872,0x3872baa7,0x3872baa7,0xb872baa7,0xb872baa7,0xbaa7b872,0xbaa7b872
.long 0xae46bbf6,0x2e463bf6,0xb913ba2f,0x39133a2f,0xbbf62e46,0x3bf6ae46,0xba2f3913,0x3a2fb913
.long 0xbb64b61f,0xbb64b61f,0xbb64361f,0xbb64361f,0xb61f3b64,0xb61f3b64,0x361f3b64,0x361f3b64
.long 0xba2f3913,0x3a2fb913,0x2e463bf6,0xae46bbf6,0x39133a2f,0xb913ba2f,0x3bf6ae46,0xbbf62e46
.long 0x323e3bd9,0x323e3bd9,0x3bd9323e,0x3bd9323e,0x3bd9b23e,0x3bd9b23e,0x323ebbd9,0x323ebbd9
.long 0x3ba834a5,0xbba8b4a5,0x378bbb0e,0xb78b3b0e,0x34a5bba8,0xb4a53ba8,0xbb0eb78b,0x3b0e378b
.long 0x3c00,0x3c00,0x3c00,0x3c00,0x3c008000,0x3c008000,0x3c008000,0x3c008000
.long 0x3ba8b4a5,0xbba834a5,0x3b0eb78b,0xbb0e378b,0xb4a5bba8,0x34a53ba8,0xb78bbb0e,0x378b3b0e
.long 0xb872baa7,0xb872baa7,0xbaa7b872,0xbaa7b872,0xbaa73872,0xbaa73872,0xb8723aa7,0xb8723aa7
.long 0xb9133a2f,0x3913ba2f,0xae463bf6,0x2e46bbf6,0x3a2f3913,0xba2fb913,0x3bf62e46,0xbbf6ae46
.long 0x3b64361f,0x3b64361f,0x3b64b61f,0x3b64b61f,0x361fbb64,0x361fbb64,0xb61fbb64,0xb61fbb64
.long 0x2e46bbf6,0xae463bf6,0xba2fb913,0x3a2f3913,0xbbf6ae46,0x3bf62e46,0xb9133a2f,0x3913ba2f
.long 0xbbd9323e,0xbbd9323e,0xb23e3bd9,0xb23e3bd9,0x323e3bd9,0x323e3bd9,0x3bd9323e,0x3bd9323e
.long 0x378b3b0e,0xb78bbb0e,0x3ba8b4a5,0xbba834a5,0x3b0eb78b,0xbb0e378b,0xb4a5bba8,0x34a53ba8
.long 0x3c00,0x3c00,0x3c00,0x3c00,0x3c008000,0x3c008000,0x3c008000,0x3c008000
.long 0x378bbb0e,0xb78b3b0e,0x34a5bba8,0xb4a53ba8,0xbb0eb78b,0x3b0e378b,0xbba8b4a5,0x3ba834a5
.long 0xbaa73872,0xbaa73872,0xb8723aa7,0xb8723aa7,0x38723aa7,0x38723aa7,0x3aa73872,0x3aa73872
.long 0x3bf6ae46,0xbbf62e46,0x3a2fb913,0xba2f3913,0xae46bbf6,0x2e463bf6,0xb913ba2f,0x39133a2f
.long 0xbb64b61f,0xbb64b61f,0xbb64361f,0xbb64361f,0xb61f3b64,0xb61f3b64,0x361f3b64,0x361f3b64
.long 0x39133a2f,0xb913ba2f,0x3bf6ae46,0xbbf62e46,0x3a2fb913,0xba2f3913,0xae46bbf6,0x2e463bf6
.long 0xb23ebbd9,0xb23ebbd9,0xbbd9b23e,0xbbd9b23e,0xbbd9323e,0xbbd9323e,0xb23e3bd9,0xb23e3bd9
.long 0xb4a53ba8,0x34a5bba8,0x3b0e378b,0xbb0eb78b,0x3ba834a5,0xbba8b4a5,0x378bbb0e,0xb78b3b0e
.long 0x3c00,0x3c00,0x3c00,0x3c00,0x3c008000,0x3c008000,0x3c008000,0x3c008000
.long 0x35643b88,0xb564bb88,0x36d73b3b,0xb6d7bb3b,0x3b88b564,0xbb883564,0x3b3bb6d7,0xbb3b36d7
.long 0x39133a2f,0x39133a2f,0x3a2f3913,0x3a2f3913,0x3a2fb913,0x3a2fb913,0x3913ba2f,0x3913ba2f
.long 0x3add381d,0xbaddb81d,0x3bc333c6,0xbbc3b3c6,0x381dbadd,0xb81d3add,0x33c6bbc3,0xb3c63bc3
.long 0x3bd9323e,0x3bd9323e,0x3bd9b23e,0x3bd9b23e,0x323ebbd9,0x323ebbd9,0xb23ebbd9,0xb23ebbd9
.long 0x3beab0b2,0xbbea30b2,0x3a6db8c4,0xba6d38c4,0xb0b2bbea,0x30b23bea,0xb8c4ba6d,0x38c43a6d
.long 0x3b0eb78b,0x3b0eb78b,0x378bbb0e,0x378bbb0e,0xb78bbb0e,0xb78bbb0e,0xbb0eb78b,0xbb0eb78b
.long 0x395fb9ed,0xb95f39ed,0x2a48bbfe,0xaa483bfe,0xb9edb95f,0x39ed395f,0xbbfeaa48,0x3bfe2a48
.long 0x3c00,0x3c00,0x3c00,0x3c00,0x3c008000,0x3c008000,0x3c008000,0x3c008000
.long 0x3b3b36d7,0xbb3bb6d7,0x3b883564,0xbb88b564,0x36d7bb3b,0xb6d73b3b,0x3564bb88,0xb5643b88
.long 0x3a2fb913,0x3a2fb913,0x3913ba2f,0x3913ba2f,0xb913ba2f,0xb913ba2f,0xba2fb913,0xba2fb913
.long 0xb3c6bbc3,0x33c63bc3,0xb81dbadd,0x381d3add,0xbbc333c6,0x3bc3b3c6,0xbadd381d,0x3addb81d
.long 0xbbd9b23e,0xbbd9b23e,0xbbd9323e,0xbbd9323e,0xb23e3bd9,0xb23e3bd9,0x323e3bd9,0x323e3bd9
.long 0xb8c43a6d,0x38c4ba6d,0xb0b23bea,0x30b2bbea,0x3a6d38c4,0xba6db8c4,0x3bea30b2,0xbbeab0b2
.long 0x378b3b0e,0x378b3b0e,0x3b0e378b,0x3b0e378b,0x3b0eb78b,0x3b0eb78b,0x378bbb0e,0x378bbb0e
.long 0x3bfeaa48,0xbbfe2a48,0x39edb95f,0xb9ed395f,0xaa48bbfe,0x2a483bfe,0xb95fb9ed,0x395f39ed
.long 0x3c00,0x3c00,0x3c00,0x3c00,0x3c008000,0x3c008000,0x3c008000,0x3c008000
.long 0x3b88b564,0xbb883564,0x3b3bb6d7,0xbb3b36d7,0xb564bb88,0x35643b88,0xb6d7bb3b,0x36d73b3b
.long 0xb913ba2f,0xb913ba2f,0xba2fb913,0xba2fb913,0xba2f3913,0xba2f3913,0xb9133a2f,0xb9133a2f
.long 0xb81d3add,0x381dbadd,0xb3c63bc3,0x33c6bbc3,0x3add381d,0xbaddb81d,0x3bc333c6,0xbbc3b3c6
.long 0x3bd9323e,0x3bd9323e,0x3bd9b23e,0x3bd9b23e,0x323ebbd9,0x323ebbd9,0xb23ebbd9,0xb23ebbd9
.long 0xb0b2bbea,0x30b23bea,0xb8c4ba6d,0x38c43a6d,0xbbea30b2,0x3beab0b2,0xba6d38c4,0x3a6db8c4
.long 0xbb0e378b,0xbb0e378b,0xb78b3b0e,0xb78b3b0e,0x378b3b0e,0x378b3b0e,0x3b0e378b,0x3b0e378b
.long 0x39ed395f,0xb9edb95f,0x3bfe2a48,0xbbfeaa48,0x395fb9ed,0xb95f39ed,0x2a48bbfe,0xaa483bfe
.long 0x3c00,0x3c00,0x3c00,0x3c00,0x3c008000,0x3c008000,0x3c008000,0x3c008000
.long 0x36d7bb3b,0xb6d73b3b,0x3564bb88,0xb5643b88,0xbb3bb6d7,0x3b3b36d7,0xbb88b564,0x3b883564
.long 0xba2f3913,0xba2f3913,0xb9133a2f,0xb9133a2f,0x39133a2f,0x39133a2f,0x3a2f3913,0x3a2f3913
.long 0x3bc3b3c6,0xbbc333c6,0x3addb81d,0xbadd381d,0xb3c6bbc3,0x33c63bc3,0xb81dbadd,0x381d3add
.long 0xbbd9b23e,0xbbd9b23e,0xbbd9323e,0xbbd9323e,0xb23e3bd9,0xb23e3bd9,0x323e3bd9,0x323e3bd9
.long 0x3a6d38c4,0xba6db8c4,0x3bea30b2,0xbbeab0b2,0x38c4ba6d,0xb8c43a6d,0x30b2bbea,0xb0b23bea
.long 0xb78bbb0e,0xb78bbb0e,0xbb0eb78b,0xbb0eb78b,0xbb0e378b,0xbb0e378b,0xb78b3b0e,0xb78b3b0e
.long 0x2a483bfe,0xaa48bbfe,0x395f39ed,0xb95fb9ed,0x3bfeaa48,0xbbfe2a48,0x39edb95f,0xb9ed395f
.long 0x3c00,0x3c00,0x3c00,0x3c00,0x3c00,0x3c00,0x3c00,0x3c00
.long 0x3c00,0xbc00,0x3b64,0xbb64,0x8000,0x8000,0xb61f,0x361f
.long 0x3c00,0x3c00,0x39a8,0x39a8,0x8000,0x8000,0xb9a8,0xb9a8
.long 0x3c00,0xbc00,0x361f,0xb61f,0x8000,0x8000,0xbb64,0x3b64
.long 0x3c000000,0x0,0x3bd90000,0xb23e0000,0x80000000,0xbc000000,0xb23e0000,0xbbd90000
.long 0x3c000000,0x80000000,0x3aa70000,0x38720000,0x80000000,0x3c000000,0xb8720000,0x3aa70000
.long 0x3c000000,0x0,0x38720000,0xbaa70000,0x80000000,0xbc000000,0xbaa70000,0xb8720000
.long 0x3c000000,0x80000000,0x323e0000,0x3bd90000,0x80000000,0x3c000000,0xbbd90000,0x323e0000
.long 0x3c00,0x3c00,0x3c00,0x3c00,0xbc00,0xbc00,0xbc00,0xbc00
.long 0x39a8,0xb9a8,0x361f,0xb61f,0xb9a8,0x39a8,0xbb64,0x3b64
.long 0x0,0x0,0xb9a8,0xb9a8,0xbc00,0xbc00,0xb9a8,0xb9a8
.long 0xb9a8,0x39a8,0xbb64,0x3b64,0xb9a8,0x39a8,0x361f,0xb61f
.long 0x3b640000,0xb61f0000,0x3aa70000,0xb8720000,0xb61f0000,0xbb640000,0xb8720000,0xbaa70000
.long 0x361f0000,0x3b640000,0xb23e0000,0x3bd90000,0xbb640000,0x361f0000,0xbbd90000,0xb23e0000
.long 0xb61f0000,0xbb640000,0xbbd90000,0xb23e0000,0xbb640000,0x361f0000,0xb23e0000,0x3bd90000
.long 0xbb640000,0x361f0000,0xb8720000,0xbaa70000,0xb61f0000,0xbb640000,0x3aa70000,0xb8720000
.long 0x3c00,0x3c00,0x3c00,0x3c00,0x3c00,0x3c00,0x3c00,0x3c00
.long 0x0,0x8000,0xb61f,0x361f,0xbc00,0x3c00,0xbb64,0x3b64
.long 0xbc00,0xbc00,0xb9a8,0xb9a8,0x8000,0x8000,0x39a8,0x39a8
.long 0x8000,0x0,0x3b64,0xbb64,0x3c00,0xbc00,0x361f,0xb61f
.long 0x39a80000,0xb9a80000,0x38720000,0xbaa70000,0xb9a80000,0xb9a80000,0xbaa70000,0xb8720000
.long 0xb9a80000,0x39a80000,0xbbd90000,0x323e0000,0xb9a80000,0xb9a80000,0xb23e0000,0xbbd90000
.long 0xb9a80000,0x39a80000,0x323e0000,0x3bd90000,0x39a80000,0x39a80000,0x3bd90000,0xb23e0000
.long 0x39a80000,0xb9a80000,0x3aa70000,0x38720000,0x39a80000,0x39a80000,0xb8720000,0x3aa70000
.long 0x3c00,0x3c00,0x3c00,0x3c00,0xbc00,0xbc00,0xbc00,0xbc00
.long 0xb9a8,0x39a8,0xbb64,0x3b64,0xb9a8,0x39a8,0xb61f,0x361f
.long 0x8000,0x8000,0x39a8,0x39a8,0x3c00,0x3c00,0x39a8,0x39a8
.long 0x39a8,0xb9a8,0xb61f,0x361f,0xb9a8,0x39a8,0xbb64,0x3b64
.long 0x361f0000,0xbb640000,0x323e0000,0xbbd90000,0xbb640000,0xb61f0000,0xbbd90000,0xb23e0000
.long 0xbb640000,0xb61f0000,0xb8720000,0xbaa70000,0x361f0000,0xbb640000,0x3aa70000,0xb8720000
.long 0x3b640000,0x361f0000,0x3aa70000,0xb8720000,0x361f0000,0xbb640000,0xb8720000,0xbaa70000
.long 0xb61f0000,0x3b640000,0xbbd90000,0xb23e0000,0xbb640000,0xb61f0000,0x323e0000,0xbbd90000
.long 0x3c00,0x3c00,0x3c00,0x3c00,0x3c00,0x3c00,0x3c00,0x3c00
.long 0x3bfe,0xbbfe,0x39ed,0xb9ed,0xaa48,0x2a48,0xb95f,0x395f
.long 0x3bf6,0x3bf6,0x2e46,0x2e46,0xae46,0xae46,0xbbf6,0xbbf6
.long 0x3bea,0xbbea,0xb8c4,0x38c4,0xb0b2,0x30b2,0xba6d,0x3a6d
.long 0x3bff0000,0xa6480000,0x3b770000,0xb5c20000,0xa6480000,0xbbff0000,0xb5c20000,0xbb770000
.long 0x3bfa0000,0x2cb50000,0x37320000,0x3b250000,0xacb50000,0x3bfa0000,0xbb250000,0x37320000
.long 0x3bf10000,0xafd60000,0xb4440000,0xbbb60000,0xafd60000,0xbbf10000,0xbbb60000,0x34440000
.long 0x3be20000,0x31790000,0xbac20000,0x38480000,0xb1790000,0x3be20000,0xb8480000,0xbac20000
.long 0x3c00,0x3c00,0x3c00,0x3c00,0xbc00,0xbc00,0xbc00,0xbc00
.long 0x395f,0xb95f,0x2a48,0xaa48,0xb9ed,0x39ed,0xbbfe,0x3bfe
.long 0xae46,0xae46,0xbbf6,0xbbf6,0xbbf6,0xbbf6,0xae46,0xae46
.long 0xba6d,0x3a6d,0xb0b2,0x30b2,0xb8c4,0x38c4,0x3bea,0xbbea
.long 0x3b500000,0xb67c0000,0x39cb0000,0xb9840000,0xb67c0000,0xbb500000,0xb9840000,0xb9cb0000
.long 0x35050000,0x3b990000,0xb93a0000,0x3a0f0000,0xbb990000,0x35050000,0xba0f0000,0xb93a0000
.long 0xb7e30000,0xbaf60000,0xba4f0000,0x38ec0000,0xbaf60000,0x37e30000,0x38ec0000,0x3a4f0000
.long 0xbbce0000,0x33030000,0x389b0000,0xba8a0000,0xb3030000,0xbbce0000,0x3a8a0000,0x389b0000
.long 0x3c00,0x3c00,0x3c00,0x3c00,0x3c00,0x3c00,0x3c00,0x3c00
.long 0xaa48,0x2a48,0xb95f,0x395f,0xbbfe,0x3bfe,0xb9ed,0x39ed
.long 0xbbf6,0xbbf6,0xae46,0xae46,0x2e46,0x2e46,0x3bf6,0x3bf6
.long 0x30b2,0xb0b2,0x3a6d,0xba6d,0x3bea,0xbbea,0xb8c4,0x38c4
.long 0x39840000,0xb9cb0000,0x367c0000,0xbb500000,0xb9cb0000,0xb9840000,0xbb500000,0xb67c0000
.long 0xba0f0000,0x393a0000,0xbb990000,0xb5050000,0xb93a0000,0xba0f0000,0x35050000,0xbb990000
.long 0xb8ec0000,0x3a4f0000,0x3af60000,0x37e30000,0x3a4f0000,0x38ec0000,0x37e30000,0xbaf60000
.long 0x3a8a0000,0xb89b0000,0xb3030000,0x3bce0000,0x389b0000,0x3a8a0000,0xbbce0000,0xb3030000
.long 0x3c00,0x3c00,0x3c00,0x3c00,0xbc00,0xbc00,0xbc00,0xbc00
.long 0xb9ed,0x39ed,0xbbfe,0x3bfe,0xb95f,0x395f,0xaa48,0x2a48
.long 0x2e46,0x2e46,0x3bf6,0x3bf6,0x3bf6,0x3bf6,0x2e46,0x2e46
.long 0x38c4,0xb8c4,0xbbea,0x3bea,0xba6d,0x3a6d,0xb0b2,0x30b2
.long 0x35c20000,0xbb770000,0x26480000,0xbbff0000,0xbb770000,0xb5c20000,0xbbff0000,0xa6480000
.long 0xbb250000,0xb7320000,0xacb50000,0xbbfa0000,0x37320000,0xbb250000,0x3bfa0000,0xacb50000
.long 0x3bb60000,0x34440000,0x2fd60000,0xbbf10000,0x34440000,0xbbb60000,0xbbf10000,0xafd60000
.long 0xb8480000,0x3ac20000,0xb1790000,0xbbe20000,0xbac20000,0xb8480000,0x3be20000,0xb1790000
.long 0x3c00,0x3c00,0x3c00,0x3c00,0x3c00,0x3c00,0x3c00,0x3c00
.long 0x3bf6,0xbbf6,0x3a2f,0xba2f,0xae46,0x2e46,0xb913,0x3913
.long 0x3bd9,0x3bd9,0x323e,0x323e,0xb23e,0xb23e,0xbbd9,0xbbd9
.long 0x3ba8,0xbba8,0xb78b,0x378b,0xb4a5,0x34a5,0xbb0e,0x3b0e
.long 0x3bfe0000,0xaa480000,0x3b880000,0xb5640000,0xaa480000,0xbbfe0000,0xb5640000,0xbb880000
.long 0x3bea0000,0x30b20000,0x381d0000,0x3add0000,0xb0b20000,0x3bea0000,0xbadd0000,0x381d0000
.long 0x3bc30000,0xb3c60000,0xb0b20000,0xbbea0000,0xb3c60000,0xbbc30000,0xbbea0000,0x30b20000
.long 0x3b880000,0x35640000,0xb9ed0000,0x395f0000,0xb5640000,0x3b880000,0xb95f0000,0xb9ed0000
.long 0x3c00,0x3c00,0x3c00,0x3c00,0xbc00,0xbc00,0xbc00,0xbc00
.long 0x3913,0xb913,0x2e46,0xae46,0xba2f,0x3a2f,0xbbf6,0x3bf6
.long 0xb23e,0xb23e,0xbbd9,0xbbd9,0xbbd9,0xbbd9,0xb23e,0xb23e
.long 0xbb0e,0x3b0e,0xb4a5,0x34a5,0xb78b,0x378b,0x3ba8,0xbba8
.long 0x3b3b0000,0xb6d70000,0x39ed0000,0xb95f0000,0xb6d70000,0xbb3b0000,0xb95f0000,0xb9ed0000
.long 0x33c60000,0x3bc30000,0xb8c40000,0x3a6d0000,0xbbc30000,0x33c60000,0xba6d0000,0xb8c40000
.long 0xb8c40000,0xba6d0000,0xbadd0000,0x381d0000,0xba6d0000,0x38c40000,0x381d0000,0x3add0000
.long 0xbbfe0000,0x2a480000,0x36d70000,0xbb3b0000,0xaa480000,0xbbfe0000,0x3b3b0000,0x36d70000
.long 0x3c00,0x3c00,0x3c00,0x3c00,0x3c00,0x3c00,0x3c00,0x3c00
.long 0xae46,0x2e46,0xb913,0x3913,0xbbf6,0x3bf6,0xba2f,0x3a2f
.long 0xbbd9,0xbbd9,0xb23e,0xb23e,0x323e,0x323e,0x3bd9,0x3bd9
.long 0x34a5,0xb4a5,0x3b0e,0xbb0e,0x3ba8,0xbba8,0xb78b,0x378b
.long 0x395f0000,0xb9ed0000,0x36d70000,0xbb3b0000,0xb9ed0000,0xb95f0000,0xbb3b0000,0xb6d70000
.long 0xba6d0000,0x38c40000,0xbbc30000,0xb3c60000,0xb8c40000,0xba6d0000,0x33c60000,0xbbc30000
.long 0xb81d0000,0x3add0000,0x3a6d0000,0x38c40000,0x3add0000,0x381d0000,0x38c40000,0xba6d0000
.long 0x3b3b0000,0xb6d70000,0xaa480000,0x3bfe0000,0x36d70000,0x3b3b0000,0xbbfe0000,0xaa480000
.long 0x3c00,0x3c00,0x3c00,0x3c00,0xbc00,0xbc00,0xbc00,0xbc00
.long 0xba2f,0x3a2f,0xbbf6,0x3bf6,0xb913,0x3913,0xae46,0x2e46
.long 0x323e,0x323e,0x3bd9,0x3bd9,0x3bd9,0x3bd9,0x323e,0x323e
.long 0x378b,0xb78b,0xbba8,0x3ba8,0xbb0e,0x3b0e,0xb4a5,0x34a5
.long 0x35640000,0xbb880000,0x2a480000,0xbbfe0000,0xbb880000,0xb5640000,0xbbfe0000,0xaa480000
.long 0xbadd0000,0xb81d0000,0xb0b20000,0xbbea0000,0x381d0000,0xbadd0000,0x3bea0000,0xb0b20000
.long 0x3bea0000,0x30b20000,0x33c60000,0xbbc30000,0x30b20000,0xbbea0000,0xbbc30000,0xb3c60000
.long 0xb95f0000,0x39ed0000,0xb5640000,0xbb880000,0xb9ed0000,0xb95f0000,0x3b880000,0xb5640000
.long 0x3c00,0x3c00,0x3c00,0x3c00,0x3c00,0x3c00,0x3c00,0x3c00
.long 0x3bea,0xbbea,0x3a6d,0xba6d,0xb0b2,0x30b2,0xb8c4,0x38c4
.long 0x3ba8,0x3ba8,0x34a5,0x34a5,0xb4a5,0xb4a5,0xbba8,0xbba8
.long 0x3b3b,0xbb3b,0xb564,0x3564,0xb6d7,0x36d7,0xbb88,0x3b88
.long 0x3bfa0000,0xacb50000,0x3b990000,0xb5050000,0xacb50000,0xbbfa0000,0xb5050000,0xbb990000
.long 0x3bce0000,0x33030000,0x389b0000,0x3a8a0000,0xb3030000,0x3bce0000,0xba8a0000,0x389b0000
.long 0x3b770000,0xb5c20000,0xa6480000,0xbbff0000,0xb5c20000,0xbb770000,0xbbff0000,0x26480000
.long 0x3af60000,0x37e30000,0xb8ec0000,0x3a4f0000,0xb7e30000,0x3af60000,0xba4f0000,0xb8ec0000
.long 0x3c00,0x3c00,0x3c00,0x3c00,0xbc00,0xbc00,0xbc00,0xbc00
.long 0x38c4,0xb8c4,0x30b2,0xb0b2,0xba6d,0x3a6d,0xbbea,0x3bea
.long 0xb4a5,0xb4a5,0xbba8,0xbba8,0xbba8,0xbba8,0xb4a5,0xb4a5
.long 0xbb88,0x3b88,0xb6d7,0x36d7,0xb564,0x3564,0x3b3b,0xbb3b
.long 0x3b250000,0xb7320000,0x3a0f0000,0xb93a0000,0xb7320000,0xbb250000,0xb93a0000,0xba0f0000
.long 0x31790000,0x3be20000,0xb8480000,0x3ac20000,0xbbe20000,0x31790000,0xbac20000,0xb8480000
.long 0xb9840000,0xb9cb0000,0xbb500000,0x367c0000,0xb9cb0000,0x39840000,0x367c0000,0x3b500000
.long 0xbbf10000,0xafd60000,0x34440000,0xbbb60000,0x2fd60000,0xbbf10000,0x3bb60000,0x34440000
.long 0x3c00,0x3c00,0x3c00,0x3c00,0x3c00,0x3c00,0x3c00,0x3c00
.long 0xb0b2,0x30b2,0xb8c4,0x38c4,0xbbea,0x3bea,0xba6d,0x3a6d
.long 0xbba8,0xbba8,0xb4a5,0xb4a5,0x34a5,0x34a5,0x3ba8,0x3ba8
.long 0x36d7,0xb6d7,0x3b88,0xbb88,0x3b3b,0xbb3b,0xb564,0x3564
.long 0x393a0000,0xba0f0000,0x37320000,0xbb250000,0xba0f0000,0xb93a0000,0xbb250000,0xb7320000
.long 0xbac20000,0x38480000,0xbbe20000,0xb1790000,0xb8480000,0xbac20000,0x31790000,0xbbe20000
.long 0xb67c0000,0x3b500000,0x39cb0000,0x39840000,0x3b500000,0x367c0000,0x39840000,0xb9cb0000
.long 0x3bb60000,0xb4440000,0x2fd60000,0x3bf10000,0x34440000,0x3bb60000,0xbbf10000,0x2fd60000
.long 0x3c00,0x3c00,0x3c00,0x3c00,0xbc00,0xbc00,0xbc00,0xbc00
.long 0xba6d,0x3a6d,0xbbea,0x3bea,0xb8c4,0x38c4,0xb0b2,0x30b2
.long 0x34a5,0x34a5,0x3ba8,0x3ba8,0x3ba8,0x3ba8,0x34a5,0x34a5
.long 0x3564,0xb564,0xbb3b,0x3b3b,0xbb88,0x3b88,0xb6d7,0x36d7
.long 0x35050000,0xbb990000,0x2cb50000,0xbbfa0000,0xbb990000,0xb5050000,0xbbfa0000,0xacb50000
.long 0xba8a0000,0xb89b0000,0xb3030000,0xbbce0000,0x389b0000,0xba8a0000,0x3bce0000,0xb3030000
.long 0x3bff0000,0x26480000,0x35c20000,0xbb770000,0x26480000,0xbbff0000,0xbb770000,0xb5c20000
.long 0xba4f0000,0x38ec0000,0xb7e30000,0xbaf60000,0xb8ec0000,0xba4f0000,0x3af60000,0xb7e30000
.long 0x3c00,0x3c00,0x3c00,0x3c00,0x3c00,0x3c00,0x3c00,0x3c00
.long 0x3bd9,0xbbd9,0x3aa7,0xbaa7,0xb23e,0x323e,0xb872,0x3872
.long 0x3b64,0x3b64,0x361f,0x361f,0xb61f,0xb61f,0xbb64,0xbb64
.long 0x3aa7,0xbaa7,0xb23e,0x323e,0xb872,0x3872,0xbbd9,0x3bd9
.long 0x3bf60000,0xae460000,0x3ba80000,0xb4a50000,0xae460000,0xbbf60000,0xb4a50000,0xbba80000
.long 0x3ba80000,0x34a50000,0x39130000,0x3a2f0000,0xb4a50000,0x3ba80000,0xba2f0000,0x39130000
.long 0x3b0e0000,0xb78b0000,0x2e460000,0xbbf60000,0xb78b0000,0xbb0e0000,0xbbf60000,0xae460000
.long 0x3a2f0000,0x39130000,0xb78b0000,0x3b0e0000,0xb9130000,0x3a2f0000,0xbb0e0000,0xb78b0000
.long 0x3c00,0x3c00,0x3c00,0x3c00,0xbc00,0xbc00,0xbc00,0xbc00
.long 0x3872,0xb872,0x323e,0xb23e,0xbaa7,0x3aa7,0xbbd9,0x3bd9
.long 0xb61f,0xb61f,0xbb64,0xbb64,0xbb64,0xbb64,0xb61f,0xb61f
.long 0xbbd9,0x3bd9,0xb872,0x3872,0xb23e,0x323e,0x3aa7,0xbaa7
.long 0x3b0e0000,0xb78b0000,0x3a2f0000,0xb9130000,0xb78b0000,0xbb0e0000,0xb9130000,0xba2f0000
.long 0x2e460000,0x3bf60000,0xb78b0000,0x3b0e0000,0xbbf60000,0x2e460000,0xbb0e0000,0xb78b0000
.long 0xba2f0000,0xb9130000,0xbba80000,0x34a50000,0xb9130000,0x3a2f0000,0x34a50000,0x3ba80000
.long 0xbba80000,0xb4a50000,0x2e460000,0xbbf60000,0x34a50000,0xbba80000,0x3bf60000,0x2e460000
.long 0x3c00,0x3c00,0x3c00,0x3c00,0x3c00,0x3c00,0x3c00,0x3c00
.long 0xb23e,0x323e,0xb872,0x3872,0xbbd9,0x3bd9,0xbaa7,0x3aa7
.long 0xbb64,0xbb64,0xb61f,0xb61f,0x361f,0x361f,0x3b64,0x3b64
.long 0x3872,0xb872,0x3bd9,0xbbd9,0x3aa7,0xbaa7,0xb23e,0x323e
.long 0x39130000,0xba2f0000,0x378b0000,0xbb0e0000,0xba2f0000,0xb9130000,0xbb0e0000,0xb78b0000
.long 0xbb0e0000,0x378b0000,0xbbf60000,0xae460000,0xb78b0000,0xbb0e0000,0x2e460000,0xbbf60000
.long 0xb4a50000,0x3ba80000,0x39130000,0x3a2f0000,0x3ba80000,0x34a50000,0x3a2f0000,0xb9130000
.long 0x3bf60000,0xae460000,0x34a50000,0x3ba80000,0x2e460000,0x3bf60000,0xbba80000,0x34a50000
.long 0x3c00,0x3c00,0x3c00,0x3c00,0xbc00,0xbc00,0xbc00,0xbc00
.long 0xbaa7,0x3aa7,0xbbd9,0x3bd9,0xb872,0x3872,0xb23e,0x323e
.long 0x361f,0x361f,0x3b64,0x3b64,0x3b64,0x3b64,0x361f,0x361f
.long 0x323e,0xb23e,0xbaa7,0x3aa7,0xbbd9,0x3bd9,0xb872,0x3872
.long 0x34a50000,0xbba80000,0x2e460000,0xbbf60000,0xbba80000,0xb4a50000,0xbbf60000,0xae460000
.long 0xba2f0000,0xb9130000,0xb4a50000,0xbba80000,0x39130000,0xba2f0000,0x3ba80000,0xb4a50000
.long 0x3bf60000,0xae460000,0x378b0000,0xbb0e0000,0xae460000,0xbbf60000,0xbb0e0000,0xb78b0000
.long 0xbb0e0000,0x378b0000,0xb9130000,0xba2f0000,0xb78b0000,0xbb0e0000,0x3a2f0000,0xb9130000
.long 0x3c00,0x3c00,0x3c00,0x3c00,0x3c00,0x3c00,0x3c00,0x3c00
.long 0x3bc3,0xbbc3,0x3add,0xbadd,0xb3c6,0x33c6,0xb81d,0x381d
.long 0x3b0e,0x3b0e,0x378b,0x378b,0xb78b,0xb78b,0xbb0e,0xbb0e
.long 0x39ed,0xb9ed,0xaa48,0x2a48,0xb95f,0x395f,0xbbfe,0x3bfe
.long 0x3bf10000,0xafd60000,0x3bb60000,0xb4440000,0xafd60000,0xbbf10000,0xb4440000,0xbbb60000
.long 0x3b770000,0x35c20000,0x39840000,0x39cb0000,0xb5c20000,0x3b770000,0xb9cb0000,0x39840000
.long 0x3a8a0000,0xb89b0000,0x33030000,0xbbce0000,0xb89b0000,0xba8a0000,0xbbce0000,0xb3030000
.long 0x393a0000,0x3a0f0000,0xb5050000,0x3b990000,0xba0f0000,0x393a0000,0xbb990000,0xb5050000
.long 0x3c00,0x3c00,0x3c00,0x3c00,0xbc00,0xbc00,0xbc00,0xbc00
.long 0x381d,0xb81d,0x33c6,0xb3c6,0xbadd,0x3add,0xbbc3,0x3bc3
.long 0xb78b,0xb78b,0xbb0e,0xbb0e,0xbb0e,0xbb0e,0xb78b,0xb78b
.long 0xbbfe,0x3bfe,0xb95f,0x395f,0xaa48,0x2a48,0x39ed,0xb9ed
.long 0x3af60000,0xb7e30000,0x3a4f0000,0xb8ec0000,0xb7e30000,0xbaf60000,0xb8ec0000,0xba4f0000
.long 0x26480000,0x3bff0000,0xb67c0000,0x3b500000,0xbbff0000,0x26480000,0xbb500000,0xb67c0000
.long 0xbac20000,0xb8480000,0xbbe20000,0x31790000,0xb8480000,0x3ac20000,0x31790000,0x3be20000
.long 0xbb250000,0xb7320000,0xacb50000,0xbbfa0000,0x37320000,0xbb250000,0x3bfa0000,0xacb50000
.long 0x3c00,0x3c00,0x3c00,0x3c00,0x3c00,0x3c00,0x3c00,0x3c00
.long 0xb3c6,0x33c6,0xb81d,0x381d,0xbbc3,0x3bc3,0xbadd,0x3add
.long 0xbb0e,0xbb0e,0xb78b,0xb78b,0x378b,0x378b,0x3b0e,0x3b0e
.long 0x395f,0xb95f,0x3bfe,0xbbfe,0x39ed,0xb9ed,0xaa48,0x2a48
.long 0x38ec0000,0xba4f0000,0x37e30000,0xbaf60000,0xba4f0000,0xb8ec0000,0xbaf60000,0xb7e30000
.long 0xbb500000,0x367c0000,0xbbff0000,0xa6480000,0xb67c0000,0xbb500000,0x26480000,0xbbff0000
.long 0xb1790000,0x3be20000,0x38480000,0x3ac20000,0x3be20000,0x31790000,0x3ac20000,0xb8480000
.long 0x3bfa0000,0x2cb50000,0x37320000,0x3b250000,0xacb50000,0x3bfa0000,0xbb250000,0x37320000
.long 0x3c00,0x3c00,0x3c00,0x3c00,0xbc00,0xbc00,0xbc00,0xbc00
.long 0xbadd,0x3add,0xbbc3,0x3bc3,0xb81d,0x381d,0xb3c6,0x33c6
.long 0x378b,0x378b,0x3b0e,0x3b0e,0x3b0e,0x3b0e,0x378b,0x378b
.long 0x2a48,0xaa48,0xb9ed,0x39ed,0xbbfe,0x3bfe,0xb95f,0x395f
.long 0x34440000,0xbbb60000,0x2fd60000,0xbbf10000,0xbbb60000,0xb4440000,0xbbf10000,0xafd60000
.long 0xb9cb0000,0xb9840000,0xb5c20000,0xbb770000,0x39840000,0xb9cb0000,0x3b770000,0xb5c20000
.long 0x3bce0000,0xb3030000,0x389b0000,0xba8a0000,0xb3030000,0xbbce0000,0xba8a0000,0xb89b0000
.long 0xbb990000,0x35050000,0xba0f0000,0xb93a0000,0xb5050000,0xbb990000,0x393a0000,0xba0f0000
.long 0x3c00,0x3c00,0x3c00,0x3c00,0x3c00,0x3c00,0x3c00,0x3c00
.long 0x3ba8,0xbba8,0x3b0e,0xbb0e,0xb4a5,0x34a5,0xb78b,0x378b
.long 0x3aa7,0x3aa7,0x3872,0x3872,0xb872,0xb872,0xbaa7,0xbaa7
.long 0x3913,0xb913,0x2e46,0xae46,0xba2f,0x3a2f,0xbbf6,0x3bf6
.long 0x3bea0000,0xb0b20000,0x3bc30000,0xb3c60000,0xb0b20000,0xbbea0000,0xb3c60000,0xbbc30000
.long 0x3b3b0000,0x36d70000,0x39ed0000,0x395f0000,0xb6d70000,0x3b3b0000,0xb95f0000,0x39ed0000
.long 0x39ed0000,0xb95f0000,0x35640000,0xbb880000,0xb95f0000,0xb9ed0000,0xbb880000,0xb5640000
.long 0x381d0000,0x3add0000,0xb0b20000,0x3bea0000,0xbadd0000,0x381d0000,0xbbea0000,0xb0b20000
.long 0x3c00,0x3c00,0x3c00,0x3c00,0xbc00,0xbc00,0xbc00,0xbc00
.long 0x378b,0xb78b,0x34a5,0xb4a5,0xbb0e,0x3b0e,0xbba8,0x3ba8
.long 0xb872,0xb872,0xbaa7,0xbaa7,0xbaa7,0xbaa7,0xb872,0xb872
.long 0xbbf6,0x3bf6,0xba2f,0x3a2f,0x2e46,0xae46,0x3913,0xb913
.long 0x3add0000,0xb81d0000,0x3a6d0000,0xb8c40000,0xb81d0000,0xbadd0000,0xb8c40000,0xba6d0000
.long 0xaa480000,0x3bfe0000,0xb5640000,0x3b880000,0xbbfe0000,0xaa480000,0xbb880000,0xb5640000
.long 0xbb3b0000,0xb6d70000,0xbbfe0000,0x2a480000,0xb6d70000,0x3b3b0000,0x2a480000,0x3bfe0000
.long 0xba6d0000,0xb8c40000,0xb3c60000,0xbbc30000,0x38c40000,0xba6d0000,0x3bc30000,0xb3c60000
.long 0x3c00,0x3c00,0x3c00,0x3c00,0x3c00,0x3c00,0x3c00,0x3c00
.long 0xb4a5,0x34a5,0xb78b,0x378b,0xbba8,0x3ba8,0xbb0e,0x3b0e
.long 0xbaa7,0xbaa7,0xb872,0xb872,0x3872,0x3872,0x3aa7,0x3aa7
.long 0x3a2f,0xba2f,0x3bf6,0xbbf6,0x3913,0xb913,0x2e46,0xae46
.long 0x38c40000,0xba6d0000,0x381d0000,0xbadd0000,0xba6d0000,0xb8c40000,0xbadd0000,0xb81d0000
.long 0xbb880000,0x35640000,0xbbfe0000,0x2a480000,0xb5640000,0xbb880000,0xaa480000,0xbbfe0000
.long 0xaa480000,0x3bfe0000,0x36d70000,0x3b3b0000,0x3bfe0000,0x2a480000,0x3b3b0000,0xb6d70000
.long 0x3bc30000,0x33c60000,0x38c40000,0x3a6d0000,0xb3c60000,0x3bc30000,0xba6d0000,0x38c40000
.long 0x3c00,0x3c00,0x3c00,0x3c00,0xbc00,0xbc00,0xbc00,0xbc00
.long 0xbb0e,0x3b0e,0xbba8,0x3ba8,0xb78b,0x378b,0xb4a5,0x34a5
.long 0x3872,0x3872,0x3aa7,0x3aa7,0x3aa7,0x3aa7,0x3872,0x3872
.long 0xae46,0x2e46,0xb913,0x3913,0xbbf6,0x3bf6,0xba2f,0x3a2f
.long 0x33c60000,0xbbc30000,0x30b20000,0xbbea0000,0xbbc30000,0xb3c60000,0xbbea0000,0xb0b20000
.long 0xb95f0000,0xb9ed0000,0xb6d70000,0xbb3b0000,0x39ed0000,0xb95f0000,0x3b3b0000,0xb6d70000
.long 0x3b880000,0xb5640000,0x395f0000,0xb9ed0000,0xb5640000,0xbb880000,0xb9ed0000,0xb95f0000
.long 0xbbea0000,0x30b20000,0xbadd0000,0xb81d0000,0xb0b20000,0xbbea0000,0x381d0000,0xbadd0000
.long 0x3c00,0x3c00,0x3c00,0x3c00,0x3c00,0x3c00,0x3c00,0x3c00
.long 0x3b88,0xbb88,0x3b3b,0xbb3b,0xb564,0x3564,0xb6d7,0x36d7
.long 0x3a2f,0x3a2f,0x3913,0x3913,0xb913,0xb913,0xba2f,0xba2f
.long 0x381d,0xb81d,0x33c6,0xb3c6,0xbadd,0x3add,0xbbc3,0x3bc3
.long 0x3be20000,0xb1790000,0x3bce0000,0xb3030000,0xb1790000,0xbbe20000,0xb3030000,0xbbce0000
.long 0x3af60000,0x37e30000,0x3a4f0000,0x38ec0000,0xb7e30000,0x3af60000,0xb8ec0000,0x3a4f0000
.long 0x393a0000,0xba0f0000,0x37320000,0xbb250000,0xba0f0000,0xb93a0000,0xbb250000,0xb7320000
.long 0x35c20000,0x3b770000,0x26480000,0x3bff0000,0xbb770000,0x35c20000,0xbbff0000,0x26480000
.long 0x3c00,0x3c00,0x3c00,0x3c00,0xbc00,0xbc00,0xbc00,0xbc00
.long 0x36d7,0xb6d7,0x3564,0xb564,0xbb3b,0x3b3b,0xbb88,0x3b88
.long 0xb913,0xb913,0xba2f,0xba2f,0xba2f,0xba2f,0xb913,0xb913
.long 0xbbc3,0x3bc3,0xbadd,0x3add,0x33c6,0xb3c6,0x381d,0xb81d
.long 0x3ac20000,0xb8480000,0x3a8a0000,0xb89b0000,0xb8480000,0xbac20000,0xb89b0000,0xba8a0000
.long 0xafd60000,0x3bf10000,0xb4440000,0x3bb60000,0xbbf10000,0xafd60000,0xbbb60000,0xb4440000
.long 0xbb990000,0xb5050000,0xbbfa0000,0xacb50000,0xb5050000,0x3b990000,0xacb50000,0x3bfa0000
.long 0xb9840000,0xb9cb0000,0xb67c0000,0xbb500000,0x39cb0000,0xb9840000,0x3b500000,0xb67c0000
.long 0x3c00,0x3c00,0x3c00,0x3c00,0x3c00,0x3c00,0x3c00,0x3c00
.long 0xb564,0x3564,0xb6d7,0x36d7,0xbb88,0x3b88,0xbb3b,0x3b3b
.long 0xba2f,0xba2f,0xb913,0xb913,0x3913,0x3913,0x3a2f,0x3a2f
.long 0x3add,0xbadd,0x3bc3,0xbbc3,0x381d,0xb81d,0x33c6,0xb3c6
.long 0x389b0000,0xba8a0000,0x38480000,0xbac20000,0xba8a0000,0xb89b0000,0xbac20000,0xb8480000
.long 0xbbb60000,0x34440000,0xbbf10000,0x2fd60000,0xb4440000,0xbbb60000,0xafd60000,0xbbf10000
.long 0x2cb50000,0x3bfa0000,0x35050000,0x3b990000,0x3bfa0000,0xacb50000,0x3b990000,0xb5050000
.long 0x3b500000,0x367c0000,0x39cb0000,0x39840000,0xb67c0000,0x3b500000,0xb9840000,0x39cb0000
.long 0x3c00,0x3c00,0x3c00,0x3c00,0xbc00,0xbc00,0xbc00,0xbc00
.long 0xbb3b,0x3b3b,0xbb88,0x3b88,0xb6d7,0x36d7,0xb564,0x3564
.long 0x3913,0x3913,0x3a2f,0x3a2f,0x3a2f,0x3a2f,0x3913,0x3913
.long 0xb3c6,0x33c6,0xb81d,0x381d,0xbbc3,0x3bc3,0xbadd,0x3add
.long 0x33030000,0xbbce0000,0x31790000,0xbbe20000,0xbbce0000,0xb3030000,0xbbe20000,0xb1790000
.long 0xb8ec0000,0xba4f0000,0xb7e30000,0xbaf60000,0x3a4f0000,0xb8ec0000,0x3af60000,0xb7e30000
.long 0x3b250000,0xb7320000,0x3a0f0000,0xb93a0000,0xb7320000,0xbb250000,0xb93a0000,0xba0f0000
.long 0xbbff0000,0xa6480000,0xbb770000,0xb5c20000,0x26480000,0xbbff0000,0x35c20000,0xbb770000
.long 0x3c00,0x3c00,0x3c00,0x3c00,0x3c00,0xbc00,0x361f3b64,0xb61f3b64
.long 0x3c00,0x3c00,0x39a839a8,0xb9a839a8,0x3c00,0xbc00,0x3b64361f,0xbb64361f
.long 0x3c00,0x3c00,0x3c000000,0xbc008000,0x3c00,0xbc00,0x3b64b61f,0xbb64b61f
.long 0x3c00,0x3c00,0x39a8b9a8,0xb9a8b9a8,0x3c00,0xbc00,0x361fbb64,0xb61fbb64
.long 0x3c00,0x3c00,0xbc00,0xbc00,0x3c00,0xbc00,0xb61fbb64,0x361fbb64
.long 0x3c00,0x3c00,0xb9a8b9a8,0x39a8b9a8,0x3c00,0xbc00,0xbb64b61f,0x3b64b61f
.long 0x3c00,0x3c00,0xbc008000,0x3c000000,0x3c00,0xbc00,0xbb64361f,0x3b64361f
.long 0x3c00,0x3c00,0xb9a839a8,0x39a839a8,0x3c00,0xbc00,0xb61f3b64,0x361f3b64
.long 0x3c00,0x3c00,0x3c00,0x3c00,0x39a839a8,0xb9a839a8,0x3b64361f,0xbb64361f
.long 0x3c000000,0xbc008000,0x39a8b9a8,0xb9a8b9a8,0x39a8b9a8,0xb9a8b9a8,0xb61fbb64,0x361fbb64
.long 0xbc00,0xbc00,0xbc008000,0x3c000000,0xb9a8b9a8,0x39a8b9a8,0xb61f3b64,0x361f3b64
.long 0xbc008000,0x3c000000,0x39a839a8,0xb9a839a8,0xb9a839a8,0x39a839a8,0x3b64b61f,0xbb64b61f
.long 0x3c00,0x3c00,0xbc00,0xbc00,0x39a839a8,0xb9a839a8,0xbb64b61f,0x3b64b61f
.long 0x3c000000,0xbc008000,0xb9a839a8,0x39a839a8,0x39a8b9a8,0xb9a8b9a8,0x361f3b64,0xb61f3b64
.long 0xbc00,0xbc00,0x3c000000,0xbc008000,0xb9a8b9a8,0x39a8b9a8,0x361fbb64,0xb61fbb64
.long 0xbc008000,0x3c000000,0xb9a8b9a8,0x39a8b9a8,0xb9a839a8,0x39a839a8,0xbb64361f,0x3b64361f
.long 0x3c00,0x3c00,0x3c00,0x3c00,0x3c000000,0xbc008000,0x3b64b61f,0xbb64b61f
.long 0xbc00,0xbc00,0xb9a8b9a8,0x39a8b9a8,0xbc008000,0x3c000000,0xb61f3b64,0x361f3b64
.long 0x3c00,0x3c00,0x3c000000,0xbc008000,0x3c000000,0xbc008000,0xb61fbb64,0x361fbb64
.long 0xbc00,0xbc00,0xb9a839a8,0x39a839a8,0xbc008000,0x3c000000,0x3b64361f,0xbb64361f
.long 0x3c00,0x3c00,0xbc00,0xbc00,0x3c000000,0xbc008000,0xbb64361f,0x3b64361f
.long 0xbc00,0xbc00,0x39a839a8,0xb9a839a8,0xbc008000,0x3c000000,0x361fbb64,0xb61fbb64
.long 0x3c00,0x3c00,0xbc008000,0x3c000000,0x3c000000,0xbc008000,0x361f3b64,0xb61f3b64
.long 0xbc00,0xbc00,0x39a8b9a8,0xb9a8b9a8,0xbc008000,0x3c000000,0xbb64b61f,0x3b64b61f
.long 0x3c00,0x3c00,0x3c00,0x3c00,0x39a8b9a8,0xb9a8b9a8,0x361fbb64,0xb61fbb64
.long 0xbc008000,0x3c000000,0xb9a839a8,0x39a839a8,0x39a839a8,0xb9a839a8,0x3b64b61f,0xbb64b61f
.long 0xbc00,0xbc00,0xbc008000,0x3c000000,0xb9a839a8,0x39a839a8,0x3b64361f,0xbb64361f
.long 0x3c000000,0xbc008000,0xb9a8b9a8,0x39a8b9a8,0xb9a8b9a8,0x39a8b9a8,0x361f3b64,0xb61f3b64
.long 0x3c00,0x3c00,0xbc00,0xbc00,0x39a8b9a8,0xb9a8b9a8,0xb61f3b64,0x361f3b64
.long 0xbc008000,0x3c000000,0x39a8b9a8,0xb9a8b9a8,0x39a839a8,0xb9a839a8,0xbb64361f,0x3b64361f
.long 0xbc00,0xbc00,0x3c000000,0xbc008000,0xb9a839a8,0x39a839a8,0xbb64b61f,0x3b64b61f
.long 0x3c000000,0xbc008000,0x39a839a8,0xb9a839a8,0xb9a8b9a8,0x39a8b9a8,0xb61fbb64,0x361fbb64
.long 0x3c008000,0x3c008000,0x3c008000,0x3c008000,0x3c008000,0xbc008000,0x3b64b61f,0x3b64361f
.long 0x3c008000,0x3c008000,0x39a8b9a8,0x39a839a8,0x3c008000,0xbc008000,0x361fbb64,0x361f3b64
.long 0x3c008000,0x3c008000,0xbc00,0x80003c00,0x3c008000,0xbc008000,0xb61fbb64,0xb61f3b64
.long 0x3c008000,0x3c008000,0xb9a8b9a8,0xb9a839a8,0x3c008000,0xbc008000,0xbb64b61f,0xbb64361f
.long 0x3c008000,0x3c008000,0xbc008000,0xbc008000,0x3c008000,0xbc008000,0xbb64361f,0xbb64b61f
.long 0x3c008000,0x3c008000,0xb9a839a8,0xb9a8b9a8,0x3c008000,0xbc008000,0xb61f3b64,0xb61fbb64
.long 0x3c008000,0x3c008000,0x80003c00,0xbc00,0x3c008000,0xbc008000,0x361f3b64,0x361fbb64
.long 0x3c008000,0x3c008000,0x39a839a8,0x39a8b9a8,0x3c008000,0xbc008000,0x3b64361f,0x3b64b61f
.long 0x3c008000,0x3c008000,0x3c008000,0x3c008000,0x39a8b9a8,0x39a839a8,0x361fbb64,0x361f3b64
.long 0xbc00,0x80003c00,0xb9a8b9a8,0xb9a839a8,0xb9a8b9a8,0xb9a839a8,0xbb64361f,0xbb64b61f
.long 0xbc008000,0xbc008000,0x80003c00,0xbc00,0xb9a839a8,0xb9a8b9a8,0x3b64361f,0x3b64b61f
.long 0x80003c00,0xbc00,0x39a8b9a8,0x39a839a8,0x39a839a8,0x39a8b9a8,0xb61fbb64,0xb61f3b64
.long 0x3c008000,0x3c008000,0xbc008000,0xbc008000,0x39a8b9a8,0x39a839a8,0xb61f3b64,0xb61fbb64
.long 0xbc00,0x80003c00,0x39a839a8,0x39a8b9a8,0xb9a8b9a8,0xb9a839a8,0x3b64b61f,0x3b64361f
.long 0xbc008000,0xbc008000,0xbc00,0x80003c00,0xb9a839a8,0xb9a8b9a8,0xbb64b61f,0xbb64361f
.long 0x80003c00,0xbc00,0xb9a839a8,0xb9a8b9a8,0x39a839a8,0x39a8b9a8,0x361f3b64,0x361fbb64
.long 0x3c008000,0x3c008000,0x3c008000,0x3c008000,0xbc00,0x80003c00,0xb61fbb64,0xb61f3b64
.long 0xbc008000,0xbc008000,0xb9a839a8,0xb9a8b9a8,0x80003c00,0xbc00,0x3b64361f,0x3b64b61f
.long 0x3c008000,0x3c008000,0xbc00,0x80003c00,0xbc00,0x80003c00,0xbb64361f,0xbb64b61f
.long 0xbc008000,0xbc008000,0x39a839a8,0x39a8b9a8,0x80003c00,0xbc00,0x361fbb64,0x361f3b64
.long 0x3c008000,0x3c008000,0xbc008000,0xbc008000,0xbc00,0x80003c00,0x361f3b64,0x361fbb64
.long 0xbc008000,0xbc008000,0x39a8b9a8,0x39a839a8,0x80003c00,0xbc00,0xbb64b61f,0xbb64361f
.long 0x3c008000,0x3c008000,0x80003c00,0xbc00,0xbc00,0x80003c00,0x3b64b61f,0x3b64361f
.long 0xbc008000,0xbc008000,0xb9a8b9a8,0xb9a839a8,0x80003c00,0xbc00,0xb61f3b64,0xb61fbb64
.long 0x3c008000,0x3c008000,0x3c008000,0x3c008000,0xb9a8b9a8,0xb9a839a8,0xbb64b61f,0xbb64361f
.long 0x80003c00,0xbc00,0x39a839a8,0x39a8b9a8,0x39a8b9a8,0x39a839a8,0xb61fbb64,0xb61f3b64
.long 0xbc008000,0xbc008000,0x80003c00,0xbc00,0x39a839a8,0x39a8b9a8,0x361fbb64,0x361f3b64
.long 0xbc00,0x80003c00,0xb9a839a8,0xb9a8b9a8,0xb9a839a8,0xb9a8b9a8,0x3b64b61f,0x3b64361f
.long 0x3c008000,0x3c008000,0xbc008000,0xbc008000,0xb9a8b9a8,0xb9a839a8,0x3b64361f,0x3b64b61f
.long 0x80003c00,0xbc00,0xb9a8b9a8,0xb9a839a8,0x39a8b9a8,0x39a839a8,0x361f3b64,0x361fbb64
.long 0xbc008000,0xbc008000,0xbc00,0x80003c00,0x39a839a8,0x39a8b9a8,0xb61f3b64,0xb61fbb64
.long 0xbc00,0x80003c00,0x39a8b9a8,0x39a839a8,0xb9a839a8,0xb9a8b9a8,0xbb64361f,0xbb64b61f
.long 0x3800,0x3800,0x3800,0x3800,0x3c00,0xbc00,0x3b64,0x3b64
.long 0x3c00,0x3c00,0x39a8,0x39a8,0x3c00,0xbc00,0x361f,0x361f
.long 0x3c00,0x3c00,0x0,0x8000,0x3c00,0xbc00,0xb61f,0xb61f
.long 0x3c00,0x3c00,0xb9a8,0xb9a8,0x3c00,0xbc00,0xbb64,0xbb64
.long 0x3c000000,0x0,0x3bd90000,0xbbd90000,0x3c000000,0x80000000,0x3aa70000,0xbaa70000
.long 0x3c000000,0x0,0x38720000,0xb8720000,0x3c000000,0x80000000,0x323e0000,0xb23e0000
.long 0x3c000000,0x0,0xb23e0000,0x323e0000,0x3c000000,0x80000000,0xb8720000,0x38720000
.long 0x3c000000,0x0,0xbaa70000,0x3aa70000,0x3c000000,0x80000000,0xbbd90000,0x3bd90000
.long 0x3800,0x3800,0x3800,0x3800,0x39a8,0x39a8,0x361f,0x361f
.long 0x0,0x8000,0xb9a8,0xb9a8,0xb9a8,0xb9a8,0xbb64,0xbb64
.long 0xbc00,0xbc00,0x8000,0x0,0xb9a8,0xb9a8,0x3b64,0x3b64
.long 0x8000,0x0,0x39a8,0x39a8,0x39a8,0x39a8,0xb61f,0xb61f
.long 0x3b640000,0xbb640000,0x3aa70000,0xbaa70000,0x361f0000,0xb61f0000,0xb23e0000,0x323e0000
.long 0xb61f0000,0x361f0000,0xbbd90000,0x3bd90000,0xbb640000,0x3b640000,0xb8720000,0x38720000
.long 0xbb640000,0x3b640000,0x38720000,0xb8720000,0xb61f0000,0x361f0000,0x3bd90000,0xbbd90000
.long 0x361f0000,0xb61f0000,0x323e0000,0xb23e0000,0x3b640000,0xbb640000,0xbaa70000,0x3aa70000
.long 0x3800,0x3800,0x3800,0x3800,0x0,0x8000,0xb61f,0xb61f
.long 0xbc00,0xbc00,0xb9a8,0xb9a8,0x8000,0x0,0x3b64,0x3b64
.long 0x3c00,0x3c00,0x0,0x8000,0x0,0x8000,0xbb64,0xbb64
.long 0xbc00,0xbc00,0x39a8,0x39a8,0x8000,0x0,0x361f,0x361f
.long 0x39a80000,0xb9a80000,0x38720000,0xb8720000,0xb9a80000,0x39a80000,0xbbd90000,0x3bd90000
.long 0xb9a80000,0x39a80000,0x323e0000,0xb23e0000,0x39a80000,0xb9a80000,0x3aa70000,0xbaa70000
.long 0x39a80000,0xb9a80000,0xbaa70000,0x3aa70000,0xb9a80000,0x39a80000,0xb23e0000,0x323e0000
.long 0xb9a80000,0x39a80000,0x3bd90000,0xbbd90000,0x39a80000,0xb9a80000,0xb8720000,0x38720000
.long 0x3800,0x3800,0x3800,0x3800,0xb9a8,0xb9a8,0xbb64,0xbb64
.long 0x8000,0x0,0x39a8,0x39a8,0x39a8,0x39a8,0xb61f,0xb61f
.long 0xbc00,0xbc00,0x8000,0x0,0x39a8,0x39a8,0x361f,0x361f
.long 0x0,0x8000,0xb9a8,0xb9a8,0xb9a8,0xb9a8,0x3b64,0x3b64
.long 0x361f0000,0xb61f0000,0x323e0000,0xb23e0000,0xbb640000,0x3b640000,0xb8720000,0x38720000
.long 0x3b640000,0xbb640000,0x3aa70000,0xbaa70000,0xb61f0000,0x361f0000,0xbbd90000,0x3bd90000
.long 0xb61f0000,0x361f0000,0x3bd90000,0xbbd90000,0x3b640000,0xbb640000,0xbaa70000,0x3aa70000
.long 0xbb640000,0x3b640000,0x38720000,0xb8720000,0x361f0000,0xb61f0000,0xb23e0000,0x323e0000
.long 0x3800,0x3800,0xb800,0xb800,0x8000,0x8000,0xb61f,0x361f
.long 0x8000,0x8000,0xb9a8,0x39a8,0x8000,0x8000,0xbb64,0x3b64
.long 0x8000,0x8000,0xbc00,0x3c00,0x8000,0x8000,0xbb64,0x3b64
.long 0x8000,0x8000,0xb9a8,0x39a8,0x8000,0x8000,0xb61f,0x361f
.long 0x80000000,0xbc000000,0xb23e0000,0xb23e0000,0x80000000,0x3c000000,0xb8720000,0xb8720000
.long 0x80000000,0xbc000000,0xbaa70000,0xbaa70000,0x80000000,0x3c000000,0xbbd90000,0xbbd90000
.long 0x80000000,0xbc000000,0xbbd90000,0xbbd90000,0x80000000,0x3c000000,0xbaa70000,0xbaa70000
.long 0x80000000,0xbc000000,0xb8720000,0xb8720000,0x80000000,0x3c000000,0xb23e0000,0xb23e0000
.long 0x3800,0x3800,0xb800,0xb800,0xb9a8,0x39a8,0xbb64,0x3b64
.long 0xbc00,0x3c00,0xb9a8,0x39a8,0xb9a8,0x39a8,0x361f,0xb61f
.long 0x8000,0x8000,0x3c00,0xbc00,0x39a8,0xb9a8,0x361f,0xb61f
.long 0x3c00,0xbc00,0xb9a8,0x39a8,0x39a8,0xb9a8,0xbb64,0x3b64
.long 0xb61f0000,0xb61f0000,0xb8720000,0xb8720000,0xbb640000,0xbb640000,0xbbd90000,0xbbd90000
.long 0xbb640000,0xbb640000,0xb23e0000,0xb23e0000,0xb61f0000,0xb61f0000,0x3aa70000,0x3aa70000
.long 0x361f0000,0x361f0000,0x3aa70000,0x3aa70000,0x3b640000,0x3b640000,0xb23e0000,0xb23e0000
.long 0x3b640000,0x3b640000,0xbbd90000,0xbbd90000,0x361f0000,0x361f0000,0xb8720000,0xb8720000
.long 0x3800,0x3800,0xb800,0xb800,0xbc00,0x3c00,0xbb64,0x3b64
.long 0x8000,0x8000,0x39a8,0xb9a8,0x3c00,0xbc00,0x361f,0xb61f
.long 0x8000,0x8000,0xbc00,0x3c00,0xbc00,0x3c00,0x361f,0xb61f
.long 0x8000,0x8000,0x39a8,0xb9a8,0x3c00,0xbc00,0xbb64,0x3b64
.long 0xb9a80000,0xb9a80000,0xbaa70000,0xbaa70000,0xb9a80000,0xb9a80000,0xb23e0000,0xb23e0000
.long 0x39a80000,0x39a80000,0x3bd90000,0x3bd90000,0x39a80000,0x39a80000,0xb8720000,0xb8720000
.long 0xb9a80000,0xb9a80000,0xb8720000,0xb8720000,0xb9a80000,0xb9a80000,0x3bd90000,0x3bd90000
.long 0x39a80000,0x39a80000,0xb23e0000,0xb23e0000,0x39a80000,0x39a80000,0xbaa70000,0xbaa70000
.long 0x3800,0x3800,0xb800,0xb800,0xb9a8,0x39a8,0xb61f,0x361f
.long 0x3c00,0xbc00,0x39a8,0xb9a8,0xb9a8,0x39a8,0xbb64,0x3b64
.long 0x8000,0x8000,0x3c00,0xbc00,0x39a8,0xb9a8,0xbb64,0x3b64
.long 0xbc00,0x3c00,0x39a8,0xb9a8,0x39a8,0xb9a8,0xb61f,0x361f
.long 0xbb640000,0xbb640000,0xbbd90000,0xbbd90000,0x361f0000,0x361f0000,0x3aa70000,0x3aa70000
.long 0x361f0000,0x361f0000,0xb8720000,0xb8720000,0xbb640000,0xbb640000,0x323e0000,0x323e0000
.long 0x3b640000,0x3b640000,0x323e0000,0x323e0000,0xb61f0000,0xb61f0000,0xb8720000,0xb8720000
.long 0xb61f0000,0xb61f0000,0x3aa70000,0x3aa70000,0x3b640000,0x3b640000,0xbbd90000,0xbbd90000
tab_end:
.size tables, 36864
.section .rodata,"a"
.p2align 6
.amdhsa_kernel adaLN_cond__spectral_fnet__moe_arch_mod__prompt_kernel
  .amdhsa_next_free_vgpr 256
  .amdhsa_next_free_sgpr 102
  .amdhsa_accum_offset 256
  .amdhsa_group_segment_fixed_size 0
  .amdhsa_kernarg_size 120
  .amdhsa_user_sgpr_count 2
  .amdhsa_user_sgpr_kernarg_segment_ptr 1
  .amdhsa_system_sgpr_workgroup_id_x 1
  .amdhsa_float_denorm_mode_32 3
  .amdhsa_float_denorm_mode_16_64 3
.end_amdhsa_kernel
```

```asm
; @launch grid=(256,1,1) block=(512,1,1) lds=139264
.amdgcn_target "amdgcn-amd-amdhsa--gfx950"
.text
.globl adaLN_cond__spectral_fnet__moe_arch_mod__prompt_kernel
.p2align 8
.type adaLN_cond__spectral_fnet__moe_arch_mod__prompt_kernel,@function
adaLN_cond__spectral_fnet__moe_arch_mod__prompt_kernel:
    s_cmp_ge_u32 s2, 256
    s_cbranch_scc1 k_done
    s_load_dwordx2 s[4:5], s[0:1], 0
    s_load_dwordx8 s[20:27], s[0:1], 80
    s_load_dwordx2 s[6:7], s[0:1], 112
    s_load_dwordx8 s[48:55], s[0:1], 48
    s_getpc_b64 s[62:63]
k_pc:
    v_lshrrev_b32 v1, 6, v0
    v_and_b32 v2, 63, v0
    v_readfirstlane_b32 s16, v1
    v_lshlrev_b32 v3, 4, v2
    s_and_b32 s34, s2, 7
    s_lshr_b32 s35, s2, 4
    s_bitcmp1_b32 s2, 3
    s_cbranch_scc0 f_start
    s_lshl_b32 s40, s35, 3
    s_add_u32 s40, s40, s16
    s_lshl_b32 s40, s40, 9
    v_lshl_add_u32 v4, v2, 7, s40
    v_min_u32 v4, tab_end-k_pc-4, v4
    s_mov_b64 exec, 15
    global_load_dword v250, v4, s[62:63]
    s_mov_b64 exec, -1
    v_bfe_u32 v7, v0, 4, 2
    v_lshlrev_b32 v4, 1, v7
    v_xor_b32 v4, v4, v0
    v_and_b32 v4, 15, v4
    v_lshlrev_b32 v4, 4, v4
    s_movk_i32 s42, 12288
    v_mad_u32_u24 v4, v7, s42, v4
    v_xor_b32 v31, 0x80, v4
    s_and_b32 s17, s35, 7
    s_lshr_b32 s41, s35, 3
    s_lshl_b32 s18, s34, 3
    s_add_u32 s18, s18, s16
    s_mul_i32 s18, s18, 196608
    s_lshl_b32 s68, s16, 12
    s_xor_b32 s70, s35, 8
    s_lshl_b32 s70, s70, 8
    s_add_u32 s70, s70, s18
    s_mov_b32 s10, 12582912
    s_mov_b32 s11, 0x00020000
    s_mov_b32 m0, s68
    s_waitcnt lgkmcnt(0)
    s_mov_b32 s8, s22
    s_mov_b32 s9, s23
    buffer_load_dwordx4 v4, s[8:11], s70 offen offset:0  lds
    s_add_u32 s70, s70, 48128
    buffer_load_dwordx4 v4, s[8:11], s70 offen offset:1024  lds
    s_add_u32 s70, s70, 48128
    buffer_load_dwordx4 v31, s[8:11], s70 offen offset:2048  lds
    s_add_u32 s70, s70, 48128
    buffer_load_dwordx4 v31, s[8:11], s70 offen offset:3072  lds
    s_branch g_start
f_start:
    s_add_u32 s62, s62, tables-k_pc
    s_addc_u32 s63, s63, 0
    s_lshl_b32 s43, s16, 11
    v_add_u32 v79, s43, v3
    s_add_u32 s40, s43, 33280
    s_lshl_b32 s42, s16, 10
    s_add_u32 s43, s42, 16384
    s_cmp_eq_u32 s34, 0
    s_cselect_b32 s68, 8192, 0
    s_add_u32 s43, s43, s68
    v_add_u32 v77, s43, v3
    s_or_b32 s69, s34, s16
    s_cselect_b32 s68, 0, 2048
    s_add_u32 s68, s68, 32768
    v_add_u32 v78, s68, v3
    s_sub_u32 s17, 16, s34
    s_cmp_eq_u32 s34, 0
    s_cselect_b32 s17, 8, s17
    s_bitcmp1_b32 s35, 0
    s_cselect_b32 s17, s17, s34
    s_lshr_b32 s36, s35, 1
    s_lshl_b32 s36, s36, 4
    s_add_u32 s17, s17, s36
    s_lshl_b32 s36, s16, 8
    s_add_u32 s36, s36, s17
    s_lshl_b32 s36, s36, 11
    s_add_u32 s37, s36, 262144
    s_mov_b32 s10, 4194304
    s_mov_b32 s11, 0x00020000
    v_and_b32 v170, 15, v0
    v_bfe_u32 v171, v0, 4, 2
    v_lshrrev_b32 v72, 1, v170
    v_and_b32 v73, 1, v0
    v_cmp_eq_u32 vcc, 1, v170
    v_mov_b32 v74, s17
    s_nop 0
    v_cndmask_b32_e64 v72, v72, 8, vcc
    v_cndmask_b32_e64 v74, v74, 0, vcc
    v_cndmask_b32_e64 v73, v73, 0, vcc
    v_lshl_add_u32 v74, v171, 9, v74
    s_waitcnt lgkmcnt(0)
    s_mov_b32 s8, s4
    s_mov_b32 s9, s5
    buffer_load_dwordx4 v[32:35], v3, s[8:11], s36 offen offset:0
    buffer_load_dwordx4 v[40:43], v3, s[8:11], s37 offen offset:0
    buffer_load_dwordx4 v[36:39], v3, s[8:11], s36 offen offset:1024
    buffer_load_dwordx4 v[44:47], v3, s[8:11], s37 offen offset:1024
    s_mov_b32 s43, 6619136
    s_load_dword s101, s[6:7], s43
    s_mov_b32 s12, s6
    s_mov_b32 s13, s7
    s_mov_b32 s14, 268435456
    s_mov_b32 s15, 0x00020000
    s_mov_b32 s20, s52
    s_mov_b32 s21, s53
    s_mov_b32 s22, 7340032
    s_mov_b32 s23, 0x00020000
    s_mov_b32 s26, 4194304
    s_mov_b32 s27, 0x00020000
    s_getreg_b32 s39, hwreg(HW_REG_XCC_ID)
    s_and_b32 s39, s39, 7
    v_mul_u32_u24 v74, v72, v74
    v_lshl_add_u32 v74, v73, 9, v74
    v_lshlrev_b32 v72, 7, v72
    v_and_b32 v48, 2047, v74
    v_add_u32 v74, v74, v72
    v_and_b32 v49, 2047, v74
    v_add_u32 v74, v74, v72
    v_and_b32 v50, 2047, v74
    v_add_u32 v74, v74, v72
    v_and_b32 v51, 2047, v74
    v_cvt_f32_u32 v48, v48
    v_cvt_f32_u32 v49, v49
    v_cvt_f32_u32 v50, v50
    v_cvt_f32_u32 v51, v51
    v_mul_f32 v48, 0x3a000000, v48
    v_mul_f32 v49, 0x3a000000, v49
    v_mul_f32 v50, 0x3a000000, v50
    v_mul_f32 v51, 0x3a000000, v51
    v_cos_f32 v48, v48
    v_cos_f32 v49, v49
    v_cos_f32 v50, v50
    v_cos_f32 v51, v51
    v_mul_f32 v48, 0x3d800000, v48
    v_mul_f32 v49, 0x3d800000, v49
    v_mul_f32 v50, 0x3d800000, v50
    v_mul_f32 v51, 0x3d800000, v51
    v_lshlrev_b32 v160, 20, v171
    v_lshl_add_u32 v160, v1, 15, v160
    v_lshl_add_u32 v160, v170, 4, v160
    v_mul_u32_u24 v161, 4128, v1
    v_add_u32 v161, v161, v3
    v_lshrrev_b32 v72, 2, v2
    v_mul_u32_u24 v162, 2064, v72
    v_and_b32 v72, 3, v0
    v_lshl_add_u32 v162, v72, 7, v162
    v_lshl_add_u32 v162, v1, 3, v162
    v_lshlrev_b32 v163, 4, v171
    v_add_u32 v163, 103040, v163
    v_lshlrev_b32 v164, 3, v171
    v_add_u32 v164, 103104, v164
    v_lshrrev_b32 v72, 5, v0
    v_lshlrev_b32 v165, 2, v72
    v_add_u32 v11, 102912, v165
    v_add_u32 v165, 103040, v165
    v_lshlrev_b32 v166, 1, v72
    v_add_u32 v166, 103104, v166
    v_mov_b32 v168, 0
    v_and_b32 v169, 1, v0
    v_lshlrev_b32 v169, 3, v169
    s_lshl_b32 s3, s34, 4
    s_and_b32 s64, s35, 1
    s_lshl_b32 s64, s64, 3
    s_lshr_b32 s65, s35, 1
    s_add_u32 s64, s64, s65
    s_and_b32 s65, s16, 3
    s_xor_b32 s64, s64, s65
    s_add_u32 s64, s64, s3
    s_add_u32 s3, s3, s35
    s_lshl_b32 s64, s64, 8
    s_add_u32 s64, s64, 0
    s_add_u32 s65, s64, 262144
    s_add_u32 s66, s64, 524288
    s_add_u32 s67, s64, 786432
    s_mov_b32 s44, 0x3f803f80
    s_mov_b32 s46, 0x3a800000
    s_mov_b32 s33, 196611
    s_lshl_b32 s60, s35, 3
    s_add_u32 s60, s60, s16
    s_lshl_b32 s30, s60, 4
    s_add_u32 s30, s30, s34
    s_cmp_lg_u32 s34, 0
    s_cbranch_scc1 f_g1
    s_cmp_ge_u32 s16, 4
    s_cselect_b32 s31, 56, 0
    s_sub_u32 s30, s30, s31
    s_cmp_lg_u32 s16, 0
    s_cbranch_scc1 f_g1
    s_cmp_ge_u32 s35, 8
    s_cselect_b32 s31, 960, 0
    s_sub_u32 s30, s30, s31
f_g1:
    s_sub_u32 s31, 2048, s30
    s_cmp_eq_u32 s30, 0
    s_cselect_b32 s31, 1024, s31
    s_lshl_b32 s18, s30, 11
    s_lshl_b32 s19, s31, 11
    s_lshl_b32 s61, s34, 19
    s_add_u32 s61, s61, 0
    s_lshl_b32 s28, s60, 8
    s_add_u32 s28, s28, s61
    s_add_u32 s29, s28, 131072
    s_add_u32 s50, s28, 262144
    s_add_u32 s51, s28, 393216
    s_lshl_b32 s73, s35, 15
    s_add_u32 s73, s73, s61
    s_lshl_b32 s42, s16, 12
    s_add_u32 s72, s73, s42
    s_add_u32 s45, s42, 49664
    s_lshl_b32 s42, s16, 8
    s_add_u32 s74, s73, s42
    s_add_u32 s75, s74, 4096
    s_lshl_b32 s76, s34, 7
    s_add_u32 s77, s76, 6509568
    s_add_u32 s76, s76, 6508544
    s_lshl_b32 s78, s35, 3
    s_add_u32 s79, s78, s77
    s_add_u32 s78, s78, s76
    s_lshl_b32 s80, s3, 4
    s_add_u32 s80, s80, 4947968
    s_lshl_b32 s81, s34, 12
    s_add_u32 s81, s81, 4947968
    s_lshl_b32 s82, s35, 11
    s_add_u32 s82, s82, 6291456
    v_cvt_f32_u32 v75, v170
    s_lshl_b32 s42, s35, 2
    s_and_b32 s43, s16, 3
    s_add_u32 s42, s42, s43
    v_lshl_add_u32 v76, v171, 8, s42
    v_mul_f32 v75, 0x3a800000, v75
    v_cvt_f32_u32 v76, v76
    v_mul_f32 v60, v76, v75
    v_fmamk_f32 v61, v75, 0x42800000, v60
    v_fmamk_f32 v62, v75, 0x43000000, v60
    v_fmamk_f32 v63, v75, 0x43400000, v60
    v_cos_f32 v64, v60
    v_cos_f32 v65, v61
    v_cos_f32 v66, v62
    v_cos_f32 v67, v63
    v_sin_f32 v68, v60
    v_sin_f32 v69, v61
    v_sin_f32 v70, v62
    v_sin_f32 v71, v63
    v_cvt_pk_f16_f32 v144, v64, v68
    v_cvt_pk_f16_f32 v145, v65, v69
    v_cvt_pk_f16_f32 v146, v66, v70
    v_cvt_pk_f16_f32 v147, v67, v71
    s_mov_b32 m0, s40
    s_nop 0
    global_load_lds_dwordx4 v79, s[62:63]
    global_load_lds_dwordx4 v79, s[62:63] offset:1024
    global_load_dwordx4 v[20:23], v77, s[62:63]
    global_load_dwordx4 v[24:27], v78, s[62:63]
    global_load_dwordx4 v[28:31], v78, s[62:63] offset:1024
    s_waitcnt lgkmcnt(0)
    s_mul_i32 s32, s101, 0x9e3779b1
    s_or_b32 s32, s32, 0x101
    s_and_b32 s32, s32, 0xfffefbfb
    s_and_b32 s56, s32, 0xff
    s_bfe_u32 s57, s32, 0x80008
    s_bfe_u32 s58, s32, 0x80010
    s_lshr_b32 s59, s32, 24
    v_lshrrev_b32 v16, v169, s32
    v_lshrrev_b32 v17, 2, v16
    v_lshrrev_b32 v18, 4, v16
    v_lshrrev_b32 v19, 6, v16
    v_mov_b32 v72, s32
    v_mov_b32 v73, s39
    v_mov_b32 v74, 111488
    s_cmp_eq_u32 s16, 0
    s_cselect_b64 exec, 1, 0
    ds_write_b32 v74, v168 offset:4
    buffer_store_dwordx2 v[72:73], v168, s[12:15], s78 offen sc1
    s_mov_b64 exec, -1
    v_mov_b32 v72, -1
    ds_write_b32 v11, v72 offset:64
    s_waitcnt vmcnt(9)
    ds_write_b128 v161, v[32:35] offset:0
    v_dot2_f32_bf16 v52, v32, s44, 0
    v_dot2_f32_bf16 v54, v32, v32, 0
    v_dot2_f32_bf16 v52, v33, s44, v52
    v_dot2_f32_bf16 v54, v33, v33, v54
    v_dot2_f32_bf16 v52, v34, s44, v52
    v_dot2_f32_bf16 v54, v34, v34, v54
    v_dot2_f32_bf16 v52, v35, s44, v52
    v_dot2_f32_bf16 v54, v35, v35, v54
    s_waitcnt vmcnt(8)
    ds_write_b128 v161, v[40:43] offset:2064
    v_dot2_f32_bf16 v53, v40, s44, 0
    v_dot2_f32_bf16 v55, v40, v40, 0
    v_dot2_f32_bf16 v53, v41, s44, v53
    v_dot2_f32_bf16 v55, v41, v41, v55
    v_dot2_f32_bf16 v53, v42, s44, v53
    v_dot2_f32_bf16 v55, v42, v42, v55
    v_dot2_f32_bf16 v53, v43, s44, v53
    v_dot2_f32_bf16 v55, v43, v43, v55
    s_waitcnt vmcnt(7)
    ds_write_b128 v161, v[36:39] offset:1024
    v_dot2_f32_bf16 v52, v36, s44, v52
    v_dot2_f32_bf16 v54, v36, v36, v54
    v_dot2_f32_bf16 v52, v37, s44, v52
    v_dot2_f32_bf16 v54, v37, v37, v54
    v_dot2_f32_bf16 v52, v38, s44, v52
    v_dot2_f32_bf16 v54, v38, v38, v54
    v_dot2_f32_bf16 v52, v39, s44, v52
    v_dot2_f32_bf16 v54, v39, v39, v54
    s_waitcnt vmcnt(6)
    ds_write_b128 v161, v[44:47] offset:3088
    v_dot2_f32_bf16 v53, v44, s44, v53
    v_dot2_f32_bf16 v55, v44, v44, v55
    v_dot2_f32_bf16 v53, v45, s44, v53
    v_dot2_f32_bf16 v55, v45, v45, v55
    v_dot2_f32_bf16 v53, v46, s44, v53
    v_dot2_f32_bf16 v55, v46, v46, v55
    v_dot2_f32_bf16 v53, v47, s44, v53
    v_dot2_f32_bf16 v55, v47, v47, v55
    s_nop 2
    v_permlane32_swap_b32 v52, v53
    v_permlane32_swap_b32 v54, v55
    v_add_f32 v52, v52, v53
    v_add_f32 v54, v54, v55
    s_nop 0
    v_add_f32_dpp v52, v52, v52 row_ror:8 row_mask:0xf bank_mask:0xf
    v_add_f32_dpp v54, v54, v54 row_ror:8 row_mask:0xf bank_mask:0xf
    s_nop 0
    v_add_f32_dpp v52, v52, v52 row_ror:4 row_mask:0xf bank_mask:0xf
    v_add_f32_dpp v54, v54, v54 row_ror:4 row_mask:0xf bank_mask:0xf
    s_nop 0
    v_add_f32_dpp v52, v52, v52 row_ror:2 row_mask:0xf bank_mask:0xf
    v_add_f32_dpp v54, v54, v54 row_ror:2 row_mask:0xf bank_mask:0xf
    s_nop 0
    v_add_f32_dpp v52, v52, v52 row_ror:1 row_mask:0xf bank_mask:0xf
    v_add_f32_dpp v54, v54, v54 row_ror:1 row_mask:0xf bank_mask:0xf
    s_nop 0
    v_add_f32_dpp v52, v52, v52 row_bcast:15 row_mask:0xa bank_mask:0xf
    v_add_f32_dpp v54, v54, v54 row_bcast:15 row_mask:0xa bank_mask:0xf
    v_mul_f32 v52, s46, v52
    v_mul_f32 v54, s46, v54
    v_mul_f32 v64, v52, v52
    v_cvt_pk_bf16_f32 v56, -v52, -v52
    v_sub_f32 v54, v54, v64
    v_mul_f32 v66, 0x44000000, v54
    v_cmp_gt_f32 vcc, v64, v66
    s_or_b32 s68, vcc_lo, vcc_hi
    s_bitcmp1_b32 s68, 31
    s_cbranch_scc1 f_slowvar
f_var:
    v_cvt_pk_bf16_f32 v54, v54, v54
    v_lshlrev_b32 v54, 16, v54
    v_add_f32 v54, 0x3727c5ac, v54
    v_cvt_pk_bf16_f32 v54, v54, v54
    v_lshlrev_b32 v54, 16, v54
    v_sqrt_f32 v54, v54
    s_nop 0
    v_cvt_pk_bf16_f32 v54, v54, v54
    v_lshlrev_b32 v54, 16, v54
    v_rcp_f32 v54, v54
    s_mov_b32 exec_lo, 0x80000000
    s_mov_b32 exec_hi, 0x80000000
    ds_write_b16 v166, v56
    ds_write_b32 v165, v54
    s_mov_b64 exec, -1
    s_waitcnt lgkmcnt(0)
    s_barrier
    ds_read_b128 v[60:63], v163
    ds_read_b64 v[64:65], v164
    ds_read_b64_tr_b16 v[80:81], v162 offset:0
    ds_read_b64_tr_b16 v[82:83], v162 offset:512
    ds_read_b64_tr_b16 v[84:85], v162 offset:1024
    ds_read_b64_tr_b16 v[86:87], v162 offset:1536
    ds_read_b64_tr_b16 v[88:89], v162 offset:64
    ds_read_b64_tr_b16 v[90:91], v162 offset:576
    ds_read_b64_tr_b16 v[92:93], v162 offset:1088
    ds_read_b64_tr_b16 v[94:95], v162 offset:1600
    s_waitcnt lgkmcnt(8)
    v_pk_mul_f32 v[48:49], v[48:49], v[60:61]
    v_pk_mul_f32 v[50:51], v[50:51], v[62:63]
    v_cvt_pk_bf16_f32 v58, v48, v49
    v_cvt_pk_bf16_f32 v59, v50, v51
    s_nop 1
    v_mfma_f32_16x16x16_bf16 v[96:99], v[58:59], v[64:65], 0
    s_waitcnt lgkmcnt(0)
    v_mfma_f32_16x16x16_bf16 v[100:103], v[58:59], v[80:81], v[96:99]
    v_mfma_f32_16x16x16_bf16 v[104:107], v[58:59], v[82:83], v[96:99]
    v_mfma_f32_16x16x16_bf16 v[108:111], v[58:59], v[84:85], v[96:99]
    v_mfma_f32_16x16x16_bf16 v[112:115], v[58:59], v[86:87], v[96:99]
    v_mfma_f32_16x16x16_bf16 v[116:119], v[58:59], v[88:89], v[96:99]
    v_mfma_f32_16x16x16_bf16 v[120:123], v[58:59], v[90:91], v[96:99]
    v_mfma_f32_16x16x16_bf16 v[124:127], v[58:59], v[92:93], v[96:99]
    v_mfma_f32_16x16x16_bf16 v[128:131], v[58:59], v[94:95], v[96:99]
    s_nop 0
    v_cvt_pk_f16_f32 v176, v100, v101
    v_cvt_pk_f16_f32 v177, v104, v105
    v_cvt_pk_f16_f32 v178, v108, v109
    v_cvt_pk_f16_f32 v179, v112, v113
    v_bfi_b32 v176, s33, v16, v176
    v_bfi_b32 v177, s33, v17, v177
    v_bfi_b32 v178, s33, v18, v178
    v_bfi_b32 v179, s33, v19, v179
    buffer_store_dwordx4 v[176:179], v160, s[12:15], s64 offen sc1
    v_cvt_pk_f16_f32 v180, v102, v103
    v_cvt_pk_f16_f32 v181, v106, v107
    v_cvt_pk_f16_f32 v182, v110, v111
    v_cvt_pk_f16_f32 v183, v114, v115
    v_bfi_b32 v180, s33, v16, v180
    v_bfi_b32 v181, s33, v17, v181
    v_bfi_b32 v182, s33, v18, v182
    v_bfi_b32 v183, s33, v19, v183
    buffer_store_dwordx4 v[180:183], v160, s[12:15], s66 offen sc1
    v_cvt_pk_f16_f32 v184, v116, v117
    v_cvt_pk_f16_f32 v185, v120, v121
    v_cvt_pk_f16_f32 v186, v124, v125
    v_cvt_pk_f16_f32 v187, v128, v129
    v_bfi_b32 v184, s33, v16, v184
    v_bfi_b32 v185, s33, v17, v185
    v_bfi_b32 v186, s33, v18, v186
    v_bfi_b32 v187, s33, v19, v187
    buffer_store_dwordx4 v[184:187], v160, s[12:15], s65 offen sc1
    v_cvt_pk_f16_f32 v188, v118, v119
    v_cvt_pk_f16_f32 v189, v122, v123
    v_cvt_pk_f16_f32 v190, v126, v127
    v_cvt_pk_f16_f32 v191, v130, v131
    v_bfi_b32 v188, s33, v16, v188
    v_bfi_b32 v189, s33, v17, v189
    v_bfi_b32 v190, s33, v18, v190
    v_bfi_b32 v191, s33, v19, v191
    buffer_store_dwordx4 v[188:191], v160, s[12:15], s67 offen sc1
    s_waitcnt vmcnt(4)
    s_barrier
    v_mov_b32 v48, v170
    v_mov_b32 v49, v171
    v_mov_b32 v50, s32
    v_mov_b32 v51, s39
    ds_read_b128 v[192:195], v3 offset:33280
    ds_read_b128 v[196:199], v3 offset:34304
    ds_read_b128 v[200:203], v3 offset:35328
    ds_read_b128 v[204:207], v3 offset:36352
    ds_read_b128 v[208:211], v3 offset:37376
    ds_read_b128 v[212:215], v3 offset:38400
    ds_read_b128 v[216:219], v3 offset:39424
    ds_read_b128 v[220:223], v3 offset:40448
    ds_read_b128 v[224:227], v3 offset:41472
    ds_read_b128 v[228:231], v3 offset:42496
    ds_read_b128 v[232:235], v3 offset:43520
    ds_read_b128 v[236:239], v3 offset:44544
    v_lshlrev_b32 v4, 15, v49
    v_lshl_add_u32 v4, v48, 4, v4
    v_lshlrev_b32 v14, 13, v49
    v_lshl_add_u32 v14, v48, 4, v14
    v_lshl_add_u32 v254, v1, 10, v14
    v_xor_b32 v255, 64, v254
    v_lshrrev_b32 v57, 1, v1
    v_lshlrev_b32 v252, 13, v57
    v_and_b32 v57, 1, v1
    v_lshl_add_u32 v252, v57, 3, v252
    v_lshl_add_u32 v252, v49, 11, v252
    v_and_b32 v57, 3, v0
    v_lshl_add_u32 v252, v57, 8, v252
    v_lshrrev_b32 v58, 2, v48
    v_lshl_add_u32 v252, v58, 4, v252
    v_and_b32 v59, 1, v0
    v_lshl_add_u32 v252, v59, 6, v252
    v_xor_b32 v253, 64, v252
    v_lshl_add_u32 v57, v49, 2, v57
    v_lshlrev_b32 v57, 4, v57
    v_lshl_add_u32 v250, v58, 8, v57
    v_add_u32 v5, 82432, v3
    v_sub_u32 v6, 83440, v3
    v_lshl_add_u32 v57, v48, 2, v49
    v_lshl_add_u32 v8, v57, 3, s45
    s_add_u32 s43, s45, 2552
    v_lshlrev_b32 v58, 3, v57
    v_sub_u32 v9, s43, v58
    v_add_u32 v57, 1, v57
    v_and_b32 v58, 3, v57
    v_and_b32 v57, 60, v57
    v_lshl_add_u32 v7, v58, 6, v57
    v_add_u32 v10, s45, v3
    v_lshlrev_b32 v12, 2, v48
    v_add_u32 v12, 102912, v12
    v_lshlrev_b32 v13, 12, v2
    v_and_b32 v251, 0x70, v3
    v_lshlrev_b32 v15, 4, v0
    v_and_b32 v57, 3, v0
    v_bfe_u32 v58, v0, 2, 4
    v_lshl_add_u32 v57, v57, 4, v58
    v_bfe_u32 v58, v0, 6, 2
    v_lshl_add_u32 v57, v58, 6, v57
    v_lshrrev_b32 v58, 8, v0
    v_lshl_add_u32 v57, v58, 9, v57
    v_lshlrev_b32 v57, 4, v57
    v_add_u32 v1, 82432, v57
    s_and_b32 s42, s35, 3
    s_lshl_b32 s42, s42, 8
    v_xor_b32 v249, s42, v3
    s_mov_b32 s44, 131074
    v_and_b32 v16, s33, v16
    v_and_b32 v17, s33, v17
    v_and_b32 v18, s33, v18
    v_and_b32 v19, s33, v19
    v_xor_b32 v16, s44, v16
    v_xor_b32 v17, s44, v17
    v_xor_b32 v18, s44, v18
    v_xor_b32 v19, s44, v19
    s_mov_b32 s41, 6496256
    s_and_b32 s40, s16, 4
    s_lshl_b32 s40, s40, 10
    s_sub_u32 s40, 6504448, s40
    s_lshl_b32 s54, s3, 13
    s_add_u32 s54, s54, 5242880
    s_lshr_b32 s43, s60, 6
    s_and_b32 s55, s60, 63
    s_mul_i32 s55, s55, 5
    s_lshl_b32 s43, s43, 9
    s_add_u32 s55, s55, s43
    s_add_u32 s55, s55, 192
    s_mul_i32 s55, s55, 7168
    s_mul_i32 s43, s34, 896
    s_add_u32 s55, s55, s43
    s_mov_b32 s48, 4294967295
    s_mov_b32 s49, 255
    s_cmp_lt_u32 s16, 0
    s_cselect_b64 s[48:49], 0, s[48:49]
    s_mov_b32 s52, 6488064
    s_mov_b32 s53, 6492160
    s_barrier
    s_mov_b32 m0, s45
    s_add_u32 s43, s45, 2048
    buffer_load_dwordx4 v3, s[8:11], s18 offen lds
    buffer_load_dwordx4 v3, s[8:11], s18 offen offset:1024 lds
    s_mov_b32 m0, s43
    s_nop 0
    buffer_load_dwordx4 v3, s[8:11], s19 offen lds
    buffer_load_dwordx4 v3, s[8:11], s19 offen offset:1024 lds
    buffer_load_dwordx4 v[244:247], v251, s[12:15], s76 offen
    v_add_u32 v248, 103296, v3
    s_mov_b32 s47, 2
    s_mov_b32 s4, 0
    s_mov_b32 s83, 0
    s_cmp_ge_u32 s16, 4
    s_cbranch_scc1 f_s0
    s_sleep 4
    s_cmp_lg_u32 s34, 0
    s_cbranch_scc1 f_ci0
    s_add_u32 s68, s82, 32768
    buffer_load_dwordx4 v[120:123], v250, s[12:15], s68 offen offset:0
    buffer_load_dwordx4 v[124:127], v250, s[12:15], s68 offen offset:1024
f_ci0:
    buffer_load_dwordx4 v[112:115], v250, s[12:15], s82 offen offset:0
    buffer_load_dwordx4 v[116:119], v250, s[12:15], s82 offen offset:1024
    s_mov_b32 s47, 0
    s_waitcnt vmcnt(0)
f_c1:
    v_xor_b32 v112, s56, v112
    v_xor_b32 v113, s57, v113
    v_xor_b32 v114, s58, v114
    v_xor_b32 v115, s59, v115
    v_xor_b32 v116, s56, v116
    v_xor_b32 v117, s57, v117
    v_xor_b32 v118, s58, v118
    v_xor_b32 v119, s59, v119
    v_or3_b32 v48, v112, v113, v114
    v_or3_b32 v48, v48, v115, v116
    v_or3_b32 v48, v48, v117, v118
    v_or_b32 v48, v48, v119
    v_and_b32 v48, 0xff, v48
    v_cmp_ne_u32 vcc, 0, v48
    s_cmp_lg_u32 s34, 0
    s_cbranch_scc1 f_c1n
    s_mov_b64 s[68:69], vcc
    v_xor_b32 v120, s56, v120
    v_xor_b32 v121, s57, v121
    v_xor_b32 v122, s58, v122
    v_xor_b32 v123, s59, v123
    v_xor_b32 v124, s56, v124
    v_xor_b32 v125, s57, v125
    v_xor_b32 v126, s58, v126
    v_xor_b32 v127, s59, v127
    v_or3_b32 v48, v120, v121, v122
    v_or3_b32 v48, v48, v123, v124
    v_or3_b32 v48, v48, v125, v126
    v_or_b32 v48, v48, v127
    v_and_b32 v48, 0xff, v48
    v_cmp_ne_u32 vcc, 0, v48
    s_or_b64 vcc, vcc, s[68:69]
f_c1n:
    s_cbranch_vccnz f_c1bad
f_c1ok:
    v_pk_add_f32 v[112:113], v[112:113], v[116:117]
    v_pk_add_f32 v[114:115], v[114:115], v[118:119]
    s_nop 0
    v_add_f32_dpp v112, v112, v112 row_ror:4 row_mask:0xf bank_mask:0xf
    v_add_f32_dpp v113, v113, v113 row_ror:4 row_mask:0xf bank_mask:0xf
    v_add_f32_dpp v114, v114, v114 row_ror:4 row_mask:0xf bank_mask:0xf
    v_add_f32_dpp v115, v115, v115 row_ror:4 row_mask:0xf bank_mask:0xf
    v_add_f32_dpp v112, v112, v112 row_ror:8 row_mask:0xf bank_mask:0xf
    v_add_f32_dpp v113, v113, v113 row_ror:8 row_mask:0xf bank_mask:0xf
    v_add_f32_dpp v114, v114, v114 row_ror:8 row_mask:0xf bank_mask:0xf
    v_add_f32_dpp v115, v115, v115 row_ror:8 row_mask:0xf bank_mask:0xf
    v_cvt_pk_bf16_f32 v48, v112, v113
    v_lshlrev_b32 v112, 16, v48
    v_and_b32 v113, 0xffff0000, v48
    v_cvt_pk_bf16_f32 v49, v114, v115
    v_lshlrev_b32 v114, 16, v49
    v_and_b32 v115, 0xffff0000, v49
    v_add_f32 v112, 1.0, v112
    v_add_f32 v113, 1.0, v113
    v_add_f32 v114, 1.0, v114
    v_add_f32 v115, 1.0, v115
    v_cvt_pk_bf16_f32 v48, v112, v113
    v_lshlrev_b32 v112, 16, v48
    v_and_b32 v113, 0xffff0000, v48
    v_cvt_pk_bf16_f32 v49, v114, v115
    v_lshlrev_b32 v114, 16, v49
    v_and_b32 v115, 0xffff0000, v49
    v_max_f32_e64 v48, abs(v112), abs(v113)
    v_max3_f32 v48, abs(v114), abs(v115), v48
    s_cmp_lg_u32 s34, 0
    s_cbranch_scc1 f_c1m
    v_mov_b32 v50, v48
    v_pk_add_f32 v[120:121], v[120:121], v[124:125]
    v_pk_add_f32 v[122:123], v[122:123], v[126:127]
    s_nop 0
    v_add_f32_dpp v120, v120, v120 row_ror:4 row_mask:0xf bank_mask:0xf
    v_add_f32_dpp v121, v121, v121 row_ror:4 row_mask:0xf bank_mask:0xf
    v_add_f32_dpp v122, v122, v122 row_ror:4 row_mask:0xf bank_mask:0xf
    v_add_f32_dpp v123, v123, v123 row_ror:4 row_mask:0xf bank_mask:0xf
    v_add_f32_dpp v120, v120, v120 row_ror:8 row_mask:0xf bank_mask:0xf
    v_add_f32_dpp v121, v121, v121 row_ror:8 row_mask:0xf bank_mask:0xf
    v_add_f32_dpp v122, v122, v122 row_ror:8 row_mask:0xf bank_mask:0xf
    v_add_f32_dpp v123, v123, v123 row_ror:8 row_mask:0xf bank_mask:0xf
    v_cvt_pk_bf16_f32 v48, v120, v121
    v_lshlrev_b32 v120, 16, v48
    v_and_b32 v121, 0xffff0000, v48
    v_cvt_pk_bf16_f32 v49, v122, v123
    v_lshlrev_b32 v122, 16, v49
    v_and_b32 v123, 0xffff0000, v49
    v_max3_f32 v48, abs(v120), abs(v121), v50
    v_max3_f32 v48, abs(v122), abs(v123), v48
f_c1m:
    s_nop 1
    v_max_f32_dpp v48, v48, v48 quad_perm:[1,0,3,2] row_mask:0xf bank_mask:0xf
    s_nop 1
    v_max_f32_dpp v48, v48, v48 quad_perm:[2,3,0,1] row_mask:0xf bank_mask:0xf
    s_nop 0
    v_readlane_b32 s68, v48, 0
    v_readlane_b32 s69, v48, 16
    v_readlane_b32 s70, v48, 32
    v_readlane_b32 s71, v48, 48
    s_max_u32 s68, s68, s69
    s_max_u32 s70, s70, s71
    s_max_u32 s68, s68, s70
    s_lshr_b32 s68, s68, 23
    s_sub_u32 s69, s68, 120
    s_sub_i32 s68, s68, 127
    s_max_i32 s68, s68, -100
    s_min_i32 s68, s68, 120
    s_cmp_le_u32 s69, 9
    s_cselect_b32 s68, 2, s68
    s_cselect_b32 s17, 0, 0x20000
    s_sub_i32 s69, 127, s68
    s_lshl_b32 s69, s69, 23
    s_bitcmp1_b32 s16, 0
    s_cselect_b64 s[64:65], -1, 0
    s_bitcmp1_b32 s16, 1
    s_cselect_b64 s[66:67], -1, 0
    s_lshl_b32 s70, s16, 11
    v_cndmask_b32 v112, v112, v113, s[64:65]
    v_cndmask_b32 v114, v114, v115, s[64:65]
    v_cndmask_b32 v112, v112, v114, s[66:67]
    v_mul_f32 v112, s69, v112
    v_add_u32 v53, s70, v248
    v_cvt_pk_f16_f32 v48, v112, v112
    s_nop 0
    s_nop 0
    v_mov_b32_dpp v56, v48 quad_perm:[0,0,0,0] row_mask:0xf bank_mask:0xf
    v_mov_b32_dpp v57, v48 quad_perm:[1,1,1,1] row_mask:0xf bank_mask:0xf
    v_mov_b32_dpp v58, v48 quad_perm:[2,2,2,2] row_mask:0xf bank_mask:0xf
    v_mov_b32_dpp v59, v48 quad_perm:[3,3,3,3] row_mask:0xf bank_mask:0xf
    v_pk_mul_f16 v64, v144, v56
    v_pk_mul_f16 v68, v144, v56 op_sel:[1,0] op_sel_hi:[0,1] neg_lo:[1,0]
    v_pk_mul_f16 v65, v145, v57
    v_pk_mul_f16 v69, v145, v57 op_sel:[1,0] op_sel_hi:[0,1] neg_lo:[1,0]
    v_pk_mul_f16 v66, v146, v58
    v_pk_mul_f16 v70, v146, v58 op_sel:[1,0] op_sel_hi:[0,1] neg_lo:[1,0]
    v_pk_mul_f16 v67, v147, v59
    v_pk_mul_f16 v71, v147, v59 op_sel:[1,0] op_sel_hi:[0,1] neg_lo:[1,0]
    ds_write_b128 v53, v[64:67]
    ds_write_b128 v53, v[68:71] offset:1024
    s_cmp_lg_u32 s16, 0
    s_cbranch_scc1 f_nkr
    v_mov_b32 v54, s17
    s_mov_b32 s61, s68
    s_cmp_eq_u32 s34, 0
    s_cselect_b32 s4, 1, s17
    s_mov_b64 exec, 1
    ds_write_b32 v248, v54 offset:8192
    s_mov_b64 exec, -1
f_nkr:
    s_cmp_eq_u32 s34, 0
    s_cbranch_scc1 f_sa
f_nsa:
    v_mov_b32 v54, 1
    s_mov_b64 exec, 1
    ds_add_u32 v248, v54 offset:8196
    s_mov_b64 exec, -1
    s_bitset1_b32 s47, 1
    s_bitcmp1_b32 s47, 0
    s_cbranch_scc1 f_bar
    s_branch f_s1
f_s0:
    s_sleep 8
f_s1:
    buffer_load_dwordx4 v[32:35], v249, s[12:15], s72 offen offset:0 sc1
    buffer_load_dwordx4 v[36:39], v249, s[12:15], s72 offen offset:1024 sc1
    buffer_load_dwordx4 v[40:43], v249, s[12:15], s72 offen offset:2048 sc1
    buffer_load_dwordx4 v[44:47], v249, s[12:15], s72 offen offset:3072 sc1
    s_waitcnt vmcnt(4)
    s_mov_b32 s83, 0
    ds_read_b64 v[96:97], v8 offset:0
    ds_read_b64 v[98:99], v8 offset:512
    ds_read_b64 v[100:101], v8 offset:1024
    ds_read_b64 v[102:103], v8 offset:1536
    ds_read_b64 v[104:105], v9 offset:1536
    ds_read_b64 v[106:107], v9 offset:1024
    ds_read_b64 v[108:109], v9 offset:512
    ds_read_b64 v[110:111], v9 offset:0
    v_xor_b32 v2, s32, v244
    v_bitop3_b32 v2, v2, v246, s32 bitop3:0xf6
    v_bitop3_b32 v2, v2, v245, s39 bitop3:0xf6
    v_bitop3_b32 v2, v2, v247, s39 bitop3:0xf6
    v_cmp_ne_u32 vcc, 0, v2
    s_mov_b32 s38, vcc_lo
    v_mov_b32 v244, 111488
    s_waitcnt lgkmcnt(0)
    v_lshlrev_b32 v160, 16, v96
    v_and_b32 v161, 0xffff0000, v96
    v_lshlrev_b32 v162, 16, v97
    v_and_b32 v163, 0xffff0000, v97
    v_lshlrev_b32 v164, 16, v98
    v_and_b32 v165, 0xffff0000, v98
    v_lshlrev_b32 v166, 16, v99
    v_and_b32 v167, 0xffff0000, v99
    v_lshlrev_b32 v168, 16, v100
    v_and_b32 v169, 0xffff0000, v100
    v_lshlrev_b32 v170, 16, v101
    v_and_b32 v171, 0xffff0000, v101
    v_lshlrev_b32 v172, 16, v102
    v_and_b32 v173, 0xffff0000, v102
    v_lshlrev_b32 v174, 16, v103
    v_and_b32 v175, 0xffff0000, v103
    v_lshlrev_b32 v176, 16, v104
    v_and_b32 v177, 0xffff0000, v104
    v_lshlrev_b32 v178, 16, v105
    v_and_b32 v179, 0xffff0000, v105
    v_lshlrev_b32 v180, 16, v106
    v_and_b32 v181, 0xffff0000, v106
    v_lshlrev_b32 v182, 16, v107
    v_and_b32 v183, 0xffff0000, v107
    v_lshlrev_b32 v184, 16, v108
    v_and_b32 v185, 0xffff0000, v108
    v_lshlrev_b32 v186, 16, v109
    v_and_b32 v187, 0xffff0000, v109
    v_lshlrev_b32 v188, 16, v110
    v_and_b32 v189, 0xffff0000, v110
    v_lshlrev_b32 v190, 16, v111
    v_and_b32 v191, 0xffff0000, v111
    ds_read_b32 v246, v244 offset:4
    s_waitcnt lgkmcnt(0)
    v_readfirstlane_b32 s43, v246
    s_cmp_lg_u32 s43, 4
    s_cbranch_scc1 f_t1
    ds_read_b128 v[112:115], v248 offset:0
    ds_read_b128 v[116:119], v248 offset:1024
    ds_read_b128 v[120:123], v248 offset:2048
    ds_read_b128 v[124:127], v248 offset:3072
    ds_read_b128 v[128:131], v248 offset:4096
    ds_read_b128 v[132:135], v248 offset:5120
    ds_read_b128 v[136:139], v248 offset:6144
    ds_read_b128 v[140:143], v248 offset:7168
    ds_read_b32 v245, v244
    s_bitset1_b32 s47, 2
f_t1:
f_z1:
    s_waitcnt vmcnt(2)
    v_xor_b32 v80, v32, v16
    v_xor_b32 v81, v36, v16
    v_xor_b32 v82, v33, v17
    v_xor_b32 v83, v37, v17
    v_xor_b32 v84, v34, v18
    v_xor_b32 v85, v38, v18
    v_xor_b32 v86, v35, v19
    v_xor_b32 v87, v39, v19
    v_mfma_f32_16x16x16_f16 v[48:51], v[20:21], v[80:81], 0
    v_xor_b32 v2, s44, v80
    v_bitop3_b32 v2, v2, v81, s44 bitop3:0xf6
    v_mfma_f32_16x16x16_f16 v[52:55], v[20:21], v[82:83], 0
    v_bitop3_b32 v2, v2, v82, s44 bitop3:0xf6
    v_bitop3_b32 v2, v2, v83, s44 bitop3:0xf6
    v_mfma_f32_16x16x16_f16 v[56:59], v[20:21], v[84:85], 0
    v_bitop3_b32 v2, v2, v84, s44 bitop3:0xf6
    v_bitop3_b32 v2, v2, v85, s44 bitop3:0xf6
    v_mfma_f32_16x16x16_f16 v[60:63], v[20:21], v[86:87], 0
    v_bitop3_b32 v2, v2, v86, s44 bitop3:0xf6
    v_bitop3_b32 v2, v2, v87, s44 bitop3:0xf6
    s_waitcnt vmcnt(0)
    v_xor_b32 v88, v40, v16
    v_xor_b32 v89, v44, v16
    v_xor_b32 v90, v41, v17
    v_xor_b32 v91, v45, v17
    v_xor_b32 v92, v42, v18
    v_xor_b32 v93, v46, v18
    v_xor_b32 v94, v43, v19
    v_xor_b32 v95, v47, v19
    v_mfma_f32_16x16x16_f16 v[64:67], v[22:23], v[88:89], 0
    v_bitop3_b32 v2, v2, v88, s44 bitop3:0xf6
    v_bitop3_b32 v2, v2, v89, s44 bitop3:0xf6
    v_mfma_f32_16x16x16_f16 v[68:71], v[22:23], v[90:91], 0
    v_bitop3_b32 v2, v2, v90, s44 bitop3:0xf6
    v_bitop3_b32 v2, v2, v91, s44 bitop3:0xf6
    v_mfma_f32_16x16x16_f16 v[72:75], v[22:23], v[92:93], 0
    v_bitop3_b32 v2, v2, v92, s44 bitop3:0xf6
    v_bitop3_b32 v2, v2, v93, s44 bitop3:0xf6
    v_mfma_f32_16x16x16_f16 v[76:79], v[22:23], v[94:95], 0
    v_bitop3_b32 v2, v2, v94, s44 bitop3:0xf6
    v_bitop3_b32 v2, v2, v95, s44 bitop3:0xf6
    v_and_b32 v2, s33, v2
    v_cmp_ne_u32 vcc, 0, v2
    s_cbranch_vccnz f_z1bad
f_z1ok:
    v_cvt_pk_f16_f32 v32, v48, v49
    v_cvt_pk_f16_f32 v33, v64, v65
    ds_write_b64 v252, v[32:33] offset:0
    v_cvt_pk_f16_f32 v34, v50, v51
    v_cvt_pk_f16_f32 v35, v66, v67
    ds_write_b64 v252, v[34:35] offset:1024
    v_cvt_pk_f16_f32 v36, v52, v53
    v_cvt_pk_f16_f32 v37, v68, v69
    ds_write_b64 v253, v[36:37] offset:0
    v_cvt_pk_f16_f32 v38, v54, v55
    v_cvt_pk_f16_f32 v39, v70, v71
    ds_write_b64 v253, v[38:39] offset:1024
    v_cvt_pk_f16_f32 v40, v56, v57
    v_cvt_pk_f16_f32 v41, v72, v73
    ds_write_b64 v252, v[40:41] offset:128
    v_cvt_pk_f16_f32 v42, v58, v59
    v_cvt_pk_f16_f32 v43, v74, v75
    ds_write_b64 v252, v[42:43] offset:1152
    v_cvt_pk_f16_f32 v44, v60, v61
    v_cvt_pk_f16_f32 v45, v76, v77
    ds_write_b64 v253, v[44:45] offset:128
    v_cvt_pk_f16_f32 v46, v62, v63
    v_cvt_pk_f16_f32 v47, v78, v79
    ds_write_b64 v253, v[46:47] offset:1152
    s_bitset1_b32 s47, 0
    s_mov_b32 s83, 0
    s_bitcmp1_b32 s47, 1
    s_cbranch_scc0 f_c1
    s_bitcmp1_b32 s47, 2
    s_cbranch_scc1 f_bar
    ds_read_b32 v246, v244 offset:4
    s_waitcnt lgkmcnt(0)
    v_readfirstlane_b32 s43, v246
    s_cmp_lg_u32 s43, 4
    s_cbranch_scc1 f_bar
    ds_read_b128 v[112:115], v248 offset:0
    ds_read_b128 v[116:119], v248 offset:1024
    ds_read_b128 v[120:123], v248 offset:2048
    ds_read_b128 v[124:127], v248 offset:3072
    ds_read_b128 v[128:131], v248 offset:4096
    ds_read_b128 v[132:135], v248 offset:5120
    ds_read_b128 v[136:139], v248 offset:6144
    ds_read_b128 v[140:143], v248 offset:7168
    ds_read_b32 v245, v244
    s_bitset1_b32 s47, 2
f_bar:
    s_waitcnt lgkmcnt(0)
    s_bitcmp1_b32 s47, 2
    s_barrier
    s_cbranch_scc0 f_t3l
f_t3d:
    ds_read_b128 v[32:35], v254 offset:0
    ds_read_b128 v[36:39], v255 offset:256
    ds_read_b128 v[40:43], v254 offset:512
    ds_read_b128 v[44:47], v255 offset:768
    v_xor_b32 v16, 65537, v16
    v_xor_b32 v17, 65537, v17
    v_xor_b32 v18, 65537, v18
    v_xor_b32 v19, 65537, v19
    s_waitcnt lgkmcnt(3)
    v_mfma_f32_16x16x32_f16 v[48:51], v[32:35], v[24:27], 0
    v_mfma_f32_16x16x32_f16 v[52:55], v[32:35], v[28:31], 0
    s_waitcnt lgkmcnt(2)
    v_mfma_f32_16x16x32_f16 v[56:59], v[36:39], v[24:27], 0
    v_mfma_f32_16x16x32_f16 v[60:63], v[36:39], v[28:31], 0
    s_waitcnt lgkmcnt(1)
    v_mfma_f32_16x16x32_f16 v[64:67], v[40:43], v[24:27], 0
    v_mfma_f32_16x16x32_f16 v[68:71], v[40:43], v[28:31], 0
    s_waitcnt lgkmcnt(0)
    v_mfma_f32_16x16x32_f16 v[72:75], v[44:47], v[24:27], 0
    v_mfma_f32_16x16x32_f16 v[76:79], v[44:47], v[28:31], 0
    v_mov_b32 v2, v245
    v_xor_b32 v19, v245, v19
    ds_read_b128 v[244:247], v3 offset:46592
    ds_read_b128 v[248:251], v3 offset:47616
    ds_read_b128 v[252:255], v3 offset:48640
    s_cmp_lt_u32 s16, 4
    s_cselect_b64 exec, -1, 0
    buffer_load_dwordx4 v[20:23], v15, s[12:15], s52 offen
    buffer_load_dwordx4 v[240:243], v15, s[12:15], s53 offen
    s_mov_b64 exec, -1
    v_cvt_pk_f16_f32 v144, v48, v52
    v_cvt_pk_f16_f32 v145, v49, v53
    v_cvt_pk_f16_f32 v146, v50, v54
    v_cvt_pk_f16_f32 v147, v51, v55
    v_cvt_pk_f16_f32 v148, v56, v60
    v_cvt_pk_f16_f32 v149, v57, v61
    v_cvt_pk_f16_f32 v150, v58, v62
    v_cvt_pk_f16_f32 v151, v59, v63
    v_mfma_f32_16x16x32_f16 v[80:83], v[144:147], v[112:115], 0
    v_mfma_f32_16x16x32_f16 v[84:87], v[144:147], v[116:119], 0
    v_cvt_pk_f16_f32 v152, v64, v68
    v_cvt_pk_f16_f32 v153, v65, v69
    v_cvt_pk_f16_f32 v154, v66, v70
    v_cvt_pk_f16_f32 v155, v67, v71
    v_mfma_f32_16x16x32_f16 v[88:91], v[148:151], v[120:123], 0
    v_mfma_f32_16x16x32_f16 v[92:95], v[148:151], v[124:127], 0
    v_cvt_pk_f16_f32 v156, v72, v76
    v_cvt_pk_f16_f32 v157, v73, v77
    v_cvt_pk_f16_f32 v158, v74, v78
    v_cvt_pk_f16_f32 v159, v75, v79
    v_mfma_f32_16x16x32_f16 v[96:99], v[152:155], v[128:131], 0
    v_mfma_f32_16x16x32_f16 v[100:103], v[152:155], v[132:135], 0
    v_mfma_f32_16x16x32_f16 v[104:107], v[156:159], v[136:139], 0
    v_mfma_f32_16x16x32_f16 v[108:111], v[156:159], v[140:143], 0
    s_cmp_lg_u32 s4, 0
    s_cbranch_scc1 f_sb
f_nsb:
    v_cvt_pk_f16_f32 v32, v80, v84
    v_cvt_pk_f16_f32 v36, v81, v85
    v_cvt_pk_f16_f32 v40, v82, v86
    v_cvt_pk_f16_f32 v44, v83, v87
    v_bfi_b32 v32, s33, v16, v32
    v_bfi_b32 v36, s33, v16, v36
    v_bfi_b32 v40, s33, v16, v40
    v_bfi_b32 v44, s33, v16, v44
    v_cvt_pk_f16_f32 v33, v88, v92
    v_cvt_pk_f16_f32 v37, v89, v93
    v_cvt_pk_f16_f32 v41, v90, v94
    v_cvt_pk_f16_f32 v45, v91, v95
    v_bfi_b32 v33, s33, v17, v33
    v_bfi_b32 v37, s33, v17, v37
    v_bfi_b32 v41, s33, v17, v41
    v_bfi_b32 v45, s33, v17, v45
    v_cvt_pk_f16_f32 v34, v96, v100
    v_cvt_pk_f16_f32 v38, v97, v101
    v_cvt_pk_f16_f32 v42, v98, v102
    v_cvt_pk_f16_f32 v46, v99, v103
    v_bfi_b32 v34, s33, v18, v34
    v_bfi_b32 v38, s33, v18, v38
    v_bfi_b32 v42, s33, v18, v42
    v_bfi_b32 v46, s33, v18, v46
    v_cvt_pk_f16_f32 v35, v104, v108
    v_cvt_pk_f16_f32 v39, v105, v109
    v_cvt_pk_f16_f32 v43, v106, v110
    v_cvt_pk_f16_f32 v47, v107, v111
    v_bfi_b32 v35, s33, v19, v35
    v_bfi_b32 v39, s33, v19, v39
    v_bfi_b32 v43, s33, v19, v43
    v_bfi_b32 v47, s33, v19, v47
    s_cmp_lg_u32 s38, 0
    s_cbranch_scc1 f_slowst
    buffer_store_dwordx4 v[32:35], v14, s[12:15], s74 offen offset:0 nt
    buffer_store_dwordx4 v[36:39], v14, s[12:15], s74 offen offset:2048 nt
    buffer_store_dwordx4 v[40:43], v14, s[12:15], s75 offen offset:0 nt
    buffer_store_dwordx4 v[44:47], v14, s[12:15], s75 offen offset:2048 nt
f_std:
    s_cmp_ge_u32 s16, 4
    s_cbranch_scc1 f_pw2
    s_mov_b32 s83, 0
    s_waitcnt vmcnt(4)
f_pp:
    v_xor_b32 v20, s56, v20
    v_xor_b32 v21, s57, v21
    v_xor_b32 v22, s58, v22
    v_xor_b32 v23, s59, v23
    v_xor_b32 v240, s56, v240
    v_xor_b32 v241, s57, v241
    v_xor_b32 v242, s58, v242
    v_xor_b32 v243, s59, v243
    v_or3_b32 v48, v20, v21, v22
    v_or3_b32 v48, v48, v23, v240
    v_or3_b32 v48, v48, v241, v242
    v_or_b32 v48, v48, v243
    v_and_b32 v48, 0xff, v48
    v_cmp_ne_u32 vcc, 0, v48
    s_cbranch_vccnz f_ppbad
f_ppok:
    ds_write_b128 v1, v[20:23]
    ds_write_b128 v1, v[240:243] offset:8192
f_pw:
    s_waitcnt lgkmcnt(0)
f_pw2:
    s_barrier
    buffer_load_dwordx4 v[32:35], v4, s[12:15], s28 offen sc1 nt
    buffer_load_dwordx4 v[36:39], v4, s[12:15], s29 offen sc1 nt
    buffer_load_dwordx4 v[40:43], v4, s[12:15], s50 offen sc1 nt
    buffer_load_dwordx4 v[44:47], v4, s[12:15], s51 offen sc1 nt
    ds_read_b128 v[240:243], v3 offset:45568
    ds_read_b128 v[112:115], v5 offset:8192
    ds_read_b128 v[128:131], v6 offset:11264
    ds_read_b128 v[48:51], v5 offset:0
    ds_read_b128 v[64:67], v6 offset:3072
    ds_read_b128 v[116:119], v5 offset:9216
    ds_read_b128 v[132:135], v6 offset:10240
    ds_read_b128 v[52:55], v5 offset:1024
    ds_read_b128 v[68:71], v6 offset:2048
    v_pk_add_f32 v[152:153], v[20:21], v[22:23]
    v_add_f32 v152, v152, v153
    s_nop 1
    v_add_f32_dpp v152, v152, v152 row_ror:8 row_mask:0xf bank_mask:0xf
    s_nop 1
    v_add_f32_dpp v152, v152, v152 row_ror:4 row_mask:0xf bank_mask:0xf
    s_nop 1
    v_add_f32_dpp v152, v152, v152 row_ror:2 row_mask:0xf bank_mask:0xf
    s_nop 1
    v_add_f32_dpp v152, v152, v152 row_ror:1 row_mask:0xf bank_mask:0xf
    s_nop 1
    v_add_f32_dpp v152, v152, v152 row_bcast:15 row_mask:0xa bank_mask:0xf
    s_nop 1
    v_add_f32_dpp v152, v152, v152 row_bcast:31 row_mask:0xc bank_mask:0xf
    v_min_u32 v152, -2, v152
    s_mov_b32 exec_lo, 0
    s_mov_b32 exec_hi, 0x80000000
    ds_write_b32 v11, v152 offset:64
    s_mov_b64 exec, -1
    v_xor_b32 v19, v2, v19
    v_xor_b32 v16, s44, v16
    v_xor_b32 v17, s44, v17
    v_xor_b32 v18, s44, v18
    v_xor_b32 v19, s44, v19
    v_bfe_u32 v20, v0, 3, 3
    v_mul_u32_u24 v20, 7168, v20
    v_and_b32 v151, 7, v0
    v_min_u32 v151, 6, v151
    v_lshl_add_u32 v151, v151, 7, v20
    v_mov_b32 v20, 102976
    v_lshrrev_b32 v23, 5, v0
    v_mov_b32 v22, 0xffffff00
    v_mov_b32 v21, 0x20000
    s_mov_b64 s[70:71], 1
    s_mov_b32 s83, 1
    s_mov_b32 s83, 0
    s_mov_b64 s[72:73], -1
    s_mov_b64 s[74:75], -1
    s_mov_b64 s[78:79], -1
    s_mov_b64 s[36:37], -1
    s_branch f_zp
f_zr:
    s_mov_b64 exec, s[72:73]
    buffer_load_dwordx4 v[32:35], v4, s[12:15], s28 offen sc1 nt
    s_mov_b64 exec, s[74:75]
    buffer_load_dwordx4 v[36:39], v4, s[12:15], s29 offen sc1 nt
    s_mov_b64 exec, s[78:79]
    buffer_load_dwordx4 v[40:43], v4, s[12:15], s50 offen sc1 nt
    s_mov_b64 exec, s[36:37]
    buffer_load_dwordx4 v[44:47], v4, s[12:15], s51 offen sc1 nt
f_zp:
    s_add_u32 s83, s83, 1
    s_cmp_lt_u32 s83, 0x40000
    s_cselect_b64 s[68:69], -1, 0
    s_mov_b64 exec, s[72:73]
    s_waitcnt vmcnt(3)
    v_xor_b32 v32, v32, v16
    v_xor_b32 v33, v33, v17
    v_xor_b32 v34, v34, v18
    v_xor_b32 v35, v35, v19
    v_bitop3_b32 v144, v35, v21, s44 bitop3:0x56
    v_bitop3_b32 v144, v144, v32, s44 bitop3:0xf6
    v_bitop3_b32 v144, v144, v33, s44 bitop3:0xf6
    v_bitop3_b32 v144, v144, v34, s44 bitop3:0xf6
    v_and_b32 v144, s33, v144
    v_cmp_ne_u32 s[72:73], 0, v144
    s_mov_b64 exec, s[74:75]
    s_waitcnt vmcnt(2)
    v_xor_b32 v36, v36, v16
    v_xor_b32 v37, v37, v17
    v_xor_b32 v38, v38, v18
    v_xor_b32 v39, v39, v19
    v_bitop3_b32 v145, v39, v21, s44 bitop3:0x56
    v_bitop3_b32 v145, v145, v36, s44 bitop3:0xf6
    v_bitop3_b32 v145, v145, v37, s44 bitop3:0xf6
    v_bitop3_b32 v145, v145, v38, s44 bitop3:0xf6
    v_and_b32 v145, s33, v145
    v_cmp_ne_u32 s[74:75], 0, v145
    s_mov_b64 exec, s[78:79]
    s_waitcnt vmcnt(1)
    v_xor_b32 v40, v40, v16
    v_xor_b32 v41, v41, v17
    v_xor_b32 v42, v42, v18
    v_xor_b32 v43, v43, v19
    v_bitop3_b32 v146, v43, v21, s44 bitop3:0x56
    v_bitop3_b32 v146, v146, v40, s44 bitop3:0xf6
    v_bitop3_b32 v146, v146, v41, s44 bitop3:0xf6
    v_bitop3_b32 v146, v146, v42, s44 bitop3:0xf6
    v_and_b32 v146, s33, v146
    v_cmp_ne_u32 s[78:79], 0, v146
    s_or_b64 s[64:65], s[72:73], s[74:75]
    s_mov_b64 exec, s[36:37]
    s_waitcnt vmcnt(0)
    v_xor_b32 v44, v44, v16
    v_xor_b32 v45, v45, v17
    v_xor_b32 v46, v46, v18
    v_xor_b32 v47, v47, v19
    v_bitop3_b32 v147, v47, v21, s44 bitop3:0x56
    v_bitop3_b32 v147, v147, v44, s44 bitop3:0xf6
    v_bitop3_b32 v147, v147, v45, s44 bitop3:0xf6
    v_bitop3_b32 v147, v147, v46, s44 bitop3:0xf6
    v_and_b32 v147, s33, v147
    v_cmp_ne_u32 s[36:37], 0, v147
    s_mov_b64 exec, -1
    v_bitop3_b32 v2, v35, v39, v21 bitop3:0x80
    v_bitop3_b32 v2, v2, v43, v47 bitop3:0x80
    v_cmp_eq_u32 vcc, 0, v2
    s_or_b64 s[66:67], s[78:79], s[36:37]
    s_or_b64 s[64:65], s[64:65], s[66:67]
    s_and_b64 s[64:65], s[64:65], s[68:69]
    s_cbranch_scc1 f_zr
    s_cbranch_vccnz f_rare
f_zf:
    v_mfma_f32_16x16x32_f16 v[80:83], v[32:35], v[192:195], 0
    ds_read_b128 v[120:123], v5 offset:10240
    ds_read_b128 v[136:139], v6 offset:9216
    v_mfma_f32_16x16x32_f16 v[80:83], v[36:39], v[196:199], v[80:83]
    ds_read_b128 v[56:59], v5 offset:2048
    ds_read_b128 v[72:75], v6 offset:1024
    v_mfma_f32_16x16x32_f16 v[80:83], v[40:43], v[200:203], v[80:83]
    ds_read_b128 v[124:127], v5 offset:11264
    ds_read_b128 v[140:143], v6 offset:8192
    v_mfma_f32_16x16x32_f16 v[80:83], v[44:47], v[204:207], v[80:83]
    ds_read_b128 v[60:63], v5 offset:3072
    ds_read_b128 v[76:79], v6 offset:0
    v_mfma_f32_16x16x32_f16 v[84:87], v[32:35], v[208:211], 0
    ds_read2_b32 v[28:29], v20 offset0:1 offset1:3
    ds_read2_b32 v[30:31], v20 offset0:5 offset1:7
    v_mfma_f32_16x16x32_f16 v[84:87], v[36:39], v[212:215], v[84:87]
    v_mfma_f32_16x16x32_f16 v[84:87], v[40:43], v[216:219], v[84:87]
    v_mfma_f32_16x16x32_f16 v[84:87], v[44:47], v[220:223], v[84:87]
f_zfok:
    s_waitcnt lgkmcnt(10)
    s_cmp_eq_u32 s30, 0
    s_cbranch_scc1 f_sp
    v_mfma_f32_16x16x32_f16 v[88:91], v[32:35], v[224:227], 0
    v_pk_fma_f32 v[160:161], v[112:113], v[80:81], v[160:161]
    v_pk_fma_f32 v[162:163], v[114:115], v[82:83], v[162:163]
    v_mfma_f32_16x16x32_f16 v[88:91], v[36:39], v[228:231], v[88:91]
    v_fmac_f32 v177, v129, v83
    v_fmac_f32 v178, v130, v82
    v_fmac_f32 v179, v131, v81
    v_mfma_f32_16x16x32_f16 v[88:91], v[40:43], v[232:235], v[88:91]
    v_pk_mul_f32 v[146:147], v[160:161], v[160:161]
    v_pk_mul_f32 v[148:149], v[160:161], v[48:49]
    v_mfma_f32_16x16x32_f16 v[88:91], v[44:47], v[236:239], v[88:91]
    v_pk_fma_f32 v[146:147], v[162:163], v[162:163], v[146:147]
    v_pk_fma_f32 v[148:149], v[162:163], v[50:51], v[148:149]
    v_mfma_f32_16x16x32_f16 v[92:95], v[32:35], v[240:243], 0
    v_cndmask_b32 v100, v80, v84, s[70:71]
    ds_bpermute_b32 v96, v7, v100
    v_pk_fma_f32 v[164:165], v[116:117], v[84:85], v[164:165]
    v_pk_fma_f32 v[166:167], v[118:119], v[86:87], v[166:167]
    v_mfma_f32_16x16x32_f16 v[92:95], v[36:39], v[244:247], v[92:95]
    v_fmac_f32 v181, v133, v87
    v_fmac_f32 v182, v134, v86
    v_fmac_f32 v183, v135, v85
    v_mfma_f32_16x16x32_f16 v[92:95], v[40:43], v[248:251], v[92:95]
    v_pk_fma_f32 v[146:147], v[164:165], v[164:165], v[146:147]
    v_pk_fma_f32 v[148:149], v[164:165], v[52:53], v[148:149]
    v_mfma_f32_16x16x32_f16 v[92:95], v[44:47], v[252:255], v[92:95]
    v_pk_fma_f32 v[146:147], v[166:167], v[166:167], v[146:147]
    v_pk_fma_f32 v[148:149], v[166:167], v[54:55], v[148:149]
    v_pk_mul_f32 v[154:155], v[178:179], v[178:179]
    v_pk_mul_f32 v[156:157], v[178:179], v[66:67]
    v_pk_fma_f32 v[154:155], v[182:183], v[182:183], v[154:155]
    v_pk_fma_f32 v[156:157], v[182:183], v[70:71], v[156:157]
    v_pk_add_f32 v[144:145], v[160:161], v[162:163]
    v_pk_add_f32 v[152:153], v[178:179], v[182:183]
    s_waitcnt lgkmcnt(1)
    v_cndmask_b32 v101, v84, v88, s[70:71]
    ds_bpermute_b32 v97, v7, v101
    v_pk_fma_f32 v[168:169], v[120:121], v[88:89], v[168:169]
    v_pk_fma_f32 v[170:171], v[122:123], v[90:91], v[170:171]
    v_fmac_f32 v185, v137, v91
    v_fmac_f32 v186, v138, v90
    v_fmac_f32 v187, v139, v89
    v_pk_add_f32 v[144:145], v[144:145], v[164:165]
    v_pk_add_f32 v[144:145], v[144:145], v[166:167]
    v_pk_fma_f32 v[146:147], v[168:169], v[168:169], v[146:147]
    v_pk_fma_f32 v[148:149], v[168:169], v[56:57], v[148:149]
    v_pk_fma_f32 v[146:147], v[170:171], v[170:171], v[146:147]
    v_pk_fma_f32 v[148:149], v[170:171], v[58:59], v[148:149]
    v_pk_fma_f32 v[154:155], v[186:187], v[186:187], v[154:155]
    v_pk_fma_f32 v[156:157], v[186:187], v[74:75], v[156:157]
    v_cndmask_b32 v102, v88, v92, s[70:71]
    ds_bpermute_b32 v98, v7, v102
    v_cndmask_b32 v103, v92, v80, s[70:71]
    ds_bpermute_b32 v99, v7, v103
    v_pk_fma_f32 v[172:173], v[124:125], v[92:93], v[172:173]
    v_pk_fma_f32 v[174:175], v[126:127], v[94:95], v[174:175]
    v_fmac_f32 v189, v141, v95
    v_fmac_f32 v190, v142, v94
    v_fmac_f32 v191, v143, v93
    v_pk_fma_f32 v[146:147], v[172:173], v[172:173], v[146:147]
    v_pk_fma_f32 v[148:149], v[172:173], v[60:61], v[148:149]
    v_pk_fma_f32 v[146:147], v[174:175], v[174:175], v[146:147]
    v_pk_fma_f32 v[148:149], v[174:175], v[62:63], v[148:149]
    v_pk_fma_f32 v[154:155], v[190:191], v[190:191], v[154:155]
    v_pk_fma_f32 v[156:157], v[190:191], v[78:79], v[156:157]
    v_pk_add_f32 v[144:145], v[144:145], v[168:169]
    v_pk_add_f32 v[144:145], v[144:145], v[170:171]
    v_pk_add_f32 v[144:145], v[144:145], v[172:173]
    v_pk_add_f32 v[144:145], v[144:145], v[174:175]
    v_pk_add_f32 v[152:153], v[152:153], v[186:187]
    v_pk_add_f32 v[152:153], v[152:153], v[190:191]
    s_waitcnt lgkmcnt(0)
    v_fmac_f32 v176, v128, v96
    v_fmac_f32 v180, v132, v97
    v_fmac_f32 v184, v136, v98
    v_fmac_f32 v188, v140, v99
    v_pk_fma_f32 v[154:155], v[176:177], v[176:177], v[154:155]
    v_pk_fma_f32 v[156:157], v[176:177], v[64:65], v[156:157]
    v_pk_add_f32 v[152:153], v[152:153], v[176:177]
    v_pk_fma_f32 v[154:155], v[180:181], v[180:181], v[154:155]
    v_pk_fma_f32 v[156:157], v[180:181], v[68:69], v[156:157]
    v_pk_add_f32 v[152:153], v[152:153], v[180:181]
    v_pk_fma_f32 v[154:155], v[184:185], v[184:185], v[154:155]
    v_pk_fma_f32 v[156:157], v[184:185], v[72:73], v[156:157]
    v_pk_add_f32 v[152:153], v[152:153], v[184:185]
    v_pk_fma_f32 v[154:155], v[188:189], v[188:189], v[154:155]
    v_pk_fma_f32 v[156:157], v[188:189], v[76:77], v[156:157]
    v_pk_add_f32 v[152:153], v[152:153], v[188:189]
f_join:
f_q:
    v_max3_u32 v2, v28, v29, v30
    v_max_u32 v2, v2, v31
    v_cmp_eq_u32 vcc, -1, v2
    s_cbranch_vccnz f_qbad
    v_pk_add_f32 v[28:29], v[28:29], v[30:31]
    s_mov_b64 exec, s[48:49]
    buffer_load_dword v150, v151, s[20:23], s55 offen
    s_mov_b64 exec, -1
f_ngo:
    v_add_f32 v104, v144, v145
    v_add_f32 v105, v146, v147
    v_add_f32 v106, v148, v149
    v_add_f32 v108, v152, v153
    v_add_f32 v109, v154, v155
    v_add_f32 v110, v156, v157
    v_add_f32 v28, v28, v29
    v_permlane32_swap_b32 v104, v108
    v_permlane32_swap_b32 v105, v109
    v_permlane32_swap_b32 v106, v110
    v_add_f32 v104, v104, v108
    v_add_f32 v105, v105, v109
    v_add_f32 v106, v106, v110
    v_add_f32_dpp v104, v104, v104 row_ror:8 row_mask:0xf bank_mask:0xf
    v_add_f32_dpp v105, v105, v105 row_ror:8 row_mask:0xf bank_mask:0xf
    v_add_f32_dpp v106, v106, v106 row_ror:8 row_mask:0xf bank_mask:0xf
    v_add_f32_dpp v104, v104, v104 row_ror:4 row_mask:0xf bank_mask:0xf
    v_add_f32_dpp v105, v105, v105 row_ror:4 row_mask:0xf bank_mask:0xf
    v_add_f32_dpp v106, v106, v106 row_ror:4 row_mask:0xf bank_mask:0xf
    v_add_f32_dpp v104, v104, v104 row_ror:2 row_mask:0xf bank_mask:0xf
    v_add_f32_dpp v105, v105, v105 row_ror:2 row_mask:0xf bank_mask:0xf
    v_add_f32_dpp v106, v106, v106 row_ror:2 row_mask:0xf bank_mask:0xf
    v_add_f32_dpp v104, v104, v104 row_ror:1 row_mask:0xf bank_mask:0xf
    v_add_f32_dpp v105, v105, v105 row_ror:1 row_mask:0xf bank_mask:0xf
    v_add_f32_dpp v106, v106, v106 row_ror:1 row_mask:0xf bank_mask:0xf
    v_add_f32_dpp v104, v104, v104 row_bcast:15 row_mask:0xa bank_mask:0xf
    v_add_f32_dpp v105, v105, v105 row_bcast:15 row_mask:0xa bank_mask:0xf
    v_add_f32_dpp v106, v106, v106 row_bcast:15 row_mask:0xa bank_mask:0xf
    v_mul_f32 v104, s46, v104
    v_mul_f32 v105, s46, v105
    v_mul_f32 v108, v104, v104
    v_fma_f32 v106, -v104, v28, v106
    v_sub_f32 v105, v105, v108
    v_mul_f32 v109, 4.0, v105
    v_cmp_gt_f32 vcc, v108, v109
    s_or_b32 s42, vcc_lo, vcc_hi
    s_bitcmp1_b32 s42, 31
    s_cbranch_scc1 f_slow2
f_var2:
    v_cvt_pk_bf16_f32 v105, v105, v105
    v_lshlrev_b32 v105, 16, v105
    v_add_f32 v105, 0x3727c5ac, v105
    v_cvt_pk_bf16_f32 v105, v105, v105
    v_lshlrev_b32 v105, 16, v105
    v_sqrt_f32 v105, v105
    s_nop 0
    v_cvt_pk_bf16_f32 v105, v105, v105
    v_lshlrev_b32 v105, 16, v105
    v_rcp_f32 v105, v105
    s_mov_b32 s42, 0x80000000
    s_mov_b32 exec_lo, s42
    s_mov_b32 exec_hi, s42
    v_mul_f32 v106, v106, v105
    v_ashrrev_i32 v108, 31, v106
    v_or_b32 v108, s42, v108
    v_xor_b32 v106, v106, v108
    v_and_or_b32 v106, v106, v22, v23
    ds_write_b32 v11, v106
    s_mov_b64 exec, -1
    s_waitcnt lgkmcnt(0)
    s_barrier
    ds_read_b32 v21, v12
    v_readlane_b32 s60, v106, 31
    v_readlane_b32 s64, v104, 31
    v_readlane_b32 s65, v105, 31
    v_readlane_b32 s61, v106, 63
    v_readlane_b32 s66, v104, 63
    v_readlane_b32 s67, v105, 63
    s_lshl_b32 s42, s3, 1
    s_movk_i32 s43, 0xff00
    v_mov_b32 v30, s32
    v_mov_b32 v31, s32
    s_cmp_lg_u32 s16, 0
    s_waitcnt lgkmcnt(0)
    s_cbranch_scc1 f_nkey
    s_setprio 3
    v_max_u32_dpp v28, v21, v21 row_ror:8 row_mask:0xf bank_mask:0xf
    s_nop 1
    v_max_u32_dpp v28, v28, v28 row_ror:4 row_mask:0xf bank_mask:0xf
    s_nop 1
    v_max_u32_dpp v28, v28, v28 row_ror:2 row_mask:0xf bank_mask:0xf
    s_nop 1
    v_max_u32_dpp v28, v28, v28 row_ror:1 row_mask:0xf bank_mask:0xf
    v_cmp_eq_u32 vcc, v28, v21
    s_nop 1
    v_cndmask_b32_e64 v29, v21, 0, vcc
    v_and_or_b32 v28, v28, v22, s42
    s_add_u32 s42, s42, 1
    v_max_u32_dpp v29, v29, v29 row_ror:8 row_mask:0xf bank_mask:0xf
    s_nop 1
    v_max_u32_dpp v29, v29, v29 row_ror:4 row_mask:0xf bank_mask:0xf
    s_nop 1
    v_max_u32_dpp v29, v29, v29 row_ror:2 row_mask:0xf bank_mask:0xf
    s_nop 1
    v_max_u32_dpp v29, v29, v29 row_ror:1 row_mask:0xf bank_mask:0xf
    v_and_or_b32 v29, v29, v22, s42
    s_mov_b64 exec, 0xff
    buffer_store_dwordx4 v[28:31], v13, s[12:15], s80 offen sc1
    s_mov_b64 exec, -1
    s_setprio 0
f_nkey:
    s_lshl_b32 s42, s16, 4
    s_or_b32 s42, s35, s42
    s_cmp_lg_u32 s42, 0
    s_cbranch_scc1 f_ng1
    v_mov_b32 v2, s32
    s_mov_b64 exec, 1
    buffer_store_dword v2, v13, s[12:15], s81 offen offset:2048 sc1
    s_mov_b64 exec, -1
f_ng1:
    s_movk_i32 s62, 0x100
    v_cmp_lt_u32 vcc, s60, v21
    s_and_b32 s42, vcc_lo, 0xffff
    s_bcnt1_i32_b32 s42, s42
    s_cmp_ge_u32 s42, 2
    s_cbranch_scc1 f_nc0
    s_setprio 2
    v_pk_add_f32 v[48:49], v[160:161], s[64:65] op_sel:[0,0] op_sel_hi:[1,0] neg_lo:[0,1] neg_hi:[0,1]
    v_pk_add_f32 v[50:51], v[162:163], s[64:65] op_sel:[0,0] op_sel_hi:[1,0] neg_lo:[0,1] neg_hi:[0,1]
    v_pk_add_f32 v[52:53], v[164:165], s[64:65] op_sel:[0,0] op_sel_hi:[1,0] neg_lo:[0,1] neg_hi:[0,1]
    v_pk_add_f32 v[54:55], v[166:167], s[64:65] op_sel:[0,0] op_sel_hi:[1,0] neg_lo:[0,1] neg_hi:[0,1]
    v_pk_add_f32 v[56:57], v[168:169], s[64:65] op_sel:[0,0] op_sel_hi:[1,0] neg_lo:[0,1] neg_hi:[0,1]
    v_pk_add_f32 v[58:59], v[170:171], s[64:65] op_sel:[0,0] op_sel_hi:[1,0] neg_lo:[0,1] neg_hi:[0,1]
    v_pk_add_f32 v[60:61], v[172:173], s[64:65] op_sel:[0,0] op_sel_hi:[1,0] neg_lo:[0,1] neg_hi:[0,1]
    v_pk_add_f32 v[62:63], v[174:175], s[64:65] op_sel:[0,0] op_sel_hi:[1,0] neg_lo:[0,1] neg_hi:[0,1]
    v_pk_mul_f32 v[48:49], v[48:49], s[64:65] op_sel:[0,1] op_sel_hi:[1,1]
    v_pk_mul_f32 v[50:51], v[50:51], s[64:65] op_sel:[0,1] op_sel_hi:[1,1]
    v_pk_mul_f32 v[52:53], v[52:53], s[64:65] op_sel:[0,1] op_sel_hi:[1,1]
    v_pk_mul_f32 v[54:55], v[54:55], s[64:65] op_sel:[0,1] op_sel_hi:[1,1]
    v_pk_mul_f32 v[56:57], v[56:57], s[64:65] op_sel:[0,1] op_sel_hi:[1,1]
    v_pk_mul_f32 v[58:59], v[58:59], s[64:65] op_sel:[0,1] op_sel_hi:[1,1]
    v_pk_mul_f32 v[60:61], v[60:61], s[64:65] op_sel:[0,1] op_sel_hi:[1,1]
    v_pk_mul_f32 v[62:63], v[62:63], s[64:65] op_sel:[0,1] op_sel_hi:[1,1]
    v_cvt_pk_f16_f32 v80, v48, v49
    v_cvt_pk_f16_f32 v81, v50, v51
    ds_write_b64 v8, v[80:81] offset:0
    v_cvt_pk_f16_f32 v82, v52, v53
    v_cvt_pk_f16_f32 v83, v54, v55
    ds_write_b64 v8, v[82:83] offset:512
    v_cvt_pk_f16_f32 v84, v56, v57
    v_cvt_pk_f16_f32 v85, v58, v59
    ds_write_b64 v8, v[84:85] offset:1024
    v_cvt_pk_f16_f32 v86, v60, v61
    v_cvt_pk_f16_f32 v87, v62, v63
    ds_write_b64 v8, v[86:87] offset:1536
    ds_read_b128 v[88:91], v10 offset:0
    ds_read_b128 v[92:95], v10 offset:1024
    s_lshl_b32 s62, s3, 1
    s_add_u32 s62, s62, s42
    s_lshl_b32 s42, s62, 11
    s_add_u32 s42, s42, 5242880
    s_lshl_b32 s43, s62, 4
    s_add_u32 s43, s43, 6512640
    s_lshl_b32 s68, s30, 8
    s_or_b32 s68, s68, s56
    s_andn2_b32 s69, s64, 0xff
    s_or_b32 s69, s69, s57
    s_andn2_b32 s70, s65, 0xff
    s_or_b32 s70, s70, s58
    s_andn2_b32 s71, s60, 0xff
    s_or_b32 s71, s71, s59
    s_waitcnt lgkmcnt(0)
    v_bfi_b32 v88, s33, v16, v88
    v_bfi_b32 v89, s33, v17, v89
    v_bfi_b32 v90, s33, v18, v90
    v_bfi_b32 v91, s33, v19, v91
    v_bfi_b32 v92, s33, v16, v92
    v_bfi_b32 v93, s33, v17, v93
    v_bfi_b32 v94, s33, v18, v94
    v_bfi_b32 v95, s33, v19, v95
    buffer_store_dwordx4 v[88:91], v3, s[12:15], s42 offen offset:0 sc1
    buffer_store_dwordx4 v[92:95], v3, s[12:15], s42 offen offset:1024 sc1
    v_mov_b32 v24, s68
    v_mov_b32 v25, s69
    v_mov_b32 v26, s70
    v_mov_b32 v27, s71
    s_mov_b64 exec, 1
    buffer_store_dwordx4 v[24:27], v3, s[12:15], s43 offen sc1
    s_mov_b64 exec, -1
    s_setprio 0
f_nc0:
    s_movk_i32 s63, 0x100
    v_cmp_lt_u32 vcc, s61, v21
    s_and_b32 s42, vcc_lo, 0xffff
    s_bcnt1_i32_b32 s42, s42
    s_cmp_ge_u32 s42, 2
    s_cbranch_scc1 f_nc1
    s_setprio 2
    v_pk_add_f32 v[64:65], v[176:177], s[66:67] op_sel:[0,0] op_sel_hi:[1,0] neg_lo:[0,1] neg_hi:[0,1]
    v_pk_add_f32 v[66:67], v[178:179], s[66:67] op_sel:[0,0] op_sel_hi:[1,0] neg_lo:[0,1] neg_hi:[0,1]
    v_pk_add_f32 v[68:69], v[180:181], s[66:67] op_sel:[0,0] op_sel_hi:[1,0] neg_lo:[0,1] neg_hi:[0,1]
    v_pk_add_f32 v[70:71], v[182:183], s[66:67] op_sel:[0,0] op_sel_hi:[1,0] neg_lo:[0,1] neg_hi:[0,1]
    v_pk_add_f32 v[72:73], v[184:185], s[66:67] op_sel:[0,0] op_sel_hi:[1,0] neg_lo:[0,1] neg_hi:[0,1]
    v_pk_add_f32 v[74:75], v[186:187], s[66:67] op_sel:[0,0] op_sel_hi:[1,0] neg_lo:[0,1] neg_hi:[0,1]
    v_pk_add_f32 v[76:77], v[188:189], s[66:67] op_sel:[0,0] op_sel_hi:[1,0] neg_lo:[0,1] neg_hi:[0,1]
    v_pk_add_f32 v[78:79], v[190:191], s[66:67] op_sel:[0,0] op_sel_hi:[1,0] neg_lo:[0,1] neg_hi:[0,1]
    v_pk_mul_f32 v[64:65], v[64:65], s[66:67] op_sel:[0,1] op_sel_hi:[1,1]
    v_pk_mul_f32 v[66:67], v[66:67], s[66:67] op_sel:[0,1] op_sel_hi:[1,1]
    v_pk_mul_f32 v[68:69], v[68:69], s[66:67] op_sel:[0,1] op_sel_hi:[1,1]
    v_pk_mul_f32 v[70:71], v[70:71], s[66:67] op_sel:[0,1] op_sel_hi:[1,1]
    v_pk_mul_f32 v[72:73], v[72:73], s[66:67] op_sel:[0,1] op_sel_hi:[1,1]
    v_pk_mul_f32 v[74:75], v[74:75], s[66:67] op_sel:[0,1] op_sel_hi:[1,1]
    v_pk_mul_f32 v[76:77], v[76:77], s[66:67] op_sel:[0,1] op_sel_hi:[1,1]
    v_pk_mul_f32 v[78:79], v[78:79], s[66:67] op_sel:[0,1] op_sel_hi:[1,1]
    v_cvt_pk_f16_f32 v80, v64, v65
    v_cvt_pk_f16_f32 v81, v66, v67
    ds_write_b64 v9, v[80:81] offset:1536
    v_cvt_pk_f16_f32 v82, v68, v69
    v_cvt_pk_f16_f32 v83, v70, v71
    ds_write_b64 v9, v[82:83] offset:1024
    v_cvt_pk_f16_f32 v84, v72, v73
    v_cvt_pk_f16_f32 v85, v74, v75
    ds_write_b64 v9, v[84:85] offset:512
    v_cvt_pk_f16_f32 v86, v76, v77
    v_cvt_pk_f16_f32 v87, v78, v79
    ds_write_b64 v9, v[86:87] offset:0
    ds_read_b128 v[88:91], v10 offset:2048
    ds_read_b128 v[92:95], v10 offset:3072
    s_lshl_b32 s63, s3, 1
    s_add_u32 s63, s63, s42
    s_lshl_b32 s42, s63, 11
    s_add_u32 s42, s42, 5242880
    s_lshl_b32 s43, s63, 4
    s_add_u32 s43, s43, 6512640
    s_lshl_b32 s68, s31, 8
    s_or_b32 s68, s68, s56
    s_andn2_b32 s69, s66, 0xff
    s_or_b32 s69, s69, s57
    s_andn2_b32 s70, s67, 0xff
    s_or_b32 s70, s70, s58
    s_andn2_b32 s71, s61, 0xff
    s_or_b32 s71, s71, s59
    s_waitcnt lgkmcnt(0)
    v_bfi_b32 v88, s33, v16, v88
    v_bfi_b32 v89, s33, v17, v89
    v_bfi_b32 v90, s33, v18, v90
    v_bfi_b32 v91, s33, v19, v91
    v_bfi_b32 v92, s33, v16, v92
    v_bfi_b32 v93, s33, v17, v93
    v_bfi_b32 v94, s33, v18, v94
    v_bfi_b32 v95, s33, v19, v95
    buffer_store_dwordx4 v[88:91], v3, s[12:15], s42 offen offset:0 sc1
    buffer_store_dwordx4 v[92:95], v3, s[12:15], s42 offen offset:1024 sc1
    v_mov_b32 v24, s68
    v_mov_b32 v25, s69
    v_mov_b32 v26, s70
    v_mov_b32 v27, s71
    s_mov_b64 exec, 1
    buffer_store_dwordx4 v[24:27], v3, s[12:15], s43 offen sc1
    s_mov_b64 exec, -1
    s_setprio 0
f_nc1:
    buffer_load_dwordx4 v[96:99], v15, s[12:15], s41 offen
    buffer_load_dwordx4 v[100:103], v15, s[12:15], s40 offen
    s_cmp_lt_u32 s62, 0x100
    s_cbranch_scc1 f_op0
    v_pk_add_f32 v[48:49], v[160:161], s[64:65] op_sel:[0,0] op_sel_hi:[1,0] neg_lo:[0,1] neg_hi:[0,1]
    v_pk_add_f32 v[50:51], v[162:163], s[64:65] op_sel:[0,0] op_sel_hi:[1,0] neg_lo:[0,1] neg_hi:[0,1]
    v_pk_add_f32 v[52:53], v[164:165], s[64:65] op_sel:[0,0] op_sel_hi:[1,0] neg_lo:[0,1] neg_hi:[0,1]
    v_pk_add_f32 v[54:55], v[166:167], s[64:65] op_sel:[0,0] op_sel_hi:[1,0] neg_lo:[0,1] neg_hi:[0,1]
    v_pk_add_f32 v[56:57], v[168:169], s[64:65] op_sel:[0,0] op_sel_hi:[1,0] neg_lo:[0,1] neg_hi:[0,1]
    v_pk_add_f32 v[58:59], v[170:171], s[64:65] op_sel:[0,0] op_sel_hi:[1,0] neg_lo:[0,1] neg_hi:[0,1]
    v_pk_add_f32 v[60:61], v[172:173], s[64:65] op_sel:[0,0] op_sel_hi:[1,0] neg_lo:[0,1] neg_hi:[0,1]
    v_pk_add_f32 v[62:63], v[174:175], s[64:65] op_sel:[0,0] op_sel_hi:[1,0] neg_lo:[0,1] neg_hi:[0,1]
    v_pk_mul_f32 v[48:49], v[48:49], s[64:65] op_sel:[0,1] op_sel_hi:[1,1]
    v_pk_mul_f32 v[50:51], v[50:51], s[64:65] op_sel:[0,1] op_sel_hi:[1,1]
    v_pk_mul_f32 v[52:53], v[52:53], s[64:65] op_sel:[0,1] op_sel_hi:[1,1]
    v_pk_mul_f32 v[54:55], v[54:55], s[64:65] op_sel:[0,1] op_sel_hi:[1,1]
    v_pk_mul_f32 v[56:57], v[56:57], s[64:65] op_sel:[0,1] op_sel_hi:[1,1]
    v_pk_mul_f32 v[58:59], v[58:59], s[64:65] op_sel:[0,1] op_sel_hi:[1,1]
    v_pk_mul_f32 v[60:61], v[60:61], s[64:65] op_sel:[0,1] op_sel_hi:[1,1]
    v_pk_mul_f32 v[62:63], v[62:63], s[64:65] op_sel:[0,1] op_sel_hi:[1,1]
f_op0:
    s_cmp_lt_u32 s63, 0x100
    s_cbranch_scc1 f_op1
    v_pk_add_f32 v[64:65], v[176:177], s[66:67] op_sel:[0,0] op_sel_hi:[1,0] neg_lo:[0,1] neg_hi:[0,1]
    v_pk_add_f32 v[66:67], v[178:179], s[66:67] op_sel:[0,0] op_sel_hi:[1,0] neg_lo:[0,1] neg_hi:[0,1]
    v_pk_add_f32 v[68:69], v[180:181], s[66:67] op_sel:[0,0] op_sel_hi:[1,0] neg_lo:[0,1] neg_hi:[0,1]
    v_pk_add_f32 v[70:71], v[182:183], s[66:67] op_sel:[0,0] op_sel_hi:[1,0] neg_lo:[0,1] neg_hi:[0,1]
    v_pk_add_f32 v[72:73], v[184:185], s[66:67] op_sel:[0,0] op_sel_hi:[1,0] neg_lo:[0,1] neg_hi:[0,1]
    v_pk_add_f32 v[74:75], v[186:187], s[66:67] op_sel:[0,0] op_sel_hi:[1,0] neg_lo:[0,1] neg_hi:[0,1]
    v_pk_add_f32 v[76:77], v[188:189], s[66:67] op_sel:[0,0] op_sel_hi:[1,0] neg_lo:[0,1] neg_hi:[0,1]
    v_pk_add_f32 v[78:79], v[190:191], s[66:67] op_sel:[0,0] op_sel_hi:[1,0] neg_lo:[0,1] neg_hi:[0,1]
    v_pk_mul_f32 v[64:65], v[64:65], s[66:67] op_sel:[0,1] op_sel_hi:[1,1]
    v_pk_mul_f32 v[66:67], v[66:67], s[66:67] op_sel:[0,1] op_sel_hi:[1,1]
    v_pk_mul_f32 v[68:69], v[68:69], s[66:67] op_sel:[0,1] op_sel_hi:[1,1]
    v_pk_mul_f32 v[70:71], v[70:71], s[66:67] op_sel:[0,1] op_sel_hi:[1,1]
    v_pk_mul_f32 v[72:73], v[72:73], s[66:67] op_sel:[0,1] op_sel_hi:[1,1]
    v_pk_mul_f32 v[74:75], v[74:75], s[66:67] op_sel:[0,1] op_sel_hi:[1,1]
    v_pk_mul_f32 v[76:77], v[76:77], s[66:67] op_sel:[0,1] op_sel_hi:[1,1]
    v_pk_mul_f32 v[78:79], v[78:79], s[66:67] op_sel:[0,1] op_sel_hi:[1,1]
f_op1:
    s_mov_b32 s83, 0
    s_waitcnt vmcnt(0)
f_pb:
    v_xor_b32 v96, s56, v96
    v_xor_b32 v97, s57, v97
    v_xor_b32 v98, s58, v98
    v_xor_b32 v99, s59, v99
    v_xor_b32 v100, s56, v100
    v_xor_b32 v101, s57, v101
    v_xor_b32 v102, s58, v102
    v_xor_b32 v103, s59, v103
    v_or3_b32 v2, v96, v97, v98
    v_or3_b32 v2, v2, v99, v100
    v_or3_b32 v2, v2, v101, v102
    v_or_b32 v2, v2, v103
    v_and_b32 v2, 0xff, v2
    v_cmp_ne_u32 vcc, 0, v2
    s_cbranch_vccnz f_pbbad
f_pbok:
    ds_write_b128 v1, v[96:99] offset:4096
    s_cmp_ge_u32 s16, 4
    s_cbranch_scc1 f_pbx
    ds_write_b128 v1, v[100:103] offset:16384
f_pbx:
    s_waitcnt lgkmcnt(0)
    s_barrier
    ds_read_b128 v[192:195], v5 offset:16384
    ds_read_b128 v[196:199], v5 offset:17408
    ds_read_b128 v[200:203], v5 offset:18432
    ds_read_b128 v[204:207], v5 offset:19456
    ds_read_b128 v[224:227], v5 offset:4096
    ds_read_b128 v[228:231], v5 offset:5120
    ds_read_b128 v[232:235], v5 offset:6144
    ds_read_b128 v[236:239], v5 offset:7168
    ds_read_b128 v[112:115], v5 offset:12288
    ds_read_b128 v[116:119], v5 offset:13312
    ds_read_b128 v[120:123], v5 offset:14336
    ds_read_b128 v[124:127], v5 offset:15360
    s_waitcnt lgkmcnt(4)
    v_pk_fma_f32 v[48:49], v[48:49], v[192:193], v[224:225]
    v_pk_fma_f32 v[50:51], v[50:51], v[194:195], v[226:227]
    v_pk_fma_f32 v[52:53], v[52:53], v[196:197], v[228:229]
    v_pk_fma_f32 v[54:55], v[54:55], v[198:199], v[230:231]
    v_pk_fma_f32 v[56:57], v[56:57], v[200:201], v[232:233]
    v_pk_fma_f32 v[58:59], v[58:59], v[202:203], v[234:235]
    v_pk_fma_f32 v[60:61], v[60:61], v[204:205], v[236:237]
    v_pk_fma_f32 v[62:63], v[62:63], v[206:207], v[238:239]
    s_waitcnt lgkmcnt(0)
    v_pk_fma_f32 v[160:161], v[112:113], v[48:49], v[160:161]
    v_pk_fma_f32 v[162:163], v[114:115], v[50:51], v[162:163]
    v_pk_fma_f32 v[164:165], v[116:117], v[52:53], v[164:165]
    v_pk_fma_f32 v[166:167], v[118:119], v[54:55], v[166:167]
    v_pk_fma_f32 v[168:169], v[120:121], v[56:57], v[168:169]
    v_pk_fma_f32 v[170:171], v[122:123], v[58:59], v[170:171]
    v_pk_fma_f32 v[172:173], v[124:125], v[60:61], v[172:173]
    v_pk_fma_f32 v[174:175], v[126:127], v[62:63], v[174:175]
    v_cvt_pk_bf16_f32 v80, v160, v161
    v_cvt_pk_bf16_f32 v81, v162, v163
    ds_write_b64 v8, v[80:81] offset:0
    v_cvt_pk_bf16_f32 v82, v164, v165
    v_cvt_pk_bf16_f32 v83, v166, v167
    ds_write_b64 v8, v[82:83] offset:512
    v_cvt_pk_bf16_f32 v84, v168, v169
    v_cvt_pk_bf16_f32 v85, v170, v171
    ds_write_b64 v8, v[84:85] offset:1024
    v_cvt_pk_bf16_f32 v86, v172, v173
    v_cvt_pk_bf16_f32 v87, v174, v175
    ds_write_b64 v8, v[86:87] offset:1536
    ds_read_b128 v[32:35], v10 offset:0
    ds_read_b128 v[36:39], v10 offset:1024
    ds_read_b128 v[208:211], v6 offset:19456
    ds_read_b128 v[212:215], v6 offset:18432
    ds_read_b128 v[216:219], v6 offset:17408
    ds_read_b128 v[220:223], v6 offset:16384
    ds_read_b128 v[240:243], v6 offset:7168
    ds_read_b128 v[244:247], v6 offset:6144
    ds_read_b128 v[248:251], v6 offset:5120
    ds_read_b128 v[252:255], v6 offset:4096
    ds_read_b128 v[128:131], v6 offset:15360
    ds_read_b128 v[132:135], v6 offset:14336
    ds_read_b128 v[136:139], v6 offset:13312
    ds_read_b128 v[140:143], v6 offset:12288
    s_waitcnt lgkmcnt(4)
    v_pk_fma_f32 v[64:65], v[64:65], v[208:209], v[240:241]
    v_pk_fma_f32 v[66:67], v[66:67], v[210:211], v[242:243]
    v_pk_fma_f32 v[68:69], v[68:69], v[212:213], v[244:245]
    v_pk_fma_f32 v[70:71], v[70:71], v[214:215], v[246:247]
    v_pk_fma_f32 v[72:73], v[72:73], v[216:217], v[248:249]
    v_pk_fma_f32 v[74:75], v[74:75], v[218:219], v[250:251]
    v_pk_fma_f32 v[76:77], v[76:77], v[220:221], v[252:253]
    v_pk_fma_f32 v[78:79], v[78:79], v[222:223], v[254:255]
    s_waitcnt lgkmcnt(0)
    v_pk_fma_f32 v[176:177], v[128:129], v[64:65], v[176:177]
    v_pk_fma_f32 v[178:179], v[130:131], v[66:67], v[178:179]
    v_pk_fma_f32 v[180:181], v[132:133], v[68:69], v[180:181]
    v_pk_fma_f32 v[182:183], v[134:135], v[70:71], v[182:183]
    v_pk_fma_f32 v[184:185], v[136:137], v[72:73], v[184:185]
    v_pk_fma_f32 v[186:187], v[138:139], v[74:75], v[186:187]
    v_pk_fma_f32 v[188:189], v[140:141], v[76:77], v[188:189]
    v_pk_fma_f32 v[190:191], v[142:143], v[78:79], v[190:191]
    v_cvt_pk_bf16_f32 v80, v176, v177
    v_cvt_pk_bf16_f32 v81, v178, v179
    ds_write_b64 v9, v[80:81] offset:1536
    v_cvt_pk_bf16_f32 v82, v180, v181
    v_cvt_pk_bf16_f32 v83, v182, v183
    ds_write_b64 v9, v[82:83] offset:1024
    v_cvt_pk_bf16_f32 v84, v184, v185
    v_cvt_pk_bf16_f32 v85, v186, v187
    ds_write_b64 v9, v[84:85] offset:512
    v_cvt_pk_bf16_f32 v86, v188, v189
    v_cvt_pk_bf16_f32 v87, v190, v191
    ds_write_b64 v9, v[86:87] offset:0
    ds_read_b128 v[40:43], v10 offset:2048
    ds_read_b128 v[44:47], v10 offset:3072
    v_mov_b32 v21, 103168
    s_cmp_lg_u32 s16, 0
    s_cbranch_scc1 f_nrs
    s_sleep 8
    s_mov_b32 s83, 0
f_kq:
    buffer_load_dwordx4 v[96:99], v3, s[12:15], s81 offen offset:0 sc1
    buffer_load_dwordx4 v[100:103], v3, s[12:15], s81 offen offset:1024 sc1
    s_waitcnt vmcnt(0)
    v_xor_b32 v2, s32, v98
    v_bitop3_b32 v2, v2, v102, s32 bitop3:0xf6
    v_cmp_ne_u32 vcc, 0, v2
    s_cbranch_vccz f_kqx
    s_sleep 4
    s_add_u32 s83, s83, 1
    s_cmp_lt_u32 s83, 0x40000
    s_cbranch_scc1 f_kq
f_kqx:
    v_max_u32 v24, v96, v100
    v_min_u32 v25, v96, v100
    v_max3_u32 v25, v25, v97, v101
    v_mov_b32 v26, v24
    s_nop 1
    v_max_u32_dpp v26, v26, v26 row_ror:8 row_mask:0xf bank_mask:0xf
    s_nop 1
    v_max_u32_dpp v26, v26, v26 row_ror:4 row_mask:0xf bank_mask:0xf
    s_nop 1
    v_max_u32_dpp v26, v26, v26 row_ror:2 row_mask:0xf bank_mask:0xf
    s_nop 1
    v_max_u32_dpp v26, v26, v26 row_ror:1 row_mask:0xf bank_mask:0xf
    s_nop 1
    v_max_u32_dpp v26, v26, v26 row_bcast:15 row_mask:0xa bank_mask:0xf
    s_nop 1
    v_max_u32_dpp v26, v26, v26 row_bcast:31 row_mask:0xc bank_mask:0xf
    s_nop 0
    v_readlane_b32 s40, v26, 63
    s_nop 1
    v_cmp_eq_u32 vcc, s40, v24
    s_nop 1
    v_cndmask_b32 v26, v24, v25, vcc
    s_nop 1
    v_max_u32_dpp v26, v26, v26 row_ror:8 row_mask:0xf bank_mask:0xf
    s_nop 1
    v_max_u32_dpp v26, v26, v26 row_ror:4 row_mask:0xf bank_mask:0xf
    s_nop 1
    v_max_u32_dpp v26, v26, v26 row_ror:2 row_mask:0xf bank_mask:0xf
    s_nop 1
    v_max_u32_dpp v26, v26, v26 row_ror:1 row_mask:0xf bank_mask:0xf
    s_nop 1
    v_max_u32_dpp v26, v26, v26 row_bcast:15 row_mask:0xa bank_mask:0xf
    s_nop 1
    v_max_u32_dpp v26, v26, v26 row_bcast:31 row_mask:0xc bank_mask:0xf
    s_nop 0
    v_readlane_b32 s41, v26, 63
    s_and_b32 s40, s40, 0xff
    s_and_b32 s41, s41, 0xff
    v_mov_b32 v28, s40
    v_mov_b32 v29, s41
    ds_write_b64 v21, v[28:29]
f_nrs:
    s_waitcnt lgkmcnt(0)
    s_barrier
    ds_read_b64 v[28:29], v21
    s_waitcnt lgkmcnt(0)
    v_readfirstlane_b32 s40, v28
    v_readfirstlane_b32 s41, v29
    s_cmp_eq_u32 s62, s40
    s_cbranch_scc1 f_e0
    s_cmp_eq_u32 s62, s41
    s_cbranch_scc1 f_e0
    s_waitcnt vmcnt(1)
    buffer_store_dwordx4 v[32:35], v3, s[24:27], s18 offen offset:0 sc1
    s_waitcnt vmcnt(1)
    buffer_store_dwordx4 v[36:39], v3, s[24:27], s18 offen offset:1024 sc1
f_e0:
    s_cmp_eq_u32 s63, s40
    s_cbranch_scc1 f_e1
    s_cmp_eq_u32 s63, s41
    s_cbranch_scc1 f_e1
    s_waitcnt vmcnt(1)
    buffer_store_dwordx4 v[40:43], v3, s[24:27], s19 offen offset:0 sc1
    s_waitcnt vmcnt(1)
    buffer_store_dwordx4 v[44:47], v3, s[24:27], s19 offen offset:1024 sc1
f_e1:
    s_endpgm
f_qbad:
    v_mov_b32 v2, 102976
    ds_read2_b32 v[28:29], v2 offset0:1 offset1:3
    ds_read2_b32 v[30:31], v2 offset0:5 offset1:7
    s_waitcnt lgkmcnt(0)
    s_branch f_q
f_t3l:
    ds_read_b128 v[112:115], v248 offset:0
    ds_read_b128 v[116:119], v248 offset:1024
    ds_read_b128 v[120:123], v248 offset:2048
    ds_read_b128 v[124:127], v248 offset:3072
    ds_read_b128 v[128:131], v248 offset:4096
    ds_read_b128 v[132:135], v248 offset:5120
    ds_read_b128 v[136:139], v248 offset:6144
    ds_read_b128 v[140:143], v248 offset:7168
    ds_read_b32 v245, v244
    s_branch f_t3d
f_c1bad:
    s_add_u32 s83, s83, 1
    s_cmp_ge_u32 s83, 0x40000
    s_cbranch_scc1 f_c1ok
    s_bitcmp1_b32 s47, 0
    s_cbranch_scc0 f_c1b2
    s_sleep 3
f_c1b2:
    s_cmp_lg_u32 s34, 0
    s_cbranch_scc1 f_ci1
    s_add_u32 s68, s82, 32768
    buffer_load_dwordx4 v[120:123], v250, s[12:15], s68 offen offset:0 sc1
    buffer_load_dwordx4 v[124:127], v250, s[12:15], s68 offen offset:1024 sc1
f_ci1:
    buffer_load_dwordx4 v[112:115], v250, s[12:15], s82 offen offset:0 sc1
    buffer_load_dwordx4 v[116:119], v250, s[12:15], s82 offen offset:1024 sc1
    s_bitcmp1_b32 s47, 0
    s_cbranch_scc0 f_s1
    s_waitcnt vmcnt(0)
    s_branch f_c1
f_z1bad:
    s_add_u32 s83, s83, 1
    s_cmp_ge_u32 s83, 0x40000
    s_cbranch_scc1 f_z1ok
    s_sleep 4
    buffer_load_dwordx4 v[32:35], v249, s[12:15], s72 offen offset:0 sc1
    buffer_load_dwordx4 v[36:39], v249, s[12:15], s72 offen offset:1024 sc1
    buffer_load_dwordx4 v[40:43], v249, s[12:15], s72 offen offset:2048 sc1
    buffer_load_dwordx4 v[44:47], v249, s[12:15], s72 offen offset:3072 sc1
    s_waitcnt vmcnt(0)
    s_branch f_z1
f_ppbad:
    s_add_u32 s83, s83, 1
    s_cmp_ge_u32 s83, 0x40000
    s_cbranch_scc1 f_ppok
    s_sleep 3
    s_cmp_lt_u32 s16, 4
    s_cselect_b64 exec, -1, 0
    buffer_load_dwordx4 v[20:23], v15, s[12:15], s52 offen sc1
    buffer_load_dwordx4 v[240:243], v15, s[12:15], s53 offen sc1
    s_mov_b64 exec, -1
    s_waitcnt vmcnt(0)
    s_branch f_pp
f_pbbad:
    s_add_u32 s83, s83, 1
    s_cmp_ge_u32 s83, 0x40000
    s_cbranch_scc1 f_pbok
    s_sleep 3
    buffer_load_dwordx4 v[96:99], v15, s[12:15], s41 offen sc1
    buffer_load_dwordx4 v[100:103], v15, s[12:15], s40 offen sc1
    s_waitcnt vmcnt(0)
    s_branch f_pb
f_slowst:
    buffer_store_dwordx4 v[32:35], v14, s[12:15], s74 offen offset:0 sc1
    buffer_store_dwordx4 v[36:39], v14, s[12:15], s74 offen offset:2048 sc1
    buffer_store_dwordx4 v[40:43], v14, s[12:15], s75 offen offset:0 sc1
    buffer_store_dwordx4 v[44:47], v14, s[12:15], s75 offen offset:2048 sc1
    s_branch f_std
f_rare:
    v_and_b32 v2, v21, v35
    v_cmp_eq_u32 s[72:73], 0, v2
    v_and_b32 v2, v21, v39
    v_cmp_eq_u32 s[74:75], 0, v2
    v_and_b32 v2, v21, v43
    v_cmp_eq_u32 s[78:79], 0, v2
    v_and_b32 v2, v21, v47
    v_cmp_eq_u32 s[36:37], 0, v2
    v_or_b32 v35, v21, v35
    v_or_b32 v39, v21, v39
    v_or_b32 v43, v21, v43
    v_or_b32 v47, v21, v47
    v_bfe_u32 v144, v0, 4, 2
    v_lshlrev_b32 v144, 3, v144
    ds_read_b128 v[120:123], v5 offset:10240
    ds_read_b128 v[136:139], v6 offset:9216
    ds_read_b128 v[56:59], v5 offset:2048
    ds_read_b128 v[72:75], v6 offset:1024
    ds_read_b128 v[124:127], v5 offset:11264
    ds_read_b128 v[140:143], v6 offset:8192
    ds_read_b128 v[60:63], v5 offset:3072
    ds_read_b128 v[76:79], v6 offset:0
    ds_read2_b32 v[28:29], v20 offset0:1 offset1:3
    ds_read2_b32 v[30:31], v20 offset0:5 offset1:7
    s_mov_b32 s83, 0
    s_waitcnt lgkmcnt(0)
f_rz:
    buffer_load_dwordx2 v[152:153], v144, s[12:15], s77 offen offset:0 sc1
    buffer_load_dwordx2 v[154:155], v144, s[12:15], s77 offen offset:32 sc1
    buffer_load_dwordx2 v[156:157], v144, s[12:15], s77 offen offset:64 sc1
    buffer_load_dwordx2 v[158:159], v144, s[12:15], s77 offen offset:96 sc1
    s_waitcnt vmcnt(0)
    v_mov_b32 v145, s32
    v_cndmask_b32 v152, v145, v152, s[72:73]
    v_cndmask_b32 v154, v145, v154, s[74:75]
    v_cndmask_b32 v156, v145, v156, s[78:79]
    v_cndmask_b32 v158, v145, v158, s[36:37]
    v_xor_b32 v2, s32, v152
    v_bitop3_b32 v2, v2, v154, s32 bitop3:0xf6
    v_bitop3_b32 v2, v2, v156, s32 bitop3:0xf6
    v_bitop3_b32 v2, v2, v158, s32 bitop3:0xf6
    v_cmp_ne_u32 vcc, 0, v2
    s_cbranch_vccz f_rzx
    s_sleep 2
    s_add_u32 s83, s83, 1
    s_cmp_lt_u32 s83, 0x40000
    s_cbranch_scc1 f_rz
f_rzx:
    v_cndmask_b32 v148, 2, v153, s[72:73]
    v_cndmask_b32 v149, 2, v155, s[74:75]
    v_cndmask_b32 v150, 2, v157, s[78:79]
    v_cndmask_b32 v151, 2, v159, s[36:37]
    v_max_i32 v145, v148, v149
    v_max3_i32 v145, v145, v150, v151
    s_nop 0
    v_readlane_b32 s64, v145, 0
    v_readlane_b32 s65, v145, 16
    v_readlane_b32 s66, v145, 32
    v_readlane_b32 s67, v145, 48
    s_max_i32 s64, s64, s65
    s_max_i32 s66, s66, s67
    s_max_i32 s64, s64, s66
    s_add_i32 s66, s64, 125
    s_lshl_b32 s66, s66, 23
    s_nop 0
    v_subrev_u32 v148, s64, v148
    v_ldexp_f32 v148, 1.0, v148
    v_cvt_pk_f16_f32 v148, v148, v148
    v_subrev_u32 v149, s64, v149
    v_ldexp_f32 v149, 1.0, v149
    v_cvt_pk_f16_f32 v149, v149, v149
    v_subrev_u32 v150, s64, v150
    v_ldexp_f32 v150, 1.0, v150
    v_cvt_pk_f16_f32 v150, v150, v150
    v_subrev_u32 v151, s64, v151
    v_ldexp_f32 v151, 1.0, v151
    v_cvt_pk_f16_f32 v151, v151, v151
    v_pk_mul_f16 v32, v32, v148
    v_pk_mul_f16 v33, v33, v148
    v_pk_mul_f16 v34, v34, v148
    v_pk_mul_f16 v35, v35, v148
    v_pk_mul_f16 v36, v36, v149
    v_pk_mul_f16 v37, v37, v149
    v_pk_mul_f16 v38, v38, v149
    v_pk_mul_f16 v39, v39, v149
    v_pk_mul_f16 v40, v40, v150
    v_pk_mul_f16 v41, v41, v150
    v_pk_mul_f16 v42, v42, v150
    v_pk_mul_f16 v43, v43, v150
    v_pk_mul_f16 v44, v44, v151
    v_pk_mul_f16 v45, v45, v151
    v_pk_mul_f16 v46, v46, v151
    v_pk_mul_f16 v47, v47, v151
    v_pk_mul_f32 v[112:113], v[112:113], s[66:67] op_sel:[0,0] op_sel_hi:[1,0]
    v_pk_mul_f32 v[114:115], v[114:115], s[66:67] op_sel:[0,0] op_sel_hi:[1,0]
    v_pk_mul_f32 v[116:117], v[116:117], s[66:67] op_sel:[0,0] op_sel_hi:[1,0]
    v_pk_mul_f32 v[118:119], v[118:119], s[66:67] op_sel:[0,0] op_sel_hi:[1,0]
    v_pk_mul_f32 v[120:121], v[120:121], s[66:67] op_sel:[0,0] op_sel_hi:[1,0]
    v_pk_mul_f32 v[122:123], v[122:123], s[66:67] op_sel:[0,0] op_sel_hi:[1,0]
    v_pk_mul_f32 v[124:125], v[124:125], s[66:67] op_sel:[0,0] op_sel_hi:[1,0]
    v_pk_mul_f32 v[126:127], v[126:127], s[66:67] op_sel:[0,0] op_sel_hi:[1,0]
    v_pk_mul_f32 v[128:129], v[128:129], s[66:67] op_sel:[0,0] op_sel_hi:[1,0]
    v_pk_mul_f32 v[130:131], v[130:131], s[66:67] op_sel:[0,0] op_sel_hi:[1,0]
    v_pk_mul_f32 v[132:133], v[132:133], s[66:67] op_sel:[0,0] op_sel_hi:[1,0]
    v_pk_mul_f32 v[134:135], v[134:135], s[66:67] op_sel:[0,0] op_sel_hi:[1,0]
    v_pk_mul_f32 v[136:137], v[136:137], s[66:67] op_sel:[0,0] op_sel_hi:[1,0]
    v_pk_mul_f32 v[138:139], v[138:139], s[66:67] op_sel:[0,0] op_sel_hi:[1,0]
    v_pk_mul_f32 v[140:141], v[140:141], s[66:67] op_sel:[0,0] op_sel_hi:[1,0]
    v_pk_mul_f32 v[142:143], v[142:143], s[66:67] op_sel:[0,0] op_sel_hi:[1,0]
    v_mfma_f32_16x16x32_f16 v[80:83], v[32:35], v[192:195], 0
    v_mfma_f32_16x16x32_f16 v[80:83], v[36:39], v[196:199], v[80:83]
    v_mfma_f32_16x16x32_f16 v[80:83], v[40:43], v[200:203], v[80:83]
    v_mfma_f32_16x16x32_f16 v[80:83], v[44:47], v[204:207], v[80:83]
    v_mfma_f32_16x16x32_f16 v[84:87], v[32:35], v[208:211], 0
    v_mfma_f32_16x16x32_f16 v[84:87], v[36:39], v[212:215], v[84:87]
    v_mfma_f32_16x16x32_f16 v[84:87], v[40:43], v[216:219], v[84:87]
    v_mfma_f32_16x16x32_f16 v[84:87], v[44:47], v[220:223], v[84:87]
    s_nop 7
    s_branch f_zfok
f_slow2:
    v_cvt_pk_bf16_f32 v144, v160, v161
    v_lshlrev_b32 v160, 16, v144
    v_and_b32 v161, 0xffff0000, v144
    v_cvt_pk_bf16_f32 v144, v162, v163
    v_lshlrev_b32 v162, 16, v144
    v_and_b32 v163, 0xffff0000, v144
    v_cvt_pk_bf16_f32 v144, v164, v165
    v_lshlrev_b32 v164, 16, v144
    v_and_b32 v165, 0xffff0000, v144
    v_cvt_pk_bf16_f32 v144, v166, v167
    v_lshlrev_b32 v166, 16, v144
    v_and_b32 v167, 0xffff0000, v144
    v_cvt_pk_bf16_f32 v144, v168, v169
    v_lshlrev_b32 v168, 16, v144
    v_and_b32 v169, 0xffff0000, v144
    v_cvt_pk_bf16_f32 v144, v170, v171
    v_lshlrev_b32 v170, 16, v144
    v_and_b32 v171, 0xffff0000, v144
    v_cvt_pk_bf16_f32 v144, v172, v173
    v_lshlrev_b32 v172, 16, v144
    v_and_b32 v173, 0xffff0000, v144
    v_cvt_pk_bf16_f32 v144, v174, v175
    v_lshlrev_b32 v174, 16, v144
    v_and_b32 v175, 0xffff0000, v144
    v_pk_add_f32 v[144:145], v[160:161], v[162:163]
    v_pk_add_f32 v[144:145], v[144:145], v[164:165]
    v_pk_add_f32 v[144:145], v[144:145], v[166:167]
    v_pk_add_f32 v[144:145], v[144:145], v[168:169]
    v_pk_add_f32 v[144:145], v[144:145], v[170:171]
    v_pk_add_f32 v[144:145], v[144:145], v[172:173]
    v_pk_add_f32 v[144:145], v[144:145], v[174:175]
    v_cvt_pk_bf16_f32 v152, v176, v177
    v_lshlrev_b32 v176, 16, v152
    v_and_b32 v177, 0xffff0000, v152
    v_cvt_pk_bf16_f32 v152, v178, v179
    v_lshlrev_b32 v178, 16, v152
    v_and_b32 v179, 0xffff0000, v152
    v_cvt_pk_bf16_f32 v152, v180, v181
    v_lshlrev_b32 v180, 16, v152
    v_and_b32 v181, 0xffff0000, v152
    v_cvt_pk_bf16_f32 v152, v182, v183
    v_lshlrev_b32 v182, 16, v152
    v_and_b32 v183, 0xffff0000, v152
    v_cvt_pk_bf16_f32 v152, v184, v185
    v_lshlrev_b32 v184, 16, v152
    v_and_b32 v185, 0xffff0000, v152
    v_cvt_pk_bf16_f32 v152, v186, v187
    v_lshlrev_b32 v186, 16, v152
    v_and_b32 v187, 0xffff0000, v152
    v_cvt_pk_bf16_f32 v152, v188, v189
    v_lshlrev_b32 v188, 16, v152
    v_and_b32 v189, 0xffff0000, v152
    v_cvt_pk_bf16_f32 v152, v190, v191
    v_lshlrev_b32 v190, 16, v152
    v_and_b32 v191, 0xffff0000, v152
    v_pk_add_f32 v[152:153], v[176:177], v[178:179]
    v_pk_add_f32 v[152:153], v[152:153], v[180:181]
    v_pk_add_f32 v[152:153], v[152:153], v[182:183]
    v_pk_add_f32 v[152:153], v[152:153], v[184:185]
    v_pk_add_f32 v[152:153], v[152:153], v[186:187]
    v_pk_add_f32 v[152:153], v[152:153], v[188:189]
    v_pk_add_f32 v[152:153], v[152:153], v[190:191]
    v_add_f32 v104, v144, v145
    v_add_f32 v108, v152, v153
    s_nop 1
    v_permlane32_swap_b32 v104, v108
    v_add_f32 v104, v104, v108
    s_nop 1
    v_add_f32_dpp v104, v104, v104 row_ror:8 row_mask:0xf bank_mask:0xf
    s_nop 1
    v_add_f32_dpp v104, v104, v104 row_ror:4 row_mask:0xf bank_mask:0xf
    s_nop 1
    v_add_f32_dpp v104, v104, v104 row_ror:2 row_mask:0xf bank_mask:0xf
    s_nop 1
    v_add_f32_dpp v104, v104, v104 row_ror:1 row_mask:0xf bank_mask:0xf
    s_nop 1
    v_add_f32_dpp v104, v104, v104 row_bcast:15 row_mask:0xa bank_mask:0xf
    v_mul_f32 v107, s46, v104
    v_cvt_pk_bf16_f32 v104, v107, v107
    v_lshlrev_b32 v104, 16, v104
    v_sub_f32 v107, v107, v104
    v_readlane_b32 s64, v104, 31
    v_readlane_b32 s66, v104, 63
    s_nop 0
    v_pk_add_f32 v[80:81], v[160:161], s[64:65] op_sel:[0,0] op_sel_hi:[1,0] neg_lo:[0,1] neg_hi:[0,1]
    v_pk_add_f32 v[82:83], v[162:163], s[64:65] op_sel:[0,0] op_sel_hi:[1,0] neg_lo:[0,1] neg_hi:[0,1]
    v_pk_add_f32 v[84:85], v[164:165], s[64:65] op_sel:[0,0] op_sel_hi:[1,0] neg_lo:[0,1] neg_hi:[0,1]
    v_pk_add_f32 v[86:87], v[166:167], s[64:65] op_sel:[0,0] op_sel_hi:[1,0] neg_lo:[0,1] neg_hi:[0,1]
    v_pk_add_f32 v[88:89], v[168:169], s[64:65] op_sel:[0,0] op_sel_hi:[1,0] neg_lo:[0,1] neg_hi:[0,1]
    v_pk_add_f32 v[90:91], v[170:171], s[64:65] op_sel:[0,0] op_sel_hi:[1,0] neg_lo:[0,1] neg_hi:[0,1]
    v_pk_add_f32 v[92:93], v[172:173], s[64:65] op_sel:[0,0] op_sel_hi:[1,0] neg_lo:[0,1] neg_hi:[0,1]
    v_pk_add_f32 v[94:95], v[174:175], s[64:65] op_sel:[0,0] op_sel_hi:[1,0] neg_lo:[0,1] neg_hi:[0,1]
    v_pk_mul_f32 v[146:147], v[80:81], v[80:81]
    v_pk_mul_f32 v[148:149], v[80:81], v[48:49]
    v_pk_fma_f32 v[146:147], v[82:83], v[82:83], v[146:147]
    v_pk_fma_f32 v[148:149], v[82:83], v[50:51], v[148:149]
    v_pk_fma_f32 v[146:147], v[84:85], v[84:85], v[146:147]
    v_pk_fma_f32 v[148:149], v[84:85], v[52:53], v[148:149]
    v_pk_fma_f32 v[146:147], v[86:87], v[86:87], v[146:147]
    v_pk_fma_f32 v[148:149], v[86:87], v[54:55], v[148:149]
    v_pk_fma_f32 v[146:147], v[88:89], v[88:89], v[146:147]
    v_pk_fma_f32 v[148:149], v[88:89], v[56:57], v[148:149]
    v_pk_fma_f32 v[146:147], v[90:91], v[90:91], v[146:147]
    v_pk_fma_f32 v[148:149], v[90:91], v[58:59], v[148:149]
    v_pk_fma_f32 v[146:147], v[92:93], v[92:93], v[146:147]
    v_pk_fma_f32 v[148:149], v[92:93], v[60:61], v[148:149]
    v_pk_fma_f32 v[146:147], v[94:95], v[94:95], v[146:147]
    v_pk_fma_f32 v[148:149], v[94:95], v[62:63], v[148:149]
    v_pk_add_f32 v[32:33], v[176:177], s[66:67] op_sel:[0,0] op_sel_hi:[1,0] neg_lo:[0,1] neg_hi:[0,1]
    v_pk_add_f32 v[34:35], v[178:179], s[66:67] op_sel:[0,0] op_sel_hi:[1,0] neg_lo:[0,1] neg_hi:[0,1]
    v_pk_add_f32 v[36:37], v[180:181], s[66:67] op_sel:[0,0] op_sel_hi:[1,0] neg_lo:[0,1] neg_hi:[0,1]
    v_pk_add_f32 v[38:39], v[182:183], s[66:67] op_sel:[0,0] op_sel_hi:[1,0] neg_lo:[0,1] neg_hi:[0,1]
    v_pk_add_f32 v[40:41], v[184:185], s[66:67] op_sel:[0,0] op_sel_hi:[1,0] neg_lo:[0,1] neg_hi:[0,1]
    v_pk_add_f32 v[42:43], v[186:187], s[66:67] op_sel:[0,0] op_sel_hi:[1,0] neg_lo:[0,1] neg_hi:[0,1]
    v_pk_add_f32 v[44:45], v[188:189], s[66:67] op_sel:[0,0] op_sel_hi:[1,0] neg_lo:[0,1] neg_hi:[0,1]
    v_pk_add_f32 v[46:47], v[190:191], s[66:67] op_sel:[0,0] op_sel_hi:[1,0] neg_lo:[0,1] neg_hi:[0,1]
    v_pk_mul_f32 v[154:155], v[32:33], v[32:33]
    v_pk_mul_f32 v[156:157], v[32:33], v[64:65]
    v_pk_fma_f32 v[154:155], v[34:35], v[34:35], v[154:155]
    v_pk_fma_f32 v[156:157], v[34:35], v[66:67], v[156:157]
    v_pk_fma_f32 v[154:155], v[36:37], v[36:37], v[154:155]
    v_pk_fma_f32 v[156:157], v[36:37], v[68:69], v[156:157]
    v_pk_fma_f32 v[154:155], v[38:39], v[38:39], v[154:155]
    v_pk_fma_f32 v[156:157], v[38:39], v[70:71], v[156:157]
    v_pk_fma_f32 v[154:155], v[40:41], v[40:41], v[154:155]
    v_pk_fma_f32 v[156:157], v[40:41], v[72:73], v[156:157]
    v_pk_fma_f32 v[154:155], v[42:43], v[42:43], v[154:155]
    v_pk_fma_f32 v[156:157], v[42:43], v[74:75], v[156:157]
    v_pk_fma_f32 v[154:155], v[44:45], v[44:45], v[154:155]
    v_pk_fma_f32 v[156:157], v[44:45], v[76:77], v[156:157]
    v_pk_fma_f32 v[154:155], v[46:47], v[46:47], v[154:155]
    v_pk_fma_f32 v[156:157], v[46:47], v[78:79], v[156:157]
    v_add_f32 v105, v146, v147
    v_add_f32 v106, v148, v149
    v_add_f32 v109, v154, v155
    v_add_f32 v110, v156, v157
    s_nop 0
    v_permlane32_swap_b32 v105, v109
    v_permlane32_swap_b32 v106, v110
    v_add_f32 v105, v105, v109
    v_add_f32 v106, v106, v110
    s_nop 0
    v_add_f32_dpp v105, v105, v105 row_ror:8 row_mask:0xf bank_mask:0xf
    v_add_f32_dpp v106, v106, v106 row_ror:8 row_mask:0xf bank_mask:0xf
    s_nop 0
    v_add_f32_dpp v105, v105, v105 row_ror:4 row_mask:0xf bank_mask:0xf
    v_add_f32_dpp v106, v106, v106 row_ror:4 row_mask:0xf bank_mask:0xf
    s_nop 0
    v_add_f32_dpp v105, v105, v105 row_ror:2 row_mask:0xf bank_mask:0xf
    v_add_f32_dpp v106, v106, v106 row_ror:2 row_mask:0xf bank_mask:0xf
    s_nop 0
    v_add_f32_dpp v105, v105, v105 row_ror:1 row_mask:0xf bank_mask:0xf
    v_add_f32_dpp v106, v106, v106 row_ror:1 row_mask:0xf bank_mask:0xf
    s_nop 0
    v_add_f32_dpp v105, v105, v105 row_bcast:15 row_mask:0xa bank_mask:0xf
    v_add_f32_dpp v106, v106, v106 row_bcast:15 row_mask:0xa bank_mask:0xf
    v_mul_f32 v105, s46, v105
    v_fma_f32 v105, -v107, v107, v105
    v_max_f32 v105, 0, v105
    s_branch f_var2
f_slowvar:
    v_lshlrev_b32 v66, 16, v56
    s_nop 0
    v_readlane_b32 s68, v66, 31
    v_readlane_b32 s70, v66, 63
    v_lshlrev_b32 v100, 16, v32
    v_and_b32 v101, 0xffff0000, v32
    v_pk_add_f32 v[100:101], v[100:101], s[68:69] op_sel_hi:[1,0]
    v_pk_mul_f32 v[102:103], v[100:101], v[100:101]
    v_lshlrev_b32 v100, 16, v33
    v_and_b32 v101, 0xffff0000, v33
    v_pk_add_f32 v[100:101], v[100:101], s[68:69] op_sel_hi:[1,0]
    v_pk_fma_f32 v[102:103], v[100:101], v[100:101], v[102:103]
    v_lshlrev_b32 v100, 16, v34
    v_and_b32 v101, 0xffff0000, v34
    v_pk_add_f32 v[100:101], v[100:101], s[68:69] op_sel_hi:[1,0]
    v_pk_fma_f32 v[102:103], v[100:101], v[100:101], v[102:103]
    v_lshlrev_b32 v100, 16, v35
    v_and_b32 v101, 0xffff0000, v35
    v_pk_add_f32 v[100:101], v[100:101], s[68:69] op_sel_hi:[1,0]
    v_pk_fma_f32 v[102:103], v[100:101], v[100:101], v[102:103]
    v_lshlrev_b32 v100, 16, v36
    v_and_b32 v101, 0xffff0000, v36
    v_pk_add_f32 v[100:101], v[100:101], s[68:69] op_sel_hi:[1,0]
    v_pk_fma_f32 v[102:103], v[100:101], v[100:101], v[102:103]
    v_lshlrev_b32 v100, 16, v37
    v_and_b32 v101, 0xffff0000, v37
    v_pk_add_f32 v[100:101], v[100:101], s[68:69] op_sel_hi:[1,0]
    v_pk_fma_f32 v[102:103], v[100:101], v[100:101], v[102:103]
    v_lshlrev_b32 v100, 16, v38
    v_and_b32 v101, 0xffff0000, v38
    v_pk_add_f32 v[100:101], v[100:101], s[68:69] op_sel_hi:[1,0]
    v_pk_fma_f32 v[102:103], v[100:101], v[100:101], v[102:103]
    v_lshlrev_b32 v100, 16, v39
    v_and_b32 v101, 0xffff0000, v39
    v_pk_add_f32 v[100:101], v[100:101], s[68:69] op_sel_hi:[1,0]
    v_pk_fma_f32 v[102:103], v[100:101], v[100:101], v[102:103]
    v_add_f32 v54, v102, v103
    v_lshlrev_b32 v100, 16, v40
    v_and_b32 v101, 0xffff0000, v40
    v_pk_add_f32 v[100:101], v[100:101], s[70:71] op_sel_hi:[1,0]
    v_pk_mul_f32 v[102:103], v[100:101], v[100:101]
    v_lshlrev_b32 v100, 16, v41
    v_and_b32 v101, 0xffff0000, v41
    v_pk_add_f32 v[100:101], v[100:101], s[70:71] op_sel_hi:[1,0]
    v_pk_fma_f32 v[102:103], v[100:101], v[100:101], v[102:103]
    v_lshlrev_b32 v100, 16, v42
    v_and_b32 v101, 0xffff0000, v42
    v_pk_add_f32 v[100:101], v[100:101], s[70:71] op_sel_hi:[1,0]
    v_pk_fma_f32 v[102:103], v[100:101], v[100:101], v[102:103]
    v_lshlrev_b32 v100, 16, v43
    v_and_b32 v101, 0xffff0000, v43
    v_pk_add_f32 v[100:101], v[100:101], s[70:71] op_sel_hi:[1,0]
    v_pk_fma_f32 v[102:103], v[100:101], v[100:101], v[102:103]
    v_lshlrev_b32 v100, 16, v44
    v_and_b32 v101, 0xffff0000, v44
    v_pk_add_f32 v[100:101], v[100:101], s[70:71] op_sel_hi:[1,0]
    v_pk_fma_f32 v[102:103], v[100:101], v[100:101], v[102:103]
    v_lshlrev_b32 v100, 16, v45
    v_and_b32 v101, 0xffff0000, v45
    v_pk_add_f32 v[100:101], v[100:101], s[70:71] op_sel_hi:[1,0]
    v_pk_fma_f32 v[102:103], v[100:101], v[100:101], v[102:103]
    v_lshlrev_b32 v100, 16, v46
    v_and_b32 v101, 0xffff0000, v46
    v_pk_add_f32 v[100:101], v[100:101], s[70:71] op_sel_hi:[1,0]
    v_pk_fma_f32 v[102:103], v[100:101], v[100:101], v[102:103]
    v_lshlrev_b32 v100, 16, v47
    v_and_b32 v101, 0xffff0000, v47
    v_pk_add_f32 v[100:101], v[100:101], s[70:71] op_sel_hi:[1,0]
    v_pk_fma_f32 v[102:103], v[100:101], v[100:101], v[102:103]
    v_add_f32 v55, v102, v103
    v_add_f32 v66, v66, v52
    s_nop 0
    v_permlane32_swap_b32 v54, v55
    v_add_f32 v54, v54, v55
    s_nop 1
    v_add_f32_dpp v54, v54, v54 row_ror:8 row_mask:0xf bank_mask:0xf
    s_nop 1
    v_add_f32_dpp v54, v54, v54 row_ror:4 row_mask:0xf bank_mask:0xf
    s_nop 1
    v_add_f32_dpp v54, v54, v54 row_ror:2 row_mask:0xf bank_mask:0xf
    s_nop 1
    v_add_f32_dpp v54, v54, v54 row_ror:1 row_mask:0xf bank_mask:0xf
    s_nop 1
    v_add_f32_dpp v54, v54, v54 row_bcast:15 row_mask:0xa bank_mask:0xf
    v_mul_f32 v54, s46, v54
    v_fma_f32 v54, -v66, v66, v54
    v_max_f32 v54, 0, v54
    s_branch f_var
f_sa:
    s_add_u32 s69, s69, 50331648
    v_cndmask_b32 v120, v120, v121, s[64:65]
    v_cndmask_b32 v122, v122, v123, s[64:65]
    v_cndmask_b32 v120, v120, v122, s[66:67]
    v_mul_f32 v120, s69, v120
    v_and_b32 v52, 15, v0
    v_cvt_pk_f16_f32 v48, v120, v120
    v_cmp_eq_u32 vcc, 0, v52
    v_mov_b32 v54, 0x3c00
    v_mov_b32 v55, 0xbc000000
    v_cndmask_b32 v54, 0, v54, vcc
    v_cndmask_b32 v55, 0, v55, vcc
    v_mov_b32_dpp v56, v48 quad_perm:[0,0,0,0] row_mask:0xf bank_mask:0xf
    v_mov_b32_dpp v57, v48 quad_perm:[1,1,1,1] row_mask:0xf bank_mask:0xf
    v_mov_b32_dpp v58, v48 quad_perm:[2,2,2,2] row_mask:0xf bank_mask:0xf
    v_mov_b32_dpp v59, v48 quad_perm:[3,3,3,3] row_mask:0xf bank_mask:0xf
    v_pk_mul_f16 v72, v54, v56
    v_pk_mul_f16 v73, v54, v57
    v_pk_mul_f16 v74, v54, v58
    v_pk_mul_f16 v75, v54, v59
    v_pk_mul_f16 v76, v55, v56
    v_pk_mul_f16 v77, v55, v57
    v_pk_mul_f16 v78, v55, v58
    v_pk_mul_f16 v79, v55, v59
    v_mfma_f32_16x16x32_f16 v[112:115], v[72:75], v[144:147], 0
    s_nop 0
    v_mfma_f32_16x16x32_f16 v[116:119], v[76:79], v[144:147], 0
    s_lshl_b32 s70, s16, 7
    v_mov_b32 v53, 8592
    v_add3_u32 v52, s70, v12, v53
    s_mov_b64 exec, 0xffff
    s_nop 3
    ds_write2_b32 v52, v112, v116 offset0:0 offset1:16
    s_mov_b64 exec, -1
    s_branch f_nsa
f_sb:
    v_mov_b32 v48, s32
    v_mov_b32 v49, s61
    v_mov_b32 v50, 0
    s_cmp_lg_u32 s17, 0
    s_cselect_b64 exec, 1, 0
    buffer_store_dwordx2 v[48:49], v50, s[12:15], s79 offen sc1
    s_mov_b64 exec, -1
    s_cmp_lg_u32 s34, 0
    s_cbranch_scc1 f_sb2
    s_mov_b64 exec, 0xffff
    ds_read_b32 v56, v12 offset:8592
    ds_read_b32 v57, v12 offset:8656
    ds_read_b32 v58, v12 offset:8720
    ds_read_b32 v59, v12 offset:8784
    ds_read_b32 v60, v12 offset:8848
    ds_read_b32 v61, v12 offset:8912
    ds_read_b32 v62, v12 offset:8976
    ds_read_b32 v63, v12 offset:9040
    s_waitcnt lgkmcnt(0)
    v_add_f32 v80, v80, v56
    v_add_f32 v84, v84, v57
    v_add_f32 v88, v88, v58
    v_add_f32 v92, v92, v59
    v_add_f32 v96, v96, v60
    v_add_f32 v100, v100, v61
    v_add_f32 v104, v104, v62
    v_add_f32 v108, v108, v63
    s_mov_b64 exec, -1
f_sb2:
    s_branch f_nsb
f_sp:
    v_mfma_f32_16x16x32_f16 v[88:91], v[32:35], v[224:227], 0
    v_mfma_f32_16x16x32_f16 v[88:91], v[36:39], v[228:231], v[88:91]
    v_mfma_f32_16x16x32_f16 v[88:91], v[40:43], v[232:235], v[88:91]
    v_mfma_f32_16x16x32_f16 v[88:91], v[44:47], v[236:239], v[88:91]
    v_subrev_u32 v25, s45, v8
    v_lshlrev_b32 v25, 1, v25
    v_sub_u32 v26, 1008, v25
    v_mfma_f32_16x16x32_f16 v[92:95], v[32:35], v[240:243], 0
    v_pk_mul_f16 v32, v32, 1.0 op_sel:[1,0] op_sel_hi:[0,0] neg_hi:[1,0]
    v_pk_mul_f16 v33, v33, 1.0 op_sel:[1,0] op_sel_hi:[0,0] neg_hi:[1,0]
    v_pk_mul_f16 v34, v34, 1.0 op_sel:[1,0] op_sel_hi:[0,0] neg_hi:[1,0]
    v_pk_mul_f16 v35, v35, 1.0 op_sel:[1,0] op_sel_hi:[0,0] neg_hi:[1,0]
    v_mfma_f32_16x16x32_f16 v[92:95], v[36:39], v[244:247], v[92:95]
    v_pk_mul_f16 v36, v36, 1.0 op_sel:[1,0] op_sel_hi:[0,0] neg_hi:[1,0]
    v_pk_mul_f16 v37, v37, 1.0 op_sel:[1,0] op_sel_hi:[0,0] neg_hi:[1,0]
    v_pk_mul_f16 v38, v38, 1.0 op_sel:[1,0] op_sel_hi:[0,0] neg_hi:[1,0]
    v_pk_mul_f16 v39, v39, 1.0 op_sel:[1,0] op_sel_hi:[0,0] neg_hi:[1,0]
    v_mfma_f32_16x16x32_f16 v[92:95], v[40:43], v[248:251], v[92:95]
    v_pk_mul_f16 v40, v40, 1.0 op_sel:[1,0] op_sel_hi:[0,0] neg_hi:[1,0]
    v_pk_mul_f16 v41, v41, 1.0 op_sel:[1,0] op_sel_hi:[0,0] neg_hi:[1,0]
    v_pk_mul_f16 v42, v42, 1.0 op_sel:[1,0] op_sel_hi:[0,0] neg_hi:[1,0]
    v_pk_mul_f16 v43, v43, 1.0 op_sel:[1,0] op_sel_hi:[0,0] neg_hi:[1,0]
    v_mfma_f32_16x16x32_f16 v[92:95], v[44:47], v[252:255], v[92:95]
    v_pk_mul_f16 v44, v44, 1.0 op_sel:[1,0] op_sel_hi:[0,0] neg_hi:[1,0]
    v_pk_mul_f16 v45, v45, 1.0 op_sel:[1,0] op_sel_hi:[0,0] neg_hi:[1,0]
    v_pk_mul_f16 v46, v46, 1.0 op_sel:[1,0] op_sel_hi:[0,0] neg_hi:[1,0]
    v_pk_mul_f16 v47, v47, 1.0 op_sel:[1,0] op_sel_hi:[0,0] neg_hi:[1,0]
    v_mfma_f32_16x16x32_f16 v[96:99], v[32:35], v[192:195], 0
    v_mfma_f32_16x16x32_f16 v[96:99], v[36:39], v[196:199], v[96:99]
    v_mfma_f32_16x16x32_f16 v[96:99], v[40:43], v[200:203], v[96:99]
    v_mfma_f32_16x16x32_f16 v[96:99], v[44:47], v[204:207], v[96:99]
    ds_write_b128 v25, v[80:83] offset:0
    s_mov_b64 exec, 1
    ds_write_b32 v25, v80 offset:4096
    s_mov_b64 exec, -1
    v_mfma_f32_16x16x32_f16 v[100:103], v[32:35], v[208:211], 0
    v_mfma_f32_16x16x32_f16 v[100:103], v[36:39], v[212:215], v[100:103]
    v_mfma_f32_16x16x32_f16 v[100:103], v[40:43], v[216:219], v[100:103]
    v_mfma_f32_16x16x32_f16 v[100:103], v[44:47], v[220:223], v[100:103]
    ds_write_b128 v25, v[84:87] offset:1024
    v_mfma_f32_16x16x32_f16 v[104:107], v[32:35], v[224:227], 0
    v_mfma_f32_16x16x32_f16 v[104:107], v[36:39], v[228:231], v[104:107]
    v_mfma_f32_16x16x32_f16 v[104:107], v[40:43], v[232:235], v[104:107]
    v_mfma_f32_16x16x32_f16 v[104:107], v[44:47], v[236:239], v[104:107]
    ds_write_b128 v25, v[88:91] offset:2048
    v_mfma_f32_16x16x32_f16 v[108:111], v[32:35], v[240:243], 0
    v_mfma_f32_16x16x32_f16 v[108:111], v[36:39], v[244:247], v[108:111]
    v_mfma_f32_16x16x32_f16 v[108:111], v[40:43], v[248:251], v[108:111]
    v_mfma_f32_16x16x32_f16 v[108:111], v[44:47], v[252:255], v[108:111]
    ds_write_b128 v25, v[92:95] offset:3072
    ds_read_b128 v[32:35], v26 offset:3072
    ds_read_b32 v152, v26 offset:3088
    ds_read_b128 v[36:39], v26 offset:2048
    ds_read_b32 v153, v26 offset:2064
    ds_read_b128 v[40:43], v26 offset:1024
    ds_read_b32 v154, v26 offset:1040
    ds_read_b128 v[44:47], v26 offset:0
    ds_read_b32 v155, v26 offset:16
    ds_write_b128 v25, v[96:99] offset:4352
    s_mov_b64 exec, 1
    ds_write_b32 v25, v96 offset:8448
    s_mov_b64 exec, -1
    ds_write_b128 v25, v[100:103] offset:5376
    ds_write_b128 v25, v[104:107] offset:6400
    ds_write_b128 v25, v[108:111] offset:7424
    s_waitcnt lgkmcnt(5)
    ds_read_b128 v[192:195], v26 offset:7424
    ds_read_b32 v156, v25 offset:4368
    ds_read_b128 v[196:199], v26 offset:6400
    ds_read_b32 v157, v25 offset:5392
    ds_read_b128 v[200:203], v26 offset:5376
    ds_read_b32 v158, v25 offset:6416
    ds_read_b128 v[204:207], v26 offset:4352
    ds_read_b32 v159, v25 offset:7440
    v_add_f32 v80, v80, v152
    v_add_f32 v81, v81, v35
    v_add_f32 v82, v82, v34
    v_add_f32 v83, v83, v33
    v_add_f32 v84, v84, v153
    v_add_f32 v85, v85, v39
    v_add_f32 v86, v86, v38
    v_add_f32 v87, v87, v37
    v_add_f32 v88, v88, v154
    v_add_f32 v89, v89, v43
    v_add_f32 v90, v90, v42
    v_add_f32 v91, v91, v41
    v_add_f32 v92, v92, v155
    v_add_f32 v93, v93, v47
    v_add_f32 v94, v94, v46
    v_add_f32 v95, v95, v45
    v_pk_fma_f32 v[160:161], v[112:113], v[80:81], v[160:161]
    v_pk_fma_f32 v[162:163], v[114:115], v[82:83], v[162:163]
    v_pk_fma_f32 v[164:165], v[116:117], v[84:85], v[164:165]
    v_pk_fma_f32 v[166:167], v[118:119], v[86:87], v[166:167]
    v_pk_fma_f32 v[168:169], v[120:121], v[88:89], v[168:169]
    v_pk_fma_f32 v[170:171], v[122:123], v[90:91], v[170:171]
    v_pk_fma_f32 v[172:173], v[124:125], v[92:93], v[172:173]
    v_pk_fma_f32 v[174:175], v[126:127], v[94:95], v[174:175]
    v_pk_mul_f32 v[146:147], v[160:161], v[160:161]
    v_pk_mul_f32 v[148:149], v[160:161], v[48:49]
    v_pk_fma_f32 v[146:147], v[162:163], v[162:163], v[146:147]
    v_pk_fma_f32 v[148:149], v[162:163], v[50:51], v[148:149]
    v_pk_fma_f32 v[146:147], v[164:165], v[164:165], v[146:147]
    v_pk_fma_f32 v[148:149], v[164:165], v[52:53], v[148:149]
    v_pk_fma_f32 v[146:147], v[166:167], v[166:167], v[146:147]
    v_pk_fma_f32 v[148:149], v[166:167], v[54:55], v[148:149]
    v_pk_fma_f32 v[146:147], v[168:169], v[168:169], v[146:147]
    v_pk_fma_f32 v[148:149], v[168:169], v[56:57], v[148:149]
    v_pk_fma_f32 v[146:147], v[170:171], v[170:171], v[146:147]
    v_pk_fma_f32 v[148:149], v[170:171], v[58:59], v[148:149]
    v_pk_fma_f32 v[146:147], v[172:173], v[172:173], v[146:147]
    v_pk_fma_f32 v[148:149], v[172:173], v[60:61], v[148:149]
    v_pk_fma_f32 v[146:147], v[174:175], v[174:175], v[146:147]
    v_pk_fma_f32 v[148:149], v[174:175], v[62:63], v[148:149]
    v_pk_add_f32 v[144:145], v[160:161], v[162:163]
    v_pk_add_f32 v[144:145], v[144:145], v[164:165]
    v_pk_add_f32 v[144:145], v[144:145], v[166:167]
    v_pk_add_f32 v[144:145], v[144:145], v[168:169]
    v_pk_add_f32 v[144:145], v[144:145], v[170:171]
    v_pk_add_f32 v[144:145], v[144:145], v[172:173]
    v_pk_add_f32 v[144:145], v[144:145], v[174:175]
    s_waitcnt lgkmcnt(0)
    v_add_f32 v192, v192, v156
    v_add_f32 v193, v193, v99
    v_add_f32 v194, v194, v98
    v_add_f32 v195, v195, v97
    v_add_f32 v196, v196, v157
    v_add_f32 v197, v197, v103
    v_add_f32 v198, v198, v102
    v_add_f32 v199, v199, v101
    v_add_f32 v200, v200, v158
    v_add_f32 v201, v201, v107
    v_add_f32 v202, v202, v106
    v_add_f32 v203, v203, v105
    v_add_f32 v204, v204, v159
    v_add_f32 v205, v205, v111
    v_add_f32 v206, v206, v110
    v_add_f32 v207, v207, v109
    v_pk_fma_f32 v[176:177], v[128:129], v[192:193], v[176:177]
    v_pk_fma_f32 v[178:179], v[130:131], v[194:195], v[178:179]
    v_pk_fma_f32 v[180:181], v[132:133], v[196:197], v[180:181]
    v_pk_fma_f32 v[182:183], v[134:135], v[198:199], v[182:183]
    v_pk_fma_f32 v[184:185], v[136:137], v[200:201], v[184:185]
    v_pk_fma_f32 v[186:187], v[138:139], v[202:203], v[186:187]
    v_pk_fma_f32 v[188:189], v[140:141], v[204:205], v[188:189]
    v_pk_fma_f32 v[190:191], v[142:143], v[206:207], v[190:191]
    v_pk_mul_f32 v[154:155], v[176:177], v[176:177]
    v_pk_mul_f32 v[156:157], v[176:177], v[64:65]
    v_pk_fma_f32 v[154:155], v[178:179], v[178:179], v[154:155]
    v_pk_fma_f32 v[156:157], v[178:179], v[66:67], v[156:157]
    v_pk_fma_f32 v[154:155], v[180:181], v[180:181], v[154:155]
    v_pk_fma_f32 v[156:157], v[180:181], v[68:69], v[156:157]
    v_pk_fma_f32 v[154:155], v[182:183], v[182:183], v[154:155]
    v_pk_fma_f32 v[156:157], v[182:183], v[70:71], v[156:157]
    v_pk_fma_f32 v[154:155], v[184:185], v[184:185], v[154:155]
    v_pk_fma_f32 v[156:157], v[184:185], v[72:73], v[156:157]
    v_pk_fma_f32 v[154:155], v[186:187], v[186:187], v[154:155]
    v_pk_fma_f32 v[156:157], v[186:187], v[74:75], v[156:157]
    v_pk_fma_f32 v[154:155], v[188:189], v[188:189], v[154:155]
    v_pk_fma_f32 v[156:157], v[188:189], v[76:77], v[156:157]
    v_pk_fma_f32 v[154:155], v[190:191], v[190:191], v[154:155]
    v_pk_fma_f32 v[156:157], v[190:191], v[78:79], v[156:157]
    v_pk_add_f32 v[152:153], v[176:177], v[178:179]
    v_pk_add_f32 v[152:153], v[152:153], v[180:181]
    v_pk_add_f32 v[152:153], v[152:153], v[182:183]
    v_pk_add_f32 v[152:153], v[152:153], v[184:185]
    v_pk_add_f32 v[152:153], v[152:153], v[186:187]
    v_pk_add_f32 v[152:153], v[152:153], v[188:189]
    v_pk_add_f32 v[152:153], v[152:153], v[190:191]
    s_branch f_join
g_start:
    s_mov_b32 s43, 6619136
    s_load_dword s101, s[6:7], s43
    s_mov_b32 s44, s20
    s_mov_b32 s45, s21
    s_mov_b32 s46, 2048
    s_mov_b32 s47, 0x00020000
    v_and_b32 v6, 127, v0
    v_lshlrev_b32 v6, 1, v6
    s_lshl_b32 s19, s34, 8
    buffer_load_ushort v110, v6, s[44:47], s19 offen
    s_and_b32 s65, s35, 1
    s_lshr_b32 s40, s35, 1
    s_mul_i32 s64, s34, 7
    s_add_u32 s64, s64, s40
    s_cmp_ge_u32 s35, 14
    s_cselect_b32 s66, 1, 0
    s_mov_b32 s40, s34
    v_bfe_u32 v5, v0, 5, 1
    v_lshlrev_b32 v5, 3, v5
    v_bfe_u32 v9, v0, 3, 2
    v_add_u32 v5, v5, v9
    v_lshlrev_b32 v9, 1, v7
    v_xor_b32 v9, v9, v0
    v_and_b32 v9, 7, v9
    v_lshlrev_b32 v9, 4, v9
    s_movk_i32 s42, 7168
    v_mad_u32_u24 v5, v5, s42, v9
    v_mov_b32 v104, -1
    v_mov_b32 v105, -1
    v_mov_b32 v106, -1
    v_mov_b32 v107, -1
    v_mov_b32 v14, 0
    s_lshl_b32 s38, s64, 12
    s_lshl_b32 s42, s16, 9
    s_add_u32 s38, s38, s42
    s_mul_i32 s42, s65, 262144
    s_add_u32 s38, s38, s42
    s_add_u32 s38, s38, 4718592
    s_mov_b32 s12, s6
    s_mov_b32 s13, s7
    s_mov_b32 s14, 268435456
    s_mov_b32 s15, 0x00020000
    s_lshl_b32 s42, s35, 3
    s_add_u32 s42, s42, s34
    s_lshl_b32 s42, s42, 3
    s_add_u32 s42, s42, s16
    s_lshl_b32 s42, s42, 8
    s_add_u32 s42, s42, 6291456
    v_lshlrev_b32 v9, 7, v2
    s_mov_b64 exec, 3
    buffer_load_dword v251, v9, s[12:15], s42 offen
    s_mov_b64 exec, -1
    s_mov_b32 s44, s50
    s_mov_b32 s45, s51
    s_mov_b32 s46, 7340032
    s_mov_b32 s47, 0x00020000
    s_mov_b32 s60, s52
    s_mov_b32 s61, s53
    s_mov_b32 s62, 7340032
    s_mov_b32 s63, 0x00020000
    s_mov_b32 s72, s54
    s_mov_b32 s73, s55
    s_mov_b32 s74, 7340032
    s_mov_b32 s75, 0x00020000
    s_mov_b32 s26, 4194304
    s_mov_b32 s27, 0x00020000
    s_lshl_b32 s67, s65, 4
    s_add_u32 s67, s67, s16
    s_mul_i32 s67, s67, 229376
    s_lshl_b32 s42, s64, 7
    s_add_u32 s67, s67, s42
    s_lshl_b32 s42, s64, 6
    s_and_b32 s43, s16, 3
    s_lshl_b32 s43, s43, 3
    s_add_u32 s42, s42, s43
    s_and_b32 s43, s16, 4
    s_add_u32 s42, s42, s43
    s_lshl_b32 s69, s42, 11
    s_lshl_b32 s43, s65, 10
    s_add_u32 s69, s69, s43
    s_and_b32 s43, s16, 1
    s_lshl_b32 s43, s43, 7
    v_xor_b32 v21, s43, v3
    v_xor_b32 v22, 32, v21
    v_xor_b32 v23, 64, v21
    v_xor_b32 v24, 96, v21
    v_add_u32 v109, 131072, v6
    v_lshrrev_b32 v6, 2, v2
    v_and_b32 v15, 3, v0
    v_bfe_u32 v16, v0, 3, 2
    v_xor_b32 v12, v16, v1
    v_and_b32 v12, 3, v12
    v_lshlrev_b32 v12, 5, v12
    v_lshl_add_u32 v12, v6, 7, v12
    v_lshl_add_u32 v12, v15, 3, v12
    v_lshrrev_b32 v16, 2, v1
    v_lshl_add_u32 v12, v16, 14, v12
    v_add_u32 v25, 65536, v12
    v_and_b32 v17, 7, v6
    v_lshlrev_b32 v8, 2, v1
    v_xor_b32 v8, v8, v17
    v_lshlrev_b32 v8, 5, v8
    v_lshl_add_u32 v8, v6, 10, v8
    v_lshl_add_u32 v8, v15, 3, v8
    v_xor_b32 v9, 32, v8
    v_xor_b32 v10, 64, v8
    v_xor_b32 v11, 96, v8
    v_and_b32 v6, 1, v0
    v_lshlrev_b32 v17, 10, v6
    v_lshl_add_u32 v17, v16, 8, v17
    v_bfe_u32 v18, v0, 1, 1
    v_lshlrev_b32 v19, 4, v18
    v_lshl_add_u32 v19, v7, 5, v19
    v_add_u32 v17, v17, v19
    v_add_u32 v17, 131584, v17
    v_lshl_add_u32 v19, v6, 7, v19
    v_add_u32 v19, 133632, v19
    v_mul_u32_u24 v213, 0xaaaa, v18
    v_add_u32 v213, 0x4444, v213
    v_lshlrev_b32 v18, 4, v18
    v_lshl_add_u32 v18, v6, 1, v18
    v_and_b32 v6, 12, v0
    v_add_u32 v18, v18, v6
    v_and_b32 v6, 15, v0
    v_lshl_add_u32 v18, v1, 5, v18
    v_lshl_add_u32 v18, v7, 7, v18
    v_add_u32 v18, 133632, v18
    v_lshlrev_b32 v20, 2, v6
    v_lshl_add_u32 v20, v1, 14, v20
    v_lshl_add_u32 v20, v7, 12, v20
    v_lshlrev_b32 v26, 4, v7
    v_add_u32 v27, 131072, v26
    v_lshlrev_b32 v28, 11, v7
    v_bfe_u32 v29, v0, 2, 3
    v_xor_b32 v29, v29, v1
    v_lshl_add_u32 v29, v29, 5, v28
    v_bfe_u32 v30, v0, 2, 2
    v_lshl_add_u32 v29, v30, 8, v29
    v_lshl_add_u32 v29, v15, 3, v29
    v_add_u32 v30, 65536, v29
    s_lshl_b32 s30, s41, 15
    s_and_b32 s42, s16, 3
    s_lshl_b32 s42, s42, 13
    s_add_u32 s30, s30, s42
    s_lshl_b32 s42, s40, 8
    s_add_u32 s30, s30, s42
    s_lshl_b32 s42, s17, 1
    s_lshr_b32 s43, s16, 2
    s_add_u32 s42, s42, s43
    s_lshl_b32 s42, s42, 4
    s_add_u32 s30, s30, s42
    s_add_u32 s30, s30, 6291456
    s_lshl_b32 s31, s41, 5
    s_lshr_b32 s42, s16, 1
    s_add_u32 s31, s31, s42
    s_lshl_b32 s31, s31, 10
    s_lshl_b32 s42, s40, 7
    s_add_u32 s31, s31, s42
    s_and_b32 s42, s16, 1
    s_lshl_b32 s42, s42, 6
    s_add_u32 s31, s31, s42
    s_add_u32 s31, s31, 6356992
    s_movk_i32 s33, 0xff
    s_cmp_eq_u32 s66, 1
    s_cbranch_scc1 x_start
    s_mul_i32 s70, s41, -4096
    s_add_u32 s70, s70, 8192
    s_add_u32 s70, s70, s18
    s_add_u32 s42, s17, 1
    s_and_b32 s42, s42, 7
    s_lshl_b32 s42, s42, 8
    s_add_u32 s70, s70, s42
    s_add_u32 s43, s68, 32768
    s_mov_b32 m0, s43
    s_add_u32 s42, s70, 0
    s_waitcnt vmcnt(5)
    buffer_load_dwordx4 v4, s[8:11], s42 offen  lds
    s_add_u32 s43, s68, 33792
    s_mov_b32 m0, s43
    s_add_u32 s42, s70, 49152
    s_waitcnt vmcnt(5)
    buffer_load_dwordx4 v4, s[8:11], s42 offen  lds
    s_add_u32 s43, s68, 34816
    s_mov_b32 m0, s43
    s_add_u32 s42, s70, 98304
    s_waitcnt vmcnt(5)
    buffer_load_dwordx4 v31, s[8:11], s42 offen  lds
    s_add_u32 s43, s68, 35840
    s_mov_b32 m0, s43
    s_add_u32 s42, s70, 147456
    s_waitcnt vmcnt(5)
    buffer_load_dwordx4 v31, s[8:11], s42 offen  lds
    s_waitcnt vmcnt(5)
    v_lshlrev_b32 v110, 16, v110
    v_mul_f32 v111, 0xbfb8aa3b, v110
    v_exp_f32 v111, v111
    s_nop 0
    v_add_f32 v111, 1.0, v111
    v_rcp_f32 v111, v111
    s_nop 0
    v_mul_f32 v110, v110, v111
    v_cvt_pk_bf16_f32 v110, v110, v110
    ds_write_b16 v109, v110
    s_waitcnt lgkmcnt(0)
    s_barrier
    ds_read_b128 v[128:131], v27 offset:0
    ds_read_b128 v[132:135], v27 offset:64
    ds_read_b128 v[136:139], v27 offset:128
    ds_read_b128 v[140:143], v27 offset:192
    ds_read_b64_tr_b16 v[144:145], v29 offset:0
    ds_read_b64_tr_b16 v[146:147], v29 offset:1024
    ds_read_b64_tr_b16 v[148:149], v29 offset:8192
    ds_read_b64_tr_b16 v[150:151], v29 offset:9216
    ds_read_b64_tr_b16 v[152:153], v29 offset:16384
    ds_read_b64_tr_b16 v[154:155], v29 offset:17408
    ds_read_b64_tr_b16 v[156:157], v29 offset:24576
    ds_read_b64_tr_b16 v[158:159], v29 offset:25600
    s_mul_i32 s32, s101, 0x9e3779b1
    s_or_b32 s32, s32, 0x101
    s_and_b32 s32, s32, 0xfffefbfb
    s_and_b32 s56, s32, 0xff
    s_bfe_u32 s57, s32, 0x80008
    s_bfe_u32 s58, s32, 0x80010
    s_lshr_b32 s59, s32, 24
    v_mov_b32 v164, s56
    v_mov_b32 v165, s57
    v_mov_b32 v166, s58
    v_mov_b32 v167, s59
    s_waitcnt lgkmcnt(6)
    v_mfma_f32_16x16x32_bf16 v[160:163], v[144:147], v[128:131], 0
    s_waitcnt lgkmcnt(4)
    v_mfma_f32_16x16x32_bf16 v[160:163], v[148:151], v[132:135], v[160:163]
    s_waitcnt lgkmcnt(2)
    v_mfma_f32_16x16x32_bf16 v[160:163], v[152:155], v[136:139], v[160:163]
    s_waitcnt lgkmcnt(0)
    v_mfma_f32_16x16x32_bf16 v[160:163], v[156:159], v[140:143], v[160:163]
    s_nop 7
    v_bfi_b32 v160, s33, v164, v160
    v_bfi_b32 v161, s33, v165, v161
    v_bfi_b32 v162, s33, v166, v162
    v_bfi_b32 v163, s33, v167, v163
    s_mov_b32 exec_lo, 0x00010001
    s_mov_b32 exec_hi, 0x00010001
    buffer_store_dwordx4 v[160:163], v28, s[12:15], s30 offen sc1
    s_mov_b64 exec, -1
    s_mul_i32 s70, s41, 4096
    s_add_u32 s70, s70, 6144
    s_add_u32 s70, s70, s18
    s_add_u32 s42, s17, 2
    s_and_b32 s42, s42, 7
    s_lshl_b32 s42, s42, 8
    s_add_u32 s70, s70, s42
    s_add_u32 s43, s68, 65536
    s_mov_b32 m0, s43
    s_add_u32 s42, s70, 0
    s_waitcnt vmcnt(4)
    buffer_load_dwordx4 v4, s[8:11], s42 offen  lds
    s_add_u32 s43, s68, 66560
    s_mov_b32 m0, s43
    s_add_u32 s42, s70, 49152
    s_waitcnt vmcnt(4)
    buffer_load_dwordx4 v4, s[8:11], s42 offen  lds
    s_add_u32 s43, s68, 67584
    s_mov_b32 m0, s43
    s_add_u32 s42, s70, 98304
    s_waitcnt vmcnt(4)
    buffer_load_dwordx4 v31, s[8:11], s42 offen  lds
    s_add_u32 s43, s68, 68608
    s_mov_b32 m0, s43
    s_add_u32 s42, s70, 147456
    s_waitcnt vmcnt(4)
    buffer_load_dwordx4 v31, s[8:11], s42 offen  lds
    s_waitcnt lgkmcnt(0)
    s_barrier
    ds_read_b64_tr_b16 v[144:145], v29 offset:32768
    ds_read_b64_tr_b16 v[146:147], v29 offset:33792
    ds_read_b64_tr_b16 v[148:149], v29 offset:40960
    ds_read_b64_tr_b16 v[150:151], v29 offset:41984
    ds_read_b64_tr_b16 v[152:153], v29 offset:49152
    ds_read_b64_tr_b16 v[154:155], v29 offset:50176
    ds_read_b64_tr_b16 v[156:157], v29 offset:57344
    ds_read_b64_tr_b16 v[158:159], v29 offset:58368
    s_waitcnt lgkmcnt(6)
    v_mfma_f32_16x16x32_bf16 v[160:163], v[144:147], v[128:131], 0
    s_waitcnt lgkmcnt(4)
    v_mfma_f32_16x16x32_bf16 v[160:163], v[148:151], v[132:135], v[160:163]
    s_waitcnt lgkmcnt(2)
    v_mfma_f32_16x16x32_bf16 v[160:163], v[152:155], v[136:139], v[160:163]
    s_waitcnt lgkmcnt(0)
    v_mfma_f32_16x16x32_bf16 v[160:163], v[156:159], v[140:143], v[160:163]
    s_add_u32 s42, s17, 1
    s_and_b32 s42, s42, 7
    s_lshl_b32 s42, s42, 12
    s_add_u32 s42, s42, s31
    s_add_u32 s42, s42, 0
    s_nop 2
    v_bfi_b32 v160, s33, v164, v160
    v_bfi_b32 v161, s33, v165, v161
    v_bfi_b32 v162, s33, v166, v162
    v_bfi_b32 v163, s33, v167, v163
    s_mov_b32 exec_lo, 0x00010001
    s_mov_b32 exec_hi, 0x00010001
    buffer_store_dwordx4 v[160:163], v26, s[12:15], s42 offen sc1
    s_mov_b64 exec, -1
    s_add_u32 s43, s68, 98304
    s_mov_b32 m0, s43
    s_add_u32 s42, s69, 0
    s_waitcnt vmcnt(4)
    buffer_load_dwordx4 v21, s[72:75], s42 offen  lds
    s_add_u32 s43, s68, 99328
    s_mov_b32 m0, s43
    s_add_u32 s42, s69, 2048
    s_waitcnt vmcnt(4)
    buffer_load_dwordx4 v22, s[72:75], s42 offen  lds
    s_add_u32 s43, s68, 100352
    s_mov_b32 m0, s43
    s_add_u32 s42, s69, 4096
    s_waitcnt vmcnt(4)
    buffer_load_dwordx4 v23, s[72:75], s42 offen  lds
    s_add_u32 s43, s68, 101376
    s_mov_b32 m0, s43
    s_add_u32 s42, s69, 6144
    s_waitcnt vmcnt(4)
    buffer_load_dwordx4 v24, s[72:75], s42 offen  lds
    s_waitcnt lgkmcnt(0)
    s_barrier
    ds_read_b64_tr_b16 v[144:145], v30 offset:0
    ds_read_b64_tr_b16 v[146:147], v30 offset:1024
    ds_read_b64_tr_b16 v[148:149], v30 offset:8192
    ds_read_b64_tr_b16 v[150:151], v30 offset:9216
    ds_read_b64_tr_b16 v[152:153], v30 offset:16384
    ds_read_b64_tr_b16 v[154:155], v30 offset:17408
    ds_read_b64_tr_b16 v[156:157], v30 offset:24576
    ds_read_b64_tr_b16 v[158:159], v30 offset:25600
    s_waitcnt lgkmcnt(6)
    v_mfma_f32_16x16x32_bf16 v[160:163], v[144:147], v[128:131], 0
    s_waitcnt lgkmcnt(4)
    v_mfma_f32_16x16x32_bf16 v[160:163], v[148:151], v[132:135], v[160:163]
    s_waitcnt lgkmcnt(2)
    v_mfma_f32_16x16x32_bf16 v[160:163], v[152:155], v[136:139], v[160:163]
    s_waitcnt lgkmcnt(0)
    v_mfma_f32_16x16x32_bf16 v[160:163], v[156:159], v[140:143], v[160:163]
    s_add_u32 s42, s17, 2
    s_and_b32 s42, s42, 7
    s_lshl_b32 s42, s42, 12
    s_add_u32 s42, s42, s31
    s_add_u32 s42, s42, 65536
    s_nop 2
    v_bfi_b32 v160, s33, v164, v160
    v_bfi_b32 v161, s33, v165, v161
    v_bfi_b32 v162, s33, v166, v162
    v_bfi_b32 v163, s33, v167, v163
    s_mov_b32 exec_lo, 0x00010001
    s_mov_b32 exec_hi, 0x00010001
    buffer_store_dwordx4 v[160:163], v26, s[12:15], s42 offen sc1
    s_mov_b64 exec, -1
    s_getreg_b32 s39, hwreg(HW_REG_XCC_ID)
    s_and_b32 s39, s39, 7
    s_lshl_b32 s38, s64, 1
    s_add_u32 s38, s38, s65
    s_lshl_b32 s38, s38, 7
    s_add_u32 s38, s38, 6537216
    s_lshl_b32 s42, s16, 28
    v_mov_b32 v28, s32
    v_mov_b32 v29, s39
    v_mov_b32 v30, s42
    s_mov_b64 exec, 1
    buffer_store_dwordx2 v[28:29], v30, s[12:15], s38 offen sc1
    s_mov_b64 exec, -1
    s_xor_b32 s38, s38, 128
    s_cmp_eq_u32 s65, s65
    s_cselect_b32 s8, s50, s52
    s_cselect_b32 s9, s51, s53
    s_mov_b32 s10, 7340032
    s_lshr_b32 s42, s8, 7
    s_sub_u32 s42, 3, s42
    s_add_u32 s42, s42, s34
    s_and_b32 s42, s42, 7
    s_cmp_eq_u32 s42, 7
    s_cselect_b32 s70, 0x1000000, 0
    s_mul_i32 s43, s34, 7
    s_add_u32 s42, s42, s43
    s_lshl_b32 s42, s42, 7
    s_lshr_b32 s43, s35, 1
    s_lshl_b32 s43, s43, 3
    s_add_u32 s43, s43, s16
    s_mul_i32 s43, s43, 35840
    s_add_u32 s42, s42, s43
    s_add_u32 s42, s42, s70
    s_mul_i32 s43, s65, 3670016
    s_add_u32 s42, s42, s43
    s_add_u32 s42, s42, 1662976
    v_mul_u32_u24 v30, 7168, v2
    s_mov_b64 exec, 31
    buffer_load_dword v252, v30, s[8:11], s42 offen
    s_mov_b64 exec, -1
    v_and_b32 v191, 3, v0
    v_lshlrev_b32 v191, 3, v191
    v_lshrrev_b32 v191, v191, s32
    v_lshlrev_b32 v212, 5, v2
    s_lshl_b32 s36, s65, 11
    s_add_u32 s37, s36, 6496256
    s_add_u32 s36, s36, 6504448
    s_mov_b32 s18, 196611
    s_mov_b32 s19, 0x00020002
    v_and_b32 v208, 1, v0
    v_lshlrev_b32 v208, 3, v208
    s_not_b32 s42, s32
    v_lshrrev_b32 v208, v208, s42
    v_lshrrev_b32 v209, 2, v208
    v_lshrrev_b32 v210, 4, v208
    v_lshrrev_b32 v211, 6, v208
    v_and_b32 v208, s18, v208
    v_and_b32 v209, s18, v209
    v_and_b32 v210, s18, v210
    v_and_b32 v211, s18, v211
    v_mov_b32 v216, s56
    v_mov_b32 v217, s57
    v_mov_b32 v218, s58
    v_mov_b32 v219, s59
    v_and_b32 v13, 1, v0
    v_lshlrev_b32 v13, 3, v13
    v_sub_u32 v13, v3, v13
    v_add_u32 v13, 131584, v13
    s_lshl_b32 s71, s65, 10
    s_add_u32 s71, s71, 5242880
    s_lshl_b32 s30, s65, 17
    s_lshl_b32 s31, s64, 6
    s_add_u32 s30, s30, s31
    s_add_u32 s30, s30, 4194304
    s_add_u32 s31, s30, 262144
    s_lshl_b32 s79, s64, 2
    s_and_b32 s42, s16, 3
    s_add_u32 s79, s79, s42
    s_lshl_b32 s79, s79, 10
    s_add_u32 s81, s79, 4718592
    s_add_u32 s82, s79, 4980736
    s_lshl_b32 s76, s65, 1
    s_lshr_b32 s42, s16, 2
    s_add_u32 s76, s76, s42
    s_lshl_b32 s76, s76, 8
    s_add_u32 s77, s76, s82
    s_add_u32 s76, s76, s81
    s_lshl_b32 s78, s34, 12
    s_add_u32 s78, s78, 4947968
    s_add_u32 s43, s68, 0
    s_mov_b32 m0, s43
    s_add_u32 s42, s69, 65536
    buffer_load_dwordx4 v21, s[72:75], s42 offen  lds
    s_add_u32 s43, s68, 1024
    s_mov_b32 m0, s43
    s_add_u32 s42, s69, 67584
    buffer_load_dwordx4 v22, s[72:75], s42 offen  lds
    s_add_u32 s43, s68, 2048
    s_mov_b32 m0, s43
    s_add_u32 s42, s69, 69632
    s_waitcnt vmcnt(8)
    buffer_load_dwordx4 v23, s[72:75], s42 offen  lds
    s_add_u32 s43, s68, 3072
    s_mov_b32 m0, s43
    s_add_u32 s42, s69, 71680
    s_waitcnt vmcnt(8)
    buffer_load_dwordx4 v24, s[72:75], s42 offen  lds
    s_add_u32 s43, s68, 32768
    s_mov_b32 m0, s43
    s_add_u32 s42, s67, 0
    s_waitcnt vmcnt(8)
    buffer_load_dwordx4 v5, s[44:47], s42 offen  lds
    s_add_u32 s43, s68, 33792
    s_mov_b32 m0, s43
    s_add_u32 s42, s67, 114688
    s_waitcnt vmcnt(8)
    buffer_load_dwordx4 v5, s[44:47], s42 offen  lds
    s_waitcnt lgkmcnt(0)
    s_barrier
    v_add_u32 v168, 65536, v8
    v_add_u32 v169, 65536, v9
    v_add_u32 v170, 65536, v10
    v_add_u32 v171, 65536, v11
    ds_read_b64_tr_b16 v[32:33], v168 offset:32768
    ds_read_b64_tr_b16 v[34:35], v168 offset:49152
    ds_read_b64_tr_b16 v[40:41], v169 offset:32768
    ds_read_b64_tr_b16 v[42:43], v169 offset:49152
    ds_read_b64_tr_b16 v[48:49], v170 offset:32768
    ds_read_b64_tr_b16 v[50:51], v170 offset:49152
    ds_read_b64_tr_b16 v[56:57], v171 offset:32768
    ds_read_b64_tr_b16 v[58:59], v171 offset:49152
    s_add_u32 s43, s68, 34816
    s_mov_b32 m0, s43
    s_add_u32 s42, s67, 28672
    s_waitcnt vmcnt(5)
    buffer_load_dwordx4 v5, s[44:47], s42 offen  lds
    s_add_u32 s43, s68, 35840
    s_mov_b32 m0, s43
    s_add_u32 s42, s67, 143360
    s_waitcnt vmcnt(5)
    buffer_load_dwordx4 v5, s[44:47], s42 offen  lds
    s_add_u32 s43, s68, 65536
    s_mov_b32 m0, s43
    s_add_u32 s42, s67, 1835008
    s_waitcnt vmcnt(5)
    buffer_load_dwordx4 v5, s[44:47], s42 offen  lds
    s_add_u32 s43, s68, 66560
    s_mov_b32 m0, s43
    s_add_u32 s42, s67, 1949696
    s_waitcnt vmcnt(5)
    buffer_load_dwordx4 v5, s[44:47], s42 offen  lds
    s_waitcnt lgkmcnt(0)
    s_barrier
    ds_read_b64_tr_b16 v[36:37], v8 offset:0
    ds_read_b64_tr_b16 v[38:39], v8 offset:16384
    ds_read_b64_tr_b16 v[44:45], v9 offset:0
    ds_read_b64_tr_b16 v[46:47], v9 offset:16384
    ds_read_b64_tr_b16 v[52:53], v10 offset:0
    ds_read_b64_tr_b16 v[54:55], v10 offset:16384
    ds_read_b64_tr_b16 v[60:61], v11 offset:0
    ds_read_b64_tr_b16 v[62:63], v11 offset:16384
    s_add_u32 s43, s68, 67584
    s_mov_b32 m0, s43
    s_add_u32 s42, s67, 1863680
    s_waitcnt vmcnt(5)
    buffer_load_dwordx4 v5, s[44:47], s42 offen  lds
    s_add_u32 s43, s68, 68608
    s_mov_b32 m0, s43
    s_add_u32 s42, s67, 1978368
    s_waitcnt vmcnt(5)
    buffer_load_dwordx4 v5, s[44:47], s42 offen  lds
    s_add_u32 s43, s68, 98304
    s_mov_b32 m0, s43
    s_add_u32 s42, s67, 0
    s_waitcnt vmcnt(5)
    buffer_load_dwordx4 v5, s[60:63], s42 offen  lds
    s_add_u32 s43, s68, 99328
    s_mov_b32 m0, s43
    s_add_u32 s42, s67, 114688
    s_waitcnt vmcnt(5)
    buffer_load_dwordx4 v5, s[60:63], s42 offen  lds
    s_waitcnt lgkmcnt(0)
    s_barrier
    ds_read_b64_tr_b16 v[64:65], v12 offset:32768
    ds_read_b64_tr_b16 v[66:67], v12 offset:34816
    ds_read_b64_tr_b16 v[68:69], v12 offset:36864
    ds_read_b64_tr_b16 v[70:71], v12 offset:38912
    ds_read_b64_tr_b16 v[72:73], v12 offset:40960
    ds_read_b64_tr_b16 v[74:75], v12 offset:43008
    ds_read_b64_tr_b16 v[76:77], v12 offset:45056
    ds_read_b64_tr_b16 v[78:79], v12 offset:47104
    s_add_u32 s43, s68, 100352
    s_mov_b32 m0, s43
    s_add_u32 s42, s67, 28672
    s_waitcnt vmcnt(5)
    buffer_load_dwordx4 v5, s[60:63], s42 offen  lds
    s_add_u32 s43, s68, 101376
    s_mov_b32 m0, s43
    s_add_u32 s42, s67, 143360
    s_waitcnt vmcnt(5)
    buffer_load_dwordx4 v5, s[60:63], s42 offen  lds
    v_lshlrev_b32 v30, 6, v2
    s_cmp_eq_u32 s16, 0
    s_cselect_b64 exec, -1, 0
    buffer_load_dword v31, v30, s[12:15], s81 offen sc1
    buffer_load_dwordx2 v[188:189], v14, s[12:15], s38 offen sc1
    buffer_load_dwordx4 v[192:195], v212, s[12:15], s36 offen offset:0
    buffer_load_dwordx4 v[196:199], v212, s[12:15], s36 offen offset:16
    buffer_load_dwordx4 v[200:203], v212, s[12:15], s37 offen offset:0
    buffer_load_dwordx4 v[204:207], v212, s[12:15], s37 offen offset:16
    s_mov_b64 exec, -1
    s_add_u32 s43, s68, 0
    s_mov_b32 m0, s43
    s_add_u32 s42, s67, 1835008
    s_waitcnt vmcnt(11)
    buffer_load_dwordx4 v5, s[60:63], s42 offen  lds
    s_add_u32 s43, s68, 1024
    s_mov_b32 m0, s43
    s_add_u32 s42, s67, 1949696
    s_waitcnt vmcnt(11)
    buffer_load_dwordx4 v5, s[60:63], s42 offen  lds
    s_waitcnt lgkmcnt(0)
    s_barrier
    ds_read_b64_tr_b16 v[80:81], v25 offset:0
    ds_read_b64_tr_b16 v[82:83], v25 offset:2048
    ds_read_b64_tr_b16 v[84:85], v25 offset:4096
    ds_read_b64_tr_b16 v[86:87], v25 offset:6144
    ds_read_b64_tr_b16 v[88:89], v25 offset:8192
    ds_read_b64_tr_b16 v[90:91], v25 offset:10240
    ds_read_b64_tr_b16 v[92:93], v25 offset:12288
    ds_read_b64_tr_b16 v[94:95], v25 offset:14336
    s_cmp_eq_u32 s16, 0
    s_cselect_b64 exec, -1, 0
    buffer_load_dword v15, v14, s[12:15], s78 offen offset:2048 sc1
    s_mov_b64 exec, -1
    s_add_u32 s43, s68, 2048
    s_mov_b32 m0, s43
    s_add_u32 s42, s67, 1863680
    s_waitcnt vmcnt(12)
    buffer_load_dwordx4 v5, s[60:63], s42 offen  lds
    s_add_u32 s43, s68, 3072
    s_mov_b32 m0, s43
    s_add_u32 s42, s67, 1978368
    s_waitcnt vmcnt(12)
    buffer_load_dwordx4 v5, s[60:63], s42 offen  lds
    s_waitcnt vmcnt(11)
    s_waitcnt lgkmcnt(0)
    s_barrier
    ds_read_b64_tr_b16 v[96:97], v25 offset:32768
    ds_read_b64_tr_b16 v[98:99], v25 offset:34816
    ds_read_b64_tr_b16 v[100:101], v25 offset:36864
    ds_read_b64_tr_b16 v[102:103], v25 offset:38912
    ds_read_b64_tr_b16 v[104:105], v25 offset:40960
    ds_read_b64_tr_b16 v[106:107], v25 offset:43008
    ds_read_b64_tr_b16 v[108:109], v25 offset:45056
    ds_read_b64_tr_b16 v[110:111], v25 offset:47104
    v_mov_b32 v160, 0
    v_mov_b32 v161, 0
    v_mov_b32 v162, 0
    v_mov_b32 v163, 0
    v_mov_b32 v164, 0
    v_mov_b32 v165, 0
    v_mov_b32 v166, 0
    v_mov_b32 v167, 0
    v_mov_b32 v168, 0
    v_mov_b32 v169, 0
    v_mov_b32 v170, 0
    v_mov_b32 v171, 0
    v_mov_b32 v190, 134656
    s_cmp_lg_u32 s16, 0
    s_cbranch_scc1 m_nk
    s_mov_b32 s83, 0
    s_waitcnt vmcnt(5)
    v_xor_b32 v188, s32, v188
    v_xor_b32 v189, s39, v189
    v_or_b32 v188, v188, v189
    ds_write_b32 v190, v188
m_pm:
    v_xor_b32 v192, s56, v192
    v_xor_b32 v193, s57, v193
    v_xor_b32 v194, s58, v194
    v_xor_b32 v195, s59, v195
    v_xor_b32 v196, s56, v196
    v_xor_b32 v197, s57, v197
    v_xor_b32 v198, s58, v198
    v_xor_b32 v199, s59, v199
    v_xor_b32 v200, s56, v200
    v_xor_b32 v201, s57, v201
    v_xor_b32 v202, s58, v202
    v_xor_b32 v203, s59, v203
    v_xor_b32 v204, s56, v204
    v_xor_b32 v205, s57, v205
    v_xor_b32 v206, s58, v206
    v_xor_b32 v207, s59, v207
    v_or3_b32 v30, v192, v193, v194
    v_or3_b32 v30, v30, v195, v196
    v_or3_b32 v30, v30, v197, v198
    v_or3_b32 v30, v30, v199, v200
    v_or3_b32 v30, v30, v201, v202
    v_or3_b32 v30, v30, v203, v204
    v_or3_b32 v30, v30, v205, v206
    v_or_b32 v30, v30, v207
    v_and_b32 v30, 0xff, v30
    v_cmp_ne_u32 vcc, 0, v30
    s_cbranch_vccz m_pmx
    s_sleep 4
    buffer_load_dwordx4 v[192:195], v212, s[12:15], s36 offen offset:0 sc1
    buffer_load_dwordx4 v[196:199], v212, s[12:15], s36 offen offset:16 sc1
    buffer_load_dwordx4 v[200:203], v212, s[12:15], s37 offen offset:0 sc1
    buffer_load_dwordx4 v[204:207], v212, s[12:15], s37 offen offset:16 sc1
    s_waitcnt vmcnt(0)
    s_add_u32 s83, s83, 1
    s_cmp_lt_u32 s83, 0x40000
    s_cbranch_scc1 m_pm
m_pmx:
    s_mov_b32 s83, 0
    s_waitcnt vmcnt(2)
m_go:
    v_cmp_ne_u32 vcc, s32, v15
    s_cbranch_vccz m_gox
    s_sleep 3
    buffer_load_dword v15, v14, s[12:15], s78 offen offset:2048 sc1
    s_waitcnt vmcnt(0)
    s_add_u32 s83, s83, 1
    s_cmp_lt_u32 s83, 0x40000
    s_cbranch_scc1 m_go
m_gox:
    s_mov_b32 s83, 0
    buffer_load_dwordx4 v[136:139], v3, s[12:15], s78 offen offset:0 sc1
    buffer_load_dwordx4 v[140:143], v3, s[12:15], s78 offen offset:1024 sc1
    s_sleep 4
m_pk:
    buffer_load_dwordx4 v[144:147], v3, s[12:15], s78 offen offset:0 sc1
    buffer_load_dwordx4 v[148:151], v3, s[12:15], s78 offen offset:1024 sc1
    s_add_u32 s83, s83, 1
    s_cmp_lt_u32 s83, 0x40000
    s_cselect_b64 s[20:21], -1, 0
    s_waitcnt vmcnt(2)
    v_max_u32 v28, v136, v140
    v_xor_b32 v31, s32, v138
    v_bitop3_b32 v31, v31, v142, s32 bitop3:0xf6
    v_max_u32_dpp v30, v28, v28 row_ror:8 row_mask:0xf bank_mask:0xf
    v_cmp_ne_u32 vcc, 0, v31
    v_min_u32 v29, v136, v140
    v_max_u32_dpp v30, v30, v30 row_ror:4 row_mask:0xf bank_mask:0xf
    v_max3_u32 v29, v29, v137, v141
    s_and_b64 vcc, vcc, s[20:21]
    v_max_u32_dpp v30, v30, v30 row_ror:2 row_mask:0xf bank_mask:0xf
    s_cbranch_scc0 m_pkx
    buffer_load_dwordx4 v[136:139], v3, s[12:15], s78 offen offset:0 sc1
    buffer_load_dwordx4 v[140:143], v3, s[12:15], s78 offen offset:1024 sc1
    s_waitcnt vmcnt(2)
    v_max_u32 v28, v144, v148
    v_xor_b32 v31, s32, v146
    v_bitop3_b32 v31, v31, v150, s32 bitop3:0xf6
    v_max_u32_dpp v30, v28, v28 row_ror:8 row_mask:0xf bank_mask:0xf
    v_cmp_ne_u32 vcc, 0, v31
    v_min_u32 v29, v144, v148
    v_max_u32_dpp v30, v30, v30 row_ror:4 row_mask:0xf bank_mask:0xf
    v_max3_u32 v29, v29, v145, v149
    s_and_b64 vcc, vcc, s[20:21]
    v_max_u32_dpp v30, v30, v30 row_ror:2 row_mask:0xf bank_mask:0xf
    s_cbranch_scc0 m_pkx
    s_branch m_pk
m_pkx:
    s_nop 0
    v_max_u32_dpp v30, v30, v30 row_ror:1 row_mask:0xf bank_mask:0xf
    s_nop 1
    v_max_u32_dpp v30, v30, v30 row_bcast:15 row_mask:0xa bank_mask:0xf
    s_nop 1
    v_max_u32_dpp v30, v30, v30 row_bcast:31 row_mask:0xc bank_mask:0xf
    s_nop 0
    v_readlane_b32 s40, v30, 63
    s_and_b32 s42, s40, 0xff
    s_lshl_b32 s42, s42, 11
    v_cmp_eq_u32 vcc, s40, v28
    s_add_u32 s42, s42, s71
    buffer_load_dwordx4 v[176:179], v3, s[12:15], s42 offen sc1
    v_cndmask_b32 v30, v28, v29, vcc
    s_nop 1
    v_max_u32_dpp v30, v30, v30 row_ror:8 row_mask:0xf bank_mask:0xf
    s_nop 1
    v_max_u32_dpp v30, v30, v30 row_ror:4 row_mask:0xf bank_mask:0xf
    s_nop 1
    v_max_u32_dpp v30, v30, v30 row_ror:2 row_mask:0xf bank_mask:0xf
    s_nop 1
    v_max_u32_dpp v30, v30, v30 row_ror:1 row_mask:0xf bank_mask:0xf
    s_nop 1
    v_max_u32_dpp v30, v30, v30 row_bcast:15 row_mask:0xa bank_mask:0xf
    s_nop 1
    v_max_u32_dpp v30, v30, v30 row_bcast:31 row_mask:0xc bank_mask:0xf
    s_nop 0
    v_readlane_b32 s41, v30, 63
    s_and_b32 s41, s41, 0xff
    s_lshl_b32 s43, s41, 11
    s_add_u32 s43, s43, s71
    buffer_load_dwordx4 v[180:183], v3, s[12:15], s43 offen sc1
    s_and_b32 s40, s40, 0xff
    s_mov_b32 s83, 0
    s_lshl_b32 s41, s41, 8
    s_or_b32 s40, s40, s41
    v_mov_b32 v28, s40
    v_mov_b32 v29, s32
    s_cmp_eq_u32 s35, 0
    s_cselect_b64 exec, 1, 0
    buffer_store_dwordx2 v[28:29], v14, s[12:15], s78 offen offset:2304 sc1
    s_mov_b64 exec, -1
    s_barrier
    ds_read_b64_tr_b16 v[112:113], v12 offset:0
    ds_read_b64_tr_b16 v[114:115], v12 offset:2048
    ds_read_b64_tr_b16 v[116:117], v12 offset:4096
    ds_read_b64_tr_b16 v[118:119], v12 offset:6144
    ds_read_b64_tr_b16 v[120:121], v12 offset:8192
    ds_read_b64_tr_b16 v[122:123], v12 offset:10240
    ds_read_b64_tr_b16 v[124:125], v12 offset:12288
    ds_read_b64_tr_b16 v[126:127], v12 offset:14336
m_ph:
    s_waitcnt vmcnt(2)
    v_xor_b32 v176, v176, v208
    v_xor_b32 v177, v177, v209
    v_xor_b32 v178, v178, v210
    v_xor_b32 v179, v179, v211
    v_fma_mix_f32 v220, v176, v192, v200 op_sel:[0,0,0] op_sel_hi:[1,0,0]
    v_fma_mix_f32 v221, v176, v193, v201 op_sel:[1,0,0] op_sel_hi:[1,0,0]
    v_fma_mix_f32 v222, v177, v194, v202 op_sel:[0,0,0] op_sel_hi:[1,0,0]
    v_fma_mix_f32 v223, v177, v195, v203 op_sel:[1,0,0] op_sel_hi:[1,0,0]
    v_fma_mix_f32 v224, v178, v196, v204 op_sel:[0,0,0] op_sel_hi:[1,0,0]
    v_fma_mix_f32 v225, v178, v197, v205 op_sel:[1,0,0] op_sel_hi:[1,0,0]
    v_fma_mix_f32 v226, v179, v198, v206 op_sel:[0,0,0] op_sel_hi:[1,0,0]
    v_fma_mix_f32 v227, v179, v199, v207 op_sel:[1,0,0] op_sel_hi:[1,0,0]
    v_cvt_pk_bf16_f32 v236, v220, v221
    v_cvt_pk_bf16_f32 v238, v222, v223
    v_cvt_pk_bf16_f32 v237, v224, v225
    v_cvt_pk_bf16_f32 v239, v226, v227
    ds_write2_b64 v13, v[236:237], v[238:239] offset0:0 offset1:2
    v_xor_b32 v30, s19, v176
    v_bitop3_b32 v30, v30, v177, s19 bitop3:0xf6
    v_bitop3_b32 v30, v30, v178, s19 bitop3:0xf6
    v_bitop3_b32 v30, v30, v179, s19 bitop3:0xf6
    s_waitcnt vmcnt(1)
    v_xor_b32 v180, v180, v208
    v_xor_b32 v181, v181, v209
    v_xor_b32 v182, v182, v210
    v_xor_b32 v183, v183, v211
    v_fma_mix_f32 v228, v180, v192, v200 op_sel:[0,0,0] op_sel_hi:[1,0,0]
    v_fma_mix_f32 v229, v180, v193, v201 op_sel:[1,0,0] op_sel_hi:[1,0,0]
    v_fma_mix_f32 v230, v181, v194, v202 op_sel:[0,0,0] op_sel_hi:[1,0,0]
    v_fma_mix_f32 v231, v181, v195, v203 op_sel:[1,0,0] op_sel_hi:[1,0,0]
    v_fma_mix_f32 v232, v182, v196, v204 op_sel:[0,0,0] op_sel_hi:[1,0,0]
    v_fma_mix_f32 v233, v182, v197, v205 op_sel:[1,0,0] op_sel_hi:[1,0,0]
    v_fma_mix_f32 v234, v183, v198, v206 op_sel:[0,0,0] op_sel_hi:[1,0,0]
    v_fma_mix_f32 v235, v183, v199, v207 op_sel:[1,0,0] op_sel_hi:[1,0,0]
    v_cvt_pk_bf16_f32 v240, v228, v229
    v_cvt_pk_bf16_f32 v242, v230, v231
    v_cvt_pk_bf16_f32 v241, v232, v233
    v_cvt_pk_bf16_f32 v243, v234, v235
    ds_write2_b64 v13, v[240:241], v[242:243] offset0:128 offset1:130
    v_bitop3_b32 v30, v30, v180, s19 bitop3:0xf6
    v_bitop3_b32 v30, v30, v181, s19 bitop3:0xf6
    v_bitop3_b32 v30, v30, v182, s19 bitop3:0xf6
    v_bitop3_b32 v30, v30, v183, s19 bitop3:0xf6
    v_and_b32 v30, s18, v30
    v_cmp_ne_u32 vcc, 0, v30
    s_cbranch_vccnz m_phb
m_phx:
m_nk2:
    s_waitcnt lgkmcnt(0)
    s_barrier
    ds_read_b32 v188, v190
    ds_read_b128 v[128:131], v17 offset:0
    ds_read_b128 v[132:135], v17 offset:128
    ds_read_b128 v[136:139], v17 offset:512
    ds_read_b128 v[140:143], v17 offset:640
    s_waitcnt lgkmcnt(3)
    v_smfmac_f32_16x16x64_bf16 v[160:163], v[128:131], v[64:71], v213
    v_smfmac_f32_16x16x64_bf16 v[164:167], v[128:131], v[96:103], v213
    s_waitcnt lgkmcnt(2)
    v_smfmac_f32_16x16x64_bf16 v[160:163], v[132:135], v[72:79], v213
    v_smfmac_f32_16x16x64_bf16 v[164:167], v[132:135], v[104:111], v213
    s_waitcnt lgkmcnt(1)
    v_smfmac_f32_16x16x64_bf16 v[160:163], v[136:139], v[80:87], v213
    v_smfmac_f32_16x16x64_bf16 v[164:167], v[136:139], v[112:119], v213
    s_waitcnt lgkmcnt(0)
    v_smfmac_f32_16x16x64_bf16 v[160:163], v[140:143], v[88:95], v213
    v_smfmac_f32_16x16x64_bf16 v[164:167], v[140:143], v[120:127], v213
    v_readfirstlane_b32 s70, v188
    s_mov_b32 s83, 0
    s_cmp_eq_u32 s70, 0
    s_cselect_b32 s82, s81, s82
    s_cselect_b64 s[20:21], 0, 0xffff
    s_nop 1
    v_pk_add_f32 v[160:161], v[160:161], v[162:163]
    v_pk_add_f32 v[164:165], v[164:165], v[166:167]
    v_bfi_b32 v184, s33, v216, v160
    v_bfi_b32 v185, s33, v217, v161
    v_bfi_b32 v186, s33, v218, v164
    v_bfi_b32 v187, s33, v219, v165
    s_mov_b64 exec, 0xffff
    buffer_store_dwordx4 v[184:187], v3, s[12:15], s76 offen
    s_mov_b64 exec, s[20:21]
    buffer_store_dwordx4 v[184:187], v3, s[12:15], s77 offen sc1
    s_mov_b64 exec, -1
    v_mov_b32 v144, 0
    v_mov_b32 v145, 0
    v_mov_b32 v146, 0
    v_mov_b32 v147, 0
    v_mov_b32 v148, 0
    v_mov_b32 v149, 0
    v_mov_b32 v150, 0
    v_mov_b32 v151, 0
    v_mov_b32 v152, 0
    v_mov_b32 v153, 0
    v_mov_b32 v154, 0
    v_mov_b32 v155, 0
    v_mov_b32 v156, 0
    v_mov_b32 v157, 0
    v_mov_b32 v158, 0
    v_mov_b32 v159, 0
    s_cmp_ge_u32 s16, 4
    s_cbranch_scc1 m_na
    s_sleep 1
m_px:
    buffer_load_dwordx4 v[24:27], v3, s[12:15], s81 offen sc1
    s_mov_b32 s42, s81
    s_mov_b32 s81, s82
    s_mov_b32 s82, s42
    s_add_u32 s83, s83, 1
    s_cmp_lt_u32 s83, 0x40000
    s_cselect_b64 s[20:21], -1, 0
    s_waitcnt vmcnt(0)
    v_xor_b32 v24, s56, v24
    v_xor_b32 v25, s57, v25
    v_xor_b32 v26, s58, v26
    v_xor_b32 v27, s59, v27
    v_or3_b32 v9, v24, v25, v26
    v_bitop3_b32 v9, v9, v27, s33 bitop3:0xa8
    v_permlane32_swap_b32 v24, v26
    v_cmp_ne_u32 vcc, 0, v9
    v_permlane32_swap_b32 v25, v27
    s_and_b64 vcc, vcc, s[20:21]
    v_pk_add_f32 v[24:25], v[24:25], v[26:27]
    s_cbranch_scc1 m_px
    s_nop 0
    v_permlane16_swap_b32 v24, v25
    v_add_f32 v24, v24, v25
    v_cvt_pk_bf16_f32 v24, v24, v24
    v_lshlrev_b32 v24, 16, v24
    v_mul_f32 v25, 0xbfb8aa3b, v24
    v_exp_f32 v25, v25
    v_mov_b32 v26, v24
    v_add_f32 v25, 1.0, v25
    v_rcp_f32 v25, v25
    v_mov_b32 v27, v24
    v_mul_f32 v25, v24, v25
    s_nop 0
    v_permlane32_swap_b32 v26, v27
    v_cvt_pk_bf16_f32 v25, v25, v25
    v_lshlrev_b32 v25, 16, v25
    v_mul_f32 v25, v25, v27
    v_cvt_pk_bf16_f32 v25, v25, v25
    ds_write_b16 v18, v25
m_na:
    s_waitcnt lgkmcnt(0)
    s_barrier
    s_mov_b32 exec_lo, 0xf000f
    s_mov_b32 exec_hi, 0xf000f
    ds_read_b128 v[144:147], v19
    s_mov_b32 exec_lo, 0xf000f0
    s_mov_b32 exec_hi, 0xf000f0
    ds_read_b128 v[148:151], v19
    s_mov_b32 exec_lo, 0xf000f00
    s_mov_b32 exec_hi, 0xf000f00
    ds_read_b128 v[152:155], v19
    s_mov_b32 exec_lo, 0xf000f000
    s_mov_b32 exec_hi, 0xf000f000
    ds_read_b128 v[156:159], v19
    s_mov_b64 exec, -1
    s_waitcnt lgkmcnt(3)
    v_smfmac_f32_16x16x64_bf16 v[168:171], v[144:147], v[32:39], v213
    s_waitcnt lgkmcnt(2)
    v_smfmac_f32_16x16x64_bf16 v[168:171], v[148:151], v[40:47], v213
    s_waitcnt lgkmcnt(1)
    v_smfmac_f32_16x16x64_bf16 v[168:171], v[152:155], v[48:55], v213
    s_waitcnt lgkmcnt(0)
    v_smfmac_f32_16x16x64_bf16 v[168:171], v[156:159], v[56:63], v213
    s_nop 7
    v_pk_add_f32 v[24:25], v[168:169], v[170:171]
    v_bfi_b32 v24, s33, v191, v24
    v_bfi_b32 v25, s33, v191, v25
    buffer_store_dword v24, v20, s[12:15], s30 offen sc1
    buffer_store_dword v25, v20, s[12:15], s31 offen sc1
    s_endpgm
m_nk:
    s_waitcnt vmcnt(0)
    s_barrier
    ds_read_b64_tr_b16 v[112:113], v12 offset:0
    ds_read_b64_tr_b16 v[114:115], v12 offset:2048
    ds_read_b64_tr_b16 v[116:117], v12 offset:4096
    ds_read_b64_tr_b16 v[118:119], v12 offset:6144
    ds_read_b64_tr_b16 v[120:121], v12 offset:8192
    ds_read_b64_tr_b16 v[122:123], v12 offset:10240
    ds_read_b64_tr_b16 v[124:125], v12 offset:12288
    ds_read_b64_tr_b16 v[126:127], v12 offset:14336
    s_branch m_nk2
m_phb:
    s_add_u32 s83, s83, 1
    s_cmp_ge_u32 s83, 0x40000
    s_cbranch_scc1 m_phx
    buffer_load_dwordx4 v[176:179], v3, s[12:15], s42 offen sc1
    buffer_load_dwordx4 v[180:183], v3, s[12:15], s43 offen sc1
    s_waitcnt vmcnt(0)
    s_branch m_ph
x_start:
    s_lshl_b32 s37, s34, 1
    s_add_u32 s37, s37, s65
    s_lshl_b32 s37, s37, 3
    s_add_u32 s37, s37, s16
    s_lshl_b32 s42, s37, 8
    s_add_u32 s42, s42, 4947968
    s_mov_b64 exec, 0xffff
    buffer_store_dwordx4 v[104:107], v3, s[12:15], s42 offen sc1
    s_mov_b64 exec, -1
    s_lshl_b32 s36, s37, 12
    s_add_u32 s36, s36, 4194304
    s_lshl_b32 s76, s16, 3
    s_add_u32 s76, s76, s34
    s_lshl_b32 s77, s76, 10
    s_add_u32 s77, s77, 6356992
    s_lshl_b32 s79, s76, 7
    s_add_u32 s79, s79, 6488064
    s_lshr_b32 s71, s76, 5
    s_cmp_eq_u32 s71, 0
    s_cselect_b32 s80, 1.0, 0
    s_lshl_b32 s78, s34, 12
    s_add_u32 s78, s78, 4947968
    s_mov_b32 s72, s48
    s_mov_b32 s73, s49
    s_mov_b32 s74, 2048
    s_mov_b32 s75, 0x00020000
    v_and_b32 v10, 7, v0
    v_lshl_add_u32 v10, v10, 2, v7
    v_lshlrev_b32 v10, 1, v10
    s_lshl_b32 s42, s76, 6
    buffer_load_ushort v10, v10, s[72:75], s42 offen
    s_mul_i32 s70, s41, -4096
    s_add_u32 s70, s70, 8192
    s_add_u32 s70, s70, s18
    s_add_u32 s42, s17, 1
    s_and_b32 s42, s42, 7
    s_lshl_b32 s42, s42, 8
    s_add_u32 s70, s70, s42
    s_add_u32 s43, s68, 32768
    s_mov_b32 m0, s43
    s_add_u32 s42, s70, 0
    s_waitcnt vmcnt(7)
    buffer_load_dwordx4 v4, s[8:11], s42 offen  lds
    s_add_u32 s43, s68, 33792
    s_mov_b32 m0, s43
    s_add_u32 s42, s70, 49152
    s_waitcnt vmcnt(7)
    buffer_load_dwordx4 v4, s[8:11], s42 offen  lds
    s_add_u32 s43, s68, 34816
    s_mov_b32 m0, s43
    s_add_u32 s42, s70, 98304
    s_waitcnt vmcnt(7)
    buffer_load_dwordx4 v31, s[8:11], s42 offen  lds
    s_add_u32 s43, s68, 35840
    s_mov_b32 m0, s43
    s_add_u32 s42, s70, 147456
    s_waitcnt vmcnt(7)
    buffer_load_dwordx4 v31, s[8:11], s42 offen  lds
    s_waitcnt vmcnt(7)
    v_lshlrev_b32 v110, 16, v110
    v_mul_f32 v111, 0xbfb8aa3b, v110
    v_exp_f32 v111, v111
    s_nop 0
    v_add_f32 v111, 1.0, v111
    v_rcp_f32 v111, v111
    s_nop 0
    v_mul_f32 v110, v110, v111
    v_cvt_pk_bf16_f32 v110, v110, v110
    ds_write_b16 v109, v110
    s_waitcnt lgkmcnt(0)
    s_barrier
    ds_read_b128 v[128:131], v27 offset:0
    ds_read_b128 v[132:135], v27 offset:64
    ds_read_b128 v[136:139], v27 offset:128
    ds_read_b128 v[140:143], v27 offset:192
    ds_read_b64_tr_b16 v[144:145], v29 offset:0
    ds_read_b64_tr_b16 v[146:147], v29 offset:1024
    ds_read_b64_tr_b16 v[148:149], v29 offset:8192
    ds_read_b64_tr_b16 v[150:151], v29 offset:9216
    ds_read_b64_tr_b16 v[152:153], v29 offset:16384
    ds_read_b64_tr_b16 v[154:155], v29 offset:17408
    ds_read_b64_tr_b16 v[156:157], v29 offset:24576
    ds_read_b64_tr_b16 v[158:159], v29 offset:25600
    s_mul_i32 s32, s101, 0x9e3779b1
    s_or_b32 s32, s32, 0x101
    s_and_b32 s32, s32, 0xfffefbfb
    s_and_b32 s56, s32, 0xff
    s_bfe_u32 s57, s32, 0x80008
    s_bfe_u32 s58, s32, 0x80010
    s_lshr_b32 s59, s32, 24
    v_mov_b32 v164, s56
    v_mov_b32 v165, s57
    v_mov_b32 v166, s58
    v_mov_b32 v167, s59
    s_waitcnt lgkmcnt(6)
    v_mfma_f32_16x16x32_bf16 v[160:163], v[144:147], v[128:131], 0
    s_waitcnt lgkmcnt(4)
    v_mfma_f32_16x16x32_bf16 v[160:163], v[148:151], v[132:135], v[160:163]
    s_waitcnt lgkmcnt(2)
    v_mfma_f32_16x16x32_bf16 v[160:163], v[152:155], v[136:139], v[160:163]
    s_waitcnt lgkmcnt(0)
    v_mfma_f32_16x16x32_bf16 v[160:163], v[156:159], v[140:143], v[160:163]
    s_nop 7
    v_bfi_b32 v160, s33, v164, v160
    v_bfi_b32 v161, s33, v165, v161
    v_bfi_b32 v162, s33, v166, v162
    v_bfi_b32 v163, s33, v167, v163
    s_mov_b32 exec_lo, 0x00010001
    s_mov_b32 exec_hi, 0x00010001
    buffer_store_dwordx4 v[160:163], v28, s[12:15], s30 offen sc1
    s_mov_b64 exec, -1
    s_mul_i32 s70, s41, 4096
    s_add_u32 s70, s70, 6144
    s_add_u32 s70, s70, s18
    s_add_u32 s42, s17, 2
    s_and_b32 s42, s42, 7
    s_lshl_b32 s42, s42, 8
    s_add_u32 s70, s70, s42
    s_add_u32 s43, s68, 65536
    s_mov_b32 m0, s43
    s_add_u32 s42, s70, 0
    s_waitcnt vmcnt(4)
    buffer_load_dwordx4 v4, s[8:11], s42 offen  lds
    s_add_u32 s43, s68, 66560
    s_mov_b32 m0, s43
    s_add_u32 s42, s70, 49152
    s_waitcnt vmcnt(4)
    buffer_load_dwordx4 v4, s[8:11], s42 offen  lds
    s_add_u32 s43, s68, 67584
    s_mov_b32 m0, s43
    s_add_u32 s42, s70, 98304
    s_waitcnt vmcnt(4)
    buffer_load_dwordx4 v31, s[8:11], s42 offen  lds
    s_add_u32 s43, s68, 68608
    s_mov_b32 m0, s43
    s_add_u32 s42, s70, 147456
    s_waitcnt vmcnt(4)
    buffer_load_dwordx4 v31, s[8:11], s42 offen  lds
    s_waitcnt lgkmcnt(0)
    s_barrier
    ds_read_b64_tr_b16 v[144:145], v29 offset:32768
    ds_read_b64_tr_b16 v[146:147], v29 offset:33792
    ds_read_b64_tr_b16 v[148:149], v29 offset:40960
    ds_read_b64_tr_b16 v[150:151], v29 offset:41984
    ds_read_b64_tr_b16 v[152:153], v29 offset:49152
    ds_read_b64_tr_b16 v[154:155], v29 offset:50176
    ds_read_b64_tr_b16 v[156:157], v29 offset:57344
    ds_read_b64_tr_b16 v[158:159], v29 offset:58368
    s_waitcnt lgkmcnt(6)
    v_mfma_f32_16x16x32_bf16 v[160:163], v[144:147], v[128:131], 0
    s_waitcnt lgkmcnt(4)
    v_mfma_f32_16x16x32_bf16 v[160:163], v[148:151], v[132:135], v[160:163]
    s_waitcnt lgkmcnt(2)
    v_mfma_f32_16x16x32_bf16 v[160:163], v[152:155], v[136:139], v[160:163]
    s_waitcnt lgkmcnt(0)
    v_mfma_f32_16x16x32_bf16 v[160:163], v[156:159], v[140:143], v[160:163]
    s_add_u32 s42, s17, 1
    s_and_b32 s42, s42, 7
    s_lshl_b32 s42, s42, 12
    s_add_u32 s42, s42, s31
    s_add_u32 s42, s42, 0
    s_nop 2
    v_bfi_b32 v160, s33, v164, v160
    v_bfi_b32 v161, s33, v165, v161
    v_bfi_b32 v162, s33, v166, v162
    v_bfi_b32 v163, s33, v167, v163
    s_mov_b32 exec_lo, 0x00010001
    s_mov_b32 exec_hi, 0x00010001
    buffer_store_dwordx4 v[160:163], v26, s[12:15], s42 offen sc1
    s_mov_b64 exec, -1
    s_waitcnt vmcnt(1)
    s_waitcnt lgkmcnt(0)
    s_barrier
    ds_read_b64_tr_b16 v[144:145], v30 offset:0
    ds_read_b64_tr_b16 v[146:147], v30 offset:1024
    ds_read_b64_tr_b16 v[148:149], v30 offset:8192
    ds_read_b64_tr_b16 v[150:151], v30 offset:9216
    ds_read_b64_tr_b16 v[152:153], v30 offset:16384
    ds_read_b64_tr_b16 v[154:155], v30 offset:17408
    ds_read_b64_tr_b16 v[156:157], v30 offset:24576
    ds_read_b64_tr_b16 v[158:159], v30 offset:25600
    s_waitcnt lgkmcnt(6)
    v_mfma_f32_16x16x32_bf16 v[160:163], v[144:147], v[128:131], 0
    s_waitcnt lgkmcnt(4)
    v_mfma_f32_16x16x32_bf16 v[160:163], v[148:151], v[132:135], v[160:163]
    s_waitcnt lgkmcnt(2)
    v_mfma_f32_16x16x32_bf16 v[160:163], v[152:155], v[136:139], v[160:163]
    s_waitcnt lgkmcnt(0)
    v_mfma_f32_16x16x32_bf16 v[160:163], v[156:159], v[140:143], v[160:163]
    s_add_u32 s42, s17, 2
    s_and_b32 s42, s42, 7
    s_lshl_b32 s42, s42, 12
    s_add_u32 s42, s42, s31
    s_add_u32 s42, s42, 65536
    s_nop 2
    v_bfi_b32 v160, s33, v164, v160
    v_bfi_b32 v161, s33, v165, v161
    v_bfi_b32 v162, s33, v166, v162
    v_bfi_b32 v163, s33, v167, v163
    s_mov_b32 exec_lo, 0x00010001
    s_mov_b32 exec_hi, 0x00010001
    buffer_store_dwordx4 v[160:163], v26, s[12:15], s42 offen sc1
    s_mov_b64 exec, -1
    s_cmp_eq_u32 s65, 1
    s_cbranch_scc1 x_na
    s_cmp_eq_u32 s80, 0
    s_cselect_b32 s42, 0x42800000, 0
    v_lshl_or_b32 v10, v10, 16, s42
    v_lshlrev_b32 v8, 3, v7
    v_lshrrev_b32 v8, v8, s32
    s_mov_b32 s83, 0
x_pa:
    buffer_load_dwordx4 v[16:19], v3, s[12:15], s77 offen sc1
    s_waitcnt vmcnt(0)
    v_xor_b32 v16, s56, v16
    v_xor_b32 v17, s57, v17
    v_xor_b32 v18, s58, v18
    v_xor_b32 v19, s59, v19
    v_or3_b32 v9, v16, v17, v18
    v_or_b32 v9, v9, v19
    v_and_b32 v9, 0xff, v9
    v_cmp_ne_u32 vcc, 0, v9
    s_cbranch_vccz x_pax
    s_sleep 4
    s_add_u32 s83, s83, 1
    s_cmp_lt_u32 s83, 0x40000
    s_cbranch_scc1 x_pa
x_pax:
    v_permlane32_swap_b32 v16, v18
    v_permlane32_swap_b32 v17, v19
    v_pk_add_f32 v[16:17], v[16:17], v[18:19]
    s_nop 1
    v_permlane16_swap_b32 v16, v17
    v_add_f32 v16, v16, v17
    s_nop 1
    v_add_f32_dpp v16, v16, v16 row_ror:8 row_mask:0xf bank_mask:0xf
    v_cvt_pk_bf16_f32 v16, v16, v16
    v_lshlrev_b32 v16, 16, v16
    v_add_f32 v16, s80, v16
    v_cvt_pk_bf16_f32 v16, v16, v16
    v_lshlrev_b32 v16, 16, v16
    v_mul_f32 v20, v16, v10
    v_bfi_b32 v20, s33, v8, v20
    v_mov_b32 v21, v20
    s_nop 1
    v_permlane16_swap_b32 v20, v21
    v_mov_b32 v22, v20
    v_mov_b32 v23, v21
    s_nop 0
    v_permlane32_swap_b32 v20, v22
    v_permlane32_swap_b32 v21, v23
    s_mov_b64 exec, 0xff
    buffer_store_dwordx4 v[20:23], v3, s[12:15], s79 offen sc1
    s_mov_b64 exec, -1
    s_cmp_eq_u32 s80, 0
    s_cbranch_scc1 x_nc
    s_add_u32 s42, s79, 16384
    v_bfi_b32 v16, s33, v8, v16
    v_mov_b32 v17, v16
    s_nop 1
    v_permlane16_swap_b32 v16, v17
    v_mov_b32 v18, v16
    v_mov_b32 v19, v17
    s_nop 0
    v_permlane32_swap_b32 v16, v18
    v_permlane32_swap_b32 v17, v19
    s_mov_b64 exec, 0xff
    buffer_store_dwordx4 v[16:19], v3, s[12:15], s42 offen sc1
    s_mov_b64 exec, -1
x_nc:
    s_add_u32 s77, s77, 65536
    s_add_u32 s79, s79, 8192
    s_mov_b32 s80, 0
    s_sleep 12
    v_lshlrev_b32 v8, 3, v7
    v_lshrrev_b32 v8, v8, s32
    s_mov_b32 s83, 0
x_pb:
    buffer_load_dwordx4 v[16:19], v3, s[12:15], s77 offen sc1
    s_waitcnt vmcnt(0)
    v_xor_b32 v16, s56, v16
    v_xor_b32 v17, s57, v17
    v_xor_b32 v18, s58, v18
    v_xor_b32 v19, s59, v19
    v_or3_b32 v9, v16, v17, v18
    v_or_b32 v9, v9, v19
    v_and_b32 v9, 0xff, v9
    v_cmp_ne_u32 vcc, 0, v9
    s_cbranch_vccz x_pbx
    s_sleep 4
    s_add_u32 s83, s83, 1
    s_cmp_lt_u32 s83, 0x40000
    s_cbranch_scc1 x_pb
x_pbx:
    v_permlane32_swap_b32 v16, v18
    v_permlane32_swap_b32 v17, v19
    v_pk_add_f32 v[16:17], v[16:17], v[18:19]
    s_nop 1
    v_permlane16_swap_b32 v16, v17
    v_add_f32 v16, v16, v17
    s_nop 1
    v_add_f32_dpp v16, v16, v16 row_ror:8 row_mask:0xf bank_mask:0xf
    v_cvt_pk_bf16_f32 v16, v16, v16
    v_lshlrev_b32 v16, 16, v16
    v_add_f32 v16, s80, v16
    v_cvt_pk_bf16_f32 v16, v16, v16
    v_lshlrev_b32 v16, 16, v16
    v_bfi_b32 v16, s33, v8, v16
    v_mov_b32 v17, v16
    s_nop 1
    v_permlane16_swap_b32 v16, v17
    v_mov_b32 v18, v16
    v_mov_b32 v19, v17
    s_nop 0
    v_permlane32_swap_b32 v16, v18
    v_permlane32_swap_b32 v17, v19
    s_mov_b64 exec, 0xff
    buffer_store_dwordx4 v[16:19], v3, s[12:15], s79 offen sc1
    s_mov_b64 exec, -1
    s_barrier
    v_lshrrev_b32 v90, 3, v2
    v_mul_u32_u24 v90, 7168, v90
    v_and_b32 v91, 7, v0
    v_min_u32 v91, 6, v91
    v_lshl_add_u32 v90, v91, 7, v90
    s_lshr_b32 s42, s16, 2
    s_lshl_b32 s42, s42, 9
    s_and_b32 s43, s16, 3
    s_lshl_b32 s43, s43, 3
    s_add_u32 s42, s42, s43
    s_add_u32 s42, s42, 160
    s_mul_i32 s42, s42, 7168
    s_mul_i32 s43, s34, 896
    s_add_u32 s42, s42, s43
    buffer_load_dword v94, v90, s[60:63], s42 offen
    s_add_u32 s42, s42, 229376
    s_branch x_nb
x_na:
    v_and_b32 v90, 255, v0
    v_lshrrev_b32 v91, 8, v0
    v_lshl_add_u32 v90, v91, 9, v90
    v_mul_u32_u24 v90, 7168, v90
    s_lshr_b32 s42, s60, 7
    s_sub_u32 s42, 3, s42
    s_add_u32 s42, s42, s34
    s_and_b32 s42, s42, 7
    s_cmp_eq_u32 s42, 7
    s_cselect_b32 s70, 0x1000000, 0
    s_mul_i32 s43, s34, 7
    s_add_u32 s42, s42, s43
    s_lshl_b32 s42, s42, 7
    s_add_u32 s42, s42, 0
    s_add_u32 s42, s42, s70
    buffer_load_dword v92, v90, s[60:63], s42 offen
    s_barrier
x_nb:
    s_mov_b32 s17, s37
    s_barrier
    v_lshlrev_b32 v9, 7, v2
    s_mov_b64 exec, 268435455
    buffer_load_dword v251, v9, s[12:15], s36 offen
    s_mov_b64 exec, -1
    s_mov_b32 s8, s48
    s_mov_b32 s9, s49
    s_mov_b32 s10, 2048
    s_mov_b32 s11, 0x00020000
    s_and_b32 s18, s17, 63
    v_and_b32 v5, 3, v0
    v_lshlrev_b32 v5, 3, v5
    v_lshl_add_u32 v5, v7, 1, v5
    v_lshlrev_b32 v6, 1, v5
    v_and_b32 v86, -4, v5
    v_and_b32 v87, 2, v5
    v_lshlrev_b32 v87, 3, v87
    s_lshl_b32 s31, s18, 6
    s_add_u32 s30, s31, 6496256
    s_add_u32 s31, s30, 4096
    s_add_u32 s29, s30, 8192
    s_mov_b32 s28, 6496256
    v_lshlrev_b32 v88, 3, v7
    v_lshrrev_b32 v88, v88, s32
    v_lshrrev_b32 v89, 1, v86
    s_not_b32 s42, s32
    v_lshrrev_b32 v89, v89, s42
    v_and_b32 v89, 196611, v89
    v_lshlrev_b32 v9, 3, v2
    buffer_load_dwordx2 v[40:41], v9, s[8:11], 0 offen offset:0
    buffer_load_dwordx2 v[42:43], v9, s[8:11], 0 offen offset:512
    buffer_load_dwordx2 v[44:45], v9, s[8:11], 0 offen offset:1024
    buffer_load_dwordx2 v[46:47], v9, s[8:11], 0 offen offset:1536
    s_waitcnt vmcnt(0)
    v_lshlrev_b32 v48, 16, v40
    v_and_b32 v49, 0xffff0000, v40
    v_lshlrev_b32 v50, 16, v41
    v_and_b32 v51, 0xffff0000, v41
    v_lshlrev_b32 v52, 16, v42
    v_and_b32 v53, 0xffff0000, v42
    v_lshlrev_b32 v54, 16, v43
    v_and_b32 v55, 0xffff0000, v43
    v_lshlrev_b32 v56, 16, v44
    v_and_b32 v57, 0xffff0000, v44
    v_lshlrev_b32 v58, 16, v45
    v_and_b32 v59, 0xffff0000, v45
    v_lshlrev_b32 v60, 16, v46
    v_and_b32 v61, 0xffff0000, v46
    v_lshlrev_b32 v62, 16, v47
    v_and_b32 v63, 0xffff0000, v47
    s_cmp_lg_u32 s16, 0
    s_cbranch_scc1 x_g1x
    s_mov_b32 s83, 0
x_g1:
    buffer_load_dword v15, v14, s[12:15], s78 offen offset:2048 sc1
    s_waitcnt vmcnt(0)
    v_cmp_ne_u32 vcc, s32, v15
    s_cbranch_vccz x_g1x
    s_sleep 6
    s_add_u32 s83, s83, 1
    s_cmp_lt_u32 s83, 0x40000
    s_cbranch_scc1 x_g1
x_g1x:
    s_barrier
    s_mov_b32 s83, 0
x_pq:
    buffer_load_dwordx4 v[64:67], v3, s[12:15], s28 offen offset:0 sc1
    buffer_load_dwordx4 v[68:71], v3, s[12:15], s28 offen offset:1024 sc1
    buffer_load_dwordx4 v[72:75], v3, s[12:15], s28 offen offset:2048 sc1
    buffer_load_dwordx4 v[76:79], v3, s[12:15], s28 offen offset:3072 sc1
    buffer_load_dword v32, v6, s[12:15], s30 offen sc1
    buffer_load_dword v33, v6, s[12:15], s31 offen sc1
    buffer_load_dword v34, v6, s[12:15], s29 offen sc1
    s_waitcnt vmcnt(0)
    v_xor_b32 v36, v32, v88
    v_bitop3_b32 v36, v36, v33, v88 bitop3:0xf6
    v_bitop3_b32 v36, v36, v34, v88 bitop3:0xf6
    v_and_b32 v36, s33, v36
    v_cmp_ne_u32 s[68:69], 0, v36
    v_xor_b32 v64, s56, v64
    v_xor_b32 v65, s57, v65
    v_xor_b32 v66, s58, v66
    v_xor_b32 v67, s59, v67
    v_xor_b32 v68, s56, v68
    v_xor_b32 v69, s57, v69
    v_xor_b32 v70, s58, v70
    v_xor_b32 v71, s59, v71
    v_xor_b32 v72, s56, v72
    v_xor_b32 v73, s57, v73
    v_xor_b32 v74, s58, v74
    v_xor_b32 v75, s59, v75
    v_xor_b32 v76, s56, v76
    v_xor_b32 v77, s57, v77
    v_xor_b32 v78, s58, v78
    v_xor_b32 v79, s59, v79
    v_or3_b32 v9, v64, v65, v66
    v_or3_b32 v9, v9, v67, v68
    v_or3_b32 v9, v9, v69, v70
    v_or3_b32 v9, v9, v71, v72
    v_or3_b32 v9, v9, v73, v74
    v_or3_b32 v9, v9, v75, v76
    v_or3_b32 v9, v9, v77, v78
    v_or_b32 v9, v9, v79
    v_and_b32 v9, 0xff, v9
    v_cmp_ne_u32 vcc, 0, v9
    s_or_b64 vcc, vcc, s[68:69]
    s_cbranch_vccz x_pqx
    s_sleep 4
    s_add_u32 s83, s83, 1
    s_cmp_lt_u32 s83, 0x40000
    s_cbranch_scc1 x_pq
x_pqx:
    v_and_b32 v32, 0xffff0000, v32
    v_and_b32 v33, 0xffff0000, v33
    v_and_b32 v34, 0xffff0000, v34
    v_pk_mul_f32 v[8:9], v[48:49], v[64:65]
    v_pk_fma_f32 v[8:9], v[50:51], v[66:67], v[8:9]
    v_pk_fma_f32 v[8:9], v[52:53], v[68:69], v[8:9]
    v_pk_fma_f32 v[8:9], v[54:55], v[70:71], v[8:9]
    v_pk_fma_f32 v[8:9], v[56:57], v[72:73], v[8:9]
    v_pk_fma_f32 v[8:9], v[58:59], v[74:75], v[8:9]
    v_pk_fma_f32 v[8:9], v[60:61], v[76:77], v[8:9]
    v_pk_fma_f32 v[8:9], v[62:63], v[78:79], v[8:9]
    v_add_f32 v8, v8, v9
    s_nop 1
    v_add_f32_dpp v8, v8, v8 row_ror:8 row_mask:0xf bank_mask:0xf
    s_nop 1
    v_add_f32_dpp v8, v8, v8 row_ror:4 row_mask:0xf bank_mask:0xf
    s_nop 1
    v_add_f32_dpp v8, v8, v8 row_ror:2 row_mask:0xf bank_mask:0xf
    s_nop 1
    v_add_f32_dpp v8, v8, v8 row_ror:1 row_mask:0xf bank_mask:0xf
    s_nop 1
    v_add_f32_dpp v8, v8, v8 row_bcast:15 row_mask:0xa bank_mask:0xf
    s_nop 1
    v_add_f32_dpp v8, v8, v8 row_bcast:31 row_mask:0xc bank_mask:0xf
    s_cmp_lg_u32 s16, 0
    s_cbranch_scc1 x_ng
    v_mov_b32 v22, 0
    s_mov_b32 s83, 0
x_r0:
    buffer_load_dwordx2 v[16:17], v22, s[12:15], s78 offen offset:2304 sc1
    s_waitcnt vmcnt(0)
    v_readfirstlane_b32 s40, v16
    v_readfirstlane_b32 s41, v17
    s_cmp_eq_u32 s41, s32
    s_cbranch_scc1 x_r0x
    s_sleep 3
    s_add_u32 s83, s83, 1
    s_cmp_lt_u32 s83, 0x40000
    s_cbranch_scc1 x_r0
x_r0x:
    s_lshr_b32 s41, s40, 8
    s_and_b32 s40, s40, 0xff
    s_and_b32 s41, s41, 0xff
x_ng:
    s_barrier
    v_mov_b32 v22, 0
    s_mov_b32 s83, 0
x_r1:
    buffer_load_dwordx2 v[16:17], v22, s[12:15], s78 offen offset:2304 sc1
    s_waitcnt vmcnt(0)
    v_readfirstlane_b32 s40, v16
    v_readfirstlane_b32 s41, v17
    s_cmp_eq_u32 s41, s32
    s_cbranch_scc1 x_r1x
    s_sleep 1
    s_add_u32 s83, s83, 1
    s_cmp_lt_u32 s83, 0x40000
    s_cbranch_scc1 x_r1
x_r1x:
    s_lshr_b32 s41, s40, 8
    s_and_b32 s40, s40, 0xff
    s_and_b32 s41, s41, 0xff
    s_cmp_lt_u32 s17, 64
    s_cselect_b32 s40, s40, s41
    s_lshl_b32 s42, s40, 11
    s_add_u32 s42, s42, 5242880
    s_lshl_b32 s19, s18, 5
    s_add_u32 s43, s42, s19
    s_lshl_b32 s40, s40, 4
    s_add_u32 s40, s40, 6512640
    s_mov_b32 s83, 0
x_ps:
    buffer_load_dwordx4 v[80:83], v14, s[12:15], s40 offen sc1
    buffer_load_dword v40, v86, s[12:15], s43 offen sc1
    s_waitcnt vmcnt(0)
    v_xor_b32 v40, v40, v89
    v_xor_b32 v35, 0x00020002, v40
    v_and_b32 v35, 196611, v35
    v_cmp_ne_u32 s[68:69], 0, v35
    v_xor_b32 v80, s56, v80
    v_xor_b32 v81, s57, v81
    v_xor_b32 v82, s58, v82
    v_xor_b32 v83, s59, v83
    v_or3_b32 v9, v80, v81, v82
    v_or_b32 v9, v9, v83
    v_and_b32 v9, 0xff, v9
    v_cmp_ne_u32 vcc, 0, v9
    s_or_b64 vcc, vcc, s[68:69]
    s_cbranch_vccz x_psx
    s_sleep 2
    s_add_u32 s83, s83, 1
    s_cmp_lt_u32 s83, 0x40000
    s_cbranch_scc1 x_ps
x_psx:
    v_readfirstlane_b32 s41, v80
    s_bfe_u32 s41, s41, 0xb0008
    s_lshl_b32 s41, s41, 11
    s_add_u32 s41, s41, s19
    v_not_b32 v36, v83
    v_ashrrev_i32 v36, 31, v36
    v_or_b32 v36, 0x80000000, v36
    v_xor_b32 v36, v36, v83
    v_add_f32 v8, v8, v36
    v_cvt_pk_bf16_f32 v8, v8, v8
    v_lshlrev_b32 v8, 16, v8
    v_mul_f32 v8, 0xbfb8aa3b, v8
    v_exp_f32 v8, v8
    s_nop 0
    v_add_f32 v8, 1.0, v8
    v_rcp_f32 v8, v8
    s_nop 0
    v_cvt_pk_bf16_f32 v8, v8, v8
    v_lshlrev_b32 v8, 16, v8
    s_nop 0
    v_readlane_b32 s46, v8, 63
    v_lshrrev_b32 v40, v87, v40
    v_cvt_f32_f16 v40, v40
    v_rcp_f32 v82, v82
    v_fma_f32 v36, v40, v34, v32
    v_fma_f32 v44, v40, v82, v81
    v_fmac_f32 v44, v33, v36
    v_mul_f32 v80, s46, v33
    s_sleep 14
    s_mov_b32 s83, 0
    s_mov_b64 s[60:61], -1
    s_mov_b64 s[62:63], -1
    s_mov_b64 s[64:65], -1
    s_mov_b32 s66, -1
    s_mov_b32 s67, 0
    v_mov_b32 v108, 0
    v_mov_b32 v109, 0
    v_mov_b32 v110, 0
    v_mov_b32 v111, 0
    s_mov_b64 exec, s[60:61]
    buffer_load_dwordx4 v[16:19], v3, s[12:15], s36 offen offset:0 sc1
    s_mov_b64 exec, s[62:63]
    buffer_load_dwordx4 v[20:23], v3, s[12:15], s36 offen offset:1024 sc1
    s_mov_b64 exec, s[64:65]
    buffer_load_dwordx4 v[24:27], v3, s[12:15], s36 offen offset:2048 sc1
    s_mov_b64 exec, s[66:67]
    buffer_load_dwordx4 v[28:31], v3, s[12:15], s36 offen offset:3072 sc1
    s_sleep 8
x_p2:
    s_mov_b64 exec, s[60:61]
    buffer_load_dwordx4 v[128:131], v3, s[12:15], s36 offen offset:0 sc1
    s_mov_b64 exec, s[62:63]
    buffer_load_dwordx4 v[132:135], v3, s[12:15], s36 offen offset:1024 sc1
    s_mov_b64 exec, s[64:65]
    buffer_load_dwordx4 v[136:139], v3, s[12:15], s36 offen offset:2048 sc1
    s_mov_b64 exec, s[66:67]
    buffer_load_dwordx4 v[140:143], v3, s[12:15], s36 offen offset:3072 sc1
    s_mov_b64 exec, s[60:61]
    s_waitcnt vmcnt(7)
    v_xor_b32 v96, s56, v16
    v_xor_b32 v97, s57, v17
    v_xor_b32 v98, s58, v18
    v_xor_b32 v99, s59, v19
    v_or3_b32 v12, v96, v97, v98
    v_bitop3_b32 v12, v12, v99, s33 bitop3:0xa8
    v_cmp_ne_u32 s[60:61], 0, v12
    s_mov_b64 exec, s[62:63]
    s_waitcnt vmcnt(6)
    v_xor_b32 v100, s56, v20
    v_xor_b32 v101, s57, v21
    v_xor_b32 v102, s58, v22
    v_xor_b32 v103, s59, v23
    v_or3_b32 v12, v100, v101, v102
    v_bitop3_b32 v12, v12, v103, s33 bitop3:0xa8
    v_cmp_ne_u32 s[62:63], 0, v12
    s_mov_b64 exec, s[64:65]
    s_waitcnt vmcnt(5)
    v_xor_b32 v104, s56, v24
    v_xor_b32 v105, s57, v25
    v_xor_b32 v106, s58, v26
    v_xor_b32 v107, s59, v27
    v_or3_b32 v12, v104, v105, v106
    v_bitop3_b32 v12, v12, v107, s33 bitop3:0xa8
    v_cmp_ne_u32 s[64:65], 0, v12
    s_or_b64 s[70:71], s[60:61], s[62:63]
    s_mov_b64 exec, s[66:67]
    s_waitcnt vmcnt(4)
    v_xor_b32 v108, s56, v28
    v_xor_b32 v109, s57, v29
    v_xor_b32 v110, s58, v30
    v_xor_b32 v111, s59, v31
    v_or3_b32 v12, v108, v109, v110
    v_bitop3_b32 v12, v12, v111, s33 bitop3:0xa8
    v_cmp_ne_u32 s[66:67], 0, v12
    s_mov_b64 exec, -1
    v_pk_add_f32 v[112:113], v[96:97], v[100:101]
    v_pk_add_f32 v[114:115], v[98:99], v[102:103]
    s_or_b64 s[72:73], s[64:65], s[66:67]
    v_pk_add_f32 v[120:121], v[104:105], v[108:109]
    v_pk_add_f32 v[122:123], v[106:107], v[110:111]
    s_or_b64 s[70:71], s[70:71], s[72:73]
    v_pk_add_f32 v[112:113], v[112:113], v[120:121]
    v_pk_add_f32 v[114:115], v[114:115], v[122:123]
    s_cbranch_scc0 x_p3
    s_mov_b64 exec, s[60:61]
    buffer_load_dwordx4 v[16:19], v3, s[12:15], s36 offen offset:0 sc1
    s_mov_b64 exec, s[62:63]
    buffer_load_dwordx4 v[20:23], v3, s[12:15], s36 offen offset:1024 sc1
    s_mov_b64 exec, s[64:65]
    buffer_load_dwordx4 v[24:27], v3, s[12:15], s36 offen offset:2048 sc1
    s_mov_b64 exec, s[66:67]
    buffer_load_dwordx4 v[28:31], v3, s[12:15], s36 offen offset:3072 sc1
    s_add_u32 s83, s83, 1
    s_cmp_lt_u32 s83, 0x40000
    s_cselect_b64 s[68:69], -1, 0
    s_mov_b64 exec, s[60:61]
    s_waitcnt vmcnt(7)
    v_xor_b32 v96, s56, v128
    v_xor_b32 v97, s57, v129
    v_xor_b32 v98, s58, v130
    v_xor_b32 v99, s59, v131
    v_or3_b32 v12, v96, v97, v98
    v_bitop3_b32 v12, v12, v99, s33 bitop3:0xa8
    v_cmp_ne_u32 s[60:61], 0, v12
    s_mov_b64 exec, s[62:63]
    s_waitcnt vmcnt(6)
    v_xor_b32 v100, s56, v132
    v_xor_b32 v101, s57, v133
    v_xor_b32 v102, s58, v134
    v_xor_b32 v103, s59, v135
    v_or3_b32 v12, v100, v101, v102
    v_bitop3_b32 v12, v12, v103, s33 bitop3:0xa8
    v_cmp_ne_u32 s[62:63], 0, v12
    s_mov_b64 exec, s[64:65]
    s_waitcnt vmcnt(5)
    v_xor_b32 v104, s56, v136
    v_xor_b32 v105, s57, v137
    v_xor_b32 v106, s58, v138
    v_xor_b32 v107, s59, v139
    v_or3_b32 v12, v104, v105, v106
    v_bitop3_b32 v12, v12, v107, s33 bitop3:0xa8
    v_cmp_ne_u32 s[64:65], 0, v12
    s_or_b64 s[70:71], s[60:61], s[62:63]
    s_mov_b64 exec, s[66:67]
    s_waitcnt vmcnt(4)
    v_xor_b32 v108, s56, v140
    v_xor_b32 v109, s57, v141
    v_xor_b32 v110, s58, v142
    v_xor_b32 v111, s59, v143
    v_or3_b32 v12, v108, v109, v110
    v_bitop3_b32 v12, v12, v111, s33 bitop3:0xa8
    v_cmp_ne_u32 s[66:67], 0, v12
    s_mov_b64 exec, -1
    v_pk_add_f32 v[112:113], v[96:97], v[100:101]
    v_pk_add_f32 v[114:115], v[98:99], v[102:103]
    s_or_b64 s[72:73], s[64:65], s[66:67]
    v_pk_add_f32 v[120:121], v[104:105], v[108:109]
    v_pk_add_f32 v[122:123], v[106:107], v[110:111]
    s_or_b64 s[70:71], s[70:71], s[72:73]
    s_and_b64 s[70:71], s[70:71], s[68:69]
    v_pk_add_f32 v[112:113], v[112:113], v[120:121]
    v_pk_add_f32 v[114:115], v[114:115], v[122:123]
    s_cbranch_scc1 x_p2
x_p3:
    s_nop 0
    v_permlane32_swap_b32 v112, v114
    v_permlane32_swap_b32 v113, v115
    v_pk_add_f32 v[112:113], v[112:113], v[114:115]
    s_nop 1
    v_permlane16_swap_b32 v112, v113
    v_add_f32 v112, v112, v113
    s_nop 1
    v_add_f32_dpp v112, v112, v112 row_ror:4 row_mask:0xf bank_mask:0xf
    s_nop 1
    v_add_f32_dpp v112, v112, v112 row_ror:8 row_mask:0xf bank_mask:0xf
    v_fmac_f32 v44, v112, v80
    s_mov_b32 exec_lo, 0x000f000f
    s_mov_b32 exec_hi, 0x000f000f
    v_cvt_pk_bf16_f32 v44, v44, v44
    buffer_store_short v44, v5, s[24:27], s41 offen
    s_cmp_lg_u32 s17, 0
    s_cbranch_scc1 x_end
    s_add_u32 s101, s101, 1
    s_mov_b32 s43, 6619136
    v_mov_b32 v8, s101
    s_mov_b64 exec, 1
    buffer_store_dword v8, v14, s[12:15], s43 offen sc1
x_end:
k_done:
    s_endpgm
code_end:
.p2align 8
.type tables,@object
tables:
.long 0x3c00,0x3c00,0x3c00,0x3c00,0x3c00,0x2e463bf6,0x323e3bd9,0x34a53ba8
.long 0x3c00,0x323e3bd9,0x361f3b64,0x38723aa7,0x3c00,0x34a53ba8,0x38723aa7,0x3a2f3913
.long 0x3c00,0x361f3b64,0x39a839a8,0x3b64361f,0x3c00,0x378b3b0e,0x3aa73872,0x3bf62e46
.long 0x3c00,0x38723aa7,0x3b64361f,0x3bd9b23e,0x3c00,0x39133a2f,0x3bd9323e,0x3b0eb78b
.long 0x3c00,0x39a839a8,0x3c000000,0x39a8b9a8,0x3c00,0x3a2f3913,0x3bd9b23e,0x378bbb0e
.long 0x3c00,0x3aa73872,0x3b64b61f,0x323ebbd9,0x3c00,0x3b0e378b,0x3aa7b872,0xae46bbf6
.long 0x3c00,0x3b64361f,0x39a8b9a8,0xb61fbb64,0x3c00,0x3ba834a5,0x3872baa7,0xb913ba2f
.long 0x3c00,0x3bd9323e,0x361fbb64,0xbaa7b872,0x3c00,0x3bf62e46,0x323ebbd9,0xbba8b4a5
.long 0x3c00,0x3c00,0x3c00,0x3c00,0x361f3b64,0x378b3b0e,0x38723aa7,0x39133a2f
.long 0x39a839a8,0x3aa73872,0x3b64361f,0x3bd9323e,0x3b64361f,0x3bf62e46,0x3bd9b23e,0x3b0eb78b
.long 0x3c000000,0x3b64b61f,0x39a8b9a8,0x361fbb64,0x3b64b61f,0x3913ba2f,0x323ebbd9,0xb4a5bba8
.long 0x39a8b9a8,0x323ebbd9,0xb61fbb64,0xbaa7b872,0x361fbb64,0xb4a5bba8,0xbaa7b872,0xbbf62e46
.long 0xbc00,0xb9a8b9a8,0xbc008000,0xb9a839a8,0xb61fbb64,0xbba8b4a5,0xbaa73872,0xae463bf6
.long 0xb9a8b9a8,0xbbd9323e,0xb61f3b64,0x38723aa7,0xbb64b61f,0xba2f3913,0x323e3bd9,0x3ba834a5
.long 0xbc008000,0xb61f3b64,0x39a839a8,0x3b64b61f,0xbb64361f,0x2e463bf6,0x3bd9323e,0x378bbb0e
.long 0xb9a839a8,0x38723aa7,0x3b64b61f,0xb23ebbd9,0xb61f3b64,0x3b0e378b,0x3872baa7,0xba2fb913
.long 0x3c00,0x3c00,0x3c00,0x3c00,0x39a839a8,0x3a2f3913,0x3aa73872,0x3b0e378b
.long 0x3c000000,0x3bd9b23e,0x3b64b61f,0x3aa7b872,0x39a8b9a8,0x378bbb0e,0x323ebbd9,0xae46bbf6
.long 0xbc00,0xb61fbb64,0xb9a8b9a8,0xbb64b61f,0xb9a8b9a8,0xbba8b4a5,0xbbd9323e,0xba2f3913
.long 0xbc008000,0xbaa73872,0xb61f3b64,0x323e3bd9,0xb9a839a8,0xae463bf6,0x38723aa7,0x3ba834a5
.long 0x3c00,0x39a839a8,0x3c000000,0x39a8b9a8,0x39a839a8,0x3bf6ae46,0x3872baa7,0xb4a5bba8
.long 0x3c000000,0x3872baa7,0xb61fbb64,0xbbd9b23e,0x39a8b9a8,0xb4a5bba8,0xbbd9b23e,0xb9133a2f
.long 0xbc00,0xbb64b61f,0xb9a839a8,0x361f3b64,0xb9a8b9a8,0xbb0e378b,0x323e3bd9,0x3bf62e46
.long 0xbc008000,0xb23e3bd9,0x3b64361f,0x3872baa7,0xb9a839a8,0x39133a2f,0x3aa7b872,0xb78bbb0e
.long 0x3c00,0x3c00,0x3c00,0x3c00,0x3b64361f,0x3ba834a5,0x3bd9323e,0x3bf62e46
.long 0x39a8b9a8,0x3872baa7,0x361fbb64,0x323ebbd9,0xb61fbb64,0xb913ba2f,0xbaa7b872,0xbba8b4a5
.long 0xbc008000,0xbb64361f,0xb9a839a8,0xb61f3b64,0xb61f3b64,0x2e463bf6,0x38723aa7,0x3b0e378b
.long 0x39a839a8,0x3bd9323e,0x3b64b61f,0x3872baa7,0x3b64b61f,0x378bbb0e,0xb23ebbd9,0xba2fb913
.long 0xbc00,0xb9a8b9a8,0xbc008000,0xb9a839a8,0xbb64b61f,0xbb0e378b,0xb23e3bd9,0x39133a2f
.long 0xb9a839a8,0x323e3bd9,0x3b64361f,0x3aa7b872,0x361f3b64,0x3bf62e46,0x3872baa7,0xb78bbb0e
.long 0x3c000000,0x361fbb64,0xb9a8b9a8,0xbb64361f,0x361fbb64,0xba2fb913,0xbaa73872,0x34a53ba8
.long 0xb9a8b9a8,0xbaa73872,0x361f3b64,0x3bd9b23e,0xbb64361f,0x34a53ba8,0x3bd9b23e,0xae46bbf6
.long 0x3c00,0x3c00,0x3c00,0x3c00,0x3c000000,0x3bf6ae46,0x3bd9b23e,0x3ba8b4a5
.long 0xbc00,0xb23ebbd9,0xb61fbb64,0xb872baa7,0xbc008000,0xbba834a5,0xbaa73872,0xb9133a2f
.long 0x3c00,0x361f3b64,0x39a839a8,0x3b64361f,0x3c000000,0x3b0eb78b,0x3872baa7,0x2e46bbf6
.long 0xbc00,0xb872baa7,0xbb64b61f,0xbbd9323e,0xbc008000,0xba2f3913,0xb23e3bd9,0x378b3b0e
.long 0x3c00,0x39a839a8,0x3c000000,0x39a8b9a8,0x3c000000,0x3913ba2f,0xb23ebbd9,0xbb0eb78b
.long 0xbc00,0xbaa7b872,0xbb64361f,0xb23e3bd9,0xbc008000,0xb78b3b0e,0x38723aa7,0x3bf6ae46
.long 0x3c00,0x3b64361f,0x39a8b9a8,0xb61fbb64,0x3c000000,0x34a5bba8,0xbaa7b872,0xba2f3913
.long 0xbc00,0xbbd9b23e,0xb61f3b64,0x3aa73872,0xbc008000,0xae463bf6,0x3bd9323e,0x34a5bba8
.long 0x3c00,0x3c00,0x3c00,0x3c00,0x3b64b61f,0x3b0eb78b,0x3aa7b872,0x3a2fb913
.long 0xb9a8b9a8,0xbaa7b872,0xbb64b61f,0xbbd9b23e,0xb61f3b64,0xae463bf6,0x323e3bd9,0x378b3b0e
.long 0x3c000000,0x3b64b61f,0x39a8b9a8,0x361fbb64,0xb61fbb64,0xba2fb913,0xbbd9b23e,0xbba834a5
.long 0xb9a839a8,0xb23e3bd9,0x361f3b64,0x3aa73872,0x3b64361f,0x3ba8b4a5,0x3872baa7,0xae46bbf6
.long 0xbc00,0xb9a8b9a8,0xbc008000,0xb9a839a8,0xbb64361f,0xb4a53ba8,0x38723aa7,0x3bf62e46
.long 0x39a839a8,0x3bd9b23e,0x361fbb64,0xb872baa7,0x361fbb64,0xb913ba2f,0xbbd9323e,0xb4a53ba8
.long 0xbc008000,0xb61f3b64,0x39a839a8,0x3b64b61f,0x361f3b64,0x3bf6ae46,0x323ebbd9,0xbb0eb78b
.long 0x39a8b9a8,0xb872baa7,0xbb64361f,0x323e3bd9,0xbb64b61f,0xb78b3b0e,0x3aa73872,0x3913ba2f
.long 0x3c00,0x3c00,0x3c00,0x3c00,0x39a8b9a8,0x3913ba2f,0x3872baa7,0x378bbb0e
.long 0xbc008000,0xbbd9323e,0xbb64361f,0xbaa73872,0x39a839a8,0x3b0e378b,0x3bd9323e,0x3bf6ae46
.long 0xbc00,0xb61fbb64,0xb9a8b9a8,0xbb64b61f,0xb9a839a8,0xb4a53ba8,0x323e3bd9,0x39133a2f
.long 0x3c000000,0x3aa7b872,0x361fbb64,0xb23ebbd9,0xb9a8b9a8,0xbbf6ae46,0xbaa73872,0xb4a53ba8
.long 0x3c00,0x39a839a8,0x3c000000,0x39a8b9a8,0x39a8b9a8,0xae46bbf6,0xbaa7b872,0xbba834a5
.long 0xbc008000,0xb8723aa7,0x361f3b64,0x3bd9323e,0x39a839a8,0x3ba8b4a5,0x323ebbd9,0xba2fb913
.long 0xbc00,0xbb64b61f,0xb9a839a8,0x361f3b64,0xb9a839a8,0x378b3b0e,0x3bd9b23e,0x2e46bbf6
.long 0x3c000000,0x323ebbd9,0xbb64b61f,0xb8723aa7,0xb9a8b9a8,0xba2f3913,0x38723aa7,0x3b0eb78b
.long 0x3c00,0x3c00,0x3c00,0x3c00,0x361fbb64,0x34a5bba8,0x323ebbd9,0x2e46bbf6
.long 0xb9a839a8,0xb8723aa7,0xb61f3b64,0xb23e3bd9,0x3b64b61f,0x3a2fb913,0x3872baa7,0x34a5bba8
.long 0xbc008000,0xbb64361f,0xb9a839a8,0xb61f3b64,0x3b64361f,0x3bf6ae46,0x3aa7b872,0x378bbb0e
.long 0xb9a8b9a8,0xbbd9b23e,0xbb64361f,0xb8723aa7,0x361f3b64,0x3b0e378b,0x3bd9b23e,0x3913ba2f
.long 0xbc00,0xb9a8b9a8,0xbc008000,0xb9a839a8,0xb61f3b64,0x378b3b0e,0x3bd9323e,0x3a2fb913
.long 0x39a8b9a8,0xb23ebbd9,0xbb64b61f,0xbaa73872,0xbb64361f,0xae463bf6,0x3aa73872,0x3b0eb78b
.long 0x3c000000,0x361fbb64,0xb9a8b9a8,0xbb64361f,0xbb64b61f,0xb9133a2f,0x38723aa7,0x3ba8b4a5
.long 0x39a839a8,0x3aa7b872,0xb61fbb64,0xbbd9323e,0xb61fbb64,0xbba834a5,0x323e3bd9,0x3bf6ae46
.long 0x3c00,0x3c00,0x3c00,0x3c00,0xbc00,0xae46bbf6,0xb23ebbd9,0xb4a5bba8
.long 0x3c00,0x323e3bd9,0x361f3b64,0x38723aa7,0xbc00,0xb4a5bba8,0xb872baa7,0xba2fb913
.long 0x3c00,0x361f3b64,0x39a839a8,0x3b64361f,0xbc00,0xb78bbb0e,0xbaa7b872,0xbbf6ae46
.long 0x3c00,0x38723aa7,0x3b64361f,0x3bd9b23e,0xbc00,0xb913ba2f,0xbbd9b23e,0xbb0e378b
.long 0x3c00,0x39a839a8,0x3c000000,0x39a8b9a8,0xbc00,0xba2fb913,0xbbd9323e,0xb78b3b0e
.long 0x3c00,0x3aa73872,0x3b64b61f,0x323ebbd9,0xbc00,0xbb0eb78b,0xbaa73872,0x2e463bf6
.long 0x3c00,0x3b64361f,0x39a8b9a8,0xb61fbb64,0xbc00,0xbba8b4a5,0xb8723aa7,0x39133a2f
.long 0x3c00,0x3bd9323e,0x361fbb64,0xbaa7b872,0xbc00,0xbbf6ae46,0xb23e3bd9,0x3ba834a5
.long 0x3c00,0x3c00,0x3c00,0x3c00,0xb61fbb64,0xb78bbb0e,0xb872baa7,0xb913ba2f
.long 0x39a839a8,0x3aa73872,0x3b64361f,0x3bd9323e,0xbb64b61f,0xbbf6ae46,0xbbd9323e,0xbb0e378b
.long 0x3c000000,0x3b64b61f,0x39a8b9a8,0x361fbb64,0xbb64361f,0xb9133a2f,0xb23e3bd9,0x34a53ba8
.long 0x39a8b9a8,0x323ebbd9,0xb61fbb64,0xbaa7b872,0xb61f3b64,0x34a53ba8,0x3aa73872,0x3bf6ae46
.long 0xbc00,0xb9a8b9a8,0xbc008000,0xb9a839a8,0x361f3b64,0x3ba834a5,0x3aa7b872,0x2e46bbf6
.long 0xb9a8b9a8,0xbbd9323e,0xb61f3b64,0x38723aa7,0x3b64361f,0x3a2fb913,0xb23ebbd9,0xbba8b4a5
.long 0xbc008000,0xb61f3b64,0x39a839a8,0x3b64b61f,0x3b64b61f,0xae46bbf6,0xbbd9b23e,0xb78b3b0e
.long 0xb9a839a8,0x38723aa7,0x3b64b61f,0xb23ebbd9,0x361fbb64,0xbb0eb78b,0xb8723aa7,0x3a2f3913
.long 0x3c00,0x3c00,0x3c00,0x3c00,0xb9a8b9a8,0xba2fb913,0xbaa7b872,0xbb0eb78b
.long 0x3c000000,0x3bd9b23e,0x3b64b61f,0x3aa7b872,0xb9a839a8,0xb78b3b0e,0xb23e3bd9,0x2e463bf6
.long 0xbc00,0xb61fbb64,0xb9a8b9a8,0xbb64b61f,0x39a839a8,0x3ba834a5,0x3bd9b23e,0x3a2fb913
.long 0xbc008000,0xbaa73872,0xb61f3b64,0x323e3bd9,0x39a8b9a8,0x2e46bbf6,0xb872baa7,0xbba8b4a5
.long 0x3c00,0x39a839a8,0x3c000000,0x39a8b9a8,0xb9a8b9a8,0xbbf62e46,0xb8723aa7,0x34a53ba8
.long 0x3c000000,0x3872baa7,0xb61fbb64,0xbbd9b23e,0xb9a839a8,0x34a53ba8,0x3bd9323e,0x3913ba2f
.long 0xbc00,0xbb64b61f,0xb9a839a8,0x361f3b64,0x39a839a8,0x3b0eb78b,0xb23ebbd9,0xbbf6ae46
.long 0xbc008000,0xb23e3bd9,0x3b64361f,0x3872baa7,0x39a8b9a8,0xb913ba2f,0xbaa73872,0x378b3b0e
.long 0x3c00,0x3c00,0x3c00,0x3c00,0xbb64b61f,0xbba8b4a5,0xbbd9b23e,0xbbf6ae46
.long 0x39a8b9a8,0x3872baa7,0x361fbb64,0x323ebbd9,0x361f3b64,0x39133a2f,0x3aa73872,0x3ba834a5
.long 0xbc008000,0xbb64361f,0xb9a839a8,0xb61f3b64,0x361fbb64,0xae46bbf6,0xb872baa7,0xbb0eb78b
.long 0x39a839a8,0x3bd9323e,0x3b64b61f,0x3872baa7,0xbb64361f,0xb78b3b0e,0x323e3bd9,0x3a2f3913
.long 0xbc00,0xb9a8b9a8,0xbc008000,0xb9a839a8,0x3b64361f,0x3b0eb78b,0x323ebbd9,0xb913ba2f
.long 0xb9a839a8,0x323e3bd9,0x3b64361f,0x3aa7b872,0xb61fbb64,0xbbf6ae46,0xb8723aa7,0x378b3b0e
.long 0x3c000000,0x361fbb64,0xb9a8b9a8,0xbb64361f,0xb61f3b64,0x3a2f3913,0x3aa7b872,0xb4a5bba8
.long 0xb9a8b9a8,0xbaa73872,0x361f3b64,0x3bd9b23e,0x3b64b61f,0xb4a5bba8,0xbbd9323e,0x2e463bf6
.long 0x3c00,0x3c00,0x3c00,0x3c00,0xbc008000,0xbbf62e46,0xbbd9323e,0xbba834a5
.long 0xbc00,0xb23ebbd9,0xb61fbb64,0xb872baa7,0x3c000000,0x3ba8b4a5,0x3aa7b872,0x3913ba2f
.long 0x3c00,0x361f3b64,0x39a839a8,0x3b64361f,0xbc008000,0xbb0e378b,0xb8723aa7,0xae463bf6
.long 0xbc00,0xb872baa7,0xbb64b61f,0xbbd9323e,0x3c000000,0x3a2fb913,0x323ebbd9,0xb78bbb0e
.long 0x3c00,0x39a839a8,0x3c000000,0x39a8b9a8,0xbc008000,0xb9133a2f,0x323e3bd9,0x3b0e378b
.long 0xbc00,0xbaa7b872,0xbb64361f,0xb23e3bd9,0x3c000000,0x378bbb0e,0xb872baa7,0xbbf62e46
.long 0x3c00,0x3b64361f,0x39a8b9a8,0xb61fbb64,0xbc008000,0xb4a53ba8,0x3aa73872,0x3a2fb913
.long 0xbc00,0xbbd9b23e,0xb61f3b64,0x3aa73872,0x3c000000,0x2e46bbf6,0xbbd9b23e,0xb4a53ba8
.long 0x3c00,0x3c00,0x3c00,0x3c00,0xbb64361f,0xbb0e378b,0xbaa73872,0xba2f3913
.long 0xb9a8b9a8,0xbaa7b872,0xbb64b61f,0xbbd9b23e,0x361fbb64,0x2e46bbf6,0xb23ebbd9,0xb78bbb0e
.long 0x3c000000,0x3b64b61f,0x39a8b9a8,0x361fbb64,0x361f3b64,0x3a2f3913,0x3bd9323e,0x3ba8b4a5
.long 0xb9a839a8,0xb23e3bd9,0x361f3b64,0x3aa73872,0xbb64b61f,0xbba834a5,0xb8723aa7,0x2e463bf6
.long 0xbc00,0xb9a8b9a8,0xbc008000,0xb9a839a8,0x3b64b61f,0x34a5bba8,0xb872baa7,0xbbf6ae46
.long 0x39a839a8,0x3bd9b23e,0x361fbb64,0xb872baa7,0xb61f3b64,0x39133a2f,0x3bd9b23e,0x34a5bba8
.long 0xbc008000,0xb61f3b64,0x39a839a8,0x3b64b61f,0xb61fbb64,0xbbf62e46,0xb23e3bd9,0x3b0e378b
.long 0x39a8b9a8,0xb872baa7,0xbb64361f,0x323e3bd9,0x3b64361f,0x378bbb0e,0xbaa7b872,0xb9133a2f
.long 0x3c00,0x3c00,0x3c00,0x3c00,0xb9a839a8,0xb9133a2f,0xb8723aa7,0xb78b3b0e
.long 0xbc008000,0xbbd9323e,0xbb64361f,0xbaa73872,0xb9a8b9a8,0xbb0eb78b,0xbbd9b23e,0xbbf62e46
.long 0xbc00,0xb61fbb64,0xb9a8b9a8,0xbb64b61f,0x39a8b9a8,0x34a5bba8,0xb23ebbd9,0xb913ba2f
.long 0x3c000000,0x3aa7b872,0x361fbb64,0xb23ebbd9,0x39a839a8,0x3bf62e46,0x3aa7b872,0x34a5bba8
.long 0x3c00,0x39a839a8,0x3c000000,0x39a8b9a8,0xb9a839a8,0x2e463bf6,0x3aa73872,0x3ba8b4a5
.long 0xbc008000,0xb8723aa7,0x361f3b64,0x3bd9323e,0xb9a8b9a8,0xbba834a5,0xb23e3bd9,0x3a2f3913
.long 0xbc00,0xbb64b61f,0xb9a839a8,0x361f3b64,0x39a8b9a8,0xb78bbb0e,0xbbd9323e,0xae463bf6
.long 0x3c000000,0x323ebbd9,0xbb64b61f,0xb8723aa7,0x39a839a8,0x3a2fb913,0xb872baa7,0xbb0e378b
.long 0x3c00,0x3c00,0x3c00,0x3c00,0xb61f3b64,0xb4a53ba8,0xb23e3bd9,0xae463bf6
.long 0xb9a839a8,0xb8723aa7,0xb61f3b64,0xb23e3bd9,0xbb64361f,0xba2f3913,0xb8723aa7,0xb4a53ba8
.long 0xbc008000,0xbb64361f,0xb9a839a8,0xb61f3b64,0xbb64b61f,0xbbf62e46,0xbaa73872,0xb78b3b0e
.long 0xb9a8b9a8,0xbbd9b23e,0xbb64361f,0xb8723aa7,0xb61fbb64,0xbb0eb78b,0xbbd9323e,0xb9133a2f
.long 0xbc00,0xb9a8b9a8,0xbc008000,0xb9a839a8,0x361fbb64,0xb78bbb0e,0xbbd9b23e,0xba2f3913
.long 0x39a8b9a8,0xb23ebbd9,0xbb64b61f,0xbaa73872,0x3b64b61f,0x2e46bbf6,0xbaa7b872,0xbb0e378b
.long 0x3c000000,0x361fbb64,0xb9a8b9a8,0xbb64361f,0x3b64361f,0x3913ba2f,0xb872baa7,0xbba834a5
.long 0x39a839a8,0x3aa7b872,0xb61fbb64,0xbbd9323e,0x361f3b64,0x3ba8b4a5,0xb23ebbd9,0xbbf62e46
.long 0x3c00,0x3c000000,0xbc00,0xbc008000,0x3c00,0x3bf6ae46,0xb23ebbd9,0xbba834a5
.long 0x3c00,0x3bd9b23e,0xb61fbb64,0xbaa73872,0x3c00,0x3ba8b4a5,0xb872baa7,0xb9133a2f
.long 0x3c00,0x3b64b61f,0xb9a8b9a8,0xb61f3b64,0x3c00,0x3b0eb78b,0xbaa7b872,0xae463bf6
.long 0x3c00,0x3aa7b872,0xbb64b61f,0x323e3bd9,0x3c00,0x3a2fb913,0xbbd9b23e,0x378b3b0e
.long 0x3c00,0x39a8b9a8,0xbc008000,0x39a839a8,0x3c00,0x3913ba2f,0xbbd9323e,0x3b0e378b
.long 0x3c00,0x3872baa7,0xbb64361f,0x3bd9323e,0x3c00,0x378bbb0e,0xbaa73872,0x3bf6ae46
.long 0x3c00,0x361fbb64,0xb9a839a8,0x3b64b61f,0x3c00,0x34a5bba8,0xb8723aa7,0x3a2fb913
.long 0x3c00,0x323ebbd9,0xb61f3b64,0x3872baa7,0x3c00,0x2e46bbf6,0xb23e3bd9,0x34a5bba8
.long 0x3c00,0x3c000000,0xbc00,0xbc008000,0x361f3b64,0x3b0eb78b,0xb872baa7,0xba2f3913
.long 0x39a839a8,0x3872baa7,0xbb64b61f,0xb23e3bd9,0x3b64361f,0x2e46bbf6,0xbbd9323e,0x378b3b0e
.long 0x3c000000,0xb61fbb64,0xb9a839a8,0x3b64361f,0x3b64b61f,0xba2fb913,0xb23e3bd9,0x3ba8b4a5
.long 0x39a8b9a8,0xbbd9b23e,0x361f3b64,0x3872baa7,0x361fbb64,0xbba834a5,0x3aa73872,0xae46bbf6
.long 0xbc00,0xb9a839a8,0x3c000000,0xb9a8b9a8,0xb61fbb64,0xb4a53ba8,0x3aa7b872,0xbbf6ae46
.long 0xb9a8b9a8,0x323e3bd9,0x361fbb64,0xbaa73872,0xbb64b61f,0x39133a2f,0xb23ebbd9,0xb4a53ba8
.long 0xbc008000,0x3b64361f,0xb9a8b9a8,0x361f3b64,0xbb64361f,0x3bf6ae46,0xbbd9b23e,0x3b0e378b
.long 0xb9a839a8,0x3aa7b872,0xbb64361f,0x3bd9b23e,0xb61f3b64,0x378bbb0e,0xb8723aa7,0x3913ba2f
.long 0x3c00,0x3c000000,0xbc00,0xbc008000,0x39a839a8,0x3913ba2f,0xbaa7b872,0xb78b3b0e
.long 0x3c000000,0xb23ebbd9,0xbb64361f,0x38723aa7,0x39a8b9a8,0xbb0eb78b,0xb23e3bd9,0x3bf6ae46
.long 0xbc00,0xbb64361f,0x39a839a8,0x361fbb64,0xb9a8b9a8,0xb4a53ba8,0x3bd9b23e,0xb913ba2f
.long 0xbc008000,0x38723aa7,0x361fbb64,0xbbd9323e,0xb9a839a8,0x3bf62e46,0xb872baa7,0xb4a53ba8
.long 0x3c00,0x39a8b9a8,0xbc008000,0x39a839a8,0x39a839a8,0xae46bbf6,0xb8723aa7,0x3ba8b4a5
.long 0x3c000000,0xbaa7b872,0x361f3b64,0x323ebbd9,0x39a8b9a8,0xbba834a5,0x3bd9323e,0xba2fb913
.long 0xbc00,0xb61f3b64,0x39a8b9a8,0xbb64361f,0xb9a8b9a8,0x378b3b0e,0xb23ebbd9,0xae463bf6
.long 0xbc008000,0x3bd9323e,0xbb64b61f,0x3aa73872,0xb9a839a8,0x3a2fb913,0xbaa73872,0x3b0eb78b
.long 0x3c00,0x3c000000,0xbc00,0xbc008000,0x3b64361f,0x34a5bba8,0xbbd9b23e,0xae463bf6
.long 0x39a8b9a8,0xbaa7b872,0xb61f3b64,0x3bd9323e,0xb61fbb64,0xba2f3913,0x3aa73872,0x34a5bba8
.long 0xbc008000,0x361f3b64,0x39a8b9a8,0xbb64b61f,0xb61f3b64,0x3bf6ae46,0xb872baa7,0xb78b3b0e
.long 0x39a839a8,0x323ebbd9,0xbb64361f,0x3aa73872,0x3b64b61f,0xbb0eb78b,0x323e3bd9,0x3913ba2f
.long 0xbc00,0xb9a839a8,0x3c000000,0xb9a8b9a8,0xbb64b61f,0x378b3b0e,0x323ebbd9,0xba2f3913
.long 0xb9a839a8,0x3bd9b23e,0xbb64b61f,0x38723aa7,0x361f3b64,0x2e46bbf6,0xb8723aa7,0x3b0eb78b
.long 0x3c000000,0xbb64b61f,0x39a839a8,0xb61fbb64,0x361fbb64,0xb9133a2f,0x3aa7b872,0xbba834a5
.long 0xb9a8b9a8,0x38723aa7,0xb61fbb64,0x323e3bd9,0xbb64361f,0x3ba8b4a5,0xbbd9323e,0x3bf6ae46
.long 0x3c00,0x3c000000,0xbc00,0xbc008000,0x3c000000,0xae46bbf6,0xbbd9323e,0x34a53ba8
.long 0xbc00,0xbbd9323e,0x361f3b64,0x3aa7b872,0xbc008000,0x34a53ba8,0x3aa7b872,0xba2fb913
.long 0x3c00,0x3b64b61f,0xb9a8b9a8,0xb61f3b64,0x3c000000,0xb78bbb0e,0xb8723aa7,0x3bf62e46
.long 0xbc00,0xbaa73872,0x3b64361f,0xb23ebbd9,0xbc008000,0x39133a2f,0x323ebbd9,0xbb0e378b
.long 0x3c00,0x39a8b9a8,0xbc008000,0x39a839a8,0x3c000000,0xba2fb913,0x323e3bd9,0x378bbb0e
.long 0xbc00,0xb8723aa7,0x3b64b61f,0xbbd9b23e,0xbc008000,0x3b0e378b,0xb872baa7,0x2e463bf6
.long 0x3c00,0x361fbb64,0xb9a839a8,0x3b64b61f,0x3c000000,0xbba8b4a5,0x3aa73872,0xb913ba2f
.long 0xbc00,0xb23e3bd9,0x361fbb64,0xb8723aa7,0xbc008000,0x3bf62e46,0xbbd9b23e,0x3ba834a5
.long 0x3c00,0x3c000000,0xbc00,0xbc008000,0x3b64b61f,0xb78bbb0e,0xbaa73872,0x39133a2f
.long 0xb9a8b9a8,0xb8723aa7,0x3b64361f,0x323ebbd9,0xb61f3b64,0x3bf62e46,0xb23ebbd9,0xbb0e378b
.long 0x3c000000,0xb61fbb64,0xb9a839a8,0x3b64361f,0xb61fbb64,0xb9133a2f,0x3bd9323e,0xb4a5bba8
.long 0xb9a839a8,0x3bd9323e,0xb61fbb64,0xb8723aa7,0x3b64361f,0xb4a5bba8,0xb8723aa7,0x3bf6ae46
.long 0xbc00,0xb9a839a8,0x3c000000,0xb9a8b9a8,0xbb64361f,0x3ba834a5,0xb872baa7,0xae463bf6
.long 0x39a839a8,0xb23ebbd9,0xb61f3b64,0x3aa7b872,0x361fbb64,0xba2f3913,0x3bd9b23e,0xbba8b4a5
.long 0xbc008000,0x3b64361f,0xb9a8b9a8,0x361f3b64,0x361f3b64,0xae46bbf6,0xb23e3bd9,0x378bbb0e
.long 0x39a8b9a8,0xbaa73872,0x3b64b61f,0xbbd9323e,0xbb64b61f,0x3b0e378b,0xbaa7b872,0x3a2f3913
.long 0x3c00,0x3c000000,0xbc00,0xbc008000,0x39a8b9a8,0xba2fb913,0xb8723aa7,0x3b0e378b
.long 0xbc008000,0x323e3bd9,0x3b64b61f,0xb872baa7,0x39a839a8,0x378bbb0e,0xbbd9b23e,0x2e463bf6
.long 0xbc00,0xbb64361f,0x39a839a8,0x361fbb64,0xb9a839a8,0x3ba834a5,0xb23ebbd9,0xba2f3913
.long 0x3c000000,0xb872baa7,0xb61f3b64,0x3bd9b23e,0xb9a8b9a8,0xae463bf6,0x3aa7b872,0xbba8b4a5
.long 0x3c00,0x39a8b9a8,0xbc008000,0x39a839a8,0x39a8b9a8,0xbbf62e46,0x3aa73872,0xb4a5bba8
.long 0xbc008000,0x3aa73872,0xb61fbb64,0xb23e3bd9,0x39a839a8,0xb4a5bba8,0xb23e3bd9,0x3913ba2f
.long 0xbc00,0xb61f3b64,0x39a8b9a8,0xbb64361f,0xb9a839a8,0x3b0eb78b,0xbbd9323e,0x3bf62e46
.long 0x3c000000,0xbbd9b23e,0x3b64361f,0xbaa7b872,0xb9a8b9a8,0x39133a2f,0xb872baa7,0x378b3b0e
.long 0x3c00,0x3c000000,0xbc00,0xbc008000,0x361fbb64,0xbba8b4a5,0xb23e3bd9,0x3bf62e46
.long 0xb9a839a8,0x3aa73872,0x361fbb64,0xbbd9b23e,0x3b64b61f,0xb913ba2f,0xb8723aa7,0x3ba834a5
.long 0xbc008000,0x361f3b64,0x39a8b9a8,0xbb64b61f,0x3b64361f,0xae46bbf6,0xbaa73872,0x3b0e378b
.long 0xb9a8b9a8,0xb23e3bd9,0x3b64b61f,0xbaa7b872,0x361f3b64,0x378bbb0e,0xbbd9323e,0x3a2f3913
.long 0xbc00,0xb9a839a8,0x3c000000,0xb9a8b9a8,0xb61f3b64,0x3b0eb78b,0xbbd9b23e,0x39133a2f
.long 0x39a8b9a8,0xbbd9323e,0x3b64361f,0xb872baa7,0xbb64361f,0x3bf62e46,0xbaa7b872,0x378b3b0e
.long 0x3c000000,0xbb64b61f,0x39a839a8,0xb61fbb64,0xbb64b61f,0x3a2f3913,0xb872baa7,0x34a53ba8
.long 0x39a839a8,0xb872baa7,0x361f3b64,0xb23ebbd9,0xb61fbb64,0x34a53ba8,0xb23ebbd9,0x2e463bf6
.long 0x3c00,0x3c000000,0xbc00,0xbc008000,0xbc00,0xbbf62e46,0x323e3bd9,0x3ba8b4a5
.long 0x3c00,0x3bd9b23e,0xb61fbb64,0xbaa73872,0xbc00,0xbba834a5,0x38723aa7,0x3913ba2f
.long 0x3c00,0x3b64b61f,0xb9a8b9a8,0xb61f3b64,0xbc00,0xbb0e378b,0x3aa73872,0x2e46bbf6
.long 0x3c00,0x3aa7b872,0xbb64b61f,0x323e3bd9,0xbc00,0xba2f3913,0x3bd9323e,0xb78bbb0e
.long 0x3c00,0x39a8b9a8,0xbc008000,0x39a839a8,0xbc00,0xb9133a2f,0x3bd9b23e,0xbb0eb78b
.long 0x3c00,0x3872baa7,0xbb64361f,0x3bd9323e,0xbc00,0xb78b3b0e,0x3aa7b872,0xbbf62e46
.long 0x3c00,0x361fbb64,0xb9a839a8,0x3b64b61f,0xbc00,0xb4a53ba8,0x3872baa7,0xba2f3913
.long 0x3c00,0x323ebbd9,0xb61f3b64,0x3872baa7,0xbc00,0xae463bf6,0x323ebbd9,0xb4a53ba8
.long 0x3c00,0x3c000000,0xbc00,0xbc008000,0xb61fbb64,0xbb0e378b,0x38723aa7,0x3a2fb913
.long 0x39a839a8,0x3872baa7,0xbb64b61f,0xb23e3bd9,0xbb64b61f,0xae463bf6,0x3bd9b23e,0xb78bbb0e
.long 0x3c000000,0xb61fbb64,0xb9a839a8,0x3b64361f,0xbb64361f,0x3a2f3913,0x323ebbd9,0xbba834a5
.long 0x39a8b9a8,0xbbd9b23e,0x361f3b64,0x3872baa7,0xb61f3b64,0x3ba8b4a5,0xbaa7b872,0x2e463bf6
.long 0xbc00,0xb9a839a8,0x3c000000,0xb9a8b9a8,0x361f3b64,0x34a5bba8,0xbaa73872,0x3bf62e46
.long 0xb9a8b9a8,0x323e3bd9,0x361fbb64,0xbaa73872,0x3b64361f,0xb913ba2f,0x323e3bd9,0x34a5bba8
.long 0xbc008000,0x3b64361f,0xb9a8b9a8,0x361f3b64,0x3b64b61f,0xbbf62e46,0x3bd9323e,0xbb0eb78b
.long 0xb9a839a8,0x3aa7b872,0xbb64361f,0x3bd9b23e,0x361fbb64,0xb78b3b0e,0x3872baa7,0xb9133a2f
.long 0x3c00,0x3c000000,0xbc00,0xbc008000,0xb9a8b9a8,0xb9133a2f,0x3aa73872,0x378bbb0e
.long 0x3c000000,0xb23ebbd9,0xbb64361f,0x38723aa7,0xb9a839a8,0x3b0e378b,0x323ebbd9,0xbbf62e46
.long 0xbc00,0xbb64361f,0x39a839a8,0x361fbb64,0x39a839a8,0x34a5bba8,0xbbd9323e,0x39133a2f
.long 0xbc008000,0x38723aa7,0x361fbb64,0xbbd9323e,0x39a8b9a8,0xbbf6ae46,0x38723aa7,0x34a5bba8
.long 0x3c00,0x39a8b9a8,0xbc008000,0x39a839a8,0xb9a8b9a8,0x2e463bf6,0x3872baa7,0xbba834a5
.long 0x3c000000,0xbaa7b872,0x361f3b64,0x323ebbd9,0xb9a839a8,0x3ba8b4a5,0xbbd9b23e,0x3a2f3913
.long 0xbc00,0xb61f3b64,0x39a8b9a8,0xbb64361f,0x39a839a8,0xb78bbb0e,0x323e3bd9,0x2e46bbf6
.long 0xbc008000,0x3bd9323e,0xbb64b61f,0x3aa73872,0x39a8b9a8,0xba2f3913,0x3aa7b872,0xbb0e378b
.long 0x3c00,0x3c000000,0xbc00,0xbc008000,0xbb64b61f,0xb4a53ba8,0x3bd9323e,0x2e46bbf6
.long 0x39a8b9a8,0xbaa7b872,0xb61f3b64,0x3bd9323e,0x361f3b64,0x3a2fb913,0xbaa7b872,0xb4a53ba8
.long 0xbc008000,0x361f3b64,0x39a8b9a8,0xbb64b61f,0x361fbb64,0xbbf62e46,0x38723aa7,0x378bbb0e
.long 0x39a839a8,0x323ebbd9,0xbb64361f,0x3aa73872,0xbb64361f,0x3b0e378b,0xb23ebbd9,0xb9133a2f
.long 0xbc00,0xb9a839a8,0x3c000000,0xb9a8b9a8,0x3b64361f,0xb78bbb0e,0xb23e3bd9,0x3a2fb913
.long 0xb9a839a8,0x3bd9b23e,0xbb64b61f,0x38723aa7,0xb61fbb64,0xae463bf6,0x3872baa7,0xbb0e378b
.long 0x3c000000,0xbb64b61f,0x39a839a8,0xb61fbb64,0xb61f3b64,0x3913ba2f,0xbaa73872,0x3ba8b4a5
.long 0xb9a8b9a8,0x38723aa7,0xb61fbb64,0x323e3bd9,0x3b64b61f,0xbba834a5,0x3bd9b23e,0xbbf62e46
.long 0x3c00,0x3c000000,0xbc00,0xbc008000,0xbc008000,0x2e463bf6,0x3bd9b23e,0xb4a5bba8
.long 0xbc00,0xbbd9323e,0x361f3b64,0x3aa7b872,0x3c000000,0xb4a5bba8,0xbaa73872,0x3a2f3913
.long 0x3c00,0x3b64b61f,0xb9a8b9a8,0xb61f3b64,0xbc008000,0x378b3b0e,0x3872baa7,0xbbf6ae46
.long 0xbc00,0xbaa73872,0x3b64361f,0xb23ebbd9,0x3c000000,0xb913ba2f,0xb23e3bd9,0x3b0eb78b
.long 0x3c00,0x39a8b9a8,0xbc008000,0x39a839a8,0xbc008000,0x3a2f3913,0xb23ebbd9,0xb78b3b0e
.long 0xbc00,0xb8723aa7,0x3b64b61f,0xbbd9b23e,0x3c000000,0xbb0eb78b,0x38723aa7,0xae46bbf6
.long 0x3c00,0x361fbb64,0xb9a839a8,0x3b64b61f,0xbc008000,0x3ba834a5,0xbaa7b872,0x39133a2f
.long 0xbc00,0xb23e3bd9,0x361fbb64,0xb8723aa7,0x3c000000,0xbbf6ae46,0x3bd9323e,0xbba8b4a5
.long 0x3c00,0x3c000000,0xbc00,0xbc008000,0xbb64361f,0x378b3b0e,0x3aa7b872,0xb913ba2f
.long 0xb9a8b9a8,0xb8723aa7,0x3b64361f,0x323ebbd9,0x361fbb64,0xbbf6ae46,0x323e3bd9,0x3b0eb78b
.long 0x3c000000,0xb61fbb64,0xb9a839a8,0x3b64361f,0x361f3b64,0x3913ba2f,0xbbd9b23e,0x34a53ba8
.long 0xb9a839a8,0x3bd9323e,0xb61fbb64,0xb8723aa7,0xbb64b61f,0x34a53ba8,0x3872baa7,0xbbf62e46
.long 0xbc00,0xb9a839a8,0x3c000000,0xb9a8b9a8,0x3b64b61f,0xbba8b4a5,0x38723aa7,0x2e46bbf6
.long 0x39a839a8,0xb23ebbd9,0xb61f3b64,0x3aa7b872,0xb61f3b64,0x3a2fb913,0xbbd9323e,0x3ba834a5
.long 0xbc008000,0x3b64361f,0xb9a8b9a8,0x361f3b64,0xb61fbb64,0x2e463bf6,0x323ebbd9,0xb78b3b0e
.long 0x39a8b9a8,0xbaa73872,0x3b64b61f,0xbbd9323e,0x3b64361f,0xbb0eb78b,0x3aa73872,0xba2fb913
.long 0x3c00,0x3c000000,0xbc00,0xbc008000,0xb9a839a8,0x3a2f3913,0x3872baa7,0xbb0eb78b
.long 0xbc008000,0x323e3bd9,0x3b64b61f,0xb872baa7,0xb9a8b9a8,0xb78b3b0e,0x3bd9323e,0xae46bbf6
.long 0xbc00,0xbb64361f,0x39a839a8,0x361fbb64,0x39a8b9a8,0xbba8b4a5,0x323e3bd9,0x3a2fb913
.long 0x3c000000,0xb872baa7,0xb61f3b64,0x3bd9b23e,0x39a839a8,0x2e46bbf6,0xbaa73872,0x3ba834a5
.long 0x3c00,0x39a8b9a8,0xbc008000,0x39a839a8,0xb9a839a8,0x3bf6ae46,0xbaa7b872,0x34a53ba8
.long 0xbc008000,0x3aa73872,0xb61fbb64,0xb23e3bd9,0xb9a8b9a8,0x34a53ba8,0x323ebbd9,0xb9133a2f
.long 0xbc00,0xb61f3b64,0x39a8b9a8,0xbb64361f,0x39a8b9a8,0xbb0e378b,0x3bd9b23e,0xbbf6ae46
.long 0x3c000000,0xbbd9b23e,0x3b64361f,0xbaa7b872,0x39a839a8,0xb913ba2f,0x38723aa7,0xb78bbb0e
.long 0x3c00,0x3c000000,0xbc00,0xbc008000,0xb61f3b64,0x3ba834a5,0x323ebbd9,0xbbf6ae46
.long 0xb9a839a8,0x3aa73872,0x361fbb64,0xbbd9b23e,0xbb64361f,0x39133a2f,0x3872baa7,0xbba8b4a5
.long 0xbc008000,0x361f3b64,0x39a8b9a8,0xbb64b61f,0xbb64b61f,0x2e463bf6,0x3aa7b872,0xbb0eb78b
.long 0xb9a8b9a8,0xb23e3bd9,0x3b64b61f,0xbaa7b872,0xb61fbb64,0xb78b3b0e,0x3bd9b23e,0xba2fb913
.long 0xbc00,0xb9a839a8,0x3c000000,0xb9a8b9a8,0x361fbb64,0xbb0e378b,0x3bd9323e,0xb913ba2f
.long 0x39a8b9a8,0xbbd9323e,0x3b64361f,0xb872baa7,0x3b64b61f,0xbbf6ae46,0x3aa73872,0xb78bbb0e
.long 0x3c000000,0xbb64b61f,0x39a839a8,0xb61fbb64,0x3b64361f,0xba2fb913,0x38723aa7,0xb4a5bba8
.long 0x39a839a8,0xb872baa7,0x361f3b64,0xb23ebbd9,0x361f3b64,0xb4a5bba8,0x323e3bd9,0xae46bbf6
.long 0x3c00,0xbc00,0x3c00,0xbc00,0x3c00,0xae46bbf6,0x323e3bd9,0xb4a5bba8
.long 0x3c00,0xb23ebbd9,0x361f3b64,0xb872baa7,0x3c00,0xb4a5bba8,0x38723aa7,0xba2fb913
.long 0x3c00,0xb61fbb64,0x39a839a8,0xbb64b61f,0x3c00,0xb78bbb0e,0x3aa73872,0xbbf6ae46
.long 0x3c00,0xb872baa7,0x3b64361f,0xbbd9323e,0x3c00,0xb913ba2f,0x3bd9323e,0xbb0e378b
.long 0x3c00,0xb9a8b9a8,0x3c000000,0xb9a839a8,0x3c00,0xba2fb913,0x3bd9b23e,0xb78b3b0e
.long 0x3c00,0xbaa7b872,0x3b64b61f,0xb23e3bd9,0x3c00,0xbb0eb78b,0x3aa7b872,0x2e463bf6
.long 0x3c00,0xbb64b61f,0x39a8b9a8,0x361f3b64,0x3c00,0xbba8b4a5,0x3872baa7,0x39133a2f
.long 0x3c00,0xbbd9b23e,0x361fbb64,0x3aa73872,0x3c00,0xbbf6ae46,0x323ebbd9,0x3ba834a5
.long 0x3c00,0xbc00,0x3c00,0xbc00,0x361f3b64,0xb78bbb0e,0x38723aa7,0xb913ba2f
.long 0x39a839a8,0xbaa7b872,0x3b64361f,0xbbd9b23e,0x3b64361f,0xbbf6ae46,0x3bd9b23e,0xbb0e378b
.long 0x3c000000,0xbb64361f,0x39a8b9a8,0xb61f3b64,0x3b64b61f,0xb9133a2f,0x323ebbd9,0x34a53ba8
.long 0x39a8b9a8,0xb23e3bd9,0xb61fbb64,0x3aa73872,0x361fbb64,0x34a53ba8,0xbaa7b872,0x3bf6ae46
.long 0xbc00,0x39a839a8,0xbc008000,0x39a8b9a8,0xb61fbb64,0x3ba834a5,0xbaa73872,0x2e46bbf6
.long 0xb9a8b9a8,0x3bd9b23e,0xb61f3b64,0xb872baa7,0xbb64b61f,0x3a2fb913,0x323e3bd9,0xbba8b4a5
.long 0xbc008000,0x361fbb64,0x39a839a8,0xbb64361f,0xbb64361f,0xae46bbf6,0x3bd9323e,0xb78b3b0e
.long 0xb9a839a8,0xb872baa7,0x3b64b61f,0x323e3bd9,0xb61f3b64,0xbb0eb78b,0x3872baa7,0x3a2f3913
.long 0x3c00,0xbc00,0x3c00,0xbc00,0x39a839a8,0xba2fb913,0x3aa73872,0xbb0eb78b
.long 0x3c000000,0xbbd9323e,0x3b64b61f,0xbaa73872,0x39a8b9a8,0xb78b3b0e,0x323ebbd9,0x2e463bf6
.long 0xbc00,0x361f3b64,0xb9a8b9a8,0x3b64361f,0xb9a8b9a8,0x3ba834a5,0xbbd9323e,0x3a2fb913
.long 0xbc008000,0x3aa7b872,0xb61f3b64,0xb23ebbd9,0xb9a839a8,0x2e46bbf6,0x38723aa7,0xbba8b4a5
.long 0x3c00,0xb9a8b9a8,0x3c000000,0xb9a839a8,0x39a839a8,0xbbf62e46,0x3872baa7,0x34a53ba8
.long 0x3c000000,0xb8723aa7,0xb61fbb64,0x3bd9323e,0x39a8b9a8,0x34a53ba8,0xbbd9b23e,0x3913ba2f
.long 0xbc00,0x3b64361f,0xb9a839a8,0xb61fbb64,0xb9a8b9a8,0x3b0eb78b,0x323e3bd9,0xbbf6ae46
.long 0xbc008000,0x323ebbd9,0x3b64361f,0xb8723aa7,0xb9a839a8,0xb913ba2f,0x3aa7b872,0x378b3b0e
.long 0x3c00,0xbc00,0x3c00,0xbc00,0x3b64361f,0xbba8b4a5,0x3bd9323e,0xbbf6ae46
.long 0x39a8b9a8,0xb8723aa7,0x361fbb64,0xb23e3bd9,0xb61fbb64,0x39133a2f,0xbaa7b872,0x3ba834a5
.long 0xbc008000,0x3b64b61f,0xb9a839a8,0x361fbb64,0xb61f3b64,0xae46bbf6,0x38723aa7,0xbb0eb78b
.long 0x39a839a8,0xbbd9b23e,0x3b64b61f,0xb8723aa7,0x3b64b61f,0xb78b3b0e,0xb23ebbd9,0x3a2f3913
.long 0xbc00,0x39a839a8,0xbc008000,0x39a8b9a8,0xbb64b61f,0x3b0eb78b,0xb23e3bd9,0xb913ba2f
.long 0xb9a839a8,0xb23ebbd9,0x3b64361f,0xbaa73872,0x361f3b64,0xbbf6ae46,0x3872baa7,0x378b3b0e
.long 0x3c000000,0xb61f3b64,0xb9a8b9a8,0x3b64b61f,0x361fbb64,0x3a2f3913,0xbaa73872,0xb4a5bba8
.long 0xb9a8b9a8,0x3aa7b872,0x361f3b64,0xbbd9323e,0xbb64361f,0xb4a5bba8,0x3bd9b23e,0x2e463bf6
.long 0x3c00,0xbc00,0x3c00,0xbc00,0x3c000000,0xbbf62e46,0x3bd9b23e,0xbba834a5
.long 0xbc00,0x323e3bd9,0xb61fbb64,0x38723aa7,0xbc008000,0x3ba8b4a5,0xbaa73872,0x3913ba2f
.long 0x3c00,0xb61fbb64,0x39a839a8,0xbb64b61f,0x3c000000,0xbb0e378b,0x3872baa7,0xae463bf6
.long 0xbc00,0x38723aa7,0xbb64b61f,0x3bd9b23e,0xbc008000,0x3a2fb913,0xb23e3bd9,0xb78bbb0e
.long 0x3c00,0xb9a8b9a8,0x3c000000,0xb9a839a8,0x3c000000,0xb9133a2f,0xb23ebbd9,0x3b0e378b
.long 0xbc00,0x3aa73872,0xbb64361f,0x323ebbd9,0xbc008000,0x378bbb0e,0x38723aa7,0xbbf62e46
.long 0x3c00,0xbb64b61f,0x39a8b9a8,0x361f3b64,0x3c000000,0xb4a53ba8,0xbaa7b872,0x3a2fb913
.long 0xbc00,0x3bd9323e,0xb61f3b64,0xbaa7b872,0xbc008000,0x2e46bbf6,0x3bd9323e,0xb4a53ba8
.long 0x3c00,0xbc00,0x3c00,0xbc00,0x3b64b61f,0xbb0e378b,0x3aa7b872,0xba2f3913
.long 0xb9a8b9a8,0x3aa73872,0xbb64b61f,0x3bd9323e,0xb61f3b64,0x2e46bbf6,0x323e3bd9,0xb78bbb0e
.long 0x3c000000,0xbb64361f,0x39a8b9a8,0xb61f3b64,0xb61fbb64,0x3a2f3913,0xbbd9b23e,0x3ba8b4a5
.long 0xb9a839a8,0x323ebbd9,0x361f3b64,0xbaa7b872,0x3b64361f,0xbba834a5,0x3872baa7,0x2e463bf6
.long 0xbc00,0x39a839a8,0xbc008000,0x39a8b9a8,0xbb64361f,0x34a5bba8,0x38723aa7,0xbbf6ae46
.long 0x39a839a8,0xbbd9323e,0x361fbb64,0x38723aa7,0x361fbb64,0x39133a2f,0xbbd9323e,0x34a5bba8
.long 0xbc008000,0x361fbb64,0x39a839a8,0xbb64361f,0x361f3b64,0xbbf62e46,0x323ebbd9,0x3b0e378b
.long 0x39a8b9a8,0x38723aa7,0xbb64361f,0xb23ebbd9,0xbb64b61f,0x378bbb0e,0x3aa73872,0xb9133a2f
.long 0x3c00,0xbc00,0x3c00,0xbc00,0x39a8b9a8,0xb9133a2f,0x3872baa7,0xb78b3b0e
.long 0xbc008000,0x3bd9b23e,0xbb64361f,0x3aa7b872,0x39a839a8,0xbb0eb78b,0x3bd9323e,0xbbf62e46
.long 0xbc00,0x361f3b64,0xb9a8b9a8,0x3b64361f,0xb9a839a8,0x34a5bba8,0x323e3bd9,0xb913ba2f
.long 0x3c000000,0xbaa73872,0x361fbb64,0x323e3bd9,0xb9a8b9a8,0x3bf62e46,0xbaa73872,0x34a5bba8
.long 0x3c00,0xb9a8b9a8,0x3c000000,0xb9a839a8,0x39a8b9a8,0x2e463bf6,0xbaa7b872,0x3ba8b4a5
.long 0xbc008000,0x3872baa7,0x361f3b64,0xbbd9b23e,0x39a839a8,0xbba834a5,0x323ebbd9,0x3a2f3913
.long 0xbc00,0x3b64361f,0xb9a839a8,0xb61fbb64,0xb9a839a8,0xb78bbb0e,0x3bd9b23e,0xae463bf6
.long 0x3c000000,0xb23e3bd9,0xbb64b61f,0x3872baa7,0xb9a8b9a8,0x3a2fb913,0x38723aa7,0xbb0e378b
.long 0x3c00,0xbc00,0x3c00,0xbc00,0x361fbb64,0xb4a53ba8,0x323ebbd9,0xae463bf6
.long 0xb9a839a8,0x3872baa7,0xb61f3b64,0x323ebbd9,0x3b64b61f,0xba2f3913,0x3872baa7,0xb4a53ba8
.long 0xbc008000,0x3b64b61f,0xb9a839a8,0x361fbb64,0x3b64361f,0xbbf62e46,0x3aa7b872,0xb78b3b0e
.long 0xb9a8b9a8,0x3bd9323e,0xbb64361f,0x3872baa7,0x361f3b64,0xbb0eb78b,0x3bd9b23e,0xb9133a2f
.long 0xbc00,0x39a839a8,0xbc008000,0x39a8b9a8,0xb61f3b64,0xb78bbb0e,0x3bd9323e,0xba2f3913
.long 0x39a8b9a8,0x323e3bd9,0xbb64b61f,0x3aa7b872,0xbb64361f,0x2e46bbf6,0x3aa73872,0xbb0e378b
.long 0x3c000000,0xb61f3b64,0xb9a8b9a8,0x3b64b61f,0xbb64b61f,0x3913ba2f,0x38723aa7,0xbba834a5
.long 0x39a839a8,0xbaa73872,0xb61fbb64,0x3bd9b23e,0xb61fbb64,0x3ba8b4a5,0x323e3bd9,0xbbf62e46
.long 0x3c00,0xbc00,0x3c00,0xbc00,0xbc00,0x2e463bf6,0xb23ebbd9,0x34a53ba8
.long 0x3c00,0xb23ebbd9,0x361f3b64,0xb872baa7,0xbc00,0x34a53ba8,0xb872baa7,0x3a2f3913
.long 0x3c00,0xb61fbb64,0x39a839a8,0xbb64b61f,0xbc00,0x378b3b0e,0xbaa7b872,0x3bf62e46
.long 0x3c00,0xb872baa7,0x3b64361f,0xbbd9323e,0xbc00,0x39133a2f,0xbbd9b23e,0x3b0eb78b
.long 0x3c00,0xb9a8b9a8,0x3c000000,0xb9a839a8,0xbc00,0x3a2f3913,0xbbd9323e,0x378bbb0e
.long 0x3c00,0xbaa7b872,0x3b64b61f,0xb23e3bd9,0xbc00,0x3b0e378b,0xbaa73872,0xae46bbf6
.long 0x3c00,0xbb64b61f,0x39a8b9a8,0x361f3b64,0xbc00,0x3ba834a5,0xb8723aa7,0xb913ba2f
.long 0x3c00,0xbbd9b23e,0x361fbb64,0x3aa73872,0xbc00,0x3bf62e46,0xb23e3bd9,0xbba8b4a5
.long 0x3c00,0xbc00,0x3c00,0xbc00,0xb61fbb64,0x378b3b0e,0xb872baa7,0x39133a2f
.long 0x39a839a8,0xbaa7b872,0x3b64361f,0xbbd9b23e,0xbb64b61f,0x3bf62e46,0xbbd9323e,0x3b0eb78b
.long 0x3c000000,0xbb64361f,0x39a8b9a8,0xb61f3b64,0xbb64361f,0x3913ba2f,0xb23e3bd9,0xb4a5bba8
.long 0x39a8b9a8,0xb23e3bd9,0xb61fbb64,0x3aa73872,0xb61f3b64,0xb4a5bba8,0x3aa73872,0xbbf62e46
.long 0xbc00,0x39a839a8,0xbc008000,0x39a8b9a8,0x361f3b64,0xbba8b4a5,0x3aa7b872,0xae463bf6
.long 0xb9a8b9a8,0x3bd9b23e,0xb61f3b64,0xb872baa7,0x3b64361f,0xba2f3913,0xb23ebbd9,0x3ba834a5
.long 0xbc008000,0x361fbb64,0x39a839a8,0xbb64361f,0x3b64b61f,0x2e463bf6,0xbbd9b23e,0x378bbb0e
.long 0xb9a839a8,0xb872baa7,0x3b64b61f,0x323e3bd9,0x361fbb64,0x3b0e378b,0xb8723aa7,0xba2fb913
.long 0x3c00,0xbc00,0x3c00,0xbc00,0xb9a8b9a8,0x3a2f3913,0xbaa7b872,0x3b0e378b
.long 0x3c000000,0xbbd9323e,0x3b64b61f,0xbaa73872,0xb9a839a8,0x378bbb0e,0xb23e3bd9,0xae46bbf6
.long 0xbc00,0x361f3b64,0xb9a8b9a8,0x3b64361f,0x39a839a8,0xbba8b4a5,0x3bd9b23e,0xba2f3913
.long 0xbc008000,0x3aa7b872,0xb61f3b64,0xb23ebbd9,0x39a8b9a8,0xae463bf6,0xb872baa7,0x3ba834a5
.long 0x3c00,0xb9a8b9a8,0x3c000000,0xb9a839a8,0xb9a8b9a8,0x3bf6ae46,0xb8723aa7,0xb4a5bba8
.long 0x3c000000,0xb8723aa7,0xb61fbb64,0x3bd9323e,0xb9a839a8,0xb4a5bba8,0x3bd9323e,0xb9133a2f
.long 0xbc00,0x3b64361f,0xb9a839a8,0xb61fbb64,0x39a839a8,0xbb0e378b,0xb23ebbd9,0x3bf62e46
.long 0xbc008000,0x323ebbd9,0x3b64361f,0xb8723aa7,0x39a8b9a8,0x39133a2f,0xbaa73872,0xb78bbb0e
.long 0x3c00,0xbc00,0x3c00,0xbc00,0xbb64b61f,0x3ba834a5,0xbbd9b23e,0x3bf62e46
.long 0x39a8b9a8,0xb8723aa7,0x361fbb64,0xb23e3bd9,0x361f3b64,0xb913ba2f,0x3aa73872,0xbba8b4a5
.long 0xbc008000,0x3b64b61f,0xb9a839a8,0x361fbb64,0x361fbb64,0x2e463bf6,0xb872baa7,0x3b0e378b
.long 0x39a839a8,0xbbd9b23e,0x3b64b61f,0xb8723aa7,0xbb64361f,0x378bbb0e,0x323e3bd9,0xba2fb913
.long 0xbc00,0x39a839a8,0xbc008000,0x39a8b9a8,0x3b64361f,0xbb0e378b,0x323ebbd9,0x39133a2f
.long 0xb9a839a8,0xb23ebbd9,0x3b64361f,0xbaa73872,0xb61fbb64,0x3bf62e46,0xb8723aa7,0xb78bbb0e
.long 0x3c000000,0xb61f3b64,0xb9a8b9a8,0x3b64b61f,0xb61f3b64,0xba2fb913,0x3aa7b872,0x34a53ba8
.long 0xb9a8b9a8,0x3aa7b872,0x361f3b64,0xbbd9323e,0x3b64b61f,0x34a53ba8,0xbbd9323e,0xae46bbf6
.long 0x3c00,0xbc00,0x3c00,0xbc00,0xbc008000,0x3bf6ae46,0xbbd9323e,0x3ba8b4a5
.long 0xbc00,0x323e3bd9,0xb61fbb64,0x38723aa7,0x3c000000,0xbba834a5,0x3aa7b872,0xb9133a2f
.long 0x3c00,0xb61fbb64,0x39a839a8,0xbb64b61f,0xbc008000,0x3b0eb78b,0xb8723aa7,0x2e46bbf6
.long 0xbc00,0x38723aa7,0xbb64b61f,0x3bd9b23e,0x3c000000,0xba2f3913,0x323ebbd9,0x378b3b0e
.long 0x3c00,0xb9a8b9a8,0x3c000000,0xb9a839a8,0xbc008000,0x3913ba2f,0x323e3bd9,0xbb0eb78b
.long 0xbc00,0x3aa73872,0xbb64361f,0x323ebbd9,0x3c000000,0xb78b3b0e,0xb872baa7,0x3bf6ae46
.long 0x3c00,0xbb64b61f,0x39a8b9a8,0x361f3b64,0xbc008000,0x34a5bba8,0x3aa73872,0xba2f3913
.long 0xbc00,0x3bd9323e,0xb61f3b64,0xbaa7b872,0x3c000000,0xae463bf6,0xbbd9b23e,0x34a5bba8
.long 0x3c00,0xbc00,0x3c00,0xbc00,0xbb64361f,0x3b0eb78b,0xbaa73872,0x3a2fb913
.long 0xb9a8b9a8,0x3aa73872,0xbb64b61f,0x3bd9323e,0x361fbb64,0xae463bf6,0xb23ebbd9,0x378b3b0e
.long 0x3c000000,0xbb64361f,0x39a8b9a8,0xb61f3b64,0x361f3b64,0xba2fb913,0x3bd9323e,0xbba834a5
.long 0xb9a839a8,0x323ebbd9,0x361f3b64,0xbaa7b872,0xbb64b61f,0x3ba8b4a5,0xb8723aa7,0xae46bbf6
.long 0xbc00,0x39a839a8,0xbc008000,0x39a8b9a8,0x3b64b61f,0xb4a53ba8,0xb872baa7,0x3bf62e46
.long 0x39a839a8,0xbbd9323e,0x361fbb64,0x38723aa7,0xb61f3b64,0xb913ba2f,0x3bd9b23e,0xb4a53ba8
.long 0xbc008000,0x361fbb64,0x39a839a8,0xbb64361f,0xb61fbb64,0x3bf6ae46,0xb23e3bd9,0xbb0eb78b
.long 0x39a8b9a8,0x38723aa7,0xbb64361f,0xb23ebbd9,0x3b64361f,0xb78b3b0e,0xbaa7b872,0x3913ba2f
.long 0x3c00,0xbc00,0x3c00,0xbc00,0xb9a839a8,0x3913ba2f,0xb8723aa7,0x378bbb0e
.long 0xbc008000,0x3bd9b23e,0xbb64361f,0x3aa7b872,0xb9a8b9a8,0x3b0e378b,0xbbd9b23e,0x3bf6ae46
.long 0xbc00,0x361f3b64,0xb9a8b9a8,0x3b64361f,0x39a8b9a8,0xb4a53ba8,0xb23ebbd9,0x39133a2f
.long 0x3c000000,0xbaa73872,0x361fbb64,0x323e3bd9,0x39a839a8,0xbbf6ae46,0x3aa7b872,0xb4a53ba8
.long 0x3c00,0xb9a8b9a8,0x3c000000,0xb9a839a8,0xb9a839a8,0xae46bbf6,0x3aa73872,0xbba834a5
.long 0xbc008000,0x3872baa7,0x361f3b64,0xbbd9b23e,0xb9a8b9a8,0x3ba8b4a5,0xb23e3bd9,0xba2fb913
.long 0xbc00,0x3b64361f,0xb9a839a8,0xb61fbb64,0x39a8b9a8,0x378b3b0e,0xbbd9323e,0x2e46bbf6
.long 0x3c000000,0xb23e3bd9,0xbb64b61f,0x3872baa7,0x39a839a8,0xba2f3913,0xb872baa7,0x3b0eb78b
.long 0x3c00,0xbc00,0x3c00,0xbc00,0xb61f3b64,0x34a5bba8,0xb23e3bd9,0x2e46bbf6
.long 0xb9a839a8,0x3872baa7,0xb61f3b64,0x323ebbd9,0xbb64361f,0x3a2fb913,0xb8723aa7,0x34a5bba8
.long 0xbc008000,0x3b64b61f,0xb9a839a8,0x361fbb64,0xbb64b61f,0x3bf6ae46,0xbaa73872,0x378bbb0e
.long 0xb9a8b9a8,0x3bd9323e,0xbb64361f,0x3872baa7,0xb61fbb64,0x3b0e378b,0xbbd9323e,0x3913ba2f
.long 0xbc00,0x39a839a8,0xbc008000,0x39a8b9a8,0x361fbb64,0x378b3b0e,0xbbd9b23e,0x3a2fb913
.long 0x39a8b9a8,0x323e3bd9,0xbb64b61f,0x3aa7b872,0x3b64b61f,0xae463bf6,0xbaa7b872,0x3b0eb78b
.long 0x3c000000,0xb61f3b64,0xb9a8b9a8,0x3b64b61f,0x3b64361f,0xb9133a2f,0xb872baa7,0x3ba8b4a5
.long 0x39a839a8,0xbaa73872,0xb61fbb64,0x3bd9b23e,0x361f3b64,0xbba834a5,0xb23ebbd9,0x3bf6ae46
.long 0x3c00,0xbc008000,0xbc00,0x3c000000,0x3c00,0xbbf62e46,0xb23ebbd9,0x3ba8b4a5
.long 0x3c00,0xbbd9323e,0xb61fbb64,0x3aa7b872,0x3c00,0xbba834a5,0xb872baa7,0x3913ba2f
.long 0x3c00,0xbb64361f,0xb9a8b9a8,0x361fbb64,0x3c00,0xbb0e378b,0xbaa7b872,0x2e46bbf6
.long 0x3c00,0xbaa73872,0xbb64b61f,0xb23ebbd9,0x3c00,0xba2f3913,0xbbd9b23e,0xb78bbb0e
.long 0x3c00,0xb9a839a8,0xbc008000,0xb9a8b9a8,0x3c00,0xb9133a2f,0xbbd9323e,0xbb0eb78b
.long 0x3c00,0xb8723aa7,0xbb64361f,0xbbd9b23e,0x3c00,0xb78b3b0e,0xbaa73872,0xbbf62e46
.long 0x3c00,0xb61f3b64,0xb9a839a8,0xbb64361f,0x3c00,0xb4a53ba8,0xb8723aa7,0xba2f3913
.long 0x3c00,0xb23e3bd9,0xb61f3b64,0xb8723aa7,0x3c00,0xae463bf6,0xb23e3bd9,0xb4a53ba8
.long 0x3c00,0xbc008000,0xbc00,0x3c000000,0x361f3b64,0xbb0e378b,0xb872baa7,0x3a2fb913
.long 0x39a839a8,0xb8723aa7,0xbb64b61f,0x323ebbd9,0x3b64361f,0xae463bf6,0xbbd9323e,0xb78bbb0e
.long 0x3c000000,0x361f3b64,0xb9a839a8,0xbb64b61f,0x3b64b61f,0x3a2f3913,0xb23e3bd9,0xbba834a5
.long 0x39a8b9a8,0x3bd9323e,0x361f3b64,0xb8723aa7,0x361fbb64,0x3ba8b4a5,0x3aa73872,0x2e463bf6
.long 0xbc00,0x39a8b9a8,0x3c000000,0x39a839a8,0xb61fbb64,0x34a5bba8,0x3aa7b872,0x3bf62e46
.long 0xb9a8b9a8,0xb23ebbd9,0x361fbb64,0x3aa7b872,0xbb64b61f,0xb913ba2f,0xb23ebbd9,0x34a5bba8
.long 0xbc008000,0xbb64b61f,0xb9a8b9a8,0xb61fbb64,0xbb64361f,0xbbf62e46,0xbbd9b23e,0xbb0eb78b
.long 0xb9a839a8,0xbaa73872,0xbb64361f,0xbbd9323e,0xb61f3b64,0xb78b3b0e,0xb8723aa7,0xb9133a2f
.long 0x3c00,0xbc008000,0xbc00,0x3c000000,0x39a839a8,0xb9133a2f,0xbaa7b872,0x378bbb0e
.long 0x3c000000,0x323e3bd9,0xbb64361f,0xb872baa7,0x39a8b9a8,0x3b0e378b,0xb23e3bd9,0xbbf62e46
.long 0xbc00,0x3b64b61f,0x39a839a8,0xb61f3b64,0xb9a8b9a8,0x34a5bba8,0x3bd9b23e,0x39133a2f
.long 0xbc008000,0xb872baa7,0x361fbb64,0x3bd9b23e,0xb9a839a8,0xbbf6ae46,0xb872baa7,0x34a5bba8
.long 0x3c00,0xb9a839a8,0xbc008000,0xb9a8b9a8,0x39a839a8,0x2e463bf6,0xb8723aa7,0xbba834a5
.long 0x3c000000,0x3aa73872,0x361f3b64,0xb23e3bd9,0x39a8b9a8,0x3ba8b4a5,0x3bd9323e,0x3a2f3913
.long 0xbc00,0x361fbb64,0x39a8b9a8,0x3b64b61f,0xb9a8b9a8,0xb78bbb0e,0xb23ebbd9,0x2e46bbf6
.long 0xbc008000,0xbbd9b23e,0xbb64b61f,0xbaa7b872,0xb9a839a8,0xba2f3913,0xbaa73872,0xbb0e378b
.long 0x3c00,0xbc008000,0xbc00,0x3c000000,0x3b64361f,0xb4a53ba8,0xbbd9b23e,0x2e46bbf6
.long 0x39a8b9a8,0x3aa73872,0xb61f3b64,0xbbd9b23e,0xb61fbb64,0x3a2fb913,0x3aa73872,0xb4a53ba8
.long 0xbc008000,0xb61fbb64,0x39a8b9a8,0x3b64361f,0xb61f3b64,0xbbf62e46,0xb872baa7,0x378bbb0e
.long 0x39a839a8,0xb23e3bd9,0xbb64361f,0xbaa7b872,0x3b64b61f,0x3b0e378b,0x323e3bd9,0xb9133a2f
.long 0xbc00,0x39a8b9a8,0x3c000000,0x39a839a8,0xbb64b61f,0xb78bbb0e,0x323ebbd9,0x3a2fb913
.long 0xb9a839a8,0xbbd9323e,0xbb64b61f,0xb872baa7,0x361f3b64,0xae463bf6,0xb8723aa7,0xbb0e378b
.long 0x3c000000,0x3b64361f,0x39a839a8,0x361f3b64,0x361fbb64,0x3913ba2f,0x3aa7b872,0x3ba8b4a5
.long 0xb9a8b9a8,0xb872baa7,0xb61fbb64,0xb23ebbd9,0xbb64361f,0xbba834a5,0xbbd9323e,0xbbf62e46
.long 0x3c00,0xbc008000,0xbc00,0x3c000000,0x3c000000,0x2e463bf6,0xbbd9323e,0xb4a5bba8
.long 0xbc00,0x3bd9b23e,0x361f3b64,0xbaa73872,0xbc008000,0xb4a5bba8,0x3aa7b872,0x3a2f3913
.long 0x3c00,0xbb64361f,0xb9a8b9a8,0x361fbb64,0x3c000000,0x378b3b0e,0xb8723aa7,0xbbf6ae46
.long 0xbc00,0x3aa7b872,0x3b64361f,0x323e3bd9,0xbc008000,0xb913ba2f,0x323ebbd9,0x3b0eb78b
.long 0x3c00,0xb9a839a8,0xbc008000,0xb9a8b9a8,0x3c000000,0x3a2f3913,0x323e3bd9,0xb78b3b0e
.long 0xbc00,0x3872baa7,0x3b64b61f,0x3bd9323e,0xbc008000,0xbb0eb78b,0xb872baa7,0xae46bbf6
.long 0x3c00,0xb61f3b64,0xb9a839a8,0xbb64361f,0x3c000000,0x3ba834a5,0x3aa73872,0x39133a2f
.long 0xbc00,0x323ebbd9,0x361fbb64,0x3872baa7,0xbc008000,0xbbf6ae46,0xbbd9b23e,0xbba8b4a5
.long 0x3c00,0xbc008000,0xbc00,0x3c000000,0x3b64b61f,0x378b3b0e,0xbaa73872,0xb913ba2f
.long 0xb9a8b9a8,0x3872baa7,0x3b64361f,0xb23e3bd9,0xb61f3b64,0xbbf6ae46,0xb23ebbd9,0x3b0eb78b
.long 0x3c000000,0x361f3b64,0xb9a839a8,0xbb64b61f,0xb61fbb64,0x3913ba2f,0x3bd9323e,0x34a53ba8
.long 0xb9a839a8,0xbbd9b23e,0xb61fbb64,0x3872baa7,0x3b64361f,0x34a53ba8,0xb8723aa7,0xbbf62e46
.long 0xbc00,0x39a8b9a8,0x3c000000,0x39a839a8,0xbb64361f,0xbba8b4a5,0xb872baa7,0x2e46bbf6
.long 0x39a839a8,0x323e3bd9,0xb61f3b64,0xbaa73872,0x361fbb64,0x3a2fb913,0x3bd9b23e,0x3ba834a5
.long 0xbc008000,0xbb64b61f,0xb9a8b9a8,0xb61fbb64,0x361f3b64,0x2e463bf6,0xb23e3bd9,0xb78b3b0e
.long 0x39a8b9a8,0x3aa7b872,0x3b64b61f,0x3bd9b23e,0xbb64b61f,0xbb0eb78b,0xbaa7b872,0xba2fb913
.long 0x3c00,0xbc008000,0xbc00,0x3c000000,0x39a8b9a8,0x3a2f3913,0xb8723aa7,0xbb0eb78b
.long 0xbc008000,0xb23ebbd9,0x3b64b61f,0x38723aa7,0x39a839a8,0xb78b3b0e,0xbbd9b23e,0xae46bbf6
.long 0xbc00,0x3b64b61f,0x39a839a8,0xb61f3b64,0xb9a839a8,0xbba8b4a5,0xb23ebbd9,0x3a2fb913
.long 0x3c000000,0x38723aa7,0xb61f3b64,0xbbd9323e,0xb9a8b9a8,0x2e46bbf6,0x3aa7b872,0x3ba834a5
.long 0x3c00,0xb9a839a8,0xbc008000,0xb9a8b9a8,0x39a8b9a8,0x3bf6ae46,0x3aa73872,0x34a53ba8
.long 0xbc008000,0xbaa7b872,0xb61fbb64,0x323ebbd9,0x39a839a8,0x34a53ba8,0xb23e3bd9,0xb9133a2f
.long 0xbc00,0x361fbb64,0x39a8b9a8,0x3b64b61f,0xb9a839a8,0xbb0e378b,0xbbd9323e,0xbbf6ae46
.long 0x3c000000,0x3bd9323e,0x3b64361f,0x3aa73872,0xb9a8b9a8,0xb913ba2f,0xb872baa7,0xb78bbb0e
.long 0x3c00,0xbc008000,0xbc00,0x3c000000,0x361fbb64,0x3ba834a5,0xb23e3bd9,0xbbf6ae46
.long 0xb9a839a8,0xbaa7b872,0x361fbb64,0x3bd9323e,0x3b64b61f,0x39133a2f,0xb8723aa7,0xbba8b4a5
.long 0xbc008000,0xb61fbb64,0x39a8b9a8,0x3b64361f,0x3b64361f,0x2e463bf6,0xbaa73872,0xbb0eb78b
.long 0xb9a8b9a8,0x323ebbd9,0x3b64b61f,0x3aa73872,0x361f3b64,0xb78b3b0e,0xbbd9323e,0xba2fb913
.long 0xbc00,0x39a8b9a8,0x3c000000,0x39a839a8,0xb61f3b64,0xbb0e378b,0xbbd9b23e,0xb913ba2f
.long 0x39a8b9a8,0x3bd9b23e,0x3b64361f,0x38723aa7,0xbb64361f,0xbbf6ae46,0xbaa7b872,0xb78bbb0e
.long 0x3c000000,0x3b64361f,0x39a839a8,0x361f3b64,0xbb64b61f,0xba2fb913,0xb872baa7,0xb4a5bba8
.long 0x39a839a8,0x38723aa7,0x361f3b64,0x323e3bd9,0xb61fbb64,0xb4a5bba8,0xb23ebbd9,0xae46bbf6
.long 0x3c00,0xbc008000,0xbc00,0x3c000000,0xbc00,0x3bf6ae46,0x323e3bd9,0xbba834a5
.long 0x3c00,0xbbd9323e,0xb61fbb64,0x3aa7b872,0xbc00,0x3ba8b4a5,0x38723aa7,0xb9133a2f
.long 0x3c00,0xbb64361f,0xb9a8b9a8,0x361fbb64,0xbc00,0x3b0eb78b,0x3aa73872,0xae463bf6
.long 0x3c00,0xbaa73872,0xbb64b61f,0xb23ebbd9,0xbc00,0x3a2fb913,0x3bd9323e,0x378b3b0e
.long 0x3c00,0xb9a839a8,0xbc008000,0xb9a8b9a8,0xbc00,0x3913ba2f,0x3bd9b23e,0x3b0e378b
.long 0x3c00,0xb8723aa7,0xbb64361f,0xbbd9b23e,0xbc00,0x378bbb0e,0x3aa7b872,0x3bf6ae46
.long 0x3c00,0xb61f3b64,0xb9a839a8,0xbb64361f,0xbc00,0x34a5bba8,0x3872baa7,0x3a2fb913
.long 0x3c00,0xb23e3bd9,0xb61f3b64,0xb8723aa7,0xbc00,0x2e46bbf6,0x323ebbd9,0x34a5bba8
.long 0x3c00,0xbc008000,0xbc00,0x3c000000,0xb61fbb64,0x3b0eb78b,0x38723aa7,0xba2f3913
.long 0x39a839a8,0xb8723aa7,0xbb64b61f,0x323ebbd9,0xbb64b61f,0x2e46bbf6,0x3bd9b23e,0x378b3b0e
.long 0x3c000000,0x361f3b64,0xb9a839a8,0xbb64b61f,0xbb64361f,0xba2fb913,0x323ebbd9,0x3ba8b4a5
.long 0x39a8b9a8,0x3bd9323e,0x361f3b64,0xb8723aa7,0xb61f3b64,0xbba834a5,0xbaa7b872,0xae46bbf6
.long 0xbc00,0x39a8b9a8,0x3c000000,0x39a839a8,0x361f3b64,0xb4a53ba8,0xbaa73872,0xbbf6ae46
.long 0xb9a8b9a8,0xb23ebbd9,0x361fbb64,0x3aa7b872,0x3b64361f,0x39133a2f,0x323e3bd9,0xb4a53ba8
.long 0xbc008000,0xbb64b61f,0xb9a8b9a8,0xb61fbb64,0x3b64b61f,0x3bf6ae46,0x3bd9323e,0x3b0e378b
.long 0xb9a839a8,0xbaa73872,0xbb64361f,0xbbd9323e,0x361fbb64,0x378bbb0e,0x3872baa7,0x3913ba2f
.long 0x3c00,0xbc008000,0xbc00,0x3c000000,0xb9a8b9a8,0x3913ba2f,0x3aa73872,0xb78b3b0e
.long 0x3c000000,0x323e3bd9,0xbb64361f,0xb872baa7,0xb9a839a8,0xbb0eb78b,0x323ebbd9,0x3bf6ae46
.long 0xbc00,0x3b64b61f,0x39a839a8,0xb61f3b64,0x39a839a8,0xb4a53ba8,0xbbd9323e,0xb913ba2f
.long 0xbc008000,0xb872baa7,0x361fbb64,0x3bd9b23e,0x39a8b9a8,0x3bf62e46,0x38723aa7,0xb4a53ba8
.long 0x3c00,0xb9a839a8,0xbc008000,0xb9a8b9a8,0xb9a8b9a8,0xae46bbf6,0x3872baa7,0x3ba8b4a5
.long 0x3c000000,0x3aa73872,0x361f3b64,0xb23e3bd9,0xb9a839a8,0xbba834a5,0xbbd9b23e,0xba2fb913
.long 0xbc00,0x361fbb64,0x39a8b9a8,0x3b64b61f,0x39a839a8,0x378b3b0e,0x323e3bd9,0xae463bf6
.long 0xbc008000,0xbbd9b23e,0xbb64b61f,0xbaa7b872,0x39a8b9a8,0x3a2fb913,0x3aa7b872,0x3b0eb78b
.long 0x3c00,0xbc008000,0xbc00,0x3c000000,0xbb64b61f,0x34a5bba8,0x3bd9323e,0xae463bf6
.long 0x39a8b9a8,0x3aa73872,0xb61f3b64,0xbbd9b23e,0x361f3b64,0xba2f3913,0xbaa7b872,0x34a5bba8
.long 0xbc008000,0xb61fbb64,0x39a8b9a8,0x3b64361f,0x361fbb64,0x3bf6ae46,0x38723aa7,0xb78b3b0e
.long 0x39a839a8,0xb23e3bd9,0xbb64361f,0xbaa7b872,0xbb64361f,0xbb0eb78b,0xb23ebbd9,0x3913ba2f
.long 0xbc00,0x39a8b9a8,0x3c000000,0x39a839a8,0x3b64361f,0x378b3b0e,0xb23e3bd9,0xba2f3913
.long 0xb9a839a8,0xbbd9323e,0xbb64b61f,0xb872baa7,0xb61fbb64,0x2e46bbf6,0x3872baa7,0x3b0eb78b
.long 0x3c000000,0x3b64361f,0x39a839a8,0x361f3b64,0xb61f3b64,0xb9133a2f,0xbaa73872,0xbba834a5
.long 0xb9a8b9a8,0xb872baa7,0xb61fbb64,0xb23ebbd9,0x3b64b61f,0x3ba8b4a5,0x3bd9b23e,0x3bf6ae46
.long 0x3c00,0xbc008000,0xbc00,0x3c000000,0xbc008000,0xae46bbf6,0x3bd9b23e,0x34a53ba8
.long 0xbc00,0x3bd9b23e,0x361f3b64,0xbaa73872,0x3c000000,0x34a53ba8,0xbaa73872,0xba2fb913
.long 0x3c00,0xbb64361f,0xb9a8b9a8,0x361fbb64,0xbc008000,0xb78bbb0e,0x3872baa7,0x3bf62e46
.long 0xbc00,0x3aa7b872,0x3b64361f,0x323e3bd9,0x3c000000,0x39133a2f,0xb23e3bd9,0xbb0e378b
.long 0x3c00,0xb9a839a8,0xbc008000,0xb9a8b9a8,0xbc008000,0xba2fb913,0xb23ebbd9,0x378bbb0e
.long 0xbc00,0x3872baa7,0x3b64b61f,0x3bd9323e,0x3c000000,0x3b0e378b,0x38723aa7,0x2e463bf6
.long 0x3c00,0xb61f3b64,0xb9a839a8,0xbb64361f,0xbc008000,0xbba8b4a5,0xbaa7b872,0xb913ba2f
.long 0xbc00,0x323ebbd9,0x361fbb64,0x3872baa7,0x3c000000,0x3bf62e46,0x3bd9323e,0x3ba834a5
.long 0x3c00,0xbc008000,0xbc00,0x3c000000,0xbb64361f,0xb78bbb0e,0x3aa7b872,0x39133a2f
.long 0xb9a8b9a8,0x3872baa7,0x3b64361f,0xb23e3bd9,0x361fbb64,0x3bf62e46,0x323e3bd9,0xbb0e378b
.long 0x3c000000,0x361f3b64,0xb9a839a8,0xbb64b61f,0x361f3b64,0xb9133a2f,0xbbd9b23e,0xb4a5bba8
.long 0xb9a839a8,0xbbd9b23e,0xb61fbb64,0x3872baa7,0xbb64b61f,0xb4a5bba8,0x3872baa7,0x3bf6ae46
.long 0xbc00,0x39a8b9a8,0x3c000000,0x39a839a8,0x3b64b61f,0x3ba834a5,0x38723aa7,0xae463bf6
.long 0x39a839a8,0x323e3bd9,0xb61f3b64,0xbaa73872,0xb61f3b64,0xba2f3913,0xbbd9323e,0xbba8b4a5
.long 0xbc008000,0xbb64b61f,0xb9a8b9a8,0xb61fbb64,0xb61fbb64,0xae46bbf6,0x323ebbd9,0x378bbb0e
.long 0x39a8b9a8,0x3aa7b872,0x3b64b61f,0x3bd9b23e,0x3b64361f,0x3b0e378b,0x3aa73872,0x3a2f3913
.long 0x3c00,0xbc008000,0xbc00,0x3c000000,0xb9a839a8,0xba2fb913,0x3872baa7,0x3b0e378b
.long 0xbc008000,0xb23ebbd9,0x3b64b61f,0x38723aa7,0xb9a8b9a8,0x378bbb0e,0x3bd9323e,0x2e463bf6
.long 0xbc00,0x3b64b61f,0x39a839a8,0xb61f3b64,0x39a8b9a8,0x3ba834a5,0x323e3bd9,0xba2f3913
.long 0x3c000000,0x38723aa7,0xb61f3b64,0xbbd9323e,0x39a839a8,0xae463bf6,0xbaa73872,0xbba8b4a5
.long 0x3c00,0xb9a839a8,0xbc008000,0xb9a8b9a8,0xb9a839a8,0xbbf62e46,0xbaa7b872,0xb4a5bba8
.long 0xbc008000,0xbaa7b872,0xb61fbb64,0x323ebbd9,0xb9a8b9a8,0xb4a5bba8,0x323ebbd9,0x3913ba2f
.long 0xbc00,0x361fbb64,0x39a8b9a8,0x3b64b61f,0x39a8b9a8,0x3b0eb78b,0x3bd9b23e,0x3bf62e46
.long 0x3c000000,0x3bd9323e,0x3b64361f,0x3aa73872,0x39a839a8,0x39133a2f,0x38723aa7,0x378b3b0e
.long 0x3c00,0xbc008000,0xbc00,0x3c000000,0xb61f3b64,0xbba8b4a5,0x323ebbd9,0x3bf62e46
.long 0xb9a839a8,0xbaa7b872,0x361fbb64,0x3bd9323e,0xbb64361f,0xb913ba2f,0x3872baa7,0x3ba834a5
.long 0xbc008000,0xb61fbb64,0x39a8b9a8,0x3b64361f,0xbb64b61f,0xae46bbf6,0x3aa7b872,0x3b0e378b
.long 0xb9a8b9a8,0x323ebbd9,0x3b64b61f,0x3aa73872,0xb61fbb64,0x378bbb0e,0x3bd9b23e,0x3a2f3913
.long 0xbc00,0x39a8b9a8,0x3c000000,0x39a839a8,0x361fbb64,0x3b0eb78b,0x3bd9323e,0x39133a2f
.long 0x39a8b9a8,0x3bd9b23e,0x3b64361f,0x38723aa7,0x3b64b61f,0x3bf62e46,0x3aa73872,0x378b3b0e
.long 0x3c000000,0x3b64361f,0x39a839a8,0x361f3b64,0x3b64361f,0x3a2f3913,0x38723aa7,0x34a53ba8
.long 0x39a839a8,0x38723aa7,0x361f3b64,0x323e3bd9,0x361f3b64,0x34a53ba8,0x323e3bd9,0x2e463bf6
.long 0x3c00,0x3c00,0x3c00,0x3c00,0x3c008000,0x3c008000,0x3c008000,0x3c008000
.long 0x3c00,0xbc00,0x361f3b64,0xb61fbb64,0x3c008000,0xbc008000,0x3b64b61f,0xbb64361f
.long 0x3c00,0x3c00,0x39a839a8,0x39a839a8,0x3c008000,0x3c008000,0x39a8b9a8,0x39a8b9a8
.long 0x3c00,0xbc00,0x3b64361f,0xbb64b61f,0x3c008000,0xbc008000,0x361fbb64,0xb61f3b64
.long 0x3c00,0x3c00,0x3c000000,0x3c000000,0x3c008000,0x3c008000,0xbc00,0xbc00
.long 0x3c00,0xbc00,0x3b64b61f,0xbb64361f,0x3c008000,0xbc008000,0xb61fbb64,0x361f3b64
.long 0x3c00,0x3c00,0x39a8b9a8,0x39a8b9a8,0x3c008000,0x3c008000,0xb9a8b9a8,0xb9a8b9a8
.long 0x3c00,0xbc00,0x361fbb64,0xb61f3b64,0x3c008000,0xbc008000,0xbb64b61f,0x3b64361f
.long 0x3c00,0x3c00,0x3c00,0x3c00,0x3c008000,0x3c008000,0x3c008000,0x3c008000
.long 0x39a839a8,0xb9a8b9a8,0x3b64361f,0xbb64b61f,0x39a8b9a8,0xb9a839a8,0x361fbb64,0xb61f3b64
.long 0x3c000000,0x3c000000,0x39a8b9a8,0x39a8b9a8,0xbc00,0xbc00,0xb9a8b9a8,0xb9a8b9a8
.long 0x39a8b9a8,0xb9a839a8,0xb61fbb64,0x361f3b64,0xb9a8b9a8,0x39a839a8,0xbb64361f,0x3b64b61f
.long 0xbc00,0xbc00,0xbc008000,0xbc008000,0xbc008000,0xbc008000,0x80003c00,0x80003c00
.long 0xb9a8b9a8,0x39a839a8,0xb61f3b64,0x361fbb64,0xb9a839a8,0x39a8b9a8,0x3b64361f,0xbb64b61f
.long 0xbc008000,0xbc008000,0x39a839a8,0x39a839a8,0x80003c00,0x80003c00,0x39a8b9a8,0x39a8b9a8
.long 0xb9a839a8,0x39a8b9a8,0x3b64b61f,0xbb64361f,0x39a839a8,0xb9a8b9a8,0xb61fbb64,0x361f3b64
.long 0x3c00,0x3c00,0x3c00,0x3c00,0x3c008000,0x3c008000,0x3c008000,0x3c008000
.long 0x3c000000,0xbc008000,0x3b64b61f,0xbb64361f,0xbc00,0x80003c00,0xb61fbb64,0x361f3b64
.long 0xbc00,0xbc00,0xb9a8b9a8,0xb9a8b9a8,0xbc008000,0xbc008000,0xb9a839a8,0xb9a839a8
.long 0xbc008000,0x3c000000,0xb61f3b64,0x361fbb64,0x80003c00,0xbc00,0x3b64361f,0xbb64b61f
.long 0x3c00,0x3c00,0x3c000000,0x3c000000,0x3c008000,0x3c008000,0xbc00,0xbc00
.long 0x3c000000,0xbc008000,0xb61fbb64,0x361f3b64,0xbc00,0x80003c00,0xbb64361f,0x3b64b61f
.long 0xbc00,0xbc00,0xb9a839a8,0xb9a839a8,0xbc008000,0xbc008000,0x39a839a8,0x39a839a8
.long 0xbc008000,0x3c000000,0x3b64361f,0xbb64b61f,0x80003c00,0xbc00,0x361fbb64,0xb61f3b64
.long 0x3c00,0x3c00,0x3c00,0x3c00,0x3c008000,0x3c008000,0x3c008000,0x3c008000
.long 0x39a8b9a8,0xb9a839a8,0x361fbb64,0xb61f3b64,0xb9a8b9a8,0x39a839a8,0xbb64b61f,0x3b64361f
.long 0xbc008000,0xbc008000,0xb9a839a8,0xb9a839a8,0x80003c00,0x80003c00,0x39a839a8,0x39a839a8
.long 0x39a839a8,0xb9a8b9a8,0x3b64b61f,0xbb64361f,0x39a8b9a8,0xb9a839a8,0xb61fbb64,0x361f3b64
.long 0xbc00,0xbc00,0xbc008000,0xbc008000,0xbc008000,0xbc008000,0x80003c00,0x80003c00
.long 0xb9a839a8,0x39a8b9a8,0x3b64361f,0xbb64b61f,0x39a839a8,0xb9a8b9a8,0x361fbb64,0xb61f3b64
.long 0x3c000000,0x3c000000,0xb9a8b9a8,0xb9a8b9a8,0xbc00,0xbc00,0xb9a839a8,0xb9a839a8
.long 0xb9a8b9a8,0x39a839a8,0x361f3b64,0xb61fbb64,0xb9a839a8,0x39a8b9a8,0x3b64b61f,0xbb64361f
.long 0x3c00,0x3c00,0x3c00,0x3c00,0x3c008000,0x3c008000,0x3c008000,0x3c008000
.long 0x2a483bfe,0xaa48bbfe,0x395f39ed,0xb95fb9ed,0x3bfeaa48,0xbbfe2a48,0x39edb95f,0xb9ed395f
.long 0x2e463bf6,0x2e463bf6,0x3bf62e46,0x3bf62e46,0x3bf6ae46,0x3bf6ae46,0x2e46bbf6,0x2e46bbf6
.long 0x30b23bea,0xb0b2bbea,0x3a6db8c4,0xba6d38c4,0x3beab0b2,0xbbea30b2,0xb8c4ba6d,0x38c43a6d
.long 0x323e3bd9,0x323e3bd9,0x323ebbd9,0x323ebbd9,0x3bd9b23e,0x3bd9b23e,0xbbd9b23e,0xbbd9b23e
.long 0x33c63bc3,0xb3c6bbc3,0xb81dbadd,0x381d3add,0x3bc3b3c6,0xbbc333c6,0xbadd381d,0x3addb81d
.long 0x34a53ba8,0x34a53ba8,0xbba8b4a5,0xbba8b4a5,0x3ba8b4a5,0x3ba8b4a5,0xb4a53ba8,0xb4a53ba8
.long 0x35643b88,0xb564bb88,0xbb3b36d7,0x3b3bb6d7,0x3b88b564,0xbb883564,0x36d73b3b,0xb6d7bb3b
.long 0x3c00,0x3c00,0x3c00,0x3c00,0x3c008000,0x3c008000,0x3c008000,0x3c008000
.long 0x39ed395f,0xb9edb95f,0x3bfe2a48,0xbbfeaa48,0x395fb9ed,0xb95f39ed,0x2a48bbfe,0xaa483bfe
.long 0x3bf6ae46,0x3bf6ae46,0x2e46bbf6,0x2e46bbf6,0xae46bbf6,0xae46bbf6,0xbbf6ae46,0xbbf6ae46
.long 0x38c4ba6d,0xb8c43a6d,0xbbeab0b2,0x3bea30b2,0xba6db8c4,0x3a6d38c4,0xb0b23bea,0x30b2bbea
.long 0xb23ebbd9,0xb23ebbd9,0xb23e3bd9,0xb23e3bd9,0xbbd9323e,0xbbd9323e,0x3bd9323e,0x3bd9323e
.long 0xbaddb81d,0x3add381d,0x3bc333c6,0xbbc3b3c6,0xb81d3add,0x381dbadd,0x33c6bbc3,0xb3c63bc3
.long 0xbba834a5,0xbba834a5,0x34a5bba8,0x34a5bba8,0x34a53ba8,0x34a53ba8,0xbba8b4a5,0xbba8b4a5
.long 0xb6d73b3b,0x36d7bb3b,0xbb88b564,0x3b883564,0x3b3b36d7,0xbb3bb6d7,0xb5643b88,0x3564bb88
.long 0x3c00,0x3c00,0x3c00,0x3c00,0x3c008000,0x3c008000,0x3c008000,0x3c008000
.long 0x3bfeaa48,0xbbfe2a48,0x39edb95f,0xb9ed395f,0xaa48bbfe,0x2a483bfe,0xb95fb9ed,0x395f39ed
.long 0xae46bbf6,0xae46bbf6,0xbbf6ae46,0xbbf6ae46,0xbbf62e46,0xbbf62e46,0xae463bf6,0xae463bf6
.long 0xbbea30b2,0x3beab0b2,0x38c43a6d,0xb8c4ba6d,0x30b23bea,0xb0b2bbea,0x3a6db8c4,0xba6d38c4
.long 0x323e3bd9,0x323e3bd9,0x323ebbd9,0x323ebbd9,0x3bd9b23e,0x3bd9b23e,0xbbd9b23e,0xbbd9b23e
.long 0x3bc3b3c6,0xbbc333c6,0xbadd381d,0x3addb81d,0xb3c6bbc3,0x33c63bc3,0x381d3add,0xb81dbadd
.long 0xb4a5bba8,0xb4a5bba8,0x3ba834a5,0x3ba834a5,0xbba834a5,0xbba834a5,0x34a5bba8,0x34a5bba8
.long 0xbb883564,0x3b88b564,0xb6d7bb3b,0x36d73b3b,0x35643b88,0xb564bb88,0xbb3b36d7,0x3b3bb6d7
.long 0x3c00,0x3c00,0x3c00,0x3c00,0x3c008000,0x3c008000,0x3c008000,0x3c008000
.long 0x395fb9ed,0xb95f39ed,0x2a48bbfe,0xaa483bfe,0xb9edb95f,0x39ed395f,0xbbfeaa48,0x3bfe2a48
.long 0xbbf62e46,0xbbf62e46,0xae463bf6,0xae463bf6,0x2e463bf6,0x2e463bf6,0x3bf62e46,0x3bf62e46
.long 0x3a6d38c4,0xba6db8c4,0x30b2bbea,0xb0b23bea,0x38c4ba6d,0xb8c43a6d,0xbbeab0b2,0x3bea30b2
.long 0xb23ebbd9,0xb23ebbd9,0xb23e3bd9,0xb23e3bd9,0xbbd9323e,0xbbd9323e,0x3bd9323e,0x3bd9323e
.long 0xb81d3add,0x381dbadd,0x33c6bbc3,0xb3c63bc3,0x3add381d,0xbaddb81d,0xbbc3b3c6,0x3bc333c6
.long 0x3ba8b4a5,0x3ba8b4a5,0xb4a53ba8,0xb4a53ba8,0xb4a5bba8,0xb4a5bba8,0x3ba834a5,0x3ba834a5
.long 0xbb3bb6d7,0x3b3b36d7,0x3564bb88,0xb5643b88,0xb6d73b3b,0x36d7bb3b,0xbb88b564,0x3b883564
.long 0x3c00,0x3c00,0x3c00,0x3c00,0x3c008000,0x3c008000,0x3c008000,0x3c008000
.long 0x2e463bf6,0xae46bbf6,0x39133a2f,0xb913ba2f,0x3bf6ae46,0xbbf62e46,0x3a2fb913,0xba2f3913
.long 0x323e3bd9,0x323e3bd9,0x3bd9323e,0x3bd9323e,0x3bd9b23e,0x3bd9b23e,0x323ebbd9,0x323ebbd9
.long 0x34a53ba8,0xb4a5bba8,0x3b0eb78b,0xbb0e378b,0x3ba8b4a5,0xbba834a5,0xb78bbb0e,0x378b3b0e
.long 0x361f3b64,0x361f3b64,0x361fbb64,0x361fbb64,0x3b64b61f,0x3b64b61f,0xbb64b61f,0xbb64b61f
.long 0x378b3b0e,0xb78bbb0e,0xb4a5bba8,0x34a53ba8,0x3b0eb78b,0xbb0e378b,0xbba834a5,0x3ba8b4a5
.long 0x38723aa7,0x38723aa7,0xbaa7b872,0xbaa7b872,0x3aa7b872,0x3aa7b872,0xb8723aa7,0xb8723aa7
.long 0x39133a2f,0xb913ba2f,0xbbf62e46,0x3bf6ae46,0x3a2fb913,0xba2f3913,0x2e463bf6,0xae46bbf6
.long 0x3c00,0x3c00,0x3c00,0x3c00,0x3c008000,0x3c008000,0x3c008000,0x3c008000
.long 0x3a2f3913,0xba2fb913,0x3bf62e46,0xbbf6ae46,0x3913ba2f,0xb9133a2f,0x2e46bbf6,0xae463bf6
.long 0x3bd9b23e,0x3bd9b23e,0x323ebbd9,0x323ebbd9,0xb23ebbd9,0xb23ebbd9,0xbbd9b23e,0xbbd9b23e
.long 0x378bbb0e,0xb78b3b0e,0xbba8b4a5,0x3ba834a5,0xbb0eb78b,0x3b0e378b,0xb4a53ba8,0x34a5bba8
.long 0xb61fbb64,0xb61fbb64,0xb61f3b64,0xb61f3b64,0xbb64361f,0xbb64361f,0x3b64361f,0x3b64361f
.long 0xbba8b4a5,0x3ba834a5,0x3b0e378b,0xbb0eb78b,0xb4a53ba8,0x34a5bba8,0x378bbb0e,0xb78b3b0e
.long 0xbaa73872,0xbaa73872,0x3872baa7,0x3872baa7,0x38723aa7,0x38723aa7,0xbaa7b872,0xbaa7b872
.long 0xae463bf6,0x2e46bbf6,0xba2fb913,0x3a2f3913,0x3bf62e46,0xbbf6ae46,0xb9133a2f,0x3913ba2f
.long 0x3c00,0x3c00,0x3c00,0x3c00,0x3c008000,0x3c008000,0x3c008000,0x3c008000
.long 0x3bf6ae46,0xbbf62e46,0x3a2fb913,0xba2f3913,0xae46bbf6,0x2e463bf6,0xb913ba2f,0x39133a2f
.long 0xb23ebbd9,0xb23ebbd9,0xbbd9b23e,0xbbd9b23e,0xbbd9323e,0xbbd9323e,0xb23e3bd9,0xb23e3bd9
.long 0xbba834a5,0x3ba8b4a5,0x378b3b0e,0xb78bbb0e,0x34a53ba8,0xb4a5bba8,0x3b0eb78b,0xbb0e378b
.long 0x361f3b64,0x361f3b64,0x361fbb64,0x361fbb64,0x3b64b61f,0x3b64b61f,0xbb64b61f,0xbb64b61f
.long 0x3b0eb78b,0xbb0e378b,0xbba834a5,0x3ba8b4a5,0xb78bbb0e,0x378b3b0e,0x34a53ba8,0xb4a5bba8
.long 0xb872baa7,0xb872baa7,0x3aa73872,0x3aa73872,0xbaa73872,0xbaa73872,0x3872baa7,0x3872baa7
.long 0xba2f3913,0x3a2fb913,0xae46bbf6,0x2e463bf6,0x39133a2f,0xb913ba2f,0xbbf62e46,0x3bf6ae46
.long 0x3c00,0x3c00,0x3c00,0x3c00,0x3c008000,0x3c008000,0x3c008000,0x3c008000
.long 0x3913ba2f,0xb9133a2f,0x2e46bbf6,0xae463bf6,0xba2fb913,0x3a2f3913,0xbbf6ae46,0x3bf62e46
.long 0xbbd9323e,0xbbd9323e,0xb23e3bd9,0xb23e3bd9,0x323e3bd9,0x323e3bd9,0x3bd9323e,0x3bd9323e
.long 0x3b0e378b,0xbb0eb78b,0x34a5bba8,0xb4a53ba8,0x378bbb0e,0xb78b3b0e,0xbba8b4a5,0x3ba834a5
.long 0xb61fbb64,0xb61fbb64,0xb61f3b64,0xb61f3b64,0xbb64361f,0xbb64361f,0x3b64361f,0x3b64361f
.long 0xb4a53ba8,0x34a5bba8,0x378bbb0e,0xb78b3b0e,0x3ba834a5,0xbba8b4a5,0xbb0eb78b,0x3b0e378b
.long 0x3aa7b872,0x3aa7b872,0xb8723aa7,0xb8723aa7,0xb872baa7,0xb872baa7,0x3aa73872,0x3aa73872
.long 0xbbf6ae46,0x3bf62e46,0x3913ba2f,0xb9133a2f,0xae463bf6,0x2e46bbf6,0xba2fb913,0x3a2f3913
.long 0x3c00,0x3c00,0x3c00,0x3c00,0x3c008000,0x3c008000,0x3c008000,0x3c008000
.long 0x30b23bea,0xb0b2bbea,0x38c43a6d,0xb8c4ba6d,0x3beab0b2,0xbbea30b2,0x3a6db8c4,0xba6d38c4
.long 0x34a53ba8,0x34a53ba8,0x3ba834a5,0x3ba834a5,0x3ba8b4a5,0x3ba8b4a5,0x34a5bba8,0x34a5bba8
.long 0x36d73b3b,0xb6d7bb3b,0x3b88b564,0xbb883564,0x3b3bb6d7,0xbb3b36d7,0xb564bb88,0x35643b88
.long 0x38723aa7,0x38723aa7,0x3872baa7,0x3872baa7,0x3aa7b872,0x3aa7b872,0xbaa7b872,0xbaa7b872
.long 0x395f39ed,0xb95fb9ed,0xaa48bbfe,0x2a483bfe,0x39edb95f,0xb9ed395f,0xbbfe2a48,0x3bfeaa48
.long 0x3a2f3913,0x3a2f3913,0xb913ba2f,0xb913ba2f,0x3913ba2f,0x3913ba2f,0xba2f3913,0xba2f3913
.long 0x3add381d,0xbaddb81d,0xbbc3b3c6,0x3bc333c6,0x381dbadd,0xb81d3add,0xb3c63bc3,0x33c6bbc3
.long 0x3c00,0x3c00,0x3c00,0x3c00,0x3c008000,0x3c008000,0x3c008000,0x3c008000
.long 0x3a6d38c4,0xba6db8c4,0x3bea30b2,0xbbeab0b2,0x38c4ba6d,0xb8c43a6d,0x30b2bbea,0xb0b23bea
.long 0x3ba8b4a5,0x3ba8b4a5,0x34a5bba8,0x34a5bba8,0xb4a5bba8,0xb4a5bba8,0xbba8b4a5,0xbba8b4a5
.long 0x3564bb88,0xb5643b88,0xbb3bb6d7,0x3b3b36d7,0xbb88b564,0x3b883564,0xb6d73b3b,0x36d7bb3b
.long 0xb872baa7,0xb872baa7,0xb8723aa7,0xb8723aa7,0xbaa73872,0xbaa73872,0x3aa73872,0x3aa73872
.long 0xbbfeaa48,0x3bfe2a48,0x39ed395f,0xb9edb95f,0xaa483bfe,0x2a48bbfe,0x395fb9ed,0xb95f39ed
.long 0xb9133a2f,0xb9133a2f,0x3a2fb913,0x3a2fb913,0x3a2f3913,0x3a2f3913,0xb913ba2f,0xb913ba2f
.long 0x33c63bc3,0xb3c6bbc3,0xb81dbadd,0x381d3add,0x3bc3b3c6,0xbbc333c6,0xbadd381d,0x3addb81d
.long 0x3c00,0x3c00,0x3c00,0x3c00,0x3c008000,0x3c008000,0x3c008000,0x3c008000
.long 0x3beab0b2,0xbbea30b2,0x3a6db8c4,0xba6d38c4,0xb0b2bbea,0x30b23bea,0xb8c4ba6d,0x38c43a6d
.long 0xb4a5bba8,0xb4a5bba8,0xbba8b4a5,0xbba8b4a5,0xbba834a5,0xbba834a5,0xb4a53ba8,0xb4a53ba8
.long 0xbb3b36d7,0x3b3bb6d7,0x35643b88,0xb564bb88,0x36d73b3b,0xb6d7bb3b,0x3b88b564,0xbb883564
.long 0x38723aa7,0x38723aa7,0x3872baa7,0x3872baa7,0x3aa7b872,0x3aa7b872,0xbaa7b872,0xbaa7b872
.long 0x39edb95f,0xb9ed395f,0xbbfe2a48,0x3bfeaa48,0xb95fb9ed,0x395f39ed,0x2a483bfe,0xaa48bbfe
.long 0xba2fb913,0xba2fb913,0x39133a2f,0x39133a2f,0xb9133a2f,0xb9133a2f,0x3a2fb913,0x3a2fb913
.long 0xb81d3add,0x381dbadd,0x33c6bbc3,0xb3c63bc3,0x3add381d,0xbaddb81d,0xbbc3b3c6,0x3bc333c6
.long 0x3c00,0x3c00,0x3c00,0x3c00,0x3c008000,0x3c008000,0x3c008000,0x3c008000
.long 0x38c4ba6d,0xb8c43a6d,0x30b2bbea,0xb0b23bea,0xba6db8c4,0x3a6d38c4,0xbbeab0b2,0x3bea30b2
.long 0xbba834a5,0xbba834a5,0xb4a53ba8,0xb4a53ba8,0x34a53ba8,0x34a53ba8,0x3ba834a5,0x3ba834a5
.long 0x3b883564,0xbb88b564,0x36d7bb3b,0xb6d73b3b,0x3564bb88,0xb5643b88,0xbb3bb6d7,0x3b3b36d7
.long 0xb872baa7,0xb872baa7,0xb8723aa7,0xb8723aa7,0xbaa73872,0xbaa73872,0x3aa73872,0x3aa73872
.long 0xaa483bfe,0x2a48bbfe,0x395fb9ed,0xb95f39ed,0x3bfe2a48,0xbbfeaa48,0xb9edb95f,0x39ed395f
.long 0x3913ba2f,0x3913ba2f,0xba2f3913,0xba2f3913,0xba2fb913,0xba2fb913,0x39133a2f,0x39133a2f
.long 0xbbc333c6,0x3bc3b3c6,0x3addb81d,0xbadd381d,0x33c63bc3,0xb3c6bbc3,0xb81dbadd,0x381d3add
.long 0x3c00,0x3c00,0x3c00,0x3c00,0x3c008000,0x3c008000,0x3c008000,0x3c008000
.long 0x323e3bd9,0xb23ebbd9,0x38723aa7,0xb872baa7,0x3bd9b23e,0xbbd9323e,0x3aa7b872,0xbaa73872
.long 0x361f3b64,0x361f3b64,0x3b64361f,0x3b64361f,0x3b64b61f,0x3b64b61f,0x361fbb64,0x361fbb64
.long 0x38723aa7,0xb872baa7,0x3bd9b23e,0xbbd9323e,0x3aa7b872,0xbaa73872,0xb23ebbd9,0x323e3bd9
.long 0x39a839a8,0x39a839a8,0x39a8b9a8,0x39a8b9a8,0x39a8b9a8,0x39a8b9a8,0xb9a8b9a8,0xb9a8b9a8
.long 0x3aa73872,0xbaa7b872,0x323ebbd9,0xb23e3bd9,0x3872baa7,0xb8723aa7,0xbbd9b23e,0x3bd9323e
.long 0x3b64361f,0x3b64361f,0xb61fbb64,0xb61fbb64,0x361fbb64,0x361fbb64,0xbb64361f,0xbb64361f
.long 0x3bd9323e,0xbbd9b23e,0xbaa7b872,0x3aa73872,0x323ebbd9,0xb23e3bd9,0xb8723aa7,0x3872baa7
.long 0x3c00,0x3c00,0x3c00,0x3c00,0x3c008000,0x3c008000,0x3c008000,0x3c008000
.long 0x3aa73872,0xbaa7b872,0x3bd9323e,0xbbd9b23e,0x3872baa7,0xb8723aa7,0x323ebbd9,0xb23e3bd9
.long 0x3b64b61f,0x3b64b61f,0x361fbb64,0x361fbb64,0xb61fbb64,0xb61fbb64,0xbb64b61f,0xbb64b61f
.long 0x323ebbd9,0xb23e3bd9,0xbaa7b872,0x3aa73872,0xbbd9b23e,0x3bd9323e,0xb8723aa7,0x3872baa7
.long 0xb9a8b9a8,0xb9a8b9a8,0xb9a839a8,0xb9a839a8,0xb9a839a8,0xb9a839a8,0x39a839a8,0x39a839a8
.long 0xbbd9323e,0x3bd9b23e,0x38723aa7,0xb872baa7,0x323e3bd9,0xb23ebbd9,0x3aa7b872,0xbaa73872
.long 0xb61f3b64,0xb61f3b64,0x3b64b61f,0x3b64b61f,0x3b64361f,0x3b64361f,0xb61fbb64,0xb61fbb64
.long 0x38723aa7,0xb872baa7,0xb23ebbd9,0x323e3bd9,0x3aa7b872,0xbaa73872,0xbbd9323e,0x3bd9b23e
.long 0x3c00,0x3c00,0x3c00,0x3c00,0x3c008000,0x3c008000,0x3c008000,0x3c008000
.long 0x3bd9b23e,0xbbd9323e,0x3aa7b872,0xbaa73872,0xb23ebbd9,0x323e3bd9,0xb872baa7,0x38723aa7
.long 0xb61fbb64,0xb61fbb64,0xbb64b61f,0xbb64b61f,0xbb64361f,0xbb64361f,0xb61f3b64,0xb61f3b64
.long 0xbaa73872,0x3aa7b872,0x323e3bd9,0xb23ebbd9,0x38723aa7,0xb872baa7,0x3bd9b23e,0xbbd9323e
.long 0x39a839a8,0x39a839a8,0x39a8b9a8,0x39a8b9a8,0x39a8b9a8,0x39a8b9a8,0xb9a8b9a8,0xb9a8b9a8
.long 0x3872baa7,0xb8723aa7,0xbbd9b23e,0x3bd9323e,0xbaa7b872,0x3aa73872,0xb23e3bd9,0x323ebbd9
.long 0xbb64b61f,0xbb64b61f,0x361f3b64,0x361f3b64,0xb61f3b64,0xb61f3b64,0x3b64b61f,0x3b64b61f
.long 0xb23e3bd9,0x323ebbd9,0x3872baa7,0xb8723aa7,0x3bd9323e,0xbbd9b23e,0xbaa7b872,0x3aa73872
.long 0x3c00,0x3c00,0x3c00,0x3c00,0x3c008000,0x3c008000,0x3c008000,0x3c008000
.long 0x3872baa7,0xb8723aa7,0x323ebbd9,0xb23e3bd9,0xbaa7b872,0x3aa73872,0xbbd9b23e,0x3bd9323e
.long 0xbb64361f,0xbb64361f,0xb61f3b64,0xb61f3b64,0x361f3b64,0x361f3b64,0x3b64361f,0x3b64361f
.long 0x3bd9323e,0xbbd9b23e,0x3872baa7,0xb8723aa7,0x323ebbd9,0xb23e3bd9,0xbaa7b872,0x3aa73872
.long 0xb9a8b9a8,0xb9a8b9a8,0xb9a839a8,0xb9a839a8,0xb9a839a8,0xb9a839a8,0x39a839a8,0x39a839a8
.long 0x323e3bd9,0xb23ebbd9,0x3aa7b872,0xbaa73872,0x3bd9b23e,0xbbd9323e,0xb872baa7,0x38723aa7
.long 0x361fbb64,0x361fbb64,0xbb64361f,0xbb64361f,0xbb64b61f,0xbb64b61f,0x361f3b64,0x361f3b64
.long 0xbaa73872,0x3aa7b872,0x3bd9b23e,0xbbd9323e,0x38723aa7,0xb872baa7,0xb23ebbd9,0x323e3bd9
.long 0x3c00,0x3c00,0x3c00,0x3c00,0x3c008000,0x3c008000,0x3c008000,0x3c008000
.long 0x33c63bc3,0xb3c6bbc3,0x381d3add,0xb81dbadd,0x3bc3b3c6,0xbbc333c6,0x3addb81d,0xbadd381d
.long 0x378b3b0e,0x378b3b0e,0x3b0e378b,0x3b0e378b,0x3b0eb78b,0x3b0eb78b,0x378bbb0e,0x378bbb0e
.long 0x395f39ed,0xb95fb9ed,0x3bfeaa48,0xbbfe2a48,0x39edb95f,0xb9ed395f,0xaa48bbfe,0x2a483bfe
.long 0x3aa73872,0x3aa73872,0x3aa7b872,0x3aa7b872,0x3872baa7,0x3872baa7,0xb872baa7,0xb872baa7
.long 0x3b883564,0xbb88b564,0x36d7bb3b,0xb6d73b3b,0x3564bb88,0xb5643b88,0xbb3bb6d7,0x3b3b36d7
.long 0x3bf62e46,0x3bf62e46,0xae46bbf6,0xae46bbf6,0x2e46bbf6,0x2e46bbf6,0xbbf62e46,0xbbf62e46
.long 0x3beab0b2,0xbbea30b2,0xb8c4ba6d,0x38c43a6d,0xb0b2bbea,0x30b23bea,0xba6d38c4,0x3a6db8c4
.long 0x3c00,0x3c00,0x3c00,0x3c00,0x3c008000,0x3c008000,0x3c008000,0x3c008000
.long 0x3add381d,0xbaddb81d,0x3bc333c6,0xbbc3b3c6,0x381dbadd,0xb81d3add,0x33c6bbc3,0xb3c63bc3
.long 0x3b0eb78b,0x3b0eb78b,0x378bbb0e,0x378bbb0e,0xb78bbb0e,0xb78bbb0e,0xbb0eb78b,0xbb0eb78b
.long 0x2a48bbfe,0xaa483bfe,0xb9edb95f,0x39ed395f,0xbbfeaa48,0x3bfe2a48,0xb95f39ed,0x395fb9ed
.long 0xbaa7b872,0xbaa7b872,0xbaa73872,0xbaa73872,0xb8723aa7,0xb8723aa7,0x38723aa7,0x38723aa7
.long 0xbb3b36d7,0x3b3bb6d7,0x35643b88,0xb564bb88,0x36d73b3b,0xb6d7bb3b,0x3b88b564,0xbb883564
.long 0xae463bf6,0xae463bf6,0x3bf6ae46,0x3bf6ae46,0x3bf62e46,0x3bf62e46,0xae46bbf6,0xae46bbf6
.long 0x3a6d38c4,0xba6db8c4,0x30b2bbea,0xb0b23bea,0x38c4ba6d,0xb8c43a6d,0xbbeab0b2,0x3bea30b2
.long 0x3c00,0x3c00,0x3c00,0x3c00,0x3c008000,0x3c008000,0x3c008000,0x3c008000
.long 0x3bc3b3c6,0xbbc333c6,0x3addb81d,0xbadd381d,0xb3c6bbc3,0x33c63bc3,0xb81dbadd,0x381d3add
.long 0xb78bbb0e,0xb78bbb0e,0xbb0eb78b,0xbb0eb78b,0xbb0e378b,0xbb0e378b,0xb78b3b0e,0xb78b3b0e
.long 0xb9ed395f,0x39edb95f,0x2a483bfe,0xaa48bbfe,0x395f39ed,0xb95fb9ed,0x3bfeaa48,0xbbfe2a48
.long 0x3aa73872,0x3aa73872,0x3aa7b872,0x3aa7b872,0x3872baa7,0x3872baa7,0xb872baa7,0xb872baa7
.long 0x3564bb88,0xb5643b88,0xbb3bb6d7,0x3b3b36d7,0xbb88b564,0x3b883564,0xb6d73b3b,0x36d7bb3b
.long 0xbbf6ae46,0xbbf6ae46,0x2e463bf6,0x2e463bf6,0xae463bf6,0xae463bf6,0x3bf6ae46,0x3bf6ae46
.long 0x30b23bea,0xb0b2bbea,0x3a6db8c4,0xba6d38c4,0x3beab0b2,0xbbea30b2,0xb8c4ba6d,0x38c43a6d
.long 0x3c00,0x3c00,0x3c00,0x3c00,0x3c008000,0x3c008000,0x3c008000,0x3c008000
.long 0x381dbadd,0xb81d3add,0x33c6bbc3,0xb3c63bc3,0xbaddb81d,0x3add381d,0xbbc3b3c6,0x3bc333c6
.long 0xbb0e378b,0xbb0e378b,0xb78b3b0e,0xb78b3b0e,0x378b3b0e,0x378b3b0e,0x3b0e378b,0x3b0e378b
.long 0x3bfe2a48,0xbbfeaa48,0x395fb9ed,0xb95f39ed,0x2a48bbfe,0xaa483bfe,0xb9edb95f,0x39ed395f
.long 0xbaa7b872,0xbaa7b872,0xbaa73872,0xbaa73872,0xb8723aa7,0xb8723aa7,0x38723aa7,0x38723aa7
.long 0x36d73b3b,0xb6d7bb3b,0x3b88b564,0xbb883564,0x3b3bb6d7,0xbb3b36d7,0xb564bb88,0x35643b88
.long 0x2e46bbf6,0x2e46bbf6,0xbbf62e46,0xbbf62e46,0xbbf6ae46,0xbbf6ae46,0x2e463bf6,0x2e463bf6
.long 0xb8c43a6d,0x38c4ba6d,0x3bea30b2,0xbbeab0b2,0x3a6d38c4,0xba6db8c4,0x30b2bbea,0xb0b23bea
.long 0x3c00,0x3c00,0x3c00,0x3c00,0x3c008000,0x3c008000,0x3c008000,0x3c008000
.long 0x34a53ba8,0xb4a5bba8,0x378b3b0e,0xb78bbb0e,0x3ba8b4a5,0xbba834a5,0x3b0eb78b,0xbb0e378b
.long 0x38723aa7,0x38723aa7,0x3aa73872,0x3aa73872,0x3aa7b872,0x3aa7b872,0x3872baa7,0x3872baa7
.long 0x3a2f3913,0xba2fb913,0x3bf62e46,0xbbf6ae46,0x3913ba2f,0xb9133a2f,0x2e46bbf6,0xae463bf6
.long 0x3b64361f,0x3b64361f,0x3b64b61f,0x3b64b61f,0x361fbb64,0x361fbb64,0xb61fbb64,0xb61fbb64
.long 0x3bf62e46,0xbbf6ae46,0x3913ba2f,0xb9133a2f,0x2e46bbf6,0xae463bf6,0xba2fb913,0x3a2f3913
.long 0x3bd9b23e,0x3bd9b23e,0x323ebbd9,0x323ebbd9,0xb23ebbd9,0xb23ebbd9,0xbbd9b23e,0xbbd9b23e
.long 0x3b0eb78b,0xbb0e378b,0xb4a5bba8,0x34a53ba8,0xb78bbb0e,0x378b3b0e,0xbba834a5,0x3ba8b4a5
.long 0x3c00,0x3c00,0x3c00,0x3c00,0x3c008000,0x3c008000,0x3c008000,0x3c008000
.long 0x3b0e378b,0xbb0eb78b,0x3ba834a5,0xbba8b4a5,0x378bbb0e,0xb78b3b0e,0x34a5bba8,0xb4a53ba8
.long 0x3aa7b872,0x3aa7b872,0x3872baa7,0x3872baa7,0xb872baa7,0xb872baa7,0xbaa7b872,0xbaa7b872
.long 0xae46bbf6,0x2e463bf6,0xb913ba2f,0x39133a2f,0xbbf62e46,0x3bf6ae46,0xba2f3913,0x3a2fb913
.long 0xbb64b61f,0xbb64b61f,0xbb64361f,0xbb64361f,0xb61f3b64,0xb61f3b64,0x361f3b64,0x361f3b64
.long 0xba2f3913,0x3a2fb913,0x2e463bf6,0xae46bbf6,0x39133a2f,0xb913ba2f,0x3bf6ae46,0xbbf62e46
.long 0x323e3bd9,0x323e3bd9,0x3bd9323e,0x3bd9323e,0x3bd9b23e,0x3bd9b23e,0x323ebbd9,0x323ebbd9
.long 0x3ba834a5,0xbba8b4a5,0x378bbb0e,0xb78b3b0e,0x34a5bba8,0xb4a53ba8,0xbb0eb78b,0x3b0e378b
.long 0x3c00,0x3c00,0x3c00,0x3c00,0x3c008000,0x3c008000,0x3c008000,0x3c008000
.long 0x3ba8b4a5,0xbba834a5,0x3b0eb78b,0xbb0e378b,0xb4a5bba8,0x34a53ba8,0xb78bbb0e,0x378b3b0e
.long 0xb872baa7,0xb872baa7,0xbaa7b872,0xbaa7b872,0xbaa73872,0xbaa73872,0xb8723aa7,0xb8723aa7
.long 0xb9133a2f,0x3913ba2f,0xae463bf6,0x2e46bbf6,0x3a2f3913,0xba2fb913,0x3bf62e46,0xbbf6ae46
.long 0x3b64361f,0x3b64361f,0x3b64b61f,0x3b64b61f,0x361fbb64,0x361fbb64,0xb61fbb64,0xb61fbb64
.long 0x2e46bbf6,0xae463bf6,0xba2fb913,0x3a2f3913,0xbbf6ae46,0x3bf62e46,0xb9133a2f,0x3913ba2f
.long 0xbbd9323e,0xbbd9323e,0xb23e3bd9,0xb23e3bd9,0x323e3bd9,0x323e3bd9,0x3bd9323e,0x3bd9323e
.long 0x378b3b0e,0xb78bbb0e,0x3ba8b4a5,0xbba834a5,0x3b0eb78b,0xbb0e378b,0xb4a5bba8,0x34a53ba8
.long 0x3c00,0x3c00,0x3c00,0x3c00,0x3c008000,0x3c008000,0x3c008000,0x3c008000
.long 0x378bbb0e,0xb78b3b0e,0x34a5bba8,0xb4a53ba8,0xbb0eb78b,0x3b0e378b,0xbba8b4a5,0x3ba834a5
.long 0xbaa73872,0xbaa73872,0xb8723aa7,0xb8723aa7,0x38723aa7,0x38723aa7,0x3aa73872,0x3aa73872
.long 0x3bf6ae46,0xbbf62e46,0x3a2fb913,0xba2f3913,0xae46bbf6,0x2e463bf6,0xb913ba2f,0x39133a2f
.long 0xbb64b61f,0xbb64b61f,0xbb64361f,0xbb64361f,0xb61f3b64,0xb61f3b64,0x361f3b64,0x361f3b64
.long 0x39133a2f,0xb913ba2f,0x3bf6ae46,0xbbf62e46,0x3a2fb913,0xba2f3913,0xae46bbf6,0x2e463bf6
.long 0xb23ebbd9,0xb23ebbd9,0xbbd9b23e,0xbbd9b23e,0xbbd9323e,0xbbd9323e,0xb23e3bd9,0xb23e3bd9
.long 0xb4a53ba8,0x34a5bba8,0x3b0e378b,0xbb0eb78b,0x3ba834a5,0xbba8b4a5,0x378bbb0e,0xb78b3b0e
.long 0x3c00,0x3c00,0x3c00,0x3c00,0x3c008000,0x3c008000,0x3c008000,0x3c008000
.long 0x35643b88,0xb564bb88,0x36d73b3b,0xb6d7bb3b,0x3b88b564,0xbb883564,0x3b3bb6d7,0xbb3b36d7
.long 0x39133a2f,0x39133a2f,0x3a2f3913,0x3a2f3913,0x3a2fb913,0x3a2fb913,0x3913ba2f,0x3913ba2f
.long 0x3add381d,0xbaddb81d,0x3bc333c6,0xbbc3b3c6,0x381dbadd,0xb81d3add,0x33c6bbc3,0xb3c63bc3
.long 0x3bd9323e,0x3bd9323e,0x3bd9b23e,0x3bd9b23e,0x323ebbd9,0x323ebbd9,0xb23ebbd9,0xb23ebbd9
.long 0x3beab0b2,0xbbea30b2,0x3a6db8c4,0xba6d38c4,0xb0b2bbea,0x30b23bea,0xb8c4ba6d,0x38c43a6d
.long 0x3b0eb78b,0x3b0eb78b,0x378bbb0e,0x378bbb0e,0xb78bbb0e,0xb78bbb0e,0xbb0eb78b,0xbb0eb78b
.long 0x395fb9ed,0xb95f39ed,0x2a48bbfe,0xaa483bfe,0xb9edb95f,0x39ed395f,0xbbfeaa48,0x3bfe2a48
.long 0x3c00,0x3c00,0x3c00,0x3c00,0x3c008000,0x3c008000,0x3c008000,0x3c008000
.long 0x3b3b36d7,0xbb3bb6d7,0x3b883564,0xbb88b564,0x36d7bb3b,0xb6d73b3b,0x3564bb88,0xb5643b88
.long 0x3a2fb913,0x3a2fb913,0x3913ba2f,0x3913ba2f,0xb913ba2f,0xb913ba2f,0xba2fb913,0xba2fb913
.long 0xb3c6bbc3,0x33c63bc3,0xb81dbadd,0x381d3add,0xbbc333c6,0x3bc3b3c6,0xbadd381d,0x3addb81d
.long 0xbbd9b23e,0xbbd9b23e,0xbbd9323e,0xbbd9323e,0xb23e3bd9,0xb23e3bd9,0x323e3bd9,0x323e3bd9
.long 0xb8c43a6d,0x38c4ba6d,0xb0b23bea,0x30b2bbea,0x3a6d38c4,0xba6db8c4,0x3bea30b2,0xbbeab0b2
.long 0x378b3b0e,0x378b3b0e,0x3b0e378b,0x3b0e378b,0x3b0eb78b,0x3b0eb78b,0x378bbb0e,0x378bbb0e
.long 0x3bfeaa48,0xbbfe2a48,0x39edb95f,0xb9ed395f,0xaa48bbfe,0x2a483bfe,0xb95fb9ed,0x395f39ed
.long 0x3c00,0x3c00,0x3c00,0x3c00,0x3c008000,0x3c008000,0x3c008000,0x3c008000
.long 0x3b88b564,0xbb883564,0x3b3bb6d7,0xbb3b36d7,0xb564bb88,0x35643b88,0xb6d7bb3b,0x36d73b3b
.long 0xb913ba2f,0xb913ba2f,0xba2fb913,0xba2fb913,0xba2f3913,0xba2f3913,0xb9133a2f,0xb9133a2f
.long 0xb81d3add,0x381dbadd,0xb3c63bc3,0x33c6bbc3,0x3add381d,0xbaddb81d,0x3bc333c6,0xbbc3b3c6
.long 0x3bd9323e,0x3bd9323e,0x3bd9b23e,0x3bd9b23e,0x323ebbd9,0x323ebbd9,0xb23ebbd9,0xb23ebbd9
.long 0xb0b2bbea,0x30b23bea,0xb8c4ba6d,0x38c43a6d,0xbbea30b2,0x3beab0b2,0xba6d38c4,0x3a6db8c4
.long 0xbb0e378b,0xbb0e378b,0xb78b3b0e,0xb78b3b0e,0x378b3b0e,0x378b3b0e,0x3b0e378b,0x3b0e378b
.long 0x39ed395f,0xb9edb95f,0x3bfe2a48,0xbbfeaa48,0x395fb9ed,0xb95f39ed,0x2a48bbfe,0xaa483bfe
.long 0x3c00,0x3c00,0x3c00,0x3c00,0x3c008000,0x3c008000,0x3c008000,0x3c008000
.long 0x36d7bb3b,0xb6d73b3b,0x3564bb88,0xb5643b88,0xbb3bb6d7,0x3b3b36d7,0xbb88b564,0x3b883564
.long 0xba2f3913,0xba2f3913,0xb9133a2f,0xb9133a2f,0x39133a2f,0x39133a2f,0x3a2f3913,0x3a2f3913
.long 0x3bc3b3c6,0xbbc333c6,0x3addb81d,0xbadd381d,0xb3c6bbc3,0x33c63bc3,0xb81dbadd,0x381d3add
.long 0xbbd9b23e,0xbbd9b23e,0xbbd9323e,0xbbd9323e,0xb23e3bd9,0xb23e3bd9,0x323e3bd9,0x323e3bd9
.long 0x3a6d38c4,0xba6db8c4,0x3bea30b2,0xbbeab0b2,0x38c4ba6d,0xb8c43a6d,0x30b2bbea,0xb0b23bea
.long 0xb78bbb0e,0xb78bbb0e,0xbb0eb78b,0xbb0eb78b,0xbb0e378b,0xbb0e378b,0xb78b3b0e,0xb78b3b0e
.long 0x2a483bfe,0xaa48bbfe,0x395f39ed,0xb95fb9ed,0x3bfeaa48,0xbbfe2a48,0x39edb95f,0xb9ed395f
.long 0x3c00,0x3c00,0x3c00,0x3c00,0x3c00,0x3c00,0x3c00,0x3c00
.long 0x3c00,0xbc00,0x3b64,0xbb64,0x8000,0x8000,0xb61f,0x361f
.long 0x3c00,0x3c00,0x39a8,0x39a8,0x8000,0x8000,0xb9a8,0xb9a8
.long 0x3c00,0xbc00,0x361f,0xb61f,0x8000,0x8000,0xbb64,0x3b64
.long 0x3c000000,0x0,0x3bd90000,0xb23e0000,0x80000000,0xbc000000,0xb23e0000,0xbbd90000
.long 0x3c000000,0x80000000,0x3aa70000,0x38720000,0x80000000,0x3c000000,0xb8720000,0x3aa70000
.long 0x3c000000,0x0,0x38720000,0xbaa70000,0x80000000,0xbc000000,0xbaa70000,0xb8720000
.long 0x3c000000,0x80000000,0x323e0000,0x3bd90000,0x80000000,0x3c000000,0xbbd90000,0x323e0000
.long 0x3c00,0x3c00,0x3c00,0x3c00,0xbc00,0xbc00,0xbc00,0xbc00
.long 0x39a8,0xb9a8,0x361f,0xb61f,0xb9a8,0x39a8,0xbb64,0x3b64
.long 0x0,0x0,0xb9a8,0xb9a8,0xbc00,0xbc00,0xb9a8,0xb9a8
.long 0xb9a8,0x39a8,0xbb64,0x3b64,0xb9a8,0x39a8,0x361f,0xb61f
.long 0x3b640000,0xb61f0000,0x3aa70000,0xb8720000,0xb61f0000,0xbb640000,0xb8720000,0xbaa70000
.long 0x361f0000,0x3b640000,0xb23e0000,0x3bd90000,0xbb640000,0x361f0000,0xbbd90000,0xb23e0000
.long 0xb61f0000,0xbb640000,0xbbd90000,0xb23e0000,0xbb640000,0x361f0000,0xb23e0000,0x3bd90000
.long 0xbb640000,0x361f0000,0xb8720000,0xbaa70000,0xb61f0000,0xbb640000,0x3aa70000,0xb8720000
.long 0x3c00,0x3c00,0x3c00,0x3c00,0x3c00,0x3c00,0x3c00,0x3c00
.long 0x0,0x8000,0xb61f,0x361f,0xbc00,0x3c00,0xbb64,0x3b64
.long 0xbc00,0xbc00,0xb9a8,0xb9a8,0x8000,0x8000,0x39a8,0x39a8
.long 0x8000,0x0,0x3b64,0xbb64,0x3c00,0xbc00,0x361f,0xb61f
.long 0x39a80000,0xb9a80000,0x38720000,0xbaa70000,0xb9a80000,0xb9a80000,0xbaa70000,0xb8720000
.long 0xb9a80000,0x39a80000,0xbbd90000,0x323e0000,0xb9a80000,0xb9a80000,0xb23e0000,0xbbd90000
.long 0xb9a80000,0x39a80000,0x323e0000,0x3bd90000,0x39a80000,0x39a80000,0x3bd90000,0xb23e0000
.long 0x39a80000,0xb9a80000,0x3aa70000,0x38720000,0x39a80000,0x39a80000,0xb8720000,0x3aa70000
.long 0x3c00,0x3c00,0x3c00,0x3c00,0xbc00,0xbc00,0xbc00,0xbc00
.long 0xb9a8,0x39a8,0xbb64,0x3b64,0xb9a8,0x39a8,0xb61f,0x361f
.long 0x8000,0x8000,0x39a8,0x39a8,0x3c00,0x3c00,0x39a8,0x39a8
.long 0x39a8,0xb9a8,0xb61f,0x361f,0xb9a8,0x39a8,0xbb64,0x3b64
.long 0x361f0000,0xbb640000,0x323e0000,0xbbd90000,0xbb640000,0xb61f0000,0xbbd90000,0xb23e0000
.long 0xbb640000,0xb61f0000,0xb8720000,0xbaa70000,0x361f0000,0xbb640000,0x3aa70000,0xb8720000
.long 0x3b640000,0x361f0000,0x3aa70000,0xb8720000,0x361f0000,0xbb640000,0xb8720000,0xbaa70000
.long 0xb61f0000,0x3b640000,0xbbd90000,0xb23e0000,0xbb640000,0xb61f0000,0x323e0000,0xbbd90000
.long 0x3c00,0x3c00,0x3c00,0x3c00,0x3c00,0x3c00,0x3c00,0x3c00
.long 0x3bfe,0xbbfe,0x39ed,0xb9ed,0xaa48,0x2a48,0xb95f,0x395f
.long 0x3bf6,0x3bf6,0x2e46,0x2e46,0xae46,0xae46,0xbbf6,0xbbf6
.long 0x3bea,0xbbea,0xb8c4,0x38c4,0xb0b2,0x30b2,0xba6d,0x3a6d
.long 0x3bff0000,0xa6480000,0x3b770000,0xb5c20000,0xa6480000,0xbbff0000,0xb5c20000,0xbb770000
.long 0x3bfa0000,0x2cb50000,0x37320000,0x3b250000,0xacb50000,0x3bfa0000,0xbb250000,0x37320000
.long 0x3bf10000,0xafd60000,0xb4440000,0xbbb60000,0xafd60000,0xbbf10000,0xbbb60000,0x34440000
.long 0x3be20000,0x31790000,0xbac20000,0x38480000,0xb1790000,0x3be20000,0xb8480000,0xbac20000
.long 0x3c00,0x3c00,0x3c00,0x3c00,0xbc00,0xbc00,0xbc00,0xbc00
.long 0x395f,0xb95f,0x2a48,0xaa48,0xb9ed,0x39ed,0xbbfe,0x3bfe
.long 0xae46,0xae46,0xbbf6,0xbbf6,0xbbf6,0xbbf6,0xae46,0xae46
.long 0xba6d,0x3a6d,0xb0b2,0x30b2,0xb8c4,0x38c4,0x3bea,0xbbea
.long 0x3b500000,0xb67c0000,0x39cb0000,0xb9840000,0xb67c0000,0xbb500000,0xb9840000,0xb9cb0000
.long 0x35050000,0x3b990000,0xb93a0000,0x3a0f0000,0xbb990000,0x35050000,0xba0f0000,0xb93a0000
.long 0xb7e30000,0xbaf60000,0xba4f0000,0x38ec0000,0xbaf60000,0x37e30000,0x38ec0000,0x3a4f0000
.long 0xbbce0000,0x33030000,0x389b0000,0xba8a0000,0xb3030000,0xbbce0000,0x3a8a0000,0x389b0000
.long 0x3c00,0x3c00,0x3c00,0x3c00,0x3c00,0x3c00,0x3c00,0x3c00
.long 0xaa48,0x2a48,0xb95f,0x395f,0xbbfe,0x3bfe,0xb9ed,0x39ed
.long 0xbbf6,0xbbf6,0xae46,0xae46,0x2e46,0x2e46,0x3bf6,0x3bf6
.long 0x30b2,0xb0b2,0x3a6d,0xba6d,0x3bea,0xbbea,0xb8c4,0x38c4
.long 0x39840000,0xb9cb0000,0x367c0000,0xbb500000,0xb9cb0000,0xb9840000,0xbb500000,0xb67c0000
.long 0xba0f0000,0x393a0000,0xbb990000,0xb5050000,0xb93a0000,0xba0f0000,0x35050000,0xbb990000
.long 0xb8ec0000,0x3a4f0000,0x3af60000,0x37e30000,0x3a4f0000,0x38ec0000,0x37e30000,0xbaf60000
.long 0x3a8a0000,0xb89b0000,0xb3030000,0x3bce0000,0x389b0000,0x3a8a0000,0xbbce0000,0xb3030000
.long 0x3c00,0x3c00,0x3c00,0x3c00,0xbc00,0xbc00,0xbc00,0xbc00
.long 0xb9ed,0x39ed,0xbbfe,0x3bfe,0xb95f,0x395f,0xaa48,0x2a48
.long 0x2e46,0x2e46,0x3bf6,0x3bf6,0x3bf6,0x3bf6,0x2e46,0x2e46
.long 0x38c4,0xb8c4,0xbbea,0x3bea,0xba6d,0x3a6d,0xb0b2,0x30b2
.long 0x35c20000,0xbb770000,0x26480000,0xbbff0000,0xbb770000,0xb5c20000,0xbbff0000,0xa6480000
.long 0xbb250000,0xb7320000,0xacb50000,0xbbfa0000,0x37320000,0xbb250000,0x3bfa0000,0xacb50000
.long 0x3bb60000,0x34440000,0x2fd60000,0xbbf10000,0x34440000,0xbbb60000,0xbbf10000,0xafd60000
.long 0xb8480000,0x3ac20000,0xb1790000,0xbbe20000,0xbac20000,0xb8480000,0x3be20000,0xb1790000
.long 0x3c00,0x3c00,0x3c00,0x3c00,0x3c00,0x3c00,0x3c00,0x3c00
.long 0x3bf6,0xbbf6,0x3a2f,0xba2f,0xae46,0x2e46,0xb913,0x3913
.long 0x3bd9,0x3bd9,0x323e,0x323e,0xb23e,0xb23e,0xbbd9,0xbbd9
.long 0x3ba8,0xbba8,0xb78b,0x378b,0xb4a5,0x34a5,0xbb0e,0x3b0e
.long 0x3bfe0000,0xaa480000,0x3b880000,0xb5640000,0xaa480000,0xbbfe0000,0xb5640000,0xbb880000
.long 0x3bea0000,0x30b20000,0x381d0000,0x3add0000,0xb0b20000,0x3bea0000,0xbadd0000,0x381d0000
.long 0x3bc30000,0xb3c60000,0xb0b20000,0xbbea0000,0xb3c60000,0xbbc30000,0xbbea0000,0x30b20000
.long 0x3b880000,0x35640000,0xb9ed0000,0x395f0000,0xb5640000,0x3b880000,0xb95f0000,0xb9ed0000
.long 0x3c00,0x3c00,0x3c00,0x3c00,0xbc00,0xbc00,0xbc00,0xbc00
.long 0x3913,0xb913,0x2e46,0xae46,0xba2f,0x3a2f,0xbbf6,0x3bf6
.long 0xb23e,0xb23e,0xbbd9,0xbbd9,0xbbd9,0xbbd9,0xb23e,0xb23e
.long 0xbb0e,0x3b0e,0xb4a5,0x34a5,0xb78b,0x378b,0x3ba8,0xbba8
.long 0x3b3b0000,0xb6d70000,0x39ed0000,0xb95f0000,0xb6d70000,0xbb3b0000,0xb95f0000,0xb9ed0000
.long 0x33c60000,0x3bc30000,0xb8c40000,0x3a6d0000,0xbbc30000,0x33c60000,0xba6d0000,0xb8c40000
.long 0xb8c40000,0xba6d0000,0xbadd0000,0x381d0000,0xba6d0000,0x38c40000,0x381d0000,0x3add0000
.long 0xbbfe0000,0x2a480000,0x36d70000,0xbb3b0000,0xaa480000,0xbbfe0000,0x3b3b0000,0x36d70000
.long 0x3c00,0x3c00,0x3c00,0x3c00,0x3c00,0x3c00,0x3c00,0x3c00
.long 0xae46,0x2e46,0xb913,0x3913,0xbbf6,0x3bf6,0xba2f,0x3a2f
.long 0xbbd9,0xbbd9,0xb23e,0xb23e,0x323e,0x323e,0x3bd9,0x3bd9
.long 0x34a5,0xb4a5,0x3b0e,0xbb0e,0x3ba8,0xbba8,0xb78b,0x378b
.long 0x395f0000,0xb9ed0000,0x36d70000,0xbb3b0000,0xb9ed0000,0xb95f0000,0xbb3b0000,0xb6d70000
.long 0xba6d0000,0x38c40000,0xbbc30000,0xb3c60000,0xb8c40000,0xba6d0000,0x33c60000,0xbbc30000
.long 0xb81d0000,0x3add0000,0x3a6d0000,0x38c40000,0x3add0000,0x381d0000,0x38c40000,0xba6d0000
.long 0x3b3b0000,0xb6d70000,0xaa480000,0x3bfe0000,0x36d70000,0x3b3b0000,0xbbfe0000,0xaa480000
.long 0x3c00,0x3c00,0x3c00,0x3c00,0xbc00,0xbc00,0xbc00,0xbc00
.long 0xba2f,0x3a2f,0xbbf6,0x3bf6,0xb913,0x3913,0xae46,0x2e46
.long 0x323e,0x323e,0x3bd9,0x3bd9,0x3bd9,0x3bd9,0x323e,0x323e
.long 0x378b,0xb78b,0xbba8,0x3ba8,0xbb0e,0x3b0e,0xb4a5,0x34a5
.long 0x35640000,0xbb880000,0x2a480000,0xbbfe0000,0xbb880000,0xb5640000,0xbbfe0000,0xaa480000
.long 0xbadd0000,0xb81d0000,0xb0b20000,0xbbea0000,0x381d0000,0xbadd0000,0x3bea0000,0xb0b20000
.long 0x3bea0000,0x30b20000,0x33c60000,0xbbc30000,0x30b20000,0xbbea0000,0xbbc30000,0xb3c60000
.long 0xb95f0000,0x39ed0000,0xb5640000,0xbb880000,0xb9ed0000,0xb95f0000,0x3b880000,0xb5640000
.long 0x3c00,0x3c00,0x3c00,0x3c00,0x3c00,0x3c00,0x3c00,0x3c00
.long 0x3bea,0xbbea,0x3a6d,0xba6d,0xb0b2,0x30b2,0xb8c4,0x38c4
.long 0x3ba8,0x3ba8,0x34a5,0x34a5,0xb4a5,0xb4a5,0xbba8,0xbba8
.long 0x3b3b,0xbb3b,0xb564,0x3564,0xb6d7,0x36d7,0xbb88,0x3b88
.long 0x3bfa0000,0xacb50000,0x3b990000,0xb5050000,0xacb50000,0xbbfa0000,0xb5050000,0xbb990000
.long 0x3bce0000,0x33030000,0x389b0000,0x3a8a0000,0xb3030000,0x3bce0000,0xba8a0000,0x389b0000
.long 0x3b770000,0xb5c20000,0xa6480000,0xbbff0000,0xb5c20000,0xbb770000,0xbbff0000,0x26480000
.long 0x3af60000,0x37e30000,0xb8ec0000,0x3a4f0000,0xb7e30000,0x3af60000,0xba4f0000,0xb8ec0000
.long 0x3c00,0x3c00,0x3c00,0x3c00,0xbc00,0xbc00,0xbc00,0xbc00
.long 0x38c4,0xb8c4,0x30b2,0xb0b2,0xba6d,0x3a6d,0xbbea,0x3bea
.long 0xb4a5,0xb4a5,0xbba8,0xbba8,0xbba8,0xbba8,0xb4a5,0xb4a5
.long 0xbb88,0x3b88,0xb6d7,0x36d7,0xb564,0x3564,0x3b3b,0xbb3b
.long 0x3b250000,0xb7320000,0x3a0f0000,0xb93a0000,0xb7320000,0xbb250000,0xb93a0000,0xba0f0000
.long 0x31790000,0x3be20000,0xb8480000,0x3ac20000,0xbbe20000,0x31790000,0xbac20000,0xb8480000
.long 0xb9840000,0xb9cb0000,0xbb500000,0x367c0000,0xb9cb0000,0x39840000,0x367c0000,0x3b500000
.long 0xbbf10000,0xafd60000,0x34440000,0xbbb60000,0x2fd60000,0xbbf10000,0x3bb60000,0x34440000
.long 0x3c00,0x3c00,0x3c00,0x3c00,0x3c00,0x3c00,0x3c00,0x3c00
.long 0xb0b2,0x30b2,0xb8c4,0x38c4,0xbbea,0x3bea,0xba6d,0x3a6d
.long 0xbba8,0xbba8,0xb4a5,0xb4a5,0x34a5,0x34a5,0x3ba8,0x3ba8
.long 0x36d7,0xb6d7,0x3b88,0xbb88,0x3b3b,0xbb3b,0xb564,0x3564
.long 0x393a0000,0xba0f0000,0x37320000,0xbb250000,0xba0f0000,0xb93a0000,0xbb250000,0xb7320000
.long 0xbac20000,0x38480000,0xbbe20000,0xb1790000,0xb8480000,0xbac20000,0x31790000,0xbbe20000
.long 0xb67c0000,0x3b500000,0x39cb0000,0x39840000,0x3b500000,0x367c0000,0x39840000,0xb9cb0000
.long 0x3bb60000,0xb4440000,0x2fd60000,0x3bf10000,0x34440000,0x3bb60000,0xbbf10000,0x2fd60000
.long 0x3c00,0x3c00,0x3c00,0x3c00,0xbc00,0xbc00,0xbc00,0xbc00
.long 0xba6d,0x3a6d,0xbbea,0x3bea,0xb8c4,0x38c4,0xb0b2,0x30b2
.long 0x34a5,0x34a5,0x3ba8,0x3ba8,0x3ba8,0x3ba8,0x34a5,0x34a5
.long 0x3564,0xb564,0xbb3b,0x3b3b,0xbb88,0x3b88,0xb6d7,0x36d7
.long 0x35050000,0xbb990000,0x2cb50000,0xbbfa0000,0xbb990000,0xb5050000,0xbbfa0000,0xacb50000
.long 0xba8a0000,0xb89b0000,0xb3030000,0xbbce0000,0x389b0000,0xba8a0000,0x3bce0000,0xb3030000
.long 0x3bff0000,0x26480000,0x35c20000,0xbb770000,0x26480000,0xbbff0000,0xbb770000,0xb5c20000
.long 0xba4f0000,0x38ec0000,0xb7e30000,0xbaf60000,0xb8ec0000,0xba4f0000,0x3af60000,0xb7e30000
.long 0x3c00,0x3c00,0x3c00,0x3c00,0x3c00,0x3c00,0x3c00,0x3c00
.long 0x3bd9,0xbbd9,0x3aa7,0xbaa7,0xb23e,0x323e,0xb872,0x3872
.long 0x3b64,0x3b64,0x361f,0x361f,0xb61f,0xb61f,0xbb64,0xbb64
.long 0x3aa7,0xbaa7,0xb23e,0x323e,0xb872,0x3872,0xbbd9,0x3bd9
.long 0x3bf60000,0xae460000,0x3ba80000,0xb4a50000,0xae460000,0xbbf60000,0xb4a50000,0xbba80000
.long 0x3ba80000,0x34a50000,0x39130000,0x3a2f0000,0xb4a50000,0x3ba80000,0xba2f0000,0x39130000
.long 0x3b0e0000,0xb78b0000,0x2e460000,0xbbf60000,0xb78b0000,0xbb0e0000,0xbbf60000,0xae460000
.long 0x3a2f0000,0x39130000,0xb78b0000,0x3b0e0000,0xb9130000,0x3a2f0000,0xbb0e0000,0xb78b0000
.long 0x3c00,0x3c00,0x3c00,0x3c00,0xbc00,0xbc00,0xbc00,0xbc00
.long 0x3872,0xb872,0x323e,0xb23e,0xbaa7,0x3aa7,0xbbd9,0x3bd9
.long 0xb61f,0xb61f,0xbb64,0xbb64,0xbb64,0xbb64,0xb61f,0xb61f
.long 0xbbd9,0x3bd9,0xb872,0x3872,0xb23e,0x323e,0x3aa7,0xbaa7
.long 0x3b0e0000,0xb78b0000,0x3a2f0000,0xb9130000,0xb78b0000,0xbb0e0000,0xb9130000,0xba2f0000
.long 0x2e460000,0x3bf60000,0xb78b0000,0x3b0e0000,0xbbf60000,0x2e460000,0xbb0e0000,0xb78b0000
.long 0xba2f0000,0xb9130000,0xbba80000,0x34a50000,0xb9130000,0x3a2f0000,0x34a50000,0x3ba80000
.long 0xbba80000,0xb4a50000,0x2e460000,0xbbf60000,0x34a50000,0xbba80000,0x3bf60000,0x2e460000
.long 0x3c00,0x3c00,0x3c00,0x3c00,0x3c00,0x3c00,0x3c00,0x3c00
.long 0xb23e,0x323e,0xb872,0x3872,0xbbd9,0x3bd9,0xbaa7,0x3aa7
.long 0xbb64,0xbb64,0xb61f,0xb61f,0x361f,0x361f,0x3b64,0x3b64
.long 0x3872,0xb872,0x3bd9,0xbbd9,0x3aa7,0xbaa7,0xb23e,0x323e
.long 0x39130000,0xba2f0000,0x378b0000,0xbb0e0000,0xba2f0000,0xb9130000,0xbb0e0000,0xb78b0000
.long 0xbb0e0000,0x378b0000,0xbbf60000,0xae460000,0xb78b0000,0xbb0e0000,0x2e460000,0xbbf60000
.long 0xb4a50000,0x3ba80000,0x39130000,0x3a2f0000,0x3ba80000,0x34a50000,0x3a2f0000,0xb9130000
.long 0x3bf60000,0xae460000,0x34a50000,0x3ba80000,0x2e460000,0x3bf60000,0xbba80000,0x34a50000
.long 0x3c00,0x3c00,0x3c00,0x3c00,0xbc00,0xbc00,0xbc00,0xbc00
.long 0xbaa7,0x3aa7,0xbbd9,0x3bd9,0xb872,0x3872,0xb23e,0x323e
.long 0x361f,0x361f,0x3b64,0x3b64,0x3b64,0x3b64,0x361f,0x361f
.long 0x323e,0xb23e,0xbaa7,0x3aa7,0xbbd9,0x3bd9,0xb872,0x3872
.long 0x34a50000,0xbba80000,0x2e460000,0xbbf60000,0xbba80000,0xb4a50000,0xbbf60000,0xae460000
.long 0xba2f0000,0xb9130000,0xb4a50000,0xbba80000,0x39130000,0xba2f0000,0x3ba80000,0xb4a50000
.long 0x3bf60000,0xae460000,0x378b0000,0xbb0e0000,0xae460000,0xbbf60000,0xbb0e0000,0xb78b0000
.long 0xbb0e0000,0x378b0000,0xb9130000,0xba2f0000,0xb78b0000,0xbb0e0000,0x3a2f0000,0xb9130000
.long 0x3c00,0x3c00,0x3c00,0x3c00,0x3c00,0x3c00,0x3c00,0x3c00
.long 0x3bc3,0xbbc3,0x3add,0xbadd,0xb3c6,0x33c6,0xb81d,0x381d
.long 0x3b0e,0x3b0e,0x378b,0x378b,0xb78b,0xb78b,0xbb0e,0xbb0e
.long 0x39ed,0xb9ed,0xaa48,0x2a48,0xb95f,0x395f,0xbbfe,0x3bfe
.long 0x3bf10000,0xafd60000,0x3bb60000,0xb4440000,0xafd60000,0xbbf10000,0xb4440000,0xbbb60000
.long 0x3b770000,0x35c20000,0x39840000,0x39cb0000,0xb5c20000,0x3b770000,0xb9cb0000,0x39840000
.long 0x3a8a0000,0xb89b0000,0x33030000,0xbbce0000,0xb89b0000,0xba8a0000,0xbbce0000,0xb3030000
.long 0x393a0000,0x3a0f0000,0xb5050000,0x3b990000,0xba0f0000,0x393a0000,0xbb990000,0xb5050000
.long 0x3c00,0x3c00,0x3c00,0x3c00,0xbc00,0xbc00,0xbc00,0xbc00
.long 0x381d,0xb81d,0x33c6,0xb3c6,0xbadd,0x3add,0xbbc3,0x3bc3
.long 0xb78b,0xb78b,0xbb0e,0xbb0e,0xbb0e,0xbb0e,0xb78b,0xb78b
.long 0xbbfe,0x3bfe,0xb95f,0x395f,0xaa48,0x2a48,0x39ed,0xb9ed
.long 0x3af60000,0xb7e30000,0x3a4f0000,0xb8ec0000,0xb7e30000,0xbaf60000,0xb8ec0000,0xba4f0000
.long 0x26480000,0x3bff0000,0xb67c0000,0x3b500000,0xbbff0000,0x26480000,0xbb500000,0xb67c0000
.long 0xbac20000,0xb8480000,0xbbe20000,0x31790000,0xb8480000,0x3ac20000,0x31790000,0x3be20000
.long 0xbb250000,0xb7320000,0xacb50000,0xbbfa0000,0x37320000,0xbb250000,0x3bfa0000,0xacb50000
.long 0x3c00,0x3c00,0x3c00,0x3c00,0x3c00,0x3c00,0x3c00,0x3c00
.long 0xb3c6,0x33c6,0xb81d,0x381d,0xbbc3,0x3bc3,0xbadd,0x3add
.long 0xbb0e,0xbb0e,0xb78b,0xb78b,0x378b,0x378b,0x3b0e,0x3b0e
.long 0x395f,0xb95f,0x3bfe,0xbbfe,0x39ed,0xb9ed,0xaa48,0x2a48
.long 0x38ec0000,0xba4f0000,0x37e30000,0xbaf60000,0xba4f0000,0xb8ec0000,0xbaf60000,0xb7e30000
.long 0xbb500000,0x367c0000,0xbbff0000,0xa6480000,0xb67c0000,0xbb500000,0x26480000,0xbbff0000
.long 0xb1790000,0x3be20000,0x38480000,0x3ac20000,0x3be20000,0x31790000,0x3ac20000,0xb8480000
.long 0x3bfa0000,0x2cb50000,0x37320000,0x3b250000,0xacb50000,0x3bfa0000,0xbb250000,0x37320000
.long 0x3c00,0x3c00,0x3c00,0x3c00,0xbc00,0xbc00,0xbc00,0xbc00
.long 0xbadd,0x3add,0xbbc3,0x3bc3,0xb81d,0x381d,0xb3c6,0x33c6
.long 0x378b,0x378b,0x3b0e,0x3b0e,0x3b0e,0x3b0e,0x378b,0x378b
.long 0x2a48,0xaa48,0xb9ed,0x39ed,0xbbfe,0x3bfe,0xb95f,0x395f
.long 0x34440000,0xbbb60000,0x2fd60000,0xbbf10000,0xbbb60000,0xb4440000,0xbbf10000,0xafd60000
.long 0xb9cb0000,0xb9840000,0xb5c20000,0xbb770000,0x39840000,0xb9cb0000,0x3b770000,0xb5c20000
.long 0x3bce0000,0xb3030000,0x389b0000,0xba8a0000,0xb3030000,0xbbce0000,0xba8a0000,0xb89b0000
.long 0xbb990000,0x35050000,0xba0f0000,0xb93a0000,0xb5050000,0xbb990000,0x393a0000,0xba0f0000
.long 0x3c00,0x3c00,0x3c00,0x3c00,0x3c00,0x3c00,0x3c00,0x3c00
.long 0x3ba8,0xbba8,0x3b0e,0xbb0e,0xb4a5,0x34a5,0xb78b,0x378b
.long 0x3aa7,0x3aa7,0x3872,0x3872,0xb872,0xb872,0xbaa7,0xbaa7
.long 0x3913,0xb913,0x2e46,0xae46,0xba2f,0x3a2f,0xbbf6,0x3bf6
.long 0x3bea0000,0xb0b20000,0x3bc30000,0xb3c60000,0xb0b20000,0xbbea0000,0xb3c60000,0xbbc30000
.long 0x3b3b0000,0x36d70000,0x39ed0000,0x395f0000,0xb6d70000,0x3b3b0000,0xb95f0000,0x39ed0000
.long 0x39ed0000,0xb95f0000,0x35640000,0xbb880000,0xb95f0000,0xb9ed0000,0xbb880000,0xb5640000
.long 0x381d0000,0x3add0000,0xb0b20000,0x3bea0000,0xbadd0000,0x381d0000,0xbbea0000,0xb0b20000
.long 0x3c00,0x3c00,0x3c00,0x3c00,0xbc00,0xbc00,0xbc00,0xbc00
.long 0x378b,0xb78b,0x34a5,0xb4a5,0xbb0e,0x3b0e,0xbba8,0x3ba8
.long 0xb872,0xb872,0xbaa7,0xbaa7,0xbaa7,0xbaa7,0xb872,0xb872
.long 0xbbf6,0x3bf6,0xba2f,0x3a2f,0x2e46,0xae46,0x3913,0xb913
.long 0x3add0000,0xb81d0000,0x3a6d0000,0xb8c40000,0xb81d0000,0xbadd0000,0xb8c40000,0xba6d0000
.long 0xaa480000,0x3bfe0000,0xb5640000,0x3b880000,0xbbfe0000,0xaa480000,0xbb880000,0xb5640000
.long 0xbb3b0000,0xb6d70000,0xbbfe0000,0x2a480000,0xb6d70000,0x3b3b0000,0x2a480000,0x3bfe0000
.long 0xba6d0000,0xb8c40000,0xb3c60000,0xbbc30000,0x38c40000,0xba6d0000,0x3bc30000,0xb3c60000
.long 0x3c00,0x3c00,0x3c00,0x3c00,0x3c00,0x3c00,0x3c00,0x3c00
.long 0xb4a5,0x34a5,0xb78b,0x378b,0xbba8,0x3ba8,0xbb0e,0x3b0e
.long 0xbaa7,0xbaa7,0xb872,0xb872,0x3872,0x3872,0x3aa7,0x3aa7
.long 0x3a2f,0xba2f,0x3bf6,0xbbf6,0x3913,0xb913,0x2e46,0xae46
.long 0x38c40000,0xba6d0000,0x381d0000,0xbadd0000,0xba6d0000,0xb8c40000,0xbadd0000,0xb81d0000
.long 0xbb880000,0x35640000,0xbbfe0000,0x2a480000,0xb5640000,0xbb880000,0xaa480000,0xbbfe0000
.long 0xaa480000,0x3bfe0000,0x36d70000,0x3b3b0000,0x3bfe0000,0x2a480000,0x3b3b0000,0xb6d70000
.long 0x3bc30000,0x33c60000,0x38c40000,0x3a6d0000,0xb3c60000,0x3bc30000,0xba6d0000,0x38c40000
.long 0x3c00,0x3c00,0x3c00,0x3c00,0xbc00,0xbc00,0xbc00,0xbc00
.long 0xbb0e,0x3b0e,0xbba8,0x3ba8,0xb78b,0x378b,0xb4a5,0x34a5
.long 0x3872,0x3872,0x3aa7,0x3aa7,0x3aa7,0x3aa7,0x3872,0x3872
.long 0xae46,0x2e46,0xb913,0x3913,0xbbf6,0x3bf6,0xba2f,0x3a2f
.long 0x33c60000,0xbbc30000,0x30b20000,0xbbea0000,0xbbc30000,0xb3c60000,0xbbea0000,0xb0b20000
.long 0xb95f0000,0xb9ed0000,0xb6d70000,0xbb3b0000,0x39ed0000,0xb95f0000,0x3b3b0000,0xb6d70000
.long 0x3b880000,0xb5640000,0x395f0000,0xb9ed0000,0xb5640000,0xbb880000,0xb9ed0000,0xb95f0000
.long 0xbbea0000,0x30b20000,0xbadd0000,0xb81d0000,0xb0b20000,0xbbea0000,0x381d0000,0xbadd0000
.long 0x3c00,0x3c00,0x3c00,0x3c00,0x3c00,0x3c00,0x3c00,0x3c00
.long 0x3b88,0xbb88,0x3b3b,0xbb3b,0xb564,0x3564,0xb6d7,0x36d7
.long 0x3a2f,0x3a2f,0x3913,0x3913,0xb913,0xb913,0xba2f,0xba2f
.long 0x381d,0xb81d,0x33c6,0xb3c6,0xbadd,0x3add,0xbbc3,0x3bc3
.long 0x3be20000,0xb1790000,0x3bce0000,0xb3030000,0xb1790000,0xbbe20000,0xb3030000,0xbbce0000
.long 0x3af60000,0x37e30000,0x3a4f0000,0x38ec0000,0xb7e30000,0x3af60000,0xb8ec0000,0x3a4f0000
.long 0x393a0000,0xba0f0000,0x37320000,0xbb250000,0xba0f0000,0xb93a0000,0xbb250000,0xb7320000
.long 0x35c20000,0x3b770000,0x26480000,0x3bff0000,0xbb770000,0x35c20000,0xbbff0000,0x26480000
.long 0x3c00,0x3c00,0x3c00,0x3c00,0xbc00,0xbc00,0xbc00,0xbc00
.long 0x36d7,0xb6d7,0x3564,0xb564,0xbb3b,0x3b3b,0xbb88,0x3b88
.long 0xb913,0xb913,0xba2f,0xba2f,0xba2f,0xba2f,0xb913,0xb913
.long 0xbbc3,0x3bc3,0xbadd,0x3add,0x33c6,0xb3c6,0x381d,0xb81d
.long 0x3ac20000,0xb8480000,0x3a8a0000,0xb89b0000,0xb8480000,0xbac20000,0xb89b0000,0xba8a0000
.long 0xafd60000,0x3bf10000,0xb4440000,0x3bb60000,0xbbf10000,0xafd60000,0xbbb60000,0xb4440000
.long 0xbb990000,0xb5050000,0xbbfa0000,0xacb50000,0xb5050000,0x3b990000,0xacb50000,0x3bfa0000
.long 0xb9840000,0xb9cb0000,0xb67c0000,0xbb500000,0x39cb0000,0xb9840000,0x3b500000,0xb67c0000
.long 0x3c00,0x3c00,0x3c00,0x3c00,0x3c00,0x3c00,0x3c00,0x3c00
.long 0xb564,0x3564,0xb6d7,0x36d7,0xbb88,0x3b88,0xbb3b,0x3b3b
.long 0xba2f,0xba2f,0xb913,0xb913,0x3913,0x3913,0x3a2f,0x3a2f
.long 0x3add,0xbadd,0x3bc3,0xbbc3,0x381d,0xb81d,0x33c6,0xb3c6
.long 0x389b0000,0xba8a0000,0x38480000,0xbac20000,0xba8a0000,0xb89b0000,0xbac20000,0xb8480000
.long 0xbbb60000,0x34440000,0xbbf10000,0x2fd60000,0xb4440000,0xbbb60000,0xafd60000,0xbbf10000
.long 0x2cb50000,0x3bfa0000,0x35050000,0x3b990000,0x3bfa0000,0xacb50000,0x3b990000,0xb5050000
.long 0x3b500000,0x367c0000,0x39cb0000,0x39840000,0xb67c0000,0x3b500000,0xb9840000,0x39cb0000
.long 0x3c00,0x3c00,0x3c00,0x3c00,0xbc00,0xbc00,0xbc00,0xbc00
.long 0xbb3b,0x3b3b,0xbb88,0x3b88,0xb6d7,0x36d7,0xb564,0x3564
.long 0x3913,0x3913,0x3a2f,0x3a2f,0x3a2f,0x3a2f,0x3913,0x3913
.long 0xb3c6,0x33c6,0xb81d,0x381d,0xbbc3,0x3bc3,0xbadd,0x3add
.long 0x33030000,0xbbce0000,0x31790000,0xbbe20000,0xbbce0000,0xb3030000,0xbbe20000,0xb1790000
.long 0xb8ec0000,0xba4f0000,0xb7e30000,0xbaf60000,0x3a4f0000,0xb8ec0000,0x3af60000,0xb7e30000
.long 0x3b250000,0xb7320000,0x3a0f0000,0xb93a0000,0xb7320000,0xbb250000,0xb93a0000,0xba0f0000
.long 0xbbff0000,0xa6480000,0xbb770000,0xb5c20000,0x26480000,0xbbff0000,0x35c20000,0xbb770000
.long 0x3c00,0x3c00,0x3c00,0x3c00,0x3c00,0xbc00,0x361f3b64,0xb61f3b64
.long 0x3c00,0x3c00,0x39a839a8,0xb9a839a8,0x3c00,0xbc00,0x3b64361f,0xbb64361f
.long 0x3c00,0x3c00,0x3c000000,0xbc008000,0x3c00,0xbc00,0x3b64b61f,0xbb64b61f
.long 0x3c00,0x3c00,0x39a8b9a8,0xb9a8b9a8,0x3c00,0xbc00,0x361fbb64,0xb61fbb64
.long 0x3c00,0x3c00,0xbc00,0xbc00,0x3c00,0xbc00,0xb61fbb64,0x361fbb64
.long 0x3c00,0x3c00,0xb9a8b9a8,0x39a8b9a8,0x3c00,0xbc00,0xbb64b61f,0x3b64b61f
.long 0x3c00,0x3c00,0xbc008000,0x3c000000,0x3c00,0xbc00,0xbb64361f,0x3b64361f
.long 0x3c00,0x3c00,0xb9a839a8,0x39a839a8,0x3c00,0xbc00,0xb61f3b64,0x361f3b64
.long 0x3c00,0x3c00,0x3c00,0x3c00,0x39a839a8,0xb9a839a8,0x3b64361f,0xbb64361f
.long 0x3c000000,0xbc008000,0x39a8b9a8,0xb9a8b9a8,0x39a8b9a8,0xb9a8b9a8,0xb61fbb64,0x361fbb64
.long 0xbc00,0xbc00,0xbc008000,0x3c000000,0xb9a8b9a8,0x39a8b9a8,0xb61f3b64,0x361f3b64
.long 0xbc008000,0x3c000000,0x39a839a8,0xb9a839a8,0xb9a839a8,0x39a839a8,0x3b64b61f,0xbb64b61f
.long 0x3c00,0x3c00,0xbc00,0xbc00,0x39a839a8,0xb9a839a8,0xbb64b61f,0x3b64b61f
.long 0x3c000000,0xbc008000,0xb9a839a8,0x39a839a8,0x39a8b9a8,0xb9a8b9a8,0x361f3b64,0xb61f3b64
.long 0xbc00,0xbc00,0x3c000000,0xbc008000,0xb9a8b9a8,0x39a8b9a8,0x361fbb64,0xb61fbb64
.long 0xbc008000,0x3c000000,0xb9a8b9a8,0x39a8b9a8,0xb9a839a8,0x39a839a8,0xbb64361f,0x3b64361f
.long 0x3c00,0x3c00,0x3c00,0x3c00,0x3c000000,0xbc008000,0x3b64b61f,0xbb64b61f
.long 0xbc00,0xbc00,0xb9a8b9a8,0x39a8b9a8,0xbc008000,0x3c000000,0xb61f3b64,0x361f3b64
.long 0x3c00,0x3c00,0x3c000000,0xbc008000,0x3c000000,0xbc008000,0xb61fbb64,0x361fbb64
.long 0xbc00,0xbc00,0xb9a839a8,0x39a839a8,0xbc008000,0x3c000000,0x3b64361f,0xbb64361f
.long 0x3c00,0x3c00,0xbc00,0xbc00,0x3c000000,0xbc008000,0xbb64361f,0x3b64361f
.long 0xbc00,0xbc00,0x39a839a8,0xb9a839a8,0xbc008000,0x3c000000,0x361fbb64,0xb61fbb64
.long 0x3c00,0x3c00,0xbc008000,0x3c000000,0x3c000000,0xbc008000,0x361f3b64,0xb61f3b64
.long 0xbc00,0xbc00,0x39a8b9a8,0xb9a8b9a8,0xbc008000,0x3c000000,0xbb64b61f,0x3b64b61f
.long 0x3c00,0x3c00,0x3c00,0x3c00,0x39a8b9a8,0xb9a8b9a8,0x361fbb64,0xb61fbb64
.long 0xbc008000,0x3c000000,0xb9a839a8,0x39a839a8,0x39a839a8,0xb9a839a8,0x3b64b61f,0xbb64b61f
.long 0xbc00,0xbc00,0xbc008000,0x3c000000,0xb9a839a8,0x39a839a8,0x3b64361f,0xbb64361f
.long 0x3c000000,0xbc008000,0xb9a8b9a8,0x39a8b9a8,0xb9a8b9a8,0x39a8b9a8,0x361f3b64,0xb61f3b64
.long 0x3c00,0x3c00,0xbc00,0xbc00,0x39a8b9a8,0xb9a8b9a8,0xb61f3b64,0x361f3b64
.long 0xbc008000,0x3c000000,0x39a8b9a8,0xb9a8b9a8,0x39a839a8,0xb9a839a8,0xbb64361f,0x3b64361f
.long 0xbc00,0xbc00,0x3c000000,0xbc008000,0xb9a839a8,0x39a839a8,0xbb64b61f,0x3b64b61f
.long 0x3c000000,0xbc008000,0x39a839a8,0xb9a839a8,0xb9a8b9a8,0x39a8b9a8,0xb61fbb64,0x361fbb64
.long 0x3c008000,0x3c008000,0x3c008000,0x3c008000,0x3c008000,0xbc008000,0x3b64b61f,0x3b64361f
.long 0x3c008000,0x3c008000,0x39a8b9a8,0x39a839a8,0x3c008000,0xbc008000,0x361fbb64,0x361f3b64
.long 0x3c008000,0x3c008000,0xbc00,0x80003c00,0x3c008000,0xbc008000,0xb61fbb64,0xb61f3b64
.long 0x3c008000,0x3c008000,0xb9a8b9a8,0xb9a839a8,0x3c008000,0xbc008000,0xbb64b61f,0xbb64361f
.long 0x3c008000,0x3c008000,0xbc008000,0xbc008000,0x3c008000,0xbc008000,0xbb64361f,0xbb64b61f
.long 0x3c008000,0x3c008000,0xb9a839a8,0xb9a8b9a8,0x3c008000,0xbc008000,0xb61f3b64,0xb61fbb64
.long 0x3c008000,0x3c008000,0x80003c00,0xbc00,0x3c008000,0xbc008000,0x361f3b64,0x361fbb64
.long 0x3c008000,0x3c008000,0x39a839a8,0x39a8b9a8,0x3c008000,0xbc008000,0x3b64361f,0x3b64b61f
.long 0x3c008000,0x3c008000,0x3c008000,0x3c008000,0x39a8b9a8,0x39a839a8,0x361fbb64,0x361f3b64
.long 0xbc00,0x80003c00,0xb9a8b9a8,0xb9a839a8,0xb9a8b9a8,0xb9a839a8,0xbb64361f,0xbb64b61f
.long 0xbc008000,0xbc008000,0x80003c00,0xbc00,0xb9a839a8,0xb9a8b9a8,0x3b64361f,0x3b64b61f
.long 0x80003c00,0xbc00,0x39a8b9a8,0x39a839a8,0x39a839a8,0x39a8b9a8,0xb61fbb64,0xb61f3b64
.long 0x3c008000,0x3c008000,0xbc008000,0xbc008000,0x39a8b9a8,0x39a839a8,0xb61f3b64,0xb61fbb64
.long 0xbc00,0x80003c00,0x39a839a8,0x39a8b9a8,0xb9a8b9a8,0xb9a839a8,0x3b64b61f,0x3b64361f
.long 0xbc008000,0xbc008000,0xbc00,0x80003c00,0xb9a839a8,0xb9a8b9a8,0xbb64b61f,0xbb64361f
.long 0x80003c00,0xbc00,0xb9a839a8,0xb9a8b9a8,0x39a839a8,0x39a8b9a8,0x361f3b64,0x361fbb64
.long 0x3c008000,0x3c008000,0x3c008000,0x3c008000,0xbc00,0x80003c00,0xb61fbb64,0xb61f3b64
.long 0xbc008000,0xbc008000,0xb9a839a8,0xb9a8b9a8,0x80003c00,0xbc00,0x3b64361f,0x3b64b61f
.long 0x3c008000,0x3c008000,0xbc00,0x80003c00,0xbc00,0x80003c00,0xbb64361f,0xbb64b61f
.long 0xbc008000,0xbc008000,0x39a839a8,0x39a8b9a8,0x80003c00,0xbc00,0x361fbb64,0x361f3b64
.long 0x3c008000,0x3c008000,0xbc008000,0xbc008000,0xbc00,0x80003c00,0x361f3b64,0x361fbb64
.long 0xbc008000,0xbc008000,0x39a8b9a8,0x39a839a8,0x80003c00,0xbc00,0xbb64b61f,0xbb64361f
.long 0x3c008000,0x3c008000,0x80003c00,0xbc00,0xbc00,0x80003c00,0x3b64b61f,0x3b64361f
.long 0xbc008000,0xbc008000,0xb9a8b9a8,0xb9a839a8,0x80003c00,0xbc00,0xb61f3b64,0xb61fbb64
.long 0x3c008000,0x3c008000,0x3c008000,0x3c008000,0xb9a8b9a8,0xb9a839a8,0xbb64b61f,0xbb64361f
.long 0x80003c00,0xbc00,0x39a839a8,0x39a8b9a8,0x39a8b9a8,0x39a839a8,0xb61fbb64,0xb61f3b64
.long 0xbc008000,0xbc008000,0x80003c00,0xbc00,0x39a839a8,0x39a8b9a8,0x361fbb64,0x361f3b64
.long 0xbc00,0x80003c00,0xb9a839a8,0xb9a8b9a8,0xb9a839a8,0xb9a8b9a8,0x3b64b61f,0x3b64361f
.long 0x3c008000,0x3c008000,0xbc008000,0xbc008000,0xb9a8b9a8,0xb9a839a8,0x3b64361f,0x3b64b61f
.long 0x80003c00,0xbc00,0xb9a8b9a8,0xb9a839a8,0x39a8b9a8,0x39a839a8,0x361f3b64,0x361fbb64
.long 0xbc008000,0xbc008000,0xbc00,0x80003c00,0x39a839a8,0x39a8b9a8,0xb61f3b64,0xb61fbb64
.long 0xbc00,0x80003c00,0x39a8b9a8,0x39a839a8,0xb9a839a8,0xb9a8b9a8,0xbb64361f,0xbb64b61f
.long 0x3800,0x3800,0x3800,0x3800,0x3c00,0xbc00,0x3b64,0x3b64
.long 0x3c00,0x3c00,0x39a8,0x39a8,0x3c00,0xbc00,0x361f,0x361f
.long 0x3c00,0x3c00,0x0,0x8000,0x3c00,0xbc00,0xb61f,0xb61f
.long 0x3c00,0x3c00,0xb9a8,0xb9a8,0x3c00,0xbc00,0xbb64,0xbb64
.long 0x3c000000,0x0,0x3bd90000,0xbbd90000,0x3c000000,0x80000000,0x3aa70000,0xbaa70000
.long 0x3c000000,0x0,0x38720000,0xb8720000,0x3c000000,0x80000000,0x323e0000,0xb23e0000
.long 0x3c000000,0x0,0xb23e0000,0x323e0000,0x3c000000,0x80000000,0xb8720000,0x38720000
.long 0x3c000000,0x0,0xbaa70000,0x3aa70000,0x3c000000,0x80000000,0xbbd90000,0x3bd90000
.long 0x3800,0x3800,0x3800,0x3800,0x39a8,0x39a8,0x361f,0x361f
.long 0x0,0x8000,0xb9a8,0xb9a8,0xb9a8,0xb9a8,0xbb64,0xbb64
.long 0xbc00,0xbc00,0x8000,0x0,0xb9a8,0xb9a8,0x3b64,0x3b64
.long 0x8000,0x0,0x39a8,0x39a8,0x39a8,0x39a8,0xb61f,0xb61f
.long 0x3b640000,0xbb640000,0x3aa70000,0xbaa70000,0x361f0000,0xb61f0000,0xb23e0000,0x323e0000
.long 0xb61f0000,0x361f0000,0xbbd90000,0x3bd90000,0xbb640000,0x3b640000,0xb8720000,0x38720000
.long 0xbb640000,0x3b640000,0x38720000,0xb8720000,0xb61f0000,0x361f0000,0x3bd90000,0xbbd90000
.long 0x361f0000,0xb61f0000,0x323e0000,0xb23e0000,0x3b640000,0xbb640000,0xbaa70000,0x3aa70000
.long 0x3800,0x3800,0x3800,0x3800,0x0,0x8000,0xb61f,0xb61f
.long 0xbc00,0xbc00,0xb9a8,0xb9a8,0x8000,0x0,0x3b64,0x3b64
.long 0x3c00,0x3c00,0x0,0x8000,0x0,0x8000,0xbb64,0xbb64
.long 0xbc00,0xbc00,0x39a8,0x39a8,0x8000,0x0,0x361f,0x361f
.long 0x39a80000,0xb9a80000,0x38720000,0xb8720000,0xb9a80000,0x39a80000,0xbbd90000,0x3bd90000
.long 0xb9a80000,0x39a80000,0x323e0000,0xb23e0000,0x39a80000,0xb9a80000,0x3aa70000,0xbaa70000
.long 0x39a80000,0xb9a80000,0xbaa70000,0x3aa70000,0xb9a80000,0x39a80000,0xb23e0000,0x323e0000
.long 0xb9a80000,0x39a80000,0x3bd90000,0xbbd90000,0x39a80000,0xb9a80000,0xb8720000,0x38720000
.long 0x3800,0x3800,0x3800,0x3800,0xb9a8,0xb9a8,0xbb64,0xbb64
.long 0x8000,0x0,0x39a8,0x39a8,0x39a8,0x39a8,0xb61f,0xb61f
.long 0xbc00,0xbc00,0x8000,0x0,0x39a8,0x39a8,0x361f,0x361f
.long 0x0,0x8000,0xb9a8,0xb9a8,0xb9a8,0xb9a8,0x3b64,0x3b64
.long 0x361f0000,0xb61f0000,0x323e0000,0xb23e0000,0xbb640000,0x3b640000,0xb8720000,0x38720000
.long 0x3b640000,0xbb640000,0x3aa70000,0xbaa70000,0xb61f0000,0x361f0000,0xbbd90000,0x3bd90000
.long 0xb61f0000,0x361f0000,0x3bd90000,0xbbd90000,0x3b640000,0xbb640000,0xbaa70000,0x3aa70000
.long 0xbb640000,0x3b640000,0x38720000,0xb8720000,0x361f0000,0xb61f0000,0xb23e0000,0x323e0000
.long 0x3800,0x3800,0xb800,0xb800,0x8000,0x8000,0xb61f,0x361f
.long 0x8000,0x8000,0xb9a8,0x39a8,0x8000,0x8000,0xbb64,0x3b64
.long 0x8000,0x8000,0xbc00,0x3c00,0x8000,0x8000,0xbb64,0x3b64
.long 0x8000,0x8000,0xb9a8,0x39a8,0x8000,0x8000,0xb61f,0x361f
.long 0x80000000,0xbc000000,0xb23e0000,0xb23e0000,0x80000000,0x3c000000,0xb8720000,0xb8720000
.long 0x80000000,0xbc000000,0xbaa70000,0xbaa70000,0x80000000,0x3c000000,0xbbd90000,0xbbd90000
.long 0x80000000,0xbc000000,0xbbd90000,0xbbd90000,0x80000000,0x3c000000,0xbaa70000,0xbaa70000
.long 0x80000000,0xbc000000,0xb8720000,0xb8720000,0x80000000,0x3c000000,0xb23e0000,0xb23e0000
.long 0x3800,0x3800,0xb800,0xb800,0xb9a8,0x39a8,0xbb64,0x3b64
.long 0xbc00,0x3c00,0xb9a8,0x39a8,0xb9a8,0x39a8,0x361f,0xb61f
.long 0x8000,0x8000,0x3c00,0xbc00,0x39a8,0xb9a8,0x361f,0xb61f
.long 0x3c00,0xbc00,0xb9a8,0x39a8,0x39a8,0xb9a8,0xbb64,0x3b64
.long 0xb61f0000,0xb61f0000,0xb8720000,0xb8720000,0xbb640000,0xbb640000,0xbbd90000,0xbbd90000
.long 0xbb640000,0xbb640000,0xb23e0000,0xb23e0000,0xb61f0000,0xb61f0000,0x3aa70000,0x3aa70000
.long 0x361f0000,0x361f0000,0x3aa70000,0x3aa70000,0x3b640000,0x3b640000,0xb23e0000,0xb23e0000
.long 0x3b640000,0x3b640000,0xbbd90000,0xbbd90000,0x361f0000,0x361f0000,0xb8720000,0xb8720000
.long 0x3800,0x3800,0xb800,0xb800,0xbc00,0x3c00,0xbb64,0x3b64
.long 0x8000,0x8000,0x39a8,0xb9a8,0x3c00,0xbc00,0x361f,0xb61f
.long 0x8000,0x8000,0xbc00,0x3c00,0xbc00,0x3c00,0x361f,0xb61f
.long 0x8000,0x8000,0x39a8,0xb9a8,0x3c00,0xbc00,0xbb64,0x3b64
.long 0xb9a80000,0xb9a80000,0xbaa70000,0xbaa70000,0xb9a80000,0xb9a80000,0xb23e0000,0xb23e0000
.long 0x39a80000,0x39a80000,0x3bd90000,0x3bd90000,0x39a80000,0x39a80000,0xb8720000,0xb8720000
.long 0xb9a80000,0xb9a80000,0xb8720000,0xb8720000,0xb9a80000,0xb9a80000,0x3bd90000,0x3bd90000
.long 0x39a80000,0x39a80000,0xb23e0000,0xb23e0000,0x39a80000,0x39a80000,0xbaa70000,0xbaa70000
.long 0x3800,0x3800,0xb800,0xb800,0xb9a8,0x39a8,0xb61f,0x361f
.long 0x3c00,0xbc00,0x39a8,0xb9a8,0xb9a8,0x39a8,0xbb64,0x3b64
.long 0x8000,0x8000,0x3c00,0xbc00,0x39a8,0xb9a8,0xbb64,0x3b64
.long 0xbc00,0x3c00,0x39a8,0xb9a8,0x39a8,0xb9a8,0xb61f,0x361f
.long 0xbb640000,0xbb640000,0xbbd90000,0xbbd90000,0x361f0000,0x361f0000,0x3aa70000,0x3aa70000
.long 0x361f0000,0x361f0000,0xb8720000,0xb8720000,0xbb640000,0xbb640000,0x323e0000,0x323e0000
.long 0x3b640000,0x3b640000,0x323e0000,0x323e0000,0xb61f0000,0xb61f0000,0xb8720000,0xb8720000
.long 0xb61f0000,0xb61f0000,0x3aa70000,0x3aa70000,0x3b640000,0x3b640000,0xbbd90000,0xbbd90000
tab_end:
.size tables, 36864
.section .rodata,"a"
.p2align 6
.amdhsa_kernel adaLN_cond__spectral_fnet__moe_arch_mod__prompt_kernel
  .amdhsa_next_free_vgpr 256
  .amdhsa_next_free_sgpr 102
  .amdhsa_accum_offset 256
  .amdhsa_group_segment_fixed_size 0
  .amdhsa_kernarg_size 120
  .amdhsa_user_sgpr_count 2
  .amdhsa_user_sgpr_kernarg_segment_ptr 1
  .amdhsa_system_sgpr_workgroup_id_x 1
  .amdhsa_float_denorm_mode_32 3
  .amdhsa_float_denorm_mode_16_64 3
.end_amdhsa_kernel
```
